```python
import torch

def _softmax(x, axis=-1):
    return torch.softmax(x, dim=axis)
def _gelu(x):
    return torch.nn.functional.gelu(x, approximate="tanh")
def _silu(x):
    return torch.nn.functional.silu(x)
def _sigmoid(x):
    return torch.sigmoid(x)
def _layernorm(x, axis=-1, eps=1e-5):
    m = x.mean(dim=axis, keepdim=True)
    v = x.var(dim=axis, keepdim=True, unbiased=False)
    return (x - m) / torch.sqrt(v + eps)
def _scatter_add(tgt, idx, src, axis=0):
    return tgt.clone().index_add_(axis, idx, src)
def _segment_sum(src, seg, n):
    out = torch.zeros((n,) + src.shape[1:], dtype=src.dtype)
    return out.index_add_(0, seg, src)
def _pad(x, pw):
    flat = tuple(v for pair in reversed(pw) for v in pair)
    return torch.nn.functional.pad(x, flat)

kernel_name = 'sequential_preLN__linear_attn_block__moe_arch_mod__prompt'

def setup_inputs():

    _w = (lambda a: (lambda t: t.to(torch.bfloat16) if t.is_floating_point() else t)(torch.as_tensor(a)))
    def _A_setup():
        B, S, D = 1, 2048, 1024
        return {
            "x": _w((lambda *s: torch.randn(*s, dtype=torch.bfloat16) * 0.05)(B, S, D)),
            "wqkv": _w((lambda *s: torch.randn(*s, dtype=torch.bfloat16) * 0.05)(D, 3 * D)),
            "wo": _w((lambda *s: torch.randn(*s, dtype=torch.bfloat16) * 0.05)(D, D)),
        }
    _A_in = _A_setup()

    def _B_setup():
        B, S, D, F, C = 1, 2048, 1024, 3584, 2
        return {
            "x": _w((lambda *s: torch.randn(*s, dtype=torch.bfloat16) * 0.05)(B, S, D)),
            "w_r": _w((lambda *s: torch.randn(*s, dtype=torch.bfloat16) * 0.05)(D)),
            "w_gate": _w((lambda *s: torch.randn(*s, dtype=torch.bfloat16) * 0.05)(D, F)),
            "w_up": _w((lambda *s: torch.randn(*s, dtype=torch.bfloat16) * 0.05)(D, F)),
            "w_down": _w((lambda *s: torch.randn(*s, dtype=torch.bfloat16) * 0.05)(F, D)),
        }
    _B_in = _B_setup()

    return {
        "A_x": _A_in["x"],
        "A_wqkv": _A_in["wqkv"],
        "A_wo": _A_in["wo"],
        "B_x": _B_in["x"],
        "B_w_r": _B_in["w_r"],
        "B_w_gate": _B_in["w_gate"],
        "B_w_up": _B_in["w_up"],
        "B_w_down": _B_in["w_down"],
    }

def reference(A_x, A_wqkv, A_wo, B_x, B_w_r, B_w_gate, B_w_up, B_w_down):
    def _A_ref(x, wqkv, wo):
        B, S, D = x.shape
        H = 32; Dh = D // H
        qkv = (lambda x, *d: x.permute(*d))((x @ wqkv).reshape(B, S, 3, H, Dh), 2, 0, 3, 1, 4)
        q, k, v = qkv[0], qkv[1], qkv[2]
        phi = lambda t: torch.where(t > 0, t + 1, torch.exp(t)) + 1e-6
        pq, pk = phi(q), phi(k)
        kv = torch.einsum("bhsd,bhse->bhde", pk, v)
        z = torch.einsum("bhsd->bhd", pk)
        num = torch.einsum("bhqd,bhde->bhqe", pq, kv)
        den = torch.einsum("bhqd,bhd->bhq", pq, z)[..., None] + 1e-6
        o = num / den
        return (lambda x, *d: x.permute(*d))(o, 0, 2, 1, 3).reshape(B, S, D) @ wo

    def _B_ref(x, w_r, w_gate, w_up, w_down):
        B, S, D = x.shape
        C = 2
        r = x @ w_r
        idx = torch.argsort(-r, axis=-1)[:, :C]
        idx_e = (lambda x, n, axis: torch.repeat_interleave(x, n, dim=axis))(idx.reshape(B, C, 1), D, axis=2)
        x_sel = (lambda x, i, axis: torch.take_along_dim(x, i, dim=axis))(x, idx_e, axis=1)
        g = _silu(x_sel @ w_gate)
        u = x_sel @ w_up
        y = (g * u) @ w_down
        r_sel = _sigmoid((lambda x, i, axis: torch.take_along_dim(x, i, dim=axis))(r, idx, axis=1))
        y = y * r_sel.reshape(B, C, 1)
        b_off = (torch.arange(B) * S).reshape(B, 1)
        flat_idx = (idx + b_off).reshape(B * C)
        zero = (x * 0.0).reshape(B * S, D)
        upd = _scatter_add(zero, flat_idx, y.reshape(B * C, D), axis=0)
        return x + upd.reshape(B, S, D)

    x = A_x
    h = x + _A_ref(_layernorm(x, axis=-1), A_wqkv, A_wo)
    h2 = h + _B_ref(_layernorm(h, axis=-1), B_w_r, B_w_gate, B_w_up, B_w_down)
    return h2
```

```asm
; @launch grid=(256,1,1) block=(512,1,1) lds=163840
.amdgcn_target "amdgcn-amd-amdhsa--gfx950"
.text
.globl sequential_preLN__linear_attn_block__moe_arch_mod__prompt_kernel
.p2align 8
.type sequential_preLN__linear_attn_block__moe_arch_mod__prompt_kernel,@function
sequential_preLN__linear_attn_block__moe_arch_mod__prompt_kernel:
s_cmp_ge_u32 s2, 256
s_cbranch_scc1 L_end
s_load_dwordx16 s[40:55], s[0:1], 0
s_load_dwordx2 s[56:57], s[0:1], 64
s_load_dwordx2 s[58:59], s[0:1], 80
v_lshrrev_b32 v2, 6, v0
v_and_b32 v1, 63, v0
v_readfirstlane_b32 s60, v2
s_and_b32 s62, s2, 7
s_lshr_b32 s63, s2, 3
s_lshl_b32 s64, s62, 1
s_and_b32 s70, s63, 1
s_add_u32 s64, s64, s70
s_lshr_b32 s65, s63, 1
s_mul_i32 s79, s62, 28
s_add_u32 s79, s79, s63
s_mov_b32 s78, 0
s_lshr_b32 s61, s60, 2
s_and_b32 s60, s60, 3
s_lshr_b32 s66, s60, 1
s_and_b32 s67, s60, 1
v_lshlrev_b32 v16, 4, v1
s_cmp_eq_u32 s61, 0
s_cbranch_scc1 L_compute
v_mov_b32 v18, v16
s_lshl_b32 s70, s65, 2
s_add_u32 s70, s70, s60
s_lshl_b32 s70, s70, 16
v_lshrrev_b32 v2, 3, v1
v_lshlrev_b32 v5, 11, v2
v_add_u32 v5, s70, v5
v_lshrrev_b32 v3, 4, v1
v_and_b32 v4, 7, v1
v_xor_b32 v3, v3, v4
v_xor_b32 v6, 0, v3
v_lshl_add_u32 v6, v6, 4, v5
v_add_u32 v8, 0, v6
v_xor_b32 v6, 4, v3
v_lshl_add_u32 v6, v6, 4, v5
v_add_u32 v9, 15360, v6
v_xor_b32 v6, 0, v3
v_lshl_add_u32 v6, v6, 4, v5
v_add_u32 v10, 30720, v6
v_xor_b32 v6, 4, v3
v_lshl_add_u32 v6, v6, 4, v5
v_add_u32 v11, 46080, v6
s_lshl_b32 s70, s60, 4
v_add_u32 v5, s70, v2
v_mul_u32_u24 v5, 6144, v5
s_lshl_b32 s70, s64, 7
v_add_u32 v5, s70, v5
v_bfe_u32 v3, v1, 4, 1
v_lshlrev_b32 v3, 1, v3
v_xor_b32 v3, v3, v4
v_xor_b32 v6, 0, v3
v_lshl_add_u32 v6, v6, 4, v5
v_add_u32 v12, 0, v6
v_xor_b32 v6, 4, v3
v_lshl_add_u32 v6, v6, 4, v5
v_add_u32 v13, 48128, v6
v_xor_b32 v6, 0, v3
v_lshl_add_u32 v6, v6, 4, v5
v_add_u32 v14, 0, v6
v_xor_b32 v6, 4, v3
v_lshl_add_u32 v6, v6, 4, v5
v_add_u32 v15, 48128, v6
v_xor_b32 v6, 0, v3
v_lshl_add_u32 v6, v6, 4, v5
v_add_u32 v16, 4096, v6
v_xor_b32 v6, 4, v3
v_lshl_add_u32 v6, v6, 4, v5
v_add_u32 v17, 52224, v6
s_lshl_b32 s76, s60, 12
s_mul_i32 s77, s60, 6144
s_add_u32 s77, s77, 16384
s_mul_i32 s75, s65, 393216
s_lshl_b32 s74, s65, 7
s_waitcnt lgkmcnt(0)
s_mov_b32 s4, s40
s_and_b32 s5, s41, 0xffff
s_mov_b32 s6, 4194304
s_mov_b32 s7, 0x20000
s_mov_b32 s8, s42
s_and_b32 s9, s43, 0xffff
s_mov_b32 s10, 6291456
s_mov_b32 s11, 0x20000
s_add_u32 m0, s76, 0
s_nop 0
buffer_load_dwordx4 v8, s[4:7], s74 offen offset:0 lds
buffer_load_dwordx4 v9, s[4:7], s74 offen offset:1024 lds
buffer_load_dwordx4 v10, s[4:7], s74 offen offset:2048 lds
buffer_load_dwordx4 v11, s[4:7], s74 offen offset:3072 lds
s_add_u32 m0, s77, 0
s_nop 0
buffer_load_dwordx4 v12, s[8:11], s75 offen offset:0 lds
buffer_load_dwordx4 v13, s[8:11], s75 offen offset:1024 lds
buffer_load_dwordx4 v14, s[8:11], s75 offen offset:2048 lds
buffer_load_dwordx4 v15, s[8:11], s75 offen offset:3072 lds
s_add_u32 m0, s77, 4096
s_nop 0
buffer_load_dwordx4 v16, s[8:11], s75 offen offset:0 lds
buffer_load_dwordx4 v17, s[8:11], s75 offen offset:1024 lds
s_add_u32 s74, s74, 128
s_add_u32 s75, s75, 393216
s_and_b32 s74, s74, 2047
s_cselect_b32 s75, s75, 0
s_add_u32 m0, s76, 40960
s_nop 0
buffer_load_dwordx4 v8, s[4:7], s74 offen offset:0 lds
buffer_load_dwordx4 v9, s[4:7], s74 offen offset:1024 lds
buffer_load_dwordx4 v10, s[4:7], s74 offen offset:2048 lds
buffer_load_dwordx4 v11, s[4:7], s74 offen offset:3072 lds
s_mov_b32 s12, s58
s_and_b32 s13, s59, 0xffff
s_mov_b32 s14, 268435456
s_mov_b32 s15, 0x20000
s_mov_b32 s16, s44
s_and_b32 s17, s45, 0xffff
s_mov_b32 s18, 2097152
s_mov_b32 s19, 0x20000
s_mov_b32 s20, s56
s_and_b32 s21, s57, 0xffff
s_mov_b32 s22, 4194304
s_mov_b32 s23, 0x20000
s_mov_b32 s24, s50
s_and_b32 s25, s51, 0xffff
s_mov_b32 s26, 7340032
s_mov_b32 s27, 0x20000
s_mov_b32 s28, s52
s_and_b32 s29, s53, 0xffff
s_mov_b32 s30, 7340032
s_mov_b32 s31, 0x20000
s_mov_b32 s32, s54
s_and_b32 s33, s55, 0xffff
s_mov_b32 s34, 7340032
s_mov_b32 s35, 0x20000
s_waitcnt vmcnt(4)
s_barrier
s_add_u32 m0, s77, 40960
s_nop 0
buffer_load_dwordx4 v12, s[8:11], s75 offen offset:0 lds
buffer_load_dwordx4 v13, s[8:11], s75 offen offset:1024 lds
buffer_load_dwordx4 v14, s[8:11], s75 offen offset:2048 lds
buffer_load_dwordx4 v15, s[8:11], s75 offen offset:3072 lds
s_add_u32 m0, s77, 45056
s_nop 0
buffer_load_dwordx4 v16, s[8:11], s75 offen offset:0 lds
buffer_load_dwordx4 v17, s[8:11], s75 offen offset:1024 lds
s_add_u32 s74, s74, 128
s_add_u32 s75, s75, 393216
s_and_b32 s74, s74, 2047
s_cselect_b32 s75, s75, 0
s_add_u32 m0, s76, 81920
s_nop 0
buffer_load_dwordx4 v8, s[4:7], s74 offen offset:0 lds
buffer_load_dwordx4 v9, s[4:7], s74 offen offset:1024 lds
buffer_load_dwordx4 v10, s[4:7], s74 offen offset:2048 lds
buffer_load_dwordx4 v11, s[4:7], s74 offen offset:3072 lds
s_add_u32 m0, s77, 81920
s_nop 0
buffer_load_dwordx4 v12, s[8:11], s75 offen offset:0 lds
buffer_load_dwordx4 v13, s[8:11], s75 offen offset:1024 lds
buffer_load_dwordx4 v14, s[8:11], s75 offen offset:2048 lds
buffer_load_dwordx4 v15, s[8:11], s75 offen offset:3072 lds
s_add_u32 m0, s77, 86016
s_nop 0
buffer_load_dwordx4 v16, s[8:11], s75 offen offset:0 lds
buffer_load_dwordx4 v17, s[8:11], s75 offen offset:1024 lds
s_add_u32 s74, s74, 128
s_add_u32 s75, s75, 393216
s_and_b32 s74, s74, 2047
s_cselect_b32 s75, s75, 0
s_waitcnt vmcnt(10)
s_barrier
s_add_u32 m0, s76, 0
s_nop 0
buffer_load_dwordx4 v8, s[4:7], s74 offen offset:0 lds
buffer_load_dwordx4 v9, s[4:7], s74 offen offset:1024 lds
buffer_load_dwordx4 v10, s[4:7], s74 offen offset:2048 lds
buffer_load_dwordx4 v11, s[4:7], s74 offen offset:3072 lds
s_add_u32 m0, s77, 0
s_nop 0
buffer_load_dwordx4 v12, s[8:11], s75 offen offset:0 lds
buffer_load_dwordx4 v13, s[8:11], s75 offen offset:1024 lds
buffer_load_dwordx4 v14, s[8:11], s75 offen offset:2048 lds
buffer_load_dwordx4 v15, s[8:11], s75 offen offset:3072 lds
s_add_u32 m0, s77, 4096
s_nop 0
buffer_load_dwordx4 v16, s[8:11], s75 offen offset:0 lds
buffer_load_dwordx4 v17, s[8:11], s75 offen offset:1024 lds
s_add_u32 s74, s74, 128
s_add_u32 s75, s75, 393216
s_and_b32 s74, s74, 2047
s_cselect_b32 s75, s75, 0
s_lshl_b32 s70, s65, 7
s_lshl_b32 s71, s64, 3
s_add_u32 s70, s70, s71
s_lshl_b32 s71, s60, 1
s_add_u32 s87, s70, s71
s_lshl_b32 s70, s87, 11
v_mov_b32 v2, 0
buffer_load_dword v19, v2, s[12:15], 0 offen sc1
buffer_load_dwordx4 v[20:23], v18, s[4:7], s70 offen offset:0
buffer_load_dwordx4 v[24:27], v18, s[4:7], s70 offen offset:1024
buffer_load_dwordx4 v[28:31], v18, s[4:7], s70 offen offset:2048
buffer_load_dwordx4 v[32:35], v18, s[4:7], s70 offen offset:3072
s_waitcnt vmcnt(15)
s_barrier
s_add_u32 m0, s76, 40960
s_nop 0
buffer_load_dwordx4 v8, s[4:7], s74 offen offset:0 lds
buffer_load_dwordx4 v9, s[4:7], s74 offen offset:1024 lds
buffer_load_dwordx4 v10, s[4:7], s74 offen offset:2048 lds
buffer_load_dwordx4 v11, s[4:7], s74 offen offset:3072 lds
s_add_u32 m0, s77, 40960
s_nop 0
buffer_load_dwordx4 v12, s[8:11], s75 offen offset:0 lds
buffer_load_dwordx4 v13, s[8:11], s75 offen offset:1024 lds
buffer_load_dwordx4 v14, s[8:11], s75 offen offset:2048 lds
buffer_load_dwordx4 v15, s[8:11], s75 offen offset:3072 lds
s_add_u32 m0, s77, 45056
s_nop 0
buffer_load_dwordx4 v16, s[8:11], s75 offen offset:0 lds
buffer_load_dwordx4 v17, s[8:11], s75 offen offset:1024 lds
s_add_u32 s74, s74, 128
s_add_u32 s75, s75, 393216
s_and_b32 s74, s74, 2047
s_cselect_b32 s75, s75, 0
s_waitcnt vmcnt(15)
s_barrier
s_add_u32 m0, s76, 81920
s_nop 0
buffer_load_dwordx4 v8, s[4:7], s74 offen offset:0 lds
buffer_load_dwordx4 v9, s[4:7], s74 offen offset:1024 lds
buffer_load_dwordx4 v10, s[4:7], s74 offen offset:2048 lds
buffer_load_dwordx4 v11, s[4:7], s74 offen offset:3072 lds
s_add_u32 m0, s77, 81920
s_nop 0
buffer_load_dwordx4 v12, s[8:11], s75 offen offset:0 lds
buffer_load_dwordx4 v13, s[8:11], s75 offen offset:1024 lds
buffer_load_dwordx4 v14, s[8:11], s75 offen offset:2048 lds
buffer_load_dwordx4 v15, s[8:11], s75 offen offset:3072 lds
s_add_u32 m0, s77, 86016
s_nop 0
buffer_load_dwordx4 v16, s[8:11], s75 offen offset:0 lds
buffer_load_dwordx4 v17, s[8:11], s75 offen offset:1024 lds
s_add_u32 s74, s74, 128
s_add_u32 s75, s75, 393216
s_and_b32 s74, s74, 2047
s_cselect_b32 s75, s75, 0
s_waitcnt vmcnt(20)
v_readfirstlane_b32 s68, v19
v_lshlrev_b32 v36, 16, v20
v_and_b32 v37, 0xffff0000, v20
v_lshlrev_b32 v38, 16, v21
v_and_b32 v39, 0xffff0000, v21
v_lshlrev_b32 v40, 16, v22
v_and_b32 v41, 0xffff0000, v22
v_lshlrev_b32 v42, 16, v23
v_and_b32 v43, 0xffff0000, v23
v_lshlrev_b32 v44, 16, v24
v_and_b32 v45, 0xffff0000, v24
v_lshlrev_b32 v46, 16, v25
v_and_b32 v47, 0xffff0000, v25
v_lshlrev_b32 v48, 16, v26
v_and_b32 v49, 0xffff0000, v26
v_lshlrev_b32 v50, 16, v27
v_and_b32 v51, 0xffff0000, v27
v_lshlrev_b32 v52, 16, v28
v_and_b32 v53, 0xffff0000, v28
v_lshlrev_b32 v54, 16, v29
v_and_b32 v55, 0xffff0000, v29
v_lshlrev_b32 v56, 16, v30
v_and_b32 v57, 0xffff0000, v30
v_lshlrev_b32 v58, 16, v31
v_and_b32 v59, 0xffff0000, v31
v_lshlrev_b32 v60, 16, v32
v_and_b32 v61, 0xffff0000, v32
v_lshlrev_b32 v62, 16, v33
v_and_b32 v63, 0xffff0000, v33
v_lshlrev_b32 v64, 16, v34
v_and_b32 v65, 0xffff0000, v34
v_lshlrev_b32 v66, 16, v35
v_and_b32 v67, 0xffff0000, v35
s_add_u32 s68, s68, 1
v_pk_add_f32 v[20:21], v[36:37], v[38:39]
v_pk_add_f32 v[22:23], v[40:41], v[42:43]
v_pk_add_f32 v[24:25], v[44:45], v[46:47]
v_pk_add_f32 v[26:27], v[48:49], v[50:51]
v_pk_add_f32 v[20:21], v[20:21], v[22:23]
v_pk_add_f32 v[24:25], v[24:25], v[26:27]
v_pk_add_f32 v[20:21], v[20:21], v[24:25]
v_add_f32 v2, v20, v21
v_pk_add_f32 v[28:29], v[52:53], v[54:55]
v_pk_add_f32 v[30:31], v[56:57], v[58:59]
v_pk_add_f32 v[32:33], v[60:61], v[62:63]
v_pk_add_f32 v[34:35], v[64:65], v[66:67]
v_pk_add_f32 v[28:29], v[28:29], v[30:31]
v_pk_add_f32 v[32:33], v[32:33], v[34:35]
v_pk_add_f32 v[28:29], v[28:29], v[32:33]
v_add_f32 v4, v28, v29
v_add_f32_dpp v2, v2, v2 row_ror:1 row_mask:0xf bank_mask:0xf
s_nop 0
v_add_f32_dpp v4, v4, v4 row_ror:1 row_mask:0xf bank_mask:0xf
v_add_f32_dpp v2, v2, v2 row_ror:2 row_mask:0xf bank_mask:0xf
s_nop 0
v_add_f32_dpp v4, v4, v4 row_ror:2 row_mask:0xf bank_mask:0xf
v_add_f32_dpp v2, v2, v2 row_ror:4 row_mask:0xf bank_mask:0xf
s_nop 0
v_add_f32_dpp v4, v4, v4 row_ror:4 row_mask:0xf bank_mask:0xf
v_add_f32_dpp v2, v2, v2 row_ror:8 row_mask:0xf bank_mask:0xf
s_nop 0
v_add_f32_dpp v4, v4, v4 row_ror:8 row_mask:0xf bank_mask:0xf
v_mov_b32 v6, v2
v_mov_b32 v7, v4
s_nop 0
v_permlane16_swap_b32 v2, v6
v_permlane16_swap_b32 v4, v7
v_add_f32 v2, v2, v6
v_add_f32 v4, v4, v7
v_mov_b32 v6, v2
v_mov_b32 v7, v4
s_nop 0
v_permlane32_swap_b32 v2, v6
v_permlane32_swap_b32 v4, v7
v_add_f32 v2, v2, v6
v_add_f32 v4, v4, v7
v_mul_f32 v2, 0xba800000, v2
v_mul_f32 v4, 0xba800000, v4
s_waitcnt vmcnt(10)
s_barrier
s_add_u32 m0, s76, 0
s_nop 0
buffer_load_dwordx4 v8, s[4:7], s74 offen offset:0 lds
buffer_load_dwordx4 v9, s[4:7], s74 offen offset:1024 lds
buffer_load_dwordx4 v10, s[4:7], s74 offen offset:2048 lds
buffer_load_dwordx4 v11, s[4:7], s74 offen offset:3072 lds
s_add_u32 m0, s77, 0
s_nop 0
buffer_load_dwordx4 v12, s[8:11], s75 offen offset:0 lds
buffer_load_dwordx4 v13, s[8:11], s75 offen offset:1024 lds
buffer_load_dwordx4 v14, s[8:11], s75 offen offset:2048 lds
buffer_load_dwordx4 v15, s[8:11], s75 offen offset:3072 lds
s_add_u32 m0, s77, 4096
s_nop 0
buffer_load_dwordx4 v16, s[8:11], s75 offen offset:0 lds
buffer_load_dwordx4 v17, s[8:11], s75 offen offset:1024 lds
s_add_u32 s74, s74, 128
s_add_u32 s75, s75, 393216
s_and_b32 s74, s74, 2047
s_cselect_b32 s75, s75, 0
v_pk_add_f32 v[36:37], v[36:37], v[2:3] op_sel_hi:[1,0]
v_pk_add_f32 v[38:39], v[38:39], v[2:3] op_sel_hi:[1,0]
v_pk_add_f32 v[40:41], v[40:41], v[2:3] op_sel_hi:[1,0]
v_pk_add_f32 v[42:43], v[42:43], v[2:3] op_sel_hi:[1,0]
v_pk_add_f32 v[44:45], v[44:45], v[2:3] op_sel_hi:[1,0]
v_pk_add_f32 v[46:47], v[46:47], v[2:3] op_sel_hi:[1,0]
v_pk_add_f32 v[48:49], v[48:49], v[2:3] op_sel_hi:[1,0]
v_pk_add_f32 v[50:51], v[50:51], v[2:3] op_sel_hi:[1,0]
v_pk_mul_f32 v[20:21], v[36:37], v[36:37]
v_pk_mul_f32 v[22:23], v[38:39], v[38:39]
v_pk_fma_f32 v[20:21], v[40:41], v[40:41], v[20:21]
v_pk_fma_f32 v[22:23], v[42:43], v[42:43], v[22:23]
v_pk_fma_f32 v[20:21], v[44:45], v[44:45], v[20:21]
v_pk_fma_f32 v[22:23], v[46:47], v[46:47], v[22:23]
v_pk_fma_f32 v[20:21], v[48:49], v[48:49], v[20:21]
v_pk_fma_f32 v[22:23], v[50:51], v[50:51], v[22:23]
v_pk_add_f32 v[20:21], v[20:21], v[22:23]
v_add_f32 v3, v20, v21
v_pk_add_f32 v[52:53], v[52:53], v[4:5] op_sel_hi:[1,0]
v_pk_add_f32 v[54:55], v[54:55], v[4:5] op_sel_hi:[1,0]
v_pk_add_f32 v[56:57], v[56:57], v[4:5] op_sel_hi:[1,0]
v_pk_add_f32 v[58:59], v[58:59], v[4:5] op_sel_hi:[1,0]
v_pk_add_f32 v[60:61], v[60:61], v[4:5] op_sel_hi:[1,0]
v_pk_add_f32 v[62:63], v[62:63], v[4:5] op_sel_hi:[1,0]
v_pk_add_f32 v[64:65], v[64:65], v[4:5] op_sel_hi:[1,0]
v_pk_add_f32 v[66:67], v[66:67], v[4:5] op_sel_hi:[1,0]
v_pk_mul_f32 v[28:29], v[52:53], v[52:53]
v_pk_mul_f32 v[30:31], v[54:55], v[54:55]
v_pk_fma_f32 v[28:29], v[56:57], v[56:57], v[28:29]
v_pk_fma_f32 v[30:31], v[58:59], v[58:59], v[30:31]
v_pk_fma_f32 v[28:29], v[60:61], v[60:61], v[28:29]
v_pk_fma_f32 v[30:31], v[62:63], v[62:63], v[30:31]
v_pk_fma_f32 v[28:29], v[64:65], v[64:65], v[28:29]
v_pk_fma_f32 v[30:31], v[66:67], v[66:67], v[30:31]
v_pk_add_f32 v[28:29], v[28:29], v[30:31]
v_add_f32 v5, v28, v29
v_add_f32_dpp v3, v3, v3 row_ror:1 row_mask:0xf bank_mask:0xf
s_nop 0
v_add_f32_dpp v5, v5, v5 row_ror:1 row_mask:0xf bank_mask:0xf
v_add_f32_dpp v3, v3, v3 row_ror:2 row_mask:0xf bank_mask:0xf
s_nop 0
v_add_f32_dpp v5, v5, v5 row_ror:2 row_mask:0xf bank_mask:0xf
v_add_f32_dpp v3, v3, v3 row_ror:4 row_mask:0xf bank_mask:0xf
s_nop 0
v_add_f32_dpp v5, v5, v5 row_ror:4 row_mask:0xf bank_mask:0xf
v_add_f32_dpp v3, v3, v3 row_ror:8 row_mask:0xf bank_mask:0xf
s_nop 0
v_add_f32_dpp v5, v5, v5 row_ror:8 row_mask:0xf bank_mask:0xf
v_mov_b32 v6, v3
v_mov_b32 v7, v5
s_nop 0
v_permlane16_swap_b32 v3, v6
v_permlane16_swap_b32 v5, v7
v_add_f32 v3, v3, v6
v_add_f32 v5, v5, v7
v_mov_b32 v6, v3
v_mov_b32 v7, v5
s_nop 0
v_permlane32_swap_b32 v3, v6
v_permlane32_swap_b32 v5, v7
v_add_f32 v3, v3, v6
v_add_f32 v5, v5, v7
v_mov_b32 v6, 0x3727c5ac
v_fmac_f32 v6, 0x3a800000, v3
v_rsq_f32 v3, v6
v_mov_b32 v6, 0x3727c5ac
v_fmac_f32 v6, 0x3a800000, v5
v_rsq_f32 v5, v6
v_cmp_eq_u32 vcc, 1, v1
s_nop 1
v_cndmask_b32 v20, v2, v4, vcc
v_cndmask_b32 v21, v3, v5, vcc
v_mov_b32 v22, 0
v_mov_b32 v23, s68
s_lshl_b32 s70, s87, 4
s_add_u32 s70, s70, 8192
s_mov_b64 exec, 3
buffer_store_dwordx4 v[20:23], v18, s[12:15], s70 offen sc1
s_mov_b64 exec, -1
s_waitcnt vmcnt(11)
s_barrier
s_add_u32 m0, s76, 40960
s_nop 0
buffer_load_dwordx4 v8, s[4:7], s74 offen offset:0 lds
buffer_load_dwordx4 v9, s[4:7], s74 offen offset:1024 lds
buffer_load_dwordx4 v10, s[4:7], s74 offen offset:2048 lds
buffer_load_dwordx4 v11, s[4:7], s74 offen offset:3072 lds
s_add_u32 m0, s77, 40960
s_nop 0
buffer_load_dwordx4 v12, s[8:11], s75 offen offset:0 lds
buffer_load_dwordx4 v13, s[8:11], s75 offen offset:1024 lds
buffer_load_dwordx4 v14, s[8:11], s75 offen offset:2048 lds
buffer_load_dwordx4 v15, s[8:11], s75 offen offset:3072 lds
s_add_u32 m0, s77, 45056
s_nop 0
buffer_load_dwordx4 v16, s[8:11], s75 offen offset:0 lds
buffer_load_dwordx4 v17, s[8:11], s75 offen offset:1024 lds
s_add_u32 s74, s74, 128
s_add_u32 s75, s75, 393216
s_and_b32 s74, s74, 2047
s_cselect_b32 s75, s75, 0
s_getreg_b32 s71, hwreg(HW_REG_XCC_ID, 0, 4)
v_mov_b32 v24, s71
v_mov_b32 v25, 0
v_mov_b32 v26, 0
v_mov_b32 v27, s68
s_lshl_b32 s70, s64, 4
s_add_u32 s70, s70, s65
s_lshl_b32 s70, s70, 4
s_add_u32 s70, s70, 4096
s_mov_b64 exec, 1
buffer_store_dwordx4 v[24:27], v18, s[12:15], s70 offen sc1
s_mov_b64 exec, -1
s_waitcnt vmcnt(12)
s_barrier
s_add_u32 m0, s76, 81920
s_nop 0
buffer_load_dwordx4 v8, s[4:7], s74 offen offset:0 lds
buffer_load_dwordx4 v9, s[4:7], s74 offen offset:1024 lds
buffer_load_dwordx4 v10, s[4:7], s74 offen offset:2048 lds
buffer_load_dwordx4 v11, s[4:7], s74 offen offset:3072 lds
s_add_u32 m0, s77, 81920
s_nop 0
buffer_load_dwordx4 v12, s[8:11], s75 offen offset:0 lds
buffer_load_dwordx4 v13, s[8:11], s75 offen offset:1024 lds
buffer_load_dwordx4 v14, s[8:11], s75 offen offset:2048 lds
buffer_load_dwordx4 v15, s[8:11], s75 offen offset:3072 lds
s_add_u32 m0, s77, 86016
s_nop 0
buffer_load_dwordx4 v16, s[8:11], s75 offen offset:0 lds
buffer_load_dwordx4 v17, s[8:11], s75 offen offset:1024 lds
s_add_u32 s74, s74, 128
s_add_u32 s75, s75, 393216
s_and_b32 s74, s74, 2047
s_cselect_b32 s75, s75, 0
s_waitcnt vmcnt(11)
s_barrier
s_add_u32 m0, s76, 0
s_nop 0
buffer_load_dwordx4 v8, s[4:7], s74 offen offset:0 lds
buffer_load_dwordx4 v9, s[4:7], s74 offen offset:1024 lds
buffer_load_dwordx4 v10, s[4:7], s74 offen offset:2048 lds
buffer_load_dwordx4 v11, s[4:7], s74 offen offset:3072 lds
s_add_u32 m0, s77, 0
s_nop 0
buffer_load_dwordx4 v12, s[8:11], s75 offen offset:0 lds
buffer_load_dwordx4 v13, s[8:11], s75 offen offset:1024 lds
buffer_load_dwordx4 v14, s[8:11], s75 offen offset:2048 lds
buffer_load_dwordx4 v15, s[8:11], s75 offen offset:3072 lds
s_add_u32 m0, s77, 4096
s_nop 0
buffer_load_dwordx4 v16, s[8:11], s75 offen offset:0 lds
buffer_load_dwordx4 v17, s[8:11], s75 offen offset:1024 lds
s_add_u32 s74, s74, 128
s_add_u32 s75, s75, 393216
s_and_b32 s74, s74, 2047
s_cselect_b32 s75, s75, 0
s_waitcnt vmcnt(10)
s_barrier
s_add_u32 m0, s76, 40960
s_nop 0
buffer_load_dwordx4 v8, s[4:7], s74 offen offset:0 lds
buffer_load_dwordx4 v9, s[4:7], s74 offen offset:1024 lds
buffer_load_dwordx4 v10, s[4:7], s74 offen offset:2048 lds
buffer_load_dwordx4 v11, s[4:7], s74 offen offset:3072 lds
s_add_u32 m0, s77, 40960
s_nop 0
buffer_load_dwordx4 v12, s[8:11], s75 offen offset:0 lds
buffer_load_dwordx4 v13, s[8:11], s75 offen offset:1024 lds
buffer_load_dwordx4 v14, s[8:11], s75 offen offset:2048 lds
buffer_load_dwordx4 v15, s[8:11], s75 offen offset:3072 lds
s_add_u32 m0, s77, 45056
s_nop 0
buffer_load_dwordx4 v16, s[8:11], s75 offen offset:0 lds
buffer_load_dwordx4 v17, s[8:11], s75 offen offset:1024 lds
s_add_u32 s74, s74, 128
s_add_u32 s75, s75, 393216
s_and_b32 s74, s74, 2047
s_cselect_b32 s75, s75, 0
v_lshrrev_b32 v2, 3, v1
v_lshlrev_b32 v2, 11, v2
v_bfe_u32 v3, v1, 4, 2
v_lshlrev_b32 v3, 1, v3
v_and_b32 v4, 7, v1
v_xor_b32 v3, v3, v4
v_lshl_add_u32 v2, v3, 4, v2
s_lshl_b32 s70, s65, 7
v_add_u32 v48, s70, v2
v_add_u32 v49, 15360, v48
v_add_u32 v50, 30720, v48
v_add_u32 v51, 46080, v48
s_waitcnt vmcnt(10)
s_barrier
s_add_u32 m0, s76, 81920
s_nop 0
buffer_load_dwordx4 v8, s[4:7], s74 offen offset:0 lds
buffer_load_dwordx4 v9, s[4:7], s74 offen offset:1024 lds
buffer_load_dwordx4 v10, s[4:7], s74 offen offset:2048 lds
buffer_load_dwordx4 v11, s[4:7], s74 offen offset:3072 lds
s_add_u32 m0, s77, 81920
s_nop 0
buffer_load_dwordx4 v12, s[8:11], s75 offen offset:0 lds
buffer_load_dwordx4 v13, s[8:11], s75 offen offset:1024 lds
buffer_load_dwordx4 v14, s[8:11], s75 offen offset:2048 lds
buffer_load_dwordx4 v15, s[8:11], s75 offen offset:3072 lds
s_add_u32 m0, s77, 86016
s_nop 0
buffer_load_dwordx4 v16, s[8:11], s75 offen offset:0 lds
buffer_load_dwordx4 v17, s[8:11], s75 offen offset:1024 lds
s_add_u32 s74, s74, 128
s_add_u32 s75, s75, 393216
s_and_b32 s74, s74, 2047
s_cselect_b32 s75, s75, 0
s_waitcnt vmcnt(10)
s_barrier
s_add_u32 m0, s76, 0
s_nop 0
buffer_load_dwordx4 v8, s[4:7], s74 offen offset:0 lds
buffer_load_dwordx4 v9, s[4:7], s74 offen offset:1024 lds
buffer_load_dwordx4 v10, s[4:7], s74 offen offset:2048 lds
buffer_load_dwordx4 v11, s[4:7], s74 offen offset:3072 lds
s_add_u32 m0, s77, 0
s_nop 0
buffer_load_dwordx4 v12, s[8:11], s75 offen offset:0 lds
buffer_load_dwordx4 v13, s[8:11], s75 offen offset:1024 lds
buffer_load_dwordx4 v14, s[8:11], s75 offen offset:2048 lds
buffer_load_dwordx4 v15, s[8:11], s75 offen offset:3072 lds
s_add_u32 m0, s77, 4096
s_nop 0
buffer_load_dwordx4 v16, s[8:11], s75 offen offset:0 lds
buffer_load_dwordx4 v17, s[8:11], s75 offen offset:1024 lds
s_add_u32 s74, s74, 128
s_add_u32 s75, s75, 393216
s_and_b32 s74, s74, 2047
s_cselect_b32 s75, s75, 0
v_lshrrev_b32 v2, 4, v1
v_and_b32 v3, 15, v1
v_lshlrev_b32 v44, 10, v2
v_lshl_add_u32 v44, v3, 4, v44
s_lshl_b32 s70, s60, 8
v_add_u32 v44, s70, v44
s_lshl_b32 s87, s64, 14
s_add_u32 s87, s87, 65536
v_and_b32 v45, 31, v1
v_lshlrev_b32 v45, 4, v45
s_lshl_b32 s88, s65, 11
s_lshl_b32 s70, s60, 9
s_add_u32 s88, s88, s70
s_add_u32 s88, s88, 8192
s_lshl_b32 s70, s64, 8
s_add_u32 s70, s70, 4096
v_lshlrev_b32 v4, 4, v3
v_add_u32 v4, s70, v4
s_lshl_b32 s70, s64, 4
s_add_u32 s70, s70, 4096
v_lshlrev_b32 v5, 8, v3
v_add_u32 v5, s70, v5
v_and_b32 v6, 1, v2
v_cmp_eq_u32 vcc, 1, v6
s_nop 1
v_cndmask_b32 v46, v4, v5, vcc
s_add_u32 s70, s87, 0
buffer_load_dwordx4 v[20:23], v44, s[12:15], s70 offen sc1
s_add_u32 s70, s87, 4096
buffer_load_dwordx4 v[24:27], v44, s[12:15], s70 offen sc1
s_add_u32 s70, s87, 8192
buffer_load_dwordx4 v[28:31], v44, s[12:15], s70 offen sc1
s_add_u32 s70, s87, 12288
buffer_load_dwordx4 v[32:35], v44, s[12:15], s70 offen sc1
buffer_load_dwordx4 v[36:39], v45, s[12:15], s88 offen sc1
buffer_load_dwordx4 v[40:43], v46, s[12:15], 0 offen offset:0 sc1
s_waitcnt vmcnt(16)
s_barrier
s_add_u32 m0, s76, 40960
s_nop 0
buffer_load_dwordx4 v8, s[4:7], s74 offen offset:0 lds
buffer_load_dwordx4 v9, s[4:7], s74 offen offset:1024 lds
buffer_load_dwordx4 v10, s[4:7], s74 offen offset:2048 lds
buffer_load_dwordx4 v11, s[4:7], s74 offen offset:3072 lds
s_add_u32 m0, s77, 40960
s_nop 0
buffer_load_dwordx4 v12, s[8:11], s75 offen offset:0 lds
buffer_load_dwordx4 v13, s[8:11], s75 offen offset:1024 lds
buffer_load_dwordx4 v14, s[8:11], s75 offen offset:2048 lds
buffer_load_dwordx4 v15, s[8:11], s75 offen offset:3072 lds
s_add_u32 m0, s77, 45056
s_nop 0
buffer_load_dwordx4 v16, s[8:11], s75 offen offset:0 lds
buffer_load_dwordx4 v17, s[8:11], s75 offen offset:1024 lds
s_add_u32 s74, s74, 128
s_add_u32 s75, s75, 393216
s_and_b32 s74, s74, 2047
s_cselect_b32 s75, s75, 0
s_waitcnt vmcnt(16)
s_barrier
s_add_u32 m0, s76, 81920
s_nop 0
buffer_load_dwordx4 v8, s[4:7], s74 offen offset:0 lds
buffer_load_dwordx4 v9, s[4:7], s74 offen offset:1024 lds
buffer_load_dwordx4 v10, s[4:7], s74 offen offset:2048 lds
buffer_load_dwordx4 v11, s[4:7], s74 offen offset:3072 lds
s_add_u32 m0, s77, 81920
s_nop 0
buffer_load_dwordx4 v12, s[8:11], s75 offen offset:0 lds
buffer_load_dwordx4 v13, s[8:11], s75 offen offset:1024 lds
buffer_load_dwordx4 v14, s[8:11], s75 offen offset:2048 lds
buffer_load_dwordx4 v15, s[8:11], s75 offen offset:3072 lds
s_add_u32 m0, s77, 86016
s_nop 0
buffer_load_dwordx4 v16, s[8:11], s75 offen offset:0 lds
buffer_load_dwordx4 v17, s[8:11], s75 offen offset:1024 lds
s_add_u32 s74, s74, 128
s_add_u32 s75, s75, 393216
s_and_b32 s74, s74, 2047
s_cselect_b32 s75, s75, 0
s_waitcnt vmcnt(20)
L_eg_chk:
v_xor_b32 v2, s68, v23
v_xor_b32 v3, s68, v27
v_xor_b32 v4, s68, v31
v_or3_b32 v2, v2, v3, v4
v_xor_b32 v3, s68, v35
v_xor_b32 v4, s68, v39
v_or3_b32 v2, v2, v3, v4
v_xor_b32 v3, s68, v43
v_or_b32 v2, v2, v3
v_cmp_ne_u32 vcc, 0, v2
s_cbranch_vccnz L_eg_rt
L_eg_ok:
v_add_f32 v20, v20, v24
v_add_f32 v28, v28, v32
v_add_f32 v21, v21, v25
v_add_f32 v29, v29, v33
v_add_f32 v22, v22, v26
v_add_f32 v30, v30, v34
v_add_f32 v20, v20, v28
v_add_f32 v21, v21, v29
v_add_f32 v22, v22, v30
v_mov_b32 v24, v20
v_mov_b32 v25, v21
v_mov_b32 v26, v22
v_permlane16_swap_b32 v20, v24
v_permlane16_swap_b32 v21, v25
v_permlane16_swap_b32 v22, v26
v_add_f32 v20, v20, v24
v_add_f32 v21, v21, v25
v_add_f32 v22, v22, v26
v_mov_b32 v24, v20
v_mov_b32 v25, v21
v_mov_b32 v26, v22
v_permlane32_swap_b32 v20, v24
v_permlane32_swap_b32 v21, v25
v_permlane32_swap_b32 v22, v26
v_add_f32 v20, v20, v24
v_add_f32 v21, v21, v25
v_add_f32 v22, v22, v26
v_and_b32 v3, 15, v1
v_lshlrev_b32 v3, 2, v3
s_lshl_b32 s70, s60, 6
s_add_u32 s70, s70, 160768
v_add_u32 v3, s70, v3
ds_write_b32 v3, v20 offset:0
ds_write_b32 v3, v21 offset:256
ds_write_b32 v3, v22 offset:512
v_lshrrev_b32 v4, 2, v45
s_lshl_b32 s70, s60, 7
s_add_u32 s70, s70, 159744
v_add_u32 v4, s70, v4
ds_write_b32 v4, v36
ds_write_b32 v4, v37 offset:512
s_getreg_b32 s71, hwreg(HW_REG_XCC_ID, 0, 4)
v_cmp_ne_u32 vcc, s71, v40
s_nop 0
s_and_b32 s70, vcc_lo, 0xffff
s_cselect_b32 s69, 0, 1
v_mov_b32 v5, s69
v_mov_b32 v6, 161536
ds_write_b32 v6, v5
s_waitcnt lgkmcnt(0)
s_waitcnt vmcnt(10)
s_barrier
s_add_u32 m0, s76, 0
s_nop 0
buffer_load_dwordx4 v8, s[4:7], s74 offen offset:0 lds
buffer_load_dwordx4 v9, s[4:7], s74 offen offset:1024 lds
buffer_load_dwordx4 v10, s[4:7], s74 offen offset:2048 lds
buffer_load_dwordx4 v11, s[4:7], s74 offen offset:3072 lds
s_add_u32 m0, s77, 0
s_nop 0
buffer_load_dwordx4 v12, s[8:11], s75 offen offset:0 lds
buffer_load_dwordx4 v13, s[8:11], s75 offen offset:1024 lds
buffer_load_dwordx4 v14, s[8:11], s75 offen offset:2048 lds
buffer_load_dwordx4 v15, s[8:11], s75 offen offset:3072 lds
s_add_u32 m0, s77, 4096
s_nop 0
buffer_load_dwordx4 v16, s[8:11], s75 offen offset:0 lds
buffer_load_dwordx4 v17, s[8:11], s75 offen offset:1024 lds
s_add_u32 s74, s74, 128
s_add_u32 s75, s75, 393216
s_and_b32 s74, s74, 2047
s_cselect_b32 s75, s75, 0
s_waitcnt vmcnt(10)
s_barrier
s_mul_i32 s70, s60, 9
s_add_u32 s70, s70, 92
s_lshl_b32 s71, s70, 14
s_lshl_b32 s70, s70, 10
s_add_u32 m0, s70, 28672
s_nop 0
buffer_load_dwordx4 v48, s[16:19], s71 offen offset:0 lds
buffer_load_dwordx4 v49, s[16:19], s71 offen offset:1024 lds
buffer_load_dwordx4 v50, s[16:19], s71 offen offset:2048 lds
buffer_load_dwordx4 v51, s[16:19], s71 offen offset:3072 lds
s_add_u32 m0, m0, 4096
s_add_u32 s71, s71, 65536
buffer_load_dwordx4 v48, s[16:19], s71 offen offset:0 lds
buffer_load_dwordx4 v49, s[16:19], s71 offen offset:1024 lds
buffer_load_dwordx4 v50, s[16:19], s71 offen offset:2048 lds
buffer_load_dwordx4 v51, s[16:19], s71 offen offset:3072 lds
s_add_u32 m0, m0, 4096
s_add_u32 s71, s71, 65536
buffer_load_dwordx4 v48, s[16:19], s71 offen offset:0 lds
s_mul_i32 s70, s60, 10
s_add_u32 s70, s70, 12
s_lshl_b32 s71, s70, 14
s_lshl_b32 s70, s70, 10
s_add_u32 m0, s70, 28672
s_nop 0
buffer_load_dwordx4 v48, s[16:19], s71 offen offset:0 lds
buffer_load_dwordx4 v49, s[16:19], s71 offen offset:1024 lds
buffer_load_dwordx4 v50, s[16:19], s71 offen offset:2048 lds
buffer_load_dwordx4 v51, s[16:19], s71 offen offset:3072 lds
s_add_u32 m0, m0, 4096
s_add_u32 s71, s71, 65536
buffer_load_dwordx4 v48, s[16:19], s71 offen offset:0 lds
buffer_load_dwordx4 v49, s[16:19], s71 offen offset:1024 lds
buffer_load_dwordx4 v50, s[16:19], s71 offen offset:2048 lds
buffer_load_dwordx4 v51, s[16:19], s71 offen offset:3072 lds
s_add_u32 m0, m0, 4096
s_add_u32 s71, s71, 65536
buffer_load_dwordx4 v48, s[16:19], s71 offen offset:0 lds
buffer_load_dwordx4 v49, s[16:19], s71 offen offset:1024 lds
s_waitcnt vmcnt(19)
s_barrier
s_mul_i32 s70, s60, 10
s_add_u32 s70, s70, 52
s_lshl_b32 s71, s70, 14
s_lshl_b32 s70, s70, 10
s_add_u32 m0, s70, 28672
s_nop 0
buffer_load_dwordx4 v48, s[16:19], s71 offen offset:0 lds
buffer_load_dwordx4 v49, s[16:19], s71 offen offset:1024 lds
buffer_load_dwordx4 v50, s[16:19], s71 offen offset:2048 lds
buffer_load_dwordx4 v51, s[16:19], s71 offen offset:3072 lds
s_add_u32 m0, m0, 4096
s_add_u32 s71, s71, 65536
buffer_load_dwordx4 v48, s[16:19], s71 offen offset:0 lds
buffer_load_dwordx4 v49, s[16:19], s71 offen offset:1024 lds
buffer_load_dwordx4 v50, s[16:19], s71 offen offset:2048 lds
buffer_load_dwordx4 v51, s[16:19], s71 offen offset:3072 lds
s_add_u32 m0, m0, 4096
s_add_u32 s71, s71, 65536
buffer_load_dwordx4 v48, s[16:19], s71 offen offset:0 lds
buffer_load_dwordx4 v49, s[16:19], s71 offen offset:1024 lds
v_lshrrev_b32 v2, 4, v1
v_and_b32 v3, 15, v1
v_mul_u32_u24 v52, 57344, v2
v_lshl_add_u32 v52, v3, 1, v52
v_lshlrev_b32 v53, 13, v2
v_lshl_add_u32 v53, v3, 4, v53
v_add_u32 v54, 4096, v53
s_mul_i32 s74, s60, 1835008
s_lshl_b32 s70, s79, 5
s_add_u32 s74, s74, s70
s_lshl_b32 s75, s79, 15
s_lshl_b32 s70, s60, 9
s_add_u32 s75, s75, s70
s_barrier
s_mul_i32 s70, s60, 3
s_add_u32 s70, s70, 0
s_lshl_b32 s71, s70, 14
s_lshl_b32 s70, s70, 10
s_add_u32 m0, s70, 28672
s_nop 0
buffer_load_dwordx4 v48, s[16:19], s71 offen offset:0 lds
buffer_load_dwordx4 v49, s[16:19], s71 offen offset:1024 lds
buffer_load_dwordx4 v50, s[16:19], s71 offen offset:2048 lds
s_sub_i32 s70, s64, s65
s_lshl_b32 s70, s70, 18
v_add_u32 v8, s70, v8
v_add_u32 v9, s70, v9
v_add_u32 v10, s70, v10
v_add_u32 v11, s70, v11
s_lshl_b32 s70, s65, 7
s_mov_b32 m0, s76
s_nop 0
buffer_load_dwordx4 v8, s[4:7], s70 offen offset:0 lds
buffer_load_dwordx4 v9, s[4:7], s70 offen offset:1024 lds
buffer_load_dwordx4 v10, s[4:7], s70 offen offset:2048 lds
buffer_load_dwordx4 v11, s[4:7], s70 offen offset:3072 lds
v_lshrrev_b32 v2, 4, v1
v_bfe_u32 v3, v1, 2, 2
v_and_b32 v4, 1, v1
v_lshlrev_b32 v4, 4, v4
v_mov_b32 v5, 0x3f80
v_lshlrev_b32 v4, v4, v5
v_cmp_eq_u32 vcc, v2, v3
s_nop 1
v_cndmask_b32 v4, 0, v4, vcc
v_and_b32 v5, 2, v1
v_cmp_eq_u32 vcc, 0, v5
s_nop 1
v_cndmask_b32 v78, 0, v4, vcc
v_cndmask_b32_e64 v79, v4, 0, vcc
v_mov_b32 v76, 0
v_mov_b32 v77, 0
v_mov_b32 v80, 0
v_mov_b32 v81, 0
s_cmp_ge_u32 s63, 28
s_cbranch_scc1 L_moeA
buffer_load_short_d16 a0, v52, s[24:27], s74 offen
buffer_load_short_d16 a32, v52, s[28:31], s74 offen
s_add_u32 s74, s74, 7168
buffer_load_short_d16_hi a0, v52, s[24:27], s74 offen
buffer_load_short_d16_hi a32, v52, s[28:31], s74 offen
s_add_u32 s74, s74, 7168
buffer_load_short_d16 a1, v52, s[24:27], s74 offen
buffer_load_short_d16 a33, v52, s[28:31], s74 offen
s_add_u32 s74, s74, 7168
buffer_load_short_d16_hi a1, v52, s[24:27], s74 offen
buffer_load_short_d16_hi a33, v52, s[28:31], s74 offen
s_add_u32 s74, s74, 7168
buffer_load_short_d16 a2, v52, s[24:27], s74 offen
buffer_load_short_d16 a34, v52, s[28:31], s74 offen
s_add_u32 s74, s74, 7168
buffer_load_short_d16_hi a2, v52, s[24:27], s74 offen
buffer_load_short_d16_hi a34, v52, s[28:31], s74 offen
s_add_u32 s74, s74, 7168
buffer_load_short_d16 a3, v52, s[24:27], s74 offen
buffer_load_short_d16 a35, v52, s[28:31], s74 offen
s_add_u32 s74, s74, 7168
buffer_load_short_d16_hi a3, v52, s[24:27], s74 offen
buffer_load_short_d16_hi a35, v52, s[28:31], s74 offen
s_add_u32 s74, s74, 179200
buffer_load_short_d16 a4, v52, s[24:27], s74 offen
buffer_load_short_d16 a36, v52, s[28:31], s74 offen
s_add_u32 s74, s74, 7168
buffer_load_short_d16_hi a4, v52, s[24:27], s74 offen
buffer_load_short_d16_hi a36, v52, s[28:31], s74 offen
s_add_u32 s74, s74, 7168
buffer_load_short_d16 a5, v52, s[24:27], s74 offen
buffer_load_short_d16 a37, v52, s[28:31], s74 offen
s_add_u32 s74, s74, 7168
buffer_load_short_d16_hi a5, v52, s[24:27], s74 offen
buffer_load_short_d16_hi a37, v52, s[28:31], s74 offen
s_add_u32 s74, s74, 7168
L_moeA:
v_and_b32 v3, 15, v1
v_mul_u32_u24 v55, 4352, v3
v_lshrrev_b32 v2, 4, v1
v_lshl_add_u32 v55, v2, 5, v55
s_mul_i32 s87, s64, 69632
s_add_u32 s87, s87, 524288
s_lshl_b32 s70, s66, 7
s_lshl_b32 s71, s67, 4
s_add_u32 s88, s70, s71
s_add_u32 s88, s88, s87
s_add_u32 s88, s88, 4096
s_lshl_b32 s70, s60, 10
s_add_u32 s87, s87, s70
s_barrier
s_add_u32 s70, s65, 1
s_and_b32 s70, s70, 15
s_mul_i32 s70, s70, 4352
s_add_u32 s70, s70, s87
buffer_load_dwordx4 v[84:87], v18, s[12:15], s70 offen sc1
s_add_u32 s70, s65, 2
s_and_b32 s70, s70, 15
s_mul_i32 s70, s70, 4352
s_add_u32 s70, s70, s87
buffer_load_dwordx4 v[88:91], v18, s[12:15], s70 offen sc1
s_add_u32 s70, s65, 3
s_and_b32 s70, s70, 15
s_mul_i32 s70, s70, 4352
s_add_u32 s70, s70, s87
buffer_load_dwordx4 v[92:95], v18, s[12:15], s70 offen sc1
s_add_u32 s70, s65, 4
s_and_b32 s70, s70, 15
s_mul_i32 s70, s70, 4352
s_add_u32 s70, s70, s87
buffer_load_dwordx4 v[96:99], v18, s[12:15], s70 offen sc1
s_add_u32 s70, s65, 5
s_and_b32 s70, s70, 15
s_mul_i32 s70, s70, 4352
s_add_u32 s70, s70, s87
buffer_load_dwordx4 v[100:103], v18, s[12:15], s70 offen sc1
s_add_u32 s70, s65, 6
s_and_b32 s70, s70, 15
s_mul_i32 s70, s70, 4352
s_add_u32 s70, s70, s87
buffer_load_dwordx4 v[104:107], v18, s[12:15], s70 offen sc1
s_add_u32 s70, s65, 7
s_and_b32 s70, s70, 15
s_mul_i32 s70, s70, 4352
s_add_u32 s70, s70, s87
buffer_load_dwordx4 v[108:111], v18, s[12:15], s70 offen sc1
s_add_u32 s70, s65, 8
s_and_b32 s70, s70, 15
s_mul_i32 s70, s70, 4352
s_add_u32 s70, s70, s87
buffer_load_dwordx4 v[112:115], v18, s[12:15], s70 offen sc1
s_add_u32 s70, s65, 9
s_and_b32 s70, s70, 15
s_mul_i32 s70, s70, 4352
s_add_u32 s70, s70, s87
buffer_load_dwordx4 v[116:119], v18, s[12:15], s70 offen sc1
s_add_u32 s70, s65, 10
s_and_b32 s70, s70, 15
s_mul_i32 s70, s70, 4352
s_add_u32 s70, s70, s87
buffer_load_dwordx4 v[120:123], v18, s[12:15], s70 offen sc1
s_add_u32 s70, s65, 11
s_and_b32 s70, s70, 15
s_mul_i32 s70, s70, 4352
s_add_u32 s70, s70, s87
buffer_load_dwordx4 v[124:127], v18, s[12:15], s70 offen sc1
s_add_u32 s70, s65, 12
s_and_b32 s70, s70, 15
s_mul_i32 s70, s70, 4352
s_add_u32 s70, s70, s87
buffer_load_dwordx4 v[128:131], v18, s[12:15], s70 offen sc1
s_add_u32 s70, s65, 13
s_and_b32 s70, s70, 15
s_mul_i32 s70, s70, 4352
s_add_u32 s70, s70, s87
buffer_load_dwordx4 v[132:135], v18, s[12:15], s70 offen sc1
s_add_u32 s70, s65, 14
s_and_b32 s70, s70, 15
s_mul_i32 s70, s70, 4352
s_add_u32 s70, s70, s87
buffer_load_dwordx4 v[136:139], v18, s[12:15], s70 offen sc1
s_add_u32 s70, s65, 15
s_and_b32 s70, s70, 15
s_mul_i32 s70, s70, 4352
s_add_u32 s70, s70, s87
buffer_load_dwordx4 v[140:143], v18, s[12:15], s70 offen sc1
s_add_u32 s70, s65, 16
s_and_b32 s70, s70, 15
s_mul_i32 s70, s70, 4352
s_add_u32 s70, s70, s87
buffer_load_dwordx4 v[144:147], v18, s[12:15], s70 offen sc1
buffer_load_dwordx4 v[148:151], v55, s[12:15], s88 offen sc1
s_waitcnt vmcnt(13)
L_kv0_chk:
v_max3_u32 v2, v84, v88, v92
v_max_u32 v2, v2, v96
v_cmp_eq_u32 vcc, -1, v2
s_cbranch_vccnz L_kv0_rt
L_kv0_ok:
v_mfma_f32_16x16x32_bf16 v[68:71], v[78:81], v[84:87], 0
v_mfma_f32_16x16x32_bf16 v[72:75], v[76:79], v[84:87], 0
v_mfma_f32_16x16x32_bf16 v[68:71], v[78:81], v[88:91], v[68:71]
v_mfma_f32_16x16x32_bf16 v[72:75], v[76:79], v[88:91], v[72:75]
v_mfma_f32_16x16x32_bf16 v[68:71], v[78:81], v[92:95], v[68:71]
v_mfma_f32_16x16x32_bf16 v[72:75], v[76:79], v[92:95], v[72:75]
v_mfma_f32_16x16x32_bf16 v[68:71], v[78:81], v[96:99], v[68:71]
v_mfma_f32_16x16x32_bf16 v[72:75], v[76:79], v[96:99], v[72:75]
s_waitcnt vmcnt(9)
L_kv1_chk:
v_max3_u32 v2, v100, v104, v108
v_max_u32 v2, v2, v112
v_cmp_eq_u32 vcc, -1, v2
s_cbranch_vccnz L_kv1_rt
L_kv1_ok:
v_mfma_f32_16x16x32_bf16 v[68:71], v[78:81], v[100:103], v[68:71]
v_mfma_f32_16x16x32_bf16 v[72:75], v[76:79], v[100:103], v[72:75]
v_mfma_f32_16x16x32_bf16 v[68:71], v[78:81], v[104:107], v[68:71]
v_mfma_f32_16x16x32_bf16 v[72:75], v[76:79], v[104:107], v[72:75]
v_mfma_f32_16x16x32_bf16 v[68:71], v[78:81], v[108:111], v[68:71]
v_mfma_f32_16x16x32_bf16 v[72:75], v[76:79], v[108:111], v[72:75]
v_mfma_f32_16x16x32_bf16 v[68:71], v[78:81], v[112:115], v[68:71]
v_mfma_f32_16x16x32_bf16 v[72:75], v[76:79], v[112:115], v[72:75]
s_waitcnt vmcnt(5)
L_kv2_chk:
v_max3_u32 v2, v116, v120, v124
v_max_u32 v2, v2, v128
v_cmp_eq_u32 vcc, -1, v2
s_cbranch_vccnz L_kv2_rt
L_kv2_ok:
v_mfma_f32_16x16x32_bf16 v[68:71], v[78:81], v[116:119], v[68:71]
v_mfma_f32_16x16x32_bf16 v[72:75], v[76:79], v[116:119], v[72:75]
v_mfma_f32_16x16x32_bf16 v[68:71], v[78:81], v[120:123], v[68:71]
v_mfma_f32_16x16x32_bf16 v[72:75], v[76:79], v[120:123], v[72:75]
v_mfma_f32_16x16x32_bf16 v[68:71], v[78:81], v[124:127], v[68:71]
v_mfma_f32_16x16x32_bf16 v[72:75], v[76:79], v[124:127], v[72:75]
v_mfma_f32_16x16x32_bf16 v[68:71], v[78:81], v[128:131], v[68:71]
v_mfma_f32_16x16x32_bf16 v[72:75], v[76:79], v[128:131], v[72:75]
s_waitcnt vmcnt(1)
L_kv3_chk:
v_max3_u32 v2, v132, v136, v140
v_max_u32 v2, v2, v144
v_cmp_eq_u32 vcc, -1, v2
s_cbranch_vccnz L_kv3_rt
L_kv3_ok:
v_mfma_f32_16x16x32_bf16 v[68:71], v[78:81], v[132:135], v[68:71]
v_mfma_f32_16x16x32_bf16 v[72:75], v[76:79], v[132:135], v[72:75]
v_mfma_f32_16x16x32_bf16 v[68:71], v[78:81], v[136:139], v[68:71]
v_mfma_f32_16x16x32_bf16 v[72:75], v[76:79], v[136:139], v[72:75]
v_mfma_f32_16x16x32_bf16 v[68:71], v[78:81], v[140:143], v[68:71]
v_mfma_f32_16x16x32_bf16 v[72:75], v[76:79], v[140:143], v[72:75]
v_mfma_f32_16x16x32_bf16 v[68:71], v[78:81], v[144:147], v[68:71]
v_mfma_f32_16x16x32_bf16 v[72:75], v[76:79], v[144:147], v[72:75]
s_waitcnt vmcnt(0)
L_z_chk:
v_cmp_eq_u32 vcc, -1, v148
s_cbranch_vccnz L_z_rt
L_z_ok:
v_add_f32_dpp v148, v148, v148 row_ror:1 row_mask:0xf bank_mask:0xf
v_add_f32_dpp v149, v149, v149 row_ror:1 row_mask:0xf bank_mask:0xf
v_add_f32_dpp v150, v150, v150 row_ror:1 row_mask:0xf bank_mask:0xf
v_add_f32_dpp v151, v151, v151 row_ror:1 row_mask:0xf bank_mask:0xf
v_add_f32_dpp v148, v148, v148 row_ror:2 row_mask:0xf bank_mask:0xf
v_add_f32_dpp v149, v149, v149 row_ror:2 row_mask:0xf bank_mask:0xf
v_add_f32_dpp v150, v150, v150 row_ror:2 row_mask:0xf bank_mask:0xf
v_add_f32_dpp v151, v151, v151 row_ror:2 row_mask:0xf bank_mask:0xf
v_add_f32_dpp v148, v148, v148 row_ror:4 row_mask:0xf bank_mask:0xf
v_add_f32_dpp v149, v149, v149 row_ror:4 row_mask:0xf bank_mask:0xf
v_add_f32_dpp v150, v150, v150 row_ror:4 row_mask:0xf bank_mask:0xf
v_add_f32_dpp v151, v151, v151 row_ror:4 row_mask:0xf bank_mask:0xf
v_add_f32_dpp v148, v148, v148 row_ror:8 row_mask:0xf bank_mask:0xf
v_add_f32_dpp v149, v149, v149 row_ror:8 row_mask:0xf bank_mask:0xf
v_add_f32_dpp v150, v150, v150 row_ror:8 row_mask:0xf bank_mask:0xf
v_add_f32_dpp v151, v151, v151 row_ror:8 row_mask:0xf bank_mask:0xf
v_cvt_pk_bf16_f32 v148, v148, v149
v_cvt_pk_bf16_f32 v149, v150, v151
s_lshl_b32 s70, s66, 6
s_lshl_b32 s71, s67, 3
s_add_u32 s70, s70, s71
s_add_u32 s70, s70, 161600
v_lshrrev_b32 v2, 4, v1
v_lshlrev_b32 v2, 4, v2
v_add_u32 v2, s70, v2
ds_write_b64 v2, v[148:149]
v_cvt_pk_bf16_f32 v68, v68, v69
v_cvt_pk_bf16_f32 v69, v70, v71
v_cvt_pk_bf16_f32 v70, v72, v73
v_cvt_pk_bf16_f32 v71, v74, v75
s_lshl_b32 s70, s60, 10
s_add_u32 s70, s70, 24576
v_add_u32 v3, s70, v18
ds_write_b128 v3, v[68:71]
s_waitcnt lgkmcnt(0)
s_barrier
s_cmp_ge_u32 s63, 28
s_cbranch_scc1 L_moeB
buffer_load_short_d16 a6, v52, s[24:27], s74 offen
buffer_load_short_d16 a38, v52, s[28:31], s74 offen
s_add_u32 s74, s74, 7168
buffer_load_short_d16_hi a6, v52, s[24:27], s74 offen
buffer_load_short_d16_hi a38, v52, s[28:31], s74 offen
s_add_u32 s74, s74, 7168
buffer_load_short_d16 a7, v52, s[24:27], s74 offen
buffer_load_short_d16 a39, v52, s[28:31], s74 offen
s_add_u32 s74, s74, 7168
buffer_load_short_d16_hi a7, v52, s[24:27], s74 offen
buffer_load_short_d16_hi a39, v52, s[28:31], s74 offen
s_add_u32 s74, s74, 179200
buffer_load_short_d16 a8, v52, s[24:27], s74 offen
buffer_load_short_d16 a40, v52, s[28:31], s74 offen
s_add_u32 s74, s74, 7168
buffer_load_short_d16_hi a8, v52, s[24:27], s74 offen
buffer_load_short_d16_hi a40, v52, s[28:31], s74 offen
s_add_u32 s74, s74, 7168
buffer_load_short_d16 a9, v52, s[24:27], s74 offen
buffer_load_short_d16 a41, v52, s[28:31], s74 offen
s_add_u32 s74, s74, 7168
buffer_load_short_d16_hi a9, v52, s[24:27], s74 offen
buffer_load_short_d16_hi a41, v52, s[28:31], s74 offen
s_add_u32 s74, s74, 7168
buffer_load_short_d16 a10, v52, s[24:27], s74 offen
buffer_load_short_d16 a42, v52, s[28:31], s74 offen
s_add_u32 s74, s74, 7168
buffer_load_short_d16_hi a10, v52, s[24:27], s74 offen
buffer_load_short_d16_hi a42, v52, s[28:31], s74 offen
s_add_u32 s74, s74, 7168
buffer_load_short_d16 a11, v52, s[24:27], s74 offen
buffer_load_short_d16 a43, v52, s[28:31], s74 offen
s_add_u32 s74, s74, 7168
buffer_load_short_d16_hi a11, v52, s[24:27], s74 offen
buffer_load_short_d16_hi a43, v52, s[28:31], s74 offen
s_add_u32 s74, s74, 179200
buffer_load_short_d16 a12, v52, s[24:27], s74 offen
buffer_load_short_d16 a44, v52, s[28:31], s74 offen
s_add_u32 s74, s74, 7168
buffer_load_short_d16_hi a12, v52, s[24:27], s74 offen
buffer_load_short_d16_hi a44, v52, s[28:31], s74 offen
s_add_u32 s74, s74, 7168
buffer_load_short_d16 a13, v52, s[24:27], s74 offen
buffer_load_short_d16 a45, v52, s[28:31], s74 offen
s_add_u32 s74, s74, 7168
buffer_load_short_d16_hi a13, v52, s[24:27], s74 offen
buffer_load_short_d16_hi a45, v52, s[28:31], s74 offen
s_add_u32 s74, s74, 7168
buffer_load_short_d16 a14, v52, s[24:27], s74 offen
buffer_load_short_d16 a46, v52, s[28:31], s74 offen
s_add_u32 s74, s74, 7168
buffer_load_short_d16_hi a14, v52, s[24:27], s74 offen
buffer_load_short_d16_hi a46, v52, s[28:31], s74 offen
s_add_u32 s74, s74, 7168
buffer_load_short_d16 a15, v52, s[24:27], s74 offen
buffer_load_short_d16 a47, v52, s[28:31], s74 offen
s_add_u32 s74, s74, 7168
buffer_load_short_d16_hi a15, v52, s[24:27], s74 offen
buffer_load_short_d16_hi a47, v52, s[28:31], s74 offen
s_add_u32 s74, s74, 179200
L_moeB:
s_barrier
s_cmp_ge_u32 s63, 28
s_cbranch_scc1 L_moeC
buffer_load_short_d16 a16, v52, s[24:27], s74 offen
buffer_load_short_d16 a48, v52, s[28:31], s74 offen
s_add_u32 s74, s74, 7168
buffer_load_short_d16_hi a16, v52, s[24:27], s74 offen
buffer_load_short_d16_hi a48, v52, s[28:31], s74 offen
s_add_u32 s74, s74, 7168
buffer_load_short_d16 a17, v52, s[24:27], s74 offen
buffer_load_short_d16 a49, v52, s[28:31], s74 offen
s_add_u32 s74, s74, 7168
buffer_load_short_d16_hi a17, v52, s[24:27], s74 offen
buffer_load_short_d16_hi a49, v52, s[28:31], s74 offen
s_add_u32 s74, s74, 7168
buffer_load_short_d16 a18, v52, s[24:27], s74 offen
buffer_load_short_d16 a50, v52, s[28:31], s74 offen
s_add_u32 s74, s74, 7168
buffer_load_short_d16_hi a18, v52, s[24:27], s74 offen
buffer_load_short_d16_hi a50, v52, s[28:31], s74 offen
s_add_u32 s74, s74, 7168
buffer_load_short_d16 a19, v52, s[24:27], s74 offen
buffer_load_short_d16 a51, v52, s[28:31], s74 offen
s_add_u32 s74, s74, 7168
buffer_load_short_d16_hi a19, v52, s[24:27], s74 offen
buffer_load_short_d16_hi a51, v52, s[28:31], s74 offen
s_add_u32 s74, s74, 179200
buffer_load_short_d16 a20, v52, s[24:27], s74 offen
buffer_load_short_d16 a52, v52, s[28:31], s74 offen
s_add_u32 s74, s74, 7168
buffer_load_short_d16_hi a20, v52, s[24:27], s74 offen
buffer_load_short_d16_hi a52, v52, s[28:31], s74 offen
s_add_u32 s74, s74, 7168
buffer_load_short_d16 a21, v52, s[24:27], s74 offen
buffer_load_short_d16 a53, v52, s[28:31], s74 offen
s_add_u32 s74, s74, 7168
buffer_load_short_d16_hi a21, v52, s[24:27], s74 offen
buffer_load_short_d16_hi a53, v52, s[28:31], s74 offen
s_add_u32 s74, s74, 7168
buffer_load_short_d16 a22, v52, s[24:27], s74 offen
buffer_load_short_d16 a54, v52, s[28:31], s74 offen
s_add_u32 s74, s74, 7168
buffer_load_short_d16_hi a22, v52, s[24:27], s74 offen
buffer_load_short_d16_hi a54, v52, s[28:31], s74 offen
s_add_u32 s74, s74, 7168
buffer_load_short_d16 a23, v52, s[24:27], s74 offen
buffer_load_short_d16 a55, v52, s[28:31], s74 offen
s_add_u32 s74, s74, 7168
buffer_load_short_d16_hi a23, v52, s[24:27], s74 offen
buffer_load_short_d16_hi a55, v52, s[28:31], s74 offen
s_add_u32 s74, s74, 179200
buffer_load_short_d16 a24, v52, s[24:27], s74 offen
buffer_load_short_d16 a56, v52, s[28:31], s74 offen
s_add_u32 s74, s74, 7168
buffer_load_short_d16_hi a24, v52, s[24:27], s74 offen
buffer_load_short_d16_hi a56, v52, s[28:31], s74 offen
s_add_u32 s74, s74, 7168
buffer_load_short_d16 a25, v52, s[24:27], s74 offen
buffer_load_short_d16 a57, v52, s[28:31], s74 offen
s_add_u32 s74, s74, 7168
buffer_load_short_d16_hi a25, v52, s[24:27], s74 offen
buffer_load_short_d16_hi a57, v52, s[28:31], s74 offen
s_add_u32 s74, s74, 7168
buffer_load_short_d16 a26, v52, s[24:27], s74 offen
s_waitcnt vmcnt(40)
buffer_load_short_d16 a58, v52, s[28:31], s74 offen
s_add_u32 s74, s74, 7168
s_waitcnt vmcnt(40)
buffer_load_short_d16_hi a26, v52, s[24:27], s74 offen
s_waitcnt vmcnt(40)
buffer_load_short_d16_hi a58, v52, s[28:31], s74 offen
s_add_u32 s74, s74, 7168
s_waitcnt vmcnt(40)
buffer_load_short_d16 a27, v52, s[24:27], s74 offen
s_waitcnt vmcnt(40)
buffer_load_short_d16 a59, v52, s[28:31], s74 offen
s_add_u32 s74, s74, 7168
s_waitcnt vmcnt(40)
buffer_load_short_d16_hi a27, v52, s[24:27], s74 offen
s_waitcnt vmcnt(40)
buffer_load_short_d16_hi a59, v52, s[28:31], s74 offen
s_add_u32 s74, s74, 179200
s_waitcnt vmcnt(40)
buffer_load_short_d16 a28, v52, s[24:27], s74 offen
s_waitcnt vmcnt(40)
buffer_load_short_d16 a60, v52, s[28:31], s74 offen
s_add_u32 s74, s74, 7168
s_waitcnt vmcnt(40)
buffer_load_short_d16_hi a28, v52, s[24:27], s74 offen
s_waitcnt vmcnt(40)
buffer_load_short_d16_hi a60, v52, s[28:31], s74 offen
s_add_u32 s74, s74, 7168
s_waitcnt vmcnt(40)
buffer_load_short_d16 a29, v52, s[24:27], s74 offen
s_waitcnt vmcnt(40)
buffer_load_short_d16 a61, v52, s[28:31], s74 offen
s_add_u32 s74, s74, 7168
s_waitcnt vmcnt(40)
buffer_load_short_d16_hi a29, v52, s[24:27], s74 offen
s_waitcnt vmcnt(40)
buffer_load_short_d16_hi a61, v52, s[28:31], s74 offen
s_add_u32 s74, s74, 7168
s_waitcnt vmcnt(40)
buffer_load_short_d16 a30, v52, s[24:27], s74 offen
s_waitcnt vmcnt(40)
buffer_load_short_d16 a62, v52, s[28:31], s74 offen
s_add_u32 s74, s74, 7168
s_waitcnt vmcnt(40)
buffer_load_short_d16_hi a30, v52, s[24:27], s74 offen
s_waitcnt vmcnt(40)
buffer_load_short_d16_hi a62, v52, s[28:31], s74 offen
s_add_u32 s74, s74, 7168
s_waitcnt vmcnt(40)
buffer_load_short_d16 a31, v52, s[24:27], s74 offen
s_waitcnt vmcnt(40)
buffer_load_short_d16 a63, v52, s[28:31], s74 offen
s_add_u32 s74, s74, 7168
s_waitcnt vmcnt(40)
buffer_load_short_d16_hi a31, v52, s[24:27], s74 offen
s_waitcnt vmcnt(40)
buffer_load_short_d16_hi a63, v52, s[28:31], s74 offen
s_add_u32 s74, s74, 179200
s_waitcnt vmcnt(40)
buffer_load_dwordx4 v[84:87], v53, s[32:35], s75 offen offset:0
s_waitcnt vmcnt(40)
buffer_load_dwordx4 v[88:91], v53, s[32:35], s75 offen offset:2048
s_waitcnt vmcnt(40)
buffer_load_dwordx4 v[92:95], v54, s[32:35], s75 offen offset:0
s_waitcnt vmcnt(40)
buffer_load_dwordx4 v[96:99], v54, s[32:35], s75 offen offset:2048
s_waitcnt vmcnt(40)
buffer_load_dwordx4 v[100:103], v53, s[32:35], s75 offen offset:256
s_waitcnt vmcnt(40)
buffer_load_dwordx4 v[104:107], v53, s[32:35], s75 offen offset:2304
s_waitcnt vmcnt(40)
buffer_load_dwordx4 v[108:111], v54, s[32:35], s75 offen offset:256
s_waitcnt vmcnt(40)
buffer_load_dwordx4 v[112:115], v54, s[32:35], s75 offen offset:2304
s_waitcnt vmcnt(40)
L_moeC:
s_barrier
s_cmp_ge_u32 s63, 28
s_cbranch_scc1 L_noprep
s_waitcnt vmcnt(0)
s_mov_b32 s94, 0x05040100
s_mov_b32 s95, 0x07060302
v_mov_b32 v76, 0x3f803f80
v_mov_b32 v77, 0x3f803f80
v_mov_b32 v78, 0x3f803f80
v_mov_b32 v79, 0x3f803f80
s_nop 1
v_mfma_f32_16x16x32_bf16 v[68:71], a[0:3], v[76:79], 0
v_mfma_f32_16x16x32_bf16 v[72:75], a[32:35], v[76:79], 0
v_mfma_f32_16x16x32_bf16 v[68:71], a[4:7], v[76:79], v[68:71]
v_mfma_f32_16x16x32_bf16 v[72:75], a[36:39], v[76:79], v[72:75]
v_mfma_f32_16x16x32_bf16 v[68:71], a[8:11], v[76:79], v[68:71]
v_mfma_f32_16x16x32_bf16 v[72:75], a[40:43], v[76:79], v[72:75]
v_mfma_f32_16x16x32_bf16 v[68:71], a[12:15], v[76:79], v[68:71]
v_mfma_f32_16x16x32_bf16 v[72:75], a[44:47], v[76:79], v[72:75]
v_mfma_f32_16x16x32_bf16 v[68:71], a[16:19], v[76:79], v[68:71]
v_mfma_f32_16x16x32_bf16 v[72:75], a[48:51], v[76:79], v[72:75]
v_mfma_f32_16x16x32_bf16 v[68:71], a[20:23], v[76:79], v[68:71]
v_mfma_f32_16x16x32_bf16 v[72:75], a[52:55], v[76:79], v[72:75]
v_mfma_f32_16x16x32_bf16 v[68:71], a[24:27], v[76:79], v[68:71]
v_mfma_f32_16x16x32_bf16 v[72:75], a[56:59], v[76:79], v[72:75]
v_mfma_f32_16x16x32_bf16 v[68:71], a[28:31], v[76:79], v[68:71]
v_mfma_f32_16x16x32_bf16 v[72:75], a[60:63], v[76:79], v[72:75]
v_perm_b32 v116, v88, v84, s94
v_perm_b32 v117, v96, v92, s94
v_perm_b32 v118, v88, v84, s95
v_perm_b32 v119, v96, v92, s95
v_perm_b32 v120, v89, v85, s94
v_perm_b32 v121, v97, v93, s94
v_perm_b32 v122, v89, v85, s95
v_perm_b32 v123, v97, v93, s95
v_perm_b32 v124, v90, v86, s94
v_perm_b32 v125, v98, v94, s94
v_perm_b32 v126, v90, v86, s95
v_perm_b32 v127, v98, v94, s95
v_perm_b32 v128, v91, v87, s94
v_perm_b32 v129, v99, v95, s94
v_perm_b32 v130, v91, v87, s95
v_perm_b32 v131, v99, v95, s95
v_perm_b32 v132, v104, v100, s94
v_perm_b32 v133, v112, v108, s94
v_perm_b32 v134, v104, v100, s95
v_perm_b32 v135, v112, v108, s95
v_perm_b32 v136, v105, v101, s94
v_perm_b32 v137, v113, v109, s94
v_perm_b32 v138, v105, v101, s95
v_perm_b32 v139, v113, v109, s95
v_perm_b32 v140, v106, v102, s94
v_perm_b32 v141, v114, v110, s94
v_perm_b32 v142, v106, v102, s95
v_perm_b32 v143, v114, v110, s95
v_perm_b32 v144, v107, v103, s94
v_perm_b32 v145, v115, v111, s94
v_perm_b32 v146, v107, v103, s95
v_perm_b32 v147, v115, v111, s95
L_noprep:
v_and_b32 v2, 1, v1
v_lshlrev_b32 v56, 4, v2
v_add_u32 v56, 161856, v56
v_lshrrev_b32 v3, 4, v1
v_lshlrev_b32 v57, 4, v3
s_lshl_b32 s70, s60, 9
s_add_u32 s70, s70, 6881280
v_add_u32 v57, s70, v57
v_lshlrev_b32 v58, 6, v2
v_lshl_add_u32 v58, v3, 4, v58
v_add_u32 v58, 162048, v58
s_lshl_b32 s70, s60, 8
v_add_u32 v59, s70, v58
v_bfe_u32 v60, v1, 1, 3
s_barrier
ds_read_b128 v[20:23], v56
s_mov_b32 s92, 0x00030003
s_mov_b32 s93, 0x00030003
s_sub_u32 s88, s63, 24
s_lshl_b32 s70, s62, 3
s_add_u32 s88, s88, s70
s_waitcnt lgkmcnt(0)
s_cmp_ge_u32 s63, 28
s_cbranch_scc1 L_nomoe
v_lshl_add_u32 v57, v23, 11, v57
s_mov_b64 exec, s[92:93]
buffer_load_dwordx4 v[24:27], v57, s[12:15], 0 offen offset:0 sc1
buffer_load_dwordx4 v[28:31], v57, s[12:15], 0 offen offset:64 sc1
buffer_load_dwordx4 v[32:35], v57, s[12:15], 0 offen offset:128 sc1
buffer_load_dwordx4 v[36:39], v57, s[12:15], 0 offen offset:192 sc1
buffer_load_dwordx4 v[40:43], v57, s[12:15], 0 offen offset:256 sc1
buffer_load_dwordx4 v[44:47], v57, s[12:15], 0 offen offset:320 sc1
buffer_load_dwordx4 v[48:51], v57, s[12:15], 0 offen offset:384 sc1
buffer_load_dwordx4 v[52:55], v57, s[12:15], 0 offen offset:448 sc1
v_mul_f32_e64 v68, v68, -v21
v_mul_f32_e64 v69, v69, -v21
v_mul_f32_e64 v70, v70, -v21
v_mul_f32_e64 v71, v71, -v21
v_mul_f32_e64 v72, v72, -v21
v_mul_f32_e64 v73, v73, -v21
v_mul_f32_e64 v74, v74, -v21
v_mul_f32_e64 v75, v75, -v21
s_waitcnt vmcnt(0)
L_x_chk:
v_max3_u32 v2, v24, v28, v32
v_max3_u32 v3, v36, v40, v44
v_max3_u32 v2, v2, v48, v52
v_max_u32 v2, v2, v3
v_cmp_eq_u32 vcc, -1, v2
s_cbranch_vccnz L_x_rt
L_x_ok:
s_mov_b64 exec, -1
v_mfma_f32_16x16x32_bf16 v[68:71], a[0:3], v[24:27], v[68:71]
v_mfma_f32_16x16x32_bf16 v[72:75], a[32:35], v[24:27], v[72:75]
v_mfma_f32_16x16x32_bf16 v[68:71], a[4:7], v[28:31], v[68:71]
v_mfma_f32_16x16x32_bf16 v[72:75], a[36:39], v[28:31], v[72:75]
v_mfma_f32_16x16x32_bf16 v[68:71], a[8:11], v[32:35], v[68:71]
v_mfma_f32_16x16x32_bf16 v[72:75], a[40:43], v[32:35], v[72:75]
v_mfma_f32_16x16x32_bf16 v[68:71], a[12:15], v[36:39], v[68:71]
v_mfma_f32_16x16x32_bf16 v[72:75], a[44:47], v[36:39], v[72:75]
v_mfma_f32_16x16x32_bf16 v[68:71], a[16:19], v[40:43], v[68:71]
v_mfma_f32_16x16x32_bf16 v[72:75], a[48:51], v[40:43], v[72:75]
v_mfma_f32_16x16x32_bf16 v[68:71], a[20:23], v[44:47], v[68:71]
v_mfma_f32_16x16x32_bf16 v[72:75], a[52:55], v[44:47], v[72:75]
v_mfma_f32_16x16x32_bf16 v[68:71], a[24:27], v[48:51], v[68:71]
v_mfma_f32_16x16x32_bf16 v[72:75], a[56:59], v[48:51], v[72:75]
v_mfma_f32_16x16x32_bf16 v[68:71], a[28:31], v[52:55], v[68:71]
v_mfma_f32_16x16x32_bf16 v[72:75], a[60:63], v[52:55], v[72:75]
s_mov_b64 exec, s[92:93]
s_nop 5
ds_write_b128 v59, v[68:71]
ds_write_b128 v59, v[72:75] offset:128
s_mov_b64 exec, -1
s_waitcnt lgkmcnt(0)
s_barrier
ds_read_b128 v[24:27], v58 offset:0
ds_read_b128 v[40:43], v58 offset:128
ds_read_b128 v[28:31], v58 offset:256
ds_read_b128 v[44:47], v58 offset:384
ds_read_b128 v[32:35], v58 offset:512
ds_read_b128 v[48:51], v58 offset:640
ds_read_b128 v[36:39], v58 offset:768
ds_read_b128 v[52:55], v58 offset:896
s_waitcnt lgkmcnt(0)
v_pk_add_f32 v[24:25], v[24:25], v[28:29]
v_pk_add_f32 v[32:33], v[32:33], v[36:37]
v_pk_add_f32 v[26:27], v[26:27], v[30:31]
v_pk_add_f32 v[34:35], v[34:35], v[38:39]
v_pk_add_f32 v[24:25], v[24:25], v[32:33]
v_pk_add_f32 v[26:27], v[26:27], v[34:35]
v_pk_mul_f32 v[24:25], v[24:25], v[22:23] op_sel_hi:[1,0]
v_pk_mul_f32 v[26:27], v[26:27], v[22:23] op_sel_hi:[1,0]
v_pk_add_f32 v[40:41], v[40:41], v[44:45]
v_pk_add_f32 v[48:49], v[48:49], v[52:53]
v_pk_add_f32 v[42:43], v[42:43], v[46:47]
v_pk_add_f32 v[50:51], v[50:51], v[54:55]
v_pk_add_f32 v[40:41], v[40:41], v[48:49]
v_pk_add_f32 v[42:43], v[42:43], v[50:51]
v_pk_mul_f32 v[40:41], v[40:41], v[22:23] op_sel_hi:[1,0]
v_pk_mul_f32 v[42:43], v[42:43], v[22:23] op_sel_hi:[1,0]
v_mul_f32 v28, 0xbfb8aa3b, v24
v_mul_f32 v29, 0xbfb8aa3b, v25
v_mul_f32 v30, 0xbfb8aa3b, v26
v_mul_f32 v31, 0xbfb8aa3b, v27
v_exp_f32 v28, v28
v_exp_f32 v29, v29
v_exp_f32 v30, v30
v_exp_f32 v31, v31
v_mul_f32 v24, v24, v40
v_mul_f32 v25, v25, v41
v_mul_f32 v26, v26, v42
v_mul_f32 v27, v27, v43
v_add_f32 v28, 1.0, v28
v_add_f32 v29, 1.0, v29
v_add_f32 v30, 1.0, v30
v_add_f32 v31, 1.0, v31
v_rcp_f32 v28, v28
v_rcp_f32 v29, v29
v_rcp_f32 v30, v30
v_rcp_f32 v31, v31
v_mul_f32 v24, v24, v28
v_mul_f32 v25, v25, v29
v_mul_f32 v26, v26, v30
v_mul_f32 v27, v27, v31
v_cvt_pk_bf16_f32 v24, v24, v25
v_cvt_pk_bf16_f32 v25, v26, v27
v_cmp_eq_u32 vcc, 0, v60
s_nop 1
v_cndmask_b32 v32, 0, v24, vcc
v_cndmask_b32 v33, 0, v25, vcc
v_cmp_eq_u32 vcc, 1, v60
s_nop 1
v_cndmask_b32 v34, 0, v24, vcc
v_cndmask_b32 v35, 0, v25, vcc
v_cmp_eq_u32 vcc, 2, v60
s_nop 1
v_cndmask_b32 v36, 0, v24, vcc
v_cndmask_b32 v37, 0, v25, vcc
v_cmp_eq_u32 vcc, 3, v60
s_nop 1
v_cndmask_b32 v38, 0, v24, vcc
v_cndmask_b32 v39, 0, v25, vcc
v_cmp_eq_u32 vcc, 4, v60
s_nop 1
v_cndmask_b32 v40, 0, v24, vcc
v_cndmask_b32 v41, 0, v25, vcc
v_cmp_eq_u32 vcc, 5, v60
s_nop 1
v_cndmask_b32 v42, 0, v24, vcc
v_cndmask_b32 v43, 0, v25, vcc
v_cmp_eq_u32 vcc, 6, v60
s_nop 1
v_cndmask_b32 v44, 0, v24, vcc
v_cndmask_b32 v45, 0, v25, vcc
v_cmp_eq_u32 vcc, 7, v60
s_nop 1
v_cndmask_b32 v46, 0, v24, vcc
v_cndmask_b32 v47, 0, v25, vcc
v_mfma_f32_16x16x32_bf16 v[68:71], v[116:119], v[32:35], 0
v_mfma_f32_16x16x32_bf16 v[72:75], v[132:135], v[32:35], 0
v_mfma_f32_16x16x32_bf16 v[68:71], v[120:123], v[36:39], v[68:71]
v_mfma_f32_16x16x32_bf16 v[72:75], v[136:139], v[36:39], v[72:75]
v_mfma_f32_16x16x32_bf16 v[68:71], v[124:127], v[40:43], v[68:71]
v_mfma_f32_16x16x32_bf16 v[72:75], v[140:143], v[40:43], v[72:75]
v_mfma_f32_16x16x32_bf16 v[68:71], v[128:131], v[44:47], v[68:71]
v_mfma_f32_16x16x32_bf16 v[72:75], v[144:147], v[44:47], v[72:75]
s_lshl_b32 s70, s79, 13
s_lshl_b32 s71, s60, 11
s_add_u32 s70, s70, s71
s_add_u32 s70, s70, 7340032
s_nop 2
buffer_store_dwordx4 v[68:71], v18, s[12:15], s70 offen offset:0 sc1
buffer_store_dwordx4 v[72:75], v18, s[12:15], s70 offen offset:1024 sc1
L_nomoe:
s_cmp_lt_u32 s63, 24
s_cbranch_scc1 L_ldone
v_lshrrev_b32 v2, 3, v1
v_and_b32 v3, 7, v1
v_lshlrev_b32 v62, 13, v2
v_lshl_add_u32 v62, v3, 4, v62
s_mul_i32 s87, s60, 458752
s_lshl_b32 s70, s88, 7
s_add_u32 s87, s87, s70
s_add_u32 s87, s87, 7340032
s_lshr_b32 s70, s88, 1
s_lshl_b32 s70, s70, 5
s_and_b32 s71, s88, 1
s_lshl_b32 s71, s71, 2
s_add_u32 s70, s70, s71
v_bfe_u32 v4, v1, 3, 2
v_lshlrev_b32 v4, 3, v4
v_bfe_u32 v5, v1, 1, 2
v_add3_u32 v63, v4, v5, s70
v_lshlrev_b32 v63, 1, v63
v_lshl_add_u32 v64, v23, 11, v63
s_mov_b32 s72, 6881280
buffer_load_ushort v61, v64, s[12:15], s72 offen sc1
s_add_u32 s70, s87, 0
buffer_load_dwordx4 v[24:27], v62, s[12:15], s70 offen sc1
s_add_u32 s70, s87, 65536
buffer_load_dwordx4 v[28:31], v62, s[12:15], s70 offen sc1
s_add_u32 s70, s87, 131072
buffer_load_dwordx4 v[32:35], v62, s[12:15], s70 offen sc1
s_add_u32 s70, s87, 196608
buffer_load_dwordx4 v[36:39], v62, s[12:15], s70 offen sc1
s_add_u32 s70, s87, 262144
buffer_load_dwordx4 v[40:43], v62, s[12:15], s70 offen sc1
s_add_u32 s70, s87, 327680
buffer_load_dwordx4 v[44:47], v62, s[12:15], s70 offen sc1
s_add_u32 s70, s87, 393216
buffer_load_dwordx4 v[48:51], v62, s[12:15], s70 offen sc1
v_and_b32 v65, 0xfffff800, v20
v_not_b32 v4, v65
v_ashrrev_i32 v4, 31, v4
v_or_b32 v4, 0x80000000, v4
v_xor_b32 v65, v65, v4
v_mul_f32 v65, 0xbfb8aa3b, v65
v_exp_f32 v65, v65
s_nop 0
v_add_f32 v65, 1.0, v65
v_rcp_f32 v65, v65
v_and_b32 v66, 0x7ff, v20
v_sub_u32 v66, 2047, v66
v_lshl_add_u32 v66, v66, 11, v63
v_add_f32 v67, 1.0, v22
v_mul_f32_e64 v21, -v21, v22
s_lshl_b32 s71, s60, 7
s_add_u32 s71, s71, 163072
v_lshlrev_b32 v6, 4, v3
v_add_u32 v6, s71, v6
v_bfe_u32 v4, v1, 3, 2
v_lshlrev_b32 v7, 4, v3
v_lshl_add_u32 v7, v4, 2, v7
v_add_u32 v7, 163072, v7
s_waitcnt vmcnt(0)
L_y_chk:
v_max3_u32 v2, v24, v28, v32
v_max3_u32 v4, v36, v40, v44
v_max3_u32 v2, v2, v4, v48
v_or_b32 v4, 0xffff0000, v61
v_max_u32 v2, v2, v4
v_cmp_eq_u32 vcc, -1, v2
s_cbranch_vccnz L_y_rt
L_y_ok:
v_pk_add_f32 v[24:25], v[24:25], v[28:29]
v_pk_add_f32 v[26:27], v[26:27], v[30:31]
v_pk_add_f32 v[32:33], v[32:33], v[36:37]
v_pk_add_f32 v[34:35], v[34:35], v[38:39]
v_pk_add_f32 v[40:41], v[40:41], v[44:45]
v_pk_add_f32 v[42:43], v[42:43], v[46:47]
v_pk_add_f32 v[24:25], v[24:25], v[32:33]
v_pk_add_f32 v[26:27], v[26:27], v[34:35]
v_pk_add_f32 v[40:41], v[40:41], v[48:49]
v_pk_add_f32 v[42:43], v[42:43], v[50:51]
v_pk_add_f32 v[24:25], v[24:25], v[40:41]
v_pk_add_f32 v[26:27], v[26:27], v[42:43]
s_nop 0
v_add_f32_dpp v24, v24, v24 row_ror:8 row_mask:0xf bank_mask:0xf
v_add_f32_dpp v25, v25, v25 row_ror:8 row_mask:0xf bank_mask:0xf
v_add_f32_dpp v26, v26, v26 row_ror:8 row_mask:0xf bank_mask:0xf
v_add_f32_dpp v27, v27, v27 row_ror:8 row_mask:0xf bank_mask:0xf
v_mov_b32 v28, v24
v_mov_b32 v29, v25
v_mov_b32 v30, v26
v_mov_b32 v31, v27
v_permlane16_swap_b32 v24, v28
v_permlane16_swap_b32 v25, v29
v_permlane16_swap_b32 v26, v30
v_permlane16_swap_b32 v27, v31
v_add_f32 v24, v24, v28
v_add_f32 v25, v25, v29
v_add_f32 v26, v26, v30
v_add_f32 v27, v27, v31
v_mov_b32 v28, v24
v_mov_b32 v29, v25
v_mov_b32 v30, v26
v_mov_b32 v31, v27
v_permlane32_swap_b32 v24, v28
v_permlane32_swap_b32 v25, v29
v_permlane32_swap_b32 v26, v30
v_permlane32_swap_b32 v27, v31
v_add_f32 v24, v24, v28
v_add_f32 v25, v25, v29
v_add_f32 v26, v26, v30
v_add_f32 v27, v27, v31
ds_write_b128 v6, v[24:27]
s_waitcnt lgkmcnt(0)
s_barrier
s_cmp_lg_u32 s60, 0
s_cbranch_scc1 L_ldone
ds_read_b32 v24, v7 offset:0
ds_read_b32 v25, v7 offset:128
ds_read_b32 v26, v7 offset:256
ds_read_b32 v27, v7 offset:384
v_lshlrev_b32 v61, 16, v61
v_fma_f32 v61, v61, v67, v21
s_waitcnt lgkmcnt(0)
v_add_f32 v24, v24, v25
v_add_f32 v26, v26, v27
v_add_f32 v24, v24, v26
v_fmac_f32 v61, v24, v65
v_cvt_pk_bf16_f32 v61, v61, v61
s_mov_b64 exec, 0xffffffff
buffer_store_short v61, v66, s[20:23], 0 offen sc1
L_ldone:
s_endpgm
L_compute:
v_and_b32 v2, 15, v1
v_lshrrev_b32 v4, 4, v1
v_lshrrev_b32 v3, 1, v2
v_xor_b32 v3, v3, v4
v_lshlrev_b32 v2, 7, v2
s_lshl_b32 s70, s66, 13
v_add_u32 v2, s70, v2
v_xor_b32 v5, 0, v3
v_lshl_add_u32 v8, v5, 4, v2
v_add_u32 v10, 81920, v8
v_xor_b32 v5, 4, v3
v_lshl_add_u32 v9, v5, 4, v2
v_add_u32 v11, 81920, v9
v_lshrrev_b32 v2, 5, v1
v_mul_u32_u24 v2, 6144, v2
v_bfe_u32 v3, v1, 4, 1
v_lshl_add_u32 v2, v3, 10, v2
v_bfe_u32 v4, v1, 2, 2
v_lshl_add_u32 v2, v4, 7, v2
v_lshlrev_b32 v3, 1, v3
v_bfe_u32 v4, v1, 3, 1
v_or_b32 v3, v3, v4
s_lshl_b32 s70, s67, 1
v_xor_b32 v3, s70, v3
v_and_b32 v4, 3, v1
v_lshl_add_u32 v2, v4, 3, v2
v_add_u32 v2, 16384, v2
v_xor_b32 v4, 0, v3
v_lshl_add_u32 v12, v4, 5, v2
v_add_u32 v14, 81920, v12
v_xor_b32 v4, 1, v3
v_lshl_add_u32 v13, v4, 5, v2
v_add_u32 v15, 81920, v13
s_waitcnt lgkmcnt(0)
s_mov_b32 s12, s58
s_and_b32 s13, s59, 0xffff
s_mov_b32 s14, 268435456
s_mov_b32 s15, 0x20000
s_mov_b32 s36, s48
s_and_b32 s37, s49, 0xffff
s_mov_b32 s38, 2048
s_mov_b32 s39, 0x20000
s_mov_b32 s20, s56
s_and_b32 s21, s57, 0xffff
s_mov_b32 s22, 4194304
s_mov_b32 s23, 0x20000
v_mov_b32 v2, 0
buffer_load_dword v19, v2, s[12:15], 0 offen sc1
buffer_load_dwordx4 v[20:23], v16, s[36:39], 0 offen
buffer_load_dwordx4 v[24:27], v16, s[36:39], 0 offen offset:1024
v_lshrrev_b32 v3, 4, v1
v_lshlrev_b32 v3, 3, v3
s_lshl_b32 s70, s65, 7
buffer_load_dwordx2 a[96:97], v3, s[36:39], s70 offen offset:0
buffer_load_dwordx2 a[98:99], v3, s[36:39], s70 offen offset:32
buffer_load_dwordx2 a[100:101], v3, s[36:39], s70 offen offset:64
buffer_load_dwordx2 a[102:103], v3, s[36:39], s70 offen offset:96
v_mov_b32 v32, 0
v_mov_b32 v33, 0
v_mov_b32 v34, 0
v_mov_b32 v35, 0
v_mov_b32 v36, 0
v_mov_b32 v37, 0
v_mov_b32 v38, 0
v_mov_b32 v39, 0
v_mov_b32 v40, 0
v_mov_b32 v41, 0
v_mov_b32 v42, 0
v_mov_b32 v43, 0
v_mov_b32 v44, 0
v_mov_b32 v45, 0
v_mov_b32 v46, 0
v_mov_b32 v47, 0
v_mov_b32 v48, 0
v_mov_b32 v49, 0
v_mov_b32 v50, 0
v_mov_b32 v51, 0
v_mov_b32 v52, 0
v_mov_b32 v53, 0
v_mov_b32 v54, 0
v_mov_b32 v55, 0
v_mov_b32 v56, 0
v_mov_b32 v57, 0
v_mov_b32 v58, 0
v_mov_b32 v59, 0
v_mov_b32 v60, 0
v_mov_b32 v61, 0
v_mov_b32 v62, 0
v_mov_b32 v63, 0
v_mov_b32 v64, 0
v_mov_b32 v65, 0
v_mov_b32 v66, 0
v_mov_b32 v67, 0
v_mov_b32 v68, 0
v_mov_b32 v69, 0
v_mov_b32 v70, 0
v_mov_b32 v71, 0
v_mov_b32 v72, 0
v_mov_b32 v73, 0
v_mov_b32 v74, 0
v_mov_b32 v75, 0
v_mov_b32 v76, 0
v_mov_b32 v77, 0
v_mov_b32 v78, 0
v_mov_b32 v79, 0
v_mov_b32 v80, 0
v_mov_b32 v81, 0
v_mov_b32 v82, 0
v_mov_b32 v83, 0
v_mov_b32 v84, 0
v_mov_b32 v85, 0
v_mov_b32 v86, 0
v_mov_b32 v87, 0
v_mov_b32 v88, 0
v_mov_b32 v89, 0
v_mov_b32 v90, 0
v_mov_b32 v91, 0
v_mov_b32 v92, 0
v_mov_b32 v93, 0
v_mov_b32 v94, 0
v_mov_b32 v95, 0
v_mov_b32 v96, 0
v_mov_b32 v97, 0
v_mov_b32 v98, 0
v_mov_b32 v99, 0
v_mov_b32 v100, 0
v_mov_b32 v101, 0
v_mov_b32 v102, 0
v_mov_b32 v103, 0
v_mov_b32 v104, 0
v_mov_b32 v105, 0
v_mov_b32 v106, 0
v_mov_b32 v107, 0
v_mov_b32 v108, 0
v_mov_b32 v109, 0
v_mov_b32 v110, 0
v_mov_b32 v111, 0
v_mov_b32 v112, 0
v_mov_b32 v113, 0
v_mov_b32 v114, 0
v_mov_b32 v115, 0
v_mov_b32 v116, 0
v_mov_b32 v117, 0
v_mov_b32 v118, 0
v_mov_b32 v119, 0
v_mov_b32 v120, 0
v_mov_b32 v121, 0
v_mov_b32 v122, 0
v_mov_b32 v123, 0
v_mov_b32 v124, 0
v_mov_b32 v125, 0
v_mov_b32 v126, 0
v_mov_b32 v127, 0
s_mov_b32 s70, 0x3f803f80
v_accvgpr_write_b32 a80, s70
v_accvgpr_write_b32 a81, s70
v_accvgpr_write_b32 a82, s70
v_accvgpr_write_b32 a83, s70
s_mov_b32 s80, 0x358637bd
s_mov_b32 s81, 0x358637bd
s_mov_b32 s82, 0x3f800008
s_mov_b32 s83, 0x3f800008
s_mov_b32 s90, 0x3fb8aa3b
s_mov_b32 s91, 0x3fb8aa3b
s_waitcnt vmcnt(4)
v_readfirstlane_b32 s68, v19
v_lshlrev_b32 v128, 16, v20
v_and_b32 v129, 0xffff0000, v20
v_lshlrev_b32 v130, 16, v21
v_and_b32 v131, 0xffff0000, v21
v_lshlrev_b32 v132, 16, v22
v_and_b32 v133, 0xffff0000, v22
v_lshlrev_b32 v134, 16, v23
v_and_b32 v135, 0xffff0000, v23
v_lshlrev_b32 v136, 16, v24
v_and_b32 v137, 0xffff0000, v24
v_lshlrev_b32 v138, 16, v25
v_and_b32 v139, 0xffff0000, v25
v_lshlrev_b32 v140, 16, v26
v_and_b32 v141, 0xffff0000, v26
v_lshlrev_b32 v142, 16, v27
v_and_b32 v143, 0xffff0000, v27
s_add_u32 s68, s68, 1
v_pk_add_f32 v[128:129], v[128:129], v[130:131]
v_pk_add_f32 v[132:133], v[132:133], v[134:135]
v_pk_add_f32 v[136:137], v[136:137], v[138:139]
v_pk_add_f32 v[140:141], v[140:141], v[142:143]
v_pk_add_f32 v[128:129], v[128:129], v[132:133]
v_pk_add_f32 v[136:137], v[136:137], v[140:141]
v_pk_add_f32 v[128:129], v[128:129], v[136:137]
v_add_f32 v2, v128, v129
s_nop 1
v_add_f32_dpp v2, v2, v2 row_ror:1 row_mask:0xf bank_mask:0xf
s_nop 1
v_add_f32_dpp v2, v2, v2 row_ror:2 row_mask:0xf bank_mask:0xf
s_nop 1
v_add_f32_dpp v2, v2, v2 row_ror:4 row_mask:0xf bank_mask:0xf
s_nop 1
v_add_f32_dpp v2, v2, v2 row_ror:8 row_mask:0xf bank_mask:0xf
v_mov_b32 v3, v2
s_nop 1
v_permlane16_swap_b32 v2, v3
v_add_f32 v2, v2, v3
v_mov_b32 v3, v2
s_nop 1
v_permlane32_swap_b32 v2, v3
v_add_f32 v2, v2, v3
s_nop 0
v_readfirstlane_b32 s84, v2
v_mov_b32 v20, -1
v_mov_b32 v21, -1
v_mov_b32 v22, -1
v_mov_b32 v23, -1
s_lshl_b32 s87, s64, 4
s_add_u32 s87, s87, s65
s_mul_i32 s87, s87, 4352
s_add_u32 s87, s87, 524288
s_lshl_b32 s88, s65, 18
s_lshl_b32 s70, s66, 17
s_add_u32 s88, s88, s70
s_lshl_b32 s70, s64, 11
s_add_u32 s88, s88, s70
s_lshl_b32 s70, s67, 10
s_add_u32 s88, s88, s70
s_add_u32 s88, s88, 2097152
s_barrier
ds_read_b128 a[0:3], v8 offset:0
ds_read_b64_tr_b16 a[32:33], v12 offset:0
ds_read_b64_tr_b16 a[34:35], v12 offset:512
ds_read_b128 a[4:7], v8 offset:2048
ds_read_b128 a[8:11], v8 offset:4096
ds_read_b128 a[12:15], v8 offset:6144
ds_read_b64_tr_b16 a[36:37], v13 offset:0
ds_read_b64_tr_b16 a[38:39], v13 offset:512
ds_read_b64_tr_b16 a[40:41], v12 offset:2048
ds_read_b64_tr_b16 a[42:43], v12 offset:2560
ds_read_b64_tr_b16 a[44:45], v13 offset:2048
ds_read_b64_tr_b16 a[46:47], v13 offset:2560
ds_read_b64_tr_b16 a[48:49], v12 offset:4096
ds_read_b64_tr_b16 a[50:51], v12 offset:4608
ds_read_b64_tr_b16 a[52:53], v13 offset:4096
ds_read_b64_tr_b16 a[54:55], v13 offset:4608
s_waitcnt lgkmcnt(0)
s_cmp_lg_u32 s66, 0
s_cbranch_scc1 L_nocs0
v_mfma_f32_16x16x32_bf16 v[128:131], a[80:83], a[32:35], 0
v_mfma_f32_16x16x32_bf16 v[132:135], a[80:83], a[36:39], 0
v_mfma_f32_16x16x32_bf16 v[136:139], a[80:83], a[40:43], 0
v_mfma_f32_16x16x32_bf16 v[140:143], a[80:83], a[44:47], 0
v_mfma_f32_16x16x32_bf16 v[144:147], a[80:83], a[48:51], 0
v_mfma_f32_16x16x32_bf16 v[148:151], a[80:83], a[52:55], 0
L_nocs0:
v_mfma_f32_16x16x32_bf16 v[32:35], a[32:35], a[0:3], v[32:35]
ds_read_b128 a[16:19], v9 offset:0
v_mfma_f32_16x16x32_bf16 v[56:59], a[32:35], a[4:7], v[56:59]
ds_read_b64_tr_b16 a[56:57], v12 offset:12288
v_mfma_f32_16x16x32_bf16 v[80:83], a[32:35], a[8:11], v[80:83]
ds_read_b64_tr_b16 a[58:59], v12 offset:12800
v_mfma_f32_16x16x32_bf16 v[104:107], a[32:35], a[12:15], v[104:107]
ds_read_b128 a[20:23], v9 offset:2048
v_mfma_f32_16x16x32_bf16 v[36:39], a[36:39], a[0:3], v[36:39]
ds_read_b128 a[24:27], v9 offset:4096
v_mfma_f32_16x16x32_bf16 v[60:63], a[36:39], a[4:7], v[60:63]
ds_read_b128 a[28:31], v9 offset:6144
v_mfma_f32_16x16x32_bf16 v[84:87], a[36:39], a[8:11], v[84:87]
ds_read_b64_tr_b16 a[60:61], v13 offset:12288
v_mfma_f32_16x16x32_bf16 v[108:111], a[36:39], a[12:15], v[108:111]
ds_read_b64_tr_b16 a[62:63], v13 offset:12800
v_mfma_f32_16x16x32_bf16 v[40:43], a[0:3], a[40:43], v[40:43]
ds_read_b64_tr_b16 a[64:65], v12 offset:14336
v_mfma_f32_16x16x32_bf16 v[64:67], a[4:7], a[40:43], v[64:67]
ds_read_b64_tr_b16 a[66:67], v12 offset:14848
v_mfma_f32_16x16x32_bf16 v[88:91], a[8:11], a[40:43], v[88:91]
ds_read_b64_tr_b16 a[68:69], v13 offset:14336
v_mfma_f32_16x16x32_bf16 v[112:115], a[12:15], a[40:43], v[112:115]
ds_read_b64_tr_b16 a[70:71], v13 offset:14848
v_mfma_f32_16x16x32_bf16 v[44:47], a[0:3], a[44:47], v[44:47]
ds_read_b64_tr_b16 a[72:73], v12 offset:16384
v_mfma_f32_16x16x32_bf16 v[68:71], a[4:7], a[44:47], v[68:71]
ds_read_b64_tr_b16 a[74:75], v12 offset:16896
v_mfma_f32_16x16x32_bf16 v[92:95], a[8:11], a[44:47], v[92:95]
ds_read_b64_tr_b16 a[76:77], v13 offset:16384
v_mfma_f32_16x16x32_bf16 v[116:119], a[12:15], a[44:47], v[116:119]
ds_read_b64_tr_b16 a[78:79], v13 offset:16896
v_mfma_f32_16x16x32_bf16 v[48:51], a[0:3], a[48:51], v[48:51]
v_mfma_f32_16x16x32_bf16 v[72:75], a[4:7], a[48:51], v[72:75]
v_mfma_f32_16x16x32_bf16 v[96:99], a[8:11], a[48:51], v[96:99]
v_mfma_f32_16x16x32_bf16 v[120:123], a[12:15], a[48:51], v[120:123]
v_mfma_f32_16x16x32_bf16 v[52:55], a[0:3], a[52:55], v[52:55]
v_mfma_f32_16x16x32_bf16 v[76:79], a[4:7], a[52:55], v[76:79]
v_mfma_f32_16x16x32_bf16 v[100:103], a[8:11], a[52:55], v[100:103]
v_mfma_f32_16x16x32_bf16 v[124:127], a[12:15], a[52:55], v[124:127]
s_waitcnt lgkmcnt(0)
s_cmp_lg_u32 s66, 0
s_cbranch_scc1 L_nocs1
v_mfma_f32_16x16x32_bf16 v[128:131], a[80:83], a[56:59], v[128:131]
v_mfma_f32_16x16x32_bf16 v[132:135], a[80:83], a[60:63], v[132:135]
v_mfma_f32_16x16x32_bf16 v[136:139], a[80:83], a[64:67], v[136:139]
v_mfma_f32_16x16x32_bf16 v[140:143], a[80:83], a[68:71], v[140:143]
v_mfma_f32_16x16x32_bf16 v[144:147], a[80:83], a[72:75], v[144:147]
v_mfma_f32_16x16x32_bf16 v[148:151], a[80:83], a[76:79], v[148:151]
L_nocs1:
v_mfma_f32_16x16x32_bf16 v[32:35], a[56:59], a[16:19], v[32:35]
s_barrier
ds_read_b128 a[0:3], v8 offset:40960
v_mfma_f32_16x16x32_bf16 v[56:59], a[56:59], a[20:23], v[56:59]
ds_read_b64_tr_b16 a[32:33], v12 offset:40960
v_mfma_f32_16x16x32_bf16 v[80:83], a[56:59], a[24:27], v[80:83]
ds_read_b64_tr_b16 a[34:35], v12 offset:41472
v_mfma_f32_16x16x32_bf16 v[104:107], a[56:59], a[28:31], v[104:107]
ds_read_b128 a[4:7], v8 offset:43008
v_mfma_f32_16x16x32_bf16 v[36:39], a[60:63], a[16:19], v[36:39]
ds_read_b128 a[8:11], v8 offset:45056
v_mfma_f32_16x16x32_bf16 v[60:63], a[60:63], a[20:23], v[60:63]
ds_read_b128 a[12:15], v8 offset:47104
v_mfma_f32_16x16x32_bf16 v[84:87], a[60:63], a[24:27], v[84:87]
ds_read_b64_tr_b16 a[36:37], v13 offset:40960
v_mfma_f32_16x16x32_bf16 v[108:111], a[60:63], a[28:31], v[108:111]
ds_read_b64_tr_b16 a[38:39], v13 offset:41472
v_mfma_f32_16x16x32_bf16 v[40:43], a[16:19], a[64:67], v[40:43]
ds_read_b64_tr_b16 a[40:41], v12 offset:43008
v_mfma_f32_16x16x32_bf16 v[64:67], a[20:23], a[64:67], v[64:67]
ds_read_b64_tr_b16 a[42:43], v12 offset:43520
v_mfma_f32_16x16x32_bf16 v[88:91], a[24:27], a[64:67], v[88:91]
ds_read_b64_tr_b16 a[44:45], v13 offset:43008
v_mfma_f32_16x16x32_bf16 v[112:115], a[28:31], a[64:67], v[112:115]
ds_read_b64_tr_b16 a[46:47], v13 offset:43520
v_mfma_f32_16x16x32_bf16 v[44:47], a[16:19], a[68:71], v[44:47]
ds_read_b64_tr_b16 a[48:49], v12 offset:45056
v_mfma_f32_16x16x32_bf16 v[68:71], a[20:23], a[68:71], v[68:71]
ds_read_b64_tr_b16 a[50:51], v12 offset:45568
v_mfma_f32_16x16x32_bf16 v[92:95], a[24:27], a[68:71], v[92:95]
ds_read_b64_tr_b16 a[52:53], v13 offset:45056
v_mfma_f32_16x16x32_bf16 v[116:119], a[28:31], a[68:71], v[116:119]
ds_read_b64_tr_b16 a[54:55], v13 offset:45568
v_mfma_f32_16x16x32_bf16 v[48:51], a[16:19], a[72:75], v[48:51]
s_lshl_b32 s70, s60, 10
s_add_u32 s70, s70, s87
buffer_store_dwordx4 v[20:23], v16, s[12:15], s70 offen sc1
v_mfma_f32_16x16x32_bf16 v[72:75], a[20:23], a[72:75], v[72:75]
v_mfma_f32_16x16x32_bf16 v[96:99], a[24:27], a[72:75], v[96:99]
s_add_u32 s70, s88, 0
buffer_store_dwordx4 v[20:23], v16, s[12:15], s70 offen sc1
v_mfma_f32_16x16x32_bf16 v[120:123], a[28:31], a[72:75], v[120:123]
v_mfma_f32_16x16x32_bf16 v[52:55], a[16:19], a[76:79], v[52:55]
s_add_u32 s70, s88, 32768
buffer_store_dwordx4 v[20:23], v16, s[12:15], s70 offen sc1
v_mfma_f32_16x16x32_bf16 v[76:79], a[20:23], a[76:79], v[76:79]
v_mfma_f32_16x16x32_bf16 v[100:103], a[24:27], a[76:79], v[100:103]
s_add_u32 s70, s88, 65536
buffer_store_dwordx4 v[20:23], v16, s[12:15], s70 offen sc1
v_mfma_f32_16x16x32_bf16 v[124:127], a[28:31], a[76:79], v[124:127]
s_waitcnt lgkmcnt(0)
v_mfma_f32_16x16x32_bf16 v[32:35], a[32:35], a[0:3], v[32:35]
ds_read_b128 a[16:19], v9 offset:40960
v_mfma_f32_16x16x32_bf16 v[56:59], a[32:35], a[4:7], v[56:59]
ds_read_b64_tr_b16 a[56:57], v12 offset:53248
v_mfma_f32_16x16x32_bf16 v[80:83], a[32:35], a[8:11], v[80:83]
ds_read_b64_tr_b16 a[58:59], v12 offset:53760
v_mfma_f32_16x16x32_bf16 v[104:107], a[32:35], a[12:15], v[104:107]
ds_read_b128 a[20:23], v9 offset:43008
v_mfma_f32_16x16x32_bf16 v[36:39], a[36:39], a[0:3], v[36:39]
ds_read_b128 a[24:27], v9 offset:45056
v_mfma_f32_16x16x32_bf16 v[60:63], a[36:39], a[4:7], v[60:63]
ds_read_b128 a[28:31], v9 offset:47104
v_mfma_f32_16x16x32_bf16 v[84:87], a[36:39], a[8:11], v[84:87]
ds_read_b64_tr_b16 a[60:61], v13 offset:53248
v_mfma_f32_16x16x32_bf16 v[108:111], a[36:39], a[12:15], v[108:111]
ds_read_b64_tr_b16 a[62:63], v13 offset:53760
v_mfma_f32_16x16x32_bf16 v[40:43], a[0:3], a[40:43], v[40:43]
ds_read_b64_tr_b16 a[64:65], v12 offset:55296
v_mfma_f32_16x16x32_bf16 v[64:67], a[4:7], a[40:43], v[64:67]
ds_read_b64_tr_b16 a[66:67], v12 offset:55808
v_mfma_f32_16x16x32_bf16 v[88:91], a[8:11], a[40:43], v[88:91]
ds_read_b64_tr_b16 a[68:69], v13 offset:55296
v_mfma_f32_16x16x32_bf16 v[112:115], a[12:15], a[40:43], v[112:115]
ds_read_b64_tr_b16 a[70:71], v13 offset:55808
v_mfma_f32_16x16x32_bf16 v[44:47], a[0:3], a[44:47], v[44:47]
ds_read_b64_tr_b16 a[72:73], v12 offset:57344
v_mfma_f32_16x16x32_bf16 v[68:71], a[4:7], a[44:47], v[68:71]
ds_read_b64_tr_b16 a[74:75], v12 offset:57856
v_mfma_f32_16x16x32_bf16 v[92:95], a[8:11], a[44:47], v[92:95]
ds_read_b64_tr_b16 a[76:77], v13 offset:57344
v_mfma_f32_16x16x32_bf16 v[116:119], a[12:15], a[44:47], v[116:119]
ds_read_b64_tr_b16 a[78:79], v13 offset:57856
v_mfma_f32_16x16x32_bf16 v[48:51], a[0:3], a[48:51], v[48:51]
s_add_u32 s70, s88, 98304
buffer_store_dwordx4 v[20:23], v16, s[12:15], s70 offen sc1
v_mfma_f32_16x16x32_bf16 v[72:75], a[4:7], a[48:51], v[72:75]
v_mfma_f32_16x16x32_bf16 v[96:99], a[8:11], a[48:51], v[96:99]
s_min_u32 s70, s79, 223
s_lshl_b32 s70, s70, 13
s_lshl_b32 s71, s60, 11
s_add_u32 s70, s70, s71
s_add_u32 s70, s70, 7340032
s_cmp_lt_u32 s63, 28
s_cbranch_scc0 L_noypc
buffer_store_dwordx4 v[20:23], v16, s[12:15], s70 offen sc1
buffer_store_dwordx4 v[20:23], v16, s[12:15], s70 offen offset:1024 sc1
L_noypc:
v_mfma_f32_16x16x32_bf16 v[120:123], a[12:15], a[48:51], v[120:123]
v_mfma_f32_16x16x32_bf16 v[52:55], a[0:3], a[52:55], v[52:55]
s_lshl_b32 s70, s60, 6
s_add_u32 s70, s70, s87
s_add_u32 s70, s70, 4096
s_mov_b64 exec, 0xf
buffer_store_dwordx4 v[20:23], v16, s[12:15], s70 offen sc1
s_mov_b64 exec, -1
v_mfma_f32_16x16x32_bf16 v[76:79], a[4:7], a[52:55], v[76:79]
v_mfma_f32_16x16x32_bf16 v[100:103], a[8:11], a[52:55], v[100:103]
s_lshl_b32 s70, s64, 12
s_lshl_b32 s71, s66, 11
s_add_u32 s70, s70, s71
s_lshl_b32 s71, s65, 7
s_add_u32 s70, s70, s71
s_lshl_b32 s71, s67, 6
s_add_u32 s70, s70, s71
s_add_u32 s70, s70, 6881280
s_mov_b64 exec, 0xf
buffer_store_dwordx4 v[20:23], v16, s[12:15], s70 offen sc1
s_mov_b64 exec, -1
v_mfma_f32_16x16x32_bf16 v[124:127], a[12:15], a[52:55], v[124:127]
s_waitcnt lgkmcnt(0)
v_mfma_f32_16x16x32_bf16 v[32:35], a[56:59], a[16:19], v[32:35]
s_barrier
ds_read_b128 a[0:3], v10 offset:0
v_mfma_f32_16x16x32_bf16 v[56:59], a[56:59], a[20:23], v[56:59]
ds_read_b64_tr_b16 a[32:33], v14 offset:0
v_mfma_f32_16x16x32_bf16 v[80:83], a[56:59], a[24:27], v[80:83]
ds_read_b64_tr_b16 a[34:35], v14 offset:512
v_mfma_f32_16x16x32_bf16 v[104:107], a[56:59], a[28:31], v[104:107]
ds_read_b128 a[4:7], v10 offset:2048
v_mfma_f32_16x16x32_bf16 v[36:39], a[60:63], a[16:19], v[36:39]
ds_read_b128 a[8:11], v10 offset:4096
v_mfma_f32_16x16x32_bf16 v[60:63], a[60:63], a[20:23], v[60:63]
ds_read_b128 a[12:15], v10 offset:6144
v_mfma_f32_16x16x32_bf16 v[84:87], a[60:63], a[24:27], v[84:87]
ds_read_b64_tr_b16 a[36:37], v15 offset:0
v_mfma_f32_16x16x32_bf16 v[108:111], a[60:63], a[28:31], v[108:111]
ds_read_b64_tr_b16 a[38:39], v15 offset:512
v_mfma_f32_16x16x32_bf16 v[40:43], a[16:19], a[64:67], v[40:43]
ds_read_b64_tr_b16 a[40:41], v14 offset:2048
v_mfma_f32_16x16x32_bf16 v[64:67], a[20:23], a[64:67], v[64:67]
ds_read_b64_tr_b16 a[42:43], v14 offset:2560
v_mfma_f32_16x16x32_bf16 v[88:91], a[24:27], a[64:67], v[88:91]
ds_read_b64_tr_b16 a[44:45], v15 offset:2048
v_mfma_f32_16x16x32_bf16 v[112:115], a[28:31], a[64:67], v[112:115]
ds_read_b64_tr_b16 a[46:47], v15 offset:2560
v_mfma_f32_16x16x32_bf16 v[44:47], a[16:19], a[68:71], v[44:47]
ds_read_b64_tr_b16 a[48:49], v14 offset:4096
v_mfma_f32_16x16x32_bf16 v[68:71], a[20:23], a[68:71], v[68:71]
ds_read_b64_tr_b16 a[50:51], v14 offset:4608
v_mfma_f32_16x16x32_bf16 v[92:95], a[24:27], a[68:71], v[92:95]
ds_read_b64_tr_b16 a[52:53], v15 offset:4096
v_mfma_f32_16x16x32_bf16 v[116:119], a[28:31], a[68:71], v[116:119]
ds_read_b64_tr_b16 a[54:55], v15 offset:4608
v_mfma_f32_16x16x32_bf16 v[48:51], a[16:19], a[72:75], v[48:51]
v_mfma_f32_16x16x32_bf16 v[72:75], a[20:23], a[72:75], v[72:75]
v_mfma_f32_16x16x32_bf16 v[96:99], a[24:27], a[72:75], v[96:99]
v_mfma_f32_16x16x32_bf16 v[120:123], a[28:31], a[72:75], v[120:123]
v_mfma_f32_16x16x32_bf16 v[52:55], a[16:19], a[76:79], v[52:55]
v_mfma_f32_16x16x32_bf16 v[76:79], a[20:23], a[76:79], v[76:79]
v_mfma_f32_16x16x32_bf16 v[100:103], a[24:27], a[76:79], v[100:103]
v_mfma_f32_16x16x32_bf16 v[124:127], a[28:31], a[76:79], v[124:127]
s_waitcnt lgkmcnt(0)
v_mfma_f32_16x16x32_bf16 v[32:35], a[32:35], a[0:3], v[32:35]
ds_read_b128 a[16:19], v11 offset:0
v_mfma_f32_16x16x32_bf16 v[56:59], a[32:35], a[4:7], v[56:59]
ds_read_b64_tr_b16 a[56:57], v14 offset:12288
v_mfma_f32_16x16x32_bf16 v[80:83], a[32:35], a[8:11], v[80:83]
ds_read_b64_tr_b16 a[58:59], v14 offset:12800
v_mfma_f32_16x16x32_bf16 v[104:107], a[32:35], a[12:15], v[104:107]
ds_read_b128 a[20:23], v11 offset:2048
v_mfma_f32_16x16x32_bf16 v[36:39], a[36:39], a[0:3], v[36:39]
ds_read_b128 a[24:27], v11 offset:4096
v_mfma_f32_16x16x32_bf16 v[60:63], a[36:39], a[4:7], v[60:63]
ds_read_b128 a[28:31], v11 offset:6144
v_mfma_f32_16x16x32_bf16 v[84:87], a[36:39], a[8:11], v[84:87]
ds_read_b64_tr_b16 a[60:61], v15 offset:12288
v_mfma_f32_16x16x32_bf16 v[108:111], a[36:39], a[12:15], v[108:111]
ds_read_b64_tr_b16 a[62:63], v15 offset:12800
v_mfma_f32_16x16x32_bf16 v[40:43], a[0:3], a[40:43], v[40:43]
ds_read_b64_tr_b16 a[64:65], v14 offset:14336
v_mfma_f32_16x16x32_bf16 v[64:67], a[4:7], a[40:43], v[64:67]
ds_read_b64_tr_b16 a[66:67], v14 offset:14848
v_mfma_f32_16x16x32_bf16 v[88:91], a[8:11], a[40:43], v[88:91]
ds_read_b64_tr_b16 a[68:69], v15 offset:14336
v_mfma_f32_16x16x32_bf16 v[112:115], a[12:15], a[40:43], v[112:115]
ds_read_b64_tr_b16 a[70:71], v15 offset:14848
v_mfma_f32_16x16x32_bf16 v[44:47], a[0:3], a[44:47], v[44:47]
ds_read_b64_tr_b16 a[72:73], v14 offset:16384
v_mfma_f32_16x16x32_bf16 v[68:71], a[4:7], a[44:47], v[68:71]
ds_read_b64_tr_b16 a[74:75], v14 offset:16896
v_mfma_f32_16x16x32_bf16 v[92:95], a[8:11], a[44:47], v[92:95]
ds_read_b64_tr_b16 a[76:77], v15 offset:16384
v_mfma_f32_16x16x32_bf16 v[116:119], a[12:15], a[44:47], v[116:119]
ds_read_b64_tr_b16 a[78:79], v15 offset:16896
v_mfma_f32_16x16x32_bf16 v[48:51], a[0:3], a[48:51], v[48:51]
v_mfma_f32_16x16x32_bf16 v[72:75], a[4:7], a[48:51], v[72:75]
v_mfma_f32_16x16x32_bf16 v[96:99], a[8:11], a[48:51], v[96:99]
v_mfma_f32_16x16x32_bf16 v[120:123], a[12:15], a[48:51], v[120:123]
v_mfma_f32_16x16x32_bf16 v[52:55], a[0:3], a[52:55], v[52:55]
v_mfma_f32_16x16x32_bf16 v[76:79], a[4:7], a[52:55], v[76:79]
v_mfma_f32_16x16x32_bf16 v[100:103], a[8:11], a[52:55], v[100:103]
v_mfma_f32_16x16x32_bf16 v[124:127], a[12:15], a[52:55], v[124:127]
s_waitcnt lgkmcnt(0)
v_mfma_f32_16x16x32_bf16 v[32:35], a[56:59], a[16:19], v[32:35]
s_barrier
ds_read_b128 a[0:3], v8 offset:0
v_mfma_f32_16x16x32_bf16 v[56:59], a[56:59], a[20:23], v[56:59]
ds_read_b64_tr_b16 a[32:33], v12 offset:0
v_mfma_f32_16x16x32_bf16 v[80:83], a[56:59], a[24:27], v[80:83]
ds_read_b64_tr_b16 a[34:35], v12 offset:512
v_mfma_f32_16x16x32_bf16 v[104:107], a[56:59], a[28:31], v[104:107]
ds_read_b128 a[4:7], v8 offset:2048
v_mfma_f32_16x16x32_bf16 v[36:39], a[60:63], a[16:19], v[36:39]
ds_read_b128 a[8:11], v8 offset:4096
v_mfma_f32_16x16x32_bf16 v[60:63], a[60:63], a[20:23], v[60:63]
ds_read_b128 a[12:15], v8 offset:6144
v_mfma_f32_16x16x32_bf16 v[84:87], a[60:63], a[24:27], v[84:87]
ds_read_b64_tr_b16 a[36:37], v13 offset:0
v_mfma_f32_16x16x32_bf16 v[108:111], a[60:63], a[28:31], v[108:111]
ds_read_b64_tr_b16 a[38:39], v13 offset:512
v_mfma_f32_16x16x32_bf16 v[40:43], a[16:19], a[64:67], v[40:43]
ds_read_b64_tr_b16 a[40:41], v12 offset:2048
v_mfma_f32_16x16x32_bf16 v[64:67], a[20:23], a[64:67], v[64:67]
ds_read_b64_tr_b16 a[42:43], v12 offset:2560
v_mfma_f32_16x16x32_bf16 v[88:91], a[24:27], a[64:67], v[88:91]
ds_read_b64_tr_b16 a[44:45], v13 offset:2048
v_mfma_f32_16x16x32_bf16 v[112:115], a[28:31], a[64:67], v[112:115]
ds_read_b64_tr_b16 a[46:47], v13 offset:2560
v_mfma_f32_16x16x32_bf16 v[44:47], a[16:19], a[68:71], v[44:47]
ds_read_b64_tr_b16 a[48:49], v12 offset:4096
v_mfma_f32_16x16x32_bf16 v[68:71], a[20:23], a[68:71], v[68:71]
ds_read_b64_tr_b16 a[50:51], v12 offset:4608
v_mfma_f32_16x16x32_bf16 v[92:95], a[24:27], a[68:71], v[92:95]
ds_read_b64_tr_b16 a[52:53], v13 offset:4096
v_mfma_f32_16x16x32_bf16 v[116:119], a[28:31], a[68:71], v[116:119]
ds_read_b64_tr_b16 a[54:55], v13 offset:4608
v_mfma_f32_16x16x32_bf16 v[48:51], a[16:19], a[72:75], v[48:51]
v_mfma_f32_16x16x32_bf16 v[72:75], a[20:23], a[72:75], v[72:75]
v_mfma_f32_16x16x32_bf16 v[96:99], a[24:27], a[72:75], v[96:99]
v_mfma_f32_16x16x32_bf16 v[120:123], a[28:31], a[72:75], v[120:123]
v_mfma_f32_16x16x32_bf16 v[52:55], a[16:19], a[76:79], v[52:55]
v_mfma_f32_16x16x32_bf16 v[76:79], a[20:23], a[76:79], v[76:79]
v_mfma_f32_16x16x32_bf16 v[100:103], a[24:27], a[76:79], v[100:103]
v_mfma_f32_16x16x32_bf16 v[124:127], a[28:31], a[76:79], v[124:127]
s_waitcnt lgkmcnt(0)
v_mfma_f32_16x16x32_bf16 v[32:35], a[32:35], a[0:3], v[32:35]
ds_read_b128 a[16:19], v9 offset:0
v_mfma_f32_16x16x32_bf16 v[56:59], a[32:35], a[4:7], v[56:59]
ds_read_b64_tr_b16 a[56:57], v12 offset:12288
v_mfma_f32_16x16x32_bf16 v[80:83], a[32:35], a[8:11], v[80:83]
ds_read_b64_tr_b16 a[58:59], v12 offset:12800
v_mfma_f32_16x16x32_bf16 v[104:107], a[32:35], a[12:15], v[104:107]
ds_read_b128 a[20:23], v9 offset:2048
v_mfma_f32_16x16x32_bf16 v[36:39], a[36:39], a[0:3], v[36:39]
ds_read_b128 a[24:27], v9 offset:4096
v_mfma_f32_16x16x32_bf16 v[60:63], a[36:39], a[4:7], v[60:63]
ds_read_b128 a[28:31], v9 offset:6144
v_mfma_f32_16x16x32_bf16 v[84:87], a[36:39], a[8:11], v[84:87]
ds_read_b64_tr_b16 a[60:61], v13 offset:12288
v_mfma_f32_16x16x32_bf16 v[108:111], a[36:39], a[12:15], v[108:111]
ds_read_b64_tr_b16 a[62:63], v13 offset:12800
v_mfma_f32_16x16x32_bf16 v[40:43], a[0:3], a[40:43], v[40:43]
ds_read_b64_tr_b16 a[64:65], v12 offset:14336
v_mfma_f32_16x16x32_bf16 v[64:67], a[4:7], a[40:43], v[64:67]
ds_read_b64_tr_b16 a[66:67], v12 offset:14848
v_mfma_f32_16x16x32_bf16 v[88:91], a[8:11], a[40:43], v[88:91]
ds_read_b64_tr_b16 a[68:69], v13 offset:14336
v_mfma_f32_16x16x32_bf16 v[112:115], a[12:15], a[40:43], v[112:115]
ds_read_b64_tr_b16 a[70:71], v13 offset:14848
v_mfma_f32_16x16x32_bf16 v[44:47], a[0:3], a[44:47], v[44:47]
ds_read_b64_tr_b16 a[72:73], v12 offset:16384
v_mfma_f32_16x16x32_bf16 v[68:71], a[4:7], a[44:47], v[68:71]
ds_read_b64_tr_b16 a[74:75], v12 offset:16896
v_mfma_f32_16x16x32_bf16 v[92:95], a[8:11], a[44:47], v[92:95]
ds_read_b64_tr_b16 a[76:77], v13 offset:16384
v_mfma_f32_16x16x32_bf16 v[116:119], a[12:15], a[44:47], v[116:119]
ds_read_b64_tr_b16 a[78:79], v13 offset:16896
v_mfma_f32_16x16x32_bf16 v[48:51], a[0:3], a[48:51], v[48:51]
s_cmp_lg_u32 s66, 0
s_cbranch_scc1 L_nocsp
v_and_b32 v2, 16, v1
v_cmp_ne_u32 vcc, 0, v2
s_nop 1
v_cndmask_b32 v24, v128, v132, vcc
v_cndmask_b32 v25, v136, v140, vcc
v_cndmask_b32 v26, v144, v148, vcc
v_mov_b32 v27, s68
s_lshl_b32 s70, s64, 4
s_add_u32 s70, s70, s65
s_lshl_b32 s70, s70, 10
s_lshl_b32 s71, s67, 9
s_add_u32 s70, s70, s71
s_add_u32 s70, s70, 65536
s_mov_b64 exec, 0xffffffff
buffer_store_dwordx4 v[24:27], v16, s[12:15], s70 offen sc1
s_mov_b64 exec, -1
L_nocsp:
v_mfma_f32_16x16x32_bf16 v[72:75], a[4:7], a[48:51], v[72:75]
v_mfma_f32_16x16x32_bf16 v[96:99], a[8:11], a[48:51], v[96:99]
v_mfma_f32_16x16x32_bf16 v[120:123], a[12:15], a[48:51], v[120:123]
v_mfma_f32_16x16x32_bf16 v[52:55], a[0:3], a[52:55], v[52:55]
v_mfma_f32_16x16x32_bf16 v[76:79], a[4:7], a[52:55], v[76:79]
v_mfma_f32_16x16x32_bf16 v[100:103], a[8:11], a[52:55], v[100:103]
v_mfma_f32_16x16x32_bf16 v[124:127], a[12:15], a[52:55], v[124:127]
s_waitcnt lgkmcnt(0)
v_mfma_f32_16x16x32_bf16 v[32:35], a[56:59], a[16:19], v[32:35]
s_barrier
ds_read_b128 a[0:3], v8 offset:40960
v_mfma_f32_16x16x32_bf16 v[56:59], a[56:59], a[20:23], v[56:59]
ds_read_b64_tr_b16 a[32:33], v12 offset:40960
v_mfma_f32_16x16x32_bf16 v[80:83], a[56:59], a[24:27], v[80:83]
ds_read_b64_tr_b16 a[34:35], v12 offset:41472
v_mfma_f32_16x16x32_bf16 v[104:107], a[56:59], a[28:31], v[104:107]
ds_read_b128 a[4:7], v8 offset:43008
v_mfma_f32_16x16x32_bf16 v[36:39], a[60:63], a[16:19], v[36:39]
ds_read_b128 a[8:11], v8 offset:45056
v_mfma_f32_16x16x32_bf16 v[60:63], a[60:63], a[20:23], v[60:63]
ds_read_b128 a[12:15], v8 offset:47104
v_mfma_f32_16x16x32_bf16 v[84:87], a[60:63], a[24:27], v[84:87]
ds_read_b64_tr_b16 a[36:37], v13 offset:40960
v_mfma_f32_16x16x32_bf16 v[108:111], a[60:63], a[28:31], v[108:111]
ds_read_b64_tr_b16 a[38:39], v13 offset:41472
v_mfma_f32_16x16x32_bf16 v[40:43], a[16:19], a[64:67], v[40:43]
ds_read_b64_tr_b16 a[40:41], v12 offset:43008
v_mfma_f32_16x16x32_bf16 v[64:67], a[20:23], a[64:67], v[64:67]
ds_read_b64_tr_b16 a[42:43], v12 offset:43520
v_mfma_f32_16x16x32_bf16 v[88:91], a[24:27], a[64:67], v[88:91]
ds_read_b64_tr_b16 a[44:45], v13 offset:43008
v_mfma_f32_16x16x32_bf16 v[112:115], a[28:31], a[64:67], v[112:115]
ds_read_b64_tr_b16 a[46:47], v13 offset:43520
v_mfma_f32_16x16x32_bf16 v[44:47], a[16:19], a[68:71], v[44:47]
ds_read_b64_tr_b16 a[48:49], v12 offset:45056
v_mfma_f32_16x16x32_bf16 v[68:71], a[20:23], a[68:71], v[68:71]
ds_read_b64_tr_b16 a[50:51], v12 offset:45568
v_mfma_f32_16x16x32_bf16 v[92:95], a[24:27], a[68:71], v[92:95]
ds_read_b64_tr_b16 a[52:53], v13 offset:45056
v_mfma_f32_16x16x32_bf16 v[116:119], a[28:31], a[68:71], v[116:119]
ds_read_b64_tr_b16 a[54:55], v13 offset:45568
v_mfma_f32_16x16x32_bf16 v[48:51], a[16:19], a[72:75], v[48:51]
v_mfma_f32_16x16x32_bf16 v[72:75], a[20:23], a[72:75], v[72:75]
v_mfma_f32_16x16x32_bf16 v[96:99], a[24:27], a[72:75], v[96:99]
v_mfma_f32_16x16x32_bf16 v[120:123], a[28:31], a[72:75], v[120:123]
v_mfma_f32_16x16x32_bf16 v[52:55], a[16:19], a[76:79], v[52:55]
v_mfma_f32_16x16x32_bf16 v[76:79], a[20:23], a[76:79], v[76:79]
v_mfma_f32_16x16x32_bf16 v[100:103], a[24:27], a[76:79], v[100:103]
v_mfma_f32_16x16x32_bf16 v[124:127], a[28:31], a[76:79], v[124:127]
s_waitcnt lgkmcnt(0)
v_mfma_f32_16x16x32_bf16 v[32:35], a[32:35], a[0:3], v[32:35]
ds_read_b128 a[16:19], v9 offset:40960
v_mfma_f32_16x16x32_bf16 v[56:59], a[32:35], a[4:7], v[56:59]
ds_read_b64_tr_b16 a[56:57], v12 offset:53248
v_mfma_f32_16x16x32_bf16 v[80:83], a[32:35], a[8:11], v[80:83]
ds_read_b64_tr_b16 a[58:59], v12 offset:53760
v_mfma_f32_16x16x32_bf16 v[104:107], a[32:35], a[12:15], v[104:107]
ds_read_b128 a[20:23], v9 offset:43008
v_mfma_f32_16x16x32_bf16 v[36:39], a[36:39], a[0:3], v[36:39]
ds_read_b128 a[24:27], v9 offset:45056
v_mfma_f32_16x16x32_bf16 v[60:63], a[36:39], a[4:7], v[60:63]
ds_read_b128 a[28:31], v9 offset:47104
v_mfma_f32_16x16x32_bf16 v[84:87], a[36:39], a[8:11], v[84:87]
ds_read_b64_tr_b16 a[60:61], v13 offset:53248
v_mfma_f32_16x16x32_bf16 v[108:111], a[36:39], a[12:15], v[108:111]
ds_read_b64_tr_b16 a[62:63], v13 offset:53760
v_mfma_f32_16x16x32_bf16 v[40:43], a[0:3], a[40:43], v[40:43]
ds_read_b64_tr_b16 a[64:65], v12 offset:55296
v_mfma_f32_16x16x32_bf16 v[64:67], a[4:7], a[40:43], v[64:67]
ds_read_b64_tr_b16 a[66:67], v12 offset:55808
v_mfma_f32_16x16x32_bf16 v[88:91], a[8:11], a[40:43], v[88:91]
ds_read_b64_tr_b16 a[68:69], v13 offset:55296
v_mfma_f32_16x16x32_bf16 v[112:115], a[12:15], a[40:43], v[112:115]
ds_read_b64_tr_b16 a[70:71], v13 offset:55808
v_mfma_f32_16x16x32_bf16 v[44:47], a[0:3], a[44:47], v[44:47]
ds_read_b64_tr_b16 a[72:73], v12 offset:57344
v_mfma_f32_16x16x32_bf16 v[68:71], a[4:7], a[44:47], v[68:71]
ds_read_b64_tr_b16 a[74:75], v12 offset:57856
v_mfma_f32_16x16x32_bf16 v[92:95], a[8:11], a[44:47], v[92:95]
ds_read_b64_tr_b16 a[76:77], v13 offset:57344
v_mfma_f32_16x16x32_bf16 v[116:119], a[12:15], a[44:47], v[116:119]
ds_read_b64_tr_b16 a[78:79], v13 offset:57856
v_mfma_f32_16x16x32_bf16 v[48:51], a[0:3], a[48:51], v[48:51]
v_mfma_f32_16x16x32_bf16 v[72:75], a[4:7], a[48:51], v[72:75]
v_mfma_f32_16x16x32_bf16 v[96:99], a[8:11], a[48:51], v[96:99]
v_mfma_f32_16x16x32_bf16 v[120:123], a[12:15], a[48:51], v[120:123]
v_mfma_f32_16x16x32_bf16 v[52:55], a[0:3], a[52:55], v[52:55]
v_mfma_f32_16x16x32_bf16 v[76:79], a[4:7], a[52:55], v[76:79]
v_mfma_f32_16x16x32_bf16 v[100:103], a[8:11], a[52:55], v[100:103]
v_mfma_f32_16x16x32_bf16 v[124:127], a[12:15], a[52:55], v[124:127]
s_waitcnt lgkmcnt(0)
v_mfma_f32_16x16x32_bf16 v[32:35], a[56:59], a[16:19], v[32:35]
s_waitcnt vmcnt(0)
s_barrier
ds_read_b128 a[0:3], v10 offset:0
v_mfma_f32_16x16x32_bf16 v[56:59], a[56:59], a[20:23], v[56:59]
ds_read_b64_tr_b16 a[32:33], v14 offset:0
v_mfma_f32_16x16x32_bf16 v[80:83], a[56:59], a[24:27], v[80:83]
ds_read_b64_tr_b16 a[34:35], v14 offset:512
v_mfma_f32_16x16x32_bf16 v[104:107], a[56:59], a[28:31], v[104:107]
ds_read_b128 a[4:7], v10 offset:2048
v_mfma_f32_16x16x32_bf16 v[36:39], a[60:63], a[16:19], v[36:39]
ds_read_b128 a[8:11], v10 offset:4096
v_mfma_f32_16x16x32_bf16 v[60:63], a[60:63], a[20:23], v[60:63]
ds_read_b128 a[12:15], v10 offset:6144
v_mfma_f32_16x16x32_bf16 v[84:87], a[60:63], a[24:27], v[84:87]
ds_read_b64_tr_b16 a[36:37], v15 offset:0
v_mfma_f32_16x16x32_bf16 v[108:111], a[60:63], a[28:31], v[108:111]
ds_read_b64_tr_b16 a[38:39], v15 offset:512
v_mfma_f32_16x16x32_bf16 v[40:43], a[16:19], a[64:67], v[40:43]
ds_read_b64_tr_b16 a[40:41], v14 offset:2048
v_mfma_f32_16x16x32_bf16 v[64:67], a[20:23], a[64:67], v[64:67]
ds_read_b64_tr_b16 a[42:43], v14 offset:2560
v_mfma_f32_16x16x32_bf16 v[88:91], a[24:27], a[64:67], v[88:91]
ds_read_b64_tr_b16 a[44:45], v15 offset:2048
v_mfma_f32_16x16x32_bf16 v[112:115], a[28:31], a[64:67], v[112:115]
ds_read_b64_tr_b16 a[46:47], v15 offset:2560
v_mfma_f32_16x16x32_bf16 v[44:47], a[16:19], a[68:71], v[44:47]
ds_read_b64_tr_b16 a[48:49], v14 offset:4096
v_mfma_f32_16x16x32_bf16 v[68:71], a[20:23], a[68:71], v[68:71]
ds_read_b64_tr_b16 a[50:51], v14 offset:4608
v_mfma_f32_16x16x32_bf16 v[92:95], a[24:27], a[68:71], v[92:95]
ds_read_b64_tr_b16 a[52:53], v15 offset:4096
v_mfma_f32_16x16x32_bf16 v[116:119], a[28:31], a[68:71], v[116:119]
ds_read_b64_tr_b16 a[54:55], v15 offset:4608
v_mfma_f32_16x16x32_bf16 v[48:51], a[16:19], a[72:75], v[48:51]
v_mfma_f32_16x16x32_bf16 v[72:75], a[20:23], a[72:75], v[72:75]
v_mfma_f32_16x16x32_bf16 v[96:99], a[24:27], a[72:75], v[96:99]
v_mfma_f32_16x16x32_bf16 v[120:123], a[28:31], a[72:75], v[120:123]
v_mfma_f32_16x16x32_bf16 v[52:55], a[16:19], a[76:79], v[52:55]
v_mfma_f32_16x16x32_bf16 v[76:79], a[20:23], a[76:79], v[76:79]
v_mfma_f32_16x16x32_bf16 v[100:103], a[24:27], a[76:79], v[100:103]
v_mfma_f32_16x16x32_bf16 v[124:127], a[28:31], a[76:79], v[124:127]
s_waitcnt lgkmcnt(0)
v_mfma_f32_16x16x32_bf16 v[32:35], a[32:35], a[0:3], v[32:35]
ds_read_b128 a[16:19], v11 offset:0
v_mfma_f32_16x16x32_bf16 v[56:59], a[32:35], a[4:7], v[56:59]
ds_read_b64_tr_b16 a[56:57], v14 offset:12288
v_mfma_f32_16x16x32_bf16 v[80:83], a[32:35], a[8:11], v[80:83]
ds_read_b64_tr_b16 a[58:59], v14 offset:12800
v_mfma_f32_16x16x32_bf16 v[104:107], a[32:35], a[12:15], v[104:107]
ds_read_b128 a[20:23], v11 offset:2048
v_mfma_f32_16x16x32_bf16 v[36:39], a[36:39], a[0:3], v[36:39]
ds_read_b128 a[24:27], v11 offset:4096
v_mfma_f32_16x16x32_bf16 v[60:63], a[36:39], a[4:7], v[60:63]
ds_read_b128 a[28:31], v11 offset:6144
v_mfma_f32_16x16x32_bf16 v[84:87], a[36:39], a[8:11], v[84:87]
ds_read_b64_tr_b16 a[60:61], v15 offset:12288
v_mfma_f32_16x16x32_bf16 v[108:111], a[36:39], a[12:15], v[108:111]
ds_read_b64_tr_b16 a[62:63], v15 offset:12800
v_mfma_f32_16x16x32_bf16 v[40:43], a[0:3], a[40:43], v[40:43]
ds_read_b64_tr_b16 a[64:65], v14 offset:14336
v_mfma_f32_16x16x32_bf16 v[64:67], a[4:7], a[40:43], v[64:67]
ds_read_b64_tr_b16 a[66:67], v14 offset:14848
v_mfma_f32_16x16x32_bf16 v[88:91], a[8:11], a[40:43], v[88:91]
ds_read_b64_tr_b16 a[68:69], v15 offset:14336
v_mfma_f32_16x16x32_bf16 v[112:115], a[12:15], a[40:43], v[112:115]
ds_read_b64_tr_b16 a[70:71], v15 offset:14848
v_mfma_f32_16x16x32_bf16 v[44:47], a[0:3], a[44:47], v[44:47]
ds_read_b64_tr_b16 a[72:73], v14 offset:16384
v_mfma_f32_16x16x32_bf16 v[68:71], a[4:7], a[44:47], v[68:71]
ds_read_b64_tr_b16 a[74:75], v14 offset:16896
v_mfma_f32_16x16x32_bf16 v[92:95], a[8:11], a[44:47], v[92:95]
ds_read_b64_tr_b16 a[76:77], v15 offset:16384
v_mfma_f32_16x16x32_bf16 v[116:119], a[12:15], a[44:47], v[116:119]
ds_read_b64_tr_b16 a[78:79], v15 offset:16896
v_mfma_f32_16x16x32_bf16 v[48:51], a[0:3], a[48:51], v[48:51]
v_mfma_f32_16x16x32_bf16 v[72:75], a[4:7], a[48:51], v[72:75]
v_mfma_f32_16x16x32_bf16 v[96:99], a[8:11], a[48:51], v[96:99]
v_mfma_f32_16x16x32_bf16 v[120:123], a[12:15], a[48:51], v[120:123]
v_mfma_f32_16x16x32_bf16 v[52:55], a[0:3], a[52:55], v[52:55]
v_mfma_f32_16x16x32_bf16 v[76:79], a[4:7], a[52:55], v[76:79]
v_mfma_f32_16x16x32_bf16 v[100:103], a[8:11], a[52:55], v[100:103]
v_mfma_f32_16x16x32_bf16 v[124:127], a[12:15], a[52:55], v[124:127]
s_waitcnt lgkmcnt(0)
v_mfma_f32_16x16x32_bf16 v[32:35], a[56:59], a[16:19], v[32:35]
s_barrier
ds_read_b128 a[0:3], v8 offset:0
v_mfma_f32_16x16x32_bf16 v[56:59], a[56:59], a[20:23], v[56:59]
ds_read_b64_tr_b16 a[32:33], v12 offset:0
v_mfma_f32_16x16x32_bf16 v[80:83], a[56:59], a[24:27], v[80:83]
ds_read_b64_tr_b16 a[34:35], v12 offset:512
v_mfma_f32_16x16x32_bf16 v[104:107], a[56:59], a[28:31], v[104:107]
ds_read_b128 a[4:7], v8 offset:2048
v_mfma_f32_16x16x32_bf16 v[36:39], a[60:63], a[16:19], v[36:39]
ds_read_b128 a[8:11], v8 offset:4096
v_mfma_f32_16x16x32_bf16 v[60:63], a[60:63], a[20:23], v[60:63]
ds_read_b128 a[12:15], v8 offset:6144
v_mfma_f32_16x16x32_bf16 v[84:87], a[60:63], a[24:27], v[84:87]
ds_read_b64_tr_b16 a[36:37], v13 offset:0
v_mfma_f32_16x16x32_bf16 v[108:111], a[60:63], a[28:31], v[108:111]
ds_read_b64_tr_b16 a[38:39], v13 offset:512
v_mfma_f32_16x16x32_bf16 v[40:43], a[16:19], a[64:67], v[40:43]
ds_read_b64_tr_b16 a[40:41], v12 offset:2048
v_mfma_f32_16x16x32_bf16 v[64:67], a[20:23], a[64:67], v[64:67]
ds_read_b64_tr_b16 a[42:43], v12 offset:2560
v_mfma_f32_16x16x32_bf16 v[88:91], a[24:27], a[64:67], v[88:91]
ds_read_b64_tr_b16 a[44:45], v13 offset:2048
v_mfma_f32_16x16x32_bf16 v[112:115], a[28:31], a[64:67], v[112:115]
ds_read_b64_tr_b16 a[46:47], v13 offset:2560
v_mfma_f32_16x16x32_bf16 v[44:47], a[16:19], a[68:71], v[44:47]
ds_read_b64_tr_b16 a[48:49], v12 offset:4096
v_mfma_f32_16x16x32_bf16 v[68:71], a[20:23], a[68:71], v[68:71]
ds_read_b64_tr_b16 a[50:51], v12 offset:4608
v_mfma_f32_16x16x32_bf16 v[92:95], a[24:27], a[68:71], v[92:95]
ds_read_b64_tr_b16 a[52:53], v13 offset:4096
v_mfma_f32_16x16x32_bf16 v[116:119], a[28:31], a[68:71], v[116:119]
ds_read_b64_tr_b16 a[54:55], v13 offset:4608
v_mfma_f32_16x16x32_bf16 v[48:51], a[16:19], a[72:75], v[48:51]
v_mfma_f32_16x16x32_bf16 v[72:75], a[20:23], a[72:75], v[72:75]
v_mfma_f32_16x16x32_bf16 v[96:99], a[24:27], a[72:75], v[96:99]
v_mfma_f32_16x16x32_bf16 v[120:123], a[28:31], a[72:75], v[120:123]
v_mfma_f32_16x16x32_bf16 v[52:55], a[16:19], a[76:79], v[52:55]
v_mfma_f32_16x16x32_bf16 v[76:79], a[20:23], a[76:79], v[76:79]
v_mfma_f32_16x16x32_bf16 v[100:103], a[24:27], a[76:79], v[100:103]
v_mfma_f32_16x16x32_bf16 v[124:127], a[28:31], a[76:79], v[124:127]
s_waitcnt lgkmcnt(0)
v_mfma_f32_16x16x32_bf16 v[32:35], a[32:35], a[0:3], v[32:35]
ds_read_b128 a[16:19], v9 offset:0
v_mfma_f32_16x16x32_bf16 v[56:59], a[32:35], a[4:7], v[56:59]
ds_read_b64_tr_b16 a[56:57], v12 offset:12288
v_mfma_f32_16x16x32_bf16 v[80:83], a[32:35], a[8:11], v[80:83]
ds_read_b64_tr_b16 a[58:59], v12 offset:12800
v_mfma_f32_16x16x32_bf16 v[104:107], a[32:35], a[12:15], v[104:107]
ds_read_b128 a[20:23], v9 offset:2048
v_mfma_f32_16x16x32_bf16 v[36:39], a[36:39], a[0:3], v[36:39]
ds_read_b128 a[24:27], v9 offset:4096
v_mfma_f32_16x16x32_bf16 v[60:63], a[36:39], a[4:7], v[60:63]
ds_read_b128 a[28:31], v9 offset:6144
v_mfma_f32_16x16x32_bf16 v[84:87], a[36:39], a[8:11], v[84:87]
ds_read_b64_tr_b16 a[60:61], v13 offset:12288
v_mfma_f32_16x16x32_bf16 v[108:111], a[36:39], a[12:15], v[108:111]
ds_read_b64_tr_b16 a[62:63], v13 offset:12800
v_mfma_f32_16x16x32_bf16 v[40:43], a[0:3], a[40:43], v[40:43]
ds_read_b64_tr_b16 a[64:65], v12 offset:14336
v_mfma_f32_16x16x32_bf16 v[64:67], a[4:7], a[40:43], v[64:67]
ds_read_b64_tr_b16 a[66:67], v12 offset:14848
v_mfma_f32_16x16x32_bf16 v[88:91], a[8:11], a[40:43], v[88:91]
ds_read_b64_tr_b16 a[68:69], v13 offset:14336
v_mfma_f32_16x16x32_bf16 v[112:115], a[12:15], a[40:43], v[112:115]
ds_read_b64_tr_b16 a[70:71], v13 offset:14848
v_mfma_f32_16x16x32_bf16 v[44:47], a[0:3], a[44:47], v[44:47]
ds_read_b64_tr_b16 a[72:73], v12 offset:16384
v_mfma_f32_16x16x32_bf16 v[68:71], a[4:7], a[44:47], v[68:71]
ds_read_b64_tr_b16 a[74:75], v12 offset:16896
v_mfma_f32_16x16x32_bf16 v[92:95], a[8:11], a[44:47], v[92:95]
ds_read_b64_tr_b16 a[76:77], v13 offset:16384
v_mfma_f32_16x16x32_bf16 v[116:119], a[12:15], a[44:47], v[116:119]
ds_read_b64_tr_b16 a[78:79], v13 offset:16896
v_mfma_f32_16x16x32_bf16 v[48:51], a[0:3], a[48:51], v[48:51]
v_mfma_f32_16x16x32_bf16 v[72:75], a[4:7], a[48:51], v[72:75]
v_mfma_f32_16x16x32_bf16 v[96:99], a[8:11], a[48:51], v[96:99]
v_mfma_f32_16x16x32_bf16 v[120:123], a[12:15], a[48:51], v[120:123]
v_mfma_f32_16x16x32_bf16 v[52:55], a[0:3], a[52:55], v[52:55]
v_mfma_f32_16x16x32_bf16 v[76:79], a[4:7], a[52:55], v[76:79]
v_mfma_f32_16x16x32_bf16 v[100:103], a[8:11], a[52:55], v[100:103]
v_mfma_f32_16x16x32_bf16 v[124:127], a[12:15], a[52:55], v[124:127]
s_waitcnt lgkmcnt(0)
v_mfma_f32_16x16x32_bf16 v[32:35], a[56:59], a[16:19], v[32:35]
s_barrier
ds_read_b128 a[0:3], v8 offset:40960
v_mfma_f32_16x16x32_bf16 v[56:59], a[56:59], a[20:23], v[56:59]
ds_read_b64_tr_b16 a[32:33], v12 offset:40960
v_mfma_f32_16x16x32_bf16 v[80:83], a[56:59], a[24:27], v[80:83]
ds_read_b64_tr_b16 a[34:35], v12 offset:41472
v_mfma_f32_16x16x32_bf16 v[104:107], a[56:59], a[28:31], v[104:107]
ds_read_b128 a[4:7], v8 offset:43008
v_mfma_f32_16x16x32_bf16 v[36:39], a[60:63], a[16:19], v[36:39]
ds_read_b128 a[8:11], v8 offset:45056
v_mfma_f32_16x16x32_bf16 v[60:63], a[60:63], a[20:23], v[60:63]
ds_read_b128 a[12:15], v8 offset:47104
v_mfma_f32_16x16x32_bf16 v[84:87], a[60:63], a[24:27], v[84:87]
ds_read_b64_tr_b16 a[36:37], v13 offset:40960
v_mfma_f32_16x16x32_bf16 v[108:111], a[60:63], a[28:31], v[108:111]
ds_read_b64_tr_b16 a[38:39], v13 offset:41472
v_mfma_f32_16x16x32_bf16 v[40:43], a[16:19], a[64:67], v[40:43]
ds_read_b64_tr_b16 a[40:41], v12 offset:43008
v_mfma_f32_16x16x32_bf16 v[64:67], a[20:23], a[64:67], v[64:67]
ds_read_b64_tr_b16 a[42:43], v12 offset:43520
v_mfma_f32_16x16x32_bf16 v[88:91], a[24:27], a[64:67], v[88:91]
ds_read_b64_tr_b16 a[44:45], v13 offset:43008
v_mfma_f32_16x16x32_bf16 v[112:115], a[28:31], a[64:67], v[112:115]
ds_read_b64_tr_b16 a[46:47], v13 offset:43520
v_mfma_f32_16x16x32_bf16 v[44:47], a[16:19], a[68:71], v[44:47]
ds_read_b64_tr_b16 a[48:49], v12 offset:45056
v_mfma_f32_16x16x32_bf16 v[68:71], a[20:23], a[68:71], v[68:71]
ds_read_b64_tr_b16 a[50:51], v12 offset:45568
v_mfma_f32_16x16x32_bf16 v[92:95], a[24:27], a[68:71], v[92:95]
ds_read_b64_tr_b16 a[52:53], v13 offset:45056
v_mfma_f32_16x16x32_bf16 v[116:119], a[28:31], a[68:71], v[116:119]
ds_read_b64_tr_b16 a[54:55], v13 offset:45568
v_mfma_f32_16x16x32_bf16 v[48:51], a[16:19], a[72:75], v[48:51]
v_mfma_f32_16x16x32_bf16 v[72:75], a[20:23], a[72:75], v[72:75]
v_mfma_f32_16x16x32_bf16 v[96:99], a[24:27], a[72:75], v[96:99]
v_mfma_f32_16x16x32_bf16 v[120:123], a[28:31], a[72:75], v[120:123]
v_mfma_f32_16x16x32_bf16 v[52:55], a[16:19], a[76:79], v[52:55]
v_mfma_f32_16x16x32_bf16 v[76:79], a[20:23], a[76:79], v[76:79]
v_mfma_f32_16x16x32_bf16 v[100:103], a[24:27], a[76:79], v[100:103]
v_mfma_f32_16x16x32_bf16 v[124:127], a[28:31], a[76:79], v[124:127]
s_waitcnt lgkmcnt(0)
v_mfma_f32_16x16x32_bf16 v[32:35], a[32:35], a[0:3], v[32:35]
ds_read_b128 a[16:19], v9 offset:40960
v_mfma_f32_16x16x32_bf16 v[56:59], a[32:35], a[4:7], v[56:59]
ds_read_b64_tr_b16 a[56:57], v12 offset:53248
v_mfma_f32_16x16x32_bf16 v[80:83], a[32:35], a[8:11], v[80:83]
ds_read_b64_tr_b16 a[58:59], v12 offset:53760
v_mfma_f32_16x16x32_bf16 v[104:107], a[32:35], a[12:15], v[104:107]
ds_read_b128 a[20:23], v9 offset:43008
v_mfma_f32_16x16x32_bf16 v[36:39], a[36:39], a[0:3], v[36:39]
ds_read_b128 a[24:27], v9 offset:45056
v_mfma_f32_16x16x32_bf16 v[60:63], a[36:39], a[4:7], v[60:63]
ds_read_b128 a[28:31], v9 offset:47104
v_mfma_f32_16x16x32_bf16 v[84:87], a[36:39], a[8:11], v[84:87]
ds_read_b64_tr_b16 a[60:61], v13 offset:53248
v_mfma_f32_16x16x32_bf16 v[108:111], a[36:39], a[12:15], v[108:111]
ds_read_b64_tr_b16 a[62:63], v13 offset:53760
v_mfma_f32_16x16x32_bf16 v[40:43], a[0:3], a[40:43], v[40:43]
ds_read_b64_tr_b16 a[64:65], v12 offset:55296
v_mfma_f32_16x16x32_bf16 v[64:67], a[4:7], a[40:43], v[64:67]
ds_read_b64_tr_b16 a[66:67], v12 offset:55808
v_mfma_f32_16x16x32_bf16 v[88:91], a[8:11], a[40:43], v[88:91]
ds_read_b64_tr_b16 a[68:69], v13 offset:55296
v_mfma_f32_16x16x32_bf16 v[112:115], a[12:15], a[40:43], v[112:115]
ds_read_b64_tr_b16 a[70:71], v13 offset:55808
v_mfma_f32_16x16x32_bf16 v[44:47], a[0:3], a[44:47], v[44:47]
ds_read_b64_tr_b16 a[72:73], v12 offset:57344
v_mfma_f32_16x16x32_bf16 v[68:71], a[4:7], a[44:47], v[68:71]
ds_read_b64_tr_b16 a[74:75], v12 offset:57856
v_mfma_f32_16x16x32_bf16 v[92:95], a[8:11], a[44:47], v[92:95]
ds_read_b64_tr_b16 a[76:77], v13 offset:57344
v_mfma_f32_16x16x32_bf16 v[116:119], a[12:15], a[44:47], v[116:119]
ds_read_b64_tr_b16 a[78:79], v13 offset:57856
v_mfma_f32_16x16x32_bf16 v[48:51], a[0:3], a[48:51], v[48:51]
v_mfma_f32_16x16x32_bf16 v[72:75], a[4:7], a[48:51], v[72:75]
v_mfma_f32_16x16x32_bf16 v[96:99], a[8:11], a[48:51], v[96:99]
v_mfma_f32_16x16x32_bf16 v[120:123], a[12:15], a[48:51], v[120:123]
v_mfma_f32_16x16x32_bf16 v[52:55], a[0:3], a[52:55], v[52:55]
v_mfma_f32_16x16x32_bf16 v[76:79], a[4:7], a[52:55], v[76:79]
v_mfma_f32_16x16x32_bf16 v[100:103], a[8:11], a[52:55], v[100:103]
v_mfma_f32_16x16x32_bf16 v[124:127], a[12:15], a[52:55], v[124:127]
s_waitcnt lgkmcnt(0)
v_mfma_f32_16x16x32_bf16 v[32:35], a[56:59], a[16:19], v[32:35]
s_barrier
ds_read_b128 a[0:3], v10 offset:0
v_mfma_f32_16x16x32_bf16 v[56:59], a[56:59], a[20:23], v[56:59]
ds_read_b64_tr_b16 a[32:33], v14 offset:0
v_mfma_f32_16x16x32_bf16 v[80:83], a[56:59], a[24:27], v[80:83]
ds_read_b64_tr_b16 a[34:35], v14 offset:512
v_mfma_f32_16x16x32_bf16 v[104:107], a[56:59], a[28:31], v[104:107]
ds_read_b128 a[4:7], v10 offset:2048
v_mfma_f32_16x16x32_bf16 v[36:39], a[60:63], a[16:19], v[36:39]
ds_read_b128 a[8:11], v10 offset:4096
v_mfma_f32_16x16x32_bf16 v[60:63], a[60:63], a[20:23], v[60:63]
ds_read_b128 a[12:15], v10 offset:6144
v_mfma_f32_16x16x32_bf16 v[84:87], a[60:63], a[24:27], v[84:87]
ds_read_b64_tr_b16 a[36:37], v15 offset:0
v_mfma_f32_16x16x32_bf16 v[108:111], a[60:63], a[28:31], v[108:111]
ds_read_b64_tr_b16 a[38:39], v15 offset:512
v_mfma_f32_16x16x32_bf16 v[40:43], a[16:19], a[64:67], v[40:43]
ds_read_b64_tr_b16 a[40:41], v14 offset:2048
v_mfma_f32_16x16x32_bf16 v[64:67], a[20:23], a[64:67], v[64:67]
ds_read_b64_tr_b16 a[42:43], v14 offset:2560
v_mfma_f32_16x16x32_bf16 v[88:91], a[24:27], a[64:67], v[88:91]
ds_read_b64_tr_b16 a[44:45], v15 offset:2048
v_mfma_f32_16x16x32_bf16 v[112:115], a[28:31], a[64:67], v[112:115]
ds_read_b64_tr_b16 a[46:47], v15 offset:2560
v_mfma_f32_16x16x32_bf16 v[44:47], a[16:19], a[68:71], v[44:47]
ds_read_b64_tr_b16 a[48:49], v14 offset:4096
v_mfma_f32_16x16x32_bf16 v[68:71], a[20:23], a[68:71], v[68:71]
ds_read_b64_tr_b16 a[50:51], v14 offset:4608
v_mfma_f32_16x16x32_bf16 v[92:95], a[24:27], a[68:71], v[92:95]
ds_read_b64_tr_b16 a[52:53], v15 offset:4096
v_mfma_f32_16x16x32_bf16 v[116:119], a[28:31], a[68:71], v[116:119]
ds_read_b64_tr_b16 a[54:55], v15 offset:4608
v_mfma_f32_16x16x32_bf16 v[48:51], a[16:19], a[72:75], v[48:51]
v_mfma_f32_16x16x32_bf16 v[72:75], a[20:23], a[72:75], v[72:75]
v_mfma_f32_16x16x32_bf16 v[96:99], a[24:27], a[72:75], v[96:99]
v_mfma_f32_16x16x32_bf16 v[120:123], a[28:31], a[72:75], v[120:123]
v_mfma_f32_16x16x32_bf16 v[52:55], a[16:19], a[76:79], v[52:55]
v_mfma_f32_16x16x32_bf16 v[76:79], a[20:23], a[76:79], v[76:79]
v_mfma_f32_16x16x32_bf16 v[100:103], a[24:27], a[76:79], v[100:103]
v_mfma_f32_16x16x32_bf16 v[124:127], a[28:31], a[76:79], v[124:127]
s_waitcnt lgkmcnt(0)
v_mfma_f32_16x16x32_bf16 v[32:35], a[32:35], a[0:3], v[32:35]
ds_read_b128 a[16:19], v11 offset:0
v_mfma_f32_16x16x32_bf16 v[56:59], a[32:35], a[4:7], v[56:59]
ds_read_b64_tr_b16 a[56:57], v14 offset:12288
v_mfma_f32_16x16x32_bf16 v[80:83], a[32:35], a[8:11], v[80:83]
ds_read_b64_tr_b16 a[58:59], v14 offset:12800
v_mfma_f32_16x16x32_bf16 v[104:107], a[32:35], a[12:15], v[104:107]
ds_read_b128 a[20:23], v11 offset:2048
v_mfma_f32_16x16x32_bf16 v[36:39], a[36:39], a[0:3], v[36:39]
ds_read_b128 a[24:27], v11 offset:4096
v_mfma_f32_16x16x32_bf16 v[60:63], a[36:39], a[4:7], v[60:63]
ds_read_b128 a[28:31], v11 offset:6144
v_mfma_f32_16x16x32_bf16 v[84:87], a[36:39], a[8:11], v[84:87]
ds_read_b64_tr_b16 a[60:61], v15 offset:12288
v_mfma_f32_16x16x32_bf16 v[108:111], a[36:39], a[12:15], v[108:111]
ds_read_b64_tr_b16 a[62:63], v15 offset:12800
v_mfma_f32_16x16x32_bf16 v[40:43], a[0:3], a[40:43], v[40:43]
ds_read_b64_tr_b16 a[64:65], v14 offset:14336
v_mfma_f32_16x16x32_bf16 v[64:67], a[4:7], a[40:43], v[64:67]
ds_read_b64_tr_b16 a[66:67], v14 offset:14848
v_mfma_f32_16x16x32_bf16 v[88:91], a[8:11], a[40:43], v[88:91]
ds_read_b64_tr_b16 a[68:69], v15 offset:14336
v_mfma_f32_16x16x32_bf16 v[112:115], a[12:15], a[40:43], v[112:115]
ds_read_b64_tr_b16 a[70:71], v15 offset:14848
v_mfma_f32_16x16x32_bf16 v[44:47], a[0:3], a[44:47], v[44:47]
ds_read_b64_tr_b16 a[72:73], v14 offset:16384
v_mfma_f32_16x16x32_bf16 v[68:71], a[4:7], a[44:47], v[68:71]
ds_read_b64_tr_b16 a[74:75], v14 offset:16896
v_mfma_f32_16x16x32_bf16 v[92:95], a[8:11], a[44:47], v[92:95]
ds_read_b64_tr_b16 a[76:77], v15 offset:16384
v_mfma_f32_16x16x32_bf16 v[116:119], a[12:15], a[44:47], v[116:119]
ds_read_b64_tr_b16 a[78:79], v15 offset:16896
v_mfma_f32_16x16x32_bf16 v[48:51], a[0:3], a[48:51], v[48:51]
v_mfma_f32_16x16x32_bf16 v[72:75], a[4:7], a[48:51], v[72:75]
v_mfma_f32_16x16x32_bf16 v[96:99], a[8:11], a[48:51], v[96:99]
v_mfma_f32_16x16x32_bf16 v[120:123], a[12:15], a[48:51], v[120:123]
v_mfma_f32_16x16x32_bf16 v[52:55], a[0:3], a[52:55], v[52:55]
v_mfma_f32_16x16x32_bf16 v[76:79], a[4:7], a[52:55], v[76:79]
v_mfma_f32_16x16x32_bf16 v[100:103], a[8:11], a[52:55], v[100:103]
v_mfma_f32_16x16x32_bf16 v[124:127], a[12:15], a[52:55], v[124:127]
s_waitcnt lgkmcnt(0)
v_mfma_f32_16x16x32_bf16 v[32:35], a[56:59], a[16:19], v[32:35]
s_barrier
ds_read_b128 a[0:3], v8 offset:0
v_mfma_f32_16x16x32_bf16 v[56:59], a[56:59], a[20:23], v[56:59]
ds_read_b64_tr_b16 a[32:33], v12 offset:0
v_mfma_f32_16x16x32_bf16 v[80:83], a[56:59], a[24:27], v[80:83]
ds_read_b64_tr_b16 a[34:35], v12 offset:512
v_mfma_f32_16x16x32_bf16 v[104:107], a[56:59], a[28:31], v[104:107]
ds_read_b128 a[4:7], v8 offset:2048
v_mfma_f32_16x16x32_bf16 v[36:39], a[60:63], a[16:19], v[36:39]
ds_read_b128 a[8:11], v8 offset:4096
v_mfma_f32_16x16x32_bf16 v[60:63], a[60:63], a[20:23], v[60:63]
ds_read_b128 a[12:15], v8 offset:6144
v_mfma_f32_16x16x32_bf16 v[84:87], a[60:63], a[24:27], v[84:87]
ds_read_b64_tr_b16 a[36:37], v13 offset:0
v_mfma_f32_16x16x32_bf16 v[108:111], a[60:63], a[28:31], v[108:111]
ds_read_b64_tr_b16 a[38:39], v13 offset:512
v_mfma_f32_16x16x32_bf16 v[40:43], a[16:19], a[64:67], v[40:43]
ds_read_b64_tr_b16 a[40:41], v12 offset:2048
v_mfma_f32_16x16x32_bf16 v[64:67], a[20:23], a[64:67], v[64:67]
ds_read_b64_tr_b16 a[42:43], v12 offset:2560
v_mfma_f32_16x16x32_bf16 v[88:91], a[24:27], a[64:67], v[88:91]
ds_read_b64_tr_b16 a[44:45], v13 offset:2048
v_mfma_f32_16x16x32_bf16 v[112:115], a[28:31], a[64:67], v[112:115]
ds_read_b64_tr_b16 a[46:47], v13 offset:2560
v_mfma_f32_16x16x32_bf16 v[44:47], a[16:19], a[68:71], v[44:47]
ds_read_b64_tr_b16 a[48:49], v12 offset:4096
v_mfma_f32_16x16x32_bf16 v[68:71], a[20:23], a[68:71], v[68:71]
ds_read_b64_tr_b16 a[50:51], v12 offset:4608
v_mfma_f32_16x16x32_bf16 v[92:95], a[24:27], a[68:71], v[92:95]
ds_read_b64_tr_b16 a[52:53], v13 offset:4096
v_mfma_f32_16x16x32_bf16 v[116:119], a[28:31], a[68:71], v[116:119]
ds_read_b64_tr_b16 a[54:55], v13 offset:4608
v_mfma_f32_16x16x32_bf16 v[48:51], a[16:19], a[72:75], v[48:51]
v_mfma_f32_16x16x32_bf16 v[72:75], a[20:23], a[72:75], v[72:75]
v_mfma_f32_16x16x32_bf16 v[96:99], a[24:27], a[72:75], v[96:99]
v_mfma_f32_16x16x32_bf16 v[120:123], a[28:31], a[72:75], v[120:123]
v_mfma_f32_16x16x32_bf16 v[52:55], a[16:19], a[76:79], v[52:55]
v_mfma_f32_16x16x32_bf16 v[76:79], a[20:23], a[76:79], v[76:79]
v_mfma_f32_16x16x32_bf16 v[100:103], a[24:27], a[76:79], v[100:103]
v_mfma_f32_16x16x32_bf16 v[124:127], a[28:31], a[76:79], v[124:127]
s_waitcnt lgkmcnt(0)
v_mfma_f32_16x16x32_bf16 v[32:35], a[32:35], a[0:3], v[32:35]
ds_read_b128 a[16:19], v9 offset:0
v_mfma_f32_16x16x32_bf16 v[56:59], a[32:35], a[4:7], v[56:59]
ds_read_b64_tr_b16 a[56:57], v12 offset:12288
v_mfma_f32_16x16x32_bf16 v[80:83], a[32:35], a[8:11], v[80:83]
ds_read_b64_tr_b16 a[58:59], v12 offset:12800
v_mfma_f32_16x16x32_bf16 v[104:107], a[32:35], a[12:15], v[104:107]
ds_read_b128 a[20:23], v9 offset:2048
v_mfma_f32_16x16x32_bf16 v[36:39], a[36:39], a[0:3], v[36:39]
ds_read_b128 a[24:27], v9 offset:4096
v_mfma_f32_16x16x32_bf16 v[60:63], a[36:39], a[4:7], v[60:63]
ds_read_b128 a[28:31], v9 offset:6144
v_mfma_f32_16x16x32_bf16 v[84:87], a[36:39], a[8:11], v[84:87]
ds_read_b64_tr_b16 a[60:61], v13 offset:12288
v_mfma_f32_16x16x32_bf16 v[108:111], a[36:39], a[12:15], v[108:111]
ds_read_b64_tr_b16 a[62:63], v13 offset:12800
v_mfma_f32_16x16x32_bf16 v[40:43], a[0:3], a[40:43], v[40:43]
ds_read_b64_tr_b16 a[64:65], v12 offset:14336
v_mfma_f32_16x16x32_bf16 v[64:67], a[4:7], a[40:43], v[64:67]
ds_read_b64_tr_b16 a[66:67], v12 offset:14848
v_mfma_f32_16x16x32_bf16 v[88:91], a[8:11], a[40:43], v[88:91]
ds_read_b64_tr_b16 a[68:69], v13 offset:14336
v_mfma_f32_16x16x32_bf16 v[112:115], a[12:15], a[40:43], v[112:115]
ds_read_b64_tr_b16 a[70:71], v13 offset:14848
v_mfma_f32_16x16x32_bf16 v[44:47], a[0:3], a[44:47], v[44:47]
ds_read_b64_tr_b16 a[72:73], v12 offset:16384
v_mfma_f32_16x16x32_bf16 v[68:71], a[4:7], a[44:47], v[68:71]
ds_read_b64_tr_b16 a[74:75], v12 offset:16896
v_mfma_f32_16x16x32_bf16 v[92:95], a[8:11], a[44:47], v[92:95]
ds_read_b64_tr_b16 a[76:77], v13 offset:16384
v_mfma_f32_16x16x32_bf16 v[116:119], a[12:15], a[44:47], v[116:119]
ds_read_b64_tr_b16 a[78:79], v13 offset:16896
v_mfma_f32_16x16x32_bf16 v[48:51], a[0:3], a[48:51], v[48:51]
v_mfma_f32_16x16x32_bf16 v[72:75], a[4:7], a[48:51], v[72:75]
v_mfma_f32_16x16x32_bf16 v[96:99], a[8:11], a[48:51], v[96:99]
v_mfma_f32_16x16x32_bf16 v[120:123], a[12:15], a[48:51], v[120:123]
v_mfma_f32_16x16x32_bf16 v[52:55], a[0:3], a[52:55], v[52:55]
v_mfma_f32_16x16x32_bf16 v[76:79], a[4:7], a[52:55], v[76:79]
v_mfma_f32_16x16x32_bf16 v[100:103], a[8:11], a[52:55], v[100:103]
v_mfma_f32_16x16x32_bf16 v[124:127], a[12:15], a[52:55], v[124:127]
s_waitcnt lgkmcnt(0)
v_mfma_f32_16x16x32_bf16 v[32:35], a[56:59], a[16:19], v[32:35]
s_barrier
ds_read_b128 a[0:3], v8 offset:40960
v_mfma_f32_16x16x32_bf16 v[56:59], a[56:59], a[20:23], v[56:59]
ds_read_b64_tr_b16 a[32:33], v12 offset:40960
v_mfma_f32_16x16x32_bf16 v[80:83], a[56:59], a[24:27], v[80:83]
ds_read_b64_tr_b16 a[34:35], v12 offset:41472
v_mfma_f32_16x16x32_bf16 v[104:107], a[56:59], a[28:31], v[104:107]
ds_read_b128 a[4:7], v8 offset:43008
v_mfma_f32_16x16x32_bf16 v[36:39], a[60:63], a[16:19], v[36:39]
ds_read_b128 a[8:11], v8 offset:45056
v_mfma_f32_16x16x32_bf16 v[60:63], a[60:63], a[20:23], v[60:63]
ds_read_b128 a[12:15], v8 offset:47104
v_mfma_f32_16x16x32_bf16 v[84:87], a[60:63], a[24:27], v[84:87]
ds_read_b64_tr_b16 a[36:37], v13 offset:40960
v_mfma_f32_16x16x32_bf16 v[108:111], a[60:63], a[28:31], v[108:111]
ds_read_b64_tr_b16 a[38:39], v13 offset:41472
v_mfma_f32_16x16x32_bf16 v[40:43], a[16:19], a[64:67], v[40:43]
ds_read_b64_tr_b16 a[40:41], v12 offset:43008
v_mfma_f32_16x16x32_bf16 v[64:67], a[20:23], a[64:67], v[64:67]
ds_read_b64_tr_b16 a[42:43], v12 offset:43520
v_mfma_f32_16x16x32_bf16 v[88:91], a[24:27], a[64:67], v[88:91]
ds_read_b64_tr_b16 a[44:45], v13 offset:43008
v_mfma_f32_16x16x32_bf16 v[112:115], a[28:31], a[64:67], v[112:115]
ds_read_b64_tr_b16 a[46:47], v13 offset:43520
v_mfma_f32_16x16x32_bf16 v[44:47], a[16:19], a[68:71], v[44:47]
ds_read_b64_tr_b16 a[48:49], v12 offset:45056
v_mfma_f32_16x16x32_bf16 v[68:71], a[20:23], a[68:71], v[68:71]
ds_read_b64_tr_b16 a[50:51], v12 offset:45568
v_mfma_f32_16x16x32_bf16 v[92:95], a[24:27], a[68:71], v[92:95]
ds_read_b64_tr_b16 a[52:53], v13 offset:45056
v_mfma_f32_16x16x32_bf16 v[116:119], a[28:31], a[68:71], v[116:119]
ds_read_b64_tr_b16 a[54:55], v13 offset:45568
v_mfma_f32_16x16x32_bf16 v[48:51], a[16:19], a[72:75], v[48:51]
v_mfma_f32_16x16x32_bf16 v[72:75], a[20:23], a[72:75], v[72:75]
v_mfma_f32_16x16x32_bf16 v[96:99], a[24:27], a[72:75], v[96:99]
v_mfma_f32_16x16x32_bf16 v[120:123], a[28:31], a[72:75], v[120:123]
v_mfma_f32_16x16x32_bf16 v[52:55], a[16:19], a[76:79], v[52:55]
v_mfma_f32_16x16x32_bf16 v[76:79], a[20:23], a[76:79], v[76:79]
v_mfma_f32_16x16x32_bf16 v[100:103], a[24:27], a[76:79], v[100:103]
v_mfma_f32_16x16x32_bf16 v[124:127], a[28:31], a[76:79], v[124:127]
s_waitcnt lgkmcnt(0)
v_mfma_f32_16x16x32_bf16 v[32:35], a[32:35], a[0:3], v[32:35]
ds_read_b128 a[16:19], v9 offset:40960
v_mfma_f32_16x16x32_bf16 v[56:59], a[32:35], a[4:7], v[56:59]
ds_read_b64_tr_b16 a[56:57], v12 offset:53248
v_mfma_f32_16x16x32_bf16 v[80:83], a[32:35], a[8:11], v[80:83]
ds_read_b64_tr_b16 a[58:59], v12 offset:53760
v_mfma_f32_16x16x32_bf16 v[104:107], a[32:35], a[12:15], v[104:107]
ds_read_b128 a[20:23], v9 offset:43008
v_mfma_f32_16x16x32_bf16 v[36:39], a[36:39], a[0:3], v[36:39]
ds_read_b128 a[24:27], v9 offset:45056
v_mfma_f32_16x16x32_bf16 v[60:63], a[36:39], a[4:7], v[60:63]
ds_read_b128 a[28:31], v9 offset:47104
v_mfma_f32_16x16x32_bf16 v[84:87], a[36:39], a[8:11], v[84:87]
ds_read_b64_tr_b16 a[60:61], v13 offset:53248
v_mfma_f32_16x16x32_bf16 v[108:111], a[36:39], a[12:15], v[108:111]
ds_read_b64_tr_b16 a[62:63], v13 offset:53760
v_mfma_f32_16x16x32_bf16 v[40:43], a[0:3], a[40:43], v[40:43]
ds_read_b64_tr_b16 a[64:65], v12 offset:55296
v_mfma_f32_16x16x32_bf16 v[64:67], a[4:7], a[40:43], v[64:67]
ds_read_b64_tr_b16 a[66:67], v12 offset:55808
v_mfma_f32_16x16x32_bf16 v[88:91], a[8:11], a[40:43], v[88:91]
ds_read_b64_tr_b16 a[68:69], v13 offset:55296
v_mfma_f32_16x16x32_bf16 v[112:115], a[12:15], a[40:43], v[112:115]
ds_read_b64_tr_b16 a[70:71], v13 offset:55808
v_mfma_f32_16x16x32_bf16 v[44:47], a[0:3], a[44:47], v[44:47]
ds_read_b64_tr_b16 a[72:73], v12 offset:57344
v_mfma_f32_16x16x32_bf16 v[68:71], a[4:7], a[44:47], v[68:71]
ds_read_b64_tr_b16 a[74:75], v12 offset:57856
v_mfma_f32_16x16x32_bf16 v[92:95], a[8:11], a[44:47], v[92:95]
ds_read_b64_tr_b16 a[76:77], v13 offset:57344
v_mfma_f32_16x16x32_bf16 v[116:119], a[12:15], a[44:47], v[116:119]
ds_read_b64_tr_b16 a[78:79], v13 offset:57856
v_mfma_f32_16x16x32_bf16 v[48:51], a[0:3], a[48:51], v[48:51]
v_mfma_f32_16x16x32_bf16 v[72:75], a[4:7], a[48:51], v[72:75]
v_mfma_f32_16x16x32_bf16 v[96:99], a[8:11], a[48:51], v[96:99]
v_mfma_f32_16x16x32_bf16 v[120:123], a[12:15], a[48:51], v[120:123]
v_mfma_f32_16x16x32_bf16 v[52:55], a[0:3], a[52:55], v[52:55]
v_mfma_f32_16x16x32_bf16 v[76:79], a[4:7], a[52:55], v[76:79]
v_mfma_f32_16x16x32_bf16 v[100:103], a[8:11], a[52:55], v[100:103]
v_mfma_f32_16x16x32_bf16 v[124:127], a[12:15], a[52:55], v[124:127]
s_waitcnt lgkmcnt(0)
v_mfma_f32_16x16x32_bf16 v[32:35], a[56:59], a[16:19], v[32:35]
s_barrier
ds_read_b128 a[0:3], v10 offset:0
v_mfma_f32_16x16x32_bf16 v[56:59], a[56:59], a[20:23], v[56:59]
ds_read_b64_tr_b16 a[32:33], v14 offset:0
v_mfma_f32_16x16x32_bf16 v[80:83], a[56:59], a[24:27], v[80:83]
ds_read_b64_tr_b16 a[34:35], v14 offset:512
v_mfma_f32_16x16x32_bf16 v[104:107], a[56:59], a[28:31], v[104:107]
ds_read_b128 a[4:7], v10 offset:2048
v_mfma_f32_16x16x32_bf16 v[36:39], a[60:63], a[16:19], v[36:39]
ds_read_b128 a[8:11], v10 offset:4096
v_mfma_f32_16x16x32_bf16 v[60:63], a[60:63], a[20:23], v[60:63]
ds_read_b128 a[12:15], v10 offset:6144
v_mfma_f32_16x16x32_bf16 v[84:87], a[60:63], a[24:27], v[84:87]
ds_read_b64_tr_b16 a[36:37], v15 offset:0
v_mfma_f32_16x16x32_bf16 v[108:111], a[60:63], a[28:31], v[108:111]
ds_read_b64_tr_b16 a[38:39], v15 offset:512
v_mfma_f32_16x16x32_bf16 v[40:43], a[16:19], a[64:67], v[40:43]
ds_read_b64_tr_b16 a[40:41], v14 offset:2048
v_mfma_f32_16x16x32_bf16 v[64:67], a[20:23], a[64:67], v[64:67]
ds_read_b64_tr_b16 a[42:43], v14 offset:2560
v_mfma_f32_16x16x32_bf16 v[88:91], a[24:27], a[64:67], v[88:91]
ds_read_b64_tr_b16 a[44:45], v15 offset:2048
v_mfma_f32_16x16x32_bf16 v[112:115], a[28:31], a[64:67], v[112:115]
ds_read_b64_tr_b16 a[46:47], v15 offset:2560
v_mfma_f32_16x16x32_bf16 v[44:47], a[16:19], a[68:71], v[44:47]
ds_read_b64_tr_b16 a[48:49], v14 offset:4096
v_mfma_f32_16x16x32_bf16 v[68:71], a[20:23], a[68:71], v[68:71]
ds_read_b64_tr_b16 a[50:51], v14 offset:4608
v_mfma_f32_16x16x32_bf16 v[92:95], a[24:27], a[68:71], v[92:95]
ds_read_b64_tr_b16 a[52:53], v15 offset:4096
v_mfma_f32_16x16x32_bf16 v[116:119], a[28:31], a[68:71], v[116:119]
ds_read_b64_tr_b16 a[54:55], v15 offset:4608
v_mfma_f32_16x16x32_bf16 v[48:51], a[16:19], a[72:75], v[48:51]
v_mfma_f32_16x16x32_bf16 v[72:75], a[20:23], a[72:75], v[72:75]
v_mfma_f32_16x16x32_bf16 v[96:99], a[24:27], a[72:75], v[96:99]
v_mfma_f32_16x16x32_bf16 v[120:123], a[28:31], a[72:75], v[120:123]
v_mfma_f32_16x16x32_bf16 v[52:55], a[16:19], a[76:79], v[52:55]
v_mfma_f32_16x16x32_bf16 v[76:79], a[20:23], a[76:79], v[76:79]
v_mfma_f32_16x16x32_bf16 v[100:103], a[24:27], a[76:79], v[100:103]
v_mfma_f32_16x16x32_bf16 v[124:127], a[28:31], a[76:79], v[124:127]
s_waitcnt lgkmcnt(0)
v_mfma_f32_16x16x32_bf16 v[32:35], a[32:35], a[0:3], v[32:35]
ds_read_b128 a[16:19], v11 offset:0
v_mfma_f32_16x16x32_bf16 v[56:59], a[32:35], a[4:7], v[56:59]
ds_read_b64_tr_b16 a[56:57], v14 offset:12288
v_mfma_f32_16x16x32_bf16 v[80:83], a[32:35], a[8:11], v[80:83]
ds_read_b64_tr_b16 a[58:59], v14 offset:12800
v_mfma_f32_16x16x32_bf16 v[104:107], a[32:35], a[12:15], v[104:107]
ds_read_b128 a[20:23], v11 offset:2048
v_mfma_f32_16x16x32_bf16 v[36:39], a[36:39], a[0:3], v[36:39]
ds_read_b128 a[24:27], v11 offset:4096
v_mfma_f32_16x16x32_bf16 v[60:63], a[36:39], a[4:7], v[60:63]
ds_read_b128 a[28:31], v11 offset:6144
v_mfma_f32_16x16x32_bf16 v[84:87], a[36:39], a[8:11], v[84:87]
ds_read_b64_tr_b16 a[60:61], v15 offset:12288
v_mfma_f32_16x16x32_bf16 v[108:111], a[36:39], a[12:15], v[108:111]
ds_read_b64_tr_b16 a[62:63], v15 offset:12800
v_mfma_f32_16x16x32_bf16 v[40:43], a[0:3], a[40:43], v[40:43]
ds_read_b64_tr_b16 a[64:65], v14 offset:14336
v_mfma_f32_16x16x32_bf16 v[64:67], a[4:7], a[40:43], v[64:67]
ds_read_b64_tr_b16 a[66:67], v14 offset:14848
v_mfma_f32_16x16x32_bf16 v[88:91], a[8:11], a[40:43], v[88:91]
ds_read_b64_tr_b16 a[68:69], v15 offset:14336
v_mfma_f32_16x16x32_bf16 v[112:115], a[12:15], a[40:43], v[112:115]
ds_read_b64_tr_b16 a[70:71], v15 offset:14848
v_mfma_f32_16x16x32_bf16 v[44:47], a[0:3], a[44:47], v[44:47]
ds_read_b64_tr_b16 a[72:73], v14 offset:16384
v_mfma_f32_16x16x32_bf16 v[68:71], a[4:7], a[44:47], v[68:71]
ds_read_b64_tr_b16 a[74:75], v14 offset:16896
v_mfma_f32_16x16x32_bf16 v[92:95], a[8:11], a[44:47], v[92:95]
ds_read_b64_tr_b16 a[76:77], v15 offset:16384
v_mfma_f32_16x16x32_bf16 v[116:119], a[12:15], a[44:47], v[116:119]
ds_read_b64_tr_b16 a[78:79], v15 offset:16896
v_mfma_f32_16x16x32_bf16 v[48:51], a[0:3], a[48:51], v[48:51]
v_mfma_f32_16x16x32_bf16 v[72:75], a[4:7], a[48:51], v[72:75]
v_mfma_f32_16x16x32_bf16 v[96:99], a[8:11], a[48:51], v[96:99]
v_mfma_f32_16x16x32_bf16 v[120:123], a[12:15], a[48:51], v[120:123]
v_mfma_f32_16x16x32_bf16 v[52:55], a[0:3], a[52:55], v[52:55]
v_mfma_f32_16x16x32_bf16 v[76:79], a[4:7], a[52:55], v[76:79]
v_mfma_f32_16x16x32_bf16 v[100:103], a[8:11], a[52:55], v[100:103]
v_mfma_f32_16x16x32_bf16 v[124:127], a[12:15], a[52:55], v[124:127]
s_waitcnt lgkmcnt(0)
v_mfma_f32_16x16x32_bf16 v[32:35], a[56:59], a[16:19], v[32:35]
s_barrier
ds_read_b128 a[0:3], v8 offset:0
v_mfma_f32_16x16x32_bf16 v[56:59], a[56:59], a[20:23], v[56:59]
ds_read_b64_tr_b16 a[32:33], v12 offset:0
v_mfma_f32_16x16x32_bf16 v[80:83], a[56:59], a[24:27], v[80:83]
ds_read_b64_tr_b16 a[34:35], v12 offset:512
v_mfma_f32_16x16x32_bf16 v[104:107], a[56:59], a[28:31], v[104:107]
ds_read_b128 a[4:7], v8 offset:2048
v_mfma_f32_16x16x32_bf16 v[36:39], a[60:63], a[16:19], v[36:39]
ds_read_b128 a[8:11], v8 offset:4096
v_mfma_f32_16x16x32_bf16 v[60:63], a[60:63], a[20:23], v[60:63]
ds_read_b128 a[12:15], v8 offset:6144
v_mfma_f32_16x16x32_bf16 v[84:87], a[60:63], a[24:27], v[84:87]
ds_read_b64_tr_b16 a[36:37], v13 offset:0
v_mfma_f32_16x16x32_bf16 v[108:111], a[60:63], a[28:31], v[108:111]
ds_read_b64_tr_b16 a[38:39], v13 offset:512
v_mfma_f32_16x16x32_bf16 v[40:43], a[16:19], a[64:67], v[40:43]
ds_read_b64_tr_b16 a[40:41], v12 offset:2048
v_mfma_f32_16x16x32_bf16 v[64:67], a[20:23], a[64:67], v[64:67]
ds_read_b64_tr_b16 a[42:43], v12 offset:2560
v_mfma_f32_16x16x32_bf16 v[88:91], a[24:27], a[64:67], v[88:91]
ds_read_b64_tr_b16 a[44:45], v13 offset:2048
v_mfma_f32_16x16x32_bf16 v[112:115], a[28:31], a[64:67], v[112:115]
ds_read_b64_tr_b16 a[46:47], v13 offset:2560
v_mfma_f32_16x16x32_bf16 v[44:47], a[16:19], a[68:71], v[44:47]
ds_read_b64_tr_b16 a[48:49], v12 offset:4096
v_mfma_f32_16x16x32_bf16 v[68:71], a[20:23], a[68:71], v[68:71]
ds_read_b64_tr_b16 a[50:51], v12 offset:4608
v_mfma_f32_16x16x32_bf16 v[92:95], a[24:27], a[68:71], v[92:95]
ds_read_b64_tr_b16 a[52:53], v13 offset:4096
v_mfma_f32_16x16x32_bf16 v[116:119], a[28:31], a[68:71], v[116:119]
ds_read_b64_tr_b16 a[54:55], v13 offset:4608
v_mfma_f32_16x16x32_bf16 v[48:51], a[16:19], a[72:75], v[48:51]
v_mfma_f32_16x16x32_bf16 v[72:75], a[20:23], a[72:75], v[72:75]
v_mfma_f32_16x16x32_bf16 v[96:99], a[24:27], a[72:75], v[96:99]
v_mfma_f32_16x16x32_bf16 v[120:123], a[28:31], a[72:75], v[120:123]
v_mfma_f32_16x16x32_bf16 v[52:55], a[16:19], a[76:79], v[52:55]
v_mfma_f32_16x16x32_bf16 v[76:79], a[20:23], a[76:79], v[76:79]
v_mfma_f32_16x16x32_bf16 v[100:103], a[24:27], a[76:79], v[100:103]
v_mfma_f32_16x16x32_bf16 v[124:127], a[28:31], a[76:79], v[124:127]
s_waitcnt lgkmcnt(0)
v_mfma_f32_16x16x32_bf16 v[32:35], a[32:35], a[0:3], v[32:35]
ds_read_b128 a[16:19], v9 offset:0
v_mfma_f32_16x16x32_bf16 v[56:59], a[32:35], a[4:7], v[56:59]
ds_read_b64_tr_b16 a[56:57], v12 offset:12288
v_mfma_f32_16x16x32_bf16 v[80:83], a[32:35], a[8:11], v[80:83]
ds_read_b64_tr_b16 a[58:59], v12 offset:12800
v_mfma_f32_16x16x32_bf16 v[104:107], a[32:35], a[12:15], v[104:107]
ds_read_b128 a[20:23], v9 offset:2048
v_mfma_f32_16x16x32_bf16 v[36:39], a[36:39], a[0:3], v[36:39]
ds_read_b128 a[24:27], v9 offset:4096
v_mfma_f32_16x16x32_bf16 v[60:63], a[36:39], a[4:7], v[60:63]
ds_read_b128 a[28:31], v9 offset:6144
v_mfma_f32_16x16x32_bf16 v[84:87], a[36:39], a[8:11], v[84:87]
ds_read_b64_tr_b16 a[60:61], v13 offset:12288
v_mfma_f32_16x16x32_bf16 v[108:111], a[36:39], a[12:15], v[108:111]
ds_read_b64_tr_b16 a[62:63], v13 offset:12800
v_mfma_f32_16x16x32_bf16 v[40:43], a[0:3], a[40:43], v[40:43]
ds_read_b64_tr_b16 a[64:65], v12 offset:14336
v_mfma_f32_16x16x32_bf16 v[64:67], a[4:7], a[40:43], v[64:67]
ds_read_b64_tr_b16 a[66:67], v12 offset:14848
v_mfma_f32_16x16x32_bf16 v[88:91], a[8:11], a[40:43], v[88:91]
ds_read_b64_tr_b16 a[68:69], v13 offset:14336
v_mfma_f32_16x16x32_bf16 v[112:115], a[12:15], a[40:43], v[112:115]
ds_read_b64_tr_b16 a[70:71], v13 offset:14848
v_mfma_f32_16x16x32_bf16 v[44:47], a[0:3], a[44:47], v[44:47]
ds_read_b64_tr_b16 a[72:73], v12 offset:16384
v_mfma_f32_16x16x32_bf16 v[68:71], a[4:7], a[44:47], v[68:71]
ds_read_b64_tr_b16 a[74:75], v12 offset:16896
v_mfma_f32_16x16x32_bf16 v[92:95], a[8:11], a[44:47], v[92:95]
ds_read_b64_tr_b16 a[76:77], v13 offset:16384
v_mfma_f32_16x16x32_bf16 v[116:119], a[12:15], a[44:47], v[116:119]
ds_read_b64_tr_b16 a[78:79], v13 offset:16896
v_mfma_f32_16x16x32_bf16 v[48:51], a[0:3], a[48:51], v[48:51]
v_mfma_f32_16x16x32_bf16 v[72:75], a[4:7], a[48:51], v[72:75]
v_mfma_f32_16x16x32_bf16 v[96:99], a[8:11], a[48:51], v[96:99]
v_mfma_f32_16x16x32_bf16 v[120:123], a[12:15], a[48:51], v[120:123]
v_mfma_f32_16x16x32_bf16 v[52:55], a[0:3], a[52:55], v[52:55]
v_mfma_f32_16x16x32_bf16 v[76:79], a[4:7], a[52:55], v[76:79]
v_mfma_f32_16x16x32_bf16 v[100:103], a[8:11], a[52:55], v[100:103]
v_mfma_f32_16x16x32_bf16 v[124:127], a[12:15], a[52:55], v[124:127]
s_waitcnt lgkmcnt(0)
v_mfma_f32_16x16x32_bf16 v[32:35], a[56:59], a[16:19], v[32:35]
s_barrier
ds_read_b128 a[0:3], v8 offset:40960
v_mfma_f32_16x16x32_bf16 v[56:59], a[56:59], a[20:23], v[56:59]
ds_read_b64_tr_b16 a[32:33], v12 offset:40960
v_mfma_f32_16x16x32_bf16 v[80:83], a[56:59], a[24:27], v[80:83]
ds_read_b64_tr_b16 a[34:35], v12 offset:41472
v_mfma_f32_16x16x32_bf16 v[104:107], a[56:59], a[28:31], v[104:107]
ds_read_b128 a[4:7], v8 offset:43008
v_mfma_f32_16x16x32_bf16 v[36:39], a[60:63], a[16:19], v[36:39]
ds_read_b128 a[8:11], v8 offset:45056
v_mfma_f32_16x16x32_bf16 v[60:63], a[60:63], a[20:23], v[60:63]
ds_read_b128 a[12:15], v8 offset:47104
v_mfma_f32_16x16x32_bf16 v[84:87], a[60:63], a[24:27], v[84:87]
ds_read_b64_tr_b16 a[36:37], v13 offset:40960
v_mfma_f32_16x16x32_bf16 v[108:111], a[60:63], a[28:31], v[108:111]
ds_read_b64_tr_b16 a[38:39], v13 offset:41472
v_mfma_f32_16x16x32_bf16 v[40:43], a[16:19], a[64:67], v[40:43]
ds_read_b64_tr_b16 a[40:41], v12 offset:43008
v_mfma_f32_16x16x32_bf16 v[64:67], a[20:23], a[64:67], v[64:67]
ds_read_b64_tr_b16 a[42:43], v12 offset:43520
v_mfma_f32_16x16x32_bf16 v[88:91], a[24:27], a[64:67], v[88:91]
ds_read_b64_tr_b16 a[44:45], v13 offset:43008
v_mfma_f32_16x16x32_bf16 v[112:115], a[28:31], a[64:67], v[112:115]
ds_read_b64_tr_b16 a[46:47], v13 offset:43520
v_mfma_f32_16x16x32_bf16 v[44:47], a[16:19], a[68:71], v[44:47]
ds_read_b64_tr_b16 a[48:49], v12 offset:45056
v_mfma_f32_16x16x32_bf16 v[68:71], a[20:23], a[68:71], v[68:71]
ds_read_b64_tr_b16 a[50:51], v12 offset:45568
v_mfma_f32_16x16x32_bf16 v[92:95], a[24:27], a[68:71], v[92:95]
ds_read_b64_tr_b16 a[52:53], v13 offset:45056
v_mfma_f32_16x16x32_bf16 v[116:119], a[28:31], a[68:71], v[116:119]
ds_read_b64_tr_b16 a[54:55], v13 offset:45568
v_mfma_f32_16x16x32_bf16 v[48:51], a[16:19], a[72:75], v[48:51]
v_mfma_f32_16x16x32_bf16 v[72:75], a[20:23], a[72:75], v[72:75]
v_mfma_f32_16x16x32_bf16 v[96:99], a[24:27], a[72:75], v[96:99]
v_mfma_f32_16x16x32_bf16 v[120:123], a[28:31], a[72:75], v[120:123]
v_mfma_f32_16x16x32_bf16 v[52:55], a[16:19], a[76:79], v[52:55]
v_mfma_f32_16x16x32_bf16 v[76:79], a[20:23], a[76:79], v[76:79]
v_mfma_f32_16x16x32_bf16 v[100:103], a[24:27], a[76:79], v[100:103]
v_mfma_f32_16x16x32_bf16 v[124:127], a[28:31], a[76:79], v[124:127]
s_waitcnt lgkmcnt(0)
v_mfma_f32_16x16x32_bf16 v[32:35], a[32:35], a[0:3], v[32:35]
ds_read_b128 a[16:19], v9 offset:40960
v_mfma_f32_16x16x32_bf16 v[56:59], a[32:35], a[4:7], v[56:59]
ds_read_b64_tr_b16 a[56:57], v12 offset:53248
v_mfma_f32_16x16x32_bf16 v[80:83], a[32:35], a[8:11], v[80:83]
ds_read_b64_tr_b16 a[58:59], v12 offset:53760
v_mfma_f32_16x16x32_bf16 v[104:107], a[32:35], a[12:15], v[104:107]
ds_read_b128 a[20:23], v9 offset:43008
v_mfma_f32_16x16x32_bf16 v[36:39], a[36:39], a[0:3], v[36:39]
ds_read_b128 a[24:27], v9 offset:45056
v_mfma_f32_16x16x32_bf16 v[60:63], a[36:39], a[4:7], v[60:63]
ds_read_b128 a[28:31], v9 offset:47104
v_mfma_f32_16x16x32_bf16 v[84:87], a[36:39], a[8:11], v[84:87]
ds_read_b64_tr_b16 a[60:61], v13 offset:53248
v_mfma_f32_16x16x32_bf16 v[108:111], a[36:39], a[12:15], v[108:111]
ds_read_b64_tr_b16 a[62:63], v13 offset:53760
v_mfma_f32_16x16x32_bf16 v[40:43], a[0:3], a[40:43], v[40:43]
ds_read_b64_tr_b16 a[64:65], v12 offset:55296
v_mfma_f32_16x16x32_bf16 v[64:67], a[4:7], a[40:43], v[64:67]
ds_read_b64_tr_b16 a[66:67], v12 offset:55808
v_mfma_f32_16x16x32_bf16 v[88:91], a[8:11], a[40:43], v[88:91]
ds_read_b64_tr_b16 a[68:69], v13 offset:55296
v_mfma_f32_16x16x32_bf16 v[112:115], a[12:15], a[40:43], v[112:115]
ds_read_b64_tr_b16 a[70:71], v13 offset:55808
v_mfma_f32_16x16x32_bf16 v[44:47], a[0:3], a[44:47], v[44:47]
ds_read_b64_tr_b16 a[72:73], v12 offset:57344
v_mfma_f32_16x16x32_bf16 v[68:71], a[4:7], a[44:47], v[68:71]
ds_read_b64_tr_b16 a[74:75], v12 offset:57856
v_mfma_f32_16x16x32_bf16 v[92:95], a[8:11], a[44:47], v[92:95]
ds_read_b64_tr_b16 a[76:77], v13 offset:57344
v_mfma_f32_16x16x32_bf16 v[116:119], a[12:15], a[44:47], v[116:119]
ds_read_b64_tr_b16 a[78:79], v13 offset:57856
v_mfma_f32_16x16x32_bf16 v[48:51], a[0:3], a[48:51], v[48:51]
v_mfma_f32_16x16x32_bf16 v[72:75], a[4:7], a[48:51], v[72:75]
v_mfma_f32_16x16x32_bf16 v[96:99], a[8:11], a[48:51], v[96:99]
v_mfma_f32_16x16x32_bf16 v[120:123], a[12:15], a[48:51], v[120:123]
v_mfma_f32_16x16x32_bf16 v[52:55], a[0:3], a[52:55], v[52:55]
v_mfma_f32_16x16x32_bf16 v[76:79], a[4:7], a[52:55], v[76:79]
v_mfma_f32_16x16x32_bf16 v[100:103], a[8:11], a[52:55], v[100:103]
v_mfma_f32_16x16x32_bf16 v[124:127], a[12:15], a[52:55], v[124:127]
s_waitcnt lgkmcnt(0)
v_mfma_f32_16x16x32_bf16 v[32:35], a[56:59], a[16:19], v[32:35]
s_barrier
ds_read_b128 a[0:3], v10 offset:0
v_mfma_f32_16x16x32_bf16 v[56:59], a[56:59], a[20:23], v[56:59]
ds_read_b64_tr_b16 a[32:33], v14 offset:0
v_mfma_f32_16x16x32_bf16 v[80:83], a[56:59], a[24:27], v[80:83]
ds_read_b64_tr_b16 a[34:35], v14 offset:512
v_mfma_f32_16x16x32_bf16 v[104:107], a[56:59], a[28:31], v[104:107]
ds_read_b128 a[4:7], v10 offset:2048
v_mfma_f32_16x16x32_bf16 v[36:39], a[60:63], a[16:19], v[36:39]
ds_read_b128 a[8:11], v10 offset:4096
v_mfma_f32_16x16x32_bf16 v[60:63], a[60:63], a[20:23], v[60:63]
ds_read_b128 a[12:15], v10 offset:6144
v_mfma_f32_16x16x32_bf16 v[84:87], a[60:63], a[24:27], v[84:87]
ds_read_b64_tr_b16 a[36:37], v15 offset:0
v_mfma_f32_16x16x32_bf16 v[108:111], a[60:63], a[28:31], v[108:111]
ds_read_b64_tr_b16 a[38:39], v15 offset:512
v_mfma_f32_16x16x32_bf16 v[40:43], a[16:19], a[64:67], v[40:43]
ds_read_b64_tr_b16 a[40:41], v14 offset:2048
v_mfma_f32_16x16x32_bf16 v[64:67], a[20:23], a[64:67], v[64:67]
ds_read_b64_tr_b16 a[42:43], v14 offset:2560
v_mfma_f32_16x16x32_bf16 v[88:91], a[24:27], a[64:67], v[88:91]
ds_read_b64_tr_b16 a[44:45], v15 offset:2048
v_mfma_f32_16x16x32_bf16 v[112:115], a[28:31], a[64:67], v[112:115]
ds_read_b64_tr_b16 a[46:47], v15 offset:2560
v_mfma_f32_16x16x32_bf16 v[44:47], a[16:19], a[68:71], v[44:47]
ds_read_b64_tr_b16 a[48:49], v14 offset:4096
v_mfma_f32_16x16x32_bf16 v[68:71], a[20:23], a[68:71], v[68:71]
ds_read_b64_tr_b16 a[50:51], v14 offset:4608
v_mfma_f32_16x16x32_bf16 v[92:95], a[24:27], a[68:71], v[92:95]
ds_read_b64_tr_b16 a[52:53], v15 offset:4096
v_mfma_f32_16x16x32_bf16 v[116:119], a[28:31], a[68:71], v[116:119]
ds_read_b64_tr_b16 a[54:55], v15 offset:4608
v_mfma_f32_16x16x32_bf16 v[48:51], a[16:19], a[72:75], v[48:51]
v_mfma_f32_16x16x32_bf16 v[72:75], a[20:23], a[72:75], v[72:75]
v_mfma_f32_16x16x32_bf16 v[96:99], a[24:27], a[72:75], v[96:99]
v_mfma_f32_16x16x32_bf16 v[120:123], a[28:31], a[72:75], v[120:123]
v_mfma_f32_16x16x32_bf16 v[52:55], a[16:19], a[76:79], v[52:55]
v_mfma_f32_16x16x32_bf16 v[76:79], a[20:23], a[76:79], v[76:79]
v_mfma_f32_16x16x32_bf16 v[100:103], a[24:27], a[76:79], v[100:103]
v_mfma_f32_16x16x32_bf16 v[124:127], a[28:31], a[76:79], v[124:127]
s_waitcnt lgkmcnt(0)
v_mfma_f32_16x16x32_bf16 v[32:35], a[32:35], a[0:3], v[32:35]
ds_read_b128 a[16:19], v11 offset:0
v_mfma_f32_16x16x32_bf16 v[56:59], a[32:35], a[4:7], v[56:59]
ds_read_b64_tr_b16 a[56:57], v14 offset:12288
v_mfma_f32_16x16x32_bf16 v[80:83], a[32:35], a[8:11], v[80:83]
ds_read_b64_tr_b16 a[58:59], v14 offset:12800
v_mfma_f32_16x16x32_bf16 v[104:107], a[32:35], a[12:15], v[104:107]
ds_read_b128 a[20:23], v11 offset:2048
v_mfma_f32_16x16x32_bf16 v[36:39], a[36:39], a[0:3], v[36:39]
ds_read_b128 a[24:27], v11 offset:4096
v_mfma_f32_16x16x32_bf16 v[60:63], a[36:39], a[4:7], v[60:63]
ds_read_b128 a[28:31], v11 offset:6144
v_mfma_f32_16x16x32_bf16 v[84:87], a[36:39], a[8:11], v[84:87]
ds_read_b64_tr_b16 a[60:61], v15 offset:12288
v_mfma_f32_16x16x32_bf16 v[108:111], a[36:39], a[12:15], v[108:111]
ds_read_b64_tr_b16 a[62:63], v15 offset:12800
v_mfma_f32_16x16x32_bf16 v[40:43], a[0:3], a[40:43], v[40:43]
ds_read_b64_tr_b16 a[64:65], v14 offset:14336
v_mfma_f32_16x16x32_bf16 v[64:67], a[4:7], a[40:43], v[64:67]
ds_read_b64_tr_b16 a[66:67], v14 offset:14848
v_mfma_f32_16x16x32_bf16 v[88:91], a[8:11], a[40:43], v[88:91]
ds_read_b64_tr_b16 a[68:69], v15 offset:14336
v_mfma_f32_16x16x32_bf16 v[112:115], a[12:15], a[40:43], v[112:115]
ds_read_b64_tr_b16 a[70:71], v15 offset:14848
v_mfma_f32_16x16x32_bf16 v[44:47], a[0:3], a[44:47], v[44:47]
ds_read_b64_tr_b16 a[72:73], v14 offset:16384
v_mfma_f32_16x16x32_bf16 v[68:71], a[4:7], a[44:47], v[68:71]
ds_read_b64_tr_b16 a[74:75], v14 offset:16896
v_mfma_f32_16x16x32_bf16 v[92:95], a[8:11], a[44:47], v[92:95]
ds_read_b64_tr_b16 a[76:77], v15 offset:16384
v_mfma_f32_16x16x32_bf16 v[116:119], a[12:15], a[44:47], v[116:119]
ds_read_b64_tr_b16 a[78:79], v15 offset:16896
v_mfma_f32_16x16x32_bf16 v[48:51], a[0:3], a[48:51], v[48:51]
v_lshrrev_b32 v2, 4, v1
v_lshlrev_b32 v2, 4, v2
s_lshl_b32 s70, s66, 8
s_add_u32 s70, s70, 159744
v_add_u32 v17, s70, v2
v_mfma_f32_16x16x32_bf16 v[72:75], a[4:7], a[48:51], v[72:75]
v_mfma_f32_16x16x32_bf16 v[96:99], a[8:11], a[48:51], v[96:99]
v_and_b32 v2, 15, v1
v_lshlrev_b32 v2, 2, v2
s_lshl_b32 s70, s67, 7
s_add_u32 s70, s70, 160768
v_add_u32 v18, s70, v2
v_mfma_f32_16x16x32_bf16 v[120:123], a[12:15], a[48:51], v[120:123]
v_mfma_f32_16x16x32_bf16 v[52:55], a[0:3], a[52:55], v[52:55]
v_mfma_f32_16x16x32_bf16 v[76:79], a[4:7], a[52:55], v[76:79]
v_mfma_f32_16x16x32_bf16 v[100:103], a[8:11], a[52:55], v[100:103]
v_mfma_f32_16x16x32_bf16 v[124:127], a[12:15], a[52:55], v[124:127]
s_waitcnt lgkmcnt(0)
v_mfma_f32_16x16x32_bf16 v[32:35], a[56:59], a[16:19], v[32:35]
s_barrier
ds_read_b128 a[0:3], v8 offset:0
v_mfma_f32_16x16x32_bf16 v[56:59], a[56:59], a[20:23], v[56:59]
ds_read_b64_tr_b16 a[32:33], v12 offset:0
v_mfma_f32_16x16x32_bf16 v[80:83], a[56:59], a[24:27], v[80:83]
ds_read_b64_tr_b16 a[34:35], v12 offset:512
v_mfma_f32_16x16x32_bf16 v[104:107], a[56:59], a[28:31], v[104:107]
ds_read_b128 a[4:7], v8 offset:2048
v_mfma_f32_16x16x32_bf16 v[36:39], a[60:63], a[16:19], v[36:39]
ds_read_b128 a[8:11], v8 offset:4096
v_mfma_f32_16x16x32_bf16 v[60:63], a[60:63], a[20:23], v[60:63]
ds_read_b128 a[12:15], v8 offset:6144
v_mfma_f32_16x16x32_bf16 v[84:87], a[60:63], a[24:27], v[84:87]
ds_read_b64_tr_b16 a[36:37], v13 offset:0
v_mfma_f32_16x16x32_bf16 v[108:111], a[60:63], a[28:31], v[108:111]
ds_read_b64_tr_b16 a[38:39], v13 offset:512
v_mfma_f32_16x16x32_bf16 v[40:43], a[16:19], a[64:67], v[40:43]
ds_read_b64_tr_b16 a[40:41], v12 offset:2048
v_mfma_f32_16x16x32_bf16 v[64:67], a[20:23], a[64:67], v[64:67]
ds_read_b64_tr_b16 a[42:43], v12 offset:2560
v_mfma_f32_16x16x32_bf16 v[88:91], a[24:27], a[64:67], v[88:91]
ds_read_b64_tr_b16 a[44:45], v13 offset:2048
v_mfma_f32_16x16x32_bf16 v[112:115], a[28:31], a[64:67], v[112:115]
ds_read_b64_tr_b16 a[46:47], v13 offset:2560
v_mfma_f32_16x16x32_bf16 v[44:47], a[16:19], a[68:71], v[44:47]
ds_read_b64_tr_b16 a[48:49], v12 offset:4096
v_mfma_f32_16x16x32_bf16 v[68:71], a[20:23], a[68:71], v[68:71]
ds_read_b64_tr_b16 a[50:51], v12 offset:4608
v_mfma_f32_16x16x32_bf16 v[92:95], a[24:27], a[68:71], v[92:95]
ds_read_b64_tr_b16 a[52:53], v13 offset:4096
v_mfma_f32_16x16x32_bf16 v[116:119], a[28:31], a[68:71], v[116:119]
ds_read_b64_tr_b16 a[54:55], v13 offset:4608
v_mfma_f32_16x16x32_bf16 v[48:51], a[16:19], a[72:75], v[48:51]
v_mfma_f32_16x16x32_bf16 v[72:75], a[20:23], a[72:75], v[72:75]
v_mfma_f32_16x16x32_bf16 v[96:99], a[24:27], a[72:75], v[96:99]
v_mfma_f32_16x16x32_bf16 v[120:123], a[28:31], a[72:75], v[120:123]
v_mfma_f32_16x16x32_bf16 v[52:55], a[16:19], a[76:79], v[52:55]
v_mfma_f32_16x16x32_bf16 v[76:79], a[20:23], a[76:79], v[76:79]
v_mfma_f32_16x16x32_bf16 v[100:103], a[24:27], a[76:79], v[100:103]
v_mfma_f32_16x16x32_bf16 v[124:127], a[28:31], a[76:79], v[124:127]
s_waitcnt lgkmcnt(0)
v_mfma_f32_16x16x32_bf16 v[32:35], a[32:35], a[0:3], v[32:35]
ds_read_b128 a[16:19], v9 offset:0
v_mfma_f32_16x16x32_bf16 v[56:59], a[32:35], a[4:7], v[56:59]
ds_read_b64_tr_b16 a[56:57], v12 offset:12288
v_mfma_f32_16x16x32_bf16 v[80:83], a[32:35], a[8:11], v[80:83]
ds_read_b64_tr_b16 a[58:59], v12 offset:12800
v_mfma_f32_16x16x32_bf16 v[104:107], a[32:35], a[12:15], v[104:107]
ds_read_b128 a[20:23], v9 offset:2048
v_mfma_f32_16x16x32_bf16 v[36:39], a[36:39], a[0:3], v[36:39]
ds_read_b128 a[24:27], v9 offset:4096
v_mfma_f32_16x16x32_bf16 v[60:63], a[36:39], a[4:7], v[60:63]
ds_read_b128 a[28:31], v9 offset:6144
v_mfma_f32_16x16x32_bf16 v[84:87], a[36:39], a[8:11], v[84:87]
ds_read_b64_tr_b16 a[60:61], v13 offset:12288
v_mfma_f32_16x16x32_bf16 v[108:111], a[36:39], a[12:15], v[108:111]
ds_read_b64_tr_b16 a[62:63], v13 offset:12800
v_mfma_f32_16x16x32_bf16 v[40:43], a[0:3], a[40:43], v[40:43]
ds_read_b64_tr_b16 a[64:65], v12 offset:14336
v_mfma_f32_16x16x32_bf16 v[64:67], a[4:7], a[40:43], v[64:67]
ds_read_b64_tr_b16 a[66:67], v12 offset:14848
v_mfma_f32_16x16x32_bf16 v[88:91], a[8:11], a[40:43], v[88:91]
ds_read_b64_tr_b16 a[68:69], v13 offset:14336
v_mfma_f32_16x16x32_bf16 v[112:115], a[12:15], a[40:43], v[112:115]
ds_read_b64_tr_b16 a[70:71], v13 offset:14848
v_mfma_f32_16x16x32_bf16 v[44:47], a[0:3], a[44:47], v[44:47]
ds_read_b64_tr_b16 a[72:73], v12 offset:16384
v_mfma_f32_16x16x32_bf16 v[68:71], a[4:7], a[44:47], v[68:71]
ds_read_b64_tr_b16 a[74:75], v12 offset:16896
v_mfma_f32_16x16x32_bf16 v[92:95], a[8:11], a[44:47], v[92:95]
ds_read_b64_tr_b16 a[76:77], v13 offset:16384
v_mfma_f32_16x16x32_bf16 v[116:119], a[12:15], a[44:47], v[116:119]
ds_read_b64_tr_b16 a[78:79], v13 offset:16896
v_mfma_f32_16x16x32_bf16 v[48:51], a[0:3], a[48:51], v[48:51]
v_mfma_f32_16x16x32_bf16 v[72:75], a[4:7], a[48:51], v[72:75]
v_mfma_f32_16x16x32_bf16 v[96:99], a[8:11], a[48:51], v[96:99]
v_mfma_f32_16x16x32_bf16 v[120:123], a[12:15], a[48:51], v[120:123]
v_mfma_f32_16x16x32_bf16 v[52:55], a[0:3], a[52:55], v[52:55]
v_mfma_f32_16x16x32_bf16 v[76:79], a[4:7], a[52:55], v[76:79]
v_mfma_f32_16x16x32_bf16 v[100:103], a[8:11], a[52:55], v[100:103]
v_mfma_f32_16x16x32_bf16 v[124:127], a[12:15], a[52:55], v[124:127]
s_waitcnt lgkmcnt(0)
v_mfma_f32_16x16x32_bf16 v[40:43], a[16:19], a[64:67], v[40:43]
s_barrier
ds_read_b128 v[20:23], v17 offset:0
v_mfma_f32_16x16x32_bf16 v[64:67], a[20:23], a[64:67], v[64:67]
ds_read_b128 v[24:27], v17 offset:512
v_mfma_f32_16x16x32_bf16 v[88:91], a[24:27], a[64:67], v[88:91]
ds_read_b32 v8, v18 offset:256
v_mfma_f32_16x16x32_bf16 v[112:115], a[28:31], a[64:67], v[112:115]
ds_read_b32 v9, v18 offset:320
v_mfma_f32_16x16x32_bf16 v[44:47], a[16:19], a[68:71], v[44:47]
ds_read_b32 v10, v18 offset:512
v_mfma_f32_16x16x32_bf16 v[68:71], a[20:23], a[68:71], v[68:71]
ds_read_b32 v11, v18 offset:576
v_mfma_f32_16x16x32_bf16 v[92:95], a[24:27], a[68:71], v[92:95]
v_mov_b32 v19, 161536
ds_read_b32 v19, v19
v_mfma_f32_16x16x32_bf16 v[116:119], a[28:31], a[68:71], v[116:119]
ds_read_b128 v[128:131], v17 offset:64
v_mfma_f32_16x16x32_bf16 v[48:51], a[16:19], a[72:75], v[48:51]
ds_read_b128 v[132:135], v17 offset:576
v_mfma_f32_16x16x32_bf16 v[72:75], a[20:23], a[72:75], v[72:75]
ds_read_b128 v[136:139], v17 offset:128
v_mfma_f32_16x16x32_bf16 v[96:99], a[24:27], a[72:75], v[96:99]
ds_read_b128 v[140:143], v17 offset:640
v_mfma_f32_16x16x32_bf16 v[120:123], a[28:31], a[72:75], v[120:123]
ds_read_b128 v[144:147], v17 offset:192
v_mfma_f32_16x16x32_bf16 v[52:55], a[16:19], a[76:79], v[52:55]
ds_read_b128 v[148:151], v17 offset:704
v_mfma_f32_16x16x32_bf16 v[76:79], a[20:23], a[76:79], v[76:79]
v_mfma_f32_16x16x32_bf16 v[100:103], a[24:27], a[76:79], v[100:103]
v_mfma_f32_16x16x32_bf16 v[124:127], a[28:31], a[76:79], v[124:127]
v_mfma_f32_16x16x32_bf16 v[32:35], a[56:59], a[16:19], v[32:35]
v_mfma_f32_16x16x32_bf16 v[56:59], a[56:59], a[20:23], v[56:59]
v_mfma_f32_16x16x32_bf16 v[80:83], a[56:59], a[24:27], v[80:83]
v_mfma_f32_16x16x32_bf16 v[104:107], a[56:59], a[28:31], v[104:107]
v_mfma_f32_16x16x32_bf16 v[36:39], a[60:63], a[16:19], v[36:39]
v_mfma_f32_16x16x32_bf16 v[60:63], a[60:63], a[20:23], v[60:63]
v_mfma_f32_16x16x32_bf16 v[84:87], a[60:63], a[24:27], v[84:87]
v_mfma_f32_16x16x32_bf16 v[108:111], a[60:63], a[28:31], v[108:111]
s_waitcnt lgkmcnt(0)
v_readfirstlane_b32 s69, v19
v_pk_mul_f32 v[28:29], v[24:25], s[90:91]
v_pk_mul_f32 v[30:31], v[26:27], s[90:91]
v_pk_fma_f32 v[40:41], v[20:21], v[8:9], v[40:41] op_sel:[0,0,0] op_sel_hi:[1,0,1]
v_pk_fma_f32 v[44:45], v[20:21], v[8:9], v[44:45] op_sel:[0,1,0] op_sel_hi:[1,1,1]
v_pk_fma_f32 v[42:43], v[22:23], v[8:9], v[42:43] op_sel:[0,0,0] op_sel_hi:[1,0,1]
v_pk_fma_f32 v[46:47], v[22:23], v[8:9], v[46:47] op_sel:[0,1,0] op_sel_hi:[1,1,1]
v_pk_mul_f32 v[2:3], v[40:41], v[28:29]
v_pk_mul_f32 v[12:13], v[44:45], v[28:29]
v_pk_mul_f32 v[4:5], v[42:43], v[30:31]
v_pk_mul_f32 v[14:15], v[46:47], v[30:31]
v_pk_fma_f32 v[40:41], v[40:41], v[24:25], s[82:83]
v_pk_fma_f32 v[44:45], v[44:45], v[24:25], s[82:83]
v_pk_fma_f32 v[42:43], v[42:43], v[26:27], s[82:83]
v_pk_fma_f32 v[46:47], v[46:47], v[26:27], s[82:83]
v_exp_f32_e64 v2, v2 clamp
v_exp_f32_e64 v12, v12 clamp
v_exp_f32_e64 v3, v3 clamp
v_exp_f32_e64 v13, v13 clamp
v_exp_f32_e64 v4, v4 clamp
v_exp_f32_e64 v14, v14 clamp
v_exp_f32_e64 v5, v5 clamp
v_exp_f32_e64 v15, v15 clamp
v_pk_add_f32 v[2:3], v[2:3], s[80:81]
v_pk_add_f32 v[12:13], v[12:13], s[80:81]
v_pk_add_f32 v[4:5], v[4:5], s[80:81]
v_pk_add_f32 v[14:15], v[14:15], s[80:81]
v_max_f32 v40, v40, v2
v_max_f32 v44, v44, v12
v_max_f32 v41, v41, v3
v_max_f32 v45, v45, v13
v_max_f32 v42, v42, v4
v_max_f32 v46, v46, v14
v_max_f32 v43, v43, v5
v_max_f32 v47, v47, v15
v_cvt_pk_bf16_f32 v40, v40, v41
v_cvt_pk_bf16_f32 v44, v44, v45
v_cvt_pk_bf16_f32 v41, v42, v43
v_cvt_pk_bf16_f32 v45, v46, v47
v_pk_fma_f32 v[48:49], v[20:21], v[10:11], v[48:49] op_sel:[0,0,0] op_sel_hi:[1,0,1]
v_pk_fma_f32 v[52:53], v[20:21], v[10:11], v[52:53] op_sel:[0,1,0] op_sel_hi:[1,1,1]
v_pk_fma_f32 v[50:51], v[22:23], v[10:11], v[50:51] op_sel:[0,0,0] op_sel_hi:[1,0,1]
v_pk_fma_f32 v[54:55], v[22:23], v[10:11], v[54:55] op_sel:[0,1,0] op_sel_hi:[1,1,1]
v_pk_mul_f32 v[48:49], v[48:49], v[24:25]
v_pk_mul_f32 v[52:53], v[52:53], v[24:25]
v_pk_mul_f32 v[50:51], v[50:51], v[26:27]
v_pk_mul_f32 v[54:55], v[54:55], v[26:27]
v_cvt_pk_bf16_f32 v48, v48, v49
v_cvt_pk_bf16_f32 v52, v52, v53
v_cvt_pk_bf16_f32 v49, v50, v51
v_cvt_pk_bf16_f32 v53, v54, v55
v_pk_mul_f32 v[28:29], v[132:133], s[90:91]
v_pk_mul_f32 v[30:31], v[134:135], s[90:91]
v_pk_fma_f32 v[64:65], v[128:129], v[8:9], v[64:65] op_sel:[0,0,0] op_sel_hi:[1,0,1]
v_pk_fma_f32 v[68:69], v[128:129], v[8:9], v[68:69] op_sel:[0,1,0] op_sel_hi:[1,1,1]
v_pk_fma_f32 v[66:67], v[130:131], v[8:9], v[66:67] op_sel:[0,0,0] op_sel_hi:[1,0,1]
v_pk_fma_f32 v[70:71], v[130:131], v[8:9], v[70:71] op_sel:[0,1,0] op_sel_hi:[1,1,1]
v_pk_mul_f32 v[2:3], v[64:65], v[28:29]
v_pk_mul_f32 v[12:13], v[68:69], v[28:29]
v_pk_mul_f32 v[4:5], v[66:67], v[30:31]
v_pk_mul_f32 v[14:15], v[70:71], v[30:31]
v_pk_fma_f32 v[64:65], v[64:65], v[132:133], s[82:83]
v_pk_fma_f32 v[68:69], v[68:69], v[132:133], s[82:83]
v_pk_fma_f32 v[66:67], v[66:67], v[134:135], s[82:83]
v_pk_fma_f32 v[70:71], v[70:71], v[134:135], s[82:83]
v_exp_f32_e64 v2, v2 clamp
v_exp_f32_e64 v12, v12 clamp
v_exp_f32_e64 v3, v3 clamp
v_exp_f32_e64 v13, v13 clamp
v_exp_f32_e64 v4, v4 clamp
v_exp_f32_e64 v14, v14 clamp
v_exp_f32_e64 v5, v5 clamp
v_exp_f32_e64 v15, v15 clamp
v_pk_add_f32 v[2:3], v[2:3], s[80:81]
v_pk_add_f32 v[12:13], v[12:13], s[80:81]
v_pk_add_f32 v[4:5], v[4:5], s[80:81]
v_pk_add_f32 v[14:15], v[14:15], s[80:81]
v_max_f32 v64, v64, v2
v_max_f32 v68, v68, v12
v_max_f32 v65, v65, v3
v_max_f32 v69, v69, v13
v_max_f32 v66, v66, v4
v_max_f32 v70, v70, v14
v_max_f32 v67, v67, v5
v_max_f32 v71, v71, v15
v_cvt_pk_bf16_f32 v42, v64, v65
v_cvt_pk_bf16_f32 v46, v68, v69
v_cvt_pk_bf16_f32 v43, v66, v67
v_cvt_pk_bf16_f32 v47, v70, v71
v_pk_fma_f32 v[72:73], v[128:129], v[10:11], v[72:73] op_sel:[0,0,0] op_sel_hi:[1,0,1]
v_pk_fma_f32 v[76:77], v[128:129], v[10:11], v[76:77] op_sel:[0,1,0] op_sel_hi:[1,1,1]
v_pk_fma_f32 v[74:75], v[130:131], v[10:11], v[74:75] op_sel:[0,0,0] op_sel_hi:[1,0,1]
v_pk_fma_f32 v[78:79], v[130:131], v[10:11], v[78:79] op_sel:[0,1,0] op_sel_hi:[1,1,1]
v_pk_mul_f32 v[72:73], v[72:73], v[132:133]
v_pk_mul_f32 v[76:77], v[76:77], v[132:133]
v_pk_mul_f32 v[74:75], v[74:75], v[134:135]
v_pk_mul_f32 v[78:79], v[78:79], v[134:135]
v_cvt_pk_bf16_f32 v50, v72, v73
v_cvt_pk_bf16_f32 v54, v76, v77
v_cvt_pk_bf16_f32 v51, v74, v75
v_cvt_pk_bf16_f32 v55, v78, v79
s_nop 0
v_mfma_f32_16x16x32_bf16 v[64:67], v[40:43], v[48:51], 0
v_mfma_f32_16x16x32_bf16 v[68:71], v[40:43], v[52:55], 0
v_mfma_f32_16x16x32_bf16 v[20:23], v[40:43], a[80:83], 0
v_mfma_f32_16x16x32_bf16 v[72:75], v[44:47], v[48:51], 0
v_mfma_f32_16x16x32_bf16 v[76:79], v[44:47], v[52:55], 0
v_mfma_f32_16x16x32_bf16 v[24:27], v[44:47], a[80:83], 0
v_pk_mul_f32 v[28:29], v[140:141], s[90:91]
v_pk_mul_f32 v[30:31], v[142:143], s[90:91]
v_pk_fma_f32 v[88:89], v[136:137], v[8:9], v[88:89] op_sel:[0,0,0] op_sel_hi:[1,0,1]
v_pk_fma_f32 v[92:93], v[136:137], v[8:9], v[92:93] op_sel:[0,1,0] op_sel_hi:[1,1,1]
v_pk_fma_f32 v[90:91], v[138:139], v[8:9], v[90:91] op_sel:[0,0,0] op_sel_hi:[1,0,1]
v_pk_fma_f32 v[94:95], v[138:139], v[8:9], v[94:95] op_sel:[0,1,0] op_sel_hi:[1,1,1]
v_pk_mul_f32 v[2:3], v[88:89], v[28:29]
v_pk_mul_f32 v[12:13], v[92:93], v[28:29]
v_pk_mul_f32 v[4:5], v[90:91], v[30:31]
v_pk_mul_f32 v[14:15], v[94:95], v[30:31]
v_pk_fma_f32 v[88:89], v[88:89], v[140:141], s[82:83]
v_pk_fma_f32 v[92:93], v[92:93], v[140:141], s[82:83]
v_pk_fma_f32 v[90:91], v[90:91], v[142:143], s[82:83]
v_pk_fma_f32 v[94:95], v[94:95], v[142:143], s[82:83]
v_exp_f32_e64 v2, v2 clamp
v_exp_f32_e64 v12, v12 clamp
v_exp_f32_e64 v3, v3 clamp
v_exp_f32_e64 v13, v13 clamp
v_exp_f32_e64 v4, v4 clamp
v_exp_f32_e64 v14, v14 clamp
v_exp_f32_e64 v5, v5 clamp
v_exp_f32_e64 v15, v15 clamp
v_pk_add_f32 v[2:3], v[2:3], s[80:81]
v_pk_add_f32 v[12:13], v[12:13], s[80:81]
v_pk_add_f32 v[4:5], v[4:5], s[80:81]
v_pk_add_f32 v[14:15], v[14:15], s[80:81]
v_max_f32 v88, v88, v2
v_max_f32 v92, v92, v12
v_max_f32 v89, v89, v3
v_max_f32 v93, v93, v13
v_max_f32 v90, v90, v4
v_max_f32 v94, v94, v14
v_max_f32 v91, v91, v5
v_max_f32 v95, v95, v15
v_cvt_pk_bf16_f32 v88, v88, v89
v_cvt_pk_bf16_f32 v92, v92, v93
v_cvt_pk_bf16_f32 v89, v90, v91
v_cvt_pk_bf16_f32 v93, v94, v95
v_pk_fma_f32 v[96:97], v[136:137], v[10:11], v[96:97] op_sel:[0,0,0] op_sel_hi:[1,0,1]
v_pk_fma_f32 v[100:101], v[136:137], v[10:11], v[100:101] op_sel:[0,1,0] op_sel_hi:[1,1,1]
v_pk_fma_f32 v[98:99], v[138:139], v[10:11], v[98:99] op_sel:[0,0,0] op_sel_hi:[1,0,1]
v_pk_fma_f32 v[102:103], v[138:139], v[10:11], v[102:103] op_sel:[0,1,0] op_sel_hi:[1,1,1]
v_pk_mul_f32 v[96:97], v[96:97], v[140:141]
v_pk_mul_f32 v[100:101], v[100:101], v[140:141]
v_pk_mul_f32 v[98:99], v[98:99], v[142:143]
v_pk_mul_f32 v[102:103], v[102:103], v[142:143]
v_cvt_pk_bf16_f32 v96, v96, v97
v_cvt_pk_bf16_f32 v100, v100, v101
v_cvt_pk_bf16_f32 v97, v98, v99
v_cvt_pk_bf16_f32 v101, v102, v103
v_pk_mul_f32 v[28:29], v[148:149], s[90:91]
v_pk_mul_f32 v[30:31], v[150:151], s[90:91]
v_pk_fma_f32 v[112:113], v[144:145], v[8:9], v[112:113] op_sel:[0,0,0] op_sel_hi:[1,0,1]
v_pk_fma_f32 v[116:117], v[144:145], v[8:9], v[116:117] op_sel:[0,1,0] op_sel_hi:[1,1,1]
v_pk_fma_f32 v[114:115], v[146:147], v[8:9], v[114:115] op_sel:[0,0,0] op_sel_hi:[1,0,1]
v_pk_fma_f32 v[118:119], v[146:147], v[8:9], v[118:119] op_sel:[0,1,0] op_sel_hi:[1,1,1]
v_pk_mul_f32 v[2:3], v[112:113], v[28:29]
v_pk_mul_f32 v[12:13], v[116:117], v[28:29]
v_pk_mul_f32 v[4:5], v[114:115], v[30:31]
v_pk_mul_f32 v[14:15], v[118:119], v[30:31]
v_pk_fma_f32 v[112:113], v[112:113], v[148:149], s[82:83]
v_pk_fma_f32 v[116:117], v[116:117], v[148:149], s[82:83]
v_pk_fma_f32 v[114:115], v[114:115], v[150:151], s[82:83]
v_pk_fma_f32 v[118:119], v[118:119], v[150:151], s[82:83]
v_exp_f32_e64 v2, v2 clamp
v_exp_f32_e64 v12, v12 clamp
v_exp_f32_e64 v3, v3 clamp
v_exp_f32_e64 v13, v13 clamp
v_exp_f32_e64 v4, v4 clamp
v_exp_f32_e64 v14, v14 clamp
v_exp_f32_e64 v5, v5 clamp
v_exp_f32_e64 v15, v15 clamp
v_pk_add_f32 v[2:3], v[2:3], s[80:81]
v_pk_add_f32 v[12:13], v[12:13], s[80:81]
v_pk_add_f32 v[4:5], v[4:5], s[80:81]
v_pk_add_f32 v[14:15], v[14:15], s[80:81]
v_max_f32 v112, v112, v2
v_max_f32 v116, v116, v12
v_max_f32 v113, v113, v3
v_max_f32 v117, v117, v13
v_max_f32 v114, v114, v4
v_max_f32 v118, v118, v14
v_max_f32 v115, v115, v5
v_max_f32 v119, v119, v15
v_cvt_pk_bf16_f32 v90, v112, v113
v_cvt_pk_bf16_f32 v94, v116, v117
v_cvt_pk_bf16_f32 v91, v114, v115
v_cvt_pk_bf16_f32 v95, v118, v119
v_pk_fma_f32 v[120:121], v[144:145], v[10:11], v[120:121] op_sel:[0,0,0] op_sel_hi:[1,0,1]
v_pk_fma_f32 v[124:125], v[144:145], v[10:11], v[124:125] op_sel:[0,1,0] op_sel_hi:[1,1,1]
v_pk_fma_f32 v[122:123], v[146:147], v[10:11], v[122:123] op_sel:[0,0,0] op_sel_hi:[1,0,1]
v_pk_fma_f32 v[126:127], v[146:147], v[10:11], v[126:127] op_sel:[0,1,0] op_sel_hi:[1,1,1]
v_pk_mul_f32 v[120:121], v[120:121], v[148:149]
v_pk_mul_f32 v[124:125], v[124:125], v[148:149]
v_pk_mul_f32 v[122:123], v[122:123], v[150:151]
v_pk_mul_f32 v[126:127], v[126:127], v[150:151]
v_cvt_pk_bf16_f32 v98, v120, v121
v_cvt_pk_bf16_f32 v102, v124, v125
v_cvt_pk_bf16_f32 v99, v122, v123
v_cvt_pk_bf16_f32 v103, v126, v127
s_nop 0
v_mfma_f32_16x16x32_bf16 v[64:67], v[88:91], v[96:99], v[64:67]
v_mfma_f32_16x16x32_bf16 v[68:71], v[88:91], v[100:103], v[68:71]
v_mfma_f32_16x16x32_bf16 v[20:23], v[88:91], a[80:83], v[20:23]
v_mfma_f32_16x16x32_bf16 v[72:75], v[92:95], v[96:99], v[72:75]
v_mfma_f32_16x16x32_bf16 v[76:79], v[92:95], v[100:103], v[76:79]
v_mfma_f32_16x16x32_bf16 v[24:27], v[92:95], a[80:83], v[24:27]
s_lshl_b32 s70, s60, 11
s_add_u32 s70, s70, 16384
v_add_u32 v2, s70, v16
v_xor_b32 v3, 4096, v2
v_lshrrev_b32 v4, 4, v1
v_lshlrev_b32 v5, 4, v4
v_lshlrev_b32 v4, 5, v4
s_lshl_b32 s70, s60, 6
s_add_u32 s70, s70, 163584
v_add_u32 v5, s70, v5
v_xor_b32 v6, 128, v5
s_lshl_b32 s72, s67, 1
s_add_u32 s72, s72, s66
s_lshl_b32 s72, s72, 10
s_add_u32 s72, s72, s87
s_lshl_b32 s73, s67, 7
s_lshl_b32 s70, s66, 4
s_add_u32 s73, s73, s70
s_add_u32 s73, s73, s87
s_add_u32 s73, s73, 4096
s_mov_b32 s92, 0x00010001
s_mov_b32 s93, 0x00010001
s_cmp_eq_u32 s66, 0
s_cbranch_scc0 L_ex1
ds_write_b128 v2, v[68:71]
ds_write_b128 v2, v[76:79] offset:1024
ds_write_b128 v5, v[24:27]
s_waitcnt lgkmcnt(0)
s_barrier
ds_read_b128 v[128:131], v3
ds_read_b128 v[132:135], v3 offset:1024
ds_read_b128 v[136:139], v6
s_waitcnt lgkmcnt(1)
v_pk_add_f32 v[128:129], v[128:129], v[64:65]
v_pk_add_f32 v[130:131], v[130:131], v[66:67]
v_pk_add_f32 v[132:133], v[132:133], v[72:73]
v_pk_add_f32 v[134:135], v[134:135], v[74:75]
s_waitcnt lgkmcnt(0)
v_pk_add_f32 v[136:137], v[136:137], v[20:21]
v_pk_add_f32 v[138:139], v[138:139], v[22:23]
L_ex_d:
v_cvt_pk_bf16_f32 v140, v128, v129
v_cvt_pk_bf16_f32 v141, v130, v131
v_cvt_pk_bf16_f32 v142, v132, v133
v_cvt_pk_bf16_f32 v143, v134, v135
s_cmp_eq_u32 s69, 0
s_cbranch_scc1 L_kvp_s
buffer_store_dwordx4 v[140:143], v16, s[12:15], s72 offen
s_mov_b64 exec, s[92:93]
buffer_store_dwordx4 v[136:139], v4, s[12:15], s73 offen
s_mov_b64 exec, -1
L_kvp_d:
v_and_b32 v2, 15, v1
v_lshlrev_b32 v2, 2, v2
s_lshl_b32 s70, s66, 8
s_add_u32 s70, s70, 159744
v_add_u32 v2, s70, v2
v_lshrrev_b32 v3, 4, v1
v_lshlrev_b32 v3, 4, v3
s_lshl_b32 s70, s67, 7
s_add_u32 s70, s70, 160768
v_add_u32 v5, s70, v3
ds_read_b32 v8, v2 offset:0
ds_read_b32 v12, v2 offset:512
ds_read_b32 v9, v2 offset:64
ds_read_b32 v13, v2 offset:576
ds_read_b32 v10, v2 offset:128
ds_read_b32 v14, v2 offset:640
ds_read_b32 v11, v2 offset:192
ds_read_b32 v15, v2 offset:704
ds_read_b128 v[144:147], v5 offset:0
ds_read_b128 v[148:151], v5 offset:64
s_lshl_b32 s70, s67, 11
s_add_u32 s70, s70, 24576
v_add_u32 v17, s70, v16
s_lshl_b32 s70, s67, 6
s_add_u32 s70, s70, 161600
v_add_u32 v18, s70, v3
s_waitcnt lgkmcnt(0)
v_pk_mul_f32 v[20:21], v[12:13], s[90:91]
v_pk_mul_f32 v[22:23], v[14:15], s[90:91]
v_pk_fma_f32 v[32:33], v[144:145], v[8:9], v[32:33] op_sel:[0,0,0] op_sel_hi:[1,0,1]
v_pk_fma_f32 v[36:37], v[148:149], v[8:9], v[36:37] op_sel:[0,0,0] op_sel_hi:[1,0,1]
v_pk_fma_f32 v[34:35], v[146:147], v[8:9], v[34:35] op_sel:[0,0,0] op_sel_hi:[1,0,1]
v_pk_fma_f32 v[38:39], v[150:151], v[8:9], v[38:39] op_sel:[0,0,0] op_sel_hi:[1,0,1]
v_pk_mul_f32 v[24:25], v[32:33], v[20:21] op_sel:[0,0] op_sel_hi:[1,0]
v_pk_mul_f32 v[28:29], v[36:37], v[20:21] op_sel:[0,0] op_sel_hi:[1,0]
v_pk_mul_f32 v[26:27], v[34:35], v[20:21] op_sel:[0,0] op_sel_hi:[1,0]
v_pk_mul_f32 v[30:31], v[38:39], v[20:21] op_sel:[0,0] op_sel_hi:[1,0]
v_pk_fma_f32 v[32:33], v[32:33], v[12:13], s[82:83] op_sel:[0,0,0] op_sel_hi:[1,0,1]
v_pk_fma_f32 v[36:37], v[36:37], v[12:13], s[82:83] op_sel:[0,0,0] op_sel_hi:[1,0,1]
v_pk_fma_f32 v[34:35], v[34:35], v[12:13], s[82:83] op_sel:[0,0,0] op_sel_hi:[1,0,1]
v_pk_fma_f32 v[38:39], v[38:39], v[12:13], s[82:83] op_sel:[0,0,0] op_sel_hi:[1,0,1]
v_exp_f32_e64 v24, v24 clamp
v_exp_f32_e64 v28, v28 clamp
v_exp_f32_e64 v25, v25 clamp
v_exp_f32_e64 v29, v29 clamp
v_exp_f32_e64 v26, v26 clamp
v_exp_f32_e64 v30, v30 clamp
v_exp_f32_e64 v27, v27 clamp
v_exp_f32_e64 v31, v31 clamp
v_pk_add_f32 v[24:25], v[24:25], s[80:81]
v_pk_add_f32 v[28:29], v[28:29], s[80:81]
v_pk_add_f32 v[26:27], v[26:27], s[80:81]
v_pk_add_f32 v[30:31], v[30:31], s[80:81]
v_max_f32 v32, v32, v24
v_max_f32 v36, v36, v28
v_max_f32 v33, v33, v25
v_max_f32 v37, v37, v29
v_max_f32 v34, v34, v26
v_max_f32 v38, v38, v30
v_max_f32 v35, v35, v27
v_max_f32 v39, v39, v31
v_cvt_pk_bf16_f32 v32, v32, v33
v_cvt_pk_bf16_f32 v34, v36, v37
v_cvt_pk_bf16_f32 v33, v34, v35
v_cvt_pk_bf16_f32 v35, v38, v39
v_pk_fma_f32 v[56:57], v[144:145], v[8:9], v[56:57] op_sel:[0,1,0] op_sel_hi:[1,1,1]
v_pk_fma_f32 v[60:61], v[148:149], v[8:9], v[60:61] op_sel:[0,1,0] op_sel_hi:[1,1,1]
v_pk_fma_f32 v[58:59], v[146:147], v[8:9], v[58:59] op_sel:[0,1,0] op_sel_hi:[1,1,1]
v_pk_fma_f32 v[62:63], v[150:151], v[8:9], v[62:63] op_sel:[0,1,0] op_sel_hi:[1,1,1]
v_pk_mul_f32 v[24:25], v[56:57], v[20:21] op_sel:[0,1] op_sel_hi:[1,1]
v_pk_mul_f32 v[28:29], v[60:61], v[20:21] op_sel:[0,1] op_sel_hi:[1,1]
v_pk_mul_f32 v[26:27], v[58:59], v[20:21] op_sel:[0,1] op_sel_hi:[1,1]
v_pk_mul_f32 v[30:31], v[62:63], v[20:21] op_sel:[0,1] op_sel_hi:[1,1]
v_pk_fma_f32 v[56:57], v[56:57], v[12:13], s[82:83] op_sel:[0,1,0] op_sel_hi:[1,1,1]
v_pk_fma_f32 v[60:61], v[60:61], v[12:13], s[82:83] op_sel:[0,1,0] op_sel_hi:[1,1,1]
v_pk_fma_f32 v[58:59], v[58:59], v[12:13], s[82:83] op_sel:[0,1,0] op_sel_hi:[1,1,1]
v_pk_fma_f32 v[62:63], v[62:63], v[12:13], s[82:83] op_sel:[0,1,0] op_sel_hi:[1,1,1]
v_exp_f32_e64 v24, v24 clamp
v_exp_f32_e64 v28, v28 clamp
v_exp_f32_e64 v25, v25 clamp
v_exp_f32_e64 v29, v29 clamp
v_exp_f32_e64 v26, v26 clamp
v_exp_f32_e64 v30, v30 clamp
v_exp_f32_e64 v27, v27 clamp
v_exp_f32_e64 v31, v31 clamp
v_pk_add_f32 v[24:25], v[24:25], s[80:81]
v_pk_add_f32 v[28:29], v[28:29], s[80:81]
v_pk_add_f32 v[26:27], v[26:27], s[80:81]
v_pk_add_f32 v[30:31], v[30:31], s[80:81]
v_max_f32 v56, v56, v24
v_max_f32 v60, v60, v28
v_max_f32 v57, v57, v25
v_max_f32 v61, v61, v29
v_max_f32 v58, v58, v26
v_max_f32 v62, v62, v30
v_max_f32 v59, v59, v27
v_max_f32 v63, v63, v31
v_cvt_pk_bf16_f32 v56, v56, v57
v_cvt_pk_bf16_f32 v58, v60, v61
v_cvt_pk_bf16_f32 v57, v58, v59
v_cvt_pk_bf16_f32 v59, v62, v63
v_pk_fma_f32 v[80:81], v[144:145], v[10:11], v[80:81] op_sel:[0,0,0] op_sel_hi:[1,0,1]
v_pk_fma_f32 v[84:85], v[148:149], v[10:11], v[84:85] op_sel:[0,0,0] op_sel_hi:[1,0,1]
v_pk_fma_f32 v[82:83], v[146:147], v[10:11], v[82:83] op_sel:[0,0,0] op_sel_hi:[1,0,1]
v_pk_fma_f32 v[86:87], v[150:151], v[10:11], v[86:87] op_sel:[0,0,0] op_sel_hi:[1,0,1]
v_pk_mul_f32 v[24:25], v[80:81], v[22:23] op_sel:[0,0] op_sel_hi:[1,0]
v_pk_mul_f32 v[28:29], v[84:85], v[22:23] op_sel:[0,0] op_sel_hi:[1,0]
v_pk_mul_f32 v[26:27], v[82:83], v[22:23] op_sel:[0,0] op_sel_hi:[1,0]
v_pk_mul_f32 v[30:31], v[86:87], v[22:23] op_sel:[0,0] op_sel_hi:[1,0]
v_pk_fma_f32 v[80:81], v[80:81], v[14:15], s[82:83] op_sel:[0,0,0] op_sel_hi:[1,0,1]
v_pk_fma_f32 v[84:85], v[84:85], v[14:15], s[82:83] op_sel:[0,0,0] op_sel_hi:[1,0,1]
v_pk_fma_f32 v[82:83], v[82:83], v[14:15], s[82:83] op_sel:[0,0,0] op_sel_hi:[1,0,1]
v_pk_fma_f32 v[86:87], v[86:87], v[14:15], s[82:83] op_sel:[0,0,0] op_sel_hi:[1,0,1]
v_exp_f32_e64 v24, v24 clamp
v_exp_f32_e64 v28, v28 clamp
v_exp_f32_e64 v25, v25 clamp
v_exp_f32_e64 v29, v29 clamp
v_exp_f32_e64 v26, v26 clamp
v_exp_f32_e64 v30, v30 clamp
v_exp_f32_e64 v27, v27 clamp
v_exp_f32_e64 v31, v31 clamp
v_pk_add_f32 v[24:25], v[24:25], s[80:81]
v_pk_add_f32 v[28:29], v[28:29], s[80:81]
v_pk_add_f32 v[26:27], v[26:27], s[80:81]
v_pk_add_f32 v[30:31], v[30:31], s[80:81]
v_max_f32 v80, v80, v24
v_max_f32 v84, v84, v28
v_max_f32 v81, v81, v25
v_max_f32 v85, v85, v29
v_max_f32 v82, v82, v26
v_max_f32 v86, v86, v30
v_max_f32 v83, v83, v27
v_max_f32 v87, v87, v31
v_cvt_pk_bf16_f32 v80, v80, v81
v_cvt_pk_bf16_f32 v82, v84, v85
v_cvt_pk_bf16_f32 v81, v82, v83
v_cvt_pk_bf16_f32 v83, v86, v87
v_pk_fma_f32 v[104:105], v[144:145], v[10:11], v[104:105] op_sel:[0,1,0] op_sel_hi:[1,1,1]
v_pk_fma_f32 v[108:109], v[148:149], v[10:11], v[108:109] op_sel:[0,1,0] op_sel_hi:[1,1,1]
v_pk_fma_f32 v[106:107], v[146:147], v[10:11], v[106:107] op_sel:[0,1,0] op_sel_hi:[1,1,1]
v_pk_fma_f32 v[110:111], v[150:151], v[10:11], v[110:111] op_sel:[0,1,0] op_sel_hi:[1,1,1]
v_pk_mul_f32 v[24:25], v[104:105], v[22:23] op_sel:[0,1] op_sel_hi:[1,1]
v_pk_mul_f32 v[28:29], v[108:109], v[22:23] op_sel:[0,1] op_sel_hi:[1,1]
v_pk_mul_f32 v[26:27], v[106:107], v[22:23] op_sel:[0,1] op_sel_hi:[1,1]
v_pk_mul_f32 v[30:31], v[110:111], v[22:23] op_sel:[0,1] op_sel_hi:[1,1]
v_pk_fma_f32 v[104:105], v[104:105], v[14:15], s[82:83] op_sel:[0,1,0] op_sel_hi:[1,1,1]
v_pk_fma_f32 v[108:109], v[108:109], v[14:15], s[82:83] op_sel:[0,1,0] op_sel_hi:[1,1,1]
v_pk_fma_f32 v[106:107], v[106:107], v[14:15], s[82:83] op_sel:[0,1,0] op_sel_hi:[1,1,1]
v_pk_fma_f32 v[110:111], v[110:111], v[14:15], s[82:83] op_sel:[0,1,0] op_sel_hi:[1,1,1]
v_exp_f32_e64 v24, v24 clamp
v_exp_f32_e64 v28, v28 clamp
v_exp_f32_e64 v25, v25 clamp
v_exp_f32_e64 v29, v29 clamp
v_exp_f32_e64 v26, v26 clamp
v_exp_f32_e64 v30, v30 clamp
v_exp_f32_e64 v27, v27 clamp
v_exp_f32_e64 v31, v31 clamp
v_pk_add_f32 v[24:25], v[24:25], s[80:81]
v_pk_add_f32 v[28:29], v[28:29], s[80:81]
v_pk_add_f32 v[26:27], v[26:27], s[80:81]
v_pk_add_f32 v[30:31], v[30:31], s[80:81]
v_max_f32 v104, v104, v24
v_max_f32 v108, v108, v28
v_max_f32 v105, v105, v25
v_max_f32 v109, v109, v29
v_max_f32 v106, v106, v26
v_max_f32 v110, v110, v30
v_max_f32 v107, v107, v27
v_max_f32 v111, v111, v31
v_cvt_pk_bf16_f32 v104, v104, v105
v_cvt_pk_bf16_f32 v106, v108, v109
v_cvt_pk_bf16_f32 v105, v106, v107
v_cvt_pk_bf16_f32 v107, v110, v111
v_lshrrev_b32 v2, 4, v1
v_bfe_u32 v3, v1, 2, 2
v_lshl_add_u32 v4, v2, 2, v3
v_lshlrev_b32 v5, 7, v4
v_bfe_u32 v4, v4, 1, 2
v_lshl_add_u32 v5, v4, 5, v5
v_and_b32 v4, 3, v1
v_lshl_add_u32 v5, v4, 3, v5
v_add_u32 v8, 28672, v5
v_xor_b32 v9, 32, v8
v_xor_b32 v10, 64, v8
v_xor_b32 v11, 96, v8
v_and_b32 v3, 15, v1
v_lshrrev_b32 v4, 1, v3
v_lshrrev_b32 v5, 1, v2
v_xor_b32 v4, v4, v5
v_lshlrev_b32 v4, 4, v4
v_lshl_add_u32 v4, v3, 7, v4
v_and_b32 v5, 1, v2
v_lshl_add_u32 v4, v5, 3, v4
s_lshl_b32 s70, s60, 12
v_add_u32 v20, s70, v4
v_xor_b32 v21, 32, v20
v_xor_b32 v22, 64, v20
v_xor_b32 v23, 96, v20
v_add_u32 v19, 32768, v16
s_lshl_b32 s74, s64, 18
s_lshl_b32 s70, s60, 16
s_add_u32 s74, s74, s70
s_add_u32 s74, s74, 2097152
s_barrier
ds_read_b128 a[0:3], v17
ds_read_b128 a[4:7], v17 offset:1024
ds_read_b128 a[8:11], v18
s_waitcnt lgkmcnt(0)
v_mfma_f32_16x16x32_bf16 v[48:51], a[8:11], v[32:35], 0
v_mfma_f32_16x16x32_bf16 v[40:43], a[0:3], v[32:35], 0
v_mfma_f32_16x16x32_bf16 v[44:47], a[4:7], v[32:35], 0
v_mfma_f32_16x16x32_bf16 v[72:75], a[8:11], v[56:59], 0
v_mfma_f32_16x16x32_bf16 v[64:67], a[0:3], v[56:59], 0
v_mfma_f32_16x16x32_bf16 v[68:71], a[4:7], v[56:59], 0
v_mfma_f32_16x16x32_bf16 v[96:99], a[8:11], v[80:83], 0
v_mfma_f32_16x16x32_bf16 v[88:91], a[0:3], v[80:83], 0
v_mfma_f32_16x16x32_bf16 v[92:95], a[4:7], v[80:83], 0
v_mfma_f32_16x16x32_bf16 v[120:123], a[8:11], v[104:107], 0
v_mfma_f32_16x16x32_bf16 v[112:115], a[0:3], v[104:107], 0
v_mfma_f32_16x16x32_bf16 v[116:119], a[4:7], v[104:107], 0
v_add_f32 v48, s80, v48
v_rcp_f32 v48, v48
s_nop 0
v_pk_mul_f32 v[40:41], v[40:41], v[48:49] op_sel_hi:[1,0]
v_pk_mul_f32 v[42:43], v[42:43], v[48:49] op_sel_hi:[1,0]
v_pk_mul_f32 v[44:45], v[44:45], v[48:49] op_sel_hi:[1,0]
v_pk_mul_f32 v[46:47], v[46:47], v[48:49] op_sel_hi:[1,0]
v_cvt_pk_bf16_f32 v52, v40, v41
v_cvt_pk_bf16_f32 v53, v42, v43
v_cvt_pk_bf16_f32 v54, v44, v45
v_cvt_pk_bf16_f32 v55, v46, v47
s_add_u32 s70, s88, 0
buffer_store_dwordx4 v[52:55], v16, s[12:15], s70 offen sc1
v_add_f32 v72, s80, v72
v_rcp_f32 v72, v72
s_nop 0
v_pk_mul_f32 v[64:65], v[64:65], v[72:73] op_sel_hi:[1,0]
v_pk_mul_f32 v[66:67], v[66:67], v[72:73] op_sel_hi:[1,0]
v_pk_mul_f32 v[68:69], v[68:69], v[72:73] op_sel_hi:[1,0]
v_pk_mul_f32 v[70:71], v[70:71], v[72:73] op_sel_hi:[1,0]
v_cvt_pk_bf16_f32 v76, v64, v65
v_cvt_pk_bf16_f32 v77, v66, v67
v_cvt_pk_bf16_f32 v78, v68, v69
v_cvt_pk_bf16_f32 v79, v70, v71
s_add_u32 s70, s88, 32768
buffer_store_dwordx4 v[76:79], v16, s[12:15], s70 offen sc1
v_add_f32 v96, s80, v96
v_rcp_f32 v96, v96
s_nop 0
v_pk_mul_f32 v[88:89], v[88:89], v[96:97] op_sel_hi:[1,0]
v_pk_mul_f32 v[90:91], v[90:91], v[96:97] op_sel_hi:[1,0]
v_pk_mul_f32 v[92:93], v[92:93], v[96:97] op_sel_hi:[1,0]
v_pk_mul_f32 v[94:95], v[94:95], v[96:97] op_sel_hi:[1,0]
v_cvt_pk_bf16_f32 v100, v88, v89
v_cvt_pk_bf16_f32 v101, v90, v91
v_cvt_pk_bf16_f32 v102, v92, v93
v_cvt_pk_bf16_f32 v103, v94, v95
s_add_u32 s70, s88, 65536
buffer_store_dwordx4 v[100:103], v16, s[12:15], s70 offen sc1
v_add_f32 v120, s80, v120
v_rcp_f32 v120, v120
s_nop 0
v_pk_mul_f32 v[112:113], v[112:113], v[120:121] op_sel_hi:[1,0]
v_pk_mul_f32 v[114:115], v[114:115], v[120:121] op_sel_hi:[1,0]
v_pk_mul_f32 v[116:117], v[116:117], v[120:121] op_sel_hi:[1,0]
v_pk_mul_f32 v[118:119], v[118:119], v[120:121] op_sel_hi:[1,0]
v_cvt_pk_bf16_f32 v124, v112, v113
v_cvt_pk_bf16_f32 v125, v114, v115
v_cvt_pk_bf16_f32 v126, v116, v117
v_cvt_pk_bf16_f32 v127, v118, v119
s_add_u32 s70, s88, 98304
buffer_store_dwordx4 v[124:127], v16, s[12:15], s70 offen sc1
s_add_u32 s70, s65, 0
s_and_b32 s70, s70, 15
s_lshl_b32 s70, s70, 11
s_add_u32 s70, s70, s74
buffer_load_dwordx4 v[56:59], v16, s[12:15], s70 offen offset:0 sc1
buffer_load_dwordx4 v[60:63], v19, s[12:15], s70 offen offset:0 sc1
buffer_load_dwordx4 v[64:67], v16, s[12:15], s70 offen offset:1024 sc1
buffer_load_dwordx4 v[68:71], v19, s[12:15], s70 offen offset:1024 sc1
s_add_u32 s70, s65, 1
s_and_b32 s70, s70, 15
s_lshl_b32 s70, s70, 11
s_add_u32 s70, s70, s74
buffer_load_dwordx4 v[72:75], v16, s[12:15], s70 offen offset:0 sc1
buffer_load_dwordx4 v[76:79], v19, s[12:15], s70 offen offset:0 sc1
buffer_load_dwordx4 v[80:83], v16, s[12:15], s70 offen offset:1024 sc1
buffer_load_dwordx4 v[84:87], v19, s[12:15], s70 offen offset:1024 sc1
s_add_u32 s70, s65, 2
s_and_b32 s70, s70, 15
s_lshl_b32 s70, s70, 11
s_add_u32 s70, s70, s74
buffer_load_dwordx4 v[88:91], v16, s[12:15], s70 offen offset:0 sc1
buffer_load_dwordx4 v[92:95], v19, s[12:15], s70 offen offset:0 sc1
buffer_load_dwordx4 v[96:99], v16, s[12:15], s70 offen offset:1024 sc1
buffer_load_dwordx4 v[100:103], v19, s[12:15], s70 offen offset:1024 sc1
s_add_u32 s70, s65, 3
s_and_b32 s70, s70, 15
s_lshl_b32 s70, s70, 11
s_add_u32 s70, s70, s74
buffer_load_dwordx4 v[104:107], v16, s[12:15], s70 offen offset:0 sc1
buffer_load_dwordx4 v[108:111], v19, s[12:15], s70 offen offset:0 sc1
buffer_load_dwordx4 v[112:115], v16, s[12:15], s70 offen offset:1024 sc1
buffer_load_dwordx4 v[116:119], v19, s[12:15], s70 offen offset:1024 sc1
s_add_u32 s70, s65, 4
s_and_b32 s70, s70, 15
s_lshl_b32 s70, s70, 11
s_add_u32 s70, s70, s74
buffer_load_dwordx4 v[120:123], v16, s[12:15], s70 offen offset:0 sc1
buffer_load_dwordx4 v[124:127], v19, s[12:15], s70 offen offset:0 sc1
buffer_load_dwordx4 v[128:131], v16, s[12:15], s70 offen offset:1024 sc1
buffer_load_dwordx4 v[132:135], v19, s[12:15], s70 offen offset:1024 sc1
s_add_u32 s70, s65, 5
s_and_b32 s70, s70, 15
s_lshl_b32 s70, s70, 11
s_add_u32 s70, s70, s74
buffer_load_dwordx4 v[136:139], v16, s[12:15], s70 offen offset:0 sc1
buffer_load_dwordx4 v[140:143], v19, s[12:15], s70 offen offset:0 sc1
buffer_load_dwordx4 v[144:147], v16, s[12:15], s70 offen offset:1024 sc1
buffer_load_dwordx4 v[148:151], v19, s[12:15], s70 offen offset:1024 sc1
ds_read_b64 v[26:27], v20 offset:0
ds_read_b64 v[30:31], v21 offset:0
ds_read_b64 v[34:35], v22 offset:0
ds_read_b64 v[38:39], v23 offset:0
ds_read_b64 v[42:43], v20 offset:2048
ds_read_b64 v[46:47], v21 offset:2048
ds_read_b64 v[50:51], v22 offset:2048
ds_read_b64 v[54:55], v23 offset:2048
s_add_u32 s71, s65, 0
s_and_b32 s71, s71, 15
s_lshl_b32 s71, s71, 13
v_add_u32 v12, s71, v8
v_add_u32 v13, s71, v9
v_add_u32 v14, s71, v10
v_add_u32 v15, s71, v11
s_waitcnt lgkmcnt(0)
ds_read_b64_tr_b16 a[0:1], v12 offset:0
ds_read_b64_tr_b16 a[2:3], v12 offset:2048
ds_read_b64_tr_b16 a[4:5], v13 offset:0
ds_read_b64_tr_b16 a[6:7], v13 offset:2048
ds_read_b64_tr_b16 a[8:9], v14 offset:0
ds_read_b64_tr_b16 a[10:11], v14 offset:2048
ds_read_b64_tr_b16 a[12:13], v15 offset:0
ds_read_b64_tr_b16 a[14:15], v15 offset:2048
v_lshlrev_b32 v24, 16, v26
v_and_b32 v25, 0xffff0000, v26
v_lshlrev_b32 v26, 16, v27
v_and_b32 v27, 0xffff0000, v27
v_lshlrev_b32 v28, 16, v30
v_and_b32 v29, 0xffff0000, v30
v_lshlrev_b32 v30, 16, v31
v_and_b32 v31, 0xffff0000, v31
v_lshlrev_b32 v32, 16, v34
v_and_b32 v33, 0xffff0000, v34
v_lshlrev_b32 v34, 16, v35
v_and_b32 v35, 0xffff0000, v35
v_lshlrev_b32 v36, 16, v38
v_and_b32 v37, 0xffff0000, v38
v_lshlrev_b32 v38, 16, v39
v_and_b32 v39, 0xffff0000, v39
v_lshlrev_b32 v40, 16, v42
v_and_b32 v41, 0xffff0000, v42
v_lshlrev_b32 v42, 16, v43
v_and_b32 v43, 0xffff0000, v43
v_lshlrev_b32 v44, 16, v46
v_and_b32 v45, 0xffff0000, v46
v_lshlrev_b32 v46, 16, v47
v_and_b32 v47, 0xffff0000, v47
v_lshlrev_b32 v48, 16, v50
v_and_b32 v49, 0xffff0000, v50
v_lshlrev_b32 v50, 16, v51
v_and_b32 v51, 0xffff0000, v51
v_lshlrev_b32 v52, 16, v54
v_and_b32 v53, 0xffff0000, v54
v_lshlrev_b32 v54, 16, v55
v_and_b32 v55, 0xffff0000, v55
s_waitcnt vmcnt(20)
L_o0_chk:
v_max3_u32 v2, v56, v60, v64
v_max_u32 v2, v2, v68
v_cmp_eq_u32 vcc, -1, v2
s_cbranch_vccnz L_o0_rt
L_o0_ok:
s_waitcnt lgkmcnt(0)
v_mfma_f32_16x16x32_bf16 v[24:27], a[0:3], v[56:59], v[24:27]
ds_read_b64_tr_b16 a[16:17], v12 offset:4096
v_mfma_f32_16x16x32_bf16 v[40:43], a[0:3], v[60:63], v[40:43]
ds_read_b64_tr_b16 a[18:19], v12 offset:6144
v_mfma_f32_16x16x32_bf16 v[28:31], a[4:7], v[56:59], v[28:31]
ds_read_b64_tr_b16 a[20:21], v13 offset:4096
v_mfma_f32_16x16x32_bf16 v[44:47], a[4:7], v[60:63], v[44:47]
ds_read_b64_tr_b16 a[22:23], v13 offset:6144
v_mfma_f32_16x16x32_bf16 v[32:35], a[8:11], v[56:59], v[32:35]
ds_read_b64_tr_b16 a[24:25], v14 offset:4096
v_mfma_f32_16x16x32_bf16 v[48:51], a[8:11], v[60:63], v[48:51]
ds_read_b64_tr_b16 a[26:27], v14 offset:6144
v_mfma_f32_16x16x32_bf16 v[36:39], a[12:15], v[56:59], v[36:39]
ds_read_b64_tr_b16 a[28:29], v15 offset:4096
v_mfma_f32_16x16x32_bf16 v[52:55], a[12:15], v[60:63], v[52:55]
ds_read_b64_tr_b16 a[30:31], v15 offset:6144
s_add_u32 s71, s65, 1
s_and_b32 s71, s71, 15
s_lshl_b32 s71, s71, 13
v_add_u32 v12, s71, v8
v_add_u32 v13, s71, v9
v_add_u32 v14, s71, v10
v_add_u32 v15, s71, v11
s_waitcnt lgkmcnt(0)
v_mfma_f32_16x16x32_bf16 v[24:27], a[16:19], v[64:67], v[24:27]
ds_read_b64_tr_b16 a[0:1], v12 offset:0
v_mfma_f32_16x16x32_bf16 v[40:43], a[16:19], v[68:71], v[40:43]
ds_read_b64_tr_b16 a[2:3], v12 offset:2048
v_mfma_f32_16x16x32_bf16 v[28:31], a[20:23], v[64:67], v[28:31]
ds_read_b64_tr_b16 a[4:5], v13 offset:0
v_mfma_f32_16x16x32_bf16 v[44:47], a[20:23], v[68:71], v[44:47]
ds_read_b64_tr_b16 a[6:7], v13 offset:2048
v_mfma_f32_16x16x32_bf16 v[32:35], a[24:27], v[64:67], v[32:35]
ds_read_b64_tr_b16 a[8:9], v14 offset:0
v_mfma_f32_16x16x32_bf16 v[48:51], a[24:27], v[68:71], v[48:51]
ds_read_b64_tr_b16 a[10:11], v14 offset:2048
v_mfma_f32_16x16x32_bf16 v[36:39], a[28:31], v[64:67], v[36:39]
ds_read_b64_tr_b16 a[12:13], v15 offset:0
v_mfma_f32_16x16x32_bf16 v[52:55], a[28:31], v[68:71], v[52:55]
ds_read_b64_tr_b16 a[14:15], v15 offset:2048
s_add_u32 s70, s65, 6
s_and_b32 s70, s70, 15
s_lshl_b32 s70, s70, 11
s_add_u32 s70, s70, s74
buffer_load_dwordx4 v[56:59], v16, s[12:15], s70 offen offset:0 sc1
buffer_load_dwordx4 v[60:63], v19, s[12:15], s70 offen offset:0 sc1
buffer_load_dwordx4 v[64:67], v16, s[12:15], s70 offen offset:1024 sc1
buffer_load_dwordx4 v[68:71], v19, s[12:15], s70 offen offset:1024 sc1
s_waitcnt vmcnt(20)
L_o1_chk:
v_max3_u32 v2, v72, v76, v80
v_max_u32 v2, v2, v84
v_cmp_eq_u32 vcc, -1, v2
s_cbranch_vccnz L_o1_rt
L_o1_ok:
s_waitcnt lgkmcnt(0)
v_mfma_f32_16x16x32_bf16 v[24:27], a[0:3], v[72:75], v[24:27]
ds_read_b64_tr_b16 a[16:17], v12 offset:4096
v_mfma_f32_16x16x32_bf16 v[40:43], a[0:3], v[76:79], v[40:43]
ds_read_b64_tr_b16 a[18:19], v12 offset:6144
v_mfma_f32_16x16x32_bf16 v[28:31], a[4:7], v[72:75], v[28:31]
ds_read_b64_tr_b16 a[20:21], v13 offset:4096
v_mfma_f32_16x16x32_bf16 v[44:47], a[4:7], v[76:79], v[44:47]
ds_read_b64_tr_b16 a[22:23], v13 offset:6144
v_mfma_f32_16x16x32_bf16 v[32:35], a[8:11], v[72:75], v[32:35]
ds_read_b64_tr_b16 a[24:25], v14 offset:4096
v_mfma_f32_16x16x32_bf16 v[48:51], a[8:11], v[76:79], v[48:51]
ds_read_b64_tr_b16 a[26:27], v14 offset:6144
v_mfma_f32_16x16x32_bf16 v[36:39], a[12:15], v[72:75], v[36:39]
ds_read_b64_tr_b16 a[28:29], v15 offset:4096
v_mfma_f32_16x16x32_bf16 v[52:55], a[12:15], v[76:79], v[52:55]
ds_read_b64_tr_b16 a[30:31], v15 offset:6144
s_add_u32 s71, s65, 2
s_and_b32 s71, s71, 15
s_lshl_b32 s71, s71, 13
v_add_u32 v12, s71, v8
v_add_u32 v13, s71, v9
v_add_u32 v14, s71, v10
v_add_u32 v15, s71, v11
s_waitcnt lgkmcnt(0)
v_mfma_f32_16x16x32_bf16 v[24:27], a[16:19], v[80:83], v[24:27]
ds_read_b64_tr_b16 a[0:1], v12 offset:0
v_mfma_f32_16x16x32_bf16 v[40:43], a[16:19], v[84:87], v[40:43]
ds_read_b64_tr_b16 a[2:3], v12 offset:2048
v_mfma_f32_16x16x32_bf16 v[28:31], a[20:23], v[80:83], v[28:31]
ds_read_b64_tr_b16 a[4:5], v13 offset:0
v_mfma_f32_16x16x32_bf16 v[44:47], a[20:23], v[84:87], v[44:47]
ds_read_b64_tr_b16 a[6:7], v13 offset:2048
v_mfma_f32_16x16x32_bf16 v[32:35], a[24:27], v[80:83], v[32:35]
ds_read_b64_tr_b16 a[8:9], v14 offset:0
v_mfma_f32_16x16x32_bf16 v[48:51], a[24:27], v[84:87], v[48:51]
ds_read_b64_tr_b16 a[10:11], v14 offset:2048
v_mfma_f32_16x16x32_bf16 v[36:39], a[28:31], v[80:83], v[36:39]
ds_read_b64_tr_b16 a[12:13], v15 offset:0
v_mfma_f32_16x16x32_bf16 v[52:55], a[28:31], v[84:87], v[52:55]
ds_read_b64_tr_b16 a[14:15], v15 offset:2048
s_add_u32 s70, s65, 7
s_and_b32 s70, s70, 15
s_lshl_b32 s70, s70, 11
s_add_u32 s70, s70, s74
buffer_load_dwordx4 v[72:75], v16, s[12:15], s70 offen offset:0 sc1
buffer_load_dwordx4 v[76:79], v19, s[12:15], s70 offen offset:0 sc1
buffer_load_dwordx4 v[80:83], v16, s[12:15], s70 offen offset:1024 sc1
buffer_load_dwordx4 v[84:87], v19, s[12:15], s70 offen offset:1024 sc1
s_waitcnt vmcnt(20)
L_o2_chk:
v_max3_u32 v2, v88, v92, v96
v_max_u32 v2, v2, v100
v_cmp_eq_u32 vcc, -1, v2
s_cbranch_vccnz L_o2_rt
L_o2_ok:
s_waitcnt lgkmcnt(0)
v_mfma_f32_16x16x32_bf16 v[24:27], a[0:3], v[88:91], v[24:27]
ds_read_b64_tr_b16 a[16:17], v12 offset:4096
v_mfma_f32_16x16x32_bf16 v[40:43], a[0:3], v[92:95], v[40:43]
ds_read_b64_tr_b16 a[18:19], v12 offset:6144
v_mfma_f32_16x16x32_bf16 v[28:31], a[4:7], v[88:91], v[28:31]
ds_read_b64_tr_b16 a[20:21], v13 offset:4096
v_mfma_f32_16x16x32_bf16 v[44:47], a[4:7], v[92:95], v[44:47]
ds_read_b64_tr_b16 a[22:23], v13 offset:6144
v_mfma_f32_16x16x32_bf16 v[32:35], a[8:11], v[88:91], v[32:35]
ds_read_b64_tr_b16 a[24:25], v14 offset:4096
v_mfma_f32_16x16x32_bf16 v[48:51], a[8:11], v[92:95], v[48:51]
ds_read_b64_tr_b16 a[26:27], v14 offset:6144
v_mfma_f32_16x16x32_bf16 v[36:39], a[12:15], v[88:91], v[36:39]
ds_read_b64_tr_b16 a[28:29], v15 offset:4096
v_mfma_f32_16x16x32_bf16 v[52:55], a[12:15], v[92:95], v[52:55]
ds_read_b64_tr_b16 a[30:31], v15 offset:6144
s_add_u32 s71, s65, 3
s_and_b32 s71, s71, 15
s_lshl_b32 s71, s71, 13
v_add_u32 v12, s71, v8
v_add_u32 v13, s71, v9
v_add_u32 v14, s71, v10
v_add_u32 v15, s71, v11
s_waitcnt lgkmcnt(0)
v_mfma_f32_16x16x32_bf16 v[24:27], a[16:19], v[96:99], v[24:27]
ds_read_b64_tr_b16 a[0:1], v12 offset:0
v_mfma_f32_16x16x32_bf16 v[40:43], a[16:19], v[100:103], v[40:43]
ds_read_b64_tr_b16 a[2:3], v12 offset:2048
v_mfma_f32_16x16x32_bf16 v[28:31], a[20:23], v[96:99], v[28:31]
ds_read_b64_tr_b16 a[4:5], v13 offset:0
v_mfma_f32_16x16x32_bf16 v[44:47], a[20:23], v[100:103], v[44:47]
ds_read_b64_tr_b16 a[6:7], v13 offset:2048
v_mfma_f32_16x16x32_bf16 v[32:35], a[24:27], v[96:99], v[32:35]
ds_read_b64_tr_b16 a[8:9], v14 offset:0
v_mfma_f32_16x16x32_bf16 v[48:51], a[24:27], v[100:103], v[48:51]
ds_read_b64_tr_b16 a[10:11], v14 offset:2048
v_mfma_f32_16x16x32_bf16 v[36:39], a[28:31], v[96:99], v[36:39]
ds_read_b64_tr_b16 a[12:13], v15 offset:0
v_mfma_f32_16x16x32_bf16 v[52:55], a[28:31], v[100:103], v[52:55]
ds_read_b64_tr_b16 a[14:15], v15 offset:2048
s_add_u32 s70, s65, 8
s_and_b32 s70, s70, 15
s_lshl_b32 s70, s70, 11
s_add_u32 s70, s70, s74
buffer_load_dwordx4 v[88:91], v16, s[12:15], s70 offen offset:0 sc1
buffer_load_dwordx4 v[92:95], v19, s[12:15], s70 offen offset:0 sc1
buffer_load_dwordx4 v[96:99], v16, s[12:15], s70 offen offset:1024 sc1
buffer_load_dwordx4 v[100:103], v19, s[12:15], s70 offen offset:1024 sc1
s_waitcnt vmcnt(20)
L_o3_chk:
v_max3_u32 v2, v104, v108, v112
v_max_u32 v2, v2, v116
v_cmp_eq_u32 vcc, -1, v2
s_cbranch_vccnz L_o3_rt
L_o3_ok:
s_waitcnt lgkmcnt(0)
v_mfma_f32_16x16x32_bf16 v[24:27], a[0:3], v[104:107], v[24:27]
ds_read_b64_tr_b16 a[16:17], v12 offset:4096
v_mfma_f32_16x16x32_bf16 v[40:43], a[0:3], v[108:111], v[40:43]
ds_read_b64_tr_b16 a[18:19], v12 offset:6144
v_mfma_f32_16x16x32_bf16 v[28:31], a[4:7], v[104:107], v[28:31]
ds_read_b64_tr_b16 a[20:21], v13 offset:4096
v_mfma_f32_16x16x32_bf16 v[44:47], a[4:7], v[108:111], v[44:47]
ds_read_b64_tr_b16 a[22:23], v13 offset:6144
v_mfma_f32_16x16x32_bf16 v[32:35], a[8:11], v[104:107], v[32:35]
ds_read_b64_tr_b16 a[24:25], v14 offset:4096
v_mfma_f32_16x16x32_bf16 v[48:51], a[8:11], v[108:111], v[48:51]
ds_read_b64_tr_b16 a[26:27], v14 offset:6144
v_mfma_f32_16x16x32_bf16 v[36:39], a[12:15], v[104:107], v[36:39]
ds_read_b64_tr_b16 a[28:29], v15 offset:4096
v_mfma_f32_16x16x32_bf16 v[52:55], a[12:15], v[108:111], v[52:55]
ds_read_b64_tr_b16 a[30:31], v15 offset:6144
s_add_u32 s71, s65, 4
s_and_b32 s71, s71, 15
s_lshl_b32 s71, s71, 13
v_add_u32 v12, s71, v8
v_add_u32 v13, s71, v9
v_add_u32 v14, s71, v10
v_add_u32 v15, s71, v11
s_waitcnt lgkmcnt(0)
v_mfma_f32_16x16x32_bf16 v[24:27], a[16:19], v[112:115], v[24:27]
ds_read_b64_tr_b16 a[0:1], v12 offset:0
v_mfma_f32_16x16x32_bf16 v[40:43], a[16:19], v[116:119], v[40:43]
ds_read_b64_tr_b16 a[2:3], v12 offset:2048
v_mfma_f32_16x16x32_bf16 v[28:31], a[20:23], v[112:115], v[28:31]
ds_read_b64_tr_b16 a[4:5], v13 offset:0
v_mfma_f32_16x16x32_bf16 v[44:47], a[20:23], v[116:119], v[44:47]
ds_read_b64_tr_b16 a[6:7], v13 offset:2048
v_mfma_f32_16x16x32_bf16 v[32:35], a[24:27], v[112:115], v[32:35]
ds_read_b64_tr_b16 a[8:9], v14 offset:0
v_mfma_f32_16x16x32_bf16 v[48:51], a[24:27], v[116:119], v[48:51]
ds_read_b64_tr_b16 a[10:11], v14 offset:2048
v_mfma_f32_16x16x32_bf16 v[36:39], a[28:31], v[112:115], v[36:39]
ds_read_b64_tr_b16 a[12:13], v15 offset:0
v_mfma_f32_16x16x32_bf16 v[52:55], a[28:31], v[116:119], v[52:55]
ds_read_b64_tr_b16 a[14:15], v15 offset:2048
s_add_u32 s70, s65, 9
s_and_b32 s70, s70, 15
s_lshl_b32 s70, s70, 11
s_add_u32 s70, s70, s74
buffer_load_dwordx4 v[104:107], v16, s[12:15], s70 offen offset:0 sc1
buffer_load_dwordx4 v[108:111], v19, s[12:15], s70 offen offset:0 sc1
buffer_load_dwordx4 v[112:115], v16, s[12:15], s70 offen offset:1024 sc1
buffer_load_dwordx4 v[116:119], v19, s[12:15], s70 offen offset:1024 sc1
s_waitcnt vmcnt(20)
L_o4_chk:
v_max3_u32 v2, v120, v124, v128
v_max_u32 v2, v2, v132
v_cmp_eq_u32 vcc, -1, v2
s_cbranch_vccnz L_o4_rt
L_o4_ok:
s_waitcnt lgkmcnt(0)
v_mfma_f32_16x16x32_bf16 v[24:27], a[0:3], v[120:123], v[24:27]
ds_read_b64_tr_b16 a[16:17], v12 offset:4096
v_mfma_f32_16x16x32_bf16 v[40:43], a[0:3], v[124:127], v[40:43]
ds_read_b64_tr_b16 a[18:19], v12 offset:6144
v_mfma_f32_16x16x32_bf16 v[28:31], a[4:7], v[120:123], v[28:31]
ds_read_b64_tr_b16 a[20:21], v13 offset:4096
v_mfma_f32_16x16x32_bf16 v[44:47], a[4:7], v[124:127], v[44:47]
ds_read_b64_tr_b16 a[22:23], v13 offset:6144
v_mfma_f32_16x16x32_bf16 v[32:35], a[8:11], v[120:123], v[32:35]
ds_read_b64_tr_b16 a[24:25], v14 offset:4096
v_mfma_f32_16x16x32_bf16 v[48:51], a[8:11], v[124:127], v[48:51]
ds_read_b64_tr_b16 a[26:27], v14 offset:6144
v_mfma_f32_16x16x32_bf16 v[36:39], a[12:15], v[120:123], v[36:39]
ds_read_b64_tr_b16 a[28:29], v15 offset:4096
v_mfma_f32_16x16x32_bf16 v[52:55], a[12:15], v[124:127], v[52:55]
ds_read_b64_tr_b16 a[30:31], v15 offset:6144
s_add_u32 s71, s65, 5
s_and_b32 s71, s71, 15
s_lshl_b32 s71, s71, 13
v_add_u32 v12, s71, v8
v_add_u32 v13, s71, v9
v_add_u32 v14, s71, v10
v_add_u32 v15, s71, v11
s_waitcnt lgkmcnt(0)
v_mfma_f32_16x16x32_bf16 v[24:27], a[16:19], v[128:131], v[24:27]
ds_read_b64_tr_b16 a[0:1], v12 offset:0
v_mfma_f32_16x16x32_bf16 v[40:43], a[16:19], v[132:135], v[40:43]
ds_read_b64_tr_b16 a[2:3], v12 offset:2048
v_mfma_f32_16x16x32_bf16 v[28:31], a[20:23], v[128:131], v[28:31]
ds_read_b64_tr_b16 a[4:5], v13 offset:0
v_mfma_f32_16x16x32_bf16 v[44:47], a[20:23], v[132:135], v[44:47]
ds_read_b64_tr_b16 a[6:7], v13 offset:2048
v_mfma_f32_16x16x32_bf16 v[32:35], a[24:27], v[128:131], v[32:35]
ds_read_b64_tr_b16 a[8:9], v14 offset:0
v_mfma_f32_16x16x32_bf16 v[48:51], a[24:27], v[132:135], v[48:51]
ds_read_b64_tr_b16 a[10:11], v14 offset:2048
v_mfma_f32_16x16x32_bf16 v[36:39], a[28:31], v[128:131], v[36:39]
ds_read_b64_tr_b16 a[12:13], v15 offset:0
v_mfma_f32_16x16x32_bf16 v[52:55], a[28:31], v[132:135], v[52:55]
ds_read_b64_tr_b16 a[14:15], v15 offset:2048
s_add_u32 s70, s65, 10
s_and_b32 s70, s70, 15
s_lshl_b32 s70, s70, 11
s_add_u32 s70, s70, s74
buffer_load_dwordx4 v[120:123], v16, s[12:15], s70 offen offset:0 sc1
buffer_load_dwordx4 v[124:127], v19, s[12:15], s70 offen offset:0 sc1
buffer_load_dwordx4 v[128:131], v16, s[12:15], s70 offen offset:1024 sc1
buffer_load_dwordx4 v[132:135], v19, s[12:15], s70 offen offset:1024 sc1
s_waitcnt vmcnt(20)
L_o5_chk:
v_max3_u32 v2, v136, v140, v144
v_max_u32 v2, v2, v148
v_cmp_eq_u32 vcc, -1, v2
s_cbranch_vccnz L_o5_rt
L_o5_ok:
s_waitcnt lgkmcnt(0)
v_mfma_f32_16x16x32_bf16 v[24:27], a[0:3], v[136:139], v[24:27]
ds_read_b64_tr_b16 a[16:17], v12 offset:4096
v_mfma_f32_16x16x32_bf16 v[40:43], a[0:3], v[140:143], v[40:43]
ds_read_b64_tr_b16 a[18:19], v12 offset:6144
v_mfma_f32_16x16x32_bf16 v[28:31], a[4:7], v[136:139], v[28:31]
ds_read_b64_tr_b16 a[20:21], v13 offset:4096
v_mfma_f32_16x16x32_bf16 v[44:47], a[4:7], v[140:143], v[44:47]
ds_read_b64_tr_b16 a[22:23], v13 offset:6144
v_mfma_f32_16x16x32_bf16 v[32:35], a[8:11], v[136:139], v[32:35]
ds_read_b64_tr_b16 a[24:25], v14 offset:4096
v_mfma_f32_16x16x32_bf16 v[48:51], a[8:11], v[140:143], v[48:51]
ds_read_b64_tr_b16 a[26:27], v14 offset:6144
v_mfma_f32_16x16x32_bf16 v[36:39], a[12:15], v[136:139], v[36:39]
ds_read_b64_tr_b16 a[28:29], v15 offset:4096
v_mfma_f32_16x16x32_bf16 v[52:55], a[12:15], v[140:143], v[52:55]
ds_read_b64_tr_b16 a[30:31], v15 offset:6144
s_add_u32 s71, s65, 6
s_and_b32 s71, s71, 15
s_lshl_b32 s71, s71, 13
v_add_u32 v12, s71, v8
v_add_u32 v13, s71, v9
v_add_u32 v14, s71, v10
v_add_u32 v15, s71, v11
s_waitcnt lgkmcnt(0)
v_mfma_f32_16x16x32_bf16 v[24:27], a[16:19], v[144:147], v[24:27]
ds_read_b64_tr_b16 a[0:1], v12 offset:0
v_mfma_f32_16x16x32_bf16 v[40:43], a[16:19], v[148:151], v[40:43]
ds_read_b64_tr_b16 a[2:3], v12 offset:2048
v_mfma_f32_16x16x32_bf16 v[28:31], a[20:23], v[144:147], v[28:31]
ds_read_b64_tr_b16 a[4:5], v13 offset:0
v_mfma_f32_16x16x32_bf16 v[44:47], a[20:23], v[148:151], v[44:47]
ds_read_b64_tr_b16 a[6:7], v13 offset:2048
v_mfma_f32_16x16x32_bf16 v[32:35], a[24:27], v[144:147], v[32:35]
ds_read_b64_tr_b16 a[8:9], v14 offset:0
v_mfma_f32_16x16x32_bf16 v[48:51], a[24:27], v[148:151], v[48:51]
ds_read_b64_tr_b16 a[10:11], v14 offset:2048
v_mfma_f32_16x16x32_bf16 v[36:39], a[28:31], v[144:147], v[36:39]
ds_read_b64_tr_b16 a[12:13], v15 offset:0
v_mfma_f32_16x16x32_bf16 v[52:55], a[28:31], v[148:151], v[52:55]
ds_read_b64_tr_b16 a[14:15], v15 offset:2048
s_add_u32 s70, s65, 11
s_and_b32 s70, s70, 15
s_lshl_b32 s70, s70, 11
s_add_u32 s70, s70, s74
buffer_load_dwordx4 v[136:139], v16, s[12:15], s70 offen offset:0 sc1
buffer_load_dwordx4 v[140:143], v19, s[12:15], s70 offen offset:0 sc1
buffer_load_dwordx4 v[144:147], v16, s[12:15], s70 offen offset:1024 sc1
buffer_load_dwordx4 v[148:151], v19, s[12:15], s70 offen offset:1024 sc1
s_waitcnt vmcnt(20)
L_o6_chk:
v_max3_u32 v2, v56, v60, v64
v_max_u32 v2, v2, v68
v_cmp_eq_u32 vcc, -1, v2
s_cbranch_vccnz L_o6_rt
L_o6_ok:
s_waitcnt lgkmcnt(0)
v_mfma_f32_16x16x32_bf16 v[24:27], a[0:3], v[56:59], v[24:27]
ds_read_b64_tr_b16 a[16:17], v12 offset:4096
v_mfma_f32_16x16x32_bf16 v[40:43], a[0:3], v[60:63], v[40:43]
ds_read_b64_tr_b16 a[18:19], v12 offset:6144
v_mfma_f32_16x16x32_bf16 v[28:31], a[4:7], v[56:59], v[28:31]
ds_read_b64_tr_b16 a[20:21], v13 offset:4096
v_mfma_f32_16x16x32_bf16 v[44:47], a[4:7], v[60:63], v[44:47]
ds_read_b64_tr_b16 a[22:23], v13 offset:6144
v_mfma_f32_16x16x32_bf16 v[32:35], a[8:11], v[56:59], v[32:35]
ds_read_b64_tr_b16 a[24:25], v14 offset:4096
v_mfma_f32_16x16x32_bf16 v[48:51], a[8:11], v[60:63], v[48:51]
ds_read_b64_tr_b16 a[26:27], v14 offset:6144
v_mfma_f32_16x16x32_bf16 v[36:39], a[12:15], v[56:59], v[36:39]
ds_read_b64_tr_b16 a[28:29], v15 offset:4096
v_mfma_f32_16x16x32_bf16 v[52:55], a[12:15], v[60:63], v[52:55]
ds_read_b64_tr_b16 a[30:31], v15 offset:6144
s_add_u32 s71, s65, 7
s_and_b32 s71, s71, 15
s_lshl_b32 s71, s71, 13
v_add_u32 v12, s71, v8
v_add_u32 v13, s71, v9
v_add_u32 v14, s71, v10
v_add_u32 v15, s71, v11
s_waitcnt lgkmcnt(0)
v_mfma_f32_16x16x32_bf16 v[24:27], a[16:19], v[64:67], v[24:27]
ds_read_b64_tr_b16 a[0:1], v12 offset:0
v_mfma_f32_16x16x32_bf16 v[40:43], a[16:19], v[68:71], v[40:43]
ds_read_b64_tr_b16 a[2:3], v12 offset:2048
v_mfma_f32_16x16x32_bf16 v[28:31], a[20:23], v[64:67], v[28:31]
ds_read_b64_tr_b16 a[4:5], v13 offset:0
v_mfma_f32_16x16x32_bf16 v[44:47], a[20:23], v[68:71], v[44:47]
ds_read_b64_tr_b16 a[6:7], v13 offset:2048
v_mfma_f32_16x16x32_bf16 v[32:35], a[24:27], v[64:67], v[32:35]
ds_read_b64_tr_b16 a[8:9], v14 offset:0
v_mfma_f32_16x16x32_bf16 v[48:51], a[24:27], v[68:71], v[48:51]
ds_read_b64_tr_b16 a[10:11], v14 offset:2048
v_mfma_f32_16x16x32_bf16 v[36:39], a[28:31], v[64:67], v[36:39]
ds_read_b64_tr_b16 a[12:13], v15 offset:0
v_mfma_f32_16x16x32_bf16 v[52:55], a[28:31], v[68:71], v[52:55]
ds_read_b64_tr_b16 a[14:15], v15 offset:2048
s_add_u32 s70, s65, 12
s_and_b32 s70, s70, 15
s_lshl_b32 s70, s70, 11
s_add_u32 s70, s70, s74
buffer_load_dwordx4 v[56:59], v16, s[12:15], s70 offen offset:0 sc1
buffer_load_dwordx4 v[60:63], v19, s[12:15], s70 offen offset:0 sc1
buffer_load_dwordx4 v[64:67], v16, s[12:15], s70 offen offset:1024 sc1
buffer_load_dwordx4 v[68:71], v19, s[12:15], s70 offen offset:1024 sc1
s_waitcnt vmcnt(20)
L_o7_chk:
v_max3_u32 v2, v72, v76, v80
v_max_u32 v2, v2, v84
v_cmp_eq_u32 vcc, -1, v2
s_cbranch_vccnz L_o7_rt
L_o7_ok:
s_waitcnt lgkmcnt(0)
v_mfma_f32_16x16x32_bf16 v[24:27], a[0:3], v[72:75], v[24:27]
ds_read_b64_tr_b16 a[16:17], v12 offset:4096
v_mfma_f32_16x16x32_bf16 v[40:43], a[0:3], v[76:79], v[40:43]
ds_read_b64_tr_b16 a[18:19], v12 offset:6144
v_mfma_f32_16x16x32_bf16 v[28:31], a[4:7], v[72:75], v[28:31]
ds_read_b64_tr_b16 a[20:21], v13 offset:4096
v_mfma_f32_16x16x32_bf16 v[44:47], a[4:7], v[76:79], v[44:47]
ds_read_b64_tr_b16 a[22:23], v13 offset:6144
v_mfma_f32_16x16x32_bf16 v[32:35], a[8:11], v[72:75], v[32:35]
ds_read_b64_tr_b16 a[24:25], v14 offset:4096
v_mfma_f32_16x16x32_bf16 v[48:51], a[8:11], v[76:79], v[48:51]
ds_read_b64_tr_b16 a[26:27], v14 offset:6144
v_mfma_f32_16x16x32_bf16 v[36:39], a[12:15], v[72:75], v[36:39]
ds_read_b64_tr_b16 a[28:29], v15 offset:4096
v_mfma_f32_16x16x32_bf16 v[52:55], a[12:15], v[76:79], v[52:55]
ds_read_b64_tr_b16 a[30:31], v15 offset:6144
s_add_u32 s71, s65, 8
s_and_b32 s71, s71, 15
s_lshl_b32 s71, s71, 13
v_add_u32 v12, s71, v8
v_add_u32 v13, s71, v9
v_add_u32 v14, s71, v10
v_add_u32 v15, s71, v11
s_waitcnt lgkmcnt(0)
v_mfma_f32_16x16x32_bf16 v[24:27], a[16:19], v[80:83], v[24:27]
ds_read_b64_tr_b16 a[0:1], v12 offset:0
v_mfma_f32_16x16x32_bf16 v[40:43], a[16:19], v[84:87], v[40:43]
ds_read_b64_tr_b16 a[2:3], v12 offset:2048
v_mfma_f32_16x16x32_bf16 v[28:31], a[20:23], v[80:83], v[28:31]
ds_read_b64_tr_b16 a[4:5], v13 offset:0
v_mfma_f32_16x16x32_bf16 v[44:47], a[20:23], v[84:87], v[44:47]
ds_read_b64_tr_b16 a[6:7], v13 offset:2048
v_mfma_f32_16x16x32_bf16 v[32:35], a[24:27], v[80:83], v[32:35]
ds_read_b64_tr_b16 a[8:9], v14 offset:0
v_mfma_f32_16x16x32_bf16 v[48:51], a[24:27], v[84:87], v[48:51]
ds_read_b64_tr_b16 a[10:11], v14 offset:2048
v_mfma_f32_16x16x32_bf16 v[36:39], a[28:31], v[80:83], v[36:39]
ds_read_b64_tr_b16 a[12:13], v15 offset:0
v_mfma_f32_16x16x32_bf16 v[52:55], a[28:31], v[84:87], v[52:55]
ds_read_b64_tr_b16 a[14:15], v15 offset:2048
s_add_u32 s70, s65, 13
s_and_b32 s70, s70, 15
s_lshl_b32 s70, s70, 11
s_add_u32 s70, s70, s74
buffer_load_dwordx4 v[72:75], v16, s[12:15], s70 offen offset:0 sc1
buffer_load_dwordx4 v[76:79], v19, s[12:15], s70 offen offset:0 sc1
buffer_load_dwordx4 v[80:83], v16, s[12:15], s70 offen offset:1024 sc1
buffer_load_dwordx4 v[84:87], v19, s[12:15], s70 offen offset:1024 sc1
s_waitcnt vmcnt(20)
L_o8_chk:
v_max3_u32 v2, v88, v92, v96
v_max_u32 v2, v2, v100
v_cmp_eq_u32 vcc, -1, v2
s_cbranch_vccnz L_o8_rt
L_o8_ok:
s_waitcnt lgkmcnt(0)
v_mfma_f32_16x16x32_bf16 v[24:27], a[0:3], v[88:91], v[24:27]
ds_read_b64_tr_b16 a[16:17], v12 offset:4096
v_mfma_f32_16x16x32_bf16 v[40:43], a[0:3], v[92:95], v[40:43]
ds_read_b64_tr_b16 a[18:19], v12 offset:6144
v_mfma_f32_16x16x32_bf16 v[28:31], a[4:7], v[88:91], v[28:31]
ds_read_b64_tr_b16 a[20:21], v13 offset:4096
v_mfma_f32_16x16x32_bf16 v[44:47], a[4:7], v[92:95], v[44:47]
ds_read_b64_tr_b16 a[22:23], v13 offset:6144
v_mfma_f32_16x16x32_bf16 v[32:35], a[8:11], v[88:91], v[32:35]
ds_read_b64_tr_b16 a[24:25], v14 offset:4096
v_mfma_f32_16x16x32_bf16 v[48:51], a[8:11], v[92:95], v[48:51]
ds_read_b64_tr_b16 a[26:27], v14 offset:6144
v_mfma_f32_16x16x32_bf16 v[36:39], a[12:15], v[88:91], v[36:39]
ds_read_b64_tr_b16 a[28:29], v15 offset:4096
v_mfma_f32_16x16x32_bf16 v[52:55], a[12:15], v[92:95], v[52:55]
ds_read_b64_tr_b16 a[30:31], v15 offset:6144
s_add_u32 s71, s65, 9
s_and_b32 s71, s71, 15
s_lshl_b32 s71, s71, 13
v_add_u32 v12, s71, v8
v_add_u32 v13, s71, v9
v_add_u32 v14, s71, v10
v_add_u32 v15, s71, v11
s_waitcnt lgkmcnt(0)
v_mfma_f32_16x16x32_bf16 v[24:27], a[16:19], v[96:99], v[24:27]
ds_read_b64_tr_b16 a[0:1], v12 offset:0
v_mfma_f32_16x16x32_bf16 v[40:43], a[16:19], v[100:103], v[40:43]
ds_read_b64_tr_b16 a[2:3], v12 offset:2048
v_mfma_f32_16x16x32_bf16 v[28:31], a[20:23], v[96:99], v[28:31]
ds_read_b64_tr_b16 a[4:5], v13 offset:0
v_mfma_f32_16x16x32_bf16 v[44:47], a[20:23], v[100:103], v[44:47]
ds_read_b64_tr_b16 a[6:7], v13 offset:2048
v_mfma_f32_16x16x32_bf16 v[32:35], a[24:27], v[96:99], v[32:35]
ds_read_b64_tr_b16 a[8:9], v14 offset:0
v_mfma_f32_16x16x32_bf16 v[48:51], a[24:27], v[100:103], v[48:51]
ds_read_b64_tr_b16 a[10:11], v14 offset:2048
v_mfma_f32_16x16x32_bf16 v[36:39], a[28:31], v[96:99], v[36:39]
ds_read_b64_tr_b16 a[12:13], v15 offset:0
v_mfma_f32_16x16x32_bf16 v[52:55], a[28:31], v[100:103], v[52:55]
ds_read_b64_tr_b16 a[14:15], v15 offset:2048
s_add_u32 s70, s65, 14
s_and_b32 s70, s70, 15
s_lshl_b32 s70, s70, 11
s_add_u32 s70, s70, s74
buffer_load_dwordx4 v[88:91], v16, s[12:15], s70 offen offset:0 sc1
buffer_load_dwordx4 v[92:95], v19, s[12:15], s70 offen offset:0 sc1
buffer_load_dwordx4 v[96:99], v16, s[12:15], s70 offen offset:1024 sc1
buffer_load_dwordx4 v[100:103], v19, s[12:15], s70 offen offset:1024 sc1
s_waitcnt vmcnt(20)
L_o9_chk:
v_max3_u32 v2, v104, v108, v112
v_max_u32 v2, v2, v116
v_cmp_eq_u32 vcc, -1, v2
s_cbranch_vccnz L_o9_rt
L_o9_ok:
s_waitcnt lgkmcnt(0)
v_mfma_f32_16x16x32_bf16 v[24:27], a[0:3], v[104:107], v[24:27]
ds_read_b64_tr_b16 a[16:17], v12 offset:4096
v_mfma_f32_16x16x32_bf16 v[40:43], a[0:3], v[108:111], v[40:43]
ds_read_b64_tr_b16 a[18:19], v12 offset:6144
v_mfma_f32_16x16x32_bf16 v[28:31], a[4:7], v[104:107], v[28:31]
ds_read_b64_tr_b16 a[20:21], v13 offset:4096
v_mfma_f32_16x16x32_bf16 v[44:47], a[4:7], v[108:111], v[44:47]
ds_read_b64_tr_b16 a[22:23], v13 offset:6144
v_mfma_f32_16x16x32_bf16 v[32:35], a[8:11], v[104:107], v[32:35]
ds_read_b64_tr_b16 a[24:25], v14 offset:4096
v_mfma_f32_16x16x32_bf16 v[48:51], a[8:11], v[108:111], v[48:51]
ds_read_b64_tr_b16 a[26:27], v14 offset:6144
v_mfma_f32_16x16x32_bf16 v[36:39], a[12:15], v[104:107], v[36:39]
ds_read_b64_tr_b16 a[28:29], v15 offset:4096
v_mfma_f32_16x16x32_bf16 v[52:55], a[12:15], v[108:111], v[52:55]
ds_read_b64_tr_b16 a[30:31], v15 offset:6144
s_add_u32 s71, s65, 10
s_and_b32 s71, s71, 15
s_lshl_b32 s71, s71, 13
v_add_u32 v12, s71, v8
v_add_u32 v13, s71, v9
v_add_u32 v14, s71, v10
v_add_u32 v15, s71, v11
s_waitcnt lgkmcnt(0)
v_mfma_f32_16x16x32_bf16 v[24:27], a[16:19], v[112:115], v[24:27]
ds_read_b64_tr_b16 a[0:1], v12 offset:0
v_mfma_f32_16x16x32_bf16 v[40:43], a[16:19], v[116:119], v[40:43]
ds_read_b64_tr_b16 a[2:3], v12 offset:2048
v_mfma_f32_16x16x32_bf16 v[28:31], a[20:23], v[112:115], v[28:31]
ds_read_b64_tr_b16 a[4:5], v13 offset:0
v_mfma_f32_16x16x32_bf16 v[44:47], a[20:23], v[116:119], v[44:47]
ds_read_b64_tr_b16 a[6:7], v13 offset:2048
v_mfma_f32_16x16x32_bf16 v[32:35], a[24:27], v[112:115], v[32:35]
ds_read_b64_tr_b16 a[8:9], v14 offset:0
v_mfma_f32_16x16x32_bf16 v[48:51], a[24:27], v[116:119], v[48:51]
ds_read_b64_tr_b16 a[10:11], v14 offset:2048
v_mfma_f32_16x16x32_bf16 v[36:39], a[28:31], v[112:115], v[36:39]
ds_read_b64_tr_b16 a[12:13], v15 offset:0
v_mfma_f32_16x16x32_bf16 v[52:55], a[28:31], v[116:119], v[52:55]
ds_read_b64_tr_b16 a[14:15], v15 offset:2048
s_add_u32 s70, s65, 15
s_and_b32 s70, s70, 15
s_lshl_b32 s70, s70, 11
s_add_u32 s70, s70, s74
buffer_load_dwordx4 v[104:107], v16, s[12:15], s70 offen offset:0 sc1
buffer_load_dwordx4 v[108:111], v19, s[12:15], s70 offen offset:0 sc1
buffer_load_dwordx4 v[112:115], v16, s[12:15], s70 offen offset:1024 sc1
buffer_load_dwordx4 v[116:119], v19, s[12:15], s70 offen offset:1024 sc1
s_waitcnt vmcnt(20)
L_o10_chk:
v_max3_u32 v2, v120, v124, v128
v_max_u32 v2, v2, v132
v_cmp_eq_u32 vcc, -1, v2
s_cbranch_vccnz L_o10_rt
L_o10_ok:
s_waitcnt lgkmcnt(0)
v_mfma_f32_16x16x32_bf16 v[24:27], a[0:3], v[120:123], v[24:27]
ds_read_b64_tr_b16 a[16:17], v12 offset:4096
v_mfma_f32_16x16x32_bf16 v[40:43], a[0:3], v[124:127], v[40:43]
ds_read_b64_tr_b16 a[18:19], v12 offset:6144
v_mfma_f32_16x16x32_bf16 v[28:31], a[4:7], v[120:123], v[28:31]
ds_read_b64_tr_b16 a[20:21], v13 offset:4096
v_mfma_f32_16x16x32_bf16 v[44:47], a[4:7], v[124:127], v[44:47]
ds_read_b64_tr_b16 a[22:23], v13 offset:6144
v_mfma_f32_16x16x32_bf16 v[32:35], a[8:11], v[120:123], v[32:35]
ds_read_b64_tr_b16 a[24:25], v14 offset:4096
v_mfma_f32_16x16x32_bf16 v[48:51], a[8:11], v[124:127], v[48:51]
ds_read_b64_tr_b16 a[26:27], v14 offset:6144
v_mfma_f32_16x16x32_bf16 v[36:39], a[12:15], v[120:123], v[36:39]
ds_read_b64_tr_b16 a[28:29], v15 offset:4096
v_mfma_f32_16x16x32_bf16 v[52:55], a[12:15], v[124:127], v[52:55]
ds_read_b64_tr_b16 a[30:31], v15 offset:6144
s_add_u32 s71, s65, 11
s_and_b32 s71, s71, 15
s_lshl_b32 s71, s71, 13
v_add_u32 v12, s71, v8
v_add_u32 v13, s71, v9
v_add_u32 v14, s71, v10
v_add_u32 v15, s71, v11
s_waitcnt lgkmcnt(0)
v_mfma_f32_16x16x32_bf16 v[24:27], a[16:19], v[128:131], v[24:27]
ds_read_b64_tr_b16 a[0:1], v12 offset:0
v_mfma_f32_16x16x32_bf16 v[40:43], a[16:19], v[132:135], v[40:43]
ds_read_b64_tr_b16 a[2:3], v12 offset:2048
v_mfma_f32_16x16x32_bf16 v[28:31], a[20:23], v[128:131], v[28:31]
ds_read_b64_tr_b16 a[4:5], v13 offset:0
v_mfma_f32_16x16x32_bf16 v[44:47], a[20:23], v[132:135], v[44:47]
ds_read_b64_tr_b16 a[6:7], v13 offset:2048
v_mfma_f32_16x16x32_bf16 v[32:35], a[24:27], v[128:131], v[32:35]
ds_read_b64_tr_b16 a[8:9], v14 offset:0
v_mfma_f32_16x16x32_bf16 v[48:51], a[24:27], v[132:135], v[48:51]
ds_read_b64_tr_b16 a[10:11], v14 offset:2048
v_mfma_f32_16x16x32_bf16 v[36:39], a[28:31], v[128:131], v[36:39]
ds_read_b64_tr_b16 a[12:13], v15 offset:0
v_mfma_f32_16x16x32_bf16 v[52:55], a[28:31], v[132:135], v[52:55]
ds_read_b64_tr_b16 a[14:15], v15 offset:2048
s_waitcnt vmcnt(16)
L_o11_chk:
v_max3_u32 v2, v136, v140, v144
v_max_u32 v2, v2, v148
v_cmp_eq_u32 vcc, -1, v2
s_cbranch_vccnz L_o11_rt
L_o11_ok:
s_waitcnt lgkmcnt(0)
v_mfma_f32_16x16x32_bf16 v[24:27], a[0:3], v[136:139], v[24:27]
ds_read_b64_tr_b16 a[16:17], v12 offset:4096
v_mfma_f32_16x16x32_bf16 v[40:43], a[0:3], v[140:143], v[40:43]
ds_read_b64_tr_b16 a[18:19], v12 offset:6144
v_mfma_f32_16x16x32_bf16 v[28:31], a[4:7], v[136:139], v[28:31]
ds_read_b64_tr_b16 a[20:21], v13 offset:4096
v_mfma_f32_16x16x32_bf16 v[44:47], a[4:7], v[140:143], v[44:47]
ds_read_b64_tr_b16 a[22:23], v13 offset:6144
v_mfma_f32_16x16x32_bf16 v[32:35], a[8:11], v[136:139], v[32:35]
ds_read_b64_tr_b16 a[24:25], v14 offset:4096
v_mfma_f32_16x16x32_bf16 v[48:51], a[8:11], v[140:143], v[48:51]
ds_read_b64_tr_b16 a[26:27], v14 offset:6144
v_mfma_f32_16x16x32_bf16 v[36:39], a[12:15], v[136:139], v[36:39]
ds_read_b64_tr_b16 a[28:29], v15 offset:4096
v_mfma_f32_16x16x32_bf16 v[52:55], a[12:15], v[140:143], v[52:55]
ds_read_b64_tr_b16 a[30:31], v15 offset:6144
s_add_u32 s71, s65, 12
s_and_b32 s71, s71, 15
s_lshl_b32 s71, s71, 13
v_add_u32 v12, s71, v8
v_add_u32 v13, s71, v9
v_add_u32 v14, s71, v10
v_add_u32 v15, s71, v11
s_waitcnt lgkmcnt(0)
v_mfma_f32_16x16x32_bf16 v[24:27], a[16:19], v[144:147], v[24:27]
ds_read_b64_tr_b16 a[0:1], v12 offset:0
v_mfma_f32_16x16x32_bf16 v[40:43], a[16:19], v[148:151], v[40:43]
ds_read_b64_tr_b16 a[2:3], v12 offset:2048
v_mfma_f32_16x16x32_bf16 v[28:31], a[20:23], v[144:147], v[28:31]
ds_read_b64_tr_b16 a[4:5], v13 offset:0
v_mfma_f32_16x16x32_bf16 v[44:47], a[20:23], v[148:151], v[44:47]
ds_read_b64_tr_b16 a[6:7], v13 offset:2048
v_mfma_f32_16x16x32_bf16 v[32:35], a[24:27], v[144:147], v[32:35]
ds_read_b64_tr_b16 a[8:9], v14 offset:0
v_mfma_f32_16x16x32_bf16 v[48:51], a[24:27], v[148:151], v[48:51]
ds_read_b64_tr_b16 a[10:11], v14 offset:2048
v_mfma_f32_16x16x32_bf16 v[36:39], a[28:31], v[144:147], v[36:39]
ds_read_b64_tr_b16 a[12:13], v15 offset:0
v_mfma_f32_16x16x32_bf16 v[52:55], a[28:31], v[148:151], v[52:55]
ds_read_b64_tr_b16 a[14:15], v15 offset:2048
s_waitcnt vmcnt(12)
L_o12_chk:
v_max3_u32 v2, v56, v60, v64
v_max_u32 v2, v2, v68
v_cmp_eq_u32 vcc, -1, v2
s_cbranch_vccnz L_o12_rt
L_o12_ok:
s_waitcnt lgkmcnt(0)
v_mfma_f32_16x16x32_bf16 v[24:27], a[0:3], v[56:59], v[24:27]
ds_read_b64_tr_b16 a[16:17], v12 offset:4096
v_mfma_f32_16x16x32_bf16 v[40:43], a[0:3], v[60:63], v[40:43]
ds_read_b64_tr_b16 a[18:19], v12 offset:6144
v_mfma_f32_16x16x32_bf16 v[28:31], a[4:7], v[56:59], v[28:31]
ds_read_b64_tr_b16 a[20:21], v13 offset:4096
v_mfma_f32_16x16x32_bf16 v[44:47], a[4:7], v[60:63], v[44:47]
ds_read_b64_tr_b16 a[22:23], v13 offset:6144
v_mfma_f32_16x16x32_bf16 v[32:35], a[8:11], v[56:59], v[32:35]
ds_read_b64_tr_b16 a[24:25], v14 offset:4096
v_mfma_f32_16x16x32_bf16 v[48:51], a[8:11], v[60:63], v[48:51]
ds_read_b64_tr_b16 a[26:27], v14 offset:6144
v_mfma_f32_16x16x32_bf16 v[36:39], a[12:15], v[56:59], v[36:39]
ds_read_b64_tr_b16 a[28:29], v15 offset:4096
v_mfma_f32_16x16x32_bf16 v[52:55], a[12:15], v[60:63], v[52:55]
ds_read_b64_tr_b16 a[30:31], v15 offset:6144
s_add_u32 s71, s65, 13
s_and_b32 s71, s71, 15
s_lshl_b32 s71, s71, 13
v_add_u32 v12, s71, v8
v_add_u32 v13, s71, v9
v_add_u32 v14, s71, v10
v_add_u32 v15, s71, v11
s_waitcnt lgkmcnt(0)
v_mfma_f32_16x16x32_bf16 v[24:27], a[16:19], v[64:67], v[24:27]
ds_read_b64_tr_b16 a[0:1], v12 offset:0
v_mfma_f32_16x16x32_bf16 v[40:43], a[16:19], v[68:71], v[40:43]
ds_read_b64_tr_b16 a[2:3], v12 offset:2048
v_mfma_f32_16x16x32_bf16 v[28:31], a[20:23], v[64:67], v[28:31]
ds_read_b64_tr_b16 a[4:5], v13 offset:0
v_mfma_f32_16x16x32_bf16 v[44:47], a[20:23], v[68:71], v[44:47]
ds_read_b64_tr_b16 a[6:7], v13 offset:2048
v_mfma_f32_16x16x32_bf16 v[32:35], a[24:27], v[64:67], v[32:35]
ds_read_b64_tr_b16 a[8:9], v14 offset:0
v_mfma_f32_16x16x32_bf16 v[48:51], a[24:27], v[68:71], v[48:51]
ds_read_b64_tr_b16 a[10:11], v14 offset:2048
v_mfma_f32_16x16x32_bf16 v[36:39], a[28:31], v[64:67], v[36:39]
ds_read_b64_tr_b16 a[12:13], v15 offset:0
v_mfma_f32_16x16x32_bf16 v[52:55], a[28:31], v[68:71], v[52:55]
ds_read_b64_tr_b16 a[14:15], v15 offset:2048
s_waitcnt vmcnt(8)
L_o13_chk:
v_max3_u32 v2, v72, v76, v80
v_max_u32 v2, v2, v84
v_cmp_eq_u32 vcc, -1, v2
s_cbranch_vccnz L_o13_rt
L_o13_ok:
s_waitcnt lgkmcnt(0)
v_mfma_f32_16x16x32_bf16 v[24:27], a[0:3], v[72:75], v[24:27]
ds_read_b64_tr_b16 a[16:17], v12 offset:4096
v_mfma_f32_16x16x32_bf16 v[40:43], a[0:3], v[76:79], v[40:43]
ds_read_b64_tr_b16 a[18:19], v12 offset:6144
v_mfma_f32_16x16x32_bf16 v[28:31], a[4:7], v[72:75], v[28:31]
ds_read_b64_tr_b16 a[20:21], v13 offset:4096
v_mfma_f32_16x16x32_bf16 v[44:47], a[4:7], v[76:79], v[44:47]
ds_read_b64_tr_b16 a[22:23], v13 offset:6144
v_mfma_f32_16x16x32_bf16 v[32:35], a[8:11], v[72:75], v[32:35]
ds_read_b64_tr_b16 a[24:25], v14 offset:4096
v_mfma_f32_16x16x32_bf16 v[48:51], a[8:11], v[76:79], v[48:51]
ds_read_b64_tr_b16 a[26:27], v14 offset:6144
v_mfma_f32_16x16x32_bf16 v[36:39], a[12:15], v[72:75], v[36:39]
ds_read_b64_tr_b16 a[28:29], v15 offset:4096
v_mfma_f32_16x16x32_bf16 v[52:55], a[12:15], v[76:79], v[52:55]
ds_read_b64_tr_b16 a[30:31], v15 offset:6144
s_add_u32 s71, s65, 14
s_and_b32 s71, s71, 15
s_lshl_b32 s71, s71, 13
v_add_u32 v12, s71, v8
v_add_u32 v13, s71, v9
v_add_u32 v14, s71, v10
v_add_u32 v15, s71, v11
s_waitcnt lgkmcnt(0)
v_mfma_f32_16x16x32_bf16 v[24:27], a[16:19], v[80:83], v[24:27]
ds_read_b64_tr_b16 a[0:1], v12 offset:0
v_mfma_f32_16x16x32_bf16 v[40:43], a[16:19], v[84:87], v[40:43]
ds_read_b64_tr_b16 a[2:3], v12 offset:2048
v_mfma_f32_16x16x32_bf16 v[28:31], a[20:23], v[80:83], v[28:31]
ds_read_b64_tr_b16 a[4:5], v13 offset:0
v_mfma_f32_16x16x32_bf16 v[44:47], a[20:23], v[84:87], v[44:47]
ds_read_b64_tr_b16 a[6:7], v13 offset:2048
v_mfma_f32_16x16x32_bf16 v[32:35], a[24:27], v[80:83], v[32:35]
ds_read_b64_tr_b16 a[8:9], v14 offset:0
v_mfma_f32_16x16x32_bf16 v[48:51], a[24:27], v[84:87], v[48:51]
ds_read_b64_tr_b16 a[10:11], v14 offset:2048
v_mfma_f32_16x16x32_bf16 v[36:39], a[28:31], v[80:83], v[36:39]
ds_read_b64_tr_b16 a[12:13], v15 offset:0
v_mfma_f32_16x16x32_bf16 v[52:55], a[28:31], v[84:87], v[52:55]
ds_read_b64_tr_b16 a[14:15], v15 offset:2048
s_waitcnt vmcnt(4)
L_o14_chk:
v_max3_u32 v2, v88, v92, v96
v_max_u32 v2, v2, v100
v_cmp_eq_u32 vcc, -1, v2
s_cbranch_vccnz L_o14_rt
L_o14_ok:
s_waitcnt lgkmcnt(0)
v_mfma_f32_16x16x32_bf16 v[24:27], a[0:3], v[88:91], v[24:27]
ds_read_b64_tr_b16 a[16:17], v12 offset:4096
v_mfma_f32_16x16x32_bf16 v[40:43], a[0:3], v[92:95], v[40:43]
ds_read_b64_tr_b16 a[18:19], v12 offset:6144
v_mfma_f32_16x16x32_bf16 v[28:31], a[4:7], v[88:91], v[28:31]
ds_read_b64_tr_b16 a[20:21], v13 offset:4096
v_mfma_f32_16x16x32_bf16 v[44:47], a[4:7], v[92:95], v[44:47]
ds_read_b64_tr_b16 a[22:23], v13 offset:6144
v_mfma_f32_16x16x32_bf16 v[32:35], a[8:11], v[88:91], v[32:35]
ds_read_b64_tr_b16 a[24:25], v14 offset:4096
v_mfma_f32_16x16x32_bf16 v[48:51], a[8:11], v[92:95], v[48:51]
ds_read_b64_tr_b16 a[26:27], v14 offset:6144
v_mfma_f32_16x16x32_bf16 v[36:39], a[12:15], v[88:91], v[36:39]
ds_read_b64_tr_b16 a[28:29], v15 offset:4096
v_mfma_f32_16x16x32_bf16 v[52:55], a[12:15], v[92:95], v[52:55]
ds_read_b64_tr_b16 a[30:31], v15 offset:6144
s_add_u32 s71, s65, 15
s_and_b32 s71, s71, 15
s_lshl_b32 s71, s71, 13
v_add_u32 v12, s71, v8
v_add_u32 v13, s71, v9
v_add_u32 v14, s71, v10
v_add_u32 v15, s71, v11
s_waitcnt lgkmcnt(0)
v_mfma_f32_16x16x32_bf16 v[24:27], a[16:19], v[96:99], v[24:27]
ds_read_b64_tr_b16 a[0:1], v12 offset:0
v_mfma_f32_16x16x32_bf16 v[40:43], a[16:19], v[100:103], v[40:43]
ds_read_b64_tr_b16 a[2:3], v12 offset:2048
v_mfma_f32_16x16x32_bf16 v[28:31], a[20:23], v[96:99], v[28:31]
ds_read_b64_tr_b16 a[4:5], v13 offset:0
v_mfma_f32_16x16x32_bf16 v[44:47], a[20:23], v[100:103], v[44:47]
ds_read_b64_tr_b16 a[6:7], v13 offset:2048
v_mfma_f32_16x16x32_bf16 v[32:35], a[24:27], v[96:99], v[32:35]
ds_read_b64_tr_b16 a[8:9], v14 offset:0
v_mfma_f32_16x16x32_bf16 v[48:51], a[24:27], v[100:103], v[48:51]
ds_read_b64_tr_b16 a[10:11], v14 offset:2048
v_mfma_f32_16x16x32_bf16 v[36:39], a[28:31], v[96:99], v[36:39]
ds_read_b64_tr_b16 a[12:13], v15 offset:0
v_mfma_f32_16x16x32_bf16 v[52:55], a[28:31], v[100:103], v[52:55]
ds_read_b64_tr_b16 a[14:15], v15 offset:2048
s_waitcnt vmcnt(0)
L_o15_chk:
v_max3_u32 v2, v104, v108, v112
v_max_u32 v2, v2, v116
v_cmp_eq_u32 vcc, -1, v2
s_cbranch_vccnz L_o15_rt
L_o15_ok:
s_waitcnt lgkmcnt(0)
v_mfma_f32_16x16x32_bf16 v[24:27], a[0:3], v[104:107], v[24:27]
ds_read_b64_tr_b16 a[16:17], v12 offset:4096
v_mfma_f32_16x16x32_bf16 v[40:43], a[0:3], v[108:111], v[40:43]
ds_read_b64_tr_b16 a[18:19], v12 offset:6144
v_mfma_f32_16x16x32_bf16 v[28:31], a[4:7], v[104:107], v[28:31]
ds_read_b64_tr_b16 a[20:21], v13 offset:4096
v_mfma_f32_16x16x32_bf16 v[44:47], a[4:7], v[108:111], v[44:47]
ds_read_b64_tr_b16 a[22:23], v13 offset:6144
v_mfma_f32_16x16x32_bf16 v[32:35], a[8:11], v[104:107], v[32:35]
ds_read_b64_tr_b16 a[24:25], v14 offset:4096
v_mfma_f32_16x16x32_bf16 v[48:51], a[8:11], v[108:111], v[48:51]
ds_read_b64_tr_b16 a[26:27], v14 offset:6144
v_mfma_f32_16x16x32_bf16 v[36:39], a[12:15], v[104:107], v[36:39]
ds_read_b64_tr_b16 a[28:29], v15 offset:4096
v_mfma_f32_16x16x32_bf16 v[52:55], a[12:15], v[108:111], v[52:55]
ds_read_b64_tr_b16 a[30:31], v15 offset:6144
s_waitcnt lgkmcnt(0)
v_mfma_f32_16x16x32_bf16 v[24:27], a[16:19], v[112:115], v[24:27]
v_mfma_f32_16x16x32_bf16 v[40:43], a[16:19], v[116:119], v[40:43]
v_mfma_f32_16x16x32_bf16 v[28:31], a[20:23], v[112:115], v[28:31]
v_mfma_f32_16x16x32_bf16 v[44:47], a[20:23], v[116:119], v[44:47]
v_mfma_f32_16x16x32_bf16 v[32:35], a[24:27], v[112:115], v[32:35]
v_mfma_f32_16x16x32_bf16 v[48:51], a[24:27], v[116:119], v[48:51]
v_mfma_f32_16x16x32_bf16 v[36:39], a[28:31], v[112:115], v[36:39]
v_mfma_f32_16x16x32_bf16 v[52:55], a[28:31], v[116:119], v[52:55]
s_barrier
v_accvgpr_read_b32 v88, a96
v_accvgpr_read_b32 v89, a97
v_accvgpr_read_b32 v90, a98
v_accvgpr_read_b32 v91, a99
v_accvgpr_read_b32 v92, a100
v_accvgpr_read_b32 v93, a101
v_accvgpr_read_b32 v94, a102
v_accvgpr_read_b32 v95, a103
v_lshlrev_b32 v56, 16, v88
v_and_b32 v57, 0xffff0000, v88
v_lshlrev_b32 v58, 16, v89
v_and_b32 v59, 0xffff0000, v89
v_lshlrev_b32 v60, 16, v90
v_and_b32 v61, 0xffff0000, v90
v_lshlrev_b32 v62, 16, v91
v_and_b32 v63, 0xffff0000, v91
v_lshlrev_b32 v64, 16, v92
v_and_b32 v65, 0xffff0000, v92
v_lshlrev_b32 v66, 16, v93
v_and_b32 v67, 0xffff0000, v93
v_lshlrev_b32 v68, 16, v94
v_and_b32 v69, 0xffff0000, v94
v_lshlrev_b32 v70, 16, v95
v_and_b32 v71, 0xffff0000, v95
v_pk_add_f32 v[72:73], v[24:25], v[26:27]
v_pk_mul_f32 v[74:75], v[24:25], v[24:25]
v_pk_mul_f32 v[76:77], v[24:25], v[56:57]
v_pk_fma_f32 v[74:75], v[26:27], v[26:27], v[74:75]
v_pk_fma_f32 v[76:77], v[26:27], v[58:59], v[76:77]
v_pk_add_f32 v[72:73], v[72:73], v[28:29]
v_pk_fma_f32 v[74:75], v[28:29], v[28:29], v[74:75]
v_pk_fma_f32 v[76:77], v[28:29], v[60:61], v[76:77]
v_pk_add_f32 v[72:73], v[72:73], v[30:31]
v_pk_fma_f32 v[74:75], v[30:31], v[30:31], v[74:75]
v_pk_fma_f32 v[76:77], v[30:31], v[62:63], v[76:77]
v_pk_add_f32 v[72:73], v[72:73], v[32:33]
v_pk_fma_f32 v[74:75], v[32:33], v[32:33], v[74:75]
v_pk_fma_f32 v[76:77], v[32:33], v[64:65], v[76:77]
v_pk_add_f32 v[72:73], v[72:73], v[34:35]
v_pk_fma_f32 v[74:75], v[34:35], v[34:35], v[74:75]
v_pk_fma_f32 v[76:77], v[34:35], v[66:67], v[76:77]
v_pk_add_f32 v[72:73], v[72:73], v[36:37]
v_pk_fma_f32 v[74:75], v[36:37], v[36:37], v[74:75]
v_pk_fma_f32 v[76:77], v[36:37], v[68:69], v[76:77]
v_pk_add_f32 v[72:73], v[72:73], v[38:39]
v_pk_fma_f32 v[74:75], v[38:39], v[38:39], v[74:75]
v_pk_fma_f32 v[76:77], v[38:39], v[70:71], v[76:77]
v_add_f32 v72, v72, v73
v_add_f32 v73, v74, v75
v_add_f32 v74, v76, v77
v_pk_add_f32 v[80:81], v[40:41], v[42:43]
v_pk_mul_f32 v[82:83], v[40:41], v[40:41]
v_pk_mul_f32 v[84:85], v[40:41], v[56:57]
v_pk_fma_f32 v[82:83], v[42:43], v[42:43], v[82:83]
v_pk_fma_f32 v[84:85], v[42:43], v[58:59], v[84:85]
v_pk_add_f32 v[80:81], v[80:81], v[44:45]
v_pk_fma_f32 v[82:83], v[44:45], v[44:45], v[82:83]
v_pk_fma_f32 v[84:85], v[44:45], v[60:61], v[84:85]
v_pk_add_f32 v[80:81], v[80:81], v[46:47]
v_pk_fma_f32 v[82:83], v[46:47], v[46:47], v[82:83]
v_pk_fma_f32 v[84:85], v[46:47], v[62:63], v[84:85]
v_pk_add_f32 v[80:81], v[80:81], v[48:49]
v_pk_fma_f32 v[82:83], v[48:49], v[48:49], v[82:83]
v_pk_fma_f32 v[84:85], v[48:49], v[64:65], v[84:85]
v_pk_add_f32 v[80:81], v[80:81], v[50:51]
v_pk_fma_f32 v[82:83], v[50:51], v[50:51], v[82:83]
v_pk_fma_f32 v[84:85], v[50:51], v[66:67], v[84:85]
v_pk_add_f32 v[80:81], v[80:81], v[52:53]
v_pk_fma_f32 v[82:83], v[52:53], v[52:53], v[82:83]
v_pk_fma_f32 v[84:85], v[52:53], v[68:69], v[84:85]
v_pk_add_f32 v[80:81], v[80:81], v[54:55]
v_pk_fma_f32 v[82:83], v[54:55], v[54:55], v[82:83]
v_pk_fma_f32 v[84:85], v[54:55], v[70:71], v[84:85]
v_add_f32 v80, v80, v81
v_add_f32 v81, v82, v83
v_add_f32 v82, v84, v85
v_permlane32_swap_b32 v72, v80
v_permlane32_swap_b32 v73, v81
v_permlane32_swap_b32 v74, v82
v_add_f32 v72, v72, v80
v_add_f32 v73, v73, v81
v_add_f32 v74, v74, v82
v_mov_b32 v80, v72
v_mov_b32 v81, v73
v_mov_b32 v82, v74
v_permlane16_swap_b32 v72, v80
v_permlane16_swap_b32 v73, v81
v_permlane16_swap_b32 v74, v82
v_add_f32 v72, v72, v80
v_add_f32 v73, v73, v81
v_add_f32 v74, v74, v82
v_mov_b32 v75, s68
v_and_b32 v2, 15, v1
v_lshrrev_b32 v3, 5, v1
v_lshlrev_b32 v4, 4, v2
v_lshl_add_u32 v4, v3, 8, v4
s_lshl_b32 s75, s64, 15
s_lshl_b32 s70, s60, 9
s_add_u32 s75, s75, s70
s_add_u32 s75, s75, 6291456
s_lshl_b32 s70, s65, 11
s_add_u32 s72, s75, s70
s_mov_b32 s92, 0xffff
s_mov_b32 s93, 0xffff
s_mov_b64 exec, s[92:93]
s_cmp_eq_u32 s69, 0
s_cbranch_scc1 L_stp_s
buffer_store_dwordx4 v[72:75], v4, s[12:15], s72 offen
L_stp_d:
s_mov_b64 exec, -1
v_and_b32 v2, 31, v1
v_lshlrev_b32 v5, 4, v2
v_lshl_add_u32 v5, v3, 11, v5
s_add_u32 s70, s75, 0
buffer_load_dwordx4 v[96:99], v5, s[12:15], s70 offen sc1
s_add_u32 s70, s75, 4096
buffer_load_dwordx4 v[100:103], v5, s[12:15], s70 offen sc1
s_add_u32 s70, s75, 8192
buffer_load_dwordx4 v[104:107], v5, s[12:15], s70 offen sc1
s_add_u32 s70, s75, 12288
buffer_load_dwordx4 v[108:111], v5, s[12:15], s70 offen sc1
s_add_u32 s70, s75, 16384
buffer_load_dwordx4 v[112:115], v5, s[12:15], s70 offen sc1
s_add_u32 s70, s75, 20480
buffer_load_dwordx4 v[116:119], v5, s[12:15], s70 offen sc1
s_add_u32 s70, s75, 24576
buffer_load_dwordx4 v[120:123], v5, s[12:15], s70 offen sc1
s_add_u32 s70, s75, 28672
buffer_load_dwordx4 v[124:127], v5, s[12:15], s70 offen sc1
v_cvt_pk_bf16_f32 v128, v24, v25
v_cvt_pk_bf16_f32 v129, v26, v27
ds_write_b64 v20, v[128:129] offset:0
v_cvt_pk_bf16_f32 v130, v28, v29
v_cvt_pk_bf16_f32 v131, v30, v31
ds_write_b64 v21, v[130:131] offset:0
v_cvt_pk_bf16_f32 v132, v32, v33
v_cvt_pk_bf16_f32 v133, v34, v35
ds_write_b64 v22, v[132:133] offset:0
v_cvt_pk_bf16_f32 v134, v36, v37
v_cvt_pk_bf16_f32 v135, v38, v39
ds_write_b64 v23, v[134:135] offset:0
v_cvt_pk_bf16_f32 v136, v40, v41
v_cvt_pk_bf16_f32 v137, v42, v43
ds_write_b64 v20, v[136:137] offset:2048
v_cvt_pk_bf16_f32 v138, v44, v45
v_cvt_pk_bf16_f32 v139, v46, v47
ds_write_b64 v21, v[138:139] offset:2048
v_cvt_pk_bf16_f32 v140, v48, v49
v_cvt_pk_bf16_f32 v141, v50, v51
ds_write_b64 v22, v[140:141] offset:2048
v_cvt_pk_bf16_f32 v142, v52, v53
v_cvt_pk_bf16_f32 v143, v54, v55
ds_write_b64 v23, v[142:143] offset:2048
s_lshl_b32 s70, s64, 7
s_lshl_b32 s71, s60, 5
s_add_u32 s70, s70, s71
s_sub_u32 s70, 2047, s70
v_sub_u32 v6, s70, v2
s_lshl_b32 s70, s60, 9
s_add_u32 s70, s70, 49152
v_lshlrev_b32 v7, 4, v2
v_add_u32 v7, s70, v7
s_waitcnt vmcnt(0)
L_st_chk:
v_xor_b32 v88, s68, v99
v_xor_b32 v89, s68, v103
v_xor_b32 v90, s68, v107
v_xor_b32 v91, s68, v111
v_xor_b32 v92, s68, v115
v_xor_b32 v93, s68, v119
v_xor_b32 v94, s68, v123
v_xor_b32 v95, s68, v127
v_or3_b32 v88, v88, v89, v90
v_or3_b32 v91, v91, v92, v93
v_or3_b32 v88, v88, v94, v95
v_or_b32 v88, v88, v91
v_cmp_ne_u32 vcc, 0, v88
s_cbranch_vccnz L_st_rt
L_st_ok:
v_pk_add_f32 v[96:97], v[96:97], v[100:101]
v_add_f32 v98, v98, v102
v_pk_add_f32 v[104:105], v[104:105], v[108:109]
v_add_f32 v106, v106, v110
v_pk_add_f32 v[112:113], v[112:113], v[116:117]
v_add_f32 v114, v114, v118
v_pk_add_f32 v[120:121], v[120:121], v[124:125]
v_add_f32 v122, v122, v126
v_pk_add_f32 v[96:97], v[96:97], v[104:105]
v_add_f32 v98, v98, v106
v_pk_add_f32 v[112:113], v[112:113], v[120:121]
v_add_f32 v114, v114, v122
v_pk_add_f32 v[96:97], v[96:97], v[112:113]
v_add_f32 v98, v98, v114
v_mov_b32 v100, v96
v_mov_b32 v101, v97
v_mov_b32 v102, v98
v_permlane32_swap_b32 v96, v100
v_permlane32_swap_b32 v97, v101
v_permlane32_swap_b32 v98, v102
v_add_f32 v96, v96, v100
v_add_f32 v97, v97, v101
v_add_f32 v98, v98, v102
v_mul_f32 v73, 0x3a800000, v96
v_mul_f32 v97, 0x3a800000, v97
v_fma_f32 v97, -v73, v73, v97
v_fma_f32 v98, -v73, s84, v98
v_max_f32 v97, 0, v97
v_add_f32 v97, 0x3727c5ac, v97
v_rsq_f32 v74, v97
v_mov_b32 v75, s68
v_mul_f32 v98, v98, v74
v_ashrrev_i32 v99, 31, v98
v_or_b32 v99, 0x80000000, v99
v_xor_b32 v98, v98, v99
s_mov_b32 s70, 0xfffff800
v_and_or_b32 v72, v98, s70, v6
ds_write_b128 v7, v[72:75]
s_nop 0
v_mov_b32_dpp v78, v72 row_ror:1 row_mask:0xf bank_mask:0xf
v_max_u32 v76, v72, v78
v_min_u32 v77, v72, v78
s_nop 0
v_mov_b32_dpp v78, v76 row_ror:2 row_mask:0xf bank_mask:0xf
v_max_u32_dpp v79, v77, v77 row_ror:2 row_mask:0xf bank_mask:0xf
v_med3_u32 v77, v76, v78, v79
v_max_u32 v76, v76, v78
s_nop 1
v_mov_b32_dpp v78, v76 row_ror:4 row_mask:0xf bank_mask:0xf
v_max_u32_dpp v79, v77, v77 row_ror:4 row_mask:0xf bank_mask:0xf
v_med3_u32 v77, v76, v78, v79
v_max_u32 v76, v76, v78
s_nop 1
v_mov_b32_dpp v78, v76 row_ror:8 row_mask:0xf bank_mask:0xf
v_max_u32_dpp v79, v77, v77 row_ror:8 row_mask:0xf bank_mask:0xf
v_med3_u32 v77, v76, v78, v79
v_max_u32 v76, v76, v78
v_mov_b32 v78, v76
v_mov_b32 v79, v77
s_nop 0
v_permlane16_swap_b32 v76, v78
v_permlane16_swap_b32 v77, v79
v_max_u32 v79, v77, v79
v_med3_u32 v77, v76, v78, v79
v_max_u32 v76, v76, v78
s_lshl_b32 s70, s60, 3
s_add_u32 s70, s70, 161792
v_mov_b32 v2, s70
ds_write_b64 v2, v[76:77]
v_mov_b32 v2, 161792
v_add_f32 v80, 1.0, v74
v_mul_f32_e64 v82, -v73, v74
v_mov_b32 v81, v80
v_mov_b32 v83, v82
s_nop 0
v_permlane16_swap_b32 v80, v81
v_permlane16_swap_b32 v82, v83
s_waitcnt lgkmcnt(0)
s_barrier
ds_read_b128 v[88:91], v2
ds_read_b128 v[92:95], v2 offset:16
s_waitcnt lgkmcnt(0)
v_max_u32 v89, v89, v91
v_max_u32 v93, v93, v95
v_med3_u32 v89, v88, v90, v89
v_med3_u32 v93, v92, v94, v93
v_max_u32 v88, v88, v90
v_max_u32 v92, v92, v94
v_max_u32 v89, v89, v93
v_med3_u32 v89, v88, v92, v89
v_max_u32 v88, v88, v92
v_readfirstlane_b32 s86, v89
v_readfirstlane_b32 s85, v88
s_not_b32 s95, s86
s_and_b32 s95, s95, 127
s_not_b32 s94, s85
s_and_b32 s94, s94, 127
s_cmp_lg_u32 s60, 0
s_cbranch_scc1 L_nocand
v_mov_b32 v2, s94
v_mov_b32 v3, s95
v_and_b32 v4, 8, v1
v_cmp_ne_u32 vcc, 0, v4
s_nop 1
v_cndmask_b32 v5, v2, v3, vcc
v_bfe_u32 v6, v5, 1, 3
v_and_b32 v7, 7, v1
v_xor_b32 v6, v6, v7
v_lshlrev_b32 v6, 4, v6
v_lshl_add_u32 v6, v5, 7, v6
ds_read_b128 v[88:91], v6
v_cmp_eq_u32 vcc, 1, v1
s_nop 1
v_cndmask_b32 v5, v2, v3, vcc
v_lshlrev_b32 v5, 4, v5
v_add_u32 v5, 49152, v5
ds_read_b128 v[92:95], v5
v_lshlrev_b32 v4, 8, v4
v_lshl_add_u32 v4, v7, 4, v4
s_lshl_b32 s70, s64, 12
s_lshl_b32 s71, s65, 7
s_add_u32 s70, s70, s71
s_add_u32 s70, s70, 6881280
s_lshl_b32 s71, s64, 5
s_add_u32 s71, s71, 6815744
s_mov_b64 exec, 0xffff
s_waitcnt lgkmcnt(1)
buffer_store_dwordx4 v[88:91], v4, s[12:15], s70 offen sc1
s_cmp_lg_u32 s64, s65
s_cbranch_scc1 L_norec
s_mov_b64 exec, 3
s_waitcnt lgkmcnt(0)
buffer_store_dwordx4 v[92:95], v16, s[12:15], s71 offen sc1
L_norec:
s_mov_b64 exec, -1
L_nocand:
v_and_b32 v8, 31, v1
v_lshlrev_b32 v8, 4, v8
s_mov_b32 s75, 6815744
v_pk_fma_f32 v[24:25], v[24:25], v[80:81], v[82:83] op_sel:[0,0,0] op_sel_hi:[1,0,0]
v_pk_fma_f32 v[26:27], v[26:27], v[80:81], v[82:83] op_sel:[0,0,0] op_sel_hi:[1,0,0]
v_cvt_pk_bf16_f32 v128, v24, v25
v_cvt_pk_bf16_f32 v129, v26, v27
ds_write_b64 v20, v[128:129] offset:32768
v_pk_fma_f32 v[28:29], v[28:29], v[80:81], v[82:83] op_sel:[0,0,0] op_sel_hi:[1,0,0]
v_pk_fma_f32 v[30:31], v[30:31], v[80:81], v[82:83] op_sel:[0,0,0] op_sel_hi:[1,0,0]
v_cvt_pk_bf16_f32 v130, v28, v29
v_cvt_pk_bf16_f32 v131, v30, v31
ds_write_b64 v21, v[130:131] offset:32768
v_pk_fma_f32 v[32:33], v[32:33], v[80:81], v[82:83] op_sel:[0,0,0] op_sel_hi:[1,0,0]
v_pk_fma_f32 v[34:35], v[34:35], v[80:81], v[82:83] op_sel:[0,0,0] op_sel_hi:[1,0,0]
v_cvt_pk_bf16_f32 v132, v32, v33
v_cvt_pk_bf16_f32 v133, v34, v35
ds_write_b64 v22, v[132:133] offset:32768
v_pk_fma_f32 v[36:37], v[36:37], v[80:81], v[82:83] op_sel:[0,0,0] op_sel_hi:[1,0,0]
v_pk_fma_f32 v[38:39], v[38:39], v[80:81], v[82:83] op_sel:[0,0,0] op_sel_hi:[1,0,0]
v_cvt_pk_bf16_f32 v134, v36, v37
v_cvt_pk_bf16_f32 v135, v38, v39
ds_write_b64 v23, v[134:135] offset:32768
v_pk_fma_f32 v[40:41], v[40:41], v[80:81], v[82:83] op_sel:[0,1,1] op_sel_hi:[1,1,1]
v_pk_fma_f32 v[42:43], v[42:43], v[80:81], v[82:83] op_sel:[0,1,1] op_sel_hi:[1,1,1]
v_cvt_pk_bf16_f32 v136, v40, v41
v_cvt_pk_bf16_f32 v137, v42, v43
ds_write_b64 v20, v[136:137] offset:34816
v_pk_fma_f32 v[44:45], v[44:45], v[80:81], v[82:83] op_sel:[0,1,1] op_sel_hi:[1,1,1]
v_pk_fma_f32 v[46:47], v[46:47], v[80:81], v[82:83] op_sel:[0,1,1] op_sel_hi:[1,1,1]
v_cvt_pk_bf16_f32 v138, v44, v45
v_cvt_pk_bf16_f32 v139, v46, v47
ds_write_b64 v21, v[138:139] offset:34816
v_pk_fma_f32 v[48:49], v[48:49], v[80:81], v[82:83] op_sel:[0,1,1] op_sel_hi:[1,1,1]
v_pk_fma_f32 v[50:51], v[50:51], v[80:81], v[82:83] op_sel:[0,1,1] op_sel_hi:[1,1,1]
v_cvt_pk_bf16_f32 v140, v48, v49
v_cvt_pk_bf16_f32 v141, v50, v51
ds_write_b64 v22, v[140:141] offset:34816
v_pk_fma_f32 v[52:53], v[52:53], v[80:81], v[82:83] op_sel:[0,1,1] op_sel_hi:[1,1,1]
v_pk_fma_f32 v[54:55], v[54:55], v[80:81], v[82:83] op_sel:[0,1,1] op_sel_hi:[1,1,1]
v_cvt_pk_bf16_f32 v142, v52, v53
v_cvt_pk_bf16_f32 v143, v54, v55
ds_write_b64 v23, v[142:143] offset:34816
v_lshrrev_b32 v2, 3, v1
v_lshrrev_b32 v3, 4, v1
v_and_b32 v4, 7, v1
v_xor_b32 v3, v3, v4
v_lshlrev_b32 v3, 4, v3
v_lshl_add_u32 v3, v2, 7, v3
s_lshl_b32 s70, s60, 12
v_add_u32 v9, s70, v3
v_xor_b32 v10, 64, v9
v_lshlrev_b32 v11, 11, v2
v_lshl_add_u32 v11, v4, 4, v11
s_lshl_b32 s70, s60, 5
v_add_u32 v12, s70, v2
s_lshl_b32 s87, s64, 18
s_lshl_b32 s70, s60, 16
s_add_u32 s87, s87, s70
s_lshl_b32 s70, s65, 7
s_add_u32 s87, s87, s70
s_waitcnt lgkmcnt(0)
ds_read_b128 v[96:99], v9 offset:32768
ds_read_b128 v[100:103], v10 offset:33792
ds_read_b128 v[104:107], v9 offset:34816
ds_read_b128 v[108:111], v10 offset:35840
v_add_u32 v2, 0, v12
v_cmp_ne_u32 vcc, s94, v2
v_cmp_ne_u32_e64 s[92:93], s95, v2
s_add_u32 s70, s87, 0
s_waitcnt lgkmcnt(3)
s_and_b64 exec, vcc, s[92:93]
buffer_store_dwordx4 v[96:99], v11, s[20:23], s70 offen
s_mov_b64 exec, -1
v_add_u32 v2, 8, v12
v_cmp_ne_u32 vcc, s94, v2
v_cmp_ne_u32_e64 s[92:93], s95, v2
s_add_u32 s70, s87, 16384
s_waitcnt lgkmcnt(2)
s_and_b64 exec, vcc, s[92:93]
buffer_store_dwordx4 v[100:103], v11, s[20:23], s70 offen
s_mov_b64 exec, -1
v_add_u32 v2, 16, v12
v_cmp_ne_u32 vcc, s94, v2
v_cmp_ne_u32_e64 s[92:93], s95, v2
s_add_u32 s70, s87, 32768
s_waitcnt lgkmcnt(1)
s_and_b64 exec, vcc, s[92:93]
buffer_store_dwordx4 v[104:107], v11, s[20:23], s70 offen
s_mov_b64 exec, -1
v_add_u32 v2, 24, v12
v_cmp_ne_u32 vcc, s94, v2
v_cmp_ne_u32_e64 s[92:93], s95, v2
s_add_u32 s70, s87, 49152
s_waitcnt lgkmcnt(0)
s_and_b64 exec, vcc, s[92:93]
buffer_store_dwordx4 v[108:111], v11, s[20:23], s70 offen
s_mov_b64 exec, -1
s_cmp_lg_u32 s60, 1
s_cbranch_scc1 L_nopick
buffer_load_dwordx4 v[84:87], v8, s[12:15], s75 offen sc1
s_waitcnt vmcnt(0)
L_rec_chk:
v_cmp_ne_u32 vcc, s68, v87
s_cbranch_vccnz L_rec_rt
L_rec_ok:
v_mov_b32_dpp v78, v84 row_ror:1 row_mask:0xf bank_mask:0xf
v_max_u32 v76, v84, v78
v_min_u32 v77, v84, v78
s_nop 0
v_mov_b32_dpp v78, v76 row_ror:2 row_mask:0xf bank_mask:0xf
v_max_u32_dpp v79, v77, v77 row_ror:2 row_mask:0xf bank_mask:0xf
v_med3_u32 v77, v76, v78, v79
v_max_u32 v76, v76, v78
s_nop 1
v_mov_b32_dpp v78, v76 row_ror:4 row_mask:0xf bank_mask:0xf
v_max_u32_dpp v79, v77, v77 row_ror:4 row_mask:0xf bank_mask:0xf
v_med3_u32 v77, v76, v78, v79
v_max_u32 v76, v76, v78
s_nop 1
v_mov_b32_dpp v78, v76 row_ror:8 row_mask:0xf bank_mask:0xf
v_max_u32_dpp v79, v77, v77 row_ror:8 row_mask:0xf bank_mask:0xf
v_med3_u32 v77, v76, v78, v79
v_max_u32 v76, v76, v78
v_mov_b32 v78, v76
v_mov_b32 v79, v77
s_nop 0
v_permlane16_swap_b32 v76, v78
v_permlane16_swap_b32 v77, v79
v_max_u32 v79, v77, v79
v_med3_u32 v77, v76, v78, v79
v_max_u32 v76, v76, v78
v_cmp_eq_u32 vcc, v84, v77
v_cmp_eq_u32_e64 s[92:93], v84, v76
v_lshrrev_b32 v87, 4, v8
v_mov_b32 v2, 161856
v_mov_b32 v3, 161872
v_cndmask_b32 v2, v2, v3, vcc
s_or_b64 exec, vcc, s[92:93]
ds_write_b128 v2, v[84:87]
s_mov_b64 exec, -1
s_cmp_lg_u32 s2, 0
s_cbranch_scc1 L_nopick
v_mov_b32 v2, s68
v_mov_b32 v3, 0
s_mov_b64 exec, 1
buffer_store_dword v2, v3, s[12:15], 0 offen sc1
s_mov_b64 exec, -1
L_nopick:
v_mov_b32 v2, 161856
s_waitcnt lgkmcnt(0)
s_barrier
ds_read_b32 v3, v2
ds_read_b32 v4, v2 offset:16
s_waitcnt lgkmcnt(0)
v_readfirstlane_b32 s72, v3
v_readfirstlane_b32 s73, v4
s_cmp_eq_u32 s85, s72
s_cselect_b32 s94, 255, s94
s_cmp_eq_u32 s85, s73
s_cselect_b32 s94, 255, s94
s_cmp_eq_u32 s86, s72
s_cselect_b32 s95, 255, s95
s_cmp_eq_u32 s86, s73
s_cselect_b32 s95, 255, s95
v_add_u32 v2, 0, v12
v_cmp_eq_u32 vcc, s94, v2
v_cmp_eq_u32_e64 s[92:93], s95, v2
s_add_u32 s70, s87, 0
s_or_b64 exec, vcc, s[92:93]
s_cbranch_execz L_nodef0
buffer_store_dwordx4 v[96:99], v11, s[20:23], s70 offen
L_nodef0:
s_mov_b64 exec, -1
v_add_u32 v2, 8, v12
v_cmp_eq_u32 vcc, s94, v2
v_cmp_eq_u32_e64 s[92:93], s95, v2
s_add_u32 s70, s87, 16384
s_or_b64 exec, vcc, s[92:93]
s_cbranch_execz L_nodef1
buffer_store_dwordx4 v[100:103], v11, s[20:23], s70 offen
L_nodef1:
s_mov_b64 exec, -1
v_add_u32 v2, 16, v12
v_cmp_eq_u32 vcc, s94, v2
v_cmp_eq_u32_e64 s[92:93], s95, v2
s_add_u32 s70, s87, 32768
s_or_b64 exec, vcc, s[92:93]
s_cbranch_execz L_nodef2
buffer_store_dwordx4 v[104:107], v11, s[20:23], s70 offen
L_nodef2:
s_mov_b64 exec, -1
v_add_u32 v2, 24, v12
v_cmp_eq_u32 vcc, s94, v2
v_cmp_eq_u32_e64 s[92:93], s95, v2
s_add_u32 s70, s87, 49152
s_or_b64 exec, vcc, s[92:93]
s_cbranch_execz L_nodef3
buffer_store_dwordx4 v[108:111], v11, s[20:23], s70 offen
L_nodef3:
s_mov_b64 exec, -1
L_end:
s_endpgm
L_eg_rt:
s_add_u32 s78, s78, 1
s_cmp_gt_u32 s78, 65536
s_cbranch_scc1 L_eg_ok
s_add_u32 s70, s87, 0
buffer_load_dwordx4 v[20:23], v44, s[12:15], s70 offen sc1
s_add_u32 s70, s87, 4096
buffer_load_dwordx4 v[24:27], v44, s[12:15], s70 offen sc1
s_add_u32 s70, s87, 8192
buffer_load_dwordx4 v[28:31], v44, s[12:15], s70 offen sc1
s_add_u32 s70, s87, 12288
buffer_load_dwordx4 v[32:35], v44, s[12:15], s70 offen sc1
buffer_load_dwordx4 v[36:39], v45, s[12:15], s88 offen sc1
buffer_load_dwordx4 v[40:43], v46, s[12:15], 0 offen offset:0 sc1
s_waitcnt vmcnt(0)
s_branch L_eg_chk
L_kv0_rt:
s_add_u32 s78, s78, 1
s_cmp_gt_u32 s78, 65536
s_cbranch_scc1 L_kv0_ok
s_add_u32 s70, s65, 1
s_and_b32 s70, s70, 15
s_mul_i32 s70, s70, 4352
s_add_u32 s70, s70, s87
buffer_load_dwordx4 v[84:87], v18, s[12:15], s70 offen sc1
s_add_u32 s70, s65, 2
s_and_b32 s70, s70, 15
s_mul_i32 s70, s70, 4352
s_add_u32 s70, s70, s87
buffer_load_dwordx4 v[88:91], v18, s[12:15], s70 offen sc1
s_add_u32 s70, s65, 3
s_and_b32 s70, s70, 15
s_mul_i32 s70, s70, 4352
s_add_u32 s70, s70, s87
buffer_load_dwordx4 v[92:95], v18, s[12:15], s70 offen sc1
s_add_u32 s70, s65, 4
s_and_b32 s70, s70, 15
s_mul_i32 s70, s70, 4352
s_add_u32 s70, s70, s87
buffer_load_dwordx4 v[96:99], v18, s[12:15], s70 offen sc1
s_waitcnt vmcnt(0)
s_branch L_kv0_chk
L_kv1_rt:
s_add_u32 s78, s78, 1
s_cmp_gt_u32 s78, 65536
s_cbranch_scc1 L_kv1_ok
s_add_u32 s70, s65, 5
s_and_b32 s70, s70, 15
s_mul_i32 s70, s70, 4352
s_add_u32 s70, s70, s87
buffer_load_dwordx4 v[100:103], v18, s[12:15], s70 offen sc1
s_add_u32 s70, s65, 6
s_and_b32 s70, s70, 15
s_mul_i32 s70, s70, 4352
s_add_u32 s70, s70, s87
buffer_load_dwordx4 v[104:107], v18, s[12:15], s70 offen sc1
s_add_u32 s70, s65, 7
s_and_b32 s70, s70, 15
s_mul_i32 s70, s70, 4352
s_add_u32 s70, s70, s87
buffer_load_dwordx4 v[108:111], v18, s[12:15], s70 offen sc1
s_add_u32 s70, s65, 8
s_and_b32 s70, s70, 15
s_mul_i32 s70, s70, 4352
s_add_u32 s70, s70, s87
buffer_load_dwordx4 v[112:115], v18, s[12:15], s70 offen sc1
s_waitcnt vmcnt(0)
s_branch L_kv1_chk
L_kv2_rt:
s_add_u32 s78, s78, 1
s_cmp_gt_u32 s78, 65536
s_cbranch_scc1 L_kv2_ok
s_add_u32 s70, s65, 9
s_and_b32 s70, s70, 15
s_mul_i32 s70, s70, 4352
s_add_u32 s70, s70, s87
buffer_load_dwordx4 v[116:119], v18, s[12:15], s70 offen sc1
s_add_u32 s70, s65, 10
s_and_b32 s70, s70, 15
s_mul_i32 s70, s70, 4352
s_add_u32 s70, s70, s87
buffer_load_dwordx4 v[120:123], v18, s[12:15], s70 offen sc1
s_add_u32 s70, s65, 11
s_and_b32 s70, s70, 15
s_mul_i32 s70, s70, 4352
s_add_u32 s70, s70, s87
buffer_load_dwordx4 v[124:127], v18, s[12:15], s70 offen sc1
s_add_u32 s70, s65, 12
s_and_b32 s70, s70, 15
s_mul_i32 s70, s70, 4352
s_add_u32 s70, s70, s87
buffer_load_dwordx4 v[128:131], v18, s[12:15], s70 offen sc1
s_waitcnt vmcnt(0)
s_branch L_kv2_chk
L_kv3_rt:
s_add_u32 s78, s78, 1
s_cmp_gt_u32 s78, 65536
s_cbranch_scc1 L_kv3_ok
s_add_u32 s70, s65, 13
s_and_b32 s70, s70, 15
s_mul_i32 s70, s70, 4352
s_add_u32 s70, s70, s87
buffer_load_dwordx4 v[132:135], v18, s[12:15], s70 offen sc1
s_add_u32 s70, s65, 14
s_and_b32 s70, s70, 15
s_mul_i32 s70, s70, 4352
s_add_u32 s70, s70, s87
buffer_load_dwordx4 v[136:139], v18, s[12:15], s70 offen sc1
s_add_u32 s70, s65, 15
s_and_b32 s70, s70, 15
s_mul_i32 s70, s70, 4352
s_add_u32 s70, s70, s87
buffer_load_dwordx4 v[140:143], v18, s[12:15], s70 offen sc1
s_add_u32 s70, s65, 16
s_and_b32 s70, s70, 15
s_mul_i32 s70, s70, 4352
s_add_u32 s70, s70, s87
buffer_load_dwordx4 v[144:147], v18, s[12:15], s70 offen sc1
s_waitcnt vmcnt(0)
s_branch L_kv3_chk
L_z_rt:
s_add_u32 s78, s78, 1
s_cmp_gt_u32 s78, 65536
s_cbranch_scc1 L_z_ok
buffer_load_dwordx4 v[148:151], v55, s[12:15], s88 offen sc1
s_waitcnt vmcnt(0)
s_branch L_z_chk
L_x_rt:
s_add_u32 s78, s78, 1
s_cmp_gt_u32 s78, 65536
s_cbranch_scc1 L_x_ok
buffer_load_dwordx4 v[24:27], v57, s[12:15], 0 offen offset:0 sc1
buffer_load_dwordx4 v[28:31], v57, s[12:15], 0 offen offset:64 sc1
buffer_load_dwordx4 v[32:35], v57, s[12:15], 0 offen offset:128 sc1
buffer_load_dwordx4 v[36:39], v57, s[12:15], 0 offen offset:192 sc1
buffer_load_dwordx4 v[40:43], v57, s[12:15], 0 offen offset:256 sc1
buffer_load_dwordx4 v[44:47], v57, s[12:15], 0 offen offset:320 sc1
buffer_load_dwordx4 v[48:51], v57, s[12:15], 0 offen offset:384 sc1
buffer_load_dwordx4 v[52:55], v57, s[12:15], 0 offen offset:448 sc1
s_waitcnt vmcnt(0)
s_branch L_x_chk
L_y_rt:
s_add_u32 s78, s78, 1
s_cmp_gt_u32 s78, 65536
s_cbranch_scc1 L_y_ok
buffer_load_ushort v61, v64, s[12:15], s72 offen sc1
s_add_u32 s70, s87, 0
buffer_load_dwordx4 v[24:27], v62, s[12:15], s70 offen sc1
s_add_u32 s70, s87, 65536
buffer_load_dwordx4 v[28:31], v62, s[12:15], s70 offen sc1
s_add_u32 s70, s87, 131072
buffer_load_dwordx4 v[32:35], v62, s[12:15], s70 offen sc1
s_add_u32 s70, s87, 196608
buffer_load_dwordx4 v[36:39], v62, s[12:15], s70 offen sc1
s_add_u32 s70, s87, 262144
buffer_load_dwordx4 v[40:43], v62, s[12:15], s70 offen sc1
s_add_u32 s70, s87, 327680
buffer_load_dwordx4 v[44:47], v62, s[12:15], s70 offen sc1
s_add_u32 s70, s87, 393216
buffer_load_dwordx4 v[48:51], v62, s[12:15], s70 offen sc1
s_waitcnt vmcnt(0)
s_branch L_y_chk
L_ex1:
ds_write_b128 v2, v[64:67]
ds_write_b128 v2, v[72:75] offset:1024
ds_write_b128 v5, v[20:23]
s_waitcnt lgkmcnt(0)
s_barrier
ds_read_b128 v[128:131], v3
ds_read_b128 v[132:135], v3 offset:1024
ds_read_b128 v[136:139], v6
s_waitcnt lgkmcnt(1)
v_pk_add_f32 v[128:129], v[128:129], v[68:69]
v_pk_add_f32 v[130:131], v[130:131], v[70:71]
v_pk_add_f32 v[132:133], v[132:133], v[76:77]
v_pk_add_f32 v[134:135], v[134:135], v[78:79]
s_waitcnt lgkmcnt(0)
v_pk_add_f32 v[136:137], v[136:137], v[24:25]
v_pk_add_f32 v[138:139], v[138:139], v[26:27]
s_branch L_ex_d
L_kvp_s:
buffer_store_dwordx4 v[140:143], v16, s[12:15], s72 offen sc1
s_mov_b64 exec, s[92:93]
buffer_store_dwordx4 v[136:139], v4, s[12:15], s73 offen sc1
s_mov_b64 exec, -1
s_branch L_kvp_d
L_o0_rt:
s_add_u32 s78, s78, 1
s_cmp_gt_u32 s78, 65536
s_cbranch_scc1 L_o0_ok
s_add_u32 s70, s65, 0
s_and_b32 s70, s70, 15
s_lshl_b32 s70, s70, 11
s_add_u32 s70, s70, s74
buffer_load_dwordx4 v[56:59], v16, s[12:15], s70 offen offset:0 sc1
buffer_load_dwordx4 v[60:63], v19, s[12:15], s70 offen offset:0 sc1
buffer_load_dwordx4 v[64:67], v16, s[12:15], s70 offen offset:1024 sc1
buffer_load_dwordx4 v[68:71], v19, s[12:15], s70 offen offset:1024 sc1
s_waitcnt vmcnt(0)
s_branch L_o0_chk
L_o1_rt:
s_add_u32 s78, s78, 1
s_cmp_gt_u32 s78, 65536
s_cbranch_scc1 L_o1_ok
s_add_u32 s70, s65, 1
s_and_b32 s70, s70, 15
s_lshl_b32 s70, s70, 11
s_add_u32 s70, s70, s74
buffer_load_dwordx4 v[72:75], v16, s[12:15], s70 offen offset:0 sc1
buffer_load_dwordx4 v[76:79], v19, s[12:15], s70 offen offset:0 sc1
buffer_load_dwordx4 v[80:83], v16, s[12:15], s70 offen offset:1024 sc1
buffer_load_dwordx4 v[84:87], v19, s[12:15], s70 offen offset:1024 sc1
s_waitcnt vmcnt(0)
s_branch L_o1_chk
L_o2_rt:
s_add_u32 s78, s78, 1
s_cmp_gt_u32 s78, 65536
s_cbranch_scc1 L_o2_ok
s_add_u32 s70, s65, 2
s_and_b32 s70, s70, 15
s_lshl_b32 s70, s70, 11
s_add_u32 s70, s70, s74
buffer_load_dwordx4 v[88:91], v16, s[12:15], s70 offen offset:0 sc1
buffer_load_dwordx4 v[92:95], v19, s[12:15], s70 offen offset:0 sc1
buffer_load_dwordx4 v[96:99], v16, s[12:15], s70 offen offset:1024 sc1
buffer_load_dwordx4 v[100:103], v19, s[12:15], s70 offen offset:1024 sc1
s_waitcnt vmcnt(0)
s_branch L_o2_chk
L_o3_rt:
s_add_u32 s78, s78, 1
s_cmp_gt_u32 s78, 65536
s_cbranch_scc1 L_o3_ok
s_add_u32 s70, s65, 3
s_and_b32 s70, s70, 15
s_lshl_b32 s70, s70, 11
s_add_u32 s70, s70, s74
buffer_load_dwordx4 v[104:107], v16, s[12:15], s70 offen offset:0 sc1
buffer_load_dwordx4 v[108:111], v19, s[12:15], s70 offen offset:0 sc1
buffer_load_dwordx4 v[112:115], v16, s[12:15], s70 offen offset:1024 sc1
buffer_load_dwordx4 v[116:119], v19, s[12:15], s70 offen offset:1024 sc1
s_waitcnt vmcnt(0)
s_branch L_o3_chk
L_o4_rt:
s_add_u32 s78, s78, 1
s_cmp_gt_u32 s78, 65536
s_cbranch_scc1 L_o4_ok
s_add_u32 s70, s65, 4
s_and_b32 s70, s70, 15
s_lshl_b32 s70, s70, 11
s_add_u32 s70, s70, s74
buffer_load_dwordx4 v[120:123], v16, s[12:15], s70 offen offset:0 sc1
buffer_load_dwordx4 v[124:127], v19, s[12:15], s70 offen offset:0 sc1
buffer_load_dwordx4 v[128:131], v16, s[12:15], s70 offen offset:1024 sc1
buffer_load_dwordx4 v[132:135], v19, s[12:15], s70 offen offset:1024 sc1
s_waitcnt vmcnt(0)
s_branch L_o4_chk
L_o5_rt:
s_add_u32 s78, s78, 1
s_cmp_gt_u32 s78, 65536
s_cbranch_scc1 L_o5_ok
s_add_u32 s70, s65, 5
s_and_b32 s70, s70, 15
s_lshl_b32 s70, s70, 11
s_add_u32 s70, s70, s74
buffer_load_dwordx4 v[136:139], v16, s[12:15], s70 offen offset:0 sc1
buffer_load_dwordx4 v[140:143], v19, s[12:15], s70 offen offset:0 sc1
buffer_load_dwordx4 v[144:147], v16, s[12:15], s70 offen offset:1024 sc1
buffer_load_dwordx4 v[148:151], v19, s[12:15], s70 offen offset:1024 sc1
s_waitcnt vmcnt(0)
s_branch L_o5_chk
L_o6_rt:
s_add_u32 s78, s78, 1
s_cmp_gt_u32 s78, 65536
s_cbranch_scc1 L_o6_ok
s_add_u32 s70, s65, 6
s_and_b32 s70, s70, 15
s_lshl_b32 s70, s70, 11
s_add_u32 s70, s70, s74
buffer_load_dwordx4 v[56:59], v16, s[12:15], s70 offen offset:0 sc1
buffer_load_dwordx4 v[60:63], v19, s[12:15], s70 offen offset:0 sc1
buffer_load_dwordx4 v[64:67], v16, s[12:15], s70 offen offset:1024 sc1
buffer_load_dwordx4 v[68:71], v19, s[12:15], s70 offen offset:1024 sc1
s_waitcnt vmcnt(0)
s_branch L_o6_chk
L_o7_rt:
s_add_u32 s78, s78, 1
s_cmp_gt_u32 s78, 65536
s_cbranch_scc1 L_o7_ok
s_add_u32 s70, s65, 7
s_and_b32 s70, s70, 15
s_lshl_b32 s70, s70, 11
s_add_u32 s70, s70, s74
buffer_load_dwordx4 v[72:75], v16, s[12:15], s70 offen offset:0 sc1
buffer_load_dwordx4 v[76:79], v19, s[12:15], s70 offen offset:0 sc1
buffer_load_dwordx4 v[80:83], v16, s[12:15], s70 offen offset:1024 sc1
buffer_load_dwordx4 v[84:87], v19, s[12:15], s70 offen offset:1024 sc1
s_waitcnt vmcnt(0)
s_branch L_o7_chk
L_o8_rt:
s_add_u32 s78, s78, 1
s_cmp_gt_u32 s78, 65536
s_cbranch_scc1 L_o8_ok
s_add_u32 s70, s65, 8
s_and_b32 s70, s70, 15
s_lshl_b32 s70, s70, 11
s_add_u32 s70, s70, s74
buffer_load_dwordx4 v[88:91], v16, s[12:15], s70 offen offset:0 sc1
buffer_load_dwordx4 v[92:95], v19, s[12:15], s70 offen offset:0 sc1
buffer_load_dwordx4 v[96:99], v16, s[12:15], s70 offen offset:1024 sc1
buffer_load_dwordx4 v[100:103], v19, s[12:15], s70 offen offset:1024 sc1
s_waitcnt vmcnt(0)
s_branch L_o8_chk
L_o9_rt:
s_add_u32 s78, s78, 1
s_cmp_gt_u32 s78, 65536
s_cbranch_scc1 L_o9_ok
s_add_u32 s70, s65, 9
s_and_b32 s70, s70, 15
s_lshl_b32 s70, s70, 11
s_add_u32 s70, s70, s74
buffer_load_dwordx4 v[104:107], v16, s[12:15], s70 offen offset:0 sc1
buffer_load_dwordx4 v[108:111], v19, s[12:15], s70 offen offset:0 sc1
buffer_load_dwordx4 v[112:115], v16, s[12:15], s70 offen offset:1024 sc1
buffer_load_dwordx4 v[116:119], v19, s[12:15], s70 offen offset:1024 sc1
s_waitcnt vmcnt(0)
s_branch L_o9_chk
L_o10_rt:
s_add_u32 s78, s78, 1
s_cmp_gt_u32 s78, 65536
s_cbranch_scc1 L_o10_ok
s_add_u32 s70, s65, 10
s_and_b32 s70, s70, 15
s_lshl_b32 s70, s70, 11
s_add_u32 s70, s70, s74
buffer_load_dwordx4 v[120:123], v16, s[12:15], s70 offen offset:0 sc1
buffer_load_dwordx4 v[124:127], v19, s[12:15], s70 offen offset:0 sc1
buffer_load_dwordx4 v[128:131], v16, s[12:15], s70 offen offset:1024 sc1
buffer_load_dwordx4 v[132:135], v19, s[12:15], s70 offen offset:1024 sc1
s_waitcnt vmcnt(0)
s_branch L_o10_chk
L_o11_rt:
s_add_u32 s78, s78, 1
s_cmp_gt_u32 s78, 65536
s_cbranch_scc1 L_o11_ok
s_add_u32 s70, s65, 11
s_and_b32 s70, s70, 15
s_lshl_b32 s70, s70, 11
s_add_u32 s70, s70, s74
buffer_load_dwordx4 v[136:139], v16, s[12:15], s70 offen offset:0 sc1
buffer_load_dwordx4 v[140:143], v19, s[12:15], s70 offen offset:0 sc1
buffer_load_dwordx4 v[144:147], v16, s[12:15], s70 offen offset:1024 sc1
buffer_load_dwordx4 v[148:151], v19, s[12:15], s70 offen offset:1024 sc1
s_waitcnt vmcnt(0)
s_branch L_o11_chk
L_o12_rt:
s_add_u32 s78, s78, 1
s_cmp_gt_u32 s78, 65536
s_cbranch_scc1 L_o12_ok
s_add_u32 s70, s65, 12
s_and_b32 s70, s70, 15
s_lshl_b32 s70, s70, 11
s_add_u32 s70, s70, s74
buffer_load_dwordx4 v[56:59], v16, s[12:15], s70 offen offset:0 sc1
buffer_load_dwordx4 v[60:63], v19, s[12:15], s70 offen offset:0 sc1
buffer_load_dwordx4 v[64:67], v16, s[12:15], s70 offen offset:1024 sc1
buffer_load_dwordx4 v[68:71], v19, s[12:15], s70 offen offset:1024 sc1
s_waitcnt vmcnt(0)
s_branch L_o12_chk
L_o13_rt:
s_add_u32 s78, s78, 1
s_cmp_gt_u32 s78, 65536
s_cbranch_scc1 L_o13_ok
s_add_u32 s70, s65, 13
s_and_b32 s70, s70, 15
s_lshl_b32 s70, s70, 11
s_add_u32 s70, s70, s74
buffer_load_dwordx4 v[72:75], v16, s[12:15], s70 offen offset:0 sc1
buffer_load_dwordx4 v[76:79], v19, s[12:15], s70 offen offset:0 sc1
buffer_load_dwordx4 v[80:83], v16, s[12:15], s70 offen offset:1024 sc1
buffer_load_dwordx4 v[84:87], v19, s[12:15], s70 offen offset:1024 sc1
s_waitcnt vmcnt(0)
s_branch L_o13_chk
L_o14_rt:
s_add_u32 s78, s78, 1
s_cmp_gt_u32 s78, 65536
s_cbranch_scc1 L_o14_ok
s_add_u32 s70, s65, 14
s_and_b32 s70, s70, 15
s_lshl_b32 s70, s70, 11
s_add_u32 s70, s70, s74
buffer_load_dwordx4 v[88:91], v16, s[12:15], s70 offen offset:0 sc1
buffer_load_dwordx4 v[92:95], v19, s[12:15], s70 offen offset:0 sc1
buffer_load_dwordx4 v[96:99], v16, s[12:15], s70 offen offset:1024 sc1
buffer_load_dwordx4 v[100:103], v19, s[12:15], s70 offen offset:1024 sc1
s_waitcnt vmcnt(0)
s_branch L_o14_chk
L_o15_rt:
s_add_u32 s78, s78, 1
s_cmp_gt_u32 s78, 65536
s_cbranch_scc1 L_o15_ok
s_add_u32 s70, s65, 15
s_and_b32 s70, s70, 15
s_lshl_b32 s70, s70, 11
s_add_u32 s70, s70, s74
buffer_load_dwordx4 v[104:107], v16, s[12:15], s70 offen offset:0 sc1
buffer_load_dwordx4 v[108:111], v19, s[12:15], s70 offen offset:0 sc1
buffer_load_dwordx4 v[112:115], v16, s[12:15], s70 offen offset:1024 sc1
buffer_load_dwordx4 v[116:119], v19, s[12:15], s70 offen offset:1024 sc1
s_waitcnt vmcnt(0)
s_branch L_o15_chk
L_stp_s:
buffer_store_dwordx4 v[72:75], v4, s[12:15], s72 offen sc1
s_branch L_stp_d
L_st_rt:
s_add_u32 s78, s78, 1
s_cmp_gt_u32 s78, 65536
s_cbranch_scc1 L_st_ok
s_add_u32 s70, s75, 0
buffer_load_dwordx4 v[96:99], v5, s[12:15], s70 offen sc1
s_add_u32 s70, s75, 4096
buffer_load_dwordx4 v[100:103], v5, s[12:15], s70 offen sc1
s_add_u32 s70, s75, 8192
buffer_load_dwordx4 v[104:107], v5, s[12:15], s70 offen sc1
s_add_u32 s70, s75, 12288
buffer_load_dwordx4 v[108:111], v5, s[12:15], s70 offen sc1
s_add_u32 s70, s75, 16384
buffer_load_dwordx4 v[112:115], v5, s[12:15], s70 offen sc1
s_add_u32 s70, s75, 20480
buffer_load_dwordx4 v[116:119], v5, s[12:15], s70 offen sc1
s_add_u32 s70, s75, 24576
buffer_load_dwordx4 v[120:123], v5, s[12:15], s70 offen sc1
s_add_u32 s70, s75, 28672
buffer_load_dwordx4 v[124:127], v5, s[12:15], s70 offen sc1
s_waitcnt vmcnt(0)
s_branch L_st_chk
L_rec_rt:
s_add_u32 s78, s78, 1
s_cmp_gt_u32 s78, 65536
s_cbranch_scc1 L_rec_ok
buffer_load_dwordx4 v[84:87], v8, s[12:15], s75 offen sc1
s_waitcnt vmcnt(0)
s_branch L_rec_chk
.section .rodata,"a"
.p2align 6
.amdhsa_kernel sequential_preLN__linear_attn_block__moe_arch_mod__prompt_kernel
  .amdhsa_next_free_vgpr 256
  .amdhsa_next_free_sgpr 102
  .amdhsa_accum_offset 152
  .amdhsa_group_segment_fixed_size 0
  .amdhsa_kernarg_size 88
  .amdhsa_user_sgpr_count 2
  .amdhsa_user_sgpr_kernarg_segment_ptr 1
  .amdhsa_system_sgpr_workgroup_id_x 1
  .amdhsa_float_denorm_mode_32 3
.end_amdhsa_kernel
```

```asm
; @launch grid=(256,1,1) block=(512,1,1) lds=163840
.amdgcn_target "amdgcn-amd-amdhsa--gfx950"
.text
.globl sequential_preLN__linear_attn_block__moe_arch_mod__prompt_kernel
.p2align 8
.type sequential_preLN__linear_attn_block__moe_arch_mod__prompt_kernel,@function
sequential_preLN__linear_attn_block__moe_arch_mod__prompt_kernel:
s_cmp_ge_u32 s2, 256
s_cbranch_scc1 L_end
s_load_dwordx16 s[40:55], s[0:1], 0
s_load_dwordx2 s[56:57], s[0:1], 64
s_load_dwordx2 s[58:59], s[0:1], 80
v_lshrrev_b32 v2, 6, v0
v_and_b32 v1, 63, v0
v_readfirstlane_b32 s60, v2
s_and_b32 s62, s2, 7
s_lshr_b32 s63, s2, 3
s_lshl_b32 s64, s62, 1
s_and_b32 s70, s63, 1
s_add_u32 s64, s64, s70
s_lshr_b32 s65, s63, 1
s_mul_i32 s79, s62, 28
s_add_u32 s79, s79, s63
s_mov_b32 s78, 0
s_lshr_b32 s61, s60, 2
s_and_b32 s60, s60, 3
s_lshr_b32 s66, s60, 1
s_and_b32 s67, s60, 1
v_lshlrev_b32 v16, 4, v1
s_cmp_eq_u32 s61, 0
s_cbranch_scc1 L_compute
v_mov_b32 v18, v16
s_lshl_b32 s70, s65, 2
s_add_u32 s70, s70, s60
s_lshl_b32 s70, s70, 16
v_lshrrev_b32 v2, 3, v1
v_lshlrev_b32 v5, 11, v2
v_add_u32 v5, s70, v5
v_lshrrev_b32 v3, 4, v1
v_and_b32 v4, 7, v1
v_xor_b32 v3, v3, v4
v_xor_b32 v6, 0, v3
v_lshl_add_u32 v6, v6, 4, v5
v_add_u32 v8, 0, v6
v_xor_b32 v6, 4, v3
v_lshl_add_u32 v6, v6, 4, v5
v_add_u32 v9, 15360, v6
v_xor_b32 v6, 0, v3
v_lshl_add_u32 v6, v6, 4, v5
v_add_u32 v10, 30720, v6
v_xor_b32 v6, 4, v3
v_lshl_add_u32 v6, v6, 4, v5
v_add_u32 v11, 46080, v6
s_lshl_b32 s70, s60, 4
v_add_u32 v5, s70, v2
v_mul_u32_u24 v5, 6144, v5
s_lshl_b32 s70, s64, 7
v_add_u32 v5, s70, v5
v_bfe_u32 v3, v1, 4, 1
v_lshlrev_b32 v3, 1, v3
v_xor_b32 v3, v3, v4
v_xor_b32 v6, 0, v3
v_lshl_add_u32 v6, v6, 4, v5
v_add_u32 v12, 0, v6
v_xor_b32 v6, 4, v3
v_lshl_add_u32 v6, v6, 4, v5
v_add_u32 v13, 48128, v6
v_xor_b32 v6, 0, v3
v_lshl_add_u32 v6, v6, 4, v5
v_add_u32 v14, 0, v6
v_xor_b32 v6, 4, v3
v_lshl_add_u32 v6, v6, 4, v5
v_add_u32 v15, 48128, v6
v_xor_b32 v6, 0, v3
v_lshl_add_u32 v6, v6, 4, v5
v_add_u32 v16, 4096, v6
v_xor_b32 v6, 4, v3
v_lshl_add_u32 v6, v6, 4, v5
v_add_u32 v17, 52224, v6
s_lshl_b32 s76, s60, 12
s_mul_i32 s77, s60, 6144
s_add_u32 s77, s77, 16384
s_mul_i32 s75, s65, 393216
s_lshl_b32 s74, s65, 7
s_waitcnt lgkmcnt(0)
s_mov_b32 s4, s40
s_and_b32 s5, s41, 0xffff
s_mov_b32 s6, 4194304
s_mov_b32 s7, 0x20000
s_mov_b32 s8, s42
s_and_b32 s9, s43, 0xffff
s_mov_b32 s10, 6291456
s_mov_b32 s11, 0x20000
s_add_u32 m0, s76, 0
s_nop 0
buffer_load_dwordx4 v8, s[4:7], s74 offen offset:0 lds
buffer_load_dwordx4 v9, s[4:7], s74 offen offset:1024 lds
buffer_load_dwordx4 v10, s[4:7], s74 offen offset:2048 lds
buffer_load_dwordx4 v11, s[4:7], s74 offen offset:3072 lds
s_add_u32 m0, s77, 0
s_nop 0
buffer_load_dwordx4 v12, s[8:11], s75 offen offset:0 lds
buffer_load_dwordx4 v13, s[8:11], s75 offen offset:1024 lds
buffer_load_dwordx4 v14, s[8:11], s75 offen offset:2048 lds
buffer_load_dwordx4 v15, s[8:11], s75 offen offset:3072 lds
s_add_u32 m0, s77, 4096
s_nop 0
buffer_load_dwordx4 v16, s[8:11], s75 offen offset:0 lds
buffer_load_dwordx4 v17, s[8:11], s75 offen offset:1024 lds
s_add_u32 s74, s74, 128
s_add_u32 s75, s75, 393216
s_and_b32 s74, s74, 2047
s_cselect_b32 s75, s75, 0
s_add_u32 m0, s76, 40960
s_nop 0
buffer_load_dwordx4 v8, s[4:7], s74 offen offset:0 lds
buffer_load_dwordx4 v9, s[4:7], s74 offen offset:1024 lds
buffer_load_dwordx4 v10, s[4:7], s74 offen offset:2048 lds
buffer_load_dwordx4 v11, s[4:7], s74 offen offset:3072 lds
s_mov_b32 s12, s58
s_and_b32 s13, s59, 0xffff
s_mov_b32 s14, 268435456
s_mov_b32 s15, 0x20000
s_mov_b32 s16, s44
s_and_b32 s17, s45, 0xffff
s_mov_b32 s18, 2097152
s_mov_b32 s19, 0x20000
s_mov_b32 s20, s56
s_and_b32 s21, s57, 0xffff
s_mov_b32 s22, 4194304
s_mov_b32 s23, 0x20000
s_mov_b32 s24, s50
s_and_b32 s25, s51, 0xffff
s_mov_b32 s26, 7340032
s_mov_b32 s27, 0x20000
s_mov_b32 s28, s52
s_and_b32 s29, s53, 0xffff
s_mov_b32 s30, 7340032
s_mov_b32 s31, 0x20000
s_mov_b32 s32, s54
s_and_b32 s33, s55, 0xffff
s_mov_b32 s34, 7340032
s_mov_b32 s35, 0x20000
s_waitcnt vmcnt(4)
s_barrier
s_add_u32 m0, s77, 40960
s_nop 0
buffer_load_dwordx4 v12, s[8:11], s75 offen offset:0 lds
buffer_load_dwordx4 v13, s[8:11], s75 offen offset:1024 lds
buffer_load_dwordx4 v14, s[8:11], s75 offen offset:2048 lds
buffer_load_dwordx4 v15, s[8:11], s75 offen offset:3072 lds
s_add_u32 m0, s77, 45056
s_nop 0
buffer_load_dwordx4 v16, s[8:11], s75 offen offset:0 lds
buffer_load_dwordx4 v17, s[8:11], s75 offen offset:1024 lds
s_add_u32 s74, s74, 128
s_add_u32 s75, s75, 393216
s_and_b32 s74, s74, 2047
s_cselect_b32 s75, s75, 0
s_add_u32 m0, s76, 81920
s_nop 0
buffer_load_dwordx4 v8, s[4:7], s74 offen offset:0 lds
buffer_load_dwordx4 v9, s[4:7], s74 offen offset:1024 lds
buffer_load_dwordx4 v10, s[4:7], s74 offen offset:2048 lds
buffer_load_dwordx4 v11, s[4:7], s74 offen offset:3072 lds
s_add_u32 m0, s77, 81920
s_nop 0
buffer_load_dwordx4 v12, s[8:11], s75 offen offset:0 lds
buffer_load_dwordx4 v13, s[8:11], s75 offen offset:1024 lds
buffer_load_dwordx4 v14, s[8:11], s75 offen offset:2048 lds
buffer_load_dwordx4 v15, s[8:11], s75 offen offset:3072 lds
s_add_u32 m0, s77, 86016
s_nop 0
buffer_load_dwordx4 v16, s[8:11], s75 offen offset:0 lds
buffer_load_dwordx4 v17, s[8:11], s75 offen offset:1024 lds
s_add_u32 s74, s74, 128
s_add_u32 s75, s75, 393216
s_and_b32 s74, s74, 2047
s_cselect_b32 s75, s75, 0
s_waitcnt vmcnt(10)
s_barrier
s_add_u32 m0, s76, 0
s_nop 0
buffer_load_dwordx4 v8, s[4:7], s74 offen offset:0 lds
buffer_load_dwordx4 v9, s[4:7], s74 offen offset:1024 lds
buffer_load_dwordx4 v10, s[4:7], s74 offen offset:2048 lds
buffer_load_dwordx4 v11, s[4:7], s74 offen offset:3072 lds
s_add_u32 m0, s77, 0
s_nop 0
buffer_load_dwordx4 v12, s[8:11], s75 offen offset:0 lds
buffer_load_dwordx4 v13, s[8:11], s75 offen offset:1024 lds
buffer_load_dwordx4 v14, s[8:11], s75 offen offset:2048 lds
buffer_load_dwordx4 v15, s[8:11], s75 offen offset:3072 lds
s_add_u32 m0, s77, 4096
s_nop 0
buffer_load_dwordx4 v16, s[8:11], s75 offen offset:0 lds
buffer_load_dwordx4 v17, s[8:11], s75 offen offset:1024 lds
s_add_u32 s74, s74, 128
s_add_u32 s75, s75, 393216
s_and_b32 s74, s74, 2047
s_cselect_b32 s75, s75, 0
s_lshl_b32 s70, s65, 7
s_lshl_b32 s71, s64, 3
s_add_u32 s70, s70, s71
s_lshl_b32 s71, s60, 1
s_add_u32 s87, s70, s71
s_lshl_b32 s70, s87, 11
v_mov_b32 v2, 0
buffer_load_dword v19, v2, s[12:15], 0 offen sc1
buffer_load_dwordx4 v[20:23], v18, s[4:7], s70 offen offset:0
buffer_load_dwordx4 v[24:27], v18, s[4:7], s70 offen offset:1024
buffer_load_dwordx4 v[28:31], v18, s[4:7], s70 offen offset:2048
buffer_load_dwordx4 v[32:35], v18, s[4:7], s70 offen offset:3072
s_waitcnt vmcnt(15)
s_barrier
s_add_u32 m0, s76, 40960
s_nop 0
buffer_load_dwordx4 v8, s[4:7], s74 offen offset:0 lds
buffer_load_dwordx4 v9, s[4:7], s74 offen offset:1024 lds
buffer_load_dwordx4 v10, s[4:7], s74 offen offset:2048 lds
buffer_load_dwordx4 v11, s[4:7], s74 offen offset:3072 lds
s_add_u32 m0, s77, 40960
s_nop 0
buffer_load_dwordx4 v12, s[8:11], s75 offen offset:0 lds
buffer_load_dwordx4 v13, s[8:11], s75 offen offset:1024 lds
buffer_load_dwordx4 v14, s[8:11], s75 offen offset:2048 lds
buffer_load_dwordx4 v15, s[8:11], s75 offen offset:3072 lds
s_add_u32 m0, s77, 45056
s_nop 0
buffer_load_dwordx4 v16, s[8:11], s75 offen offset:0 lds
buffer_load_dwordx4 v17, s[8:11], s75 offen offset:1024 lds
s_add_u32 s74, s74, 128
s_add_u32 s75, s75, 393216
s_and_b32 s74, s74, 2047
s_cselect_b32 s75, s75, 0
s_waitcnt vmcnt(15)
s_barrier
s_add_u32 m0, s76, 81920
s_nop 0
buffer_load_dwordx4 v8, s[4:7], s74 offen offset:0 lds
buffer_load_dwordx4 v9, s[4:7], s74 offen offset:1024 lds
buffer_load_dwordx4 v10, s[4:7], s74 offen offset:2048 lds
buffer_load_dwordx4 v11, s[4:7], s74 offen offset:3072 lds
s_add_u32 m0, s77, 81920
s_nop 0
buffer_load_dwordx4 v12, s[8:11], s75 offen offset:0 lds
buffer_load_dwordx4 v13, s[8:11], s75 offen offset:1024 lds
buffer_load_dwordx4 v14, s[8:11], s75 offen offset:2048 lds
buffer_load_dwordx4 v15, s[8:11], s75 offen offset:3072 lds
s_add_u32 m0, s77, 86016
s_nop 0
buffer_load_dwordx4 v16, s[8:11], s75 offen offset:0 lds
buffer_load_dwordx4 v17, s[8:11], s75 offen offset:1024 lds
s_add_u32 s74, s74, 128
s_add_u32 s75, s75, 393216
s_and_b32 s74, s74, 2047
s_cselect_b32 s75, s75, 0
s_waitcnt vmcnt(20)
v_readfirstlane_b32 s68, v19
v_lshlrev_b32 v36, 16, v20
v_and_b32 v37, 0xffff0000, v20
v_lshlrev_b32 v38, 16, v21
v_and_b32 v39, 0xffff0000, v21
v_lshlrev_b32 v40, 16, v22
v_and_b32 v41, 0xffff0000, v22
v_lshlrev_b32 v42, 16, v23
v_and_b32 v43, 0xffff0000, v23
v_lshlrev_b32 v44, 16, v24
v_and_b32 v45, 0xffff0000, v24
v_lshlrev_b32 v46, 16, v25
v_and_b32 v47, 0xffff0000, v25
v_lshlrev_b32 v48, 16, v26
v_and_b32 v49, 0xffff0000, v26
v_lshlrev_b32 v50, 16, v27
v_and_b32 v51, 0xffff0000, v27
v_lshlrev_b32 v52, 16, v28
v_and_b32 v53, 0xffff0000, v28
v_lshlrev_b32 v54, 16, v29
v_and_b32 v55, 0xffff0000, v29
v_lshlrev_b32 v56, 16, v30
v_and_b32 v57, 0xffff0000, v30
v_lshlrev_b32 v58, 16, v31
v_and_b32 v59, 0xffff0000, v31
v_lshlrev_b32 v60, 16, v32
v_and_b32 v61, 0xffff0000, v32
v_lshlrev_b32 v62, 16, v33
v_and_b32 v63, 0xffff0000, v33
v_lshlrev_b32 v64, 16, v34
v_and_b32 v65, 0xffff0000, v34
v_lshlrev_b32 v66, 16, v35
v_and_b32 v67, 0xffff0000, v35
s_add_u32 s68, s68, 1
v_pk_add_f32 v[20:21], v[36:37], v[38:39]
v_pk_add_f32 v[22:23], v[40:41], v[42:43]
v_pk_add_f32 v[24:25], v[44:45], v[46:47]
v_pk_add_f32 v[26:27], v[48:49], v[50:51]
v_pk_add_f32 v[20:21], v[20:21], v[22:23]
v_pk_add_f32 v[24:25], v[24:25], v[26:27]
v_pk_add_f32 v[20:21], v[20:21], v[24:25]
v_add_f32 v2, v20, v21
v_pk_add_f32 v[28:29], v[52:53], v[54:55]
v_pk_add_f32 v[30:31], v[56:57], v[58:59]
v_pk_add_f32 v[32:33], v[60:61], v[62:63]
v_pk_add_f32 v[34:35], v[64:65], v[66:67]
v_pk_add_f32 v[28:29], v[28:29], v[30:31]
v_pk_add_f32 v[32:33], v[32:33], v[34:35]
v_pk_add_f32 v[28:29], v[28:29], v[32:33]
v_add_f32 v4, v28, v29
v_add_f32_dpp v2, v2, v2 row_ror:1 row_mask:0xf bank_mask:0xf
s_nop 0
v_add_f32_dpp v4, v4, v4 row_ror:1 row_mask:0xf bank_mask:0xf
v_add_f32_dpp v2, v2, v2 row_ror:2 row_mask:0xf bank_mask:0xf
s_nop 0
v_add_f32_dpp v4, v4, v4 row_ror:2 row_mask:0xf bank_mask:0xf
v_add_f32_dpp v2, v2, v2 row_ror:4 row_mask:0xf bank_mask:0xf
s_nop 0
v_add_f32_dpp v4, v4, v4 row_ror:4 row_mask:0xf bank_mask:0xf
v_add_f32_dpp v2, v2, v2 row_ror:8 row_mask:0xf bank_mask:0xf
s_nop 0
v_add_f32_dpp v4, v4, v4 row_ror:8 row_mask:0xf bank_mask:0xf
v_mov_b32 v6, v2
v_mov_b32 v7, v4
s_nop 0
v_permlane16_swap_b32 v2, v6
v_permlane16_swap_b32 v4, v7
v_add_f32 v2, v2, v6
v_add_f32 v4, v4, v7
v_mov_b32 v6, v2
v_mov_b32 v7, v4
s_nop 0
v_permlane32_swap_b32 v2, v6
v_permlane32_swap_b32 v4, v7
v_add_f32 v2, v2, v6
v_add_f32 v4, v4, v7
v_mul_f32 v2, 0xba800000, v2
v_mul_f32 v4, 0xba800000, v4
s_waitcnt vmcnt(10)
s_barrier
s_add_u32 m0, s76, 0
s_nop 0
buffer_load_dwordx4 v8, s[4:7], s74 offen offset:0 lds
buffer_load_dwordx4 v9, s[4:7], s74 offen offset:1024 lds
buffer_load_dwordx4 v10, s[4:7], s74 offen offset:2048 lds
buffer_load_dwordx4 v11, s[4:7], s74 offen offset:3072 lds
s_add_u32 m0, s77, 0
s_nop 0
buffer_load_dwordx4 v12, s[8:11], s75 offen offset:0 lds
buffer_load_dwordx4 v13, s[8:11], s75 offen offset:1024 lds
buffer_load_dwordx4 v14, s[8:11], s75 offen offset:2048 lds
buffer_load_dwordx4 v15, s[8:11], s75 offen offset:3072 lds
s_add_u32 m0, s77, 4096
s_nop 0
buffer_load_dwordx4 v16, s[8:11], s75 offen offset:0 lds
buffer_load_dwordx4 v17, s[8:11], s75 offen offset:1024 lds
s_add_u32 s74, s74, 128
s_add_u32 s75, s75, 393216
s_and_b32 s74, s74, 2047
s_cselect_b32 s75, s75, 0
v_pk_add_f32 v[36:37], v[36:37], v[2:3] op_sel_hi:[1,0]
v_pk_add_f32 v[38:39], v[38:39], v[2:3] op_sel_hi:[1,0]
v_pk_add_f32 v[40:41], v[40:41], v[2:3] op_sel_hi:[1,0]
v_pk_add_f32 v[42:43], v[42:43], v[2:3] op_sel_hi:[1,0]
v_pk_add_f32 v[44:45], v[44:45], v[2:3] op_sel_hi:[1,0]
v_pk_add_f32 v[46:47], v[46:47], v[2:3] op_sel_hi:[1,0]
v_pk_add_f32 v[48:49], v[48:49], v[2:3] op_sel_hi:[1,0]
v_pk_add_f32 v[50:51], v[50:51], v[2:3] op_sel_hi:[1,0]
v_pk_mul_f32 v[20:21], v[36:37], v[36:37]
v_pk_mul_f32 v[22:23], v[38:39], v[38:39]
v_pk_fma_f32 v[20:21], v[40:41], v[40:41], v[20:21]
v_pk_fma_f32 v[22:23], v[42:43], v[42:43], v[22:23]
v_pk_fma_f32 v[20:21], v[44:45], v[44:45], v[20:21]
v_pk_fma_f32 v[22:23], v[46:47], v[46:47], v[22:23]
v_pk_fma_f32 v[20:21], v[48:49], v[48:49], v[20:21]
v_pk_fma_f32 v[22:23], v[50:51], v[50:51], v[22:23]
v_pk_add_f32 v[20:21], v[20:21], v[22:23]
v_add_f32 v3, v20, v21
v_pk_add_f32 v[52:53], v[52:53], v[4:5] op_sel_hi:[1,0]
v_pk_add_f32 v[54:55], v[54:55], v[4:5] op_sel_hi:[1,0]
v_pk_add_f32 v[56:57], v[56:57], v[4:5] op_sel_hi:[1,0]
v_pk_add_f32 v[58:59], v[58:59], v[4:5] op_sel_hi:[1,0]
v_pk_add_f32 v[60:61], v[60:61], v[4:5] op_sel_hi:[1,0]
v_pk_add_f32 v[62:63], v[62:63], v[4:5] op_sel_hi:[1,0]
v_pk_add_f32 v[64:65], v[64:65], v[4:5] op_sel_hi:[1,0]
v_pk_add_f32 v[66:67], v[66:67], v[4:5] op_sel_hi:[1,0]
v_pk_mul_f32 v[28:29], v[52:53], v[52:53]
v_pk_mul_f32 v[30:31], v[54:55], v[54:55]
v_pk_fma_f32 v[28:29], v[56:57], v[56:57], v[28:29]
v_pk_fma_f32 v[30:31], v[58:59], v[58:59], v[30:31]
v_pk_fma_f32 v[28:29], v[60:61], v[60:61], v[28:29]
v_pk_fma_f32 v[30:31], v[62:63], v[62:63], v[30:31]
v_pk_fma_f32 v[28:29], v[64:65], v[64:65], v[28:29]
v_pk_fma_f32 v[30:31], v[66:67], v[66:67], v[30:31]
v_pk_add_f32 v[28:29], v[28:29], v[30:31]
v_add_f32 v5, v28, v29
v_add_f32_dpp v3, v3, v3 row_ror:1 row_mask:0xf bank_mask:0xf
s_nop 0
v_add_f32_dpp v5, v5, v5 row_ror:1 row_mask:0xf bank_mask:0xf
v_add_f32_dpp v3, v3, v3 row_ror:2 row_mask:0xf bank_mask:0xf
s_nop 0
v_add_f32_dpp v5, v5, v5 row_ror:2 row_mask:0xf bank_mask:0xf
v_add_f32_dpp v3, v3, v3 row_ror:4 row_mask:0xf bank_mask:0xf
s_nop 0
v_add_f32_dpp v5, v5, v5 row_ror:4 row_mask:0xf bank_mask:0xf
v_add_f32_dpp v3, v3, v3 row_ror:8 row_mask:0xf bank_mask:0xf
s_nop 0
v_add_f32_dpp v5, v5, v5 row_ror:8 row_mask:0xf bank_mask:0xf
v_mov_b32 v6, v3
v_mov_b32 v7, v5
s_nop 0
v_permlane16_swap_b32 v3, v6
v_permlane16_swap_b32 v5, v7
v_add_f32 v3, v3, v6
v_add_f32 v5, v5, v7
v_mov_b32 v6, v3
v_mov_b32 v7, v5
s_nop 0
v_permlane32_swap_b32 v3, v6
v_permlane32_swap_b32 v5, v7
v_add_f32 v3, v3, v6
v_add_f32 v5, v5, v7
v_mov_b32 v6, 0x3727c5ac
v_fmac_f32 v6, 0x3a800000, v3
v_rsq_f32 v3, v6
v_mov_b32 v6, 0x3727c5ac
v_fmac_f32 v6, 0x3a800000, v5
v_rsq_f32 v5, v6
v_cmp_eq_u32 vcc, 1, v1
s_nop 1
v_cndmask_b32 v20, v2, v4, vcc
v_cndmask_b32 v21, v3, v5, vcc
v_mov_b32 v22, 0
v_mov_b32 v23, s68
s_lshl_b32 s70, s87, 4
s_add_u32 s70, s70, 8192
s_mov_b64 exec, 3
buffer_store_dwordx4 v[20:23], v18, s[12:15], s70 offen sc1
s_mov_b64 exec, -1
s_waitcnt vmcnt(11)
s_barrier
s_add_u32 m0, s76, 40960
s_nop 0
buffer_load_dwordx4 v8, s[4:7], s74 offen offset:0 lds
buffer_load_dwordx4 v9, s[4:7], s74 offen offset:1024 lds
buffer_load_dwordx4 v10, s[4:7], s74 offen offset:2048 lds
buffer_load_dwordx4 v11, s[4:7], s74 offen offset:3072 lds
s_add_u32 m0, s77, 40960
s_nop 0
buffer_load_dwordx4 v12, s[8:11], s75 offen offset:0 lds
buffer_load_dwordx4 v13, s[8:11], s75 offen offset:1024 lds
buffer_load_dwordx4 v14, s[8:11], s75 offen offset:2048 lds
buffer_load_dwordx4 v15, s[8:11], s75 offen offset:3072 lds
s_add_u32 m0, s77, 45056
s_nop 0
buffer_load_dwordx4 v16, s[8:11], s75 offen offset:0 lds
buffer_load_dwordx4 v17, s[8:11], s75 offen offset:1024 lds
s_add_u32 s74, s74, 128
s_add_u32 s75, s75, 393216
s_and_b32 s74, s74, 2047
s_cselect_b32 s75, s75, 0
s_getreg_b32 s71, hwreg(HW_REG_XCC_ID, 0, 4)
v_mov_b32 v24, s71
v_mov_b32 v25, 0
v_mov_b32 v26, 0
v_mov_b32 v27, s68
s_lshl_b32 s70, s64, 4
s_add_u32 s70, s70, s65
s_lshl_b32 s70, s70, 4
s_add_u32 s70, s70, 4096
s_mov_b64 exec, 1
buffer_store_dwordx4 v[24:27], v18, s[12:15], s70 offen sc1
s_mov_b64 exec, -1
s_waitcnt vmcnt(12)
s_barrier
s_add_u32 m0, s76, 81920
s_nop 0
buffer_load_dwordx4 v8, s[4:7], s74 offen offset:0 lds
buffer_load_dwordx4 v9, s[4:7], s74 offen offset:1024 lds
buffer_load_dwordx4 v10, s[4:7], s74 offen offset:2048 lds
buffer_load_dwordx4 v11, s[4:7], s74 offen offset:3072 lds
s_add_u32 m0, s77, 81920
s_nop 0
buffer_load_dwordx4 v12, s[8:11], s75 offen offset:0 lds
buffer_load_dwordx4 v13, s[8:11], s75 offen offset:1024 lds
buffer_load_dwordx4 v14, s[8:11], s75 offen offset:2048 lds
buffer_load_dwordx4 v15, s[8:11], s75 offen offset:3072 lds
s_add_u32 m0, s77, 86016
s_nop 0
buffer_load_dwordx4 v16, s[8:11], s75 offen offset:0 lds
buffer_load_dwordx4 v17, s[8:11], s75 offen offset:1024 lds
s_add_u32 s74, s74, 128
s_add_u32 s75, s75, 393216
s_and_b32 s74, s74, 2047
s_cselect_b32 s75, s75, 0
s_waitcnt vmcnt(11)
s_barrier
s_add_u32 m0, s76, 0
s_nop 0
buffer_load_dwordx4 v8, s[4:7], s74 offen offset:0 lds
buffer_load_dwordx4 v9, s[4:7], s74 offen offset:1024 lds
buffer_load_dwordx4 v10, s[4:7], s74 offen offset:2048 lds
buffer_load_dwordx4 v11, s[4:7], s74 offen offset:3072 lds
s_add_u32 m0, s77, 0
s_nop 0
buffer_load_dwordx4 v12, s[8:11], s75 offen offset:0 lds
buffer_load_dwordx4 v13, s[8:11], s75 offen offset:1024 lds
buffer_load_dwordx4 v14, s[8:11], s75 offen offset:2048 lds
buffer_load_dwordx4 v15, s[8:11], s75 offen offset:3072 lds
s_add_u32 m0, s77, 4096
s_nop 0
buffer_load_dwordx4 v16, s[8:11], s75 offen offset:0 lds
buffer_load_dwordx4 v17, s[8:11], s75 offen offset:1024 lds
s_add_u32 s74, s74, 128
s_add_u32 s75, s75, 393216
s_and_b32 s74, s74, 2047
s_cselect_b32 s75, s75, 0
s_waitcnt vmcnt(10)
s_barrier
s_add_u32 m0, s76, 40960
s_nop 0
buffer_load_dwordx4 v8, s[4:7], s74 offen offset:0 lds
buffer_load_dwordx4 v9, s[4:7], s74 offen offset:1024 lds
buffer_load_dwordx4 v10, s[4:7], s74 offen offset:2048 lds
buffer_load_dwordx4 v11, s[4:7], s74 offen offset:3072 lds
s_add_u32 m0, s77, 40960
s_nop 0
buffer_load_dwordx4 v12, s[8:11], s75 offen offset:0 lds
buffer_load_dwordx4 v13, s[8:11], s75 offen offset:1024 lds
buffer_load_dwordx4 v14, s[8:11], s75 offen offset:2048 lds
buffer_load_dwordx4 v15, s[8:11], s75 offen offset:3072 lds
s_add_u32 m0, s77, 45056
s_nop 0
buffer_load_dwordx4 v16, s[8:11], s75 offen offset:0 lds
buffer_load_dwordx4 v17, s[8:11], s75 offen offset:1024 lds
s_add_u32 s74, s74, 128
s_add_u32 s75, s75, 393216
s_and_b32 s74, s74, 2047
s_cselect_b32 s75, s75, 0
v_lshrrev_b32 v2, 3, v1
v_lshlrev_b32 v2, 11, v2
v_bfe_u32 v3, v1, 4, 2
v_lshlrev_b32 v3, 1, v3
v_and_b32 v4, 7, v1
v_xor_b32 v3, v3, v4
v_lshl_add_u32 v2, v3, 4, v2
s_lshl_b32 s70, s65, 7
v_add_u32 v48, s70, v2
v_add_u32 v49, 15360, v48
v_add_u32 v50, 30720, v48
v_add_u32 v51, 46080, v48
s_waitcnt vmcnt(10)
s_barrier
s_add_u32 m0, s76, 81920
s_nop 0
buffer_load_dwordx4 v8, s[4:7], s74 offen offset:0 lds
buffer_load_dwordx4 v9, s[4:7], s74 offen offset:1024 lds
buffer_load_dwordx4 v10, s[4:7], s74 offen offset:2048 lds
buffer_load_dwordx4 v11, s[4:7], s74 offen offset:3072 lds
s_add_u32 m0, s77, 81920
s_nop 0
buffer_load_dwordx4 v12, s[8:11], s75 offen offset:0 lds
buffer_load_dwordx4 v13, s[8:11], s75 offen offset:1024 lds
buffer_load_dwordx4 v14, s[8:11], s75 offen offset:2048 lds
buffer_load_dwordx4 v15, s[8:11], s75 offen offset:3072 lds
s_add_u32 m0, s77, 86016
s_nop 0
buffer_load_dwordx4 v16, s[8:11], s75 offen offset:0 lds
buffer_load_dwordx4 v17, s[8:11], s75 offen offset:1024 lds
s_add_u32 s74, s74, 128
s_add_u32 s75, s75, 393216
s_and_b32 s74, s74, 2047
s_cselect_b32 s75, s75, 0
s_waitcnt vmcnt(10)
s_barrier
s_add_u32 m0, s76, 0
s_nop 0
buffer_load_dwordx4 v8, s[4:7], s74 offen offset:0 lds
buffer_load_dwordx4 v9, s[4:7], s74 offen offset:1024 lds
buffer_load_dwordx4 v10, s[4:7], s74 offen offset:2048 lds
buffer_load_dwordx4 v11, s[4:7], s74 offen offset:3072 lds
s_add_u32 m0, s77, 0
s_nop 0
buffer_load_dwordx4 v12, s[8:11], s75 offen offset:0 lds
buffer_load_dwordx4 v13, s[8:11], s75 offen offset:1024 lds
buffer_load_dwordx4 v14, s[8:11], s75 offen offset:2048 lds
buffer_load_dwordx4 v15, s[8:11], s75 offen offset:3072 lds
s_add_u32 m0, s77, 4096
s_nop 0
buffer_load_dwordx4 v16, s[8:11], s75 offen offset:0 lds
buffer_load_dwordx4 v17, s[8:11], s75 offen offset:1024 lds
s_add_u32 s74, s74, 128
s_add_u32 s75, s75, 393216
s_and_b32 s74, s74, 2047
s_cselect_b32 s75, s75, 0
v_lshrrev_b32 v2, 4, v1
v_and_b32 v3, 15, v1
v_lshlrev_b32 v44, 10, v2
v_lshl_add_u32 v44, v3, 4, v44
s_lshl_b32 s70, s60, 8
v_add_u32 v44, s70, v44
s_lshl_b32 s87, s64, 14
s_add_u32 s87, s87, 65536
v_and_b32 v45, 31, v1
v_lshlrev_b32 v45, 4, v45
s_lshl_b32 s88, s65, 11
s_lshl_b32 s70, s60, 9
s_add_u32 s88, s88, s70
s_add_u32 s88, s88, 8192
s_lshl_b32 s70, s64, 8
s_add_u32 s70, s70, 4096
v_lshlrev_b32 v4, 4, v3
v_add_u32 v4, s70, v4
s_lshl_b32 s70, s64, 4
s_add_u32 s70, s70, 4096
v_lshlrev_b32 v5, 8, v3
v_add_u32 v5, s70, v5
v_and_b32 v6, 1, v2
v_cmp_eq_u32 vcc, 1, v6
s_nop 1
v_cndmask_b32 v46, v4, v5, vcc
s_add_u32 s70, s87, 0
buffer_load_dwordx4 v[20:23], v44, s[12:15], s70 offen sc1
s_add_u32 s70, s87, 4096
buffer_load_dwordx4 v[24:27], v44, s[12:15], s70 offen sc1
s_add_u32 s70, s87, 8192
buffer_load_dwordx4 v[28:31], v44, s[12:15], s70 offen sc1
s_add_u32 s70, s87, 12288
buffer_load_dwordx4 v[32:35], v44, s[12:15], s70 offen sc1
buffer_load_dwordx4 v[36:39], v45, s[12:15], s88 offen sc1
buffer_load_dwordx4 v[40:43], v46, s[12:15], 0 offen offset:0 sc1
s_waitcnt vmcnt(16)
s_barrier
s_add_u32 m0, s76, 40960
s_nop 0
buffer_load_dwordx4 v8, s[4:7], s74 offen offset:0 lds
buffer_load_dwordx4 v9, s[4:7], s74 offen offset:1024 lds
buffer_load_dwordx4 v10, s[4:7], s74 offen offset:2048 lds
buffer_load_dwordx4 v11, s[4:7], s74 offen offset:3072 lds
s_add_u32 m0, s77, 40960
s_nop 0
buffer_load_dwordx4 v12, s[8:11], s75 offen offset:0 lds
buffer_load_dwordx4 v13, s[8:11], s75 offen offset:1024 lds
buffer_load_dwordx4 v14, s[8:11], s75 offen offset:2048 lds
buffer_load_dwordx4 v15, s[8:11], s75 offen offset:3072 lds
s_add_u32 m0, s77, 45056
s_nop 0
buffer_load_dwordx4 v16, s[8:11], s75 offen offset:0 lds
buffer_load_dwordx4 v17, s[8:11], s75 offen offset:1024 lds
s_add_u32 s74, s74, 128
s_add_u32 s75, s75, 393216
s_and_b32 s74, s74, 2047
s_cselect_b32 s75, s75, 0
s_waitcnt vmcnt(16)
s_barrier
s_add_u32 m0, s76, 81920
s_nop 0
buffer_load_dwordx4 v8, s[4:7], s74 offen offset:0 lds
buffer_load_dwordx4 v9, s[4:7], s74 offen offset:1024 lds
buffer_load_dwordx4 v10, s[4:7], s74 offen offset:2048 lds
buffer_load_dwordx4 v11, s[4:7], s74 offen offset:3072 lds
s_add_u32 m0, s77, 81920
s_nop 0
buffer_load_dwordx4 v12, s[8:11], s75 offen offset:0 lds
buffer_load_dwordx4 v13, s[8:11], s75 offen offset:1024 lds
buffer_load_dwordx4 v14, s[8:11], s75 offen offset:2048 lds
buffer_load_dwordx4 v15, s[8:11], s75 offen offset:3072 lds
s_add_u32 m0, s77, 86016
s_nop 0
buffer_load_dwordx4 v16, s[8:11], s75 offen offset:0 lds
buffer_load_dwordx4 v17, s[8:11], s75 offen offset:1024 lds
s_add_u32 s74, s74, 128
s_add_u32 s75, s75, 393216
s_and_b32 s74, s74, 2047
s_cselect_b32 s75, s75, 0
s_waitcnt vmcnt(20)
L_eg_chk:
v_xor_b32 v2, s68, v23
v_xor_b32 v3, s68, v27
v_xor_b32 v4, s68, v31
v_or3_b32 v2, v2, v3, v4
v_xor_b32 v3, s68, v35
v_xor_b32 v4, s68, v39
v_or3_b32 v2, v2, v3, v4
v_xor_b32 v3, s68, v43
v_or_b32 v2, v2, v3
v_cmp_ne_u32 vcc, 0, v2
s_cbranch_vccnz L_eg_rt
L_eg_ok:
v_add_f32 v20, v20, v24
v_add_f32 v28, v28, v32
v_add_f32 v21, v21, v25
v_add_f32 v29, v29, v33
v_add_f32 v22, v22, v26
v_add_f32 v30, v30, v34
v_add_f32 v20, v20, v28
v_add_f32 v21, v21, v29
v_add_f32 v22, v22, v30
v_mov_b32 v24, v20
v_mov_b32 v25, v21
v_mov_b32 v26, v22
v_permlane16_swap_b32 v20, v24
v_permlane16_swap_b32 v21, v25
v_permlane16_swap_b32 v22, v26
v_add_f32 v20, v20, v24
v_add_f32 v21, v21, v25
v_add_f32 v22, v22, v26
v_mov_b32 v24, v20
v_mov_b32 v25, v21
v_mov_b32 v26, v22
v_permlane32_swap_b32 v20, v24
v_permlane32_swap_b32 v21, v25
v_permlane32_swap_b32 v22, v26
v_add_f32 v20, v20, v24
v_add_f32 v21, v21, v25
v_add_f32 v22, v22, v26
v_and_b32 v3, 15, v1
v_lshlrev_b32 v3, 2, v3
s_lshl_b32 s70, s60, 6
s_add_u32 s70, s70, 160768
v_add_u32 v3, s70, v3
ds_write_b32 v3, v20 offset:0
ds_write_b32 v3, v21 offset:256
ds_write_b32 v3, v22 offset:512
v_lshrrev_b32 v4, 2, v45
s_lshl_b32 s70, s60, 7
s_add_u32 s70, s70, 159744
v_add_u32 v4, s70, v4
ds_write_b32 v4, v36
ds_write_b32 v4, v37 offset:512
s_getreg_b32 s71, hwreg(HW_REG_XCC_ID, 0, 4)
v_cmp_ne_u32 vcc, s71, v40
s_nop 0
s_and_b32 s70, vcc_lo, 0xffff
s_cselect_b32 s69, 0, 1
v_mov_b32 v5, s69
v_mov_b32 v6, 161536
ds_write_b32 v6, v5
s_waitcnt lgkmcnt(0)
s_waitcnt vmcnt(10)
s_barrier
s_add_u32 m0, s76, 0
s_nop 0
buffer_load_dwordx4 v8, s[4:7], s74 offen offset:0 lds
buffer_load_dwordx4 v9, s[4:7], s74 offen offset:1024 lds
buffer_load_dwordx4 v10, s[4:7], s74 offen offset:2048 lds
buffer_load_dwordx4 v11, s[4:7], s74 offen offset:3072 lds
s_add_u32 m0, s77, 0
s_nop 0
buffer_load_dwordx4 v12, s[8:11], s75 offen offset:0 lds
buffer_load_dwordx4 v13, s[8:11], s75 offen offset:1024 lds
buffer_load_dwordx4 v14, s[8:11], s75 offen offset:2048 lds
buffer_load_dwordx4 v15, s[8:11], s75 offen offset:3072 lds
s_add_u32 m0, s77, 4096
s_nop 0
buffer_load_dwordx4 v16, s[8:11], s75 offen offset:0 lds
buffer_load_dwordx4 v17, s[8:11], s75 offen offset:1024 lds
s_add_u32 s74, s74, 128
s_add_u32 s75, s75, 393216
s_and_b32 s74, s74, 2047
s_cselect_b32 s75, s75, 0
s_waitcnt vmcnt(10)
s_barrier
s_mul_i32 s70, s60, 9
s_add_u32 s70, s70, 92
s_lshl_b32 s71, s70, 14
s_lshl_b32 s70, s70, 10
s_add_u32 m0, s70, 28672
s_nop 0
buffer_load_dwordx4 v48, s[16:19], s71 offen offset:0 lds
buffer_load_dwordx4 v49, s[16:19], s71 offen offset:1024 lds
buffer_load_dwordx4 v50, s[16:19], s71 offen offset:2048 lds
buffer_load_dwordx4 v51, s[16:19], s71 offen offset:3072 lds
s_add_u32 m0, m0, 4096
s_add_u32 s71, s71, 65536
buffer_load_dwordx4 v48, s[16:19], s71 offen offset:0 lds
buffer_load_dwordx4 v49, s[16:19], s71 offen offset:1024 lds
buffer_load_dwordx4 v50, s[16:19], s71 offen offset:2048 lds
buffer_load_dwordx4 v51, s[16:19], s71 offen offset:3072 lds
s_add_u32 m0, m0, 4096
s_add_u32 s71, s71, 65536
buffer_load_dwordx4 v48, s[16:19], s71 offen offset:0 lds
s_mul_i32 s70, s60, 10
s_add_u32 s70, s70, 12
s_lshl_b32 s71, s70, 14
s_lshl_b32 s70, s70, 10
s_add_u32 m0, s70, 28672
s_nop 0
buffer_load_dwordx4 v48, s[16:19], s71 offen offset:0 lds
buffer_load_dwordx4 v49, s[16:19], s71 offen offset:1024 lds
buffer_load_dwordx4 v50, s[16:19], s71 offen offset:2048 lds
buffer_load_dwordx4 v51, s[16:19], s71 offen offset:3072 lds
s_add_u32 m0, m0, 4096
s_add_u32 s71, s71, 65536
buffer_load_dwordx4 v48, s[16:19], s71 offen offset:0 lds
buffer_load_dwordx4 v49, s[16:19], s71 offen offset:1024 lds
buffer_load_dwordx4 v50, s[16:19], s71 offen offset:2048 lds
buffer_load_dwordx4 v51, s[16:19], s71 offen offset:3072 lds
s_add_u32 m0, m0, 4096
s_add_u32 s71, s71, 65536
buffer_load_dwordx4 v48, s[16:19], s71 offen offset:0 lds
buffer_load_dwordx4 v49, s[16:19], s71 offen offset:1024 lds
s_waitcnt vmcnt(19)
s_barrier
s_mul_i32 s70, s60, 10
s_add_u32 s70, s70, 52
s_lshl_b32 s71, s70, 14
s_lshl_b32 s70, s70, 10
s_add_u32 m0, s70, 28672
s_nop 0
buffer_load_dwordx4 v48, s[16:19], s71 offen offset:0 lds
buffer_load_dwordx4 v49, s[16:19], s71 offen offset:1024 lds
buffer_load_dwordx4 v50, s[16:19], s71 offen offset:2048 lds
buffer_load_dwordx4 v51, s[16:19], s71 offen offset:3072 lds
s_add_u32 m0, m0, 4096
s_add_u32 s71, s71, 65536
buffer_load_dwordx4 v48, s[16:19], s71 offen offset:0 lds
buffer_load_dwordx4 v49, s[16:19], s71 offen offset:1024 lds
buffer_load_dwordx4 v50, s[16:19], s71 offen offset:2048 lds
buffer_load_dwordx4 v51, s[16:19], s71 offen offset:3072 lds
s_add_u32 m0, m0, 4096
s_add_u32 s71, s71, 65536
buffer_load_dwordx4 v48, s[16:19], s71 offen offset:0 lds
buffer_load_dwordx4 v49, s[16:19], s71 offen offset:1024 lds
v_bfe_u32 v2, v1, 3, 2
v_lshlrev_b32 v2, 3, v2
v_lshrrev_b32 v3, 5, v1
v_lshl_add_u32 v2, v3, 2, v2
v_bfe_u32 v3, v1, 1, 2
v_add_u32 v2, v2, v3
v_mul_u32_u24 v52, 7168, v2
v_and_b32 v3, 1, v1
v_lshl_add_u32 v52, v3, 4, v52
v_lshrrev_b32 v2, 4, v1
v_and_b32 v3, 15, v1
v_lshlrev_b32 v53, 13, v2
v_lshl_add_u32 v53, v3, 4, v53
v_add_u32 v54, 4096, v53
s_mul_i32 s74, s60, 1835008
s_lshl_b32 s70, s79, 5
s_add_u32 s74, s74, s70
s_lshl_b32 s75, s79, 15
s_lshl_b32 s70, s60, 9
s_add_u32 s75, s75, s70
s_barrier
s_mul_i32 s70, s60, 3
s_add_u32 s70, s70, 0
s_lshl_b32 s71, s70, 14
s_lshl_b32 s70, s70, 10
s_add_u32 m0, s70, 28672
s_nop 0
buffer_load_dwordx4 v48, s[16:19], s71 offen offset:0 lds
buffer_load_dwordx4 v49, s[16:19], s71 offen offset:1024 lds
buffer_load_dwordx4 v50, s[16:19], s71 offen offset:2048 lds
s_sub_i32 s70, s64, s65
s_lshl_b32 s70, s70, 18
v_add_u32 v8, s70, v8
v_add_u32 v9, s70, v9
v_add_u32 v10, s70, v10
v_add_u32 v11, s70, v11
s_lshl_b32 s70, s65, 7
s_mov_b32 m0, s76
s_nop 0
buffer_load_dwordx4 v8, s[4:7], s70 offen offset:0 lds
buffer_load_dwordx4 v9, s[4:7], s70 offen offset:1024 lds
buffer_load_dwordx4 v10, s[4:7], s70 offen offset:2048 lds
buffer_load_dwordx4 v11, s[4:7], s70 offen offset:3072 lds
v_lshrrev_b32 v2, 4, v1
v_bfe_u32 v3, v1, 2, 2
v_and_b32 v4, 1, v1
v_lshlrev_b32 v4, 4, v4
v_mov_b32 v5, 0x3f80
v_lshlrev_b32 v4, v4, v5
v_cmp_eq_u32 vcc, v2, v3
s_nop 1
v_cndmask_b32 v4, 0, v4, vcc
v_and_b32 v5, 2, v1
v_cmp_eq_u32 vcc, 0, v5
s_nop 1
v_cndmask_b32 v78, 0, v4, vcc
v_cndmask_b32_e64 v79, v4, 0, vcc
v_mov_b32 v76, 0
v_mov_b32 v77, 0
v_mov_b32 v80, 0
v_mov_b32 v81, 0
s_cmp_ge_u32 s63, 28
s_cbranch_scc1 L_moeA
buffer_load_dwordx4 a[0:3], v52, s[24:27], s74 offen
buffer_load_dwordx4 a[32:35], v52, s[28:31], s74 offen
s_add_u32 s74, s74, 229376
buffer_load_dwordx4 a[4:7], v52, s[24:27], s74 offen
L_moeA:
v_and_b32 v3, 15, v1
v_mul_u32_u24 v55, 4352, v3
v_lshrrev_b32 v2, 4, v1
v_lshl_add_u32 v55, v2, 5, v55
s_mul_i32 s87, s64, 69632
s_add_u32 s87, s87, 524288
s_lshl_b32 s70, s66, 7
s_lshl_b32 s71, s67, 4
s_add_u32 s88, s70, s71
s_add_u32 s88, s88, s87
s_add_u32 s88, s88, 4096
s_lshl_b32 s70, s60, 10
s_add_u32 s87, s87, s70
s_barrier
s_add_u32 s70, s65, 1
s_and_b32 s70, s70, 15
s_mul_i32 s70, s70, 4352
s_add_u32 s70, s70, s87
buffer_load_dwordx4 v[84:87], v18, s[12:15], s70 offen sc1
s_add_u32 s70, s65, 2
s_and_b32 s70, s70, 15
s_mul_i32 s70, s70, 4352
s_add_u32 s70, s70, s87
buffer_load_dwordx4 v[88:91], v18, s[12:15], s70 offen sc1
s_add_u32 s70, s65, 3
s_and_b32 s70, s70, 15
s_mul_i32 s70, s70, 4352
s_add_u32 s70, s70, s87
buffer_load_dwordx4 v[92:95], v18, s[12:15], s70 offen sc1
s_add_u32 s70, s65, 4
s_and_b32 s70, s70, 15
s_mul_i32 s70, s70, 4352
s_add_u32 s70, s70, s87
buffer_load_dwordx4 v[96:99], v18, s[12:15], s70 offen sc1
s_add_u32 s70, s65, 5
s_and_b32 s70, s70, 15
s_mul_i32 s70, s70, 4352
s_add_u32 s70, s70, s87
buffer_load_dwordx4 v[100:103], v18, s[12:15], s70 offen sc1
s_add_u32 s70, s65, 6
s_and_b32 s70, s70, 15
s_mul_i32 s70, s70, 4352
s_add_u32 s70, s70, s87
buffer_load_dwordx4 v[104:107], v18, s[12:15], s70 offen sc1
s_add_u32 s70, s65, 7
s_and_b32 s70, s70, 15
s_mul_i32 s70, s70, 4352
s_add_u32 s70, s70, s87
buffer_load_dwordx4 v[108:111], v18, s[12:15], s70 offen sc1
s_add_u32 s70, s65, 8
s_and_b32 s70, s70, 15
s_mul_i32 s70, s70, 4352
s_add_u32 s70, s70, s87
buffer_load_dwordx4 v[112:115], v18, s[12:15], s70 offen sc1
s_add_u32 s70, s65, 9
s_and_b32 s70, s70, 15
s_mul_i32 s70, s70, 4352
s_add_u32 s70, s70, s87
buffer_load_dwordx4 v[116:119], v18, s[12:15], s70 offen sc1
s_add_u32 s70, s65, 10
s_and_b32 s70, s70, 15
s_mul_i32 s70, s70, 4352
s_add_u32 s70, s70, s87
buffer_load_dwordx4 v[120:123], v18, s[12:15], s70 offen sc1
s_add_u32 s70, s65, 11
s_and_b32 s70, s70, 15
s_mul_i32 s70, s70, 4352
s_add_u32 s70, s70, s87
buffer_load_dwordx4 v[124:127], v18, s[12:15], s70 offen sc1
s_add_u32 s70, s65, 12
s_and_b32 s70, s70, 15
s_mul_i32 s70, s70, 4352
s_add_u32 s70, s70, s87
buffer_load_dwordx4 v[128:131], v18, s[12:15], s70 offen sc1
s_add_u32 s70, s65, 13
s_and_b32 s70, s70, 15
s_mul_i32 s70, s70, 4352
s_add_u32 s70, s70, s87
buffer_load_dwordx4 v[132:135], v18, s[12:15], s70 offen sc1
s_add_u32 s70, s65, 14
s_and_b32 s70, s70, 15
s_mul_i32 s70, s70, 4352
s_add_u32 s70, s70, s87
buffer_load_dwordx4 v[136:139], v18, s[12:15], s70 offen sc1
s_add_u32 s70, s65, 15
s_and_b32 s70, s70, 15
s_mul_i32 s70, s70, 4352
s_add_u32 s70, s70, s87
buffer_load_dwordx4 v[140:143], v18, s[12:15], s70 offen sc1
s_add_u32 s70, s65, 16
s_and_b32 s70, s70, 15
s_mul_i32 s70, s70, 4352
s_add_u32 s70, s70, s87
buffer_load_dwordx4 v[144:147], v18, s[12:15], s70 offen sc1
buffer_load_dwordx4 v[148:151], v55, s[12:15], s88 offen sc1
s_waitcnt vmcnt(13)
L_kv0_chk:
v_max3_u32 v2, v84, v88, v92
v_max_u32 v2, v2, v96
v_cmp_eq_u32 vcc, -1, v2
s_cbranch_vccnz L_kv0_rt
L_kv0_ok:
v_mfma_f32_16x16x32_bf16 v[68:71], v[78:81], v[84:87], 0
v_mfma_f32_16x16x32_bf16 v[72:75], v[76:79], v[84:87], 0
v_mfma_f32_16x16x32_bf16 v[68:71], v[78:81], v[88:91], v[68:71]
v_mfma_f32_16x16x32_bf16 v[72:75], v[76:79], v[88:91], v[72:75]
v_mfma_f32_16x16x32_bf16 v[68:71], v[78:81], v[92:95], v[68:71]
v_mfma_f32_16x16x32_bf16 v[72:75], v[76:79], v[92:95], v[72:75]
v_mfma_f32_16x16x32_bf16 v[68:71], v[78:81], v[96:99], v[68:71]
v_mfma_f32_16x16x32_bf16 v[72:75], v[76:79], v[96:99], v[72:75]
s_waitcnt vmcnt(9)
L_kv1_chk:
v_max3_u32 v2, v100, v104, v108
v_max_u32 v2, v2, v112
v_cmp_eq_u32 vcc, -1, v2
s_cbranch_vccnz L_kv1_rt
L_kv1_ok:
v_mfma_f32_16x16x32_bf16 v[68:71], v[78:81], v[100:103], v[68:71]
v_mfma_f32_16x16x32_bf16 v[72:75], v[76:79], v[100:103], v[72:75]
v_mfma_f32_16x16x32_bf16 v[68:71], v[78:81], v[104:107], v[68:71]
v_mfma_f32_16x16x32_bf16 v[72:75], v[76:79], v[104:107], v[72:75]
v_mfma_f32_16x16x32_bf16 v[68:71], v[78:81], v[108:111], v[68:71]
v_mfma_f32_16x16x32_bf16 v[72:75], v[76:79], v[108:111], v[72:75]
v_mfma_f32_16x16x32_bf16 v[68:71], v[78:81], v[112:115], v[68:71]
v_mfma_f32_16x16x32_bf16 v[72:75], v[76:79], v[112:115], v[72:75]
s_waitcnt vmcnt(5)
L_kv2_chk:
v_max3_u32 v2, v116, v120, v124
v_max_u32 v2, v2, v128
v_cmp_eq_u32 vcc, -1, v2
s_cbranch_vccnz L_kv2_rt
L_kv2_ok:
v_mfma_f32_16x16x32_bf16 v[68:71], v[78:81], v[116:119], v[68:71]
v_mfma_f32_16x16x32_bf16 v[72:75], v[76:79], v[116:119], v[72:75]
v_mfma_f32_16x16x32_bf16 v[68:71], v[78:81], v[120:123], v[68:71]
v_mfma_f32_16x16x32_bf16 v[72:75], v[76:79], v[120:123], v[72:75]
v_mfma_f32_16x16x32_bf16 v[68:71], v[78:81], v[124:127], v[68:71]
v_mfma_f32_16x16x32_bf16 v[72:75], v[76:79], v[124:127], v[72:75]
v_mfma_f32_16x16x32_bf16 v[68:71], v[78:81], v[128:131], v[68:71]
v_mfma_f32_16x16x32_bf16 v[72:75], v[76:79], v[128:131], v[72:75]
s_waitcnt vmcnt(1)
L_kv3_chk:
v_max3_u32 v2, v132, v136, v140
v_max_u32 v2, v2, v144
v_cmp_eq_u32 vcc, -1, v2
s_cbranch_vccnz L_kv3_rt
L_kv3_ok:
v_mfma_f32_16x16x32_bf16 v[68:71], v[78:81], v[132:135], v[68:71]
v_mfma_f32_16x16x32_bf16 v[72:75], v[76:79], v[132:135], v[72:75]
v_mfma_f32_16x16x32_bf16 v[68:71], v[78:81], v[136:139], v[68:71]
v_mfma_f32_16x16x32_bf16 v[72:75], v[76:79], v[136:139], v[72:75]
v_mfma_f32_16x16x32_bf16 v[68:71], v[78:81], v[140:143], v[68:71]
v_mfma_f32_16x16x32_bf16 v[72:75], v[76:79], v[140:143], v[72:75]
v_mfma_f32_16x16x32_bf16 v[68:71], v[78:81], v[144:147], v[68:71]
v_mfma_f32_16x16x32_bf16 v[72:75], v[76:79], v[144:147], v[72:75]
s_waitcnt vmcnt(0)
L_z_chk:
v_cmp_eq_u32 vcc, -1, v148
s_cbranch_vccnz L_z_rt
L_z_ok:
v_add_f32_dpp v148, v148, v148 row_ror:1 row_mask:0xf bank_mask:0xf
v_add_f32_dpp v149, v149, v149 row_ror:1 row_mask:0xf bank_mask:0xf
v_add_f32_dpp v150, v150, v150 row_ror:1 row_mask:0xf bank_mask:0xf
v_add_f32_dpp v151, v151, v151 row_ror:1 row_mask:0xf bank_mask:0xf
v_add_f32_dpp v148, v148, v148 row_ror:2 row_mask:0xf bank_mask:0xf
v_add_f32_dpp v149, v149, v149 row_ror:2 row_mask:0xf bank_mask:0xf
v_add_f32_dpp v150, v150, v150 row_ror:2 row_mask:0xf bank_mask:0xf
v_add_f32_dpp v151, v151, v151 row_ror:2 row_mask:0xf bank_mask:0xf
v_add_f32_dpp v148, v148, v148 row_ror:4 row_mask:0xf bank_mask:0xf
v_add_f32_dpp v149, v149, v149 row_ror:4 row_mask:0xf bank_mask:0xf
v_add_f32_dpp v150, v150, v150 row_ror:4 row_mask:0xf bank_mask:0xf
v_add_f32_dpp v151, v151, v151 row_ror:4 row_mask:0xf bank_mask:0xf
v_add_f32_dpp v148, v148, v148 row_ror:8 row_mask:0xf bank_mask:0xf
v_add_f32_dpp v149, v149, v149 row_ror:8 row_mask:0xf bank_mask:0xf
v_add_f32_dpp v150, v150, v150 row_ror:8 row_mask:0xf bank_mask:0xf
v_add_f32_dpp v151, v151, v151 row_ror:8 row_mask:0xf bank_mask:0xf
v_cvt_pk_bf16_f32 v148, v148, v149
v_cvt_pk_bf16_f32 v149, v150, v151
s_lshl_b32 s70, s66, 6
s_lshl_b32 s71, s67, 3
s_add_u32 s70, s70, s71
s_add_u32 s70, s70, 161600
v_lshrrev_b32 v2, 4, v1
v_lshlrev_b32 v2, 4, v2
v_add_u32 v2, s70, v2
ds_write_b64 v2, v[148:149]
v_cvt_pk_bf16_f32 v68, v68, v69
v_cvt_pk_bf16_f32 v69, v70, v71
v_cvt_pk_bf16_f32 v70, v72, v73
v_cvt_pk_bf16_f32 v71, v74, v75
s_lshl_b32 s70, s60, 10
s_add_u32 s70, s70, 24576
v_add_u32 v3, s70, v18
ds_write_b128 v3, v[68:71]
s_waitcnt lgkmcnt(0)
s_barrier
s_cmp_ge_u32 s63, 28
s_cbranch_scc1 L_moeB
buffer_load_dwordx4 a[36:39], v52, s[28:31], s74 offen
s_add_u32 s74, s74, 229376
buffer_load_dwordx4 a[8:11], v52, s[24:27], s74 offen
buffer_load_dwordx4 a[40:43], v52, s[28:31], s74 offen
s_add_u32 s74, s74, 229376
buffer_load_dwordx4 a[12:15], v52, s[24:27], s74 offen
buffer_load_dwordx4 a[44:47], v52, s[28:31], s74 offen
s_add_u32 s74, s74, 229376
L_moeB:
s_barrier
s_cmp_ge_u32 s63, 28
s_cbranch_scc1 L_moeC
buffer_load_dwordx4 a[16:19], v52, s[24:27], s74 offen
buffer_load_dwordx4 a[48:51], v52, s[28:31], s74 offen
s_add_u32 s74, s74, 229376
buffer_load_dwordx4 a[20:23], v52, s[24:27], s74 offen
buffer_load_dwordx4 a[52:55], v52, s[28:31], s74 offen
s_add_u32 s74, s74, 229376
buffer_load_dwordx4 a[24:27], v52, s[24:27], s74 offen
buffer_load_dwordx4 a[56:59], v52, s[28:31], s74 offen
s_add_u32 s74, s74, 229376
buffer_load_dwordx4 a[28:31], v52, s[24:27], s74 offen
buffer_load_dwordx4 a[60:63], v52, s[28:31], s74 offen
s_add_u32 s74, s74, 229376
buffer_load_dwordx4 v[84:87], v53, s[32:35], s75 offen offset:0
buffer_load_dwordx4 v[88:91], v53, s[32:35], s75 offen offset:2048
buffer_load_dwordx4 v[92:95], v54, s[32:35], s75 offen offset:0
buffer_load_dwordx4 v[96:99], v54, s[32:35], s75 offen offset:2048
buffer_load_dwordx4 v[100:103], v53, s[32:35], s75 offen offset:256
buffer_load_dwordx4 v[104:107], v53, s[32:35], s75 offen offset:2304
buffer_load_dwordx4 v[108:111], v54, s[32:35], s75 offen offset:256
buffer_load_dwordx4 v[112:115], v54, s[32:35], s75 offen offset:2304
L_moeC:
s_barrier
s_cmp_ge_u32 s63, 28
s_cbranch_scc1 L_noprep
s_lshl_b32 s70, s60, 14
s_add_u32 s70, s70, 65536
v_add_u32 v2, s70, v18
v_lshlrev_b32 v3, 3, v1
v_add_u32 v3, s70, v3
s_mov_b32 s94, 0x05040100
s_mov_b32 s95, 0x07060302
v_mov_b32 v76, 0x3f803f80
v_mov_b32 v77, 0x3f803f80
v_mov_b32 v78, 0x3f803f80
v_mov_b32 v79, 0x3f803f80
s_waitcnt vmcnt(0)
ds_write_b128 v2, a[0:3] offset:0
ds_write_b128 v2, a[4:7] offset:1024
ds_write_b128 v2, a[8:11] offset:2048
ds_write_b128 v2, a[12:15] offset:3072
ds_write_b128 v2, a[16:19] offset:4096
ds_write_b128 v2, a[20:23] offset:5120
ds_write_b128 v2, a[24:27] offset:6144
ds_write_b128 v2, a[28:31] offset:7168
ds_write_b128 v2, a[32:35] offset:8192
ds_write_b128 v2, a[36:39] offset:9216
ds_write_b128 v2, a[40:43] offset:10240
ds_write_b128 v2, a[44:47] offset:11264
ds_write_b128 v2, a[48:51] offset:12288
ds_write_b128 v2, a[52:55] offset:13312
ds_write_b128 v2, a[56:59] offset:14336
ds_write_b128 v2, a[60:63] offset:15360
s_waitcnt lgkmcnt(0)
ds_read_b64_tr_b16 a[0:1], v3 offset:0
ds_read_b64_tr_b16 a[2:3], v3 offset:512
ds_read_b64_tr_b16 a[4:5], v3 offset:1024
ds_read_b64_tr_b16 a[6:7], v3 offset:1536
ds_read_b64_tr_b16 a[8:9], v3 offset:2048
ds_read_b64_tr_b16 a[10:11], v3 offset:2560
ds_read_b64_tr_b16 a[12:13], v3 offset:3072
ds_read_b64_tr_b16 a[14:15], v3 offset:3584
ds_read_b64_tr_b16 a[16:17], v3 offset:4096
ds_read_b64_tr_b16 a[18:19], v3 offset:4608
ds_read_b64_tr_b16 a[20:21], v3 offset:5120
ds_read_b64_tr_b16 a[22:23], v3 offset:5632
ds_read_b64_tr_b16 a[24:25], v3 offset:6144
ds_read_b64_tr_b16 a[26:27], v3 offset:6656
ds_read_b64_tr_b16 a[28:29], v3 offset:7168
ds_read_b64_tr_b16 a[30:31], v3 offset:7680
ds_read_b64_tr_b16 a[32:33], v3 offset:8192
ds_read_b64_tr_b16 a[34:35], v3 offset:8704
ds_read_b64_tr_b16 a[36:37], v3 offset:9216
ds_read_b64_tr_b16 a[38:39], v3 offset:9728
ds_read_b64_tr_b16 a[40:41], v3 offset:10240
ds_read_b64_tr_b16 a[42:43], v3 offset:10752
ds_read_b64_tr_b16 a[44:45], v3 offset:11264
ds_read_b64_tr_b16 a[46:47], v3 offset:11776
ds_read_b64_tr_b16 a[48:49], v3 offset:12288
ds_read_b64_tr_b16 a[50:51], v3 offset:12800
ds_read_b64_tr_b16 a[52:53], v3 offset:13312
ds_read_b64_tr_b16 a[54:55], v3 offset:13824
ds_read_b64_tr_b16 a[56:57], v3 offset:14336
ds_read_b64_tr_b16 a[58:59], v3 offset:14848
ds_read_b64_tr_b16 a[60:61], v3 offset:15360
ds_read_b64_tr_b16 a[62:63], v3 offset:15872
v_perm_b32 v116, v88, v84, s94
v_perm_b32 v117, v96, v92, s94
v_perm_b32 v118, v88, v84, s95
v_perm_b32 v119, v96, v92, s95
v_perm_b32 v120, v89, v85, s94
v_perm_b32 v121, v97, v93, s94
v_perm_b32 v122, v89, v85, s95
v_perm_b32 v123, v97, v93, s95
v_perm_b32 v124, v90, v86, s94
v_perm_b32 v125, v98, v94, s94
v_perm_b32 v126, v90, v86, s95
v_perm_b32 v127, v98, v94, s95
v_perm_b32 v128, v91, v87, s94
v_perm_b32 v129, v99, v95, s94
v_perm_b32 v130, v91, v87, s95
v_perm_b32 v131, v99, v95, s95
v_perm_b32 v132, v104, v100, s94
v_perm_b32 v133, v112, v108, s94
v_perm_b32 v134, v104, v100, s95
v_perm_b32 v135, v112, v108, s95
v_perm_b32 v136, v105, v101, s94
v_perm_b32 v137, v113, v109, s94
v_perm_b32 v138, v105, v101, s95
v_perm_b32 v139, v113, v109, s95
v_perm_b32 v140, v106, v102, s94
v_perm_b32 v141, v114, v110, s94
v_perm_b32 v142, v106, v102, s95
v_perm_b32 v143, v114, v110, s95
v_perm_b32 v144, v107, v103, s94
v_perm_b32 v145, v115, v111, s94
v_perm_b32 v146, v107, v103, s95
v_perm_b32 v147, v115, v111, s95
s_waitcnt lgkmcnt(0)
v_mfma_f32_16x16x32_bf16 v[68:71], a[0:3], v[76:79], 0
v_mfma_f32_16x16x32_bf16 v[72:75], a[32:35], v[76:79], 0
v_mfma_f32_16x16x32_bf16 v[68:71], a[4:7], v[76:79], v[68:71]
v_mfma_f32_16x16x32_bf16 v[72:75], a[36:39], v[76:79], v[72:75]
v_mfma_f32_16x16x32_bf16 v[68:71], a[8:11], v[76:79], v[68:71]
v_mfma_f32_16x16x32_bf16 v[72:75], a[40:43], v[76:79], v[72:75]
v_mfma_f32_16x16x32_bf16 v[68:71], a[12:15], v[76:79], v[68:71]
v_mfma_f32_16x16x32_bf16 v[72:75], a[44:47], v[76:79], v[72:75]
v_mfma_f32_16x16x32_bf16 v[68:71], a[16:19], v[76:79], v[68:71]
v_mfma_f32_16x16x32_bf16 v[72:75], a[48:51], v[76:79], v[72:75]
v_mfma_f32_16x16x32_bf16 v[68:71], a[20:23], v[76:79], v[68:71]
v_mfma_f32_16x16x32_bf16 v[72:75], a[52:55], v[76:79], v[72:75]
v_mfma_f32_16x16x32_bf16 v[68:71], a[24:27], v[76:79], v[68:71]
v_mfma_f32_16x16x32_bf16 v[72:75], a[56:59], v[76:79], v[72:75]
v_mfma_f32_16x16x32_bf16 v[68:71], a[28:31], v[76:79], v[68:71]
v_mfma_f32_16x16x32_bf16 v[72:75], a[60:63], v[76:79], v[72:75]
L_noprep:
v_and_b32 v2, 1, v1
v_lshlrev_b32 v56, 4, v2
v_add_u32 v56, 161856, v56
v_lshrrev_b32 v3, 4, v1
v_lshlrev_b32 v57, 4, v3
s_lshl_b32 s70, s60, 9
s_add_u32 s70, s70, 6881280
v_add_u32 v57, s70, v57
v_lshlrev_b32 v58, 6, v2
v_lshl_add_u32 v58, v3, 4, v58
v_add_u32 v58, 162048, v58
s_lshl_b32 s70, s60, 8
v_add_u32 v59, s70, v58
v_bfe_u32 v60, v1, 1, 3
s_barrier
ds_read_b128 v[20:23], v56
s_mov_b32 s92, 0x00030003
s_mov_b32 s93, 0x00030003
s_sub_u32 s88, s63, 24
s_lshl_b32 s70, s62, 3
s_add_u32 s88, s88, s70
s_waitcnt lgkmcnt(0)
s_cmp_ge_u32 s63, 28
s_cbranch_scc1 L_nomoe
v_lshl_add_u32 v57, v23, 11, v57
s_mov_b64 exec, s[92:93]
buffer_load_dwordx4 v[24:27], v57, s[12:15], 0 offen offset:0 sc1
buffer_load_dwordx4 v[28:31], v57, s[12:15], 0 offen offset:64 sc1
buffer_load_dwordx4 v[32:35], v57, s[12:15], 0 offen offset:128 sc1
buffer_load_dwordx4 v[36:39], v57, s[12:15], 0 offen offset:192 sc1
buffer_load_dwordx4 v[40:43], v57, s[12:15], 0 offen offset:256 sc1
buffer_load_dwordx4 v[44:47], v57, s[12:15], 0 offen offset:320 sc1
buffer_load_dwordx4 v[48:51], v57, s[12:15], 0 offen offset:384 sc1
buffer_load_dwordx4 v[52:55], v57, s[12:15], 0 offen offset:448 sc1
v_mul_f32_e64 v68, v68, -v21
v_mul_f32_e64 v69, v69, -v21
v_mul_f32_e64 v70, v70, -v21
v_mul_f32_e64 v71, v71, -v21
v_mul_f32_e64 v72, v72, -v21
v_mul_f32_e64 v73, v73, -v21
v_mul_f32_e64 v74, v74, -v21
v_mul_f32_e64 v75, v75, -v21
s_waitcnt vmcnt(0)
L_x_chk:
v_max3_u32 v2, v24, v28, v32
v_max3_u32 v3, v36, v40, v44
v_max3_u32 v2, v2, v48, v52
v_max_u32 v2, v2, v3
v_cmp_eq_u32 vcc, -1, v2
s_cbranch_vccnz L_x_rt
L_x_ok:
s_mov_b64 exec, -1
v_mfma_f32_16x16x32_bf16 v[68:71], a[0:3], v[24:27], v[68:71]
v_mfma_f32_16x16x32_bf16 v[72:75], a[32:35], v[24:27], v[72:75]
v_mfma_f32_16x16x32_bf16 v[68:71], a[4:7], v[28:31], v[68:71]
v_mfma_f32_16x16x32_bf16 v[72:75], a[36:39], v[28:31], v[72:75]
v_mfma_f32_16x16x32_bf16 v[68:71], a[8:11], v[32:35], v[68:71]
v_mfma_f32_16x16x32_bf16 v[72:75], a[40:43], v[32:35], v[72:75]
v_mfma_f32_16x16x32_bf16 v[68:71], a[12:15], v[36:39], v[68:71]
v_mfma_f32_16x16x32_bf16 v[72:75], a[44:47], v[36:39], v[72:75]
v_mfma_f32_16x16x32_bf16 v[68:71], a[16:19], v[40:43], v[68:71]
v_mfma_f32_16x16x32_bf16 v[72:75], a[48:51], v[40:43], v[72:75]
v_mfma_f32_16x16x32_bf16 v[68:71], a[20:23], v[44:47], v[68:71]
v_mfma_f32_16x16x32_bf16 v[72:75], a[52:55], v[44:47], v[72:75]
v_mfma_f32_16x16x32_bf16 v[68:71], a[24:27], v[48:51], v[68:71]
v_mfma_f32_16x16x32_bf16 v[72:75], a[56:59], v[48:51], v[72:75]
v_mfma_f32_16x16x32_bf16 v[68:71], a[28:31], v[52:55], v[68:71]
v_mfma_f32_16x16x32_bf16 v[72:75], a[60:63], v[52:55], v[72:75]
s_mov_b64 exec, s[92:93]
s_nop 5
ds_write_b128 v59, v[68:71]
ds_write_b128 v59, v[72:75] offset:128
s_mov_b64 exec, -1
s_waitcnt lgkmcnt(0)
s_barrier
ds_read_b128 v[24:27], v58 offset:0
ds_read_b128 v[40:43], v58 offset:128
ds_read_b128 v[28:31], v58 offset:256
ds_read_b128 v[44:47], v58 offset:384
ds_read_b128 v[32:35], v58 offset:512
ds_read_b128 v[48:51], v58 offset:640
ds_read_b128 v[36:39], v58 offset:768
ds_read_b128 v[52:55], v58 offset:896
s_waitcnt lgkmcnt(0)
v_pk_add_f32 v[24:25], v[24:25], v[28:29]
v_pk_add_f32 v[32:33], v[32:33], v[36:37]
v_pk_add_f32 v[26:27], v[26:27], v[30:31]
v_pk_add_f32 v[34:35], v[34:35], v[38:39]
v_pk_add_f32 v[24:25], v[24:25], v[32:33]
v_pk_add_f32 v[26:27], v[26:27], v[34:35]
v_pk_mul_f32 v[24:25], v[24:25], v[22:23] op_sel_hi:[1,0]
v_pk_mul_f32 v[26:27], v[26:27], v[22:23] op_sel_hi:[1,0]
v_pk_add_f32 v[40:41], v[40:41], v[44:45]
v_pk_add_f32 v[48:49], v[48:49], v[52:53]
v_pk_add_f32 v[42:43], v[42:43], v[46:47]
v_pk_add_f32 v[50:51], v[50:51], v[54:55]
v_pk_add_f32 v[40:41], v[40:41], v[48:49]
v_pk_add_f32 v[42:43], v[42:43], v[50:51]
v_pk_mul_f32 v[40:41], v[40:41], v[22:23] op_sel_hi:[1,0]
v_pk_mul_f32 v[42:43], v[42:43], v[22:23] op_sel_hi:[1,0]
v_mul_f32 v28, 0xbfb8aa3b, v24
v_mul_f32 v29, 0xbfb8aa3b, v25
v_mul_f32 v30, 0xbfb8aa3b, v26
v_mul_f32 v31, 0xbfb8aa3b, v27
v_exp_f32 v28, v28
v_exp_f32 v29, v29
v_exp_f32 v30, v30
v_exp_f32 v31, v31
v_mul_f32 v24, v24, v40
v_mul_f32 v25, v25, v41
v_mul_f32 v26, v26, v42
v_mul_f32 v27, v27, v43
v_add_f32 v28, 1.0, v28
v_add_f32 v29, 1.0, v29
v_add_f32 v30, 1.0, v30
v_add_f32 v31, 1.0, v31
v_rcp_f32 v28, v28
v_rcp_f32 v29, v29
v_rcp_f32 v30, v30
v_rcp_f32 v31, v31
v_mul_f32 v24, v24, v28
v_mul_f32 v25, v25, v29
v_mul_f32 v26, v26, v30
v_mul_f32 v27, v27, v31
v_cvt_pk_bf16_f32 v24, v24, v25
v_cvt_pk_bf16_f32 v25, v26, v27
v_cmp_eq_u32 vcc, 0, v60
s_nop 1
v_cndmask_b32 v32, 0, v24, vcc
v_cndmask_b32 v33, 0, v25, vcc
v_cmp_eq_u32 vcc, 1, v60
s_nop 1
v_cndmask_b32 v34, 0, v24, vcc
v_cndmask_b32 v35, 0, v25, vcc
v_cmp_eq_u32 vcc, 2, v60
s_nop 1
v_cndmask_b32 v36, 0, v24, vcc
v_cndmask_b32 v37, 0, v25, vcc
v_cmp_eq_u32 vcc, 3, v60
s_nop 1
v_cndmask_b32 v38, 0, v24, vcc
v_cndmask_b32 v39, 0, v25, vcc
v_cmp_eq_u32 vcc, 4, v60
s_nop 1
v_cndmask_b32 v40, 0, v24, vcc
v_cndmask_b32 v41, 0, v25, vcc
v_cmp_eq_u32 vcc, 5, v60
s_nop 1
v_cndmask_b32 v42, 0, v24, vcc
v_cndmask_b32 v43, 0, v25, vcc
v_cmp_eq_u32 vcc, 6, v60
s_nop 1
v_cndmask_b32 v44, 0, v24, vcc
v_cndmask_b32 v45, 0, v25, vcc
v_cmp_eq_u32 vcc, 7, v60
s_nop 1
v_cndmask_b32 v46, 0, v24, vcc
v_cndmask_b32 v47, 0, v25, vcc
v_mfma_f32_16x16x32_bf16 v[68:71], v[116:119], v[32:35], 0
v_mfma_f32_16x16x32_bf16 v[72:75], v[132:135], v[32:35], 0
v_mfma_f32_16x16x32_bf16 v[68:71], v[120:123], v[36:39], v[68:71]
v_mfma_f32_16x16x32_bf16 v[72:75], v[136:139], v[36:39], v[72:75]
v_mfma_f32_16x16x32_bf16 v[68:71], v[124:127], v[40:43], v[68:71]
v_mfma_f32_16x16x32_bf16 v[72:75], v[140:143], v[40:43], v[72:75]
v_mfma_f32_16x16x32_bf16 v[68:71], v[128:131], v[44:47], v[68:71]
v_mfma_f32_16x16x32_bf16 v[72:75], v[144:147], v[44:47], v[72:75]
s_lshl_b32 s70, s79, 13
s_lshl_b32 s71, s60, 11
s_add_u32 s70, s70, s71
s_add_u32 s70, s70, 7340032
s_nop 2
buffer_store_dwordx4 v[68:71], v18, s[12:15], s70 offen offset:0 sc1
buffer_store_dwordx4 v[72:75], v18, s[12:15], s70 offen offset:1024 sc1
L_nomoe:
s_cmp_lt_u32 s63, 24
s_cbranch_scc1 L_ldone
v_lshrrev_b32 v2, 3, v1
v_and_b32 v3, 7, v1
v_lshlrev_b32 v62, 13, v2
v_lshl_add_u32 v62, v3, 4, v62
s_mul_i32 s87, s60, 458752
s_lshl_b32 s70, s88, 7
s_add_u32 s87, s87, s70
s_add_u32 s87, s87, 7340032
s_lshr_b32 s70, s88, 1
s_lshl_b32 s70, s70, 5
s_and_b32 s71, s88, 1
s_lshl_b32 s71, s71, 2
s_add_u32 s70, s70, s71
v_bfe_u32 v4, v1, 3, 2
v_lshlrev_b32 v4, 3, v4
v_bfe_u32 v5, v1, 1, 2
v_add3_u32 v63, v4, v5, s70
v_lshlrev_b32 v63, 1, v63
v_lshl_add_u32 v64, v23, 11, v63
s_mov_b32 s72, 6881280
buffer_load_ushort v61, v64, s[12:15], s72 offen sc1
s_add_u32 s70, s87, 0
buffer_load_dwordx4 v[24:27], v62, s[12:15], s70 offen sc1
s_add_u32 s70, s87, 65536
buffer_load_dwordx4 v[28:31], v62, s[12:15], s70 offen sc1
s_add_u32 s70, s87, 131072
buffer_load_dwordx4 v[32:35], v62, s[12:15], s70 offen sc1
s_add_u32 s70, s87, 196608
buffer_load_dwordx4 v[36:39], v62, s[12:15], s70 offen sc1
s_add_u32 s70, s87, 262144
buffer_load_dwordx4 v[40:43], v62, s[12:15], s70 offen sc1
s_add_u32 s70, s87, 327680
buffer_load_dwordx4 v[44:47], v62, s[12:15], s70 offen sc1
s_add_u32 s70, s87, 393216
buffer_load_dwordx4 v[48:51], v62, s[12:15], s70 offen sc1
v_and_b32 v65, 0xfffff800, v20
v_not_b32 v4, v65
v_ashrrev_i32 v4, 31, v4
v_or_b32 v4, 0x80000000, v4
v_xor_b32 v65, v65, v4
v_mul_f32 v65, 0xbfb8aa3b, v65
v_exp_f32 v65, v65
s_nop 0
v_add_f32 v65, 1.0, v65
v_rcp_f32 v65, v65
v_and_b32 v66, 0x7ff, v20
v_sub_u32 v66, 2047, v66
v_lshl_add_u32 v66, v66, 11, v63
v_add_f32 v67, 1.0, v22
v_mul_f32_e64 v21, -v21, v22
s_lshl_b32 s71, s60, 7
s_add_u32 s71, s71, 163072
v_lshlrev_b32 v6, 4, v3
v_add_u32 v6, s71, v6
v_bfe_u32 v4, v1, 3, 2
v_lshlrev_b32 v7, 4, v3
v_lshl_add_u32 v7, v4, 2, v7
v_add_u32 v7, 163072, v7
s_waitcnt vmcnt(0)
L_y_chk:
v_max3_u32 v2, v24, v28, v32
v_max3_u32 v4, v36, v40, v44
v_max3_u32 v2, v2, v4, v48
v_or_b32 v4, 0xffff0000, v61
v_max_u32 v2, v2, v4
v_cmp_eq_u32 vcc, -1, v2
s_cbranch_vccnz L_y_rt
L_y_ok:
v_pk_add_f32 v[24:25], v[24:25], v[28:29]
v_pk_add_f32 v[26:27], v[26:27], v[30:31]
v_pk_add_f32 v[32:33], v[32:33], v[36:37]
v_pk_add_f32 v[34:35], v[34:35], v[38:39]
v_pk_add_f32 v[40:41], v[40:41], v[44:45]
v_pk_add_f32 v[42:43], v[42:43], v[46:47]
v_pk_add_f32 v[24:25], v[24:25], v[32:33]
v_pk_add_f32 v[26:27], v[26:27], v[34:35]
v_pk_add_f32 v[40:41], v[40:41], v[48:49]
v_pk_add_f32 v[42:43], v[42:43], v[50:51]
v_pk_add_f32 v[24:25], v[24:25], v[40:41]
v_pk_add_f32 v[26:27], v[26:27], v[42:43]
s_nop 0
v_add_f32_dpp v24, v24, v24 row_ror:8 row_mask:0xf bank_mask:0xf
v_add_f32_dpp v25, v25, v25 row_ror:8 row_mask:0xf bank_mask:0xf
v_add_f32_dpp v26, v26, v26 row_ror:8 row_mask:0xf bank_mask:0xf
v_add_f32_dpp v27, v27, v27 row_ror:8 row_mask:0xf bank_mask:0xf
v_mov_b32 v28, v24
v_mov_b32 v29, v25
v_mov_b32 v30, v26
v_mov_b32 v31, v27
v_permlane16_swap_b32 v24, v28
v_permlane16_swap_b32 v25, v29
v_permlane16_swap_b32 v26, v30
v_permlane16_swap_b32 v27, v31
v_add_f32 v24, v24, v28
v_add_f32 v25, v25, v29
v_add_f32 v26, v26, v30
v_add_f32 v27, v27, v31
v_mov_b32 v28, v24
v_mov_b32 v29, v25
v_mov_b32 v30, v26
v_mov_b32 v31, v27
v_permlane32_swap_b32 v24, v28
v_permlane32_swap_b32 v25, v29
v_permlane32_swap_b32 v26, v30
v_permlane32_swap_b32 v27, v31
v_add_f32 v24, v24, v28
v_add_f32 v25, v25, v29
v_add_f32 v26, v26, v30
v_add_f32 v27, v27, v31
ds_write_b128 v6, v[24:27]
s_waitcnt lgkmcnt(0)
s_barrier
s_cmp_lg_u32 s60, 0
s_cbranch_scc1 L_ldone
ds_read_b32 v24, v7 offset:0
ds_read_b32 v25, v7 offset:128
ds_read_b32 v26, v7 offset:256
ds_read_b32 v27, v7 offset:384
v_lshlrev_b32 v61, 16, v61
v_fma_f32 v61, v61, v67, v21
s_waitcnt lgkmcnt(0)
v_add_f32 v24, v24, v25
v_add_f32 v26, v26, v27
v_add_f32 v24, v24, v26
v_fmac_f32 v61, v24, v65
v_cvt_pk_bf16_f32 v61, v61, v61
s_mov_b64 exec, 0xffffffff
buffer_store_short v61, v66, s[20:23], 0 offen sc1
L_ldone:
s_endpgm
L_compute:
v_and_b32 v2, 15, v1
v_lshrrev_b32 v4, 4, v1
v_lshrrev_b32 v3, 1, v2
v_xor_b32 v3, v3, v4
v_lshlrev_b32 v2, 7, v2
s_lshl_b32 s70, s66, 13
v_add_u32 v2, s70, v2
v_xor_b32 v5, 0, v3
v_lshl_add_u32 v8, v5, 4, v2
v_add_u32 v10, 81920, v8
v_xor_b32 v5, 4, v3
v_lshl_add_u32 v9, v5, 4, v2
v_add_u32 v11, 81920, v9
v_lshrrev_b32 v2, 5, v1
v_mul_u32_u24 v2, 6144, v2
v_bfe_u32 v3, v1, 4, 1
v_lshl_add_u32 v2, v3, 10, v2
v_bfe_u32 v4, v1, 2, 2
v_lshl_add_u32 v2, v4, 7, v2
v_lshlrev_b32 v3, 1, v3
v_bfe_u32 v4, v1, 3, 1
v_or_b32 v3, v3, v4
s_lshl_b32 s70, s67, 1
v_xor_b32 v3, s70, v3
v_and_b32 v4, 3, v1
v_lshl_add_u32 v2, v4, 3, v2
v_add_u32 v2, 16384, v2
v_xor_b32 v4, 0, v3
v_lshl_add_u32 v12, v4, 5, v2
v_add_u32 v14, 81920, v12
v_xor_b32 v4, 1, v3
v_lshl_add_u32 v13, v4, 5, v2
v_add_u32 v15, 81920, v13
s_waitcnt lgkmcnt(0)
s_mov_b32 s12, s58
s_and_b32 s13, s59, 0xffff
s_mov_b32 s14, 268435456
s_mov_b32 s15, 0x20000
s_mov_b32 s36, s48
s_and_b32 s37, s49, 0xffff
s_mov_b32 s38, 2048
s_mov_b32 s39, 0x20000
s_mov_b32 s20, s56
s_and_b32 s21, s57, 0xffff
s_mov_b32 s22, 4194304
s_mov_b32 s23, 0x20000
v_mov_b32 v2, 0
buffer_load_dword v19, v2, s[12:15], 0 offen sc1
buffer_load_dwordx4 v[20:23], v16, s[36:39], 0 offen
buffer_load_dwordx4 v[24:27], v16, s[36:39], 0 offen offset:1024
v_lshrrev_b32 v3, 4, v1
v_lshlrev_b32 v3, 3, v3
s_lshl_b32 s70, s65, 7
buffer_load_dwordx2 a[96:97], v3, s[36:39], s70 offen offset:0
buffer_load_dwordx2 a[98:99], v3, s[36:39], s70 offen offset:32
buffer_load_dwordx2 a[100:101], v3, s[36:39], s70 offen offset:64
buffer_load_dwordx2 a[102:103], v3, s[36:39], s70 offen offset:96
v_mov_b32 v32, 0
v_mov_b32 v33, 0
v_mov_b32 v34, 0
v_mov_b32 v35, 0
v_mov_b32 v36, 0
v_mov_b32 v37, 0
v_mov_b32 v38, 0
v_mov_b32 v39, 0
v_mov_b32 v40, 0
v_mov_b32 v41, 0
v_mov_b32 v42, 0
v_mov_b32 v43, 0
v_mov_b32 v44, 0
v_mov_b32 v45, 0
v_mov_b32 v46, 0
v_mov_b32 v47, 0
v_mov_b32 v48, 0
v_mov_b32 v49, 0
v_mov_b32 v50, 0
v_mov_b32 v51, 0
v_mov_b32 v52, 0
v_mov_b32 v53, 0
v_mov_b32 v54, 0
v_mov_b32 v55, 0
v_mov_b32 v56, 0
v_mov_b32 v57, 0
v_mov_b32 v58, 0
v_mov_b32 v59, 0
v_mov_b32 v60, 0
v_mov_b32 v61, 0
v_mov_b32 v62, 0
v_mov_b32 v63, 0
v_mov_b32 v64, 0
v_mov_b32 v65, 0
v_mov_b32 v66, 0
v_mov_b32 v67, 0
v_mov_b32 v68, 0
v_mov_b32 v69, 0
v_mov_b32 v70, 0
v_mov_b32 v71, 0
v_mov_b32 v72, 0
v_mov_b32 v73, 0
v_mov_b32 v74, 0
v_mov_b32 v75, 0
v_mov_b32 v76, 0
v_mov_b32 v77, 0
v_mov_b32 v78, 0
v_mov_b32 v79, 0
v_mov_b32 v80, 0
v_mov_b32 v81, 0
v_mov_b32 v82, 0
v_mov_b32 v83, 0
v_mov_b32 v84, 0
v_mov_b32 v85, 0
v_mov_b32 v86, 0
v_mov_b32 v87, 0
v_mov_b32 v88, 0
v_mov_b32 v89, 0
v_mov_b32 v90, 0
v_mov_b32 v91, 0
v_mov_b32 v92, 0
v_mov_b32 v93, 0
v_mov_b32 v94, 0
v_mov_b32 v95, 0
v_mov_b32 v96, 0
v_mov_b32 v97, 0
v_mov_b32 v98, 0
v_mov_b32 v99, 0
v_mov_b32 v100, 0
v_mov_b32 v101, 0
v_mov_b32 v102, 0
v_mov_b32 v103, 0
v_mov_b32 v104, 0
v_mov_b32 v105, 0
v_mov_b32 v106, 0
v_mov_b32 v107, 0
v_mov_b32 v108, 0
v_mov_b32 v109, 0
v_mov_b32 v110, 0
v_mov_b32 v111, 0
v_mov_b32 v112, 0
v_mov_b32 v113, 0
v_mov_b32 v114, 0
v_mov_b32 v115, 0
v_mov_b32 v116, 0
v_mov_b32 v117, 0
v_mov_b32 v118, 0
v_mov_b32 v119, 0
v_mov_b32 v120, 0
v_mov_b32 v121, 0
v_mov_b32 v122, 0
v_mov_b32 v123, 0
v_mov_b32 v124, 0
v_mov_b32 v125, 0
v_mov_b32 v126, 0
v_mov_b32 v127, 0
s_mov_b32 s70, 0x3f803f80
v_accvgpr_write_b32 a80, s70
v_accvgpr_write_b32 a81, s70
v_accvgpr_write_b32 a82, s70
v_accvgpr_write_b32 a83, s70
s_mov_b32 s80, 0x358637bd
s_mov_b32 s81, 0x358637bd
s_mov_b32 s82, 0x3f800008
s_mov_b32 s83, 0x3f800008
s_mov_b32 s90, 0x3fb8aa3b
s_mov_b32 s91, 0x3fb8aa3b
s_waitcnt vmcnt(4)
v_readfirstlane_b32 s68, v19
v_lshlrev_b32 v128, 16, v20
v_and_b32 v129, 0xffff0000, v20
v_lshlrev_b32 v130, 16, v21
v_and_b32 v131, 0xffff0000, v21
v_lshlrev_b32 v132, 16, v22
v_and_b32 v133, 0xffff0000, v22
v_lshlrev_b32 v134, 16, v23
v_and_b32 v135, 0xffff0000, v23
v_lshlrev_b32 v136, 16, v24
v_and_b32 v137, 0xffff0000, v24
v_lshlrev_b32 v138, 16, v25
v_and_b32 v139, 0xffff0000, v25
v_lshlrev_b32 v140, 16, v26
v_and_b32 v141, 0xffff0000, v26
v_lshlrev_b32 v142, 16, v27
v_and_b32 v143, 0xffff0000, v27
s_add_u32 s68, s68, 1
v_pk_add_f32 v[128:129], v[128:129], v[130:131]
v_pk_add_f32 v[132:133], v[132:133], v[134:135]
v_pk_add_f32 v[136:137], v[136:137], v[138:139]
v_pk_add_f32 v[140:141], v[140:141], v[142:143]
v_pk_add_f32 v[128:129], v[128:129], v[132:133]
v_pk_add_f32 v[136:137], v[136:137], v[140:141]
v_pk_add_f32 v[128:129], v[128:129], v[136:137]
v_add_f32 v2, v128, v129
s_nop 1
v_add_f32_dpp v2, v2, v2 row_ror:1 row_mask:0xf bank_mask:0xf
s_nop 1
v_add_f32_dpp v2, v2, v2 row_ror:2 row_mask:0xf bank_mask:0xf
s_nop 1
v_add_f32_dpp v2, v2, v2 row_ror:4 row_mask:0xf bank_mask:0xf
s_nop 1
v_add_f32_dpp v2, v2, v2 row_ror:8 row_mask:0xf bank_mask:0xf
v_mov_b32 v3, v2
s_nop 1
v_permlane16_swap_b32 v2, v3
v_add_f32 v2, v2, v3
v_mov_b32 v3, v2
s_nop 1
v_permlane32_swap_b32 v2, v3
v_add_f32 v2, v2, v3
s_nop 0
v_readfirstlane_b32 s84, v2
v_mov_b32 v20, -1
v_mov_b32 v21, -1
v_mov_b32 v22, -1
v_mov_b32 v23, -1
s_lshl_b32 s87, s64, 4
s_add_u32 s87, s87, s65
s_mul_i32 s87, s87, 4352
s_add_u32 s87, s87, 524288
s_lshl_b32 s88, s65, 18
s_lshl_b32 s70, s66, 17
s_add_u32 s88, s88, s70
s_lshl_b32 s70, s64, 11
s_add_u32 s88, s88, s70
s_lshl_b32 s70, s67, 10
s_add_u32 s88, s88, s70
s_add_u32 s88, s88, 2097152
s_barrier
ds_read_b128 a[0:3], v8 offset:0
ds_read_b64_tr_b16 a[32:33], v12 offset:0
ds_read_b64_tr_b16 a[34:35], v12 offset:512
ds_read_b128 a[4:7], v8 offset:2048
ds_read_b128 a[8:11], v8 offset:4096
ds_read_b128 a[12:15], v8 offset:6144
ds_read_b64_tr_b16 a[36:37], v13 offset:0
ds_read_b64_tr_b16 a[38:39], v13 offset:512
ds_read_b64_tr_b16 a[40:41], v12 offset:2048
ds_read_b64_tr_b16 a[42:43], v12 offset:2560
ds_read_b64_tr_b16 a[44:45], v13 offset:2048
ds_read_b64_tr_b16 a[46:47], v13 offset:2560
ds_read_b64_tr_b16 a[48:49], v12 offset:4096
ds_read_b64_tr_b16 a[50:51], v12 offset:4608
ds_read_b64_tr_b16 a[52:53], v13 offset:4096
ds_read_b64_tr_b16 a[54:55], v13 offset:4608
s_waitcnt lgkmcnt(0)
s_cmp_lg_u32 s66, 0
s_cbranch_scc1 L_nocs0
v_mfma_f32_16x16x32_bf16 v[128:131], a[80:83], a[32:35], 0
v_mfma_f32_16x16x32_bf16 v[132:135], a[80:83], a[36:39], 0
v_mfma_f32_16x16x32_bf16 v[136:139], a[80:83], a[40:43], 0
v_mfma_f32_16x16x32_bf16 v[140:143], a[80:83], a[44:47], 0
v_mfma_f32_16x16x32_bf16 v[144:147], a[80:83], a[48:51], 0
v_mfma_f32_16x16x32_bf16 v[148:151], a[80:83], a[52:55], 0
L_nocs0:
v_mfma_f32_16x16x32_bf16 v[32:35], a[32:35], a[0:3], v[32:35]
ds_read_b128 a[16:19], v9 offset:0
v_mfma_f32_16x16x32_bf16 v[56:59], a[32:35], a[4:7], v[56:59]
ds_read_b64_tr_b16 a[56:57], v12 offset:12288
v_mfma_f32_16x16x32_bf16 v[80:83], a[32:35], a[8:11], v[80:83]
ds_read_b64_tr_b16 a[58:59], v12 offset:12800
v_mfma_f32_16x16x32_bf16 v[104:107], a[32:35], a[12:15], v[104:107]
ds_read_b128 a[20:23], v9 offset:2048
v_mfma_f32_16x16x32_bf16 v[36:39], a[36:39], a[0:3], v[36:39]
ds_read_b128 a[24:27], v9 offset:4096
v_mfma_f32_16x16x32_bf16 v[60:63], a[36:39], a[4:7], v[60:63]
ds_read_b128 a[28:31], v9 offset:6144
v_mfma_f32_16x16x32_bf16 v[84:87], a[36:39], a[8:11], v[84:87]
ds_read_b64_tr_b16 a[60:61], v13 offset:12288
v_mfma_f32_16x16x32_bf16 v[108:111], a[36:39], a[12:15], v[108:111]
ds_read_b64_tr_b16 a[62:63], v13 offset:12800
v_mfma_f32_16x16x32_bf16 v[40:43], a[0:3], a[40:43], v[40:43]
ds_read_b64_tr_b16 a[64:65], v12 offset:14336
v_mfma_f32_16x16x32_bf16 v[64:67], a[4:7], a[40:43], v[64:67]
ds_read_b64_tr_b16 a[66:67], v12 offset:14848
v_mfma_f32_16x16x32_bf16 v[88:91], a[8:11], a[40:43], v[88:91]
ds_read_b64_tr_b16 a[68:69], v13 offset:14336
v_mfma_f32_16x16x32_bf16 v[112:115], a[12:15], a[40:43], v[112:115]
ds_read_b64_tr_b16 a[70:71], v13 offset:14848
v_mfma_f32_16x16x32_bf16 v[44:47], a[0:3], a[44:47], v[44:47]
ds_read_b64_tr_b16 a[72:73], v12 offset:16384
v_mfma_f32_16x16x32_bf16 v[68:71], a[4:7], a[44:47], v[68:71]
ds_read_b64_tr_b16 a[74:75], v12 offset:16896
v_mfma_f32_16x16x32_bf16 v[92:95], a[8:11], a[44:47], v[92:95]
ds_read_b64_tr_b16 a[76:77], v13 offset:16384
v_mfma_f32_16x16x32_bf16 v[116:119], a[12:15], a[44:47], v[116:119]
ds_read_b64_tr_b16 a[78:79], v13 offset:16896
v_mfma_f32_16x16x32_bf16 v[48:51], a[0:3], a[48:51], v[48:51]
v_mfma_f32_16x16x32_bf16 v[72:75], a[4:7], a[48:51], v[72:75]
v_mfma_f32_16x16x32_bf16 v[96:99], a[8:11], a[48:51], v[96:99]
v_mfma_f32_16x16x32_bf16 v[120:123], a[12:15], a[48:51], v[120:123]
v_mfma_f32_16x16x32_bf16 v[52:55], a[0:3], a[52:55], v[52:55]
v_mfma_f32_16x16x32_bf16 v[76:79], a[4:7], a[52:55], v[76:79]
v_mfma_f32_16x16x32_bf16 v[100:103], a[8:11], a[52:55], v[100:103]
v_mfma_f32_16x16x32_bf16 v[124:127], a[12:15], a[52:55], v[124:127]
s_waitcnt lgkmcnt(0)
s_cmp_lg_u32 s66, 0
s_cbranch_scc1 L_nocs1
v_mfma_f32_16x16x32_bf16 v[128:131], a[80:83], a[56:59], v[128:131]
v_mfma_f32_16x16x32_bf16 v[132:135], a[80:83], a[60:63], v[132:135]
v_mfma_f32_16x16x32_bf16 v[136:139], a[80:83], a[64:67], v[136:139]
v_mfma_f32_16x16x32_bf16 v[140:143], a[80:83], a[68:71], v[140:143]
v_mfma_f32_16x16x32_bf16 v[144:147], a[80:83], a[72:75], v[144:147]
v_mfma_f32_16x16x32_bf16 v[148:151], a[80:83], a[76:79], v[148:151]
L_nocs1:
v_mfma_f32_16x16x32_bf16 v[32:35], a[56:59], a[16:19], v[32:35]
s_barrier
ds_read_b128 a[0:3], v8 offset:40960
v_mfma_f32_16x16x32_bf16 v[56:59], a[56:59], a[20:23], v[56:59]
ds_read_b64_tr_b16 a[32:33], v12 offset:40960
v_mfma_f32_16x16x32_bf16 v[80:83], a[56:59], a[24:27], v[80:83]
ds_read_b64_tr_b16 a[34:35], v12 offset:41472
v_mfma_f32_16x16x32_bf16 v[104:107], a[56:59], a[28:31], v[104:107]
ds_read_b128 a[4:7], v8 offset:43008
v_mfma_f32_16x16x32_bf16 v[36:39], a[60:63], a[16:19], v[36:39]
ds_read_b128 a[8:11], v8 offset:45056
v_mfma_f32_16x16x32_bf16 v[60:63], a[60:63], a[20:23], v[60:63]
ds_read_b128 a[12:15], v8 offset:47104
v_mfma_f32_16x16x32_bf16 v[84:87], a[60:63], a[24:27], v[84:87]
ds_read_b64_tr_b16 a[36:37], v13 offset:40960
v_mfma_f32_16x16x32_bf16 v[108:111], a[60:63], a[28:31], v[108:111]
ds_read_b64_tr_b16 a[38:39], v13 offset:41472
v_mfma_f32_16x16x32_bf16 v[40:43], a[16:19], a[64:67], v[40:43]
ds_read_b64_tr_b16 a[40:41], v12 offset:43008
v_mfma_f32_16x16x32_bf16 v[64:67], a[20:23], a[64:67], v[64:67]
ds_read_b64_tr_b16 a[42:43], v12 offset:43520
v_mfma_f32_16x16x32_bf16 v[88:91], a[24:27], a[64:67], v[88:91]
ds_read_b64_tr_b16 a[44:45], v13 offset:43008
v_mfma_f32_16x16x32_bf16 v[112:115], a[28:31], a[64:67], v[112:115]
ds_read_b64_tr_b16 a[46:47], v13 offset:43520
v_mfma_f32_16x16x32_bf16 v[44:47], a[16:19], a[68:71], v[44:47]
ds_read_b64_tr_b16 a[48:49], v12 offset:45056
v_mfma_f32_16x16x32_bf16 v[68:71], a[20:23], a[68:71], v[68:71]
ds_read_b64_tr_b16 a[50:51], v12 offset:45568
v_mfma_f32_16x16x32_bf16 v[92:95], a[24:27], a[68:71], v[92:95]
ds_read_b64_tr_b16 a[52:53], v13 offset:45056
v_mfma_f32_16x16x32_bf16 v[116:119], a[28:31], a[68:71], v[116:119]
ds_read_b64_tr_b16 a[54:55], v13 offset:45568
v_mfma_f32_16x16x32_bf16 v[48:51], a[16:19], a[72:75], v[48:51]
s_lshl_b32 s70, s60, 10
s_add_u32 s70, s70, s87
buffer_store_dwordx4 v[20:23], v16, s[12:15], s70 offen sc1
v_mfma_f32_16x16x32_bf16 v[72:75], a[20:23], a[72:75], v[72:75]
v_mfma_f32_16x16x32_bf16 v[96:99], a[24:27], a[72:75], v[96:99]
s_add_u32 s70, s88, 0
buffer_store_dwordx4 v[20:23], v16, s[12:15], s70 offen sc1
v_mfma_f32_16x16x32_bf16 v[120:123], a[28:31], a[72:75], v[120:123]
v_mfma_f32_16x16x32_bf16 v[52:55], a[16:19], a[76:79], v[52:55]
s_add_u32 s70, s88, 32768
buffer_store_dwordx4 v[20:23], v16, s[12:15], s70 offen sc1
v_mfma_f32_16x16x32_bf16 v[76:79], a[20:23], a[76:79], v[76:79]
v_mfma_f32_16x16x32_bf16 v[100:103], a[24:27], a[76:79], v[100:103]
s_add_u32 s70, s88, 65536
buffer_store_dwordx4 v[20:23], v16, s[12:15], s70 offen sc1
v_mfma_f32_16x16x32_bf16 v[124:127], a[28:31], a[76:79], v[124:127]
s_waitcnt lgkmcnt(0)
v_mfma_f32_16x16x32_bf16 v[32:35], a[32:35], a[0:3], v[32:35]
ds_read_b128 a[16:19], v9 offset:40960
v_mfma_f32_16x16x32_bf16 v[56:59], a[32:35], a[4:7], v[56:59]
ds_read_b64_tr_b16 a[56:57], v12 offset:53248
v_mfma_f32_16x16x32_bf16 v[80:83], a[32:35], a[8:11], v[80:83]
ds_read_b64_tr_b16 a[58:59], v12 offset:53760
v_mfma_f32_16x16x32_bf16 v[104:107], a[32:35], a[12:15], v[104:107]
ds_read_b128 a[20:23], v9 offset:43008
v_mfma_f32_16x16x32_bf16 v[36:39], a[36:39], a[0:3], v[36:39]
ds_read_b128 a[24:27], v9 offset:45056
v_mfma_f32_16x16x32_bf16 v[60:63], a[36:39], a[4:7], v[60:63]
ds_read_b128 a[28:31], v9 offset:47104
v_mfma_f32_16x16x32_bf16 v[84:87], a[36:39], a[8:11], v[84:87]
ds_read_b64_tr_b16 a[60:61], v13 offset:53248
v_mfma_f32_16x16x32_bf16 v[108:111], a[36:39], a[12:15], v[108:111]
ds_read_b64_tr_b16 a[62:63], v13 offset:53760
v_mfma_f32_16x16x32_bf16 v[40:43], a[0:3], a[40:43], v[40:43]
ds_read_b64_tr_b16 a[64:65], v12 offset:55296
v_mfma_f32_16x16x32_bf16 v[64:67], a[4:7], a[40:43], v[64:67]
ds_read_b64_tr_b16 a[66:67], v12 offset:55808
v_mfma_f32_16x16x32_bf16 v[88:91], a[8:11], a[40:43], v[88:91]
ds_read_b64_tr_b16 a[68:69], v13 offset:55296
v_mfma_f32_16x16x32_bf16 v[112:115], a[12:15], a[40:43], v[112:115]
ds_read_b64_tr_b16 a[70:71], v13 offset:55808
v_mfma_f32_16x16x32_bf16 v[44:47], a[0:3], a[44:47], v[44:47]
ds_read_b64_tr_b16 a[72:73], v12 offset:57344
v_mfma_f32_16x16x32_bf16 v[68:71], a[4:7], a[44:47], v[68:71]
ds_read_b64_tr_b16 a[74:75], v12 offset:57856
v_mfma_f32_16x16x32_bf16 v[92:95], a[8:11], a[44:47], v[92:95]
ds_read_b64_tr_b16 a[76:77], v13 offset:57344
v_mfma_f32_16x16x32_bf16 v[116:119], a[12:15], a[44:47], v[116:119]
ds_read_b64_tr_b16 a[78:79], v13 offset:57856
v_mfma_f32_16x16x32_bf16 v[48:51], a[0:3], a[48:51], v[48:51]
s_add_u32 s70, s88, 98304
buffer_store_dwordx4 v[20:23], v16, s[12:15], s70 offen sc1
v_mfma_f32_16x16x32_bf16 v[72:75], a[4:7], a[48:51], v[72:75]
v_mfma_f32_16x16x32_bf16 v[96:99], a[8:11], a[48:51], v[96:99]
s_min_u32 s70, s79, 223
s_lshl_b32 s70, s70, 13
s_lshl_b32 s71, s60, 11
s_add_u32 s70, s70, s71
s_add_u32 s70, s70, 7340032
s_cmp_lt_u32 s63, 28
s_cbranch_scc0 L_noypc
buffer_store_dwordx4 v[20:23], v16, s[12:15], s70 offen sc1
buffer_store_dwordx4 v[20:23], v16, s[12:15], s70 offen offset:1024 sc1
L_noypc:
v_mfma_f32_16x16x32_bf16 v[120:123], a[12:15], a[48:51], v[120:123]
v_mfma_f32_16x16x32_bf16 v[52:55], a[0:3], a[52:55], v[52:55]
s_lshl_b32 s70, s60, 6
s_add_u32 s70, s70, s87
s_add_u32 s70, s70, 4096
s_mov_b64 exec, 0xf
buffer_store_dwordx4 v[20:23], v16, s[12:15], s70 offen sc1
s_mov_b64 exec, -1
v_mfma_f32_16x16x32_bf16 v[76:79], a[4:7], a[52:55], v[76:79]
v_mfma_f32_16x16x32_bf16 v[100:103], a[8:11], a[52:55], v[100:103]
s_lshl_b32 s70, s64, 12
s_lshl_b32 s71, s66, 11
s_add_u32 s70, s70, s71
s_lshl_b32 s71, s65, 7
s_add_u32 s70, s70, s71
s_lshl_b32 s71, s67, 6
s_add_u32 s70, s70, s71
s_add_u32 s70, s70, 6881280
s_mov_b64 exec, 0xf
buffer_store_dwordx4 v[20:23], v16, s[12:15], s70 offen sc1
s_mov_b64 exec, -1
v_mfma_f32_16x16x32_bf16 v[124:127], a[12:15], a[52:55], v[124:127]
s_waitcnt lgkmcnt(0)
v_mfma_f32_16x16x32_bf16 v[32:35], a[56:59], a[16:19], v[32:35]
s_barrier
ds_read_b128 a[0:3], v10 offset:0
v_mfma_f32_16x16x32_bf16 v[56:59], a[56:59], a[20:23], v[56:59]
ds_read_b64_tr_b16 a[32:33], v14 offset:0
v_mfma_f32_16x16x32_bf16 v[80:83], a[56:59], a[24:27], v[80:83]
ds_read_b64_tr_b16 a[34:35], v14 offset:512
v_mfma_f32_16x16x32_bf16 v[104:107], a[56:59], a[28:31], v[104:107]
ds_read_b128 a[4:7], v10 offset:2048
v_mfma_f32_16x16x32_bf16 v[36:39], a[60:63], a[16:19], v[36:39]
ds_read_b128 a[8:11], v10 offset:4096
v_mfma_f32_16x16x32_bf16 v[60:63], a[60:63], a[20:23], v[60:63]
ds_read_b128 a[12:15], v10 offset:6144
v_mfma_f32_16x16x32_bf16 v[84:87], a[60:63], a[24:27], v[84:87]
ds_read_b64_tr_b16 a[36:37], v15 offset:0
v_mfma_f32_16x16x32_bf16 v[108:111], a[60:63], a[28:31], v[108:111]
ds_read_b64_tr_b16 a[38:39], v15 offset:512
v_mfma_f32_16x16x32_bf16 v[40:43], a[16:19], a[64:67], v[40:43]
ds_read_b64_tr_b16 a[40:41], v14 offset:2048
v_mfma_f32_16x16x32_bf16 v[64:67], a[20:23], a[64:67], v[64:67]
ds_read_b64_tr_b16 a[42:43], v14 offset:2560
v_mfma_f32_16x16x32_bf16 v[88:91], a[24:27], a[64:67], v[88:91]
ds_read_b64_tr_b16 a[44:45], v15 offset:2048
v_mfma_f32_16x16x32_bf16 v[112:115], a[28:31], a[64:67], v[112:115]
ds_read_b64_tr_b16 a[46:47], v15 offset:2560
v_mfma_f32_16x16x32_bf16 v[44:47], a[16:19], a[68:71], v[44:47]
ds_read_b64_tr_b16 a[48:49], v14 offset:4096
v_mfma_f32_16x16x32_bf16 v[68:71], a[20:23], a[68:71], v[68:71]
ds_read_b64_tr_b16 a[50:51], v14 offset:4608
v_mfma_f32_16x16x32_bf16 v[92:95], a[24:27], a[68:71], v[92:95]
ds_read_b64_tr_b16 a[52:53], v15 offset:4096
v_mfma_f32_16x16x32_bf16 v[116:119], a[28:31], a[68:71], v[116:119]
ds_read_b64_tr_b16 a[54:55], v15 offset:4608
v_mfma_f32_16x16x32_bf16 v[48:51], a[16:19], a[72:75], v[48:51]
v_mfma_f32_16x16x32_bf16 v[72:75], a[20:23], a[72:75], v[72:75]
v_mfma_f32_16x16x32_bf16 v[96:99], a[24:27], a[72:75], v[96:99]
v_mfma_f32_16x16x32_bf16 v[120:123], a[28:31], a[72:75], v[120:123]
v_mfma_f32_16x16x32_bf16 v[52:55], a[16:19], a[76:79], v[52:55]
v_mfma_f32_16x16x32_bf16 v[76:79], a[20:23], a[76:79], v[76:79]
v_mfma_f32_16x16x32_bf16 v[100:103], a[24:27], a[76:79], v[100:103]
v_mfma_f32_16x16x32_bf16 v[124:127], a[28:31], a[76:79], v[124:127]
s_waitcnt lgkmcnt(0)
v_mfma_f32_16x16x32_bf16 v[32:35], a[32:35], a[0:3], v[32:35]
ds_read_b128 a[16:19], v11 offset:0
v_mfma_f32_16x16x32_bf16 v[56:59], a[32:35], a[4:7], v[56:59]
ds_read_b64_tr_b16 a[56:57], v14 offset:12288
v_mfma_f32_16x16x32_bf16 v[80:83], a[32:35], a[8:11], v[80:83]
ds_read_b64_tr_b16 a[58:59], v14 offset:12800
v_mfma_f32_16x16x32_bf16 v[104:107], a[32:35], a[12:15], v[104:107]
ds_read_b128 a[20:23], v11 offset:2048
v_mfma_f32_16x16x32_bf16 v[36:39], a[36:39], a[0:3], v[36:39]
ds_read_b128 a[24:27], v11 offset:4096
v_mfma_f32_16x16x32_bf16 v[60:63], a[36:39], a[4:7], v[60:63]
ds_read_b128 a[28:31], v11 offset:6144
v_mfma_f32_16x16x32_bf16 v[84:87], a[36:39], a[8:11], v[84:87]
ds_read_b64_tr_b16 a[60:61], v15 offset:12288
v_mfma_f32_16x16x32_bf16 v[108:111], a[36:39], a[12:15], v[108:111]
ds_read_b64_tr_b16 a[62:63], v15 offset:12800
v_mfma_f32_16x16x32_bf16 v[40:43], a[0:3], a[40:43], v[40:43]
ds_read_b64_tr_b16 a[64:65], v14 offset:14336
v_mfma_f32_16x16x32_bf16 v[64:67], a[4:7], a[40:43], v[64:67]
ds_read_b64_tr_b16 a[66:67], v14 offset:14848
v_mfma_f32_16x16x32_bf16 v[88:91], a[8:11], a[40:43], v[88:91]
ds_read_b64_tr_b16 a[68:69], v15 offset:14336
v_mfma_f32_16x16x32_bf16 v[112:115], a[12:15], a[40:43], v[112:115]
ds_read_b64_tr_b16 a[70:71], v15 offset:14848
v_mfma_f32_16x16x32_bf16 v[44:47], a[0:3], a[44:47], v[44:47]
ds_read_b64_tr_b16 a[72:73], v14 offset:16384
v_mfma_f32_16x16x32_bf16 v[68:71], a[4:7], a[44:47], v[68:71]
ds_read_b64_tr_b16 a[74:75], v14 offset:16896
v_mfma_f32_16x16x32_bf16 v[92:95], a[8:11], a[44:47], v[92:95]
ds_read_b64_tr_b16 a[76:77], v15 offset:16384
v_mfma_f32_16x16x32_bf16 v[116:119], a[12:15], a[44:47], v[116:119]
ds_read_b64_tr_b16 a[78:79], v15 offset:16896
v_mfma_f32_16x16x32_bf16 v[48:51], a[0:3], a[48:51], v[48:51]
v_mfma_f32_16x16x32_bf16 v[72:75], a[4:7], a[48:51], v[72:75]
v_mfma_f32_16x16x32_bf16 v[96:99], a[8:11], a[48:51], v[96:99]
v_mfma_f32_16x16x32_bf16 v[120:123], a[12:15], a[48:51], v[120:123]
v_mfma_f32_16x16x32_bf16 v[52:55], a[0:3], a[52:55], v[52:55]
v_mfma_f32_16x16x32_bf16 v[76:79], a[4:7], a[52:55], v[76:79]
v_mfma_f32_16x16x32_bf16 v[100:103], a[8:11], a[52:55], v[100:103]
v_mfma_f32_16x16x32_bf16 v[124:127], a[12:15], a[52:55], v[124:127]
s_waitcnt lgkmcnt(0)
v_mfma_f32_16x16x32_bf16 v[32:35], a[56:59], a[16:19], v[32:35]
s_barrier
ds_read_b128 a[0:3], v8 offset:0
v_mfma_f32_16x16x32_bf16 v[56:59], a[56:59], a[20:23], v[56:59]
ds_read_b64_tr_b16 a[32:33], v12 offset:0
v_mfma_f32_16x16x32_bf16 v[80:83], a[56:59], a[24:27], v[80:83]
ds_read_b64_tr_b16 a[34:35], v12 offset:512
v_mfma_f32_16x16x32_bf16 v[104:107], a[56:59], a[28:31], v[104:107]
ds_read_b128 a[4:7], v8 offset:2048
v_mfma_f32_16x16x32_bf16 v[36:39], a[60:63], a[16:19], v[36:39]
ds_read_b128 a[8:11], v8 offset:4096
v_mfma_f32_16x16x32_bf16 v[60:63], a[60:63], a[20:23], v[60:63]
ds_read_b128 a[12:15], v8 offset:6144
v_mfma_f32_16x16x32_bf16 v[84:87], a[60:63], a[24:27], v[84:87]
ds_read_b64_tr_b16 a[36:37], v13 offset:0
v_mfma_f32_16x16x32_bf16 v[108:111], a[60:63], a[28:31], v[108:111]
ds_read_b64_tr_b16 a[38:39], v13 offset:512
v_mfma_f32_16x16x32_bf16 v[40:43], a[16:19], a[64:67], v[40:43]
ds_read_b64_tr_b16 a[40:41], v12 offset:2048
v_mfma_f32_16x16x32_bf16 v[64:67], a[20:23], a[64:67], v[64:67]
ds_read_b64_tr_b16 a[42:43], v12 offset:2560
v_mfma_f32_16x16x32_bf16 v[88:91], a[24:27], a[64:67], v[88:91]
ds_read_b64_tr_b16 a[44:45], v13 offset:2048
v_mfma_f32_16x16x32_bf16 v[112:115], a[28:31], a[64:67], v[112:115]
ds_read_b64_tr_b16 a[46:47], v13 offset:2560
v_mfma_f32_16x16x32_bf16 v[44:47], a[16:19], a[68:71], v[44:47]
ds_read_b64_tr_b16 a[48:49], v12 offset:4096
v_mfma_f32_16x16x32_bf16 v[68:71], a[20:23], a[68:71], v[68:71]
ds_read_b64_tr_b16 a[50:51], v12 offset:4608
v_mfma_f32_16x16x32_bf16 v[92:95], a[24:27], a[68:71], v[92:95]
ds_read_b64_tr_b16 a[52:53], v13 offset:4096
v_mfma_f32_16x16x32_bf16 v[116:119], a[28:31], a[68:71], v[116:119]
ds_read_b64_tr_b16 a[54:55], v13 offset:4608
v_mfma_f32_16x16x32_bf16 v[48:51], a[16:19], a[72:75], v[48:51]
v_mfma_f32_16x16x32_bf16 v[72:75], a[20:23], a[72:75], v[72:75]
v_mfma_f32_16x16x32_bf16 v[96:99], a[24:27], a[72:75], v[96:99]
v_mfma_f32_16x16x32_bf16 v[120:123], a[28:31], a[72:75], v[120:123]
v_mfma_f32_16x16x32_bf16 v[52:55], a[16:19], a[76:79], v[52:55]
v_mfma_f32_16x16x32_bf16 v[76:79], a[20:23], a[76:79], v[76:79]
v_mfma_f32_16x16x32_bf16 v[100:103], a[24:27], a[76:79], v[100:103]
v_mfma_f32_16x16x32_bf16 v[124:127], a[28:31], a[76:79], v[124:127]
s_waitcnt lgkmcnt(0)
v_mfma_f32_16x16x32_bf16 v[32:35], a[32:35], a[0:3], v[32:35]
ds_read_b128 a[16:19], v9 offset:0
v_mfma_f32_16x16x32_bf16 v[56:59], a[32:35], a[4:7], v[56:59]
ds_read_b64_tr_b16 a[56:57], v12 offset:12288
v_mfma_f32_16x16x32_bf16 v[80:83], a[32:35], a[8:11], v[80:83]
ds_read_b64_tr_b16 a[58:59], v12 offset:12800
v_mfma_f32_16x16x32_bf16 v[104:107], a[32:35], a[12:15], v[104:107]
ds_read_b128 a[20:23], v9 offset:2048
v_mfma_f32_16x16x32_bf16 v[36:39], a[36:39], a[0:3], v[36:39]
ds_read_b128 a[24:27], v9 offset:4096
v_mfma_f32_16x16x32_bf16 v[60:63], a[36:39], a[4:7], v[60:63]
ds_read_b128 a[28:31], v9 offset:6144
v_mfma_f32_16x16x32_bf16 v[84:87], a[36:39], a[8:11], v[84:87]
ds_read_b64_tr_b16 a[60:61], v13 offset:12288
v_mfma_f32_16x16x32_bf16 v[108:111], a[36:39], a[12:15], v[108:111]
ds_read_b64_tr_b16 a[62:63], v13 offset:12800
v_mfma_f32_16x16x32_bf16 v[40:43], a[0:3], a[40:43], v[40:43]
ds_read_b64_tr_b16 a[64:65], v12 offset:14336
v_mfma_f32_16x16x32_bf16 v[64:67], a[4:7], a[40:43], v[64:67]
ds_read_b64_tr_b16 a[66:67], v12 offset:14848
v_mfma_f32_16x16x32_bf16 v[88:91], a[8:11], a[40:43], v[88:91]
ds_read_b64_tr_b16 a[68:69], v13 offset:14336
v_mfma_f32_16x16x32_bf16 v[112:115], a[12:15], a[40:43], v[112:115]
ds_read_b64_tr_b16 a[70:71], v13 offset:14848
v_mfma_f32_16x16x32_bf16 v[44:47], a[0:3], a[44:47], v[44:47]
ds_read_b64_tr_b16 a[72:73], v12 offset:16384
v_mfma_f32_16x16x32_bf16 v[68:71], a[4:7], a[44:47], v[68:71]
ds_read_b64_tr_b16 a[74:75], v12 offset:16896
v_mfma_f32_16x16x32_bf16 v[92:95], a[8:11], a[44:47], v[92:95]
ds_read_b64_tr_b16 a[76:77], v13 offset:16384
v_mfma_f32_16x16x32_bf16 v[116:119], a[12:15], a[44:47], v[116:119]
ds_read_b64_tr_b16 a[78:79], v13 offset:16896
v_mfma_f32_16x16x32_bf16 v[48:51], a[0:3], a[48:51], v[48:51]
s_cmp_lg_u32 s66, 0
s_cbranch_scc1 L_nocsp
v_and_b32 v2, 16, v1
v_cmp_ne_u32 vcc, 0, v2
s_nop 1
v_cndmask_b32 v24, v128, v132, vcc
v_cndmask_b32 v25, v136, v140, vcc
v_cndmask_b32 v26, v144, v148, vcc
v_mov_b32 v27, s68
s_lshl_b32 s70, s64, 4
s_add_u32 s70, s70, s65
s_lshl_b32 s70, s70, 10
s_lshl_b32 s71, s67, 9
s_add_u32 s70, s70, s71
s_add_u32 s70, s70, 65536
s_mov_b64 exec, 0xffffffff
buffer_store_dwordx4 v[24:27], v16, s[12:15], s70 offen sc1
s_mov_b64 exec, -1
L_nocsp:
v_mfma_f32_16x16x32_bf16 v[72:75], a[4:7], a[48:51], v[72:75]
v_mfma_f32_16x16x32_bf16 v[96:99], a[8:11], a[48:51], v[96:99]
v_mfma_f32_16x16x32_bf16 v[120:123], a[12:15], a[48:51], v[120:123]
v_mfma_f32_16x16x32_bf16 v[52:55], a[0:3], a[52:55], v[52:55]
v_mfma_f32_16x16x32_bf16 v[76:79], a[4:7], a[52:55], v[76:79]
v_mfma_f32_16x16x32_bf16 v[100:103], a[8:11], a[52:55], v[100:103]
v_mfma_f32_16x16x32_bf16 v[124:127], a[12:15], a[52:55], v[124:127]
s_waitcnt lgkmcnt(0)
v_mfma_f32_16x16x32_bf16 v[32:35], a[56:59], a[16:19], v[32:35]
s_barrier
ds_read_b128 a[0:3], v8 offset:40960
v_mfma_f32_16x16x32_bf16 v[56:59], a[56:59], a[20:23], v[56:59]
ds_read_b64_tr_b16 a[32:33], v12 offset:40960
v_mfma_f32_16x16x32_bf16 v[80:83], a[56:59], a[24:27], v[80:83]
ds_read_b64_tr_b16 a[34:35], v12 offset:41472
v_mfma_f32_16x16x32_bf16 v[104:107], a[56:59], a[28:31], v[104:107]
ds_read_b128 a[4:7], v8 offset:43008
v_mfma_f32_16x16x32_bf16 v[36:39], a[60:63], a[16:19], v[36:39]
ds_read_b128 a[8:11], v8 offset:45056
v_mfma_f32_16x16x32_bf16 v[60:63], a[60:63], a[20:23], v[60:63]
ds_read_b128 a[12:15], v8 offset:47104
v_mfma_f32_16x16x32_bf16 v[84:87], a[60:63], a[24:27], v[84:87]
ds_read_b64_tr_b16 a[36:37], v13 offset:40960
v_mfma_f32_16x16x32_bf16 v[108:111], a[60:63], a[28:31], v[108:111]
ds_read_b64_tr_b16 a[38:39], v13 offset:41472
v_mfma_f32_16x16x32_bf16 v[40:43], a[16:19], a[64:67], v[40:43]
ds_read_b64_tr_b16 a[40:41], v12 offset:43008
v_mfma_f32_16x16x32_bf16 v[64:67], a[20:23], a[64:67], v[64:67]
ds_read_b64_tr_b16 a[42:43], v12 offset:43520
v_mfma_f32_16x16x32_bf16 v[88:91], a[24:27], a[64:67], v[88:91]
ds_read_b64_tr_b16 a[44:45], v13 offset:43008
v_mfma_f32_16x16x32_bf16 v[112:115], a[28:31], a[64:67], v[112:115]
ds_read_b64_tr_b16 a[46:47], v13 offset:43520
v_mfma_f32_16x16x32_bf16 v[44:47], a[16:19], a[68:71], v[44:47]
ds_read_b64_tr_b16 a[48:49], v12 offset:45056
v_mfma_f32_16x16x32_bf16 v[68:71], a[20:23], a[68:71], v[68:71]
ds_read_b64_tr_b16 a[50:51], v12 offset:45568
v_mfma_f32_16x16x32_bf16 v[92:95], a[24:27], a[68:71], v[92:95]
ds_read_b64_tr_b16 a[52:53], v13 offset:45056
v_mfma_f32_16x16x32_bf16 v[116:119], a[28:31], a[68:71], v[116:119]
ds_read_b64_tr_b16 a[54:55], v13 offset:45568
v_mfma_f32_16x16x32_bf16 v[48:51], a[16:19], a[72:75], v[48:51]
v_mfma_f32_16x16x32_bf16 v[72:75], a[20:23], a[72:75], v[72:75]
v_mfma_f32_16x16x32_bf16 v[96:99], a[24:27], a[72:75], v[96:99]
v_mfma_f32_16x16x32_bf16 v[120:123], a[28:31], a[72:75], v[120:123]
v_mfma_f32_16x16x32_bf16 v[52:55], a[16:19], a[76:79], v[52:55]
v_mfma_f32_16x16x32_bf16 v[76:79], a[20:23], a[76:79], v[76:79]
v_mfma_f32_16x16x32_bf16 v[100:103], a[24:27], a[76:79], v[100:103]
v_mfma_f32_16x16x32_bf16 v[124:127], a[28:31], a[76:79], v[124:127]
s_waitcnt lgkmcnt(0)
v_mfma_f32_16x16x32_bf16 v[32:35], a[32:35], a[0:3], v[32:35]
ds_read_b128 a[16:19], v9 offset:40960
v_mfma_f32_16x16x32_bf16 v[56:59], a[32:35], a[4:7], v[56:59]
ds_read_b64_tr_b16 a[56:57], v12 offset:53248
v_mfma_f32_16x16x32_bf16 v[80:83], a[32:35], a[8:11], v[80:83]
ds_read_b64_tr_b16 a[58:59], v12 offset:53760
v_mfma_f32_16x16x32_bf16 v[104:107], a[32:35], a[12:15], v[104:107]
ds_read_b128 a[20:23], v9 offset:43008
v_mfma_f32_16x16x32_bf16 v[36:39], a[36:39], a[0:3], v[36:39]
ds_read_b128 a[24:27], v9 offset:45056
v_mfma_f32_16x16x32_bf16 v[60:63], a[36:39], a[4:7], v[60:63]
ds_read_b128 a[28:31], v9 offset:47104
v_mfma_f32_16x16x32_bf16 v[84:87], a[36:39], a[8:11], v[84:87]
ds_read_b64_tr_b16 a[60:61], v13 offset:53248
v_mfma_f32_16x16x32_bf16 v[108:111], a[36:39], a[12:15], v[108:111]
ds_read_b64_tr_b16 a[62:63], v13 offset:53760
v_mfma_f32_16x16x32_bf16 v[40:43], a[0:3], a[40:43], v[40:43]
ds_read_b64_tr_b16 a[64:65], v12 offset:55296
v_mfma_f32_16x16x32_bf16 v[64:67], a[4:7], a[40:43], v[64:67]
ds_read_b64_tr_b16 a[66:67], v12 offset:55808
v_mfma_f32_16x16x32_bf16 v[88:91], a[8:11], a[40:43], v[88:91]
ds_read_b64_tr_b16 a[68:69], v13 offset:55296
v_mfma_f32_16x16x32_bf16 v[112:115], a[12:15], a[40:43], v[112:115]
ds_read_b64_tr_b16 a[70:71], v13 offset:55808
v_mfma_f32_16x16x32_bf16 v[44:47], a[0:3], a[44:47], v[44:47]
ds_read_b64_tr_b16 a[72:73], v12 offset:57344
v_mfma_f32_16x16x32_bf16 v[68:71], a[4:7], a[44:47], v[68:71]
ds_read_b64_tr_b16 a[74:75], v12 offset:57856
v_mfma_f32_16x16x32_bf16 v[92:95], a[8:11], a[44:47], v[92:95]
ds_read_b64_tr_b16 a[76:77], v13 offset:57344
v_mfma_f32_16x16x32_bf16 v[116:119], a[12:15], a[44:47], v[116:119]
ds_read_b64_tr_b16 a[78:79], v13 offset:57856
v_mfma_f32_16x16x32_bf16 v[48:51], a[0:3], a[48:51], v[48:51]
v_mfma_f32_16x16x32_bf16 v[72:75], a[4:7], a[48:51], v[72:75]
v_mfma_f32_16x16x32_bf16 v[96:99], a[8:11], a[48:51], v[96:99]
v_mfma_f32_16x16x32_bf16 v[120:123], a[12:15], a[48:51], v[120:123]
v_mfma_f32_16x16x32_bf16 v[52:55], a[0:3], a[52:55], v[52:55]
v_mfma_f32_16x16x32_bf16 v[76:79], a[4:7], a[52:55], v[76:79]
v_mfma_f32_16x16x32_bf16 v[100:103], a[8:11], a[52:55], v[100:103]
v_mfma_f32_16x16x32_bf16 v[124:127], a[12:15], a[52:55], v[124:127]
s_waitcnt lgkmcnt(0)
v_mfma_f32_16x16x32_bf16 v[32:35], a[56:59], a[16:19], v[32:35]
s_waitcnt vmcnt(0)
s_barrier
ds_read_b128 a[0:3], v10 offset:0
v_mfma_f32_16x16x32_bf16 v[56:59], a[56:59], a[20:23], v[56:59]
ds_read_b64_tr_b16 a[32:33], v14 offset:0
v_mfma_f32_16x16x32_bf16 v[80:83], a[56:59], a[24:27], v[80:83]
ds_read_b64_tr_b16 a[34:35], v14 offset:512
v_mfma_f32_16x16x32_bf16 v[104:107], a[56:59], a[28:31], v[104:107]
ds_read_b128 a[4:7], v10 offset:2048
v_mfma_f32_16x16x32_bf16 v[36:39], a[60:63], a[16:19], v[36:39]
ds_read_b128 a[8:11], v10 offset:4096
v_mfma_f32_16x16x32_bf16 v[60:63], a[60:63], a[20:23], v[60:63]
ds_read_b128 a[12:15], v10 offset:6144
v_mfma_f32_16x16x32_bf16 v[84:87], a[60:63], a[24:27], v[84:87]
ds_read_b64_tr_b16 a[36:37], v15 offset:0
v_mfma_f32_16x16x32_bf16 v[108:111], a[60:63], a[28:31], v[108:111]
ds_read_b64_tr_b16 a[38:39], v15 offset:512
v_mfma_f32_16x16x32_bf16 v[40:43], a[16:19], a[64:67], v[40:43]
ds_read_b64_tr_b16 a[40:41], v14 offset:2048
v_mfma_f32_16x16x32_bf16 v[64:67], a[20:23], a[64:67], v[64:67]
ds_read_b64_tr_b16 a[42:43], v14 offset:2560
v_mfma_f32_16x16x32_bf16 v[88:91], a[24:27], a[64:67], v[88:91]
ds_read_b64_tr_b16 a[44:45], v15 offset:2048
v_mfma_f32_16x16x32_bf16 v[112:115], a[28:31], a[64:67], v[112:115]
ds_read_b64_tr_b16 a[46:47], v15 offset:2560
v_mfma_f32_16x16x32_bf16 v[44:47], a[16:19], a[68:71], v[44:47]
ds_read_b64_tr_b16 a[48:49], v14 offset:4096
v_mfma_f32_16x16x32_bf16 v[68:71], a[20:23], a[68:71], v[68:71]
ds_read_b64_tr_b16 a[50:51], v14 offset:4608
v_mfma_f32_16x16x32_bf16 v[92:95], a[24:27], a[68:71], v[92:95]
ds_read_b64_tr_b16 a[52:53], v15 offset:4096
v_mfma_f32_16x16x32_bf16 v[116:119], a[28:31], a[68:71], v[116:119]
ds_read_b64_tr_b16 a[54:55], v15 offset:4608
v_mfma_f32_16x16x32_bf16 v[48:51], a[16:19], a[72:75], v[48:51]
v_mfma_f32_16x16x32_bf16 v[72:75], a[20:23], a[72:75], v[72:75]
v_mfma_f32_16x16x32_bf16 v[96:99], a[24:27], a[72:75], v[96:99]
v_mfma_f32_16x16x32_bf16 v[120:123], a[28:31], a[72:75], v[120:123]
v_mfma_f32_16x16x32_bf16 v[52:55], a[16:19], a[76:79], v[52:55]
v_mfma_f32_16x16x32_bf16 v[76:79], a[20:23], a[76:79], v[76:79]
v_mfma_f32_16x16x32_bf16 v[100:103], a[24:27], a[76:79], v[100:103]
v_mfma_f32_16x16x32_bf16 v[124:127], a[28:31], a[76:79], v[124:127]
s_waitcnt lgkmcnt(0)
v_mfma_f32_16x16x32_bf16 v[32:35], a[32:35], a[0:3], v[32:35]
ds_read_b128 a[16:19], v11 offset:0
v_mfma_f32_16x16x32_bf16 v[56:59], a[32:35], a[4:7], v[56:59]
ds_read_b64_tr_b16 a[56:57], v14 offset:12288
v_mfma_f32_16x16x32_bf16 v[80:83], a[32:35], a[8:11], v[80:83]
ds_read_b64_tr_b16 a[58:59], v14 offset:12800
v_mfma_f32_16x16x32_bf16 v[104:107], a[32:35], a[12:15], v[104:107]
ds_read_b128 a[20:23], v11 offset:2048
v_mfma_f32_16x16x32_bf16 v[36:39], a[36:39], a[0:3], v[36:39]
ds_read_b128 a[24:27], v11 offset:4096
v_mfma_f32_16x16x32_bf16 v[60:63], a[36:39], a[4:7], v[60:63]
ds_read_b128 a[28:31], v11 offset:6144
v_mfma_f32_16x16x32_bf16 v[84:87], a[36:39], a[8:11], v[84:87]
ds_read_b64_tr_b16 a[60:61], v15 offset:12288
v_mfma_f32_16x16x32_bf16 v[108:111], a[36:39], a[12:15], v[108:111]
ds_read_b64_tr_b16 a[62:63], v15 offset:12800
v_mfma_f32_16x16x32_bf16 v[40:43], a[0:3], a[40:43], v[40:43]
ds_read_b64_tr_b16 a[64:65], v14 offset:14336
v_mfma_f32_16x16x32_bf16 v[64:67], a[4:7], a[40:43], v[64:67]
ds_read_b64_tr_b16 a[66:67], v14 offset:14848
v_mfma_f32_16x16x32_bf16 v[88:91], a[8:11], a[40:43], v[88:91]
ds_read_b64_tr_b16 a[68:69], v15 offset:14336
v_mfma_f32_16x16x32_bf16 v[112:115], a[12:15], a[40:43], v[112:115]
ds_read_b64_tr_b16 a[70:71], v15 offset:14848
v_mfma_f32_16x16x32_bf16 v[44:47], a[0:3], a[44:47], v[44:47]
ds_read_b64_tr_b16 a[72:73], v14 offset:16384
v_mfma_f32_16x16x32_bf16 v[68:71], a[4:7], a[44:47], v[68:71]
ds_read_b64_tr_b16 a[74:75], v14 offset:16896
v_mfma_f32_16x16x32_bf16 v[92:95], a[8:11], a[44:47], v[92:95]
ds_read_b64_tr_b16 a[76:77], v15 offset:16384
v_mfma_f32_16x16x32_bf16 v[116:119], a[12:15], a[44:47], v[116:119]
ds_read_b64_tr_b16 a[78:79], v15 offset:16896
v_mfma_f32_16x16x32_bf16 v[48:51], a[0:3], a[48:51], v[48:51]
v_mfma_f32_16x16x32_bf16 v[72:75], a[4:7], a[48:51], v[72:75]
v_mfma_f32_16x16x32_bf16 v[96:99], a[8:11], a[48:51], v[96:99]
v_mfma_f32_16x16x32_bf16 v[120:123], a[12:15], a[48:51], v[120:123]
v_mfma_f32_16x16x32_bf16 v[52:55], a[0:3], a[52:55], v[52:55]
v_mfma_f32_16x16x32_bf16 v[76:79], a[4:7], a[52:55], v[76:79]
v_mfma_f32_16x16x32_bf16 v[100:103], a[8:11], a[52:55], v[100:103]
v_mfma_f32_16x16x32_bf16 v[124:127], a[12:15], a[52:55], v[124:127]
s_waitcnt lgkmcnt(0)
v_mfma_f32_16x16x32_bf16 v[32:35], a[56:59], a[16:19], v[32:35]
s_barrier
ds_read_b128 a[0:3], v8 offset:0
v_mfma_f32_16x16x32_bf16 v[56:59], a[56:59], a[20:23], v[56:59]
ds_read_b64_tr_b16 a[32:33], v12 offset:0
v_mfma_f32_16x16x32_bf16 v[80:83], a[56:59], a[24:27], v[80:83]
ds_read_b64_tr_b16 a[34:35], v12 offset:512
v_mfma_f32_16x16x32_bf16 v[104:107], a[56:59], a[28:31], v[104:107]
ds_read_b128 a[4:7], v8 offset:2048
v_mfma_f32_16x16x32_bf16 v[36:39], a[60:63], a[16:19], v[36:39]
ds_read_b128 a[8:11], v8 offset:4096
v_mfma_f32_16x16x32_bf16 v[60:63], a[60:63], a[20:23], v[60:63]
ds_read_b128 a[12:15], v8 offset:6144
v_mfma_f32_16x16x32_bf16 v[84:87], a[60:63], a[24:27], v[84:87]
ds_read_b64_tr_b16 a[36:37], v13 offset:0
v_mfma_f32_16x16x32_bf16 v[108:111], a[60:63], a[28:31], v[108:111]
ds_read_b64_tr_b16 a[38:39], v13 offset:512
v_mfma_f32_16x16x32_bf16 v[40:43], a[16:19], a[64:67], v[40:43]
ds_read_b64_tr_b16 a[40:41], v12 offset:2048
v_mfma_f32_16x16x32_bf16 v[64:67], a[20:23], a[64:67], v[64:67]
ds_read_b64_tr_b16 a[42:43], v12 offset:2560
v_mfma_f32_16x16x32_bf16 v[88:91], a[24:27], a[64:67], v[88:91]
ds_read_b64_tr_b16 a[44:45], v13 offset:2048
v_mfma_f32_16x16x32_bf16 v[112:115], a[28:31], a[64:67], v[112:115]
ds_read_b64_tr_b16 a[46:47], v13 offset:2560
v_mfma_f32_16x16x32_bf16 v[44:47], a[16:19], a[68:71], v[44:47]
ds_read_b64_tr_b16 a[48:49], v12 offset:4096
v_mfma_f32_16x16x32_bf16 v[68:71], a[20:23], a[68:71], v[68:71]
ds_read_b64_tr_b16 a[50:51], v12 offset:4608
v_mfma_f32_16x16x32_bf16 v[92:95], a[24:27], a[68:71], v[92:95]
ds_read_b64_tr_b16 a[52:53], v13 offset:4096
v_mfma_f32_16x16x32_bf16 v[116:119], a[28:31], a[68:71], v[116:119]
ds_read_b64_tr_b16 a[54:55], v13 offset:4608
v_mfma_f32_16x16x32_bf16 v[48:51], a[16:19], a[72:75], v[48:51]
v_mfma_f32_16x16x32_bf16 v[72:75], a[20:23], a[72:75], v[72:75]
v_mfma_f32_16x16x32_bf16 v[96:99], a[24:27], a[72:75], v[96:99]
v_mfma_f32_16x16x32_bf16 v[120:123], a[28:31], a[72:75], v[120:123]
v_mfma_f32_16x16x32_bf16 v[52:55], a[16:19], a[76:79], v[52:55]
v_mfma_f32_16x16x32_bf16 v[76:79], a[20:23], a[76:79], v[76:79]
v_mfma_f32_16x16x32_bf16 v[100:103], a[24:27], a[76:79], v[100:103]
v_mfma_f32_16x16x32_bf16 v[124:127], a[28:31], a[76:79], v[124:127]
s_waitcnt lgkmcnt(0)
v_mfma_f32_16x16x32_bf16 v[32:35], a[32:35], a[0:3], v[32:35]
ds_read_b128 a[16:19], v9 offset:0
v_mfma_f32_16x16x32_bf16 v[56:59], a[32:35], a[4:7], v[56:59]
ds_read_b64_tr_b16 a[56:57], v12 offset:12288
v_mfma_f32_16x16x32_bf16 v[80:83], a[32:35], a[8:11], v[80:83]
ds_read_b64_tr_b16 a[58:59], v12 offset:12800
v_mfma_f32_16x16x32_bf16 v[104:107], a[32:35], a[12:15], v[104:107]
ds_read_b128 a[20:23], v9 offset:2048
v_mfma_f32_16x16x32_bf16 v[36:39], a[36:39], a[0:3], v[36:39]
ds_read_b128 a[24:27], v9 offset:4096
v_mfma_f32_16x16x32_bf16 v[60:63], a[36:39], a[4:7], v[60:63]
ds_read_b128 a[28:31], v9 offset:6144
v_mfma_f32_16x16x32_bf16 v[84:87], a[36:39], a[8:11], v[84:87]
ds_read_b64_tr_b16 a[60:61], v13 offset:12288
v_mfma_f32_16x16x32_bf16 v[108:111], a[36:39], a[12:15], v[108:111]
ds_read_b64_tr_b16 a[62:63], v13 offset:12800
v_mfma_f32_16x16x32_bf16 v[40:43], a[0:3], a[40:43], v[40:43]
ds_read_b64_tr_b16 a[64:65], v12 offset:14336
v_mfma_f32_16x16x32_bf16 v[64:67], a[4:7], a[40:43], v[64:67]
ds_read_b64_tr_b16 a[66:67], v12 offset:14848
v_mfma_f32_16x16x32_bf16 v[88:91], a[8:11], a[40:43], v[88:91]
ds_read_b64_tr_b16 a[68:69], v13 offset:14336
v_mfma_f32_16x16x32_bf16 v[112:115], a[12:15], a[40:43], v[112:115]
ds_read_b64_tr_b16 a[70:71], v13 offset:14848
v_mfma_f32_16x16x32_bf16 v[44:47], a[0:3], a[44:47], v[44:47]
ds_read_b64_tr_b16 a[72:73], v12 offset:16384
v_mfma_f32_16x16x32_bf16 v[68:71], a[4:7], a[44:47], v[68:71]
ds_read_b64_tr_b16 a[74:75], v12 offset:16896
v_mfma_f32_16x16x32_bf16 v[92:95], a[8:11], a[44:47], v[92:95]
ds_read_b64_tr_b16 a[76:77], v13 offset:16384
v_mfma_f32_16x16x32_bf16 v[116:119], a[12:15], a[44:47], v[116:119]
ds_read_b64_tr_b16 a[78:79], v13 offset:16896
v_mfma_f32_16x16x32_bf16 v[48:51], a[0:3], a[48:51], v[48:51]
v_mfma_f32_16x16x32_bf16 v[72:75], a[4:7], a[48:51], v[72:75]
v_mfma_f32_16x16x32_bf16 v[96:99], a[8:11], a[48:51], v[96:99]
v_mfma_f32_16x16x32_bf16 v[120:123], a[12:15], a[48:51], v[120:123]
v_mfma_f32_16x16x32_bf16 v[52:55], a[0:3], a[52:55], v[52:55]
v_mfma_f32_16x16x32_bf16 v[76:79], a[4:7], a[52:55], v[76:79]
v_mfma_f32_16x16x32_bf16 v[100:103], a[8:11], a[52:55], v[100:103]
v_mfma_f32_16x16x32_bf16 v[124:127], a[12:15], a[52:55], v[124:127]
s_waitcnt lgkmcnt(0)
v_mfma_f32_16x16x32_bf16 v[32:35], a[56:59], a[16:19], v[32:35]
s_barrier
ds_read_b128 a[0:3], v8 offset:40960
v_mfma_f32_16x16x32_bf16 v[56:59], a[56:59], a[20:23], v[56:59]
ds_read_b64_tr_b16 a[32:33], v12 offset:40960
v_mfma_f32_16x16x32_bf16 v[80:83], a[56:59], a[24:27], v[80:83]
ds_read_b64_tr_b16 a[34:35], v12 offset:41472
v_mfma_f32_16x16x32_bf16 v[104:107], a[56:59], a[28:31], v[104:107]
ds_read_b128 a[4:7], v8 offset:43008
v_mfma_f32_16x16x32_bf16 v[36:39], a[60:63], a[16:19], v[36:39]
ds_read_b128 a[8:11], v8 offset:45056
v_mfma_f32_16x16x32_bf16 v[60:63], a[60:63], a[20:23], v[60:63]
ds_read_b128 a[12:15], v8 offset:47104
v_mfma_f32_16x16x32_bf16 v[84:87], a[60:63], a[24:27], v[84:87]
ds_read_b64_tr_b16 a[36:37], v13 offset:40960
v_mfma_f32_16x16x32_bf16 v[108:111], a[60:63], a[28:31], v[108:111]
ds_read_b64_tr_b16 a[38:39], v13 offset:41472
v_mfma_f32_16x16x32_bf16 v[40:43], a[16:19], a[64:67], v[40:43]
ds_read_b64_tr_b16 a[40:41], v12 offset:43008
v_mfma_f32_16x16x32_bf16 v[64:67], a[20:23], a[64:67], v[64:67]
ds_read_b64_tr_b16 a[42:43], v12 offset:43520
v_mfma_f32_16x16x32_bf16 v[88:91], a[24:27], a[64:67], v[88:91]
ds_read_b64_tr_b16 a[44:45], v13 offset:43008
v_mfma_f32_16x16x32_bf16 v[112:115], a[28:31], a[64:67], v[112:115]
ds_read_b64_tr_b16 a[46:47], v13 offset:43520
v_mfma_f32_16x16x32_bf16 v[44:47], a[16:19], a[68:71], v[44:47]
ds_read_b64_tr_b16 a[48:49], v12 offset:45056
v_mfma_f32_16x16x32_bf16 v[68:71], a[20:23], a[68:71], v[68:71]
ds_read_b64_tr_b16 a[50:51], v12 offset:45568
v_mfma_f32_16x16x32_bf16 v[92:95], a[24:27], a[68:71], v[92:95]
ds_read_b64_tr_b16 a[52:53], v13 offset:45056
v_mfma_f32_16x16x32_bf16 v[116:119], a[28:31], a[68:71], v[116:119]
ds_read_b64_tr_b16 a[54:55], v13 offset:45568
v_mfma_f32_16x16x32_bf16 v[48:51], a[16:19], a[72:75], v[48:51]
v_mfma_f32_16x16x32_bf16 v[72:75], a[20:23], a[72:75], v[72:75]
v_mfma_f32_16x16x32_bf16 v[96:99], a[24:27], a[72:75], v[96:99]
v_mfma_f32_16x16x32_bf16 v[120:123], a[28:31], a[72:75], v[120:123]
v_mfma_f32_16x16x32_bf16 v[52:55], a[16:19], a[76:79], v[52:55]
v_mfma_f32_16x16x32_bf16 v[76:79], a[20:23], a[76:79], v[76:79]
v_mfma_f32_16x16x32_bf16 v[100:103], a[24:27], a[76:79], v[100:103]
v_mfma_f32_16x16x32_bf16 v[124:127], a[28:31], a[76:79], v[124:127]
s_waitcnt lgkmcnt(0)
v_mfma_f32_16x16x32_bf16 v[32:35], a[32:35], a[0:3], v[32:35]
ds_read_b128 a[16:19], v9 offset:40960
v_mfma_f32_16x16x32_bf16 v[56:59], a[32:35], a[4:7], v[56:59]
ds_read_b64_tr_b16 a[56:57], v12 offset:53248
v_mfma_f32_16x16x32_bf16 v[80:83], a[32:35], a[8:11], v[80:83]
ds_read_b64_tr_b16 a[58:59], v12 offset:53760
v_mfma_f32_16x16x32_bf16 v[104:107], a[32:35], a[12:15], v[104:107]
ds_read_b128 a[20:23], v9 offset:43008
v_mfma_f32_16x16x32_bf16 v[36:39], a[36:39], a[0:3], v[36:39]
ds_read_b128 a[24:27], v9 offset:45056
v_mfma_f32_16x16x32_bf16 v[60:63], a[36:39], a[4:7], v[60:63]
ds_read_b128 a[28:31], v9 offset:47104
v_mfma_f32_16x16x32_bf16 v[84:87], a[36:39], a[8:11], v[84:87]
ds_read_b64_tr_b16 a[60:61], v13 offset:53248
v_mfma_f32_16x16x32_bf16 v[108:111], a[36:39], a[12:15], v[108:111]
ds_read_b64_tr_b16 a[62:63], v13 offset:53760
v_mfma_f32_16x16x32_bf16 v[40:43], a[0:3], a[40:43], v[40:43]
ds_read_b64_tr_b16 a[64:65], v12 offset:55296
v_mfma_f32_16x16x32_bf16 v[64:67], a[4:7], a[40:43], v[64:67]
ds_read_b64_tr_b16 a[66:67], v12 offset:55808
v_mfma_f32_16x16x32_bf16 v[88:91], a[8:11], a[40:43], v[88:91]
ds_read_b64_tr_b16 a[68:69], v13 offset:55296
v_mfma_f32_16x16x32_bf16 v[112:115], a[12:15], a[40:43], v[112:115]
ds_read_b64_tr_b16 a[70:71], v13 offset:55808
v_mfma_f32_16x16x32_bf16 v[44:47], a[0:3], a[44:47], v[44:47]
ds_read_b64_tr_b16 a[72:73], v12 offset:57344
v_mfma_f32_16x16x32_bf16 v[68:71], a[4:7], a[44:47], v[68:71]
ds_read_b64_tr_b16 a[74:75], v12 offset:57856
v_mfma_f32_16x16x32_bf16 v[92:95], a[8:11], a[44:47], v[92:95]
ds_read_b64_tr_b16 a[76:77], v13 offset:57344
v_mfma_f32_16x16x32_bf16 v[116:119], a[12:15], a[44:47], v[116:119]
ds_read_b64_tr_b16 a[78:79], v13 offset:57856
v_mfma_f32_16x16x32_bf16 v[48:51], a[0:3], a[48:51], v[48:51]
v_mfma_f32_16x16x32_bf16 v[72:75], a[4:7], a[48:51], v[72:75]
v_mfma_f32_16x16x32_bf16 v[96:99], a[8:11], a[48:51], v[96:99]
v_mfma_f32_16x16x32_bf16 v[120:123], a[12:15], a[48:51], v[120:123]
v_mfma_f32_16x16x32_bf16 v[52:55], a[0:3], a[52:55], v[52:55]
v_mfma_f32_16x16x32_bf16 v[76:79], a[4:7], a[52:55], v[76:79]
v_mfma_f32_16x16x32_bf16 v[100:103], a[8:11], a[52:55], v[100:103]
v_mfma_f32_16x16x32_bf16 v[124:127], a[12:15], a[52:55], v[124:127]
s_waitcnt lgkmcnt(0)
v_mfma_f32_16x16x32_bf16 v[32:35], a[56:59], a[16:19], v[32:35]
s_barrier
ds_read_b128 a[0:3], v10 offset:0
v_mfma_f32_16x16x32_bf16 v[56:59], a[56:59], a[20:23], v[56:59]
ds_read_b64_tr_b16 a[32:33], v14 offset:0
v_mfma_f32_16x16x32_bf16 v[80:83], a[56:59], a[24:27], v[80:83]
ds_read_b64_tr_b16 a[34:35], v14 offset:512
v_mfma_f32_16x16x32_bf16 v[104:107], a[56:59], a[28:31], v[104:107]
ds_read_b128 a[4:7], v10 offset:2048
v_mfma_f32_16x16x32_bf16 v[36:39], a[60:63], a[16:19], v[36:39]
ds_read_b128 a[8:11], v10 offset:4096
v_mfma_f32_16x16x32_bf16 v[60:63], a[60:63], a[20:23], v[60:63]
ds_read_b128 a[12:15], v10 offset:6144
v_mfma_f32_16x16x32_bf16 v[84:87], a[60:63], a[24:27], v[84:87]
ds_read_b64_tr_b16 a[36:37], v15 offset:0
v_mfma_f32_16x16x32_bf16 v[108:111], a[60:63], a[28:31], v[108:111]
ds_read_b64_tr_b16 a[38:39], v15 offset:512
v_mfma_f32_16x16x32_bf16 v[40:43], a[16:19], a[64:67], v[40:43]
ds_read_b64_tr_b16 a[40:41], v14 offset:2048
v_mfma_f32_16x16x32_bf16 v[64:67], a[20:23], a[64:67], v[64:67]
ds_read_b64_tr_b16 a[42:43], v14 offset:2560
v_mfma_f32_16x16x32_bf16 v[88:91], a[24:27], a[64:67], v[88:91]
ds_read_b64_tr_b16 a[44:45], v15 offset:2048
v_mfma_f32_16x16x32_bf16 v[112:115], a[28:31], a[64:67], v[112:115]
ds_read_b64_tr_b16 a[46:47], v15 offset:2560
v_mfma_f32_16x16x32_bf16 v[44:47], a[16:19], a[68:71], v[44:47]
ds_read_b64_tr_b16 a[48:49], v14 offset:4096
v_mfma_f32_16x16x32_bf16 v[68:71], a[20:23], a[68:71], v[68:71]
ds_read_b64_tr_b16 a[50:51], v14 offset:4608
v_mfma_f32_16x16x32_bf16 v[92:95], a[24:27], a[68:71], v[92:95]
ds_read_b64_tr_b16 a[52:53], v15 offset:4096
v_mfma_f32_16x16x32_bf16 v[116:119], a[28:31], a[68:71], v[116:119]
ds_read_b64_tr_b16 a[54:55], v15 offset:4608
v_mfma_f32_16x16x32_bf16 v[48:51], a[16:19], a[72:75], v[48:51]
v_mfma_f32_16x16x32_bf16 v[72:75], a[20:23], a[72:75], v[72:75]
v_mfma_f32_16x16x32_bf16 v[96:99], a[24:27], a[72:75], v[96:99]
v_mfma_f32_16x16x32_bf16 v[120:123], a[28:31], a[72:75], v[120:123]
v_mfma_f32_16x16x32_bf16 v[52:55], a[16:19], a[76:79], v[52:55]
v_mfma_f32_16x16x32_bf16 v[76:79], a[20:23], a[76:79], v[76:79]
v_mfma_f32_16x16x32_bf16 v[100:103], a[24:27], a[76:79], v[100:103]
v_mfma_f32_16x16x32_bf16 v[124:127], a[28:31], a[76:79], v[124:127]
s_waitcnt lgkmcnt(0)
v_mfma_f32_16x16x32_bf16 v[32:35], a[32:35], a[0:3], v[32:35]
ds_read_b128 a[16:19], v11 offset:0
v_mfma_f32_16x16x32_bf16 v[56:59], a[32:35], a[4:7], v[56:59]
ds_read_b64_tr_b16 a[56:57], v14 offset:12288
v_mfma_f32_16x16x32_bf16 v[80:83], a[32:35], a[8:11], v[80:83]
ds_read_b64_tr_b16 a[58:59], v14 offset:12800
v_mfma_f32_16x16x32_bf16 v[104:107], a[32:35], a[12:15], v[104:107]
ds_read_b128 a[20:23], v11 offset:2048
v_mfma_f32_16x16x32_bf16 v[36:39], a[36:39], a[0:3], v[36:39]
ds_read_b128 a[24:27], v11 offset:4096
v_mfma_f32_16x16x32_bf16 v[60:63], a[36:39], a[4:7], v[60:63]
ds_read_b128 a[28:31], v11 offset:6144
v_mfma_f32_16x16x32_bf16 v[84:87], a[36:39], a[8:11], v[84:87]
ds_read_b64_tr_b16 a[60:61], v15 offset:12288
v_mfma_f32_16x16x32_bf16 v[108:111], a[36:39], a[12:15], v[108:111]
ds_read_b64_tr_b16 a[62:63], v15 offset:12800
v_mfma_f32_16x16x32_bf16 v[40:43], a[0:3], a[40:43], v[40:43]
ds_read_b64_tr_b16 a[64:65], v14 offset:14336
v_mfma_f32_16x16x32_bf16 v[64:67], a[4:7], a[40:43], v[64:67]
ds_read_b64_tr_b16 a[66:67], v14 offset:14848
v_mfma_f32_16x16x32_bf16 v[88:91], a[8:11], a[40:43], v[88:91]
ds_read_b64_tr_b16 a[68:69], v15 offset:14336
v_mfma_f32_16x16x32_bf16 v[112:115], a[12:15], a[40:43], v[112:115]
ds_read_b64_tr_b16 a[70:71], v15 offset:14848
v_mfma_f32_16x16x32_bf16 v[44:47], a[0:3], a[44:47], v[44:47]
ds_read_b64_tr_b16 a[72:73], v14 offset:16384
v_mfma_f32_16x16x32_bf16 v[68:71], a[4:7], a[44:47], v[68:71]
ds_read_b64_tr_b16 a[74:75], v14 offset:16896
v_mfma_f32_16x16x32_bf16 v[92:95], a[8:11], a[44:47], v[92:95]
ds_read_b64_tr_b16 a[76:77], v15 offset:16384
v_mfma_f32_16x16x32_bf16 v[116:119], a[12:15], a[44:47], v[116:119]
ds_read_b64_tr_b16 a[78:79], v15 offset:16896
v_mfma_f32_16x16x32_bf16 v[48:51], a[0:3], a[48:51], v[48:51]
v_mfma_f32_16x16x32_bf16 v[72:75], a[4:7], a[48:51], v[72:75]
v_mfma_f32_16x16x32_bf16 v[96:99], a[8:11], a[48:51], v[96:99]
v_mfma_f32_16x16x32_bf16 v[120:123], a[12:15], a[48:51], v[120:123]
v_mfma_f32_16x16x32_bf16 v[52:55], a[0:3], a[52:55], v[52:55]
v_mfma_f32_16x16x32_bf16 v[76:79], a[4:7], a[52:55], v[76:79]
v_mfma_f32_16x16x32_bf16 v[100:103], a[8:11], a[52:55], v[100:103]
v_mfma_f32_16x16x32_bf16 v[124:127], a[12:15], a[52:55], v[124:127]
s_waitcnt lgkmcnt(0)
v_mfma_f32_16x16x32_bf16 v[32:35], a[56:59], a[16:19], v[32:35]
s_barrier
ds_read_b128 a[0:3], v8 offset:0
v_mfma_f32_16x16x32_bf16 v[56:59], a[56:59], a[20:23], v[56:59]
ds_read_b64_tr_b16 a[32:33], v12 offset:0
v_mfma_f32_16x16x32_bf16 v[80:83], a[56:59], a[24:27], v[80:83]
ds_read_b64_tr_b16 a[34:35], v12 offset:512
v_mfma_f32_16x16x32_bf16 v[104:107], a[56:59], a[28:31], v[104:107]
ds_read_b128 a[4:7], v8 offset:2048
v_mfma_f32_16x16x32_bf16 v[36:39], a[60:63], a[16:19], v[36:39]
ds_read_b128 a[8:11], v8 offset:4096
v_mfma_f32_16x16x32_bf16 v[60:63], a[60:63], a[20:23], v[60:63]
ds_read_b128 a[12:15], v8 offset:6144
v_mfma_f32_16x16x32_bf16 v[84:87], a[60:63], a[24:27], v[84:87]
ds_read_b64_tr_b16 a[36:37], v13 offset:0
v_mfma_f32_16x16x32_bf16 v[108:111], a[60:63], a[28:31], v[108:111]
ds_read_b64_tr_b16 a[38:39], v13 offset:512
v_mfma_f32_16x16x32_bf16 v[40:43], a[16:19], a[64:67], v[40:43]
ds_read_b64_tr_b16 a[40:41], v12 offset:2048
v_mfma_f32_16x16x32_bf16 v[64:67], a[20:23], a[64:67], v[64:67]
ds_read_b64_tr_b16 a[42:43], v12 offset:2560
v_mfma_f32_16x16x32_bf16 v[88:91], a[24:27], a[64:67], v[88:91]
ds_read_b64_tr_b16 a[44:45], v13 offset:2048
v_mfma_f32_16x16x32_bf16 v[112:115], a[28:31], a[64:67], v[112:115]
ds_read_b64_tr_b16 a[46:47], v13 offset:2560
v_mfma_f32_16x16x32_bf16 v[44:47], a[16:19], a[68:71], v[44:47]
ds_read_b64_tr_b16 a[48:49], v12 offset:4096
v_mfma_f32_16x16x32_bf16 v[68:71], a[20:23], a[68:71], v[68:71]
ds_read_b64_tr_b16 a[50:51], v12 offset:4608
v_mfma_f32_16x16x32_bf16 v[92:95], a[24:27], a[68:71], v[92:95]
ds_read_b64_tr_b16 a[52:53], v13 offset:4096
v_mfma_f32_16x16x32_bf16 v[116:119], a[28:31], a[68:71], v[116:119]
ds_read_b64_tr_b16 a[54:55], v13 offset:4608
v_mfma_f32_16x16x32_bf16 v[48:51], a[16:19], a[72:75], v[48:51]
v_mfma_f32_16x16x32_bf16 v[72:75], a[20:23], a[72:75], v[72:75]
v_mfma_f32_16x16x32_bf16 v[96:99], a[24:27], a[72:75], v[96:99]
v_mfma_f32_16x16x32_bf16 v[120:123], a[28:31], a[72:75], v[120:123]
v_mfma_f32_16x16x32_bf16 v[52:55], a[16:19], a[76:79], v[52:55]
v_mfma_f32_16x16x32_bf16 v[76:79], a[20:23], a[76:79], v[76:79]
v_mfma_f32_16x16x32_bf16 v[100:103], a[24:27], a[76:79], v[100:103]
v_mfma_f32_16x16x32_bf16 v[124:127], a[28:31], a[76:79], v[124:127]
s_waitcnt lgkmcnt(0)
v_mfma_f32_16x16x32_bf16 v[32:35], a[32:35], a[0:3], v[32:35]
ds_read_b128 a[16:19], v9 offset:0
v_mfma_f32_16x16x32_bf16 v[56:59], a[32:35], a[4:7], v[56:59]
ds_read_b64_tr_b16 a[56:57], v12 offset:12288
v_mfma_f32_16x16x32_bf16 v[80:83], a[32:35], a[8:11], v[80:83]
ds_read_b64_tr_b16 a[58:59], v12 offset:12800
v_mfma_f32_16x16x32_bf16 v[104:107], a[32:35], a[12:15], v[104:107]
ds_read_b128 a[20:23], v9 offset:2048
v_mfma_f32_16x16x32_bf16 v[36:39], a[36:39], a[0:3], v[36:39]
ds_read_b128 a[24:27], v9 offset:4096
v_mfma_f32_16x16x32_bf16 v[60:63], a[36:39], a[4:7], v[60:63]
ds_read_b128 a[28:31], v9 offset:6144
v_mfma_f32_16x16x32_bf16 v[84:87], a[36:39], a[8:11], v[84:87]
ds_read_b64_tr_b16 a[60:61], v13 offset:12288
v_mfma_f32_16x16x32_bf16 v[108:111], a[36:39], a[12:15], v[108:111]
ds_read_b64_tr_b16 a[62:63], v13 offset:12800
v_mfma_f32_16x16x32_bf16 v[40:43], a[0:3], a[40:43], v[40:43]
ds_read_b64_tr_b16 a[64:65], v12 offset:14336
v_mfma_f32_16x16x32_bf16 v[64:67], a[4:7], a[40:43], v[64:67]
ds_read_b64_tr_b16 a[66:67], v12 offset:14848
v_mfma_f32_16x16x32_bf16 v[88:91], a[8:11], a[40:43], v[88:91]
ds_read_b64_tr_b16 a[68:69], v13 offset:14336
v_mfma_f32_16x16x32_bf16 v[112:115], a[12:15], a[40:43], v[112:115]
ds_read_b64_tr_b16 a[70:71], v13 offset:14848
v_mfma_f32_16x16x32_bf16 v[44:47], a[0:3], a[44:47], v[44:47]
ds_read_b64_tr_b16 a[72:73], v12 offset:16384
v_mfma_f32_16x16x32_bf16 v[68:71], a[4:7], a[44:47], v[68:71]
ds_read_b64_tr_b16 a[74:75], v12 offset:16896
v_mfma_f32_16x16x32_bf16 v[92:95], a[8:11], a[44:47], v[92:95]
ds_read_b64_tr_b16 a[76:77], v13 offset:16384
v_mfma_f32_16x16x32_bf16 v[116:119], a[12:15], a[44:47], v[116:119]
ds_read_b64_tr_b16 a[78:79], v13 offset:16896
v_mfma_f32_16x16x32_bf16 v[48:51], a[0:3], a[48:51], v[48:51]
v_mfma_f32_16x16x32_bf16 v[72:75], a[4:7], a[48:51], v[72:75]
v_mfma_f32_16x16x32_bf16 v[96:99], a[8:11], a[48:51], v[96:99]
v_mfma_f32_16x16x32_bf16 v[120:123], a[12:15], a[48:51], v[120:123]
v_mfma_f32_16x16x32_bf16 v[52:55], a[0:3], a[52:55], v[52:55]
v_mfma_f32_16x16x32_bf16 v[76:79], a[4:7], a[52:55], v[76:79]
v_mfma_f32_16x16x32_bf16 v[100:103], a[8:11], a[52:55], v[100:103]
v_mfma_f32_16x16x32_bf16 v[124:127], a[12:15], a[52:55], v[124:127]
s_waitcnt lgkmcnt(0)
v_mfma_f32_16x16x32_bf16 v[32:35], a[56:59], a[16:19], v[32:35]
s_barrier
ds_read_b128 a[0:3], v8 offset:40960
v_mfma_f32_16x16x32_bf16 v[56:59], a[56:59], a[20:23], v[56:59]
ds_read_b64_tr_b16 a[32:33], v12 offset:40960
v_mfma_f32_16x16x32_bf16 v[80:83], a[56:59], a[24:27], v[80:83]
ds_read_b64_tr_b16 a[34:35], v12 offset:41472
v_mfma_f32_16x16x32_bf16 v[104:107], a[56:59], a[28:31], v[104:107]
ds_read_b128 a[4:7], v8 offset:43008
v_mfma_f32_16x16x32_bf16 v[36:39], a[60:63], a[16:19], v[36:39]
ds_read_b128 a[8:11], v8 offset:45056
v_mfma_f32_16x16x32_bf16 v[60:63], a[60:63], a[20:23], v[60:63]
ds_read_b128 a[12:15], v8 offset:47104
v_mfma_f32_16x16x32_bf16 v[84:87], a[60:63], a[24:27], v[84:87]
ds_read_b64_tr_b16 a[36:37], v13 offset:40960
v_mfma_f32_16x16x32_bf16 v[108:111], a[60:63], a[28:31], v[108:111]
ds_read_b64_tr_b16 a[38:39], v13 offset:41472
v_mfma_f32_16x16x32_bf16 v[40:43], a[16:19], a[64:67], v[40:43]
ds_read_b64_tr_b16 a[40:41], v12 offset:43008
v_mfma_f32_16x16x32_bf16 v[64:67], a[20:23], a[64:67], v[64:67]
ds_read_b64_tr_b16 a[42:43], v12 offset:43520
v_mfma_f32_16x16x32_bf16 v[88:91], a[24:27], a[64:67], v[88:91]
ds_read_b64_tr_b16 a[44:45], v13 offset:43008
v_mfma_f32_16x16x32_bf16 v[112:115], a[28:31], a[64:67], v[112:115]
ds_read_b64_tr_b16 a[46:47], v13 offset:43520
v_mfma_f32_16x16x32_bf16 v[44:47], a[16:19], a[68:71], v[44:47]
ds_read_b64_tr_b16 a[48:49], v12 offset:45056
v_mfma_f32_16x16x32_bf16 v[68:71], a[20:23], a[68:71], v[68:71]
ds_read_b64_tr_b16 a[50:51], v12 offset:45568
v_mfma_f32_16x16x32_bf16 v[92:95], a[24:27], a[68:71], v[92:95]
ds_read_b64_tr_b16 a[52:53], v13 offset:45056
v_mfma_f32_16x16x32_bf16 v[116:119], a[28:31], a[68:71], v[116:119]
ds_read_b64_tr_b16 a[54:55], v13 offset:45568
v_mfma_f32_16x16x32_bf16 v[48:51], a[16:19], a[72:75], v[48:51]
v_mfma_f32_16x16x32_bf16 v[72:75], a[20:23], a[72:75], v[72:75]
v_mfma_f32_16x16x32_bf16 v[96:99], a[24:27], a[72:75], v[96:99]
v_mfma_f32_16x16x32_bf16 v[120:123], a[28:31], a[72:75], v[120:123]
v_mfma_f32_16x16x32_bf16 v[52:55], a[16:19], a[76:79], v[52:55]
v_mfma_f32_16x16x32_bf16 v[76:79], a[20:23], a[76:79], v[76:79]
v_mfma_f32_16x16x32_bf16 v[100:103], a[24:27], a[76:79], v[100:103]
v_mfma_f32_16x16x32_bf16 v[124:127], a[28:31], a[76:79], v[124:127]
s_waitcnt lgkmcnt(0)
v_mfma_f32_16x16x32_bf16 v[32:35], a[32:35], a[0:3], v[32:35]
ds_read_b128 a[16:19], v9 offset:40960
v_mfma_f32_16x16x32_bf16 v[56:59], a[32:35], a[4:7], v[56:59]
ds_read_b64_tr_b16 a[56:57], v12 offset:53248
v_mfma_f32_16x16x32_bf16 v[80:83], a[32:35], a[8:11], v[80:83]
ds_read_b64_tr_b16 a[58:59], v12 offset:53760
v_mfma_f32_16x16x32_bf16 v[104:107], a[32:35], a[12:15], v[104:107]
ds_read_b128 a[20:23], v9 offset:43008
v_mfma_f32_16x16x32_bf16 v[36:39], a[36:39], a[0:3], v[36:39]
ds_read_b128 a[24:27], v9 offset:45056
v_mfma_f32_16x16x32_bf16 v[60:63], a[36:39], a[4:7], v[60:63]
ds_read_b128 a[28:31], v9 offset:47104
v_mfma_f32_16x16x32_bf16 v[84:87], a[36:39], a[8:11], v[84:87]
ds_read_b64_tr_b16 a[60:61], v13 offset:53248
v_mfma_f32_16x16x32_bf16 v[108:111], a[36:39], a[12:15], v[108:111]
ds_read_b64_tr_b16 a[62:63], v13 offset:53760
v_mfma_f32_16x16x32_bf16 v[40:43], a[0:3], a[40:43], v[40:43]
ds_read_b64_tr_b16 a[64:65], v12 offset:55296
v_mfma_f32_16x16x32_bf16 v[64:67], a[4:7], a[40:43], v[64:67]
ds_read_b64_tr_b16 a[66:67], v12 offset:55808
v_mfma_f32_16x16x32_bf16 v[88:91], a[8:11], a[40:43], v[88:91]
ds_read_b64_tr_b16 a[68:69], v13 offset:55296
v_mfma_f32_16x16x32_bf16 v[112:115], a[12:15], a[40:43], v[112:115]
ds_read_b64_tr_b16 a[70:71], v13 offset:55808
v_mfma_f32_16x16x32_bf16 v[44:47], a[0:3], a[44:47], v[44:47]
ds_read_b64_tr_b16 a[72:73], v12 offset:57344
v_mfma_f32_16x16x32_bf16 v[68:71], a[4:7], a[44:47], v[68:71]
ds_read_b64_tr_b16 a[74:75], v12 offset:57856
v_mfma_f32_16x16x32_bf16 v[92:95], a[8:11], a[44:47], v[92:95]
ds_read_b64_tr_b16 a[76:77], v13 offset:57344
v_mfma_f32_16x16x32_bf16 v[116:119], a[12:15], a[44:47], v[116:119]
ds_read_b64_tr_b16 a[78:79], v13 offset:57856
v_mfma_f32_16x16x32_bf16 v[48:51], a[0:3], a[48:51], v[48:51]
v_mfma_f32_16x16x32_bf16 v[72:75], a[4:7], a[48:51], v[72:75]
v_mfma_f32_16x16x32_bf16 v[96:99], a[8:11], a[48:51], v[96:99]
v_mfma_f32_16x16x32_bf16 v[120:123], a[12:15], a[48:51], v[120:123]
v_mfma_f32_16x16x32_bf16 v[52:55], a[0:3], a[52:55], v[52:55]
v_mfma_f32_16x16x32_bf16 v[76:79], a[4:7], a[52:55], v[76:79]
v_mfma_f32_16x16x32_bf16 v[100:103], a[8:11], a[52:55], v[100:103]
v_mfma_f32_16x16x32_bf16 v[124:127], a[12:15], a[52:55], v[124:127]
s_waitcnt lgkmcnt(0)
v_mfma_f32_16x16x32_bf16 v[32:35], a[56:59], a[16:19], v[32:35]
s_barrier
ds_read_b128 a[0:3], v10 offset:0
v_mfma_f32_16x16x32_bf16 v[56:59], a[56:59], a[20:23], v[56:59]
ds_read_b64_tr_b16 a[32:33], v14 offset:0
v_mfma_f32_16x16x32_bf16 v[80:83], a[56:59], a[24:27], v[80:83]
ds_read_b64_tr_b16 a[34:35], v14 offset:512
v_mfma_f32_16x16x32_bf16 v[104:107], a[56:59], a[28:31], v[104:107]
ds_read_b128 a[4:7], v10 offset:2048
v_mfma_f32_16x16x32_bf16 v[36:39], a[60:63], a[16:19], v[36:39]
ds_read_b128 a[8:11], v10 offset:4096
v_mfma_f32_16x16x32_bf16 v[60:63], a[60:63], a[20:23], v[60:63]
ds_read_b128 a[12:15], v10 offset:6144
v_mfma_f32_16x16x32_bf16 v[84:87], a[60:63], a[24:27], v[84:87]
ds_read_b64_tr_b16 a[36:37], v15 offset:0
v_mfma_f32_16x16x32_bf16 v[108:111], a[60:63], a[28:31], v[108:111]
ds_read_b64_tr_b16 a[38:39], v15 offset:512
v_mfma_f32_16x16x32_bf16 v[40:43], a[16:19], a[64:67], v[40:43]
ds_read_b64_tr_b16 a[40:41], v14 offset:2048
v_mfma_f32_16x16x32_bf16 v[64:67], a[20:23], a[64:67], v[64:67]
ds_read_b64_tr_b16 a[42:43], v14 offset:2560
v_mfma_f32_16x16x32_bf16 v[88:91], a[24:27], a[64:67], v[88:91]
ds_read_b64_tr_b16 a[44:45], v15 offset:2048
v_mfma_f32_16x16x32_bf16 v[112:115], a[28:31], a[64:67], v[112:115]
ds_read_b64_tr_b16 a[46:47], v15 offset:2560
v_mfma_f32_16x16x32_bf16 v[44:47], a[16:19], a[68:71], v[44:47]
ds_read_b64_tr_b16 a[48:49], v14 offset:4096
v_mfma_f32_16x16x32_bf16 v[68:71], a[20:23], a[68:71], v[68:71]
ds_read_b64_tr_b16 a[50:51], v14 offset:4608
v_mfma_f32_16x16x32_bf16 v[92:95], a[24:27], a[68:71], v[92:95]
ds_read_b64_tr_b16 a[52:53], v15 offset:4096
v_mfma_f32_16x16x32_bf16 v[116:119], a[28:31], a[68:71], v[116:119]
ds_read_b64_tr_b16 a[54:55], v15 offset:4608
v_mfma_f32_16x16x32_bf16 v[48:51], a[16:19], a[72:75], v[48:51]
v_mfma_f32_16x16x32_bf16 v[72:75], a[20:23], a[72:75], v[72:75]
v_mfma_f32_16x16x32_bf16 v[96:99], a[24:27], a[72:75], v[96:99]
v_mfma_f32_16x16x32_bf16 v[120:123], a[28:31], a[72:75], v[120:123]
v_mfma_f32_16x16x32_bf16 v[52:55], a[16:19], a[76:79], v[52:55]
v_mfma_f32_16x16x32_bf16 v[76:79], a[20:23], a[76:79], v[76:79]
v_mfma_f32_16x16x32_bf16 v[100:103], a[24:27], a[76:79], v[100:103]
v_mfma_f32_16x16x32_bf16 v[124:127], a[28:31], a[76:79], v[124:127]
s_waitcnt lgkmcnt(0)
v_mfma_f32_16x16x32_bf16 v[32:35], a[32:35], a[0:3], v[32:35]
ds_read_b128 a[16:19], v11 offset:0
v_mfma_f32_16x16x32_bf16 v[56:59], a[32:35], a[4:7], v[56:59]
ds_read_b64_tr_b16 a[56:57], v14 offset:12288
v_mfma_f32_16x16x32_bf16 v[80:83], a[32:35], a[8:11], v[80:83]
ds_read_b64_tr_b16 a[58:59], v14 offset:12800
v_mfma_f32_16x16x32_bf16 v[104:107], a[32:35], a[12:15], v[104:107]
ds_read_b128 a[20:23], v11 offset:2048
v_mfma_f32_16x16x32_bf16 v[36:39], a[36:39], a[0:3], v[36:39]
ds_read_b128 a[24:27], v11 offset:4096
v_mfma_f32_16x16x32_bf16 v[60:63], a[36:39], a[4:7], v[60:63]
ds_read_b128 a[28:31], v11 offset:6144
v_mfma_f32_16x16x32_bf16 v[84:87], a[36:39], a[8:11], v[84:87]
ds_read_b64_tr_b16 a[60:61], v15 offset:12288
v_mfma_f32_16x16x32_bf16 v[108:111], a[36:39], a[12:15], v[108:111]
ds_read_b64_tr_b16 a[62:63], v15 offset:12800
v_mfma_f32_16x16x32_bf16 v[40:43], a[0:3], a[40:43], v[40:43]
ds_read_b64_tr_b16 a[64:65], v14 offset:14336
v_mfma_f32_16x16x32_bf16 v[64:67], a[4:7], a[40:43], v[64:67]
ds_read_b64_tr_b16 a[66:67], v14 offset:14848
v_mfma_f32_16x16x32_bf16 v[88:91], a[8:11], a[40:43], v[88:91]
ds_read_b64_tr_b16 a[68:69], v15 offset:14336
v_mfma_f32_16x16x32_bf16 v[112:115], a[12:15], a[40:43], v[112:115]
ds_read_b64_tr_b16 a[70:71], v15 offset:14848
v_mfma_f32_16x16x32_bf16 v[44:47], a[0:3], a[44:47], v[44:47]
ds_read_b64_tr_b16 a[72:73], v14 offset:16384
v_mfma_f32_16x16x32_bf16 v[68:71], a[4:7], a[44:47], v[68:71]
ds_read_b64_tr_b16 a[74:75], v14 offset:16896
v_mfma_f32_16x16x32_bf16 v[92:95], a[8:11], a[44:47], v[92:95]
ds_read_b64_tr_b16 a[76:77], v15 offset:16384
v_mfma_f32_16x16x32_bf16 v[116:119], a[12:15], a[44:47], v[116:119]
ds_read_b64_tr_b16 a[78:79], v15 offset:16896
v_mfma_f32_16x16x32_bf16 v[48:51], a[0:3], a[48:51], v[48:51]
v_mfma_f32_16x16x32_bf16 v[72:75], a[4:7], a[48:51], v[72:75]
v_mfma_f32_16x16x32_bf16 v[96:99], a[8:11], a[48:51], v[96:99]
v_mfma_f32_16x16x32_bf16 v[120:123], a[12:15], a[48:51], v[120:123]
v_mfma_f32_16x16x32_bf16 v[52:55], a[0:3], a[52:55], v[52:55]
v_mfma_f32_16x16x32_bf16 v[76:79], a[4:7], a[52:55], v[76:79]
v_mfma_f32_16x16x32_bf16 v[100:103], a[8:11], a[52:55], v[100:103]
v_mfma_f32_16x16x32_bf16 v[124:127], a[12:15], a[52:55], v[124:127]
s_waitcnt lgkmcnt(0)
v_mfma_f32_16x16x32_bf16 v[32:35], a[56:59], a[16:19], v[32:35]
s_barrier
ds_read_b128 a[0:3], v8 offset:0
v_mfma_f32_16x16x32_bf16 v[56:59], a[56:59], a[20:23], v[56:59]
ds_read_b64_tr_b16 a[32:33], v12 offset:0
v_mfma_f32_16x16x32_bf16 v[80:83], a[56:59], a[24:27], v[80:83]
ds_read_b64_tr_b16 a[34:35], v12 offset:512
v_mfma_f32_16x16x32_bf16 v[104:107], a[56:59], a[28:31], v[104:107]
ds_read_b128 a[4:7], v8 offset:2048
v_mfma_f32_16x16x32_bf16 v[36:39], a[60:63], a[16:19], v[36:39]
ds_read_b128 a[8:11], v8 offset:4096
v_mfma_f32_16x16x32_bf16 v[60:63], a[60:63], a[20:23], v[60:63]
ds_read_b128 a[12:15], v8 offset:6144
v_mfma_f32_16x16x32_bf16 v[84:87], a[60:63], a[24:27], v[84:87]
ds_read_b64_tr_b16 a[36:37], v13 offset:0
v_mfma_f32_16x16x32_bf16 v[108:111], a[60:63], a[28:31], v[108:111]
ds_read_b64_tr_b16 a[38:39], v13 offset:512
v_mfma_f32_16x16x32_bf16 v[40:43], a[16:19], a[64:67], v[40:43]
ds_read_b64_tr_b16 a[40:41], v12 offset:2048
v_mfma_f32_16x16x32_bf16 v[64:67], a[20:23], a[64:67], v[64:67]
ds_read_b64_tr_b16 a[42:43], v12 offset:2560
v_mfma_f32_16x16x32_bf16 v[88:91], a[24:27], a[64:67], v[88:91]
ds_read_b64_tr_b16 a[44:45], v13 offset:2048
v_mfma_f32_16x16x32_bf16 v[112:115], a[28:31], a[64:67], v[112:115]
ds_read_b64_tr_b16 a[46:47], v13 offset:2560
v_mfma_f32_16x16x32_bf16 v[44:47], a[16:19], a[68:71], v[44:47]
ds_read_b64_tr_b16 a[48:49], v12 offset:4096
v_mfma_f32_16x16x32_bf16 v[68:71], a[20:23], a[68:71], v[68:71]
ds_read_b64_tr_b16 a[50:51], v12 offset:4608
v_mfma_f32_16x16x32_bf16 v[92:95], a[24:27], a[68:71], v[92:95]
ds_read_b64_tr_b16 a[52:53], v13 offset:4096
v_mfma_f32_16x16x32_bf16 v[116:119], a[28:31], a[68:71], v[116:119]
ds_read_b64_tr_b16 a[54:55], v13 offset:4608
v_mfma_f32_16x16x32_bf16 v[48:51], a[16:19], a[72:75], v[48:51]
v_mfma_f32_16x16x32_bf16 v[72:75], a[20:23], a[72:75], v[72:75]
v_mfma_f32_16x16x32_bf16 v[96:99], a[24:27], a[72:75], v[96:99]
v_mfma_f32_16x16x32_bf16 v[120:123], a[28:31], a[72:75], v[120:123]
v_mfma_f32_16x16x32_bf16 v[52:55], a[16:19], a[76:79], v[52:55]
v_mfma_f32_16x16x32_bf16 v[76:79], a[20:23], a[76:79], v[76:79]
v_mfma_f32_16x16x32_bf16 v[100:103], a[24:27], a[76:79], v[100:103]
v_mfma_f32_16x16x32_bf16 v[124:127], a[28:31], a[76:79], v[124:127]
s_waitcnt lgkmcnt(0)
v_mfma_f32_16x16x32_bf16 v[32:35], a[32:35], a[0:3], v[32:35]
ds_read_b128 a[16:19], v9 offset:0
v_mfma_f32_16x16x32_bf16 v[56:59], a[32:35], a[4:7], v[56:59]
ds_read_b64_tr_b16 a[56:57], v12 offset:12288
v_mfma_f32_16x16x32_bf16 v[80:83], a[32:35], a[8:11], v[80:83]
ds_read_b64_tr_b16 a[58:59], v12 offset:12800
v_mfma_f32_16x16x32_bf16 v[104:107], a[32:35], a[12:15], v[104:107]
ds_read_b128 a[20:23], v9 offset:2048
v_mfma_f32_16x16x32_bf16 v[36:39], a[36:39], a[0:3], v[36:39]
ds_read_b128 a[24:27], v9 offset:4096
v_mfma_f32_16x16x32_bf16 v[60:63], a[36:39], a[4:7], v[60:63]
ds_read_b128 a[28:31], v9 offset:6144
v_mfma_f32_16x16x32_bf16 v[84:87], a[36:39], a[8:11], v[84:87]
ds_read_b64_tr_b16 a[60:61], v13 offset:12288
v_mfma_f32_16x16x32_bf16 v[108:111], a[36:39], a[12:15], v[108:111]
ds_read_b64_tr_b16 a[62:63], v13 offset:12800
v_mfma_f32_16x16x32_bf16 v[40:43], a[0:3], a[40:43], v[40:43]
ds_read_b64_tr_b16 a[64:65], v12 offset:14336
v_mfma_f32_16x16x32_bf16 v[64:67], a[4:7], a[40:43], v[64:67]
ds_read_b64_tr_b16 a[66:67], v12 offset:14848
v_mfma_f32_16x16x32_bf16 v[88:91], a[8:11], a[40:43], v[88:91]
ds_read_b64_tr_b16 a[68:69], v13 offset:14336
v_mfma_f32_16x16x32_bf16 v[112:115], a[12:15], a[40:43], v[112:115]
ds_read_b64_tr_b16 a[70:71], v13 offset:14848
v_mfma_f32_16x16x32_bf16 v[44:47], a[0:3], a[44:47], v[44:47]
ds_read_b64_tr_b16 a[72:73], v12 offset:16384
v_mfma_f32_16x16x32_bf16 v[68:71], a[4:7], a[44:47], v[68:71]
ds_read_b64_tr_b16 a[74:75], v12 offset:16896
v_mfma_f32_16x16x32_bf16 v[92:95], a[8:11], a[44:47], v[92:95]
ds_read_b64_tr_b16 a[76:77], v13 offset:16384
v_mfma_f32_16x16x32_bf16 v[116:119], a[12:15], a[44:47], v[116:119]
ds_read_b64_tr_b16 a[78:79], v13 offset:16896
v_mfma_f32_16x16x32_bf16 v[48:51], a[0:3], a[48:51], v[48:51]
v_mfma_f32_16x16x32_bf16 v[72:75], a[4:7], a[48:51], v[72:75]
v_mfma_f32_16x16x32_bf16 v[96:99], a[8:11], a[48:51], v[96:99]
v_mfma_f32_16x16x32_bf16 v[120:123], a[12:15], a[48:51], v[120:123]
v_mfma_f32_16x16x32_bf16 v[52:55], a[0:3], a[52:55], v[52:55]
v_mfma_f32_16x16x32_bf16 v[76:79], a[4:7], a[52:55], v[76:79]
v_mfma_f32_16x16x32_bf16 v[100:103], a[8:11], a[52:55], v[100:103]
v_mfma_f32_16x16x32_bf16 v[124:127], a[12:15], a[52:55], v[124:127]
s_waitcnt lgkmcnt(0)
v_mfma_f32_16x16x32_bf16 v[32:35], a[56:59], a[16:19], v[32:35]
s_barrier
ds_read_b128 a[0:3], v8 offset:40960
v_mfma_f32_16x16x32_bf16 v[56:59], a[56:59], a[20:23], v[56:59]
ds_read_b64_tr_b16 a[32:33], v12 offset:40960
v_mfma_f32_16x16x32_bf16 v[80:83], a[56:59], a[24:27], v[80:83]
ds_read_b64_tr_b16 a[34:35], v12 offset:41472
v_mfma_f32_16x16x32_bf16 v[104:107], a[56:59], a[28:31], v[104:107]
ds_read_b128 a[4:7], v8 offset:43008
v_mfma_f32_16x16x32_bf16 v[36:39], a[60:63], a[16:19], v[36:39]
ds_read_b128 a[8:11], v8 offset:45056
v_mfma_f32_16x16x32_bf16 v[60:63], a[60:63], a[20:23], v[60:63]
ds_read_b128 a[12:15], v8 offset:47104
v_mfma_f32_16x16x32_bf16 v[84:87], a[60:63], a[24:27], v[84:87]
ds_read_b64_tr_b16 a[36:37], v13 offset:40960
v_mfma_f32_16x16x32_bf16 v[108:111], a[60:63], a[28:31], v[108:111]
ds_read_b64_tr_b16 a[38:39], v13 offset:41472
v_mfma_f32_16x16x32_bf16 v[40:43], a[16:19], a[64:67], v[40:43]
ds_read_b64_tr_b16 a[40:41], v12 offset:43008
v_mfma_f32_16x16x32_bf16 v[64:67], a[20:23], a[64:67], v[64:67]
ds_read_b64_tr_b16 a[42:43], v12 offset:43520
v_mfma_f32_16x16x32_bf16 v[88:91], a[24:27], a[64:67], v[88:91]
ds_read_b64_tr_b16 a[44:45], v13 offset:43008
v_mfma_f32_16x16x32_bf16 v[112:115], a[28:31], a[64:67], v[112:115]
ds_read_b64_tr_b16 a[46:47], v13 offset:43520
v_mfma_f32_16x16x32_bf16 v[44:47], a[16:19], a[68:71], v[44:47]
ds_read_b64_tr_b16 a[48:49], v12 offset:45056
v_mfma_f32_16x16x32_bf16 v[68:71], a[20:23], a[68:71], v[68:71]
ds_read_b64_tr_b16 a[50:51], v12 offset:45568
v_mfma_f32_16x16x32_bf16 v[92:95], a[24:27], a[68:71], v[92:95]
ds_read_b64_tr_b16 a[52:53], v13 offset:45056
v_mfma_f32_16x16x32_bf16 v[116:119], a[28:31], a[68:71], v[116:119]
ds_read_b64_tr_b16 a[54:55], v13 offset:45568
v_mfma_f32_16x16x32_bf16 v[48:51], a[16:19], a[72:75], v[48:51]
v_mfma_f32_16x16x32_bf16 v[72:75], a[20:23], a[72:75], v[72:75]
v_mfma_f32_16x16x32_bf16 v[96:99], a[24:27], a[72:75], v[96:99]
v_mfma_f32_16x16x32_bf16 v[120:123], a[28:31], a[72:75], v[120:123]
v_mfma_f32_16x16x32_bf16 v[52:55], a[16:19], a[76:79], v[52:55]
v_mfma_f32_16x16x32_bf16 v[76:79], a[20:23], a[76:79], v[76:79]
v_mfma_f32_16x16x32_bf16 v[100:103], a[24:27], a[76:79], v[100:103]
v_mfma_f32_16x16x32_bf16 v[124:127], a[28:31], a[76:79], v[124:127]
s_waitcnt lgkmcnt(0)
v_mfma_f32_16x16x32_bf16 v[32:35], a[32:35], a[0:3], v[32:35]
ds_read_b128 a[16:19], v9 offset:40960
v_mfma_f32_16x16x32_bf16 v[56:59], a[32:35], a[4:7], v[56:59]
ds_read_b64_tr_b16 a[56:57], v12 offset:53248
v_mfma_f32_16x16x32_bf16 v[80:83], a[32:35], a[8:11], v[80:83]
ds_read_b64_tr_b16 a[58:59], v12 offset:53760
v_mfma_f32_16x16x32_bf16 v[104:107], a[32:35], a[12:15], v[104:107]
ds_read_b128 a[20:23], v9 offset:43008
v_mfma_f32_16x16x32_bf16 v[36:39], a[36:39], a[0:3], v[36:39]
ds_read_b128 a[24:27], v9 offset:45056
v_mfma_f32_16x16x32_bf16 v[60:63], a[36:39], a[4:7], v[60:63]
ds_read_b128 a[28:31], v9 offset:47104
v_mfma_f32_16x16x32_bf16 v[84:87], a[36:39], a[8:11], v[84:87]
ds_read_b64_tr_b16 a[60:61], v13 offset:53248
v_mfma_f32_16x16x32_bf16 v[108:111], a[36:39], a[12:15], v[108:111]
ds_read_b64_tr_b16 a[62:63], v13 offset:53760
v_mfma_f32_16x16x32_bf16 v[40:43], a[0:3], a[40:43], v[40:43]
ds_read_b64_tr_b16 a[64:65], v12 offset:55296
v_mfma_f32_16x16x32_bf16 v[64:67], a[4:7], a[40:43], v[64:67]
ds_read_b64_tr_b16 a[66:67], v12 offset:55808
v_mfma_f32_16x16x32_bf16 v[88:91], a[8:11], a[40:43], v[88:91]
ds_read_b64_tr_b16 a[68:69], v13 offset:55296
v_mfma_f32_16x16x32_bf16 v[112:115], a[12:15], a[40:43], v[112:115]
ds_read_b64_tr_b16 a[70:71], v13 offset:55808
v_mfma_f32_16x16x32_bf16 v[44:47], a[0:3], a[44:47], v[44:47]
ds_read_b64_tr_b16 a[72:73], v12 offset:57344
v_mfma_f32_16x16x32_bf16 v[68:71], a[4:7], a[44:47], v[68:71]
ds_read_b64_tr_b16 a[74:75], v12 offset:57856
v_mfma_f32_16x16x32_bf16 v[92:95], a[8:11], a[44:47], v[92:95]
ds_read_b64_tr_b16 a[76:77], v13 offset:57344
v_mfma_f32_16x16x32_bf16 v[116:119], a[12:15], a[44:47], v[116:119]
ds_read_b64_tr_b16 a[78:79], v13 offset:57856
v_mfma_f32_16x16x32_bf16 v[48:51], a[0:3], a[48:51], v[48:51]
v_mfma_f32_16x16x32_bf16 v[72:75], a[4:7], a[48:51], v[72:75]
v_mfma_f32_16x16x32_bf16 v[96:99], a[8:11], a[48:51], v[96:99]
v_mfma_f32_16x16x32_bf16 v[120:123], a[12:15], a[48:51], v[120:123]
v_mfma_f32_16x16x32_bf16 v[52:55], a[0:3], a[52:55], v[52:55]
v_mfma_f32_16x16x32_bf16 v[76:79], a[4:7], a[52:55], v[76:79]
v_mfma_f32_16x16x32_bf16 v[100:103], a[8:11], a[52:55], v[100:103]
v_mfma_f32_16x16x32_bf16 v[124:127], a[12:15], a[52:55], v[124:127]
s_waitcnt lgkmcnt(0)
v_mfma_f32_16x16x32_bf16 v[32:35], a[56:59], a[16:19], v[32:35]
s_barrier
ds_read_b128 a[0:3], v10 offset:0
v_mfma_f32_16x16x32_bf16 v[56:59], a[56:59], a[20:23], v[56:59]
ds_read_b64_tr_b16 a[32:33], v14 offset:0
v_mfma_f32_16x16x32_bf16 v[80:83], a[56:59], a[24:27], v[80:83]
ds_read_b64_tr_b16 a[34:35], v14 offset:512
v_mfma_f32_16x16x32_bf16 v[104:107], a[56:59], a[28:31], v[104:107]
ds_read_b128 a[4:7], v10 offset:2048
v_mfma_f32_16x16x32_bf16 v[36:39], a[60:63], a[16:19], v[36:39]
ds_read_b128 a[8:11], v10 offset:4096
v_mfma_f32_16x16x32_bf16 v[60:63], a[60:63], a[20:23], v[60:63]
ds_read_b128 a[12:15], v10 offset:6144
v_mfma_f32_16x16x32_bf16 v[84:87], a[60:63], a[24:27], v[84:87]
ds_read_b64_tr_b16 a[36:37], v15 offset:0
v_mfma_f32_16x16x32_bf16 v[108:111], a[60:63], a[28:31], v[108:111]
ds_read_b64_tr_b16 a[38:39], v15 offset:512
v_mfma_f32_16x16x32_bf16 v[40:43], a[16:19], a[64:67], v[40:43]
ds_read_b64_tr_b16 a[40:41], v14 offset:2048
v_mfma_f32_16x16x32_bf16 v[64:67], a[20:23], a[64:67], v[64:67]
ds_read_b64_tr_b16 a[42:43], v14 offset:2560
v_mfma_f32_16x16x32_bf16 v[88:91], a[24:27], a[64:67], v[88:91]
ds_read_b64_tr_b16 a[44:45], v15 offset:2048
v_mfma_f32_16x16x32_bf16 v[112:115], a[28:31], a[64:67], v[112:115]
ds_read_b64_tr_b16 a[46:47], v15 offset:2560
v_mfma_f32_16x16x32_bf16 v[44:47], a[16:19], a[68:71], v[44:47]
ds_read_b64_tr_b16 a[48:49], v14 offset:4096
v_mfma_f32_16x16x32_bf16 v[68:71], a[20:23], a[68:71], v[68:71]
ds_read_b64_tr_b16 a[50:51], v14 offset:4608
v_mfma_f32_16x16x32_bf16 v[92:95], a[24:27], a[68:71], v[92:95]
ds_read_b64_tr_b16 a[52:53], v15 offset:4096
v_mfma_f32_16x16x32_bf16 v[116:119], a[28:31], a[68:71], v[116:119]
ds_read_b64_tr_b16 a[54:55], v15 offset:4608
v_mfma_f32_16x16x32_bf16 v[48:51], a[16:19], a[72:75], v[48:51]
v_mfma_f32_16x16x32_bf16 v[72:75], a[20:23], a[72:75], v[72:75]
v_mfma_f32_16x16x32_bf16 v[96:99], a[24:27], a[72:75], v[96:99]
v_mfma_f32_16x16x32_bf16 v[120:123], a[28:31], a[72:75], v[120:123]
v_mfma_f32_16x16x32_bf16 v[52:55], a[16:19], a[76:79], v[52:55]
v_mfma_f32_16x16x32_bf16 v[76:79], a[20:23], a[76:79], v[76:79]
v_mfma_f32_16x16x32_bf16 v[100:103], a[24:27], a[76:79], v[100:103]
v_mfma_f32_16x16x32_bf16 v[124:127], a[28:31], a[76:79], v[124:127]
s_waitcnt lgkmcnt(0)
v_mfma_f32_16x16x32_bf16 v[32:35], a[32:35], a[0:3], v[32:35]
ds_read_b128 a[16:19], v11 offset:0
v_mfma_f32_16x16x32_bf16 v[56:59], a[32:35], a[4:7], v[56:59]
ds_read_b64_tr_b16 a[56:57], v14 offset:12288
v_mfma_f32_16x16x32_bf16 v[80:83], a[32:35], a[8:11], v[80:83]
ds_read_b64_tr_b16 a[58:59], v14 offset:12800
v_mfma_f32_16x16x32_bf16 v[104:107], a[32:35], a[12:15], v[104:107]
ds_read_b128 a[20:23], v11 offset:2048
v_mfma_f32_16x16x32_bf16 v[36:39], a[36:39], a[0:3], v[36:39]
ds_read_b128 a[24:27], v11 offset:4096
v_mfma_f32_16x16x32_bf16 v[60:63], a[36:39], a[4:7], v[60:63]
ds_read_b128 a[28:31], v11 offset:6144
v_mfma_f32_16x16x32_bf16 v[84:87], a[36:39], a[8:11], v[84:87]
ds_read_b64_tr_b16 a[60:61], v15 offset:12288
v_mfma_f32_16x16x32_bf16 v[108:111], a[36:39], a[12:15], v[108:111]
ds_read_b64_tr_b16 a[62:63], v15 offset:12800
v_mfma_f32_16x16x32_bf16 v[40:43], a[0:3], a[40:43], v[40:43]
ds_read_b64_tr_b16 a[64:65], v14 offset:14336
v_mfma_f32_16x16x32_bf16 v[64:67], a[4:7], a[40:43], v[64:67]
ds_read_b64_tr_b16 a[66:67], v14 offset:14848
v_mfma_f32_16x16x32_bf16 v[88:91], a[8:11], a[40:43], v[88:91]
ds_read_b64_tr_b16 a[68:69], v15 offset:14336
v_mfma_f32_16x16x32_bf16 v[112:115], a[12:15], a[40:43], v[112:115]
ds_read_b64_tr_b16 a[70:71], v15 offset:14848
v_mfma_f32_16x16x32_bf16 v[44:47], a[0:3], a[44:47], v[44:47]
ds_read_b64_tr_b16 a[72:73], v14 offset:16384
v_mfma_f32_16x16x32_bf16 v[68:71], a[4:7], a[44:47], v[68:71]
ds_read_b64_tr_b16 a[74:75], v14 offset:16896
v_mfma_f32_16x16x32_bf16 v[92:95], a[8:11], a[44:47], v[92:95]
ds_read_b64_tr_b16 a[76:77], v15 offset:16384
v_mfma_f32_16x16x32_bf16 v[116:119], a[12:15], a[44:47], v[116:119]
ds_read_b64_tr_b16 a[78:79], v15 offset:16896
v_mfma_f32_16x16x32_bf16 v[48:51], a[0:3], a[48:51], v[48:51]
v_lshrrev_b32 v2, 4, v1
v_lshlrev_b32 v2, 4, v2
s_lshl_b32 s70, s66, 8
s_add_u32 s70, s70, 159744
v_add_u32 v17, s70, v2
v_mfma_f32_16x16x32_bf16 v[72:75], a[4:7], a[48:51], v[72:75]
v_mfma_f32_16x16x32_bf16 v[96:99], a[8:11], a[48:51], v[96:99]
v_and_b32 v2, 15, v1
v_lshlrev_b32 v2, 2, v2
s_lshl_b32 s70, s67, 7
s_add_u32 s70, s70, 160768
v_add_u32 v18, s70, v2
v_mfma_f32_16x16x32_bf16 v[120:123], a[12:15], a[48:51], v[120:123]
v_mfma_f32_16x16x32_bf16 v[52:55], a[0:3], a[52:55], v[52:55]
v_mfma_f32_16x16x32_bf16 v[76:79], a[4:7], a[52:55], v[76:79]
v_mfma_f32_16x16x32_bf16 v[100:103], a[8:11], a[52:55], v[100:103]
v_mfma_f32_16x16x32_bf16 v[124:127], a[12:15], a[52:55], v[124:127]
s_waitcnt lgkmcnt(0)
v_mfma_f32_16x16x32_bf16 v[32:35], a[56:59], a[16:19], v[32:35]
s_barrier
ds_read_b128 a[0:3], v8 offset:0
v_mfma_f32_16x16x32_bf16 v[56:59], a[56:59], a[20:23], v[56:59]
ds_read_b64_tr_b16 a[32:33], v12 offset:0
v_mfma_f32_16x16x32_bf16 v[80:83], a[56:59], a[24:27], v[80:83]
ds_read_b64_tr_b16 a[34:35], v12 offset:512
v_mfma_f32_16x16x32_bf16 v[104:107], a[56:59], a[28:31], v[104:107]
ds_read_b128 a[4:7], v8 offset:2048
v_mfma_f32_16x16x32_bf16 v[36:39], a[60:63], a[16:19], v[36:39]
ds_read_b128 a[8:11], v8 offset:4096
v_mfma_f32_16x16x32_bf16 v[60:63], a[60:63], a[20:23], v[60:63]
ds_read_b128 a[12:15], v8 offset:6144
v_mfma_f32_16x16x32_bf16 v[84:87], a[60:63], a[24:27], v[84:87]
ds_read_b64_tr_b16 a[36:37], v13 offset:0
v_mfma_f32_16x16x32_bf16 v[108:111], a[60:63], a[28:31], v[108:111]
ds_read_b64_tr_b16 a[38:39], v13 offset:512
v_mfma_f32_16x16x32_bf16 v[40:43], a[16:19], a[64:67], v[40:43]
ds_read_b64_tr_b16 a[40:41], v12 offset:2048
v_mfma_f32_16x16x32_bf16 v[64:67], a[20:23], a[64:67], v[64:67]
ds_read_b64_tr_b16 a[42:43], v12 offset:2560
v_mfma_f32_16x16x32_bf16 v[88:91], a[24:27], a[64:67], v[88:91]
ds_read_b64_tr_b16 a[44:45], v13 offset:2048
v_mfma_f32_16x16x32_bf16 v[112:115], a[28:31], a[64:67], v[112:115]
ds_read_b64_tr_b16 a[46:47], v13 offset:2560
v_mfma_f32_16x16x32_bf16 v[44:47], a[16:19], a[68:71], v[44:47]
ds_read_b64_tr_b16 a[48:49], v12 offset:4096
v_mfma_f32_16x16x32_bf16 v[68:71], a[20:23], a[68:71], v[68:71]
ds_read_b64_tr_b16 a[50:51], v12 offset:4608
v_mfma_f32_16x16x32_bf16 v[92:95], a[24:27], a[68:71], v[92:95]
ds_read_b64_tr_b16 a[52:53], v13 offset:4096
v_mfma_f32_16x16x32_bf16 v[116:119], a[28:31], a[68:71], v[116:119]
ds_read_b64_tr_b16 a[54:55], v13 offset:4608
v_mfma_f32_16x16x32_bf16 v[48:51], a[16:19], a[72:75], v[48:51]
v_mfma_f32_16x16x32_bf16 v[72:75], a[20:23], a[72:75], v[72:75]
v_mfma_f32_16x16x32_bf16 v[96:99], a[24:27], a[72:75], v[96:99]
v_mfma_f32_16x16x32_bf16 v[120:123], a[28:31], a[72:75], v[120:123]
v_mfma_f32_16x16x32_bf16 v[52:55], a[16:19], a[76:79], v[52:55]
v_mfma_f32_16x16x32_bf16 v[76:79], a[20:23], a[76:79], v[76:79]
v_mfma_f32_16x16x32_bf16 v[100:103], a[24:27], a[76:79], v[100:103]
v_mfma_f32_16x16x32_bf16 v[124:127], a[28:31], a[76:79], v[124:127]
s_waitcnt lgkmcnt(0)
v_mfma_f32_16x16x32_bf16 v[32:35], a[32:35], a[0:3], v[32:35]
ds_read_b128 a[16:19], v9 offset:0
v_mfma_f32_16x16x32_bf16 v[56:59], a[32:35], a[4:7], v[56:59]
ds_read_b64_tr_b16 a[56:57], v12 offset:12288
v_mfma_f32_16x16x32_bf16 v[80:83], a[32:35], a[8:11], v[80:83]
ds_read_b64_tr_b16 a[58:59], v12 offset:12800
v_mfma_f32_16x16x32_bf16 v[104:107], a[32:35], a[12:15], v[104:107]
ds_read_b128 a[20:23], v9 offset:2048
v_mfma_f32_16x16x32_bf16 v[36:39], a[36:39], a[0:3], v[36:39]
ds_read_b128 a[24:27], v9 offset:4096
v_mfma_f32_16x16x32_bf16 v[60:63], a[36:39], a[4:7], v[60:63]
ds_read_b128 a[28:31], v9 offset:6144
v_mfma_f32_16x16x32_bf16 v[84:87], a[36:39], a[8:11], v[84:87]
ds_read_b64_tr_b16 a[60:61], v13 offset:12288
v_mfma_f32_16x16x32_bf16 v[108:111], a[36:39], a[12:15], v[108:111]
ds_read_b64_tr_b16 a[62:63], v13 offset:12800
v_mfma_f32_16x16x32_bf16 v[40:43], a[0:3], a[40:43], v[40:43]
ds_read_b64_tr_b16 a[64:65], v12 offset:14336
v_mfma_f32_16x16x32_bf16 v[64:67], a[4:7], a[40:43], v[64:67]
ds_read_b64_tr_b16 a[66:67], v12 offset:14848
v_mfma_f32_16x16x32_bf16 v[88:91], a[8:11], a[40:43], v[88:91]
ds_read_b64_tr_b16 a[68:69], v13 offset:14336
v_mfma_f32_16x16x32_bf16 v[112:115], a[12:15], a[40:43], v[112:115]
ds_read_b64_tr_b16 a[70:71], v13 offset:14848
v_mfma_f32_16x16x32_bf16 v[44:47], a[0:3], a[44:47], v[44:47]
ds_read_b64_tr_b16 a[72:73], v12 offset:16384
v_mfma_f32_16x16x32_bf16 v[68:71], a[4:7], a[44:47], v[68:71]
ds_read_b64_tr_b16 a[74:75], v12 offset:16896
v_mfma_f32_16x16x32_bf16 v[92:95], a[8:11], a[44:47], v[92:95]
ds_read_b64_tr_b16 a[76:77], v13 offset:16384
v_mfma_f32_16x16x32_bf16 v[116:119], a[12:15], a[44:47], v[116:119]
ds_read_b64_tr_b16 a[78:79], v13 offset:16896
v_mfma_f32_16x16x32_bf16 v[48:51], a[0:3], a[48:51], v[48:51]
v_mfma_f32_16x16x32_bf16 v[72:75], a[4:7], a[48:51], v[72:75]
v_mfma_f32_16x16x32_bf16 v[96:99], a[8:11], a[48:51], v[96:99]
v_mfma_f32_16x16x32_bf16 v[120:123], a[12:15], a[48:51], v[120:123]
v_mfma_f32_16x16x32_bf16 v[52:55], a[0:3], a[52:55], v[52:55]
v_mfma_f32_16x16x32_bf16 v[76:79], a[4:7], a[52:55], v[76:79]
v_mfma_f32_16x16x32_bf16 v[100:103], a[8:11], a[52:55], v[100:103]
v_mfma_f32_16x16x32_bf16 v[124:127], a[12:15], a[52:55], v[124:127]
s_waitcnt lgkmcnt(0)
v_mfma_f32_16x16x32_bf16 v[40:43], a[16:19], a[64:67], v[40:43]
s_barrier
ds_read_b128 v[20:23], v17 offset:0
v_mfma_f32_16x16x32_bf16 v[64:67], a[20:23], a[64:67], v[64:67]
ds_read_b128 v[24:27], v17 offset:512
v_mfma_f32_16x16x32_bf16 v[88:91], a[24:27], a[64:67], v[88:91]
ds_read_b32 v8, v18 offset:256
v_mfma_f32_16x16x32_bf16 v[112:115], a[28:31], a[64:67], v[112:115]
ds_read_b32 v9, v18 offset:320
v_mfma_f32_16x16x32_bf16 v[44:47], a[16:19], a[68:71], v[44:47]
ds_read_b32 v10, v18 offset:512
v_mfma_f32_16x16x32_bf16 v[68:71], a[20:23], a[68:71], v[68:71]
ds_read_b32 v11, v18 offset:576
v_mfma_f32_16x16x32_bf16 v[92:95], a[24:27], a[68:71], v[92:95]
v_mov_b32 v19, 161536
ds_read_b32 v19, v19
v_mfma_f32_16x16x32_bf16 v[116:119], a[28:31], a[68:71], v[116:119]
ds_read_b128 v[128:131], v17 offset:64
v_mfma_f32_16x16x32_bf16 v[48:51], a[16:19], a[72:75], v[48:51]
ds_read_b128 v[132:135], v17 offset:576
v_mfma_f32_16x16x32_bf16 v[72:75], a[20:23], a[72:75], v[72:75]
ds_read_b128 v[136:139], v17 offset:128
v_mfma_f32_16x16x32_bf16 v[96:99], a[24:27], a[72:75], v[96:99]
ds_read_b128 v[140:143], v17 offset:640
v_mfma_f32_16x16x32_bf16 v[120:123], a[28:31], a[72:75], v[120:123]
ds_read_b128 v[144:147], v17 offset:192
v_mfma_f32_16x16x32_bf16 v[52:55], a[16:19], a[76:79], v[52:55]
ds_read_b128 v[148:151], v17 offset:704
v_mfma_f32_16x16x32_bf16 v[76:79], a[20:23], a[76:79], v[76:79]
v_mfma_f32_16x16x32_bf16 v[100:103], a[24:27], a[76:79], v[100:103]
v_mfma_f32_16x16x32_bf16 v[124:127], a[28:31], a[76:79], v[124:127]
v_mfma_f32_16x16x32_bf16 v[32:35], a[56:59], a[16:19], v[32:35]
v_mfma_f32_16x16x32_bf16 v[56:59], a[56:59], a[20:23], v[56:59]
v_mfma_f32_16x16x32_bf16 v[80:83], a[56:59], a[24:27], v[80:83]
v_mfma_f32_16x16x32_bf16 v[104:107], a[56:59], a[28:31], v[104:107]
v_mfma_f32_16x16x32_bf16 v[36:39], a[60:63], a[16:19], v[36:39]
v_mfma_f32_16x16x32_bf16 v[60:63], a[60:63], a[20:23], v[60:63]
v_mfma_f32_16x16x32_bf16 v[84:87], a[60:63], a[24:27], v[84:87]
v_mfma_f32_16x16x32_bf16 v[108:111], a[60:63], a[28:31], v[108:111]
s_waitcnt lgkmcnt(0)
v_readfirstlane_b32 s69, v19
v_pk_mul_f32 v[28:29], v[24:25], s[90:91]
v_pk_mul_f32 v[30:31], v[26:27], s[90:91]
v_pk_fma_f32 v[40:41], v[20:21], v[8:9], v[40:41] op_sel:[0,0,0] op_sel_hi:[1,0,1]
v_pk_fma_f32 v[44:45], v[20:21], v[8:9], v[44:45] op_sel:[0,1,0] op_sel_hi:[1,1,1]
v_pk_fma_f32 v[42:43], v[22:23], v[8:9], v[42:43] op_sel:[0,0,0] op_sel_hi:[1,0,1]
v_pk_fma_f32 v[46:47], v[22:23], v[8:9], v[46:47] op_sel:[0,1,0] op_sel_hi:[1,1,1]
v_pk_mul_f32 v[2:3], v[40:41], v[28:29]
v_pk_mul_f32 v[12:13], v[44:45], v[28:29]
v_pk_mul_f32 v[4:5], v[42:43], v[30:31]
v_pk_mul_f32 v[14:15], v[46:47], v[30:31]
v_pk_fma_f32 v[40:41], v[40:41], v[24:25], s[82:83]
v_pk_fma_f32 v[44:45], v[44:45], v[24:25], s[82:83]
v_pk_fma_f32 v[42:43], v[42:43], v[26:27], s[82:83]
v_pk_fma_f32 v[46:47], v[46:47], v[26:27], s[82:83]
v_exp_f32_e64 v2, v2 clamp
v_exp_f32_e64 v12, v12 clamp
v_exp_f32_e64 v3, v3 clamp
v_exp_f32_e64 v13, v13 clamp
v_exp_f32_e64 v4, v4 clamp
v_exp_f32_e64 v14, v14 clamp
v_exp_f32_e64 v5, v5 clamp
v_exp_f32_e64 v15, v15 clamp
v_pk_add_f32 v[2:3], v[2:3], s[80:81]
v_pk_add_f32 v[12:13], v[12:13], s[80:81]
v_pk_add_f32 v[4:5], v[4:5], s[80:81]
v_pk_add_f32 v[14:15], v[14:15], s[80:81]
v_max_f32 v40, v40, v2
v_max_f32 v44, v44, v12
v_max_f32 v41, v41, v3
v_max_f32 v45, v45, v13
v_max_f32 v42, v42, v4
v_max_f32 v46, v46, v14
v_max_f32 v43, v43, v5
v_max_f32 v47, v47, v15
v_cvt_pk_bf16_f32 v40, v40, v41
v_cvt_pk_bf16_f32 v44, v44, v45
v_cvt_pk_bf16_f32 v41, v42, v43
v_cvt_pk_bf16_f32 v45, v46, v47
v_pk_fma_f32 v[48:49], v[20:21], v[10:11], v[48:49] op_sel:[0,0,0] op_sel_hi:[1,0,1]
v_pk_fma_f32 v[52:53], v[20:21], v[10:11], v[52:53] op_sel:[0,1,0] op_sel_hi:[1,1,1]
v_pk_fma_f32 v[50:51], v[22:23], v[10:11], v[50:51] op_sel:[0,0,0] op_sel_hi:[1,0,1]
v_pk_fma_f32 v[54:55], v[22:23], v[10:11], v[54:55] op_sel:[0,1,0] op_sel_hi:[1,1,1]
v_pk_mul_f32 v[48:49], v[48:49], v[24:25]
v_pk_mul_f32 v[52:53], v[52:53], v[24:25]
v_pk_mul_f32 v[50:51], v[50:51], v[26:27]
v_pk_mul_f32 v[54:55], v[54:55], v[26:27]
v_cvt_pk_bf16_f32 v48, v48, v49
v_cvt_pk_bf16_f32 v52, v52, v53
v_cvt_pk_bf16_f32 v49, v50, v51
v_cvt_pk_bf16_f32 v53, v54, v55
v_pk_mul_f32 v[28:29], v[132:133], s[90:91]
v_pk_mul_f32 v[30:31], v[134:135], s[90:91]
v_pk_fma_f32 v[64:65], v[128:129], v[8:9], v[64:65] op_sel:[0,0,0] op_sel_hi:[1,0,1]
v_pk_fma_f32 v[68:69], v[128:129], v[8:9], v[68:69] op_sel:[0,1,0] op_sel_hi:[1,1,1]
v_pk_fma_f32 v[66:67], v[130:131], v[8:9], v[66:67] op_sel:[0,0,0] op_sel_hi:[1,0,1]
v_pk_fma_f32 v[70:71], v[130:131], v[8:9], v[70:71] op_sel:[0,1,0] op_sel_hi:[1,1,1]
v_pk_mul_f32 v[2:3], v[64:65], v[28:29]
v_pk_mul_f32 v[12:13], v[68:69], v[28:29]
v_pk_mul_f32 v[4:5], v[66:67], v[30:31]
v_pk_mul_f32 v[14:15], v[70:71], v[30:31]
v_pk_fma_f32 v[64:65], v[64:65], v[132:133], s[82:83]
v_pk_fma_f32 v[68:69], v[68:69], v[132:133], s[82:83]
v_pk_fma_f32 v[66:67], v[66:67], v[134:135], s[82:83]
v_pk_fma_f32 v[70:71], v[70:71], v[134:135], s[82:83]
v_exp_f32_e64 v2, v2 clamp
v_exp_f32_e64 v12, v12 clamp
v_exp_f32_e64 v3, v3 clamp
v_exp_f32_e64 v13, v13 clamp
v_exp_f32_e64 v4, v4 clamp
v_exp_f32_e64 v14, v14 clamp
v_exp_f32_e64 v5, v5 clamp
v_exp_f32_e64 v15, v15 clamp
v_pk_add_f32 v[2:3], v[2:3], s[80:81]
v_pk_add_f32 v[12:13], v[12:13], s[80:81]
v_pk_add_f32 v[4:5], v[4:5], s[80:81]
v_pk_add_f32 v[14:15], v[14:15], s[80:81]
v_max_f32 v64, v64, v2
v_max_f32 v68, v68, v12
v_max_f32 v65, v65, v3
v_max_f32 v69, v69, v13
v_max_f32 v66, v66, v4
v_max_f32 v70, v70, v14
v_max_f32 v67, v67, v5
v_max_f32 v71, v71, v15
v_cvt_pk_bf16_f32 v42, v64, v65
v_cvt_pk_bf16_f32 v46, v68, v69
v_cvt_pk_bf16_f32 v43, v66, v67
v_cvt_pk_bf16_f32 v47, v70, v71
v_pk_fma_f32 v[72:73], v[128:129], v[10:11], v[72:73] op_sel:[0,0,0] op_sel_hi:[1,0,1]
v_pk_fma_f32 v[76:77], v[128:129], v[10:11], v[76:77] op_sel:[0,1,0] op_sel_hi:[1,1,1]
v_pk_fma_f32 v[74:75], v[130:131], v[10:11], v[74:75] op_sel:[0,0,0] op_sel_hi:[1,0,1]
v_pk_fma_f32 v[78:79], v[130:131], v[10:11], v[78:79] op_sel:[0,1,0] op_sel_hi:[1,1,1]
v_pk_mul_f32 v[72:73], v[72:73], v[132:133]
v_pk_mul_f32 v[76:77], v[76:77], v[132:133]
v_pk_mul_f32 v[74:75], v[74:75], v[134:135]
v_pk_mul_f32 v[78:79], v[78:79], v[134:135]
v_cvt_pk_bf16_f32 v50, v72, v73
v_cvt_pk_bf16_f32 v54, v76, v77
v_cvt_pk_bf16_f32 v51, v74, v75
v_cvt_pk_bf16_f32 v55, v78, v79
s_nop 0
v_mfma_f32_16x16x32_bf16 v[64:67], v[40:43], v[48:51], 0
v_mfma_f32_16x16x32_bf16 v[68:71], v[40:43], v[52:55], 0
v_mfma_f32_16x16x32_bf16 v[20:23], v[40:43], a[80:83], 0
v_mfma_f32_16x16x32_bf16 v[72:75], v[44:47], v[48:51], 0
v_mfma_f32_16x16x32_bf16 v[76:79], v[44:47], v[52:55], 0
v_mfma_f32_16x16x32_bf16 v[24:27], v[44:47], a[80:83], 0
v_pk_mul_f32 v[28:29], v[140:141], s[90:91]
v_pk_mul_f32 v[30:31], v[142:143], s[90:91]
v_pk_fma_f32 v[88:89], v[136:137], v[8:9], v[88:89] op_sel:[0,0,0] op_sel_hi:[1,0,1]
v_pk_fma_f32 v[92:93], v[136:137], v[8:9], v[92:93] op_sel:[0,1,0] op_sel_hi:[1,1,1]
v_pk_fma_f32 v[90:91], v[138:139], v[8:9], v[90:91] op_sel:[0,0,0] op_sel_hi:[1,0,1]
v_pk_fma_f32 v[94:95], v[138:139], v[8:9], v[94:95] op_sel:[0,1,0] op_sel_hi:[1,1,1]
v_pk_mul_f32 v[2:3], v[88:89], v[28:29]
v_pk_mul_f32 v[12:13], v[92:93], v[28:29]
v_pk_mul_f32 v[4:5], v[90:91], v[30:31]
v_pk_mul_f32 v[14:15], v[94:95], v[30:31]
v_pk_fma_f32 v[88:89], v[88:89], v[140:141], s[82:83]
v_pk_fma_f32 v[92:93], v[92:93], v[140:141], s[82:83]
v_pk_fma_f32 v[90:91], v[90:91], v[142:143], s[82:83]
v_pk_fma_f32 v[94:95], v[94:95], v[142:143], s[82:83]
v_exp_f32_e64 v2, v2 clamp
v_exp_f32_e64 v12, v12 clamp
v_exp_f32_e64 v3, v3 clamp
v_exp_f32_e64 v13, v13 clamp
v_exp_f32_e64 v4, v4 clamp
v_exp_f32_e64 v14, v14 clamp
v_exp_f32_e64 v5, v5 clamp
v_exp_f32_e64 v15, v15 clamp
v_pk_add_f32 v[2:3], v[2:3], s[80:81]
v_pk_add_f32 v[12:13], v[12:13], s[80:81]
v_pk_add_f32 v[4:5], v[4:5], s[80:81]
v_pk_add_f32 v[14:15], v[14:15], s[80:81]
v_max_f32 v88, v88, v2
v_max_f32 v92, v92, v12
v_max_f32 v89, v89, v3
v_max_f32 v93, v93, v13
v_max_f32 v90, v90, v4
v_max_f32 v94, v94, v14
v_max_f32 v91, v91, v5
v_max_f32 v95, v95, v15
v_cvt_pk_bf16_f32 v88, v88, v89
v_cvt_pk_bf16_f32 v92, v92, v93
v_cvt_pk_bf16_f32 v89, v90, v91
v_cvt_pk_bf16_f32 v93, v94, v95
v_pk_fma_f32 v[96:97], v[136:137], v[10:11], v[96:97] op_sel:[0,0,0] op_sel_hi:[1,0,1]
v_pk_fma_f32 v[100:101], v[136:137], v[10:11], v[100:101] op_sel:[0,1,0] op_sel_hi:[1,1,1]
v_pk_fma_f32 v[98:99], v[138:139], v[10:11], v[98:99] op_sel:[0,0,0] op_sel_hi:[1,0,1]
v_pk_fma_f32 v[102:103], v[138:139], v[10:11], v[102:103] op_sel:[0,1,0] op_sel_hi:[1,1,1]
v_pk_mul_f32 v[96:97], v[96:97], v[140:141]
v_pk_mul_f32 v[100:101], v[100:101], v[140:141]
v_pk_mul_f32 v[98:99], v[98:99], v[142:143]
v_pk_mul_f32 v[102:103], v[102:103], v[142:143]
v_cvt_pk_bf16_f32 v96, v96, v97
v_cvt_pk_bf16_f32 v100, v100, v101
v_cvt_pk_bf16_f32 v97, v98, v99
v_cvt_pk_bf16_f32 v101, v102, v103
v_pk_mul_f32 v[28:29], v[148:149], s[90:91]
v_pk_mul_f32 v[30:31], v[150:151], s[90:91]
v_pk_fma_f32 v[112:113], v[144:145], v[8:9], v[112:113] op_sel:[0,0,0] op_sel_hi:[1,0,1]
v_pk_fma_f32 v[116:117], v[144:145], v[8:9], v[116:117] op_sel:[0,1,0] op_sel_hi:[1,1,1]
v_pk_fma_f32 v[114:115], v[146:147], v[8:9], v[114:115] op_sel:[0,0,0] op_sel_hi:[1,0,1]
v_pk_fma_f32 v[118:119], v[146:147], v[8:9], v[118:119] op_sel:[0,1,0] op_sel_hi:[1,1,1]
v_pk_mul_f32 v[2:3], v[112:113], v[28:29]
v_pk_mul_f32 v[12:13], v[116:117], v[28:29]
v_pk_mul_f32 v[4:5], v[114:115], v[30:31]
v_pk_mul_f32 v[14:15], v[118:119], v[30:31]
v_pk_fma_f32 v[112:113], v[112:113], v[148:149], s[82:83]
v_pk_fma_f32 v[116:117], v[116:117], v[148:149], s[82:83]
v_pk_fma_f32 v[114:115], v[114:115], v[150:151], s[82:83]
v_pk_fma_f32 v[118:119], v[118:119], v[150:151], s[82:83]
v_exp_f32_e64 v2, v2 clamp
v_exp_f32_e64 v12, v12 clamp
v_exp_f32_e64 v3, v3 clamp
v_exp_f32_e64 v13, v13 clamp
v_exp_f32_e64 v4, v4 clamp
v_exp_f32_e64 v14, v14 clamp
v_exp_f32_e64 v5, v5 clamp
v_exp_f32_e64 v15, v15 clamp
v_pk_add_f32 v[2:3], v[2:3], s[80:81]
v_pk_add_f32 v[12:13], v[12:13], s[80:81]
v_pk_add_f32 v[4:5], v[4:5], s[80:81]
v_pk_add_f32 v[14:15], v[14:15], s[80:81]
v_max_f32 v112, v112, v2
v_max_f32 v116, v116, v12
v_max_f32 v113, v113, v3
v_max_f32 v117, v117, v13
v_max_f32 v114, v114, v4
v_max_f32 v118, v118, v14
v_max_f32 v115, v115, v5
v_max_f32 v119, v119, v15
v_cvt_pk_bf16_f32 v90, v112, v113
v_cvt_pk_bf16_f32 v94, v116, v117
v_cvt_pk_bf16_f32 v91, v114, v115
v_cvt_pk_bf16_f32 v95, v118, v119
v_pk_fma_f32 v[120:121], v[144:145], v[10:11], v[120:121] op_sel:[0,0,0] op_sel_hi:[1,0,1]
v_pk_fma_f32 v[124:125], v[144:145], v[10:11], v[124:125] op_sel:[0,1,0] op_sel_hi:[1,1,1]
v_pk_fma_f32 v[122:123], v[146:147], v[10:11], v[122:123] op_sel:[0,0,0] op_sel_hi:[1,0,1]
v_pk_fma_f32 v[126:127], v[146:147], v[10:11], v[126:127] op_sel:[0,1,0] op_sel_hi:[1,1,1]
v_pk_mul_f32 v[120:121], v[120:121], v[148:149]
v_pk_mul_f32 v[124:125], v[124:125], v[148:149]
v_pk_mul_f32 v[122:123], v[122:123], v[150:151]
v_pk_mul_f32 v[126:127], v[126:127], v[150:151]
v_cvt_pk_bf16_f32 v98, v120, v121
v_cvt_pk_bf16_f32 v102, v124, v125
v_cvt_pk_bf16_f32 v99, v122, v123
v_cvt_pk_bf16_f32 v103, v126, v127
s_nop 0
v_mfma_f32_16x16x32_bf16 v[64:67], v[88:91], v[96:99], v[64:67]
v_mfma_f32_16x16x32_bf16 v[68:71], v[88:91], v[100:103], v[68:71]
v_mfma_f32_16x16x32_bf16 v[20:23], v[88:91], a[80:83], v[20:23]
v_mfma_f32_16x16x32_bf16 v[72:75], v[92:95], v[96:99], v[72:75]
v_mfma_f32_16x16x32_bf16 v[76:79], v[92:95], v[100:103], v[76:79]
v_mfma_f32_16x16x32_bf16 v[24:27], v[92:95], a[80:83], v[24:27]
s_lshl_b32 s70, s60, 11
s_add_u32 s70, s70, 16384
v_add_u32 v2, s70, v16
v_xor_b32 v3, 4096, v2
v_lshrrev_b32 v4, 4, v1
v_lshlrev_b32 v5, 4, v4
v_lshlrev_b32 v4, 5, v4
s_lshl_b32 s70, s60, 6
s_add_u32 s70, s70, 163584
v_add_u32 v5, s70, v5
v_xor_b32 v6, 128, v5
s_lshl_b32 s72, s67, 1
s_add_u32 s72, s72, s66
s_lshl_b32 s72, s72, 10
s_add_u32 s72, s72, s87
s_lshl_b32 s73, s67, 7
s_lshl_b32 s70, s66, 4
s_add_u32 s73, s73, s70
s_add_u32 s73, s73, s87
s_add_u32 s73, s73, 4096
s_mov_b32 s92, 0x00010001
s_mov_b32 s93, 0x00010001
s_cmp_eq_u32 s66, 0
s_cbranch_scc0 L_ex1
ds_write_b128 v2, v[68:71]
ds_write_b128 v2, v[76:79] offset:1024
ds_write_b128 v5, v[24:27]
s_waitcnt lgkmcnt(0)
s_barrier
ds_read_b128 v[128:131], v3
ds_read_b128 v[132:135], v3 offset:1024
ds_read_b128 v[136:139], v6
s_waitcnt lgkmcnt(1)
v_pk_add_f32 v[128:129], v[128:129], v[64:65]
v_pk_add_f32 v[130:131], v[130:131], v[66:67]
v_pk_add_f32 v[132:133], v[132:133], v[72:73]
v_pk_add_f32 v[134:135], v[134:135], v[74:75]
s_waitcnt lgkmcnt(0)
v_pk_add_f32 v[136:137], v[136:137], v[20:21]
v_pk_add_f32 v[138:139], v[138:139], v[22:23]
L_ex_d:
v_cvt_pk_bf16_f32 v140, v128, v129
v_cvt_pk_bf16_f32 v141, v130, v131
v_cvt_pk_bf16_f32 v142, v132, v133
v_cvt_pk_bf16_f32 v143, v134, v135
s_cmp_eq_u32 s69, 0
s_cbranch_scc1 L_kvp_s
buffer_store_dwordx4 v[140:143], v16, s[12:15], s72 offen
s_mov_b64 exec, s[92:93]
buffer_store_dwordx4 v[136:139], v4, s[12:15], s73 offen
s_mov_b64 exec, -1
L_kvp_d:
v_and_b32 v2, 15, v1
v_lshlrev_b32 v2, 2, v2
s_lshl_b32 s70, s66, 8
s_add_u32 s70, s70, 159744
v_add_u32 v2, s70, v2
v_lshrrev_b32 v3, 4, v1
v_lshlrev_b32 v3, 4, v3
s_lshl_b32 s70, s67, 7
s_add_u32 s70, s70, 160768
v_add_u32 v5, s70, v3
ds_read_b32 v8, v2 offset:0
ds_read_b32 v12, v2 offset:512
ds_read_b32 v9, v2 offset:64
ds_read_b32 v13, v2 offset:576
ds_read_b32 v10, v2 offset:128
ds_read_b32 v14, v2 offset:640
ds_read_b32 v11, v2 offset:192
ds_read_b32 v15, v2 offset:704
ds_read_b128 v[144:147], v5 offset:0
ds_read_b128 v[148:151], v5 offset:64
s_lshl_b32 s70, s67, 11
s_add_u32 s70, s70, 24576
v_add_u32 v17, s70, v16
s_lshl_b32 s70, s67, 6
s_add_u32 s70, s70, 161600
v_add_u32 v18, s70, v3
s_waitcnt lgkmcnt(0)
v_pk_mul_f32 v[20:21], v[12:13], s[90:91]
v_pk_mul_f32 v[22:23], v[14:15], s[90:91]
v_pk_fma_f32 v[32:33], v[144:145], v[8:9], v[32:33] op_sel:[0,0,0] op_sel_hi:[1,0,1]
v_pk_fma_f32 v[36:37], v[148:149], v[8:9], v[36:37] op_sel:[0,0,0] op_sel_hi:[1,0,1]
v_pk_fma_f32 v[34:35], v[146:147], v[8:9], v[34:35] op_sel:[0,0,0] op_sel_hi:[1,0,1]
v_pk_fma_f32 v[38:39], v[150:151], v[8:9], v[38:39] op_sel:[0,0,0] op_sel_hi:[1,0,1]
v_pk_mul_f32 v[24:25], v[32:33], v[20:21] op_sel:[0,0] op_sel_hi:[1,0]
v_pk_mul_f32 v[28:29], v[36:37], v[20:21] op_sel:[0,0] op_sel_hi:[1,0]
v_pk_mul_f32 v[26:27], v[34:35], v[20:21] op_sel:[0,0] op_sel_hi:[1,0]
v_pk_mul_f32 v[30:31], v[38:39], v[20:21] op_sel:[0,0] op_sel_hi:[1,0]
v_pk_fma_f32 v[32:33], v[32:33], v[12:13], s[82:83] op_sel:[0,0,0] op_sel_hi:[1,0,1]
v_pk_fma_f32 v[36:37], v[36:37], v[12:13], s[82:83] op_sel:[0,0,0] op_sel_hi:[1,0,1]
v_pk_fma_f32 v[34:35], v[34:35], v[12:13], s[82:83] op_sel:[0,0,0] op_sel_hi:[1,0,1]
v_pk_fma_f32 v[38:39], v[38:39], v[12:13], s[82:83] op_sel:[0,0,0] op_sel_hi:[1,0,1]
v_exp_f32_e64 v24, v24 clamp
v_exp_f32_e64 v28, v28 clamp
v_exp_f32_e64 v25, v25 clamp
v_exp_f32_e64 v29, v29 clamp
v_exp_f32_e64 v26, v26 clamp
v_exp_f32_e64 v30, v30 clamp
v_exp_f32_e64 v27, v27 clamp
v_exp_f32_e64 v31, v31 clamp
v_pk_add_f32 v[24:25], v[24:25], s[80:81]
v_pk_add_f32 v[28:29], v[28:29], s[80:81]
v_pk_add_f32 v[26:27], v[26:27], s[80:81]
v_pk_add_f32 v[30:31], v[30:31], s[80:81]
v_max_f32 v32, v32, v24
v_max_f32 v36, v36, v28
v_max_f32 v33, v33, v25
v_max_f32 v37, v37, v29
v_max_f32 v34, v34, v26
v_max_f32 v38, v38, v30
v_max_f32 v35, v35, v27
v_max_f32 v39, v39, v31
v_cvt_pk_bf16_f32 v32, v32, v33
v_cvt_pk_bf16_f32 v33, v34, v35
v_cvt_pk_bf16_f32 v34, v36, v37
v_cvt_pk_bf16_f32 v35, v38, v39
v_pk_fma_f32 v[56:57], v[144:145], v[8:9], v[56:57] op_sel:[0,1,0] op_sel_hi:[1,1,1]
v_pk_fma_f32 v[60:61], v[148:149], v[8:9], v[60:61] op_sel:[0,1,0] op_sel_hi:[1,1,1]
v_pk_fma_f32 v[58:59], v[146:147], v[8:9], v[58:59] op_sel:[0,1,0] op_sel_hi:[1,1,1]
v_pk_fma_f32 v[62:63], v[150:151], v[8:9], v[62:63] op_sel:[0,1,0] op_sel_hi:[1,1,1]
v_pk_mul_f32 v[24:25], v[56:57], v[20:21] op_sel:[0,1] op_sel_hi:[1,1]
v_pk_mul_f32 v[28:29], v[60:61], v[20:21] op_sel:[0,1] op_sel_hi:[1,1]
v_pk_mul_f32 v[26:27], v[58:59], v[20:21] op_sel:[0,1] op_sel_hi:[1,1]
v_pk_mul_f32 v[30:31], v[62:63], v[20:21] op_sel:[0,1] op_sel_hi:[1,1]
v_pk_fma_f32 v[56:57], v[56:57], v[12:13], s[82:83] op_sel:[0,1,0] op_sel_hi:[1,1,1]
v_pk_fma_f32 v[60:61], v[60:61], v[12:13], s[82:83] op_sel:[0,1,0] op_sel_hi:[1,1,1]
v_pk_fma_f32 v[58:59], v[58:59], v[12:13], s[82:83] op_sel:[0,1,0] op_sel_hi:[1,1,1]
v_pk_fma_f32 v[62:63], v[62:63], v[12:13], s[82:83] op_sel:[0,1,0] op_sel_hi:[1,1,1]
v_exp_f32_e64 v24, v24 clamp
v_exp_f32_e64 v28, v28 clamp
v_exp_f32_e64 v25, v25 clamp
v_exp_f32_e64 v29, v29 clamp
v_exp_f32_e64 v26, v26 clamp
v_exp_f32_e64 v30, v30 clamp
v_exp_f32_e64 v27, v27 clamp
v_exp_f32_e64 v31, v31 clamp
v_pk_add_f32 v[24:25], v[24:25], s[80:81]
v_pk_add_f32 v[28:29], v[28:29], s[80:81]
v_pk_add_f32 v[26:27], v[26:27], s[80:81]
v_pk_add_f32 v[30:31], v[30:31], s[80:81]
v_max_f32 v56, v56, v24
v_max_f32 v60, v60, v28
v_max_f32 v57, v57, v25
v_max_f32 v61, v61, v29
v_max_f32 v58, v58, v26
v_max_f32 v62, v62, v30
v_max_f32 v59, v59, v27
v_max_f32 v63, v63, v31
v_cvt_pk_bf16_f32 v56, v56, v57
v_cvt_pk_bf16_f32 v57, v58, v59
v_cvt_pk_bf16_f32 v58, v60, v61
v_cvt_pk_bf16_f32 v59, v62, v63
v_pk_fma_f32 v[80:81], v[144:145], v[10:11], v[80:81] op_sel:[0,0,0] op_sel_hi:[1,0,1]
v_pk_fma_f32 v[84:85], v[148:149], v[10:11], v[84:85] op_sel:[0,0,0] op_sel_hi:[1,0,1]
v_pk_fma_f32 v[82:83], v[146:147], v[10:11], v[82:83] op_sel:[0,0,0] op_sel_hi:[1,0,1]
v_pk_fma_f32 v[86:87], v[150:151], v[10:11], v[86:87] op_sel:[0,0,0] op_sel_hi:[1,0,1]
v_pk_mul_f32 v[24:25], v[80:81], v[22:23] op_sel:[0,0] op_sel_hi:[1,0]
v_pk_mul_f32 v[28:29], v[84:85], v[22:23] op_sel:[0,0] op_sel_hi:[1,0]
v_pk_mul_f32 v[26:27], v[82:83], v[22:23] op_sel:[0,0] op_sel_hi:[1,0]
v_pk_mul_f32 v[30:31], v[86:87], v[22:23] op_sel:[0,0] op_sel_hi:[1,0]
v_pk_fma_f32 v[80:81], v[80:81], v[14:15], s[82:83] op_sel:[0,0,0] op_sel_hi:[1,0,1]
v_pk_fma_f32 v[84:85], v[84:85], v[14:15], s[82:83] op_sel:[0,0,0] op_sel_hi:[1,0,1]
v_pk_fma_f32 v[82:83], v[82:83], v[14:15], s[82:83] op_sel:[0,0,0] op_sel_hi:[1,0,1]
v_pk_fma_f32 v[86:87], v[86:87], v[14:15], s[82:83] op_sel:[0,0,0] op_sel_hi:[1,0,1]
v_exp_f32_e64 v24, v24 clamp
v_exp_f32_e64 v28, v28 clamp
v_exp_f32_e64 v25, v25 clamp
v_exp_f32_e64 v29, v29 clamp
v_exp_f32_e64 v26, v26 clamp
v_exp_f32_e64 v30, v30 clamp
v_exp_f32_e64 v27, v27 clamp
v_exp_f32_e64 v31, v31 clamp
v_pk_add_f32 v[24:25], v[24:25], s[80:81]
v_pk_add_f32 v[28:29], v[28:29], s[80:81]
v_pk_add_f32 v[26:27], v[26:27], s[80:81]
v_pk_add_f32 v[30:31], v[30:31], s[80:81]
v_max_f32 v80, v80, v24
v_max_f32 v84, v84, v28
v_max_f32 v81, v81, v25
v_max_f32 v85, v85, v29
v_max_f32 v82, v82, v26
v_max_f32 v86, v86, v30
v_max_f32 v83, v83, v27
v_max_f32 v87, v87, v31
v_cvt_pk_bf16_f32 v80, v80, v81
v_cvt_pk_bf16_f32 v81, v82, v83
v_cvt_pk_bf16_f32 v82, v84, v85
v_cvt_pk_bf16_f32 v83, v86, v87
v_pk_fma_f32 v[104:105], v[144:145], v[10:11], v[104:105] op_sel:[0,1,0] op_sel_hi:[1,1,1]
v_pk_fma_f32 v[108:109], v[148:149], v[10:11], v[108:109] op_sel:[0,1,0] op_sel_hi:[1,1,1]
v_pk_fma_f32 v[106:107], v[146:147], v[10:11], v[106:107] op_sel:[0,1,0] op_sel_hi:[1,1,1]
v_pk_fma_f32 v[110:111], v[150:151], v[10:11], v[110:111] op_sel:[0,1,0] op_sel_hi:[1,1,1]
v_pk_mul_f32 v[24:25], v[104:105], v[22:23] op_sel:[0,1] op_sel_hi:[1,1]
v_pk_mul_f32 v[28:29], v[108:109], v[22:23] op_sel:[0,1] op_sel_hi:[1,1]
v_pk_mul_f32 v[26:27], v[106:107], v[22:23] op_sel:[0,1] op_sel_hi:[1,1]
v_pk_mul_f32 v[30:31], v[110:111], v[22:23] op_sel:[0,1] op_sel_hi:[1,1]
v_pk_fma_f32 v[104:105], v[104:105], v[14:15], s[82:83] op_sel:[0,1,0] op_sel_hi:[1,1,1]
v_pk_fma_f32 v[108:109], v[108:109], v[14:15], s[82:83] op_sel:[0,1,0] op_sel_hi:[1,1,1]
v_pk_fma_f32 v[106:107], v[106:107], v[14:15], s[82:83] op_sel:[0,1,0] op_sel_hi:[1,1,1]
v_pk_fma_f32 v[110:111], v[110:111], v[14:15], s[82:83] op_sel:[0,1,0] op_sel_hi:[1,1,1]
v_exp_f32_e64 v24, v24 clamp
v_exp_f32_e64 v28, v28 clamp
v_exp_f32_e64 v25, v25 clamp
v_exp_f32_e64 v29, v29 clamp
v_exp_f32_e64 v26, v26 clamp
v_exp_f32_e64 v30, v30 clamp
v_exp_f32_e64 v27, v27 clamp
v_exp_f32_e64 v31, v31 clamp
v_pk_add_f32 v[24:25], v[24:25], s[80:81]
v_pk_add_f32 v[28:29], v[28:29], s[80:81]
v_pk_add_f32 v[26:27], v[26:27], s[80:81]
v_pk_add_f32 v[30:31], v[30:31], s[80:81]
v_max_f32 v104, v104, v24
v_max_f32 v108, v108, v28
v_max_f32 v105, v105, v25
v_max_f32 v109, v109, v29
v_max_f32 v106, v106, v26
v_max_f32 v110, v110, v30
v_max_f32 v107, v107, v27
v_max_f32 v111, v111, v31
v_cvt_pk_bf16_f32 v104, v104, v105
v_cvt_pk_bf16_f32 v105, v106, v107
v_cvt_pk_bf16_f32 v106, v108, v109
v_cvt_pk_bf16_f32 v107, v110, v111
v_lshrrev_b32 v2, 4, v1
v_bfe_u32 v3, v1, 2, 2
v_lshl_add_u32 v4, v2, 2, v3
v_lshlrev_b32 v5, 7, v4
v_bfe_u32 v4, v4, 1, 2
v_lshl_add_u32 v5, v4, 5, v5
v_and_b32 v4, 3, v1
v_lshl_add_u32 v5, v4, 3, v5
v_add_u32 v8, 28672, v5
v_xor_b32 v9, 32, v8
v_xor_b32 v10, 64, v8
v_xor_b32 v11, 96, v8
v_and_b32 v3, 15, v1
v_lshrrev_b32 v4, 1, v3
v_lshrrev_b32 v5, 1, v2
v_xor_b32 v4, v4, v5
v_lshlrev_b32 v4, 4, v4
v_lshl_add_u32 v4, v3, 7, v4
v_and_b32 v5, 1, v2
v_lshl_add_u32 v4, v5, 3, v4
s_lshl_b32 s70, s60, 12
v_add_u32 v20, s70, v4
v_xor_b32 v21, 32, v20
v_xor_b32 v22, 64, v20
v_xor_b32 v23, 96, v20
v_add_u32 v19, 32768, v16
s_lshl_b32 s74, s64, 18
s_lshl_b32 s70, s60, 16
s_add_u32 s74, s74, s70
s_add_u32 s74, s74, 2097152
s_barrier
ds_read_b128 a[0:3], v17
ds_read_b128 a[4:7], v17 offset:1024
ds_read_b128 a[8:11], v18
s_waitcnt lgkmcnt(0)
v_mfma_f32_16x16x32_bf16 v[48:51], a[8:11], v[32:35], 0
v_mfma_f32_16x16x32_bf16 v[40:43], a[0:3], v[32:35], 0
v_mfma_f32_16x16x32_bf16 v[44:47], a[4:7], v[32:35], 0
v_mfma_f32_16x16x32_bf16 v[72:75], a[8:11], v[56:59], 0
v_mfma_f32_16x16x32_bf16 v[64:67], a[0:3], v[56:59], 0
v_mfma_f32_16x16x32_bf16 v[68:71], a[4:7], v[56:59], 0
v_mfma_f32_16x16x32_bf16 v[96:99], a[8:11], v[80:83], 0
v_mfma_f32_16x16x32_bf16 v[88:91], a[0:3], v[80:83], 0
v_mfma_f32_16x16x32_bf16 v[92:95], a[4:7], v[80:83], 0
v_mfma_f32_16x16x32_bf16 v[120:123], a[8:11], v[104:107], 0
v_mfma_f32_16x16x32_bf16 v[112:115], a[0:3], v[104:107], 0
v_mfma_f32_16x16x32_bf16 v[116:119], a[4:7], v[104:107], 0
v_add_f32 v48, s80, v48
v_rcp_f32 v48, v48
s_nop 0
v_pk_mul_f32 v[40:41], v[40:41], v[48:49] op_sel_hi:[1,0]
v_pk_mul_f32 v[42:43], v[42:43], v[48:49] op_sel_hi:[1,0]
v_pk_mul_f32 v[44:45], v[44:45], v[48:49] op_sel_hi:[1,0]
v_pk_mul_f32 v[46:47], v[46:47], v[48:49] op_sel_hi:[1,0]
v_cvt_pk_bf16_f32 v52, v40, v41
v_cvt_pk_bf16_f32 v53, v42, v43
v_cvt_pk_bf16_f32 v54, v44, v45
v_cvt_pk_bf16_f32 v55, v46, v47
s_add_u32 s70, s88, 0
buffer_store_dwordx4 v[52:55], v16, s[12:15], s70 offen sc1
v_add_f32 v72, s80, v72
v_rcp_f32 v72, v72
s_nop 0
v_pk_mul_f32 v[64:65], v[64:65], v[72:73] op_sel_hi:[1,0]
v_pk_mul_f32 v[66:67], v[66:67], v[72:73] op_sel_hi:[1,0]
v_pk_mul_f32 v[68:69], v[68:69], v[72:73] op_sel_hi:[1,0]
v_pk_mul_f32 v[70:71], v[70:71], v[72:73] op_sel_hi:[1,0]
v_cvt_pk_bf16_f32 v76, v64, v65
v_cvt_pk_bf16_f32 v77, v66, v67
v_cvt_pk_bf16_f32 v78, v68, v69
v_cvt_pk_bf16_f32 v79, v70, v71
s_add_u32 s70, s88, 32768
buffer_store_dwordx4 v[76:79], v16, s[12:15], s70 offen sc1
v_add_f32 v96, s80, v96
v_rcp_f32 v96, v96
s_nop 0
v_pk_mul_f32 v[88:89], v[88:89], v[96:97] op_sel_hi:[1,0]
v_pk_mul_f32 v[90:91], v[90:91], v[96:97] op_sel_hi:[1,0]
v_pk_mul_f32 v[92:93], v[92:93], v[96:97] op_sel_hi:[1,0]
v_pk_mul_f32 v[94:95], v[94:95], v[96:97] op_sel_hi:[1,0]
v_cvt_pk_bf16_f32 v100, v88, v89
v_cvt_pk_bf16_f32 v101, v90, v91
v_cvt_pk_bf16_f32 v102, v92, v93
v_cvt_pk_bf16_f32 v103, v94, v95
s_add_u32 s70, s88, 65536
buffer_store_dwordx4 v[100:103], v16, s[12:15], s70 offen sc1
v_add_f32 v120, s80, v120
v_rcp_f32 v120, v120
s_nop 0
v_pk_mul_f32 v[112:113], v[112:113], v[120:121] op_sel_hi:[1,0]
v_pk_mul_f32 v[114:115], v[114:115], v[120:121] op_sel_hi:[1,0]
v_pk_mul_f32 v[116:117], v[116:117], v[120:121] op_sel_hi:[1,0]
v_pk_mul_f32 v[118:119], v[118:119], v[120:121] op_sel_hi:[1,0]
v_cvt_pk_bf16_f32 v124, v112, v113
v_cvt_pk_bf16_f32 v125, v114, v115
v_cvt_pk_bf16_f32 v126, v116, v117
v_cvt_pk_bf16_f32 v127, v118, v119
s_add_u32 s70, s88, 98304
buffer_store_dwordx4 v[124:127], v16, s[12:15], s70 offen sc1
s_add_u32 s70, s65, 0
s_and_b32 s70, s70, 15
s_lshl_b32 s70, s70, 11
s_add_u32 s70, s70, s74
buffer_load_dwordx4 v[56:59], v16, s[12:15], s70 offen offset:0 sc1
buffer_load_dwordx4 v[60:63], v19, s[12:15], s70 offen offset:0 sc1
buffer_load_dwordx4 v[64:67], v16, s[12:15], s70 offen offset:1024 sc1
buffer_load_dwordx4 v[68:71], v19, s[12:15], s70 offen offset:1024 sc1
s_add_u32 s70, s65, 1
s_and_b32 s70, s70, 15
s_lshl_b32 s70, s70, 11
s_add_u32 s70, s70, s74
buffer_load_dwordx4 v[72:75], v16, s[12:15], s70 offen offset:0 sc1
buffer_load_dwordx4 v[76:79], v19, s[12:15], s70 offen offset:0 sc1
buffer_load_dwordx4 v[80:83], v16, s[12:15], s70 offen offset:1024 sc1
buffer_load_dwordx4 v[84:87], v19, s[12:15], s70 offen offset:1024 sc1
s_add_u32 s70, s65, 2
s_and_b32 s70, s70, 15
s_lshl_b32 s70, s70, 11
s_add_u32 s70, s70, s74
buffer_load_dwordx4 v[88:91], v16, s[12:15], s70 offen offset:0 sc1
buffer_load_dwordx4 v[92:95], v19, s[12:15], s70 offen offset:0 sc1
buffer_load_dwordx4 v[96:99], v16, s[12:15], s70 offen offset:1024 sc1
buffer_load_dwordx4 v[100:103], v19, s[12:15], s70 offen offset:1024 sc1
s_add_u32 s70, s65, 3
s_and_b32 s70, s70, 15
s_lshl_b32 s70, s70, 11
s_add_u32 s70, s70, s74
buffer_load_dwordx4 v[104:107], v16, s[12:15], s70 offen offset:0 sc1
buffer_load_dwordx4 v[108:111], v19, s[12:15], s70 offen offset:0 sc1
buffer_load_dwordx4 v[112:115], v16, s[12:15], s70 offen offset:1024 sc1
buffer_load_dwordx4 v[116:119], v19, s[12:15], s70 offen offset:1024 sc1
s_add_u32 s70, s65, 4
s_and_b32 s70, s70, 15
s_lshl_b32 s70, s70, 11
s_add_u32 s70, s70, s74
buffer_load_dwordx4 v[120:123], v16, s[12:15], s70 offen offset:0 sc1
buffer_load_dwordx4 v[124:127], v19, s[12:15], s70 offen offset:0 sc1
buffer_load_dwordx4 v[128:131], v16, s[12:15], s70 offen offset:1024 sc1
buffer_load_dwordx4 v[132:135], v19, s[12:15], s70 offen offset:1024 sc1
s_add_u32 s70, s65, 5
s_and_b32 s70, s70, 15
s_lshl_b32 s70, s70, 11
s_add_u32 s70, s70, s74
buffer_load_dwordx4 v[136:139], v16, s[12:15], s70 offen offset:0 sc1
buffer_load_dwordx4 v[140:143], v19, s[12:15], s70 offen offset:0 sc1
buffer_load_dwordx4 v[144:147], v16, s[12:15], s70 offen offset:1024 sc1
buffer_load_dwordx4 v[148:151], v19, s[12:15], s70 offen offset:1024 sc1
ds_read_b64 v[26:27], v20 offset:0
ds_read_b64 v[30:31], v21 offset:0
ds_read_b64 v[34:35], v22 offset:0
ds_read_b64 v[38:39], v23 offset:0
ds_read_b64 v[42:43], v20 offset:2048
ds_read_b64 v[46:47], v21 offset:2048
ds_read_b64 v[50:51], v22 offset:2048
ds_read_b64 v[54:55], v23 offset:2048
s_add_u32 s71, s65, 0
s_and_b32 s71, s71, 15
s_lshl_b32 s71, s71, 13
v_add_u32 v12, s71, v8
v_add_u32 v13, s71, v9
v_add_u32 v14, s71, v10
v_add_u32 v15, s71, v11
s_waitcnt lgkmcnt(0)
ds_read_b64_tr_b16 a[0:1], v12 offset:0
ds_read_b64_tr_b16 a[2:3], v12 offset:2048
ds_read_b64_tr_b16 a[4:5], v13 offset:0
ds_read_b64_tr_b16 a[6:7], v13 offset:2048
ds_read_b64_tr_b16 a[8:9], v14 offset:0
ds_read_b64_tr_b16 a[10:11], v14 offset:2048
ds_read_b64_tr_b16 a[12:13], v15 offset:0
ds_read_b64_tr_b16 a[14:15], v15 offset:2048
v_lshlrev_b32 v24, 16, v26
v_and_b32 v25, 0xffff0000, v26
v_lshlrev_b32 v26, 16, v27
v_and_b32 v27, 0xffff0000, v27
v_lshlrev_b32 v28, 16, v30
v_and_b32 v29, 0xffff0000, v30
v_lshlrev_b32 v30, 16, v31
v_and_b32 v31, 0xffff0000, v31
v_lshlrev_b32 v32, 16, v34
v_and_b32 v33, 0xffff0000, v34
v_lshlrev_b32 v34, 16, v35
v_and_b32 v35, 0xffff0000, v35
v_lshlrev_b32 v36, 16, v38
v_and_b32 v37, 0xffff0000, v38
v_lshlrev_b32 v38, 16, v39
v_and_b32 v39, 0xffff0000, v39
v_lshlrev_b32 v40, 16, v42
v_and_b32 v41, 0xffff0000, v42
v_lshlrev_b32 v42, 16, v43
v_and_b32 v43, 0xffff0000, v43
v_lshlrev_b32 v44, 16, v46
v_and_b32 v45, 0xffff0000, v46
v_lshlrev_b32 v46, 16, v47
v_and_b32 v47, 0xffff0000, v47
v_lshlrev_b32 v48, 16, v50
v_and_b32 v49, 0xffff0000, v50
v_lshlrev_b32 v50, 16, v51
v_and_b32 v51, 0xffff0000, v51
v_lshlrev_b32 v52, 16, v54
v_and_b32 v53, 0xffff0000, v54
v_lshlrev_b32 v54, 16, v55
v_and_b32 v55, 0xffff0000, v55
s_waitcnt vmcnt(20)
L_o0_chk:
v_max3_u32 v2, v56, v60, v64
v_max_u32 v2, v2, v68
v_cmp_eq_u32 vcc, -1, v2
s_cbranch_vccnz L_o0_rt
L_o0_ok:
s_waitcnt lgkmcnt(0)
v_mfma_f32_16x16x32_bf16 v[24:27], a[0:3], v[56:59], v[24:27]
ds_read_b64_tr_b16 a[16:17], v12 offset:4096
v_mfma_f32_16x16x32_bf16 v[40:43], a[0:3], v[60:63], v[40:43]
ds_read_b64_tr_b16 a[18:19], v12 offset:6144
v_mfma_f32_16x16x32_bf16 v[28:31], a[4:7], v[56:59], v[28:31]
ds_read_b64_tr_b16 a[20:21], v13 offset:4096
v_mfma_f32_16x16x32_bf16 v[44:47], a[4:7], v[60:63], v[44:47]
ds_read_b64_tr_b16 a[22:23], v13 offset:6144
v_mfma_f32_16x16x32_bf16 v[32:35], a[8:11], v[56:59], v[32:35]
ds_read_b64_tr_b16 a[24:25], v14 offset:4096
v_mfma_f32_16x16x32_bf16 v[48:51], a[8:11], v[60:63], v[48:51]
ds_read_b64_tr_b16 a[26:27], v14 offset:6144
v_mfma_f32_16x16x32_bf16 v[36:39], a[12:15], v[56:59], v[36:39]
ds_read_b64_tr_b16 a[28:29], v15 offset:4096
v_mfma_f32_16x16x32_bf16 v[52:55], a[12:15], v[60:63], v[52:55]
ds_read_b64_tr_b16 a[30:31], v15 offset:6144
s_add_u32 s71, s65, 1
s_and_b32 s71, s71, 15
s_lshl_b32 s71, s71, 13
v_add_u32 v12, s71, v8
v_add_u32 v13, s71, v9
v_add_u32 v14, s71, v10
v_add_u32 v15, s71, v11
s_waitcnt lgkmcnt(0)
v_mfma_f32_16x16x32_bf16 v[24:27], a[16:19], v[64:67], v[24:27]
ds_read_b64_tr_b16 a[0:1], v12 offset:0
v_mfma_f32_16x16x32_bf16 v[40:43], a[16:19], v[68:71], v[40:43]
ds_read_b64_tr_b16 a[2:3], v12 offset:2048
v_mfma_f32_16x16x32_bf16 v[28:31], a[20:23], v[64:67], v[28:31]
ds_read_b64_tr_b16 a[4:5], v13 offset:0
v_mfma_f32_16x16x32_bf16 v[44:47], a[20:23], v[68:71], v[44:47]
ds_read_b64_tr_b16 a[6:7], v13 offset:2048
v_mfma_f32_16x16x32_bf16 v[32:35], a[24:27], v[64:67], v[32:35]
ds_read_b64_tr_b16 a[8:9], v14 offset:0
v_mfma_f32_16x16x32_bf16 v[48:51], a[24:27], v[68:71], v[48:51]
ds_read_b64_tr_b16 a[10:11], v14 offset:2048
v_mfma_f32_16x16x32_bf16 v[36:39], a[28:31], v[64:67], v[36:39]
ds_read_b64_tr_b16 a[12:13], v15 offset:0
v_mfma_f32_16x16x32_bf16 v[52:55], a[28:31], v[68:71], v[52:55]
ds_read_b64_tr_b16 a[14:15], v15 offset:2048
s_add_u32 s70, s65, 6
s_and_b32 s70, s70, 15
s_lshl_b32 s70, s70, 11
s_add_u32 s70, s70, s74
buffer_load_dwordx4 v[56:59], v16, s[12:15], s70 offen offset:0 sc1
buffer_load_dwordx4 v[60:63], v19, s[12:15], s70 offen offset:0 sc1
buffer_load_dwordx4 v[64:67], v16, s[12:15], s70 offen offset:1024 sc1
buffer_load_dwordx4 v[68:71], v19, s[12:15], s70 offen offset:1024 sc1
s_waitcnt vmcnt(20)
L_o1_chk:
v_max3_u32 v2, v72, v76, v80
v_max_u32 v2, v2, v84
v_cmp_eq_u32 vcc, -1, v2
s_cbranch_vccnz L_o1_rt
L_o1_ok:
s_waitcnt lgkmcnt(0)
v_mfma_f32_16x16x32_bf16 v[24:27], a[0:3], v[72:75], v[24:27]
ds_read_b64_tr_b16 a[16:17], v12 offset:4096
v_mfma_f32_16x16x32_bf16 v[40:43], a[0:3], v[76:79], v[40:43]
ds_read_b64_tr_b16 a[18:19], v12 offset:6144
v_mfma_f32_16x16x32_bf16 v[28:31], a[4:7], v[72:75], v[28:31]
ds_read_b64_tr_b16 a[20:21], v13 offset:4096
v_mfma_f32_16x16x32_bf16 v[44:47], a[4:7], v[76:79], v[44:47]
ds_read_b64_tr_b16 a[22:23], v13 offset:6144
v_mfma_f32_16x16x32_bf16 v[32:35], a[8:11], v[72:75], v[32:35]
ds_read_b64_tr_b16 a[24:25], v14 offset:4096
v_mfma_f32_16x16x32_bf16 v[48:51], a[8:11], v[76:79], v[48:51]
ds_read_b64_tr_b16 a[26:27], v14 offset:6144
v_mfma_f32_16x16x32_bf16 v[36:39], a[12:15], v[72:75], v[36:39]
ds_read_b64_tr_b16 a[28:29], v15 offset:4096
v_mfma_f32_16x16x32_bf16 v[52:55], a[12:15], v[76:79], v[52:55]
ds_read_b64_tr_b16 a[30:31], v15 offset:6144
s_add_u32 s71, s65, 2
s_and_b32 s71, s71, 15
s_lshl_b32 s71, s71, 13
v_add_u32 v12, s71, v8
v_add_u32 v13, s71, v9
v_add_u32 v14, s71, v10
v_add_u32 v15, s71, v11
s_waitcnt lgkmcnt(0)
v_mfma_f32_16x16x32_bf16 v[24:27], a[16:19], v[80:83], v[24:27]
ds_read_b64_tr_b16 a[0:1], v12 offset:0
v_mfma_f32_16x16x32_bf16 v[40:43], a[16:19], v[84:87], v[40:43]
ds_read_b64_tr_b16 a[2:3], v12 offset:2048
v_mfma_f32_16x16x32_bf16 v[28:31], a[20:23], v[80:83], v[28:31]
ds_read_b64_tr_b16 a[4:5], v13 offset:0
v_mfma_f32_16x16x32_bf16 v[44:47], a[20:23], v[84:87], v[44:47]
ds_read_b64_tr_b16 a[6:7], v13 offset:2048
v_mfma_f32_16x16x32_bf16 v[32:35], a[24:27], v[80:83], v[32:35]
ds_read_b64_tr_b16 a[8:9], v14 offset:0
v_mfma_f32_16x16x32_bf16 v[48:51], a[24:27], v[84:87], v[48:51]
ds_read_b64_tr_b16 a[10:11], v14 offset:2048
v_mfma_f32_16x16x32_bf16 v[36:39], a[28:31], v[80:83], v[36:39]
ds_read_b64_tr_b16 a[12:13], v15 offset:0
v_mfma_f32_16x16x32_bf16 v[52:55], a[28:31], v[84:87], v[52:55]
ds_read_b64_tr_b16 a[14:15], v15 offset:2048
s_add_u32 s70, s65, 7
s_and_b32 s70, s70, 15
s_lshl_b32 s70, s70, 11
s_add_u32 s70, s70, s74
buffer_load_dwordx4 v[72:75], v16, s[12:15], s70 offen offset:0 sc1
buffer_load_dwordx4 v[76:79], v19, s[12:15], s70 offen offset:0 sc1
buffer_load_dwordx4 v[80:83], v16, s[12:15], s70 offen offset:1024 sc1
buffer_load_dwordx4 v[84:87], v19, s[12:15], s70 offen offset:1024 sc1
s_waitcnt vmcnt(20)
L_o2_chk:
v_max3_u32 v2, v88, v92, v96
v_max_u32 v2, v2, v100
v_cmp_eq_u32 vcc, -1, v2
s_cbranch_vccnz L_o2_rt
L_o2_ok:
s_waitcnt lgkmcnt(0)
v_mfma_f32_16x16x32_bf16 v[24:27], a[0:3], v[88:91], v[24:27]
ds_read_b64_tr_b16 a[16:17], v12 offset:4096
v_mfma_f32_16x16x32_bf16 v[40:43], a[0:3], v[92:95], v[40:43]
ds_read_b64_tr_b16 a[18:19], v12 offset:6144
v_mfma_f32_16x16x32_bf16 v[28:31], a[4:7], v[88:91], v[28:31]
ds_read_b64_tr_b16 a[20:21], v13 offset:4096
v_mfma_f32_16x16x32_bf16 v[44:47], a[4:7], v[92:95], v[44:47]
ds_read_b64_tr_b16 a[22:23], v13 offset:6144
v_mfma_f32_16x16x32_bf16 v[32:35], a[8:11], v[88:91], v[32:35]
ds_read_b64_tr_b16 a[24:25], v14 offset:4096
v_mfma_f32_16x16x32_bf16 v[48:51], a[8:11], v[92:95], v[48:51]
ds_read_b64_tr_b16 a[26:27], v14 offset:6144
v_mfma_f32_16x16x32_bf16 v[36:39], a[12:15], v[88:91], v[36:39]
ds_read_b64_tr_b16 a[28:29], v15 offset:4096
v_mfma_f32_16x16x32_bf16 v[52:55], a[12:15], v[92:95], v[52:55]
ds_read_b64_tr_b16 a[30:31], v15 offset:6144
s_add_u32 s71, s65, 3
s_and_b32 s71, s71, 15
s_lshl_b32 s71, s71, 13
v_add_u32 v12, s71, v8
v_add_u32 v13, s71, v9
v_add_u32 v14, s71, v10
v_add_u32 v15, s71, v11
s_waitcnt lgkmcnt(0)
v_mfma_f32_16x16x32_bf16 v[24:27], a[16:19], v[96:99], v[24:27]
ds_read_b64_tr_b16 a[0:1], v12 offset:0
v_mfma_f32_16x16x32_bf16 v[40:43], a[16:19], v[100:103], v[40:43]
ds_read_b64_tr_b16 a[2:3], v12 offset:2048
v_mfma_f32_16x16x32_bf16 v[28:31], a[20:23], v[96:99], v[28:31]
ds_read_b64_tr_b16 a[4:5], v13 offset:0
v_mfma_f32_16x16x32_bf16 v[44:47], a[20:23], v[100:103], v[44:47]
ds_read_b64_tr_b16 a[6:7], v13 offset:2048
v_mfma_f32_16x16x32_bf16 v[32:35], a[24:27], v[96:99], v[32:35]
ds_read_b64_tr_b16 a[8:9], v14 offset:0
v_mfma_f32_16x16x32_bf16 v[48:51], a[24:27], v[100:103], v[48:51]
ds_read_b64_tr_b16 a[10:11], v14 offset:2048
v_mfma_f32_16x16x32_bf16 v[36:39], a[28:31], v[96:99], v[36:39]
ds_read_b64_tr_b16 a[12:13], v15 offset:0
v_mfma_f32_16x16x32_bf16 v[52:55], a[28:31], v[100:103], v[52:55]
ds_read_b64_tr_b16 a[14:15], v15 offset:2048
s_add_u32 s70, s65, 8
s_and_b32 s70, s70, 15
s_lshl_b32 s70, s70, 11
s_add_u32 s70, s70, s74
buffer_load_dwordx4 v[88:91], v16, s[12:15], s70 offen offset:0 sc1
buffer_load_dwordx4 v[92:95], v19, s[12:15], s70 offen offset:0 sc1
buffer_load_dwordx4 v[96:99], v16, s[12:15], s70 offen offset:1024 sc1
buffer_load_dwordx4 v[100:103], v19, s[12:15], s70 offen offset:1024 sc1
s_waitcnt vmcnt(20)
L_o3_chk:
v_max3_u32 v2, v104, v108, v112
v_max_u32 v2, v2, v116
v_cmp_eq_u32 vcc, -1, v2
s_cbranch_vccnz L_o3_rt
L_o3_ok:
s_waitcnt lgkmcnt(0)
v_mfma_f32_16x16x32_bf16 v[24:27], a[0:3], v[104:107], v[24:27]
ds_read_b64_tr_b16 a[16:17], v12 offset:4096
v_mfma_f32_16x16x32_bf16 v[40:43], a[0:3], v[108:111], v[40:43]
ds_read_b64_tr_b16 a[18:19], v12 offset:6144
v_mfma_f32_16x16x32_bf16 v[28:31], a[4:7], v[104:107], v[28:31]
ds_read_b64_tr_b16 a[20:21], v13 offset:4096
v_mfma_f32_16x16x32_bf16 v[44:47], a[4:7], v[108:111], v[44:47]
ds_read_b64_tr_b16 a[22:23], v13 offset:6144
v_mfma_f32_16x16x32_bf16 v[32:35], a[8:11], v[104:107], v[32:35]
ds_read_b64_tr_b16 a[24:25], v14 offset:4096
v_mfma_f32_16x16x32_bf16 v[48:51], a[8:11], v[108:111], v[48:51]
ds_read_b64_tr_b16 a[26:27], v14 offset:6144
v_mfma_f32_16x16x32_bf16 v[36:39], a[12:15], v[104:107], v[36:39]
ds_read_b64_tr_b16 a[28:29], v15 offset:4096
v_mfma_f32_16x16x32_bf16 v[52:55], a[12:15], v[108:111], v[52:55]
ds_read_b64_tr_b16 a[30:31], v15 offset:6144
s_add_u32 s71, s65, 4
s_and_b32 s71, s71, 15
s_lshl_b32 s71, s71, 13
v_add_u32 v12, s71, v8
v_add_u32 v13, s71, v9
v_add_u32 v14, s71, v10
v_add_u32 v15, s71, v11
s_waitcnt lgkmcnt(0)
v_mfma_f32_16x16x32_bf16 v[24:27], a[16:19], v[112:115], v[24:27]
ds_read_b64_tr_b16 a[0:1], v12 offset:0
v_mfma_f32_16x16x32_bf16 v[40:43], a[16:19], v[116:119], v[40:43]
ds_read_b64_tr_b16 a[2:3], v12 offset:2048
v_mfma_f32_16x16x32_bf16 v[28:31], a[20:23], v[112:115], v[28:31]
ds_read_b64_tr_b16 a[4:5], v13 offset:0
v_mfma_f32_16x16x32_bf16 v[44:47], a[20:23], v[116:119], v[44:47]
ds_read_b64_tr_b16 a[6:7], v13 offset:2048
v_mfma_f32_16x16x32_bf16 v[32:35], a[24:27], v[112:115], v[32:35]
ds_read_b64_tr_b16 a[8:9], v14 offset:0
v_mfma_f32_16x16x32_bf16 v[48:51], a[24:27], v[116:119], v[48:51]
ds_read_b64_tr_b16 a[10:11], v14 offset:2048
v_mfma_f32_16x16x32_bf16 v[36:39], a[28:31], v[112:115], v[36:39]
ds_read_b64_tr_b16 a[12:13], v15 offset:0
v_mfma_f32_16x16x32_bf16 v[52:55], a[28:31], v[116:119], v[52:55]
ds_read_b64_tr_b16 a[14:15], v15 offset:2048
s_add_u32 s70, s65, 9
s_and_b32 s70, s70, 15
s_lshl_b32 s70, s70, 11
s_add_u32 s70, s70, s74
buffer_load_dwordx4 v[104:107], v16, s[12:15], s70 offen offset:0 sc1
buffer_load_dwordx4 v[108:111], v19, s[12:15], s70 offen offset:0 sc1
buffer_load_dwordx4 v[112:115], v16, s[12:15], s70 offen offset:1024 sc1
buffer_load_dwordx4 v[116:119], v19, s[12:15], s70 offen offset:1024 sc1
s_waitcnt vmcnt(20)
L_o4_chk:
v_max3_u32 v2, v120, v124, v128
v_max_u32 v2, v2, v132
v_cmp_eq_u32 vcc, -1, v2
s_cbranch_vccnz L_o4_rt
L_o4_ok:
s_waitcnt lgkmcnt(0)
v_mfma_f32_16x16x32_bf16 v[24:27], a[0:3], v[120:123], v[24:27]
ds_read_b64_tr_b16 a[16:17], v12 offset:4096
v_mfma_f32_16x16x32_bf16 v[40:43], a[0:3], v[124:127], v[40:43]
ds_read_b64_tr_b16 a[18:19], v12 offset:6144
v_mfma_f32_16x16x32_bf16 v[28:31], a[4:7], v[120:123], v[28:31]
ds_read_b64_tr_b16 a[20:21], v13 offset:4096
v_mfma_f32_16x16x32_bf16 v[44:47], a[4:7], v[124:127], v[44:47]
ds_read_b64_tr_b16 a[22:23], v13 offset:6144
v_mfma_f32_16x16x32_bf16 v[32:35], a[8:11], v[120:123], v[32:35]
ds_read_b64_tr_b16 a[24:25], v14 offset:4096
v_mfma_f32_16x16x32_bf16 v[48:51], a[8:11], v[124:127], v[48:51]
ds_read_b64_tr_b16 a[26:27], v14 offset:6144
v_mfma_f32_16x16x32_bf16 v[36:39], a[12:15], v[120:123], v[36:39]
ds_read_b64_tr_b16 a[28:29], v15 offset:4096
v_mfma_f32_16x16x32_bf16 v[52:55], a[12:15], v[124:127], v[52:55]
ds_read_b64_tr_b16 a[30:31], v15 offset:6144
s_add_u32 s71, s65, 5
s_and_b32 s71, s71, 15
s_lshl_b32 s71, s71, 13
v_add_u32 v12, s71, v8
v_add_u32 v13, s71, v9
v_add_u32 v14, s71, v10
v_add_u32 v15, s71, v11
s_waitcnt lgkmcnt(0)
v_mfma_f32_16x16x32_bf16 v[24:27], a[16:19], v[128:131], v[24:27]
ds_read_b64_tr_b16 a[0:1], v12 offset:0
v_mfma_f32_16x16x32_bf16 v[40:43], a[16:19], v[132:135], v[40:43]
ds_read_b64_tr_b16 a[2:3], v12 offset:2048
v_mfma_f32_16x16x32_bf16 v[28:31], a[20:23], v[128:131], v[28:31]
ds_read_b64_tr_b16 a[4:5], v13 offset:0
v_mfma_f32_16x16x32_bf16 v[44:47], a[20:23], v[132:135], v[44:47]
ds_read_b64_tr_b16 a[6:7], v13 offset:2048
v_mfma_f32_16x16x32_bf16 v[32:35], a[24:27], v[128:131], v[32:35]
ds_read_b64_tr_b16 a[8:9], v14 offset:0
v_mfma_f32_16x16x32_bf16 v[48:51], a[24:27], v[132:135], v[48:51]
ds_read_b64_tr_b16 a[10:11], v14 offset:2048
v_mfma_f32_16x16x32_bf16 v[36:39], a[28:31], v[128:131], v[36:39]
ds_read_b64_tr_b16 a[12:13], v15 offset:0
v_mfma_f32_16x16x32_bf16 v[52:55], a[28:31], v[132:135], v[52:55]
ds_read_b64_tr_b16 a[14:15], v15 offset:2048
s_add_u32 s70, s65, 10
s_and_b32 s70, s70, 15
s_lshl_b32 s70, s70, 11
s_add_u32 s70, s70, s74
buffer_load_dwordx4 v[120:123], v16, s[12:15], s70 offen offset:0 sc1
buffer_load_dwordx4 v[124:127], v19, s[12:15], s70 offen offset:0 sc1
buffer_load_dwordx4 v[128:131], v16, s[12:15], s70 offen offset:1024 sc1
buffer_load_dwordx4 v[132:135], v19, s[12:15], s70 offen offset:1024 sc1
s_waitcnt vmcnt(20)
L_o5_chk:
v_max3_u32 v2, v136, v140, v144
v_max_u32 v2, v2, v148
v_cmp_eq_u32 vcc, -1, v2
s_cbranch_vccnz L_o5_rt
L_o5_ok:
s_waitcnt lgkmcnt(0)
v_mfma_f32_16x16x32_bf16 v[24:27], a[0:3], v[136:139], v[24:27]
ds_read_b64_tr_b16 a[16:17], v12 offset:4096
v_mfma_f32_16x16x32_bf16 v[40:43], a[0:3], v[140:143], v[40:43]
ds_read_b64_tr_b16 a[18:19], v12 offset:6144
v_mfma_f32_16x16x32_bf16 v[28:31], a[4:7], v[136:139], v[28:31]
ds_read_b64_tr_b16 a[20:21], v13 offset:4096
v_mfma_f32_16x16x32_bf16 v[44:47], a[4:7], v[140:143], v[44:47]
ds_read_b64_tr_b16 a[22:23], v13 offset:6144
v_mfma_f32_16x16x32_bf16 v[32:35], a[8:11], v[136:139], v[32:35]
ds_read_b64_tr_b16 a[24:25], v14 offset:4096
v_mfma_f32_16x16x32_bf16 v[48:51], a[8:11], v[140:143], v[48:51]
ds_read_b64_tr_b16 a[26:27], v14 offset:6144
v_mfma_f32_16x16x32_bf16 v[36:39], a[12:15], v[136:139], v[36:39]
ds_read_b64_tr_b16 a[28:29], v15 offset:4096
v_mfma_f32_16x16x32_bf16 v[52:55], a[12:15], v[140:143], v[52:55]
ds_read_b64_tr_b16 a[30:31], v15 offset:6144
s_add_u32 s71, s65, 6
s_and_b32 s71, s71, 15
s_lshl_b32 s71, s71, 13
v_add_u32 v12, s71, v8
v_add_u32 v13, s71, v9
v_add_u32 v14, s71, v10
v_add_u32 v15, s71, v11
s_waitcnt lgkmcnt(0)
v_mfma_f32_16x16x32_bf16 v[24:27], a[16:19], v[144:147], v[24:27]
ds_read_b64_tr_b16 a[0:1], v12 offset:0
v_mfma_f32_16x16x32_bf16 v[40:43], a[16:19], v[148:151], v[40:43]
ds_read_b64_tr_b16 a[2:3], v12 offset:2048
v_mfma_f32_16x16x32_bf16 v[28:31], a[20:23], v[144:147], v[28:31]
ds_read_b64_tr_b16 a[4:5], v13 offset:0
v_mfma_f32_16x16x32_bf16 v[44:47], a[20:23], v[148:151], v[44:47]
ds_read_b64_tr_b16 a[6:7], v13 offset:2048
v_mfma_f32_16x16x32_bf16 v[32:35], a[24:27], v[144:147], v[32:35]
ds_read_b64_tr_b16 a[8:9], v14 offset:0
v_mfma_f32_16x16x32_bf16 v[48:51], a[24:27], v[148:151], v[48:51]
ds_read_b64_tr_b16 a[10:11], v14 offset:2048
v_mfma_f32_16x16x32_bf16 v[36:39], a[28:31], v[144:147], v[36:39]
ds_read_b64_tr_b16 a[12:13], v15 offset:0
v_mfma_f32_16x16x32_bf16 v[52:55], a[28:31], v[148:151], v[52:55]
ds_read_b64_tr_b16 a[14:15], v15 offset:2048
s_add_u32 s70, s65, 11
s_and_b32 s70, s70, 15
s_lshl_b32 s70, s70, 11
s_add_u32 s70, s70, s74
buffer_load_dwordx4 v[136:139], v16, s[12:15], s70 offen offset:0 sc1
buffer_load_dwordx4 v[140:143], v19, s[12:15], s70 offen offset:0 sc1
buffer_load_dwordx4 v[144:147], v16, s[12:15], s70 offen offset:1024 sc1
buffer_load_dwordx4 v[148:151], v19, s[12:15], s70 offen offset:1024 sc1
s_waitcnt vmcnt(20)
L_o6_chk:
v_max3_u32 v2, v56, v60, v64
v_max_u32 v2, v2, v68
v_cmp_eq_u32 vcc, -1, v2
s_cbranch_vccnz L_o6_rt
L_o6_ok:
s_waitcnt lgkmcnt(0)
v_mfma_f32_16x16x32_bf16 v[24:27], a[0:3], v[56:59], v[24:27]
ds_read_b64_tr_b16 a[16:17], v12 offset:4096
v_mfma_f32_16x16x32_bf16 v[40:43], a[0:3], v[60:63], v[40:43]
ds_read_b64_tr_b16 a[18:19], v12 offset:6144
v_mfma_f32_16x16x32_bf16 v[28:31], a[4:7], v[56:59], v[28:31]
ds_read_b64_tr_b16 a[20:21], v13 offset:4096
v_mfma_f32_16x16x32_bf16 v[44:47], a[4:7], v[60:63], v[44:47]
ds_read_b64_tr_b16 a[22:23], v13 offset:6144
v_mfma_f32_16x16x32_bf16 v[32:35], a[8:11], v[56:59], v[32:35]
ds_read_b64_tr_b16 a[24:25], v14 offset:4096
v_mfma_f32_16x16x32_bf16 v[48:51], a[8:11], v[60:63], v[48:51]
ds_read_b64_tr_b16 a[26:27], v14 offset:6144
v_mfma_f32_16x16x32_bf16 v[36:39], a[12:15], v[56:59], v[36:39]
ds_read_b64_tr_b16 a[28:29], v15 offset:4096
v_mfma_f32_16x16x32_bf16 v[52:55], a[12:15], v[60:63], v[52:55]
ds_read_b64_tr_b16 a[30:31], v15 offset:6144
s_add_u32 s71, s65, 7
s_and_b32 s71, s71, 15
s_lshl_b32 s71, s71, 13
v_add_u32 v12, s71, v8
v_add_u32 v13, s71, v9
v_add_u32 v14, s71, v10
v_add_u32 v15, s71, v11
s_waitcnt lgkmcnt(0)
v_mfma_f32_16x16x32_bf16 v[24:27], a[16:19], v[64:67], v[24:27]
ds_read_b64_tr_b16 a[0:1], v12 offset:0
v_mfma_f32_16x16x32_bf16 v[40:43], a[16:19], v[68:71], v[40:43]
ds_read_b64_tr_b16 a[2:3], v12 offset:2048
v_mfma_f32_16x16x32_bf16 v[28:31], a[20:23], v[64:67], v[28:31]
ds_read_b64_tr_b16 a[4:5], v13 offset:0
v_mfma_f32_16x16x32_bf16 v[44:47], a[20:23], v[68:71], v[44:47]
ds_read_b64_tr_b16 a[6:7], v13 offset:2048
v_mfma_f32_16x16x32_bf16 v[32:35], a[24:27], v[64:67], v[32:35]
ds_read_b64_tr_b16 a[8:9], v14 offset:0
v_mfma_f32_16x16x32_bf16 v[48:51], a[24:27], v[68:71], v[48:51]
ds_read_b64_tr_b16 a[10:11], v14 offset:2048
v_mfma_f32_16x16x32_bf16 v[36:39], a[28:31], v[64:67], v[36:39]
ds_read_b64_tr_b16 a[12:13], v15 offset:0
v_mfma_f32_16x16x32_bf16 v[52:55], a[28:31], v[68:71], v[52:55]
ds_read_b64_tr_b16 a[14:15], v15 offset:2048
s_add_u32 s70, s65, 12
s_and_b32 s70, s70, 15
s_lshl_b32 s70, s70, 11
s_add_u32 s70, s70, s74
buffer_load_dwordx4 v[56:59], v16, s[12:15], s70 offen offset:0 sc1
buffer_load_dwordx4 v[60:63], v19, s[12:15], s70 offen offset:0 sc1
buffer_load_dwordx4 v[64:67], v16, s[12:15], s70 offen offset:1024 sc1
buffer_load_dwordx4 v[68:71], v19, s[12:15], s70 offen offset:1024 sc1
s_waitcnt vmcnt(20)
L_o7_chk:
v_max3_u32 v2, v72, v76, v80
v_max_u32 v2, v2, v84
v_cmp_eq_u32 vcc, -1, v2
s_cbranch_vccnz L_o7_rt
L_o7_ok:
s_waitcnt lgkmcnt(0)
v_mfma_f32_16x16x32_bf16 v[24:27], a[0:3], v[72:75], v[24:27]
ds_read_b64_tr_b16 a[16:17], v12 offset:4096
v_mfma_f32_16x16x32_bf16 v[40:43], a[0:3], v[76:79], v[40:43]
ds_read_b64_tr_b16 a[18:19], v12 offset:6144
v_mfma_f32_16x16x32_bf16 v[28:31], a[4:7], v[72:75], v[28:31]
ds_read_b64_tr_b16 a[20:21], v13 offset:4096
v_mfma_f32_16x16x32_bf16 v[44:47], a[4:7], v[76:79], v[44:47]
ds_read_b64_tr_b16 a[22:23], v13 offset:6144
v_mfma_f32_16x16x32_bf16 v[32:35], a[8:11], v[72:75], v[32:35]
ds_read_b64_tr_b16 a[24:25], v14 offset:4096
v_mfma_f32_16x16x32_bf16 v[48:51], a[8:11], v[76:79], v[48:51]
ds_read_b64_tr_b16 a[26:27], v14 offset:6144
v_mfma_f32_16x16x32_bf16 v[36:39], a[12:15], v[72:75], v[36:39]
ds_read_b64_tr_b16 a[28:29], v15 offset:4096
v_mfma_f32_16x16x32_bf16 v[52:55], a[12:15], v[76:79], v[52:55]
ds_read_b64_tr_b16 a[30:31], v15 offset:6144
s_add_u32 s71, s65, 8
s_and_b32 s71, s71, 15
s_lshl_b32 s71, s71, 13
v_add_u32 v12, s71, v8
v_add_u32 v13, s71, v9
v_add_u32 v14, s71, v10
v_add_u32 v15, s71, v11
s_waitcnt lgkmcnt(0)
v_mfma_f32_16x16x32_bf16 v[24:27], a[16:19], v[80:83], v[24:27]
ds_read_b64_tr_b16 a[0:1], v12 offset:0
v_mfma_f32_16x16x32_bf16 v[40:43], a[16:19], v[84:87], v[40:43]
ds_read_b64_tr_b16 a[2:3], v12 offset:2048
v_mfma_f32_16x16x32_bf16 v[28:31], a[20:23], v[80:83], v[28:31]
ds_read_b64_tr_b16 a[4:5], v13 offset:0
v_mfma_f32_16x16x32_bf16 v[44:47], a[20:23], v[84:87], v[44:47]
ds_read_b64_tr_b16 a[6:7], v13 offset:2048
v_mfma_f32_16x16x32_bf16 v[32:35], a[24:27], v[80:83], v[32:35]
ds_read_b64_tr_b16 a[8:9], v14 offset:0
v_mfma_f32_16x16x32_bf16 v[48:51], a[24:27], v[84:87], v[48:51]
ds_read_b64_tr_b16 a[10:11], v14 offset:2048
v_mfma_f32_16x16x32_bf16 v[36:39], a[28:31], v[80:83], v[36:39]
ds_read_b64_tr_b16 a[12:13], v15 offset:0
v_mfma_f32_16x16x32_bf16 v[52:55], a[28:31], v[84:87], v[52:55]
ds_read_b64_tr_b16 a[14:15], v15 offset:2048
s_add_u32 s70, s65, 13
s_and_b32 s70, s70, 15
s_lshl_b32 s70, s70, 11
s_add_u32 s70, s70, s74
buffer_load_dwordx4 v[72:75], v16, s[12:15], s70 offen offset:0 sc1
buffer_load_dwordx4 v[76:79], v19, s[12:15], s70 offen offset:0 sc1
buffer_load_dwordx4 v[80:83], v16, s[12:15], s70 offen offset:1024 sc1
buffer_load_dwordx4 v[84:87], v19, s[12:15], s70 offen offset:1024 sc1
s_waitcnt vmcnt(20)
L_o8_chk:
v_max3_u32 v2, v88, v92, v96
v_max_u32 v2, v2, v100
v_cmp_eq_u32 vcc, -1, v2
s_cbranch_vccnz L_o8_rt
L_o8_ok:
s_waitcnt lgkmcnt(0)
v_mfma_f32_16x16x32_bf16 v[24:27], a[0:3], v[88:91], v[24:27]
ds_read_b64_tr_b16 a[16:17], v12 offset:4096
v_mfma_f32_16x16x32_bf16 v[40:43], a[0:3], v[92:95], v[40:43]
ds_read_b64_tr_b16 a[18:19], v12 offset:6144
v_mfma_f32_16x16x32_bf16 v[28:31], a[4:7], v[88:91], v[28:31]
ds_read_b64_tr_b16 a[20:21], v13 offset:4096
v_mfma_f32_16x16x32_bf16 v[44:47], a[4:7], v[92:95], v[44:47]
ds_read_b64_tr_b16 a[22:23], v13 offset:6144
v_mfma_f32_16x16x32_bf16 v[32:35], a[8:11], v[88:91], v[32:35]
ds_read_b64_tr_b16 a[24:25], v14 offset:4096
v_mfma_f32_16x16x32_bf16 v[48:51], a[8:11], v[92:95], v[48:51]
ds_read_b64_tr_b16 a[26:27], v14 offset:6144
v_mfma_f32_16x16x32_bf16 v[36:39], a[12:15], v[88:91], v[36:39]
ds_read_b64_tr_b16 a[28:29], v15 offset:4096
v_mfma_f32_16x16x32_bf16 v[52:55], a[12:15], v[92:95], v[52:55]
ds_read_b64_tr_b16 a[30:31], v15 offset:6144
s_add_u32 s71, s65, 9
s_and_b32 s71, s71, 15
s_lshl_b32 s71, s71, 13
v_add_u32 v12, s71, v8
v_add_u32 v13, s71, v9
v_add_u32 v14, s71, v10
v_add_u32 v15, s71, v11
s_waitcnt lgkmcnt(0)
v_mfma_f32_16x16x32_bf16 v[24:27], a[16:19], v[96:99], v[24:27]
ds_read_b64_tr_b16 a[0:1], v12 offset:0
v_mfma_f32_16x16x32_bf16 v[40:43], a[16:19], v[100:103], v[40:43]
ds_read_b64_tr_b16 a[2:3], v12 offset:2048
v_mfma_f32_16x16x32_bf16 v[28:31], a[20:23], v[96:99], v[28:31]
ds_read_b64_tr_b16 a[4:5], v13 offset:0
v_mfma_f32_16x16x32_bf16 v[44:47], a[20:23], v[100:103], v[44:47]
ds_read_b64_tr_b16 a[6:7], v13 offset:2048
v_mfma_f32_16x16x32_bf16 v[32:35], a[24:27], v[96:99], v[32:35]
ds_read_b64_tr_b16 a[8:9], v14 offset:0
v_mfma_f32_16x16x32_bf16 v[48:51], a[24:27], v[100:103], v[48:51]
ds_read_b64_tr_b16 a[10:11], v14 offset:2048
v_mfma_f32_16x16x32_bf16 v[36:39], a[28:31], v[96:99], v[36:39]
ds_read_b64_tr_b16 a[12:13], v15 offset:0
v_mfma_f32_16x16x32_bf16 v[52:55], a[28:31], v[100:103], v[52:55]
ds_read_b64_tr_b16 a[14:15], v15 offset:2048
s_add_u32 s70, s65, 14
s_and_b32 s70, s70, 15
s_lshl_b32 s70, s70, 11
s_add_u32 s70, s70, s74
buffer_load_dwordx4 v[88:91], v16, s[12:15], s70 offen offset:0 sc1
buffer_load_dwordx4 v[92:95], v19, s[12:15], s70 offen offset:0 sc1
buffer_load_dwordx4 v[96:99], v16, s[12:15], s70 offen offset:1024 sc1
buffer_load_dwordx4 v[100:103], v19, s[12:15], s70 offen offset:1024 sc1
s_waitcnt vmcnt(20)
L_o9_chk:
v_max3_u32 v2, v104, v108, v112
v_max_u32 v2, v2, v116
v_cmp_eq_u32 vcc, -1, v2
s_cbranch_vccnz L_o9_rt
L_o9_ok:
s_waitcnt lgkmcnt(0)
v_mfma_f32_16x16x32_bf16 v[24:27], a[0:3], v[104:107], v[24:27]
ds_read_b64_tr_b16 a[16:17], v12 offset:4096
v_mfma_f32_16x16x32_bf16 v[40:43], a[0:3], v[108:111], v[40:43]
ds_read_b64_tr_b16 a[18:19], v12 offset:6144
v_mfma_f32_16x16x32_bf16 v[28:31], a[4:7], v[104:107], v[28:31]
ds_read_b64_tr_b16 a[20:21], v13 offset:4096
v_mfma_f32_16x16x32_bf16 v[44:47], a[4:7], v[108:111], v[44:47]
ds_read_b64_tr_b16 a[22:23], v13 offset:6144
v_mfma_f32_16x16x32_bf16 v[32:35], a[8:11], v[104:107], v[32:35]
ds_read_b64_tr_b16 a[24:25], v14 offset:4096
v_mfma_f32_16x16x32_bf16 v[48:51], a[8:11], v[108:111], v[48:51]
ds_read_b64_tr_b16 a[26:27], v14 offset:6144
v_mfma_f32_16x16x32_bf16 v[36:39], a[12:15], v[104:107], v[36:39]
ds_read_b64_tr_b16 a[28:29], v15 offset:4096
v_mfma_f32_16x16x32_bf16 v[52:55], a[12:15], v[108:111], v[52:55]
ds_read_b64_tr_b16 a[30:31], v15 offset:6144
s_add_u32 s71, s65, 10
s_and_b32 s71, s71, 15
s_lshl_b32 s71, s71, 13
v_add_u32 v12, s71, v8
v_add_u32 v13, s71, v9
v_add_u32 v14, s71, v10
v_add_u32 v15, s71, v11
s_waitcnt lgkmcnt(0)
v_mfma_f32_16x16x32_bf16 v[24:27], a[16:19], v[112:115], v[24:27]
ds_read_b64_tr_b16 a[0:1], v12 offset:0
v_mfma_f32_16x16x32_bf16 v[40:43], a[16:19], v[116:119], v[40:43]
ds_read_b64_tr_b16 a[2:3], v12 offset:2048
v_mfma_f32_16x16x32_bf16 v[28:31], a[20:23], v[112:115], v[28:31]
ds_read_b64_tr_b16 a[4:5], v13 offset:0
v_mfma_f32_16x16x32_bf16 v[44:47], a[20:23], v[116:119], v[44:47]
ds_read_b64_tr_b16 a[6:7], v13 offset:2048
v_mfma_f32_16x16x32_bf16 v[32:35], a[24:27], v[112:115], v[32:35]
ds_read_b64_tr_b16 a[8:9], v14 offset:0
v_mfma_f32_16x16x32_bf16 v[48:51], a[24:27], v[116:119], v[48:51]
ds_read_b64_tr_b16 a[10:11], v14 offset:2048
v_mfma_f32_16x16x32_bf16 v[36:39], a[28:31], v[112:115], v[36:39]
ds_read_b64_tr_b16 a[12:13], v15 offset:0
v_mfma_f32_16x16x32_bf16 v[52:55], a[28:31], v[116:119], v[52:55]
ds_read_b64_tr_b16 a[14:15], v15 offset:2048
s_add_u32 s70, s65, 15
s_and_b32 s70, s70, 15
s_lshl_b32 s70, s70, 11
s_add_u32 s70, s70, s74
buffer_load_dwordx4 v[104:107], v16, s[12:15], s70 offen offset:0 sc1
buffer_load_dwordx4 v[108:111], v19, s[12:15], s70 offen offset:0 sc1
buffer_load_dwordx4 v[112:115], v16, s[12:15], s70 offen offset:1024 sc1
buffer_load_dwordx4 v[116:119], v19, s[12:15], s70 offen offset:1024 sc1
s_waitcnt vmcnt(20)
L_o10_chk:
v_max3_u32 v2, v120, v124, v128
v_max_u32 v2, v2, v132
v_cmp_eq_u32 vcc, -1, v2
s_cbranch_vccnz L_o10_rt
L_o10_ok:
s_waitcnt lgkmcnt(0)
v_mfma_f32_16x16x32_bf16 v[24:27], a[0:3], v[120:123], v[24:27]
ds_read_b64_tr_b16 a[16:17], v12 offset:4096
v_mfma_f32_16x16x32_bf16 v[40:43], a[0:3], v[124:127], v[40:43]
ds_read_b64_tr_b16 a[18:19], v12 offset:6144
v_mfma_f32_16x16x32_bf16 v[28:31], a[4:7], v[120:123], v[28:31]
ds_read_b64_tr_b16 a[20:21], v13 offset:4096
v_mfma_f32_16x16x32_bf16 v[44:47], a[4:7], v[124:127], v[44:47]
ds_read_b64_tr_b16 a[22:23], v13 offset:6144
v_mfma_f32_16x16x32_bf16 v[32:35], a[8:11], v[120:123], v[32:35]
ds_read_b64_tr_b16 a[24:25], v14 offset:4096
v_mfma_f32_16x16x32_bf16 v[48:51], a[8:11], v[124:127], v[48:51]
ds_read_b64_tr_b16 a[26:27], v14 offset:6144
v_mfma_f32_16x16x32_bf16 v[36:39], a[12:15], v[120:123], v[36:39]
ds_read_b64_tr_b16 a[28:29], v15 offset:4096
v_mfma_f32_16x16x32_bf16 v[52:55], a[12:15], v[124:127], v[52:55]
ds_read_b64_tr_b16 a[30:31], v15 offset:6144
s_add_u32 s71, s65, 11
s_and_b32 s71, s71, 15
s_lshl_b32 s71, s71, 13
v_add_u32 v12, s71, v8
v_add_u32 v13, s71, v9
v_add_u32 v14, s71, v10
v_add_u32 v15, s71, v11
s_waitcnt lgkmcnt(0)
v_mfma_f32_16x16x32_bf16 v[24:27], a[16:19], v[128:131], v[24:27]
ds_read_b64_tr_b16 a[0:1], v12 offset:0
v_mfma_f32_16x16x32_bf16 v[40:43], a[16:19], v[132:135], v[40:43]
ds_read_b64_tr_b16 a[2:3], v12 offset:2048
v_mfma_f32_16x16x32_bf16 v[28:31], a[20:23], v[128:131], v[28:31]
ds_read_b64_tr_b16 a[4:5], v13 offset:0
v_mfma_f32_16x16x32_bf16 v[44:47], a[20:23], v[132:135], v[44:47]
ds_read_b64_tr_b16 a[6:7], v13 offset:2048
v_mfma_f32_16x16x32_bf16 v[32:35], a[24:27], v[128:131], v[32:35]
ds_read_b64_tr_b16 a[8:9], v14 offset:0
v_mfma_f32_16x16x32_bf16 v[48:51], a[24:27], v[132:135], v[48:51]
ds_read_b64_tr_b16 a[10:11], v14 offset:2048
v_mfma_f32_16x16x32_bf16 v[36:39], a[28:31], v[128:131], v[36:39]
ds_read_b64_tr_b16 a[12:13], v15 offset:0
v_mfma_f32_16x16x32_bf16 v[52:55], a[28:31], v[132:135], v[52:55]
ds_read_b64_tr_b16 a[14:15], v15 offset:2048
s_waitcnt vmcnt(16)
L_o11_chk:
v_max3_u32 v2, v136, v140, v144
v_max_u32 v2, v2, v148
v_cmp_eq_u32 vcc, -1, v2
s_cbranch_vccnz L_o11_rt
L_o11_ok:
s_waitcnt lgkmcnt(0)
v_mfma_f32_16x16x32_bf16 v[24:27], a[0:3], v[136:139], v[24:27]
ds_read_b64_tr_b16 a[16:17], v12 offset:4096
v_mfma_f32_16x16x32_bf16 v[40:43], a[0:3], v[140:143], v[40:43]
ds_read_b64_tr_b16 a[18:19], v12 offset:6144
v_mfma_f32_16x16x32_bf16 v[28:31], a[4:7], v[136:139], v[28:31]
ds_read_b64_tr_b16 a[20:21], v13 offset:4096
v_mfma_f32_16x16x32_bf16 v[44:47], a[4:7], v[140:143], v[44:47]
ds_read_b64_tr_b16 a[22:23], v13 offset:6144
v_mfma_f32_16x16x32_bf16 v[32:35], a[8:11], v[136:139], v[32:35]
ds_read_b64_tr_b16 a[24:25], v14 offset:4096
v_mfma_f32_16x16x32_bf16 v[48:51], a[8:11], v[140:143], v[48:51]
ds_read_b64_tr_b16 a[26:27], v14 offset:6144
v_mfma_f32_16x16x32_bf16 v[36:39], a[12:15], v[136:139], v[36:39]
ds_read_b64_tr_b16 a[28:29], v15 offset:4096
v_mfma_f32_16x16x32_bf16 v[52:55], a[12:15], v[140:143], v[52:55]
ds_read_b64_tr_b16 a[30:31], v15 offset:6144
s_add_u32 s71, s65, 12
s_and_b32 s71, s71, 15
s_lshl_b32 s71, s71, 13
v_add_u32 v12, s71, v8
v_add_u32 v13, s71, v9
v_add_u32 v14, s71, v10
v_add_u32 v15, s71, v11
s_waitcnt lgkmcnt(0)
v_mfma_f32_16x16x32_bf16 v[24:27], a[16:19], v[144:147], v[24:27]
ds_read_b64_tr_b16 a[0:1], v12 offset:0
v_mfma_f32_16x16x32_bf16 v[40:43], a[16:19], v[148:151], v[40:43]
ds_read_b64_tr_b16 a[2:3], v12 offset:2048
v_mfma_f32_16x16x32_bf16 v[28:31], a[20:23], v[144:147], v[28:31]
ds_read_b64_tr_b16 a[4:5], v13 offset:0
v_mfma_f32_16x16x32_bf16 v[44:47], a[20:23], v[148:151], v[44:47]
ds_read_b64_tr_b16 a[6:7], v13 offset:2048
v_mfma_f32_16x16x32_bf16 v[32:35], a[24:27], v[144:147], v[32:35]
ds_read_b64_tr_b16 a[8:9], v14 offset:0
v_mfma_f32_16x16x32_bf16 v[48:51], a[24:27], v[148:151], v[48:51]
ds_read_b64_tr_b16 a[10:11], v14 offset:2048
v_mfma_f32_16x16x32_bf16 v[36:39], a[28:31], v[144:147], v[36:39]
ds_read_b64_tr_b16 a[12:13], v15 offset:0
v_mfma_f32_16x16x32_bf16 v[52:55], a[28:31], v[148:151], v[52:55]
ds_read_b64_tr_b16 a[14:15], v15 offset:2048
s_waitcnt vmcnt(12)
L_o12_chk:
v_max3_u32 v2, v56, v60, v64
v_max_u32 v2, v2, v68
v_cmp_eq_u32 vcc, -1, v2
s_cbranch_vccnz L_o12_rt
L_o12_ok:
s_waitcnt lgkmcnt(0)
v_mfma_f32_16x16x32_bf16 v[24:27], a[0:3], v[56:59], v[24:27]
ds_read_b64_tr_b16 a[16:17], v12 offset:4096
v_mfma_f32_16x16x32_bf16 v[40:43], a[0:3], v[60:63], v[40:43]
ds_read_b64_tr_b16 a[18:19], v12 offset:6144
v_mfma_f32_16x16x32_bf16 v[28:31], a[4:7], v[56:59], v[28:31]
ds_read_b64_tr_b16 a[20:21], v13 offset:4096
v_mfma_f32_16x16x32_bf16 v[44:47], a[4:7], v[60:63], v[44:47]
ds_read_b64_tr_b16 a[22:23], v13 offset:6144
v_mfma_f32_16x16x32_bf16 v[32:35], a[8:11], v[56:59], v[32:35]
ds_read_b64_tr_b16 a[24:25], v14 offset:4096
v_mfma_f32_16x16x32_bf16 v[48:51], a[8:11], v[60:63], v[48:51]
ds_read_b64_tr_b16 a[26:27], v14 offset:6144
v_mfma_f32_16x16x32_bf16 v[36:39], a[12:15], v[56:59], v[36:39]
ds_read_b64_tr_b16 a[28:29], v15 offset:4096
v_mfma_f32_16x16x32_bf16 v[52:55], a[12:15], v[60:63], v[52:55]
ds_read_b64_tr_b16 a[30:31], v15 offset:6144
s_add_u32 s71, s65, 13
s_and_b32 s71, s71, 15
s_lshl_b32 s71, s71, 13
v_add_u32 v12, s71, v8
v_add_u32 v13, s71, v9
v_add_u32 v14, s71, v10
v_add_u32 v15, s71, v11
s_waitcnt lgkmcnt(0)
v_mfma_f32_16x16x32_bf16 v[24:27], a[16:19], v[64:67], v[24:27]
ds_read_b64_tr_b16 a[0:1], v12 offset:0
v_mfma_f32_16x16x32_bf16 v[40:43], a[16:19], v[68:71], v[40:43]
ds_read_b64_tr_b16 a[2:3], v12 offset:2048
v_mfma_f32_16x16x32_bf16 v[28:31], a[20:23], v[64:67], v[28:31]
ds_read_b64_tr_b16 a[4:5], v13 offset:0
v_mfma_f32_16x16x32_bf16 v[44:47], a[20:23], v[68:71], v[44:47]
ds_read_b64_tr_b16 a[6:7], v13 offset:2048
v_mfma_f32_16x16x32_bf16 v[32:35], a[24:27], v[64:67], v[32:35]
ds_read_b64_tr_b16 a[8:9], v14 offset:0
v_mfma_f32_16x16x32_bf16 v[48:51], a[24:27], v[68:71], v[48:51]
ds_read_b64_tr_b16 a[10:11], v14 offset:2048
v_mfma_f32_16x16x32_bf16 v[36:39], a[28:31], v[64:67], v[36:39]
ds_read_b64_tr_b16 a[12:13], v15 offset:0
v_mfma_f32_16x16x32_bf16 v[52:55], a[28:31], v[68:71], v[52:55]
ds_read_b64_tr_b16 a[14:15], v15 offset:2048
s_waitcnt vmcnt(8)
L_o13_chk:
v_max3_u32 v2, v72, v76, v80
v_max_u32 v2, v2, v84
v_cmp_eq_u32 vcc, -1, v2
s_cbranch_vccnz L_o13_rt
L_o13_ok:
s_waitcnt lgkmcnt(0)
v_mfma_f32_16x16x32_bf16 v[24:27], a[0:3], v[72:75], v[24:27]
ds_read_b64_tr_b16 a[16:17], v12 offset:4096
v_mfma_f32_16x16x32_bf16 v[40:43], a[0:3], v[76:79], v[40:43]
ds_read_b64_tr_b16 a[18:19], v12 offset:6144
v_mfma_f32_16x16x32_bf16 v[28:31], a[4:7], v[72:75], v[28:31]
ds_read_b64_tr_b16 a[20:21], v13 offset:4096
v_mfma_f32_16x16x32_bf16 v[44:47], a[4:7], v[76:79], v[44:47]
ds_read_b64_tr_b16 a[22:23], v13 offset:6144
v_mfma_f32_16x16x32_bf16 v[32:35], a[8:11], v[72:75], v[32:35]
ds_read_b64_tr_b16 a[24:25], v14 offset:4096
v_mfma_f32_16x16x32_bf16 v[48:51], a[8:11], v[76:79], v[48:51]
ds_read_b64_tr_b16 a[26:27], v14 offset:6144
v_mfma_f32_16x16x32_bf16 v[36:39], a[12:15], v[72:75], v[36:39]
ds_read_b64_tr_b16 a[28:29], v15 offset:4096
v_mfma_f32_16x16x32_bf16 v[52:55], a[12:15], v[76:79], v[52:55]
ds_read_b64_tr_b16 a[30:31], v15 offset:6144
s_add_u32 s71, s65, 14
s_and_b32 s71, s71, 15
s_lshl_b32 s71, s71, 13
v_add_u32 v12, s71, v8
v_add_u32 v13, s71, v9
v_add_u32 v14, s71, v10
v_add_u32 v15, s71, v11
s_waitcnt lgkmcnt(0)
v_mfma_f32_16x16x32_bf16 v[24:27], a[16:19], v[80:83], v[24:27]
ds_read_b64_tr_b16 a[0:1], v12 offset:0
v_mfma_f32_16x16x32_bf16 v[40:43], a[16:19], v[84:87], v[40:43]
ds_read_b64_tr_b16 a[2:3], v12 offset:2048
v_mfma_f32_16x16x32_bf16 v[28:31], a[20:23], v[80:83], v[28:31]
ds_read_b64_tr_b16 a[4:5], v13 offset:0
v_mfma_f32_16x16x32_bf16 v[44:47], a[20:23], v[84:87], v[44:47]
ds_read_b64_tr_b16 a[6:7], v13 offset:2048
v_mfma_f32_16x16x32_bf16 v[32:35], a[24:27], v[80:83], v[32:35]
ds_read_b64_tr_b16 a[8:9], v14 offset:0
v_mfma_f32_16x16x32_bf16 v[48:51], a[24:27], v[84:87], v[48:51]
ds_read_b64_tr_b16 a[10:11], v14 offset:2048
v_mfma_f32_16x16x32_bf16 v[36:39], a[28:31], v[80:83], v[36:39]
ds_read_b64_tr_b16 a[12:13], v15 offset:0
v_mfma_f32_16x16x32_bf16 v[52:55], a[28:31], v[84:87], v[52:55]
ds_read_b64_tr_b16 a[14:15], v15 offset:2048
s_waitcnt vmcnt(4)
L_o14_chk:
v_max3_u32 v2, v88, v92, v96
v_max_u32 v2, v2, v100
v_cmp_eq_u32 vcc, -1, v2
s_cbranch_vccnz L_o14_rt
L_o14_ok:
s_waitcnt lgkmcnt(0)
v_mfma_f32_16x16x32_bf16 v[24:27], a[0:3], v[88:91], v[24:27]
ds_read_b64_tr_b16 a[16:17], v12 offset:4096
v_mfma_f32_16x16x32_bf16 v[40:43], a[0:3], v[92:95], v[40:43]
ds_read_b64_tr_b16 a[18:19], v12 offset:6144
v_mfma_f32_16x16x32_bf16 v[28:31], a[4:7], v[88:91], v[28:31]
ds_read_b64_tr_b16 a[20:21], v13 offset:4096
v_mfma_f32_16x16x32_bf16 v[44:47], a[4:7], v[92:95], v[44:47]
ds_read_b64_tr_b16 a[22:23], v13 offset:6144
v_mfma_f32_16x16x32_bf16 v[32:35], a[8:11], v[88:91], v[32:35]
ds_read_b64_tr_b16 a[24:25], v14 offset:4096
v_mfma_f32_16x16x32_bf16 v[48:51], a[8:11], v[92:95], v[48:51]
ds_read_b64_tr_b16 a[26:27], v14 offset:6144
v_mfma_f32_16x16x32_bf16 v[36:39], a[12:15], v[88:91], v[36:39]
ds_read_b64_tr_b16 a[28:29], v15 offset:4096
v_mfma_f32_16x16x32_bf16 v[52:55], a[12:15], v[92:95], v[52:55]
ds_read_b64_tr_b16 a[30:31], v15 offset:6144
s_add_u32 s71, s65, 15
s_and_b32 s71, s71, 15
s_lshl_b32 s71, s71, 13
v_add_u32 v12, s71, v8
v_add_u32 v13, s71, v9
v_add_u32 v14, s71, v10
v_add_u32 v15, s71, v11
s_waitcnt lgkmcnt(0)
v_mfma_f32_16x16x32_bf16 v[24:27], a[16:19], v[96:99], v[24:27]
ds_read_b64_tr_b16 a[0:1], v12 offset:0
v_mfma_f32_16x16x32_bf16 v[40:43], a[16:19], v[100:103], v[40:43]
ds_read_b64_tr_b16 a[2:3], v12 offset:2048
v_mfma_f32_16x16x32_bf16 v[28:31], a[20:23], v[96:99], v[28:31]
ds_read_b64_tr_b16 a[4:5], v13 offset:0
v_mfma_f32_16x16x32_bf16 v[44:47], a[20:23], v[100:103], v[44:47]
ds_read_b64_tr_b16 a[6:7], v13 offset:2048
v_mfma_f32_16x16x32_bf16 v[32:35], a[24:27], v[96:99], v[32:35]
ds_read_b64_tr_b16 a[8:9], v14 offset:0
v_mfma_f32_16x16x32_bf16 v[48:51], a[24:27], v[100:103], v[48:51]
ds_read_b64_tr_b16 a[10:11], v14 offset:2048
v_mfma_f32_16x16x32_bf16 v[36:39], a[28:31], v[96:99], v[36:39]
ds_read_b64_tr_b16 a[12:13], v15 offset:0
v_mfma_f32_16x16x32_bf16 v[52:55], a[28:31], v[100:103], v[52:55]
ds_read_b64_tr_b16 a[14:15], v15 offset:2048
s_waitcnt vmcnt(0)
L_o15_chk:
v_max3_u32 v2, v104, v108, v112
v_max_u32 v2, v2, v116
v_cmp_eq_u32 vcc, -1, v2
s_cbranch_vccnz L_o15_rt
L_o15_ok:
s_waitcnt lgkmcnt(0)
v_mfma_f32_16x16x32_bf16 v[24:27], a[0:3], v[104:107], v[24:27]
ds_read_b64_tr_b16 a[16:17], v12 offset:4096
v_mfma_f32_16x16x32_bf16 v[40:43], a[0:3], v[108:111], v[40:43]
ds_read_b64_tr_b16 a[18:19], v12 offset:6144
v_mfma_f32_16x16x32_bf16 v[28:31], a[4:7], v[104:107], v[28:31]
ds_read_b64_tr_b16 a[20:21], v13 offset:4096
v_mfma_f32_16x16x32_bf16 v[44:47], a[4:7], v[108:111], v[44:47]
ds_read_b64_tr_b16 a[22:23], v13 offset:6144
v_mfma_f32_16x16x32_bf16 v[32:35], a[8:11], v[104:107], v[32:35]
ds_read_b64_tr_b16 a[24:25], v14 offset:4096
v_mfma_f32_16x16x32_bf16 v[48:51], a[8:11], v[108:111], v[48:51]
ds_read_b64_tr_b16 a[26:27], v14 offset:6144
v_mfma_f32_16x16x32_bf16 v[36:39], a[12:15], v[104:107], v[36:39]
ds_read_b64_tr_b16 a[28:29], v15 offset:4096
v_mfma_f32_16x16x32_bf16 v[52:55], a[12:15], v[108:111], v[52:55]
ds_read_b64_tr_b16 a[30:31], v15 offset:6144
s_waitcnt lgkmcnt(0)
v_mfma_f32_16x16x32_bf16 v[24:27], a[16:19], v[112:115], v[24:27]
v_mfma_f32_16x16x32_bf16 v[40:43], a[16:19], v[116:119], v[40:43]
v_mfma_f32_16x16x32_bf16 v[28:31], a[20:23], v[112:115], v[28:31]
v_mfma_f32_16x16x32_bf16 v[44:47], a[20:23], v[116:119], v[44:47]
v_mfma_f32_16x16x32_bf16 v[32:35], a[24:27], v[112:115], v[32:35]
v_mfma_f32_16x16x32_bf16 v[48:51], a[24:27], v[116:119], v[48:51]
v_mfma_f32_16x16x32_bf16 v[36:39], a[28:31], v[112:115], v[36:39]
v_mfma_f32_16x16x32_bf16 v[52:55], a[28:31], v[116:119], v[52:55]
s_barrier
v_accvgpr_read_b32 v88, a96
v_accvgpr_read_b32 v89, a97
v_accvgpr_read_b32 v90, a98
v_accvgpr_read_b32 v91, a99
v_accvgpr_read_b32 v92, a100
v_accvgpr_read_b32 v93, a101
v_accvgpr_read_b32 v94, a102
v_accvgpr_read_b32 v95, a103
v_lshlrev_b32 v56, 16, v88
v_and_b32 v57, 0xffff0000, v88
v_lshlrev_b32 v58, 16, v89
v_and_b32 v59, 0xffff0000, v89
v_lshlrev_b32 v60, 16, v90
v_and_b32 v61, 0xffff0000, v90
v_lshlrev_b32 v62, 16, v91
v_and_b32 v63, 0xffff0000, v91
v_lshlrev_b32 v64, 16, v92
v_and_b32 v65, 0xffff0000, v92
v_lshlrev_b32 v66, 16, v93
v_and_b32 v67, 0xffff0000, v93
v_lshlrev_b32 v68, 16, v94
v_and_b32 v69, 0xffff0000, v94
v_lshlrev_b32 v70, 16, v95
v_and_b32 v71, 0xffff0000, v95
v_pk_add_f32 v[72:73], v[24:25], v[26:27]
v_pk_mul_f32 v[74:75], v[24:25], v[24:25]
v_pk_mul_f32 v[76:77], v[24:25], v[56:57]
v_pk_fma_f32 v[74:75], v[26:27], v[26:27], v[74:75]
v_pk_fma_f32 v[76:77], v[26:27], v[58:59], v[76:77]
v_pk_add_f32 v[72:73], v[72:73], v[28:29]
v_pk_fma_f32 v[74:75], v[28:29], v[28:29], v[74:75]
v_pk_fma_f32 v[76:77], v[28:29], v[60:61], v[76:77]
v_pk_add_f32 v[72:73], v[72:73], v[30:31]
v_pk_fma_f32 v[74:75], v[30:31], v[30:31], v[74:75]
v_pk_fma_f32 v[76:77], v[30:31], v[62:63], v[76:77]
v_pk_add_f32 v[72:73], v[72:73], v[32:33]
v_pk_fma_f32 v[74:75], v[32:33], v[32:33], v[74:75]
v_pk_fma_f32 v[76:77], v[32:33], v[64:65], v[76:77]
v_pk_add_f32 v[72:73], v[72:73], v[34:35]
v_pk_fma_f32 v[74:75], v[34:35], v[34:35], v[74:75]
v_pk_fma_f32 v[76:77], v[34:35], v[66:67], v[76:77]
v_pk_add_f32 v[72:73], v[72:73], v[36:37]
v_pk_fma_f32 v[74:75], v[36:37], v[36:37], v[74:75]
v_pk_fma_f32 v[76:77], v[36:37], v[68:69], v[76:77]
v_pk_add_f32 v[72:73], v[72:73], v[38:39]
v_pk_fma_f32 v[74:75], v[38:39], v[38:39], v[74:75]
v_pk_fma_f32 v[76:77], v[38:39], v[70:71], v[76:77]
v_add_f32 v72, v72, v73
v_add_f32 v73, v74, v75
v_add_f32 v74, v76, v77
v_pk_add_f32 v[80:81], v[40:41], v[42:43]
v_pk_mul_f32 v[82:83], v[40:41], v[40:41]
v_pk_mul_f32 v[84:85], v[40:41], v[56:57]
v_pk_fma_f32 v[82:83], v[42:43], v[42:43], v[82:83]
v_pk_fma_f32 v[84:85], v[42:43], v[58:59], v[84:85]
v_pk_add_f32 v[80:81], v[80:81], v[44:45]
v_pk_fma_f32 v[82:83], v[44:45], v[44:45], v[82:83]
v_pk_fma_f32 v[84:85], v[44:45], v[60:61], v[84:85]
v_pk_add_f32 v[80:81], v[80:81], v[46:47]
v_pk_fma_f32 v[82:83], v[46:47], v[46:47], v[82:83]
v_pk_fma_f32 v[84:85], v[46:47], v[62:63], v[84:85]
v_pk_add_f32 v[80:81], v[80:81], v[48:49]
v_pk_fma_f32 v[82:83], v[48:49], v[48:49], v[82:83]
v_pk_fma_f32 v[84:85], v[48:49], v[64:65], v[84:85]
v_pk_add_f32 v[80:81], v[80:81], v[50:51]
v_pk_fma_f32 v[82:83], v[50:51], v[50:51], v[82:83]
v_pk_fma_f32 v[84:85], v[50:51], v[66:67], v[84:85]
v_pk_add_f32 v[80:81], v[80:81], v[52:53]
v_pk_fma_f32 v[82:83], v[52:53], v[52:53], v[82:83]
v_pk_fma_f32 v[84:85], v[52:53], v[68:69], v[84:85]
v_pk_add_f32 v[80:81], v[80:81], v[54:55]
v_pk_fma_f32 v[82:83], v[54:55], v[54:55], v[82:83]
v_pk_fma_f32 v[84:85], v[54:55], v[70:71], v[84:85]
v_add_f32 v80, v80, v81
v_add_f32 v81, v82, v83
v_add_f32 v82, v84, v85
v_permlane32_swap_b32 v72, v80
v_permlane32_swap_b32 v73, v81
v_permlane32_swap_b32 v74, v82
v_add_f32 v72, v72, v80
v_add_f32 v73, v73, v81
v_add_f32 v74, v74, v82
v_mov_b32 v80, v72
v_mov_b32 v81, v73
v_mov_b32 v82, v74
v_permlane16_swap_b32 v72, v80
v_permlane16_swap_b32 v73, v81
v_permlane16_swap_b32 v74, v82
v_add_f32 v72, v72, v80
v_add_f32 v73, v73, v81
v_add_f32 v74, v74, v82
v_mov_b32 v75, s68
v_and_b32 v2, 15, v1
v_lshrrev_b32 v3, 5, v1
v_lshlrev_b32 v4, 4, v2
v_lshl_add_u32 v4, v3, 8, v4
s_lshl_b32 s75, s64, 15
s_lshl_b32 s70, s60, 9
s_add_u32 s75, s75, s70
s_add_u32 s75, s75, 6291456
s_lshl_b32 s70, s65, 11
s_add_u32 s72, s75, s70
s_mov_b32 s92, 0xffff
s_mov_b32 s93, 0xffff
s_mov_b64 exec, s[92:93]
s_cmp_eq_u32 s69, 0
s_cbranch_scc1 L_stp_s
buffer_store_dwordx4 v[72:75], v4, s[12:15], s72 offen
L_stp_d:
s_mov_b64 exec, -1
v_and_b32 v2, 31, v1
v_lshlrev_b32 v5, 4, v2
v_lshl_add_u32 v5, v3, 11, v5
s_add_u32 s70, s75, 0
buffer_load_dwordx4 v[96:99], v5, s[12:15], s70 offen sc1
s_add_u32 s70, s75, 4096
buffer_load_dwordx4 v[100:103], v5, s[12:15], s70 offen sc1
s_add_u32 s70, s75, 8192
buffer_load_dwordx4 v[104:107], v5, s[12:15], s70 offen sc1
s_add_u32 s70, s75, 12288
buffer_load_dwordx4 v[108:111], v5, s[12:15], s70 offen sc1
s_add_u32 s70, s75, 16384
buffer_load_dwordx4 v[112:115], v5, s[12:15], s70 offen sc1
s_add_u32 s70, s75, 20480
buffer_load_dwordx4 v[116:119], v5, s[12:15], s70 offen sc1
s_add_u32 s70, s75, 24576
buffer_load_dwordx4 v[120:123], v5, s[12:15], s70 offen sc1
s_add_u32 s70, s75, 28672
buffer_load_dwordx4 v[124:127], v5, s[12:15], s70 offen sc1
v_cvt_pk_bf16_f32 v128, v24, v25
v_cvt_pk_bf16_f32 v129, v26, v27
ds_write_b64 v20, v[128:129] offset:0
v_cvt_pk_bf16_f32 v130, v28, v29
v_cvt_pk_bf16_f32 v131, v30, v31
ds_write_b64 v21, v[130:131] offset:0
v_cvt_pk_bf16_f32 v132, v32, v33
v_cvt_pk_bf16_f32 v133, v34, v35
ds_write_b64 v22, v[132:133] offset:0
v_cvt_pk_bf16_f32 v134, v36, v37
v_cvt_pk_bf16_f32 v135, v38, v39
ds_write_b64 v23, v[134:135] offset:0
v_cvt_pk_bf16_f32 v136, v40, v41
v_cvt_pk_bf16_f32 v137, v42, v43
ds_write_b64 v20, v[136:137] offset:2048
v_cvt_pk_bf16_f32 v138, v44, v45
v_cvt_pk_bf16_f32 v139, v46, v47
ds_write_b64 v21, v[138:139] offset:2048
v_cvt_pk_bf16_f32 v140, v48, v49
v_cvt_pk_bf16_f32 v141, v50, v51
ds_write_b64 v22, v[140:141] offset:2048
v_cvt_pk_bf16_f32 v142, v52, v53
v_cvt_pk_bf16_f32 v143, v54, v55
ds_write_b64 v23, v[142:143] offset:2048
s_lshl_b32 s70, s64, 7
s_lshl_b32 s71, s60, 5
s_add_u32 s70, s70, s71
s_sub_u32 s70, 2047, s70
v_sub_u32 v6, s70, v2
s_lshl_b32 s70, s60, 9
s_add_u32 s70, s70, 49152
v_lshlrev_b32 v7, 4, v2
v_add_u32 v7, s70, v7
s_waitcnt vmcnt(0)
L_st_chk:
v_xor_b32 v88, s68, v99
v_xor_b32 v89, s68, v103
v_xor_b32 v90, s68, v107
v_xor_b32 v91, s68, v111
v_xor_b32 v92, s68, v115
v_xor_b32 v93, s68, v119
v_xor_b32 v94, s68, v123
v_xor_b32 v95, s68, v127
v_or3_b32 v88, v88, v89, v90
v_or3_b32 v91, v91, v92, v93
v_or3_b32 v88, v88, v94, v95
v_or_b32 v88, v88, v91
v_cmp_ne_u32 vcc, 0, v88
s_cbranch_vccnz L_st_rt
L_st_ok:
v_pk_add_f32 v[96:97], v[96:97], v[100:101]
v_add_f32 v98, v98, v102
v_pk_add_f32 v[104:105], v[104:105], v[108:109]
v_add_f32 v106, v106, v110
v_pk_add_f32 v[112:113], v[112:113], v[116:117]
v_add_f32 v114, v114, v118
v_pk_add_f32 v[120:121], v[120:121], v[124:125]
v_add_f32 v122, v122, v126
v_pk_add_f32 v[96:97], v[96:97], v[104:105]
v_add_f32 v98, v98, v106
v_pk_add_f32 v[112:113], v[112:113], v[120:121]
v_add_f32 v114, v114, v122
v_pk_add_f32 v[96:97], v[96:97], v[112:113]
v_add_f32 v98, v98, v114
v_mov_b32 v100, v96
v_mov_b32 v101, v97
v_mov_b32 v102, v98
v_permlane32_swap_b32 v96, v100
v_permlane32_swap_b32 v97, v101
v_permlane32_swap_b32 v98, v102
v_add_f32 v96, v96, v100
v_add_f32 v97, v97, v101
v_add_f32 v98, v98, v102
v_mul_f32 v73, 0x3a800000, v96
v_mul_f32 v97, 0x3a800000, v97
v_fma_f32 v97, -v73, v73, v97
v_fma_f32 v98, -v73, s84, v98
v_max_f32 v97, 0, v97
v_add_f32 v97, 0x3727c5ac, v97
v_rsq_f32 v74, v97
v_mov_b32 v75, s68
v_mul_f32 v98, v98, v74
v_ashrrev_i32 v99, 31, v98
v_or_b32 v99, 0x80000000, v99
v_xor_b32 v98, v98, v99
s_mov_b32 s70, 0xfffff800
v_and_or_b32 v72, v98, s70, v6
ds_write_b128 v7, v[72:75]
s_nop 0
v_mov_b32_dpp v78, v72 row_ror:1 row_mask:0xf bank_mask:0xf
v_max_u32 v76, v72, v78
v_min_u32 v77, v72, v78
s_nop 0
v_mov_b32_dpp v78, v76 row_ror:2 row_mask:0xf bank_mask:0xf
v_max_u32_dpp v79, v77, v77 row_ror:2 row_mask:0xf bank_mask:0xf
v_med3_u32 v77, v76, v78, v79
v_max_u32 v76, v76, v78
s_nop 1
v_mov_b32_dpp v78, v76 row_ror:4 row_mask:0xf bank_mask:0xf
v_max_u32_dpp v79, v77, v77 row_ror:4 row_mask:0xf bank_mask:0xf
v_med3_u32 v77, v76, v78, v79
v_max_u32 v76, v76, v78
s_nop 1
v_mov_b32_dpp v78, v76 row_ror:8 row_mask:0xf bank_mask:0xf
v_max_u32_dpp v79, v77, v77 row_ror:8 row_mask:0xf bank_mask:0xf
v_med3_u32 v77, v76, v78, v79
v_max_u32 v76, v76, v78
v_mov_b32 v78, v76
v_mov_b32 v79, v77
s_nop 0
v_permlane16_swap_b32 v76, v78
v_permlane16_swap_b32 v77, v79
v_max_u32 v79, v77, v79
v_med3_u32 v77, v76, v78, v79
v_max_u32 v76, v76, v78
s_lshl_b32 s70, s60, 3
s_add_u32 s70, s70, 161792
v_mov_b32 v2, s70
ds_write_b64 v2, v[76:77]
v_mov_b32 v2, 161792
v_add_f32 v80, 1.0, v74
v_mul_f32_e64 v82, -v73, v74
v_mov_b32 v81, v80
v_mov_b32 v83, v82
s_nop 0
v_permlane16_swap_b32 v80, v81
v_permlane16_swap_b32 v82, v83
s_waitcnt lgkmcnt(0)
s_barrier
ds_read_b128 v[88:91], v2
ds_read_b128 v[92:95], v2 offset:16
s_waitcnt lgkmcnt(0)
v_max_u32 v89, v89, v91
v_max_u32 v93, v93, v95
v_med3_u32 v89, v88, v90, v89
v_med3_u32 v93, v92, v94, v93
v_max_u32 v88, v88, v90
v_max_u32 v92, v92, v94
v_max_u32 v89, v89, v93
v_med3_u32 v89, v88, v92, v89
v_max_u32 v88, v88, v92
v_readfirstlane_b32 s86, v89
v_readfirstlane_b32 s85, v88
s_not_b32 s95, s86
s_and_b32 s95, s95, 127
s_not_b32 s94, s85
s_and_b32 s94, s94, 127
s_cmp_lg_u32 s60, 0
s_cbranch_scc1 L_nocand
v_mov_b32 v2, s94
v_mov_b32 v3, s95
v_and_b32 v4, 8, v1
v_cmp_ne_u32 vcc, 0, v4
s_nop 1
v_cndmask_b32 v5, v2, v3, vcc
v_bfe_u32 v6, v5, 1, 3
v_and_b32 v7, 7, v1
v_xor_b32 v6, v6, v7
v_lshlrev_b32 v6, 4, v6
v_lshl_add_u32 v6, v5, 7, v6
ds_read_b128 v[88:91], v6
v_cmp_eq_u32 vcc, 1, v1
s_nop 1
v_cndmask_b32 v5, v2, v3, vcc
v_lshlrev_b32 v5, 4, v5
v_add_u32 v5, 49152, v5
ds_read_b128 v[92:95], v5
v_lshlrev_b32 v4, 8, v4
v_lshl_add_u32 v4, v7, 4, v4
s_lshl_b32 s70, s64, 12
s_lshl_b32 s71, s65, 7
s_add_u32 s70, s70, s71
s_add_u32 s70, s70, 6881280
s_lshl_b32 s71, s64, 5
s_add_u32 s71, s71, 6815744
s_mov_b64 exec, 0xffff
s_waitcnt lgkmcnt(1)
buffer_store_dwordx4 v[88:91], v4, s[12:15], s70 offen sc1
s_cmp_lg_u32 s64, s65
s_cbranch_scc1 L_norec
s_mov_b64 exec, 3
s_waitcnt lgkmcnt(0)
buffer_store_dwordx4 v[92:95], v16, s[12:15], s71 offen sc1
L_norec:
s_mov_b64 exec, -1
L_nocand:
v_and_b32 v8, 31, v1
v_lshlrev_b32 v8, 4, v8
s_mov_b32 s75, 6815744
v_pk_fma_f32 v[24:25], v[24:25], v[80:81], v[82:83] op_sel:[0,0,0] op_sel_hi:[1,0,0]
v_pk_fma_f32 v[26:27], v[26:27], v[80:81], v[82:83] op_sel:[0,0,0] op_sel_hi:[1,0,0]
v_cvt_pk_bf16_f32 v128, v24, v25
v_cvt_pk_bf16_f32 v129, v26, v27
ds_write_b64 v20, v[128:129] offset:32768
v_pk_fma_f32 v[28:29], v[28:29], v[80:81], v[82:83] op_sel:[0,0,0] op_sel_hi:[1,0,0]
v_pk_fma_f32 v[30:31], v[30:31], v[80:81], v[82:83] op_sel:[0,0,0] op_sel_hi:[1,0,0]
v_cvt_pk_bf16_f32 v130, v28, v29
v_cvt_pk_bf16_f32 v131, v30, v31
ds_write_b64 v21, v[130:131] offset:32768
v_pk_fma_f32 v[32:33], v[32:33], v[80:81], v[82:83] op_sel:[0,0,0] op_sel_hi:[1,0,0]
v_pk_fma_f32 v[34:35], v[34:35], v[80:81], v[82:83] op_sel:[0,0,0] op_sel_hi:[1,0,0]
v_cvt_pk_bf16_f32 v132, v32, v33
v_cvt_pk_bf16_f32 v133, v34, v35
ds_write_b64 v22, v[132:133] offset:32768
v_pk_fma_f32 v[36:37], v[36:37], v[80:81], v[82:83] op_sel:[0,0,0] op_sel_hi:[1,0,0]
v_pk_fma_f32 v[38:39], v[38:39], v[80:81], v[82:83] op_sel:[0,0,0] op_sel_hi:[1,0,0]
v_cvt_pk_bf16_f32 v134, v36, v37
v_cvt_pk_bf16_f32 v135, v38, v39
ds_write_b64 v23, v[134:135] offset:32768
v_pk_fma_f32 v[40:41], v[40:41], v[80:81], v[82:83] op_sel:[0,1,1] op_sel_hi:[1,1,1]
v_pk_fma_f32 v[42:43], v[42:43], v[80:81], v[82:83] op_sel:[0,1,1] op_sel_hi:[1,1,1]
v_cvt_pk_bf16_f32 v136, v40, v41
v_cvt_pk_bf16_f32 v137, v42, v43
ds_write_b64 v20, v[136:137] offset:34816
v_pk_fma_f32 v[44:45], v[44:45], v[80:81], v[82:83] op_sel:[0,1,1] op_sel_hi:[1,1,1]
v_pk_fma_f32 v[46:47], v[46:47], v[80:81], v[82:83] op_sel:[0,1,1] op_sel_hi:[1,1,1]
v_cvt_pk_bf16_f32 v138, v44, v45
v_cvt_pk_bf16_f32 v139, v46, v47
ds_write_b64 v21, v[138:139] offset:34816
v_pk_fma_f32 v[48:49], v[48:49], v[80:81], v[82:83] op_sel:[0,1,1] op_sel_hi:[1,1,1]
v_pk_fma_f32 v[50:51], v[50:51], v[80:81], v[82:83] op_sel:[0,1,1] op_sel_hi:[1,1,1]
v_cvt_pk_bf16_f32 v140, v48, v49
v_cvt_pk_bf16_f32 v141, v50, v51
ds_write_b64 v22, v[140:141] offset:34816
v_pk_fma_f32 v[52:53], v[52:53], v[80:81], v[82:83] op_sel:[0,1,1] op_sel_hi:[1,1,1]
v_pk_fma_f32 v[54:55], v[54:55], v[80:81], v[82:83] op_sel:[0,1,1] op_sel_hi:[1,1,1]
v_cvt_pk_bf16_f32 v142, v52, v53
v_cvt_pk_bf16_f32 v143, v54, v55
ds_write_b64 v23, v[142:143] offset:34816
v_lshrrev_b32 v2, 3, v1
v_lshrrev_b32 v3, 4, v1
v_and_b32 v4, 7, v1
v_xor_b32 v3, v3, v4
v_lshlrev_b32 v3, 4, v3
v_lshl_add_u32 v3, v2, 7, v3
s_lshl_b32 s70, s60, 12
v_add_u32 v9, s70, v3
v_xor_b32 v10, 64, v9
v_lshlrev_b32 v11, 11, v2
v_lshl_add_u32 v11, v4, 4, v11
s_lshl_b32 s70, s60, 5
v_add_u32 v12, s70, v2
s_lshl_b32 s87, s64, 18
s_lshl_b32 s70, s60, 16
s_add_u32 s87, s87, s70
s_lshl_b32 s70, s65, 7
s_add_u32 s87, s87, s70
s_waitcnt lgkmcnt(0)
ds_read_b128 v[96:99], v9 offset:32768
ds_read_b128 v[100:103], v10 offset:33792
ds_read_b128 v[104:107], v9 offset:34816
ds_read_b128 v[108:111], v10 offset:35840
v_add_u32 v2, 0, v12
v_cmp_ne_u32 vcc, s94, v2
v_cmp_ne_u32_e64 s[92:93], s95, v2
s_add_u32 s70, s87, 0
s_waitcnt lgkmcnt(3)
s_and_b64 exec, vcc, s[92:93]
buffer_store_dwordx4 v[96:99], v11, s[20:23], s70 offen
s_mov_b64 exec, -1
v_add_u32 v2, 8, v12
v_cmp_ne_u32 vcc, s94, v2
v_cmp_ne_u32_e64 s[92:93], s95, v2
s_add_u32 s70, s87, 16384
s_waitcnt lgkmcnt(2)
s_and_b64 exec, vcc, s[92:93]
buffer_store_dwordx4 v[100:103], v11, s[20:23], s70 offen
s_mov_b64 exec, -1
v_add_u32 v2, 16, v12
v_cmp_ne_u32 vcc, s94, v2
v_cmp_ne_u32_e64 s[92:93], s95, v2
s_add_u32 s70, s87, 32768
s_waitcnt lgkmcnt(1)
s_and_b64 exec, vcc, s[92:93]
buffer_store_dwordx4 v[104:107], v11, s[20:23], s70 offen
s_mov_b64 exec, -1
v_add_u32 v2, 24, v12
v_cmp_ne_u32 vcc, s94, v2
v_cmp_ne_u32_e64 s[92:93], s95, v2
s_add_u32 s70, s87, 49152
s_waitcnt lgkmcnt(0)
s_and_b64 exec, vcc, s[92:93]
buffer_store_dwordx4 v[108:111], v11, s[20:23], s70 offen
s_mov_b64 exec, -1
s_cmp_lg_u32 s60, 1
s_cbranch_scc1 L_nopick
buffer_load_dwordx4 v[84:87], v8, s[12:15], s75 offen sc1
s_waitcnt vmcnt(0)
L_rec_chk:
v_cmp_ne_u32 vcc, s68, v87
s_cbranch_vccnz L_rec_rt
L_rec_ok:
v_mov_b32_dpp v78, v84 row_ror:1 row_mask:0xf bank_mask:0xf
v_max_u32 v76, v84, v78
v_min_u32 v77, v84, v78
s_nop 0
v_mov_b32_dpp v78, v76 row_ror:2 row_mask:0xf bank_mask:0xf
v_max_u32_dpp v79, v77, v77 row_ror:2 row_mask:0xf bank_mask:0xf
v_med3_u32 v77, v76, v78, v79
v_max_u32 v76, v76, v78
s_nop 1
v_mov_b32_dpp v78, v76 row_ror:4 row_mask:0xf bank_mask:0xf
v_max_u32_dpp v79, v77, v77 row_ror:4 row_mask:0xf bank_mask:0xf
v_med3_u32 v77, v76, v78, v79
v_max_u32 v76, v76, v78
s_nop 1
v_mov_b32_dpp v78, v76 row_ror:8 row_mask:0xf bank_mask:0xf
v_max_u32_dpp v79, v77, v77 row_ror:8 row_mask:0xf bank_mask:0xf
v_med3_u32 v77, v76, v78, v79
v_max_u32 v76, v76, v78
v_mov_b32 v78, v76
v_mov_b32 v79, v77
s_nop 0
v_permlane16_swap_b32 v76, v78
v_permlane16_swap_b32 v77, v79
v_max_u32 v79, v77, v79
v_med3_u32 v77, v76, v78, v79
v_max_u32 v76, v76, v78
v_cmp_eq_u32 vcc, v84, v77
v_cmp_eq_u32_e64 s[92:93], v84, v76
v_lshrrev_b32 v87, 4, v8
v_mov_b32 v2, 161856
v_mov_b32 v3, 161872
v_cndmask_b32 v2, v2, v3, vcc
s_or_b64 exec, vcc, s[92:93]
ds_write_b128 v2, v[84:87]
s_mov_b64 exec, -1
s_cmp_lg_u32 s2, 0
s_cbranch_scc1 L_nopick
v_mov_b32 v2, s68
v_mov_b32 v3, 0
s_mov_b64 exec, 1
buffer_store_dword v2, v3, s[12:15], 0 offen sc1
s_mov_b64 exec, -1
L_nopick:
v_mov_b32 v2, 161856
s_waitcnt lgkmcnt(0)
s_barrier
ds_read_b32 v3, v2
ds_read_b32 v4, v2 offset:16
s_waitcnt lgkmcnt(0)
v_readfirstlane_b32 s72, v3
v_readfirstlane_b32 s73, v4
s_cmp_eq_u32 s85, s72
s_cselect_b32 s94, 255, s94
s_cmp_eq_u32 s85, s73
s_cselect_b32 s94, 255, s94
s_cmp_eq_u32 s86, s72
s_cselect_b32 s95, 255, s95
s_cmp_eq_u32 s86, s73
s_cselect_b32 s95, 255, s95
v_add_u32 v2, 0, v12
v_cmp_eq_u32 vcc, s94, v2
v_cmp_eq_u32_e64 s[92:93], s95, v2
s_add_u32 s70, s87, 0
s_or_b64 exec, vcc, s[92:93]
s_cbranch_execz L_nodef0
buffer_store_dwordx4 v[96:99], v11, s[20:23], s70 offen
L_nodef0:
s_mov_b64 exec, -1
v_add_u32 v2, 8, v12
v_cmp_eq_u32 vcc, s94, v2
v_cmp_eq_u32_e64 s[92:93], s95, v2
s_add_u32 s70, s87, 16384
s_or_b64 exec, vcc, s[92:93]
s_cbranch_execz L_nodef1
buffer_store_dwordx4 v[100:103], v11, s[20:23], s70 offen
L_nodef1:
s_mov_b64 exec, -1
v_add_u32 v2, 16, v12
v_cmp_eq_u32 vcc, s94, v2
v_cmp_eq_u32_e64 s[92:93], s95, v2
s_add_u32 s70, s87, 32768
s_or_b64 exec, vcc, s[92:93]
s_cbranch_execz L_nodef2
buffer_store_dwordx4 v[104:107], v11, s[20:23], s70 offen
L_nodef2:
s_mov_b64 exec, -1
v_add_u32 v2, 24, v12
v_cmp_eq_u32 vcc, s94, v2
v_cmp_eq_u32_e64 s[92:93], s95, v2
s_add_u32 s70, s87, 49152
s_or_b64 exec, vcc, s[92:93]
s_cbranch_execz L_nodef3
buffer_store_dwordx4 v[108:111], v11, s[20:23], s70 offen
L_nodef3:
s_mov_b64 exec, -1
L_end:
s_endpgm
L_eg_rt:
s_add_u32 s78, s78, 1
s_cmp_gt_u32 s78, 65536
s_cbranch_scc1 L_eg_ok
s_add_u32 s70, s87, 0
buffer_load_dwordx4 v[20:23], v44, s[12:15], s70 offen sc1
s_add_u32 s70, s87, 4096
buffer_load_dwordx4 v[24:27], v44, s[12:15], s70 offen sc1
s_add_u32 s70, s87, 8192
buffer_load_dwordx4 v[28:31], v44, s[12:15], s70 offen sc1
s_add_u32 s70, s87, 12288
buffer_load_dwordx4 v[32:35], v44, s[12:15], s70 offen sc1
buffer_load_dwordx4 v[36:39], v45, s[12:15], s88 offen sc1
buffer_load_dwordx4 v[40:43], v46, s[12:15], 0 offen offset:0 sc1
s_waitcnt vmcnt(0)
s_branch L_eg_chk
L_kv0_rt:
s_add_u32 s78, s78, 1
s_cmp_gt_u32 s78, 65536
s_cbranch_scc1 L_kv0_ok
s_add_u32 s70, s65, 1
s_and_b32 s70, s70, 15
s_mul_i32 s70, s70, 4352
s_add_u32 s70, s70, s87
buffer_load_dwordx4 v[84:87], v18, s[12:15], s70 offen sc1
s_add_u32 s70, s65, 2
s_and_b32 s70, s70, 15
s_mul_i32 s70, s70, 4352
s_add_u32 s70, s70, s87
buffer_load_dwordx4 v[88:91], v18, s[12:15], s70 offen sc1
s_add_u32 s70, s65, 3
s_and_b32 s70, s70, 15
s_mul_i32 s70, s70, 4352
s_add_u32 s70, s70, s87
buffer_load_dwordx4 v[92:95], v18, s[12:15], s70 offen sc1
s_add_u32 s70, s65, 4
s_and_b32 s70, s70, 15
s_mul_i32 s70, s70, 4352
s_add_u32 s70, s70, s87
buffer_load_dwordx4 v[96:99], v18, s[12:15], s70 offen sc1
s_waitcnt vmcnt(0)
s_branch L_kv0_chk
L_kv1_rt:
s_add_u32 s78, s78, 1
s_cmp_gt_u32 s78, 65536
s_cbranch_scc1 L_kv1_ok
s_add_u32 s70, s65, 5
s_and_b32 s70, s70, 15
s_mul_i32 s70, s70, 4352
s_add_u32 s70, s70, s87
buffer_load_dwordx4 v[100:103], v18, s[12:15], s70 offen sc1
s_add_u32 s70, s65, 6
s_and_b32 s70, s70, 15
s_mul_i32 s70, s70, 4352
s_add_u32 s70, s70, s87
buffer_load_dwordx4 v[104:107], v18, s[12:15], s70 offen sc1
s_add_u32 s70, s65, 7
s_and_b32 s70, s70, 15
s_mul_i32 s70, s70, 4352
s_add_u32 s70, s70, s87
buffer_load_dwordx4 v[108:111], v18, s[12:15], s70 offen sc1
s_add_u32 s70, s65, 8
s_and_b32 s70, s70, 15
s_mul_i32 s70, s70, 4352
s_add_u32 s70, s70, s87
buffer_load_dwordx4 v[112:115], v18, s[12:15], s70 offen sc1
s_waitcnt vmcnt(0)
s_branch L_kv1_chk
L_kv2_rt:
s_add_u32 s78, s78, 1
s_cmp_gt_u32 s78, 65536
s_cbranch_scc1 L_kv2_ok
s_add_u32 s70, s65, 9
s_and_b32 s70, s70, 15
s_mul_i32 s70, s70, 4352
s_add_u32 s70, s70, s87
buffer_load_dwordx4 v[116:119], v18, s[12:15], s70 offen sc1
s_add_u32 s70, s65, 10
s_and_b32 s70, s70, 15
s_mul_i32 s70, s70, 4352
s_add_u32 s70, s70, s87
buffer_load_dwordx4 v[120:123], v18, s[12:15], s70 offen sc1
s_add_u32 s70, s65, 11
s_and_b32 s70, s70, 15
s_mul_i32 s70, s70, 4352
s_add_u32 s70, s70, s87
buffer_load_dwordx4 v[124:127], v18, s[12:15], s70 offen sc1
s_add_u32 s70, s65, 12
s_and_b32 s70, s70, 15
s_mul_i32 s70, s70, 4352
s_add_u32 s70, s70, s87
buffer_load_dwordx4 v[128:131], v18, s[12:15], s70 offen sc1
s_waitcnt vmcnt(0)
s_branch L_kv2_chk
L_kv3_rt:
s_add_u32 s78, s78, 1
s_cmp_gt_u32 s78, 65536
s_cbranch_scc1 L_kv3_ok
s_add_u32 s70, s65, 13
s_and_b32 s70, s70, 15
s_mul_i32 s70, s70, 4352
s_add_u32 s70, s70, s87
buffer_load_dwordx4 v[132:135], v18, s[12:15], s70 offen sc1
s_add_u32 s70, s65, 14
s_and_b32 s70, s70, 15
s_mul_i32 s70, s70, 4352
s_add_u32 s70, s70, s87
buffer_load_dwordx4 v[136:139], v18, s[12:15], s70 offen sc1
s_add_u32 s70, s65, 15
s_and_b32 s70, s70, 15
s_mul_i32 s70, s70, 4352
s_add_u32 s70, s70, s87
buffer_load_dwordx4 v[140:143], v18, s[12:15], s70 offen sc1
s_add_u32 s70, s65, 16
s_and_b32 s70, s70, 15
s_mul_i32 s70, s70, 4352
s_add_u32 s70, s70, s87
buffer_load_dwordx4 v[144:147], v18, s[12:15], s70 offen sc1
s_waitcnt vmcnt(0)
s_branch L_kv3_chk
L_z_rt:
s_add_u32 s78, s78, 1
s_cmp_gt_u32 s78, 65536
s_cbranch_scc1 L_z_ok
buffer_load_dwordx4 v[148:151], v55, s[12:15], s88 offen sc1
s_waitcnt vmcnt(0)
s_branch L_z_chk
L_x_rt:
s_add_u32 s78, s78, 1
s_cmp_gt_u32 s78, 65536
s_cbranch_scc1 L_x_ok
buffer_load_dwordx4 v[24:27], v57, s[12:15], 0 offen offset:0 sc1
buffer_load_dwordx4 v[28:31], v57, s[12:15], 0 offen offset:64 sc1
buffer_load_dwordx4 v[32:35], v57, s[12:15], 0 offen offset:128 sc1
buffer_load_dwordx4 v[36:39], v57, s[12:15], 0 offen offset:192 sc1
buffer_load_dwordx4 v[40:43], v57, s[12:15], 0 offen offset:256 sc1
buffer_load_dwordx4 v[44:47], v57, s[12:15], 0 offen offset:320 sc1
buffer_load_dwordx4 v[48:51], v57, s[12:15], 0 offen offset:384 sc1
buffer_load_dwordx4 v[52:55], v57, s[12:15], 0 offen offset:448 sc1
s_waitcnt vmcnt(0)
s_branch L_x_chk
L_y_rt:
s_add_u32 s78, s78, 1
s_cmp_gt_u32 s78, 65536
s_cbranch_scc1 L_y_ok
buffer_load_ushort v61, v64, s[12:15], s72 offen sc1
s_add_u32 s70, s87, 0
buffer_load_dwordx4 v[24:27], v62, s[12:15], s70 offen sc1
s_add_u32 s70, s87, 65536
buffer_load_dwordx4 v[28:31], v62, s[12:15], s70 offen sc1
s_add_u32 s70, s87, 131072
buffer_load_dwordx4 v[32:35], v62, s[12:15], s70 offen sc1
s_add_u32 s70, s87, 196608
buffer_load_dwordx4 v[36:39], v62, s[12:15], s70 offen sc1
s_add_u32 s70, s87, 262144
buffer_load_dwordx4 v[40:43], v62, s[12:15], s70 offen sc1
s_add_u32 s70, s87, 327680
buffer_load_dwordx4 v[44:47], v62, s[12:15], s70 offen sc1
s_add_u32 s70, s87, 393216
buffer_load_dwordx4 v[48:51], v62, s[12:15], s70 offen sc1
s_waitcnt vmcnt(0)
s_branch L_y_chk
L_ex1:
ds_write_b128 v2, v[64:67]
ds_write_b128 v2, v[72:75] offset:1024
ds_write_b128 v5, v[20:23]
s_waitcnt lgkmcnt(0)
s_barrier
ds_read_b128 v[128:131], v3
ds_read_b128 v[132:135], v3 offset:1024
ds_read_b128 v[136:139], v6
s_waitcnt lgkmcnt(1)
v_pk_add_f32 v[128:129], v[128:129], v[68:69]
v_pk_add_f32 v[130:131], v[130:131], v[70:71]
v_pk_add_f32 v[132:133], v[132:133], v[76:77]
v_pk_add_f32 v[134:135], v[134:135], v[78:79]
s_waitcnt lgkmcnt(0)
v_pk_add_f32 v[136:137], v[136:137], v[24:25]
v_pk_add_f32 v[138:139], v[138:139], v[26:27]
s_branch L_ex_d
L_kvp_s:
buffer_store_dwordx4 v[140:143], v16, s[12:15], s72 offen sc1
s_mov_b64 exec, s[92:93]
buffer_store_dwordx4 v[136:139], v4, s[12:15], s73 offen sc1
s_mov_b64 exec, -1
s_branch L_kvp_d
L_o0_rt:
s_add_u32 s78, s78, 1
s_cmp_gt_u32 s78, 65536
s_cbranch_scc1 L_o0_ok
s_add_u32 s70, s65, 0
s_and_b32 s70, s70, 15
s_lshl_b32 s70, s70, 11
s_add_u32 s70, s70, s74
buffer_load_dwordx4 v[56:59], v16, s[12:15], s70 offen offset:0 sc1
buffer_load_dwordx4 v[60:63], v19, s[12:15], s70 offen offset:0 sc1
buffer_load_dwordx4 v[64:67], v16, s[12:15], s70 offen offset:1024 sc1
buffer_load_dwordx4 v[68:71], v19, s[12:15], s70 offen offset:1024 sc1
s_waitcnt vmcnt(0)
s_branch L_o0_chk
L_o1_rt:
s_add_u32 s78, s78, 1
s_cmp_gt_u32 s78, 65536
s_cbranch_scc1 L_o1_ok
s_add_u32 s70, s65, 1
s_and_b32 s70, s70, 15
s_lshl_b32 s70, s70, 11
s_add_u32 s70, s70, s74
buffer_load_dwordx4 v[72:75], v16, s[12:15], s70 offen offset:0 sc1
buffer_load_dwordx4 v[76:79], v19, s[12:15], s70 offen offset:0 sc1
buffer_load_dwordx4 v[80:83], v16, s[12:15], s70 offen offset:1024 sc1
buffer_load_dwordx4 v[84:87], v19, s[12:15], s70 offen offset:1024 sc1
s_waitcnt vmcnt(0)
s_branch L_o1_chk
L_o2_rt:
s_add_u32 s78, s78, 1
s_cmp_gt_u32 s78, 65536
s_cbranch_scc1 L_o2_ok
s_add_u32 s70, s65, 2
s_and_b32 s70, s70, 15
s_lshl_b32 s70, s70, 11
s_add_u32 s70, s70, s74
buffer_load_dwordx4 v[88:91], v16, s[12:15], s70 offen offset:0 sc1
buffer_load_dwordx4 v[92:95], v19, s[12:15], s70 offen offset:0 sc1
buffer_load_dwordx4 v[96:99], v16, s[12:15], s70 offen offset:1024 sc1
buffer_load_dwordx4 v[100:103], v19, s[12:15], s70 offen offset:1024 sc1
s_waitcnt vmcnt(0)
s_branch L_o2_chk
L_o3_rt:
s_add_u32 s78, s78, 1
s_cmp_gt_u32 s78, 65536
s_cbranch_scc1 L_o3_ok
s_add_u32 s70, s65, 3
s_and_b32 s70, s70, 15
s_lshl_b32 s70, s70, 11
s_add_u32 s70, s70, s74
buffer_load_dwordx4 v[104:107], v16, s[12:15], s70 offen offset:0 sc1
buffer_load_dwordx4 v[108:111], v19, s[12:15], s70 offen offset:0 sc1
buffer_load_dwordx4 v[112:115], v16, s[12:15], s70 offen offset:1024 sc1
buffer_load_dwordx4 v[116:119], v19, s[12:15], s70 offen offset:1024 sc1
s_waitcnt vmcnt(0)
s_branch L_o3_chk
L_o4_rt:
s_add_u32 s78, s78, 1
s_cmp_gt_u32 s78, 65536
s_cbranch_scc1 L_o4_ok
s_add_u32 s70, s65, 4
s_and_b32 s70, s70, 15
s_lshl_b32 s70, s70, 11
s_add_u32 s70, s70, s74
buffer_load_dwordx4 v[120:123], v16, s[12:15], s70 offen offset:0 sc1
buffer_load_dwordx4 v[124:127], v19, s[12:15], s70 offen offset:0 sc1
buffer_load_dwordx4 v[128:131], v16, s[12:15], s70 offen offset:1024 sc1
buffer_load_dwordx4 v[132:135], v19, s[12:15], s70 offen offset:1024 sc1
s_waitcnt vmcnt(0)
s_branch L_o4_chk
L_o5_rt:
s_add_u32 s78, s78, 1
s_cmp_gt_u32 s78, 65536
s_cbranch_scc1 L_o5_ok
s_add_u32 s70, s65, 5
s_and_b32 s70, s70, 15
s_lshl_b32 s70, s70, 11
s_add_u32 s70, s70, s74
buffer_load_dwordx4 v[136:139], v16, s[12:15], s70 offen offset:0 sc1
buffer_load_dwordx4 v[140:143], v19, s[12:15], s70 offen offset:0 sc1
buffer_load_dwordx4 v[144:147], v16, s[12:15], s70 offen offset:1024 sc1
buffer_load_dwordx4 v[148:151], v19, s[12:15], s70 offen offset:1024 sc1
s_waitcnt vmcnt(0)
s_branch L_o5_chk
L_o6_rt:
s_add_u32 s78, s78, 1
s_cmp_gt_u32 s78, 65536
s_cbranch_scc1 L_o6_ok
s_add_u32 s70, s65, 6
s_and_b32 s70, s70, 15
s_lshl_b32 s70, s70, 11
s_add_u32 s70, s70, s74
buffer_load_dwordx4 v[56:59], v16, s[12:15], s70 offen offset:0 sc1
buffer_load_dwordx4 v[60:63], v19, s[12:15], s70 offen offset:0 sc1
buffer_load_dwordx4 v[64:67], v16, s[12:15], s70 offen offset:1024 sc1
buffer_load_dwordx4 v[68:71], v19, s[12:15], s70 offen offset:1024 sc1
s_waitcnt vmcnt(0)
s_branch L_o6_chk
L_o7_rt:
s_add_u32 s78, s78, 1
s_cmp_gt_u32 s78, 65536
s_cbranch_scc1 L_o7_ok
s_add_u32 s70, s65, 7
s_and_b32 s70, s70, 15
s_lshl_b32 s70, s70, 11
s_add_u32 s70, s70, s74
buffer_load_dwordx4 v[72:75], v16, s[12:15], s70 offen offset:0 sc1
buffer_load_dwordx4 v[76:79], v19, s[12:15], s70 offen offset:0 sc1
buffer_load_dwordx4 v[80:83], v16, s[12:15], s70 offen offset:1024 sc1
buffer_load_dwordx4 v[84:87], v19, s[12:15], s70 offen offset:1024 sc1
s_waitcnt vmcnt(0)
s_branch L_o7_chk
L_o8_rt:
s_add_u32 s78, s78, 1
s_cmp_gt_u32 s78, 65536
s_cbranch_scc1 L_o8_ok
s_add_u32 s70, s65, 8
s_and_b32 s70, s70, 15
s_lshl_b32 s70, s70, 11
s_add_u32 s70, s70, s74
buffer_load_dwordx4 v[88:91], v16, s[12:15], s70 offen offset:0 sc1
buffer_load_dwordx4 v[92:95], v19, s[12:15], s70 offen offset:0 sc1
buffer_load_dwordx4 v[96:99], v16, s[12:15], s70 offen offset:1024 sc1
buffer_load_dwordx4 v[100:103], v19, s[12:15], s70 offen offset:1024 sc1
s_waitcnt vmcnt(0)
s_branch L_o8_chk
L_o9_rt:
s_add_u32 s78, s78, 1
s_cmp_gt_u32 s78, 65536
s_cbranch_scc1 L_o9_ok
s_add_u32 s70, s65, 9
s_and_b32 s70, s70, 15
s_lshl_b32 s70, s70, 11
s_add_u32 s70, s70, s74
buffer_load_dwordx4 v[104:107], v16, s[12:15], s70 offen offset:0 sc1
buffer_load_dwordx4 v[108:111], v19, s[12:15], s70 offen offset:0 sc1
buffer_load_dwordx4 v[112:115], v16, s[12:15], s70 offen offset:1024 sc1
buffer_load_dwordx4 v[116:119], v19, s[12:15], s70 offen offset:1024 sc1
s_waitcnt vmcnt(0)
s_branch L_o9_chk
L_o10_rt:
s_add_u32 s78, s78, 1
s_cmp_gt_u32 s78, 65536
s_cbranch_scc1 L_o10_ok
s_add_u32 s70, s65, 10
s_and_b32 s70, s70, 15
s_lshl_b32 s70, s70, 11
s_add_u32 s70, s70, s74
buffer_load_dwordx4 v[120:123], v16, s[12:15], s70 offen offset:0 sc1
buffer_load_dwordx4 v[124:127], v19, s[12:15], s70 offen offset:0 sc1
buffer_load_dwordx4 v[128:131], v16, s[12:15], s70 offen offset:1024 sc1
buffer_load_dwordx4 v[132:135], v19, s[12:15], s70 offen offset:1024 sc1
s_waitcnt vmcnt(0)
s_branch L_o10_chk
L_o11_rt:
s_add_u32 s78, s78, 1
s_cmp_gt_u32 s78, 65536
s_cbranch_scc1 L_o11_ok
s_add_u32 s70, s65, 11
s_and_b32 s70, s70, 15
s_lshl_b32 s70, s70, 11
s_add_u32 s70, s70, s74
buffer_load_dwordx4 v[136:139], v16, s[12:15], s70 offen offset:0 sc1
buffer_load_dwordx4 v[140:143], v19, s[12:15], s70 offen offset:0 sc1
buffer_load_dwordx4 v[144:147], v16, s[12:15], s70 offen offset:1024 sc1
buffer_load_dwordx4 v[148:151], v19, s[12:15], s70 offen offset:1024 sc1
s_waitcnt vmcnt(0)
s_branch L_o11_chk
L_o12_rt:
s_add_u32 s78, s78, 1
s_cmp_gt_u32 s78, 65536
s_cbranch_scc1 L_o12_ok
s_add_u32 s70, s65, 12
s_and_b32 s70, s70, 15
s_lshl_b32 s70, s70, 11
s_add_u32 s70, s70, s74
buffer_load_dwordx4 v[56:59], v16, s[12:15], s70 offen offset:0 sc1
buffer_load_dwordx4 v[60:63], v19, s[12:15], s70 offen offset:0 sc1
buffer_load_dwordx4 v[64:67], v16, s[12:15], s70 offen offset:1024 sc1
buffer_load_dwordx4 v[68:71], v19, s[12:15], s70 offen offset:1024 sc1
s_waitcnt vmcnt(0)
s_branch L_o12_chk
L_o13_rt:
s_add_u32 s78, s78, 1
s_cmp_gt_u32 s78, 65536
s_cbranch_scc1 L_o13_ok
s_add_u32 s70, s65, 13
s_and_b32 s70, s70, 15
s_lshl_b32 s70, s70, 11
s_add_u32 s70, s70, s74
buffer_load_dwordx4 v[72:75], v16, s[12:15], s70 offen offset:0 sc1
buffer_load_dwordx4 v[76:79], v19, s[12:15], s70 offen offset:0 sc1
buffer_load_dwordx4 v[80:83], v16, s[12:15], s70 offen offset:1024 sc1
buffer_load_dwordx4 v[84:87], v19, s[12:15], s70 offen offset:1024 sc1
s_waitcnt vmcnt(0)
s_branch L_o13_chk
L_o14_rt:
s_add_u32 s78, s78, 1
s_cmp_gt_u32 s78, 65536
s_cbranch_scc1 L_o14_ok
s_add_u32 s70, s65, 14
s_and_b32 s70, s70, 15
s_lshl_b32 s70, s70, 11
s_add_u32 s70, s70, s74
buffer_load_dwordx4 v[88:91], v16, s[12:15], s70 offen offset:0 sc1
buffer_load_dwordx4 v[92:95], v19, s[12:15], s70 offen offset:0 sc1
buffer_load_dwordx4 v[96:99], v16, s[12:15], s70 offen offset:1024 sc1
buffer_load_dwordx4 v[100:103], v19, s[12:15], s70 offen offset:1024 sc1
s_waitcnt vmcnt(0)
s_branch L_o14_chk
L_o15_rt:
s_add_u32 s78, s78, 1
s_cmp_gt_u32 s78, 65536
s_cbranch_scc1 L_o15_ok
s_add_u32 s70, s65, 15
s_and_b32 s70, s70, 15
s_lshl_b32 s70, s70, 11
s_add_u32 s70, s70, s74
buffer_load_dwordx4 v[104:107], v16, s[12:15], s70 offen offset:0 sc1
buffer_load_dwordx4 v[108:111], v19, s[12:15], s70 offen offset:0 sc1
buffer_load_dwordx4 v[112:115], v16, s[12:15], s70 offen offset:1024 sc1
buffer_load_dwordx4 v[116:119], v19, s[12:15], s70 offen offset:1024 sc1
s_waitcnt vmcnt(0)
s_branch L_o15_chk
L_stp_s:
buffer_store_dwordx4 v[72:75], v4, s[12:15], s72 offen sc1
s_branch L_stp_d
L_st_rt:
s_add_u32 s78, s78, 1
s_cmp_gt_u32 s78, 65536
s_cbranch_scc1 L_st_ok
s_add_u32 s70, s75, 0
buffer_load_dwordx4 v[96:99], v5, s[12:15], s70 offen sc1
s_add_u32 s70, s75, 4096
buffer_load_dwordx4 v[100:103], v5, s[12:15], s70 offen sc1
s_add_u32 s70, s75, 8192
buffer_load_dwordx4 v[104:107], v5, s[12:15], s70 offen sc1
s_add_u32 s70, s75, 12288
buffer_load_dwordx4 v[108:111], v5, s[12:15], s70 offen sc1
s_add_u32 s70, s75, 16384
buffer_load_dwordx4 v[112:115], v5, s[12:15], s70 offen sc1
s_add_u32 s70, s75, 20480
buffer_load_dwordx4 v[116:119], v5, s[12:15], s70 offen sc1
s_add_u32 s70, s75, 24576
buffer_load_dwordx4 v[120:123], v5, s[12:15], s70 offen sc1
s_add_u32 s70, s75, 28672
buffer_load_dwordx4 v[124:127], v5, s[12:15], s70 offen sc1
s_waitcnt vmcnt(0)
s_branch L_st_chk
L_rec_rt:
s_add_u32 s78, s78, 1
s_cmp_gt_u32 s78, 65536
s_cbranch_scc1 L_rec_ok
buffer_load_dwordx4 v[84:87], v8, s[12:15], s75 offen sc1
s_waitcnt vmcnt(0)
s_branch L_rec_chk
.section .rodata,"a"
.p2align 6
.amdhsa_kernel sequential_preLN__linear_attn_block__moe_arch_mod__prompt_kernel
  .amdhsa_next_free_vgpr 256
  .amdhsa_next_free_sgpr 102
  .amdhsa_accum_offset 152
  .amdhsa_group_segment_fixed_size 0
  .amdhsa_kernarg_size 88
  .amdhsa_user_sgpr_count 2
  .amdhsa_user_sgpr_kernarg_segment_ptr 1
  .amdhsa_system_sgpr_workgroup_id_x 1
  .amdhsa_float_denorm_mode_32 3
.end_amdhsa_kernel
```

```asm
; @launch grid=(256,1,1) block=(512,1,1) lds=163840
.amdgcn_target "amdgcn-amd-amdhsa--gfx950"
.text
.globl sequential_preLN__linear_attn_block__moe_arch_mod__prompt_kernel
.p2align 8
.type sequential_preLN__linear_attn_block__moe_arch_mod__prompt_kernel,@function
sequential_preLN__linear_attn_block__moe_arch_mod__prompt_kernel:
s_cmp_ge_u32 s2, 256
s_cbranch_scc1 L_end
s_load_dwordx16 s[40:55], s[0:1], 0
s_load_dwordx2 s[56:57], s[0:1], 64
s_load_dwordx2 s[58:59], s[0:1], 80
v_lshrrev_b32 v2, 6, v0
v_and_b32 v1, 63, v0
v_readfirstlane_b32 s60, v2
s_and_b32 s62, s2, 7
s_lshr_b32 s63, s2, 3
s_lshl_b32 s64, s62, 1
s_and_b32 s70, s63, 1
s_add_u32 s64, s64, s70
s_lshr_b32 s65, s63, 1
s_lshl_b32 s79, s64, 4
s_add_u32 s79, s79, s65
s_mov_b32 s78, 0
s_lshr_b32 s61, s60, 2
s_and_b32 s60, s60, 3
s_lshr_b32 s66, s60, 1
s_and_b32 s67, s60, 1
v_lshlrev_b32 v16, 4, v1
s_cmp_eq_u32 s61, 0
s_cbranch_scc1 L_compute
s_setprio 1
v_mov_b32 v18, v16
s_lshl_b32 s70, s65, 2
s_add_u32 s70, s70, s60
s_lshl_b32 s70, s70, 16
v_lshrrev_b32 v2, 3, v1
v_lshlrev_b32 v5, 11, v2
v_add_u32 v5, s70, v5
v_lshrrev_b32 v3, 4, v1
v_and_b32 v4, 7, v1
v_xor_b32 v3, v3, v4
v_xor_b32 v6, 0, v3
v_lshl_add_u32 v6, v6, 4, v5
v_add_u32 v8, 0, v6
v_xor_b32 v6, 4, v3
v_lshl_add_u32 v6, v6, 4, v5
v_add_u32 v9, 15360, v6
v_xor_b32 v6, 0, v3
v_lshl_add_u32 v6, v6, 4, v5
v_add_u32 v10, 30720, v6
v_xor_b32 v6, 4, v3
v_lshl_add_u32 v6, v6, 4, v5
v_add_u32 v11, 46080, v6
s_lshl_b32 s70, s60, 4
v_add_u32 v5, s70, v2
v_mul_u32_u24 v5, 6144, v5
s_lshl_b32 s70, s64, 7
v_add_u32 v5, s70, v5
v_bfe_u32 v3, v1, 4, 1
v_lshlrev_b32 v3, 1, v3
v_xor_b32 v3, v3, v4
v_xor_b32 v6, 0, v3
v_lshl_add_u32 v6, v6, 4, v5
v_add_u32 v12, 0, v6
v_xor_b32 v6, 4, v3
v_lshl_add_u32 v6, v6, 4, v5
v_add_u32 v13, 48128, v6
v_xor_b32 v6, 0, v3
v_lshl_add_u32 v6, v6, 4, v5
v_add_u32 v14, 0, v6
v_xor_b32 v6, 4, v3
v_lshl_add_u32 v6, v6, 4, v5
v_add_u32 v15, 48128, v6
v_xor_b32 v6, 0, v3
v_lshl_add_u32 v6, v6, 4, v5
v_add_u32 v16, 4096, v6
v_xor_b32 v6, 4, v3
v_lshl_add_u32 v6, v6, 4, v5
v_add_u32 v17, 52224, v6
s_lshl_b32 s76, s60, 12
s_mul_i32 s77, s60, 6144
s_mul_i32 s75, s65, 393216
s_lshl_b32 s74, s65, 7
s_waitcnt lgkmcnt(0)
s_mov_b32 s4, s40
s_and_b32 s5, s41, 0xffff
s_mov_b32 s6, 4194304
s_mov_b32 s7, 0x20000
s_mov_b32 s8, s42
s_and_b32 s9, s43, 0xffff
s_mov_b32 s10, 6291456
s_mov_b32 s11, 0x20000
s_add_u32 m0, s76, 122880
s_nop 0
buffer_load_dwordx4 v8, s[4:7], s74 offen offset:0 lds
buffer_load_dwordx4 v9, s[4:7], s74 offen offset:1024 lds
buffer_load_dwordx4 v10, s[4:7], s74 offen offset:2048 lds
buffer_load_dwordx4 v11, s[4:7], s74 offen offset:3072 lds
s_add_u32 s74, s74, 128
s_and_b32 s74, s74, 2047
s_add_u32 m0, s77, 0
s_nop 0
buffer_load_dwordx4 v12, s[8:11], s75 offen offset:0 lds
buffer_load_dwordx4 v13, s[8:11], s75 offen offset:1024 lds
buffer_load_dwordx4 v14, s[8:11], s75 offen offset:2048 lds
buffer_load_dwordx4 v15, s[8:11], s75 offen offset:3072 lds
s_add_u32 m0, s77, 4096
s_nop 0
buffer_load_dwordx4 v16, s[8:11], s75 offen offset:0 lds
buffer_load_dwordx4 v17, s[8:11], s75 offen offset:1024 lds
s_add_u32 s75, s75, 393216
s_cmp_eq_u32 s75, 6291456
s_cselect_b32 s75, 0, s75
s_add_u32 m0, s76, 106496
s_nop 0
buffer_load_dwordx4 v8, s[4:7], s74 offen offset:0 lds
buffer_load_dwordx4 v9, s[4:7], s74 offen offset:1024 lds
buffer_load_dwordx4 v10, s[4:7], s74 offen offset:2048 lds
buffer_load_dwordx4 v11, s[4:7], s74 offen offset:3072 lds
s_add_u32 s74, s74, 128
s_and_b32 s74, s74, 2047
s_mov_b32 s12, s58
s_and_b32 s13, s59, 0xffff
s_mov_b32 s14, 268435456
s_mov_b32 s15, 0x20000
s_mov_b32 s16, s44
s_and_b32 s17, s45, 0xffff
s_mov_b32 s18, 2097152
s_mov_b32 s19, 0x20000
s_mov_b32 s20, s56
s_and_b32 s21, s57, 0xffff
s_mov_b32 s22, 4194304
s_mov_b32 s23, 0x20000
s_mov_b32 s24, s50
s_and_b32 s25, s51, 0xffff
s_mov_b32 s26, 7340032
s_mov_b32 s27, 0x20000
s_mov_b32 s28, s52
s_and_b32 s29, s53, 0xffff
s_mov_b32 s30, 7340032
s_mov_b32 s31, 0x20000
s_mov_b32 s32, s54
s_and_b32 s33, s55, 0xffff
s_mov_b32 s34, 7340032
s_mov_b32 s35, 0x20000
s_lshl_b32 s70, s65, 7
s_lshl_b32 s71, s64, 3
s_add_u32 s70, s70, s71
s_lshl_b32 s71, s60, 1
s_add_u32 s87, s70, s71
v_lshrrev_b32 v2, 3, v1
v_lshlrev_b32 v3, 11, v2
v_bfe_u32 v5, v1, 4, 2
v_lshlrev_b32 v5, 1, v5
v_and_b32 v4, 7, v1
v_xor_b32 v5, v5, v4
v_lshl_add_u32 v3, v5, 4, v3
s_lshl_b32 s70, s65, 7
v_add_u32 v68, s70, v3
v_add_u32 v69, 15360, v68
v_add_u32 v70, 30720, v68
v_add_u32 v71, 46080, v68
v_mov_b32 v72, -1
v_mov_b32 v73, -1
v_mov_b32 v74, -1
v_mov_b32 v75, -1
s_mul_i32 s80, s79, 4352
s_add_u32 s80, s80, 524288
s_lshl_b32 s81, s65, 18
s_lshl_b32 s70, s66, 17
s_add_u32 s81, s81, s70
s_lshl_b32 s70, s64, 11
s_add_u32 s81, s81, s70
s_lshl_b32 s70, s67, 10
s_add_u32 s81, s81, s70
s_add_u32 s81, s81, 2097152
v_mul_u32_u24 v76, 7168, v2
v_lshl_add_u32 v76, v4, 4, v76
v_lshrrev_b32 v2, 4, v1
v_and_b32 v3, 15, v1
v_lshlrev_b32 v77, 13, v2
v_lshl_add_u32 v77, v3, 4, v77
v_add_u32 v78, 4096, v77
s_and_b32 s70, s65, 3
s_lshl_b32 s70, s70, 2
s_add_u32 s70, s70, s60
s_mul_i32 s85, s70, 458752
s_lshr_b32 s70, s79, 2
s_lshl_b32 s70, s70, 7
s_add_u32 s85, s85, s70
s_lshl_b32 s86, s79, 15
s_lshl_b32 s70, s60, 9
s_add_u32 s86, s86, s70
s_cmp_lt_u32 s64, 14
s_cselect_b32 s26, s26, 0
s_cselect_b32 s30, s30, 0
s_cselect_b32 s34, s34, 0
s_lshl_b32 s70, s79, 10
s_add_u32 s70, s70, 65536
v_and_b32 v2, 7, v1
v_lshlrev_b32 v2, 7, v2
v_add_u32 v79, s70, v2
s_lshl_b32 s70, s87, 4
s_add_u32 s70, s70, 8192
v_writelane_b32 v79, s70, 0
s_lshl_b32 s70, s79, 4
s_add_u32 s70, s70, 4096
v_writelane_b32 v79, s70, 1
s_lshl_b32 s70, s64, 7
s_add_u32 s70, s70, 6815744
v_writelane_b32 v79, s70, 2
s_waitcnt vmcnt(4)
s_barrier
s_add_u32 m0, s77, 81920
s_nop 0
buffer_load_dwordx4 v12, s[8:11], s75 offen offset:0 lds
buffer_load_dwordx4 v13, s[8:11], s75 offen offset:1024 lds
buffer_load_dwordx4 v14, s[8:11], s75 offen offset:2048 lds
buffer_load_dwordx4 v15, s[8:11], s75 offen offset:3072 lds
s_add_u32 m0, s77, 86016
s_nop 0
buffer_load_dwordx4 v16, s[8:11], s75 offen offset:0 lds
buffer_load_dwordx4 v17, s[8:11], s75 offen offset:1024 lds
s_add_u32 s75, s75, 393216
s_cmp_eq_u32 s75, 6291456
s_cselect_b32 s75, 0, s75
s_add_u32 m0, s76, 65536
s_nop 0
buffer_load_dwordx4 v8, s[4:7], s74 offen offset:0 lds
buffer_load_dwordx4 v9, s[4:7], s74 offen offset:1024 lds
buffer_load_dwordx4 v10, s[4:7], s74 offen offset:2048 lds
buffer_load_dwordx4 v11, s[4:7], s74 offen offset:3072 lds
s_add_u32 s74, s74, 128
s_and_b32 s74, s74, 2047
s_add_u32 m0, s77, 40960
s_nop 0
buffer_load_dwordx4 v12, s[8:11], s75 offen offset:0 lds
buffer_load_dwordx4 v13, s[8:11], s75 offen offset:1024 lds
buffer_load_dwordx4 v14, s[8:11], s75 offen offset:2048 lds
buffer_load_dwordx4 v15, s[8:11], s75 offen offset:3072 lds
s_add_u32 m0, s77, 45056
s_nop 0
buffer_load_dwordx4 v16, s[8:11], s75 offen offset:0 lds
buffer_load_dwordx4 v17, s[8:11], s75 offen offset:1024 lds
s_add_u32 s75, s75, 393216
s_cmp_eq_u32 s75, 6291456
s_cselect_b32 s75, 0, s75
s_add_u32 m0, s76, 24576
s_nop 0
buffer_load_dwordx4 v8, s[4:7], s74 offen offset:0 lds
buffer_load_dwordx4 v9, s[4:7], s74 offen offset:1024 lds
buffer_load_dwordx4 v10, s[4:7], s74 offen offset:2048 lds
buffer_load_dwordx4 v11, s[4:7], s74 offen offset:3072 lds
s_add_u32 s74, s74, 128
s_and_b32 s74, s74, 2047
s_waitcnt vmcnt(14)
s_barrier
s_add_u32 m0, s77, 0
s_nop 0
buffer_load_dwordx4 v12, s[8:11], s75 offen offset:0 lds
buffer_load_dwordx4 v13, s[8:11], s75 offen offset:1024 lds
buffer_load_dwordx4 v14, s[8:11], s75 offen offset:2048 lds
buffer_load_dwordx4 v15, s[8:11], s75 offen offset:3072 lds
s_add_u32 m0, s77, 4096
s_nop 0
buffer_load_dwordx4 v16, s[8:11], s75 offen offset:0 lds
buffer_load_dwordx4 v17, s[8:11], s75 offen offset:1024 lds
s_add_u32 s75, s75, 393216
s_cmp_eq_u32 s75, 6291456
s_cselect_b32 s75, 0, s75
s_add_u32 m0, s76, 122880
s_nop 0
buffer_load_dwordx4 v8, s[4:7], s74 offen offset:0 lds
buffer_load_dwordx4 v9, s[4:7], s74 offen offset:1024 lds
buffer_load_dwordx4 v10, s[4:7], s74 offen offset:2048 lds
buffer_load_dwordx4 v11, s[4:7], s74 offen offset:3072 lds
s_add_u32 s74, s74, 128
s_and_b32 s74, s74, 2047
v_mov_b32 v2, 0
buffer_load_dword v19, v2, s[12:15], 0 offen sc1
s_lshl_b32 s70, s87, 11
buffer_load_dwordx4 v[20:23], v18, s[4:7], s70 offen offset:0
s_lshl_b32 s70, s87, 11
buffer_load_dwordx4 v[24:27], v18, s[4:7], s70 offen offset:1024
s_lshl_b32 s70, s87, 11
buffer_load_dwordx4 v[28:31], v18, s[4:7], s70 offen offset:2048
s_lshl_b32 s70, s87, 11
buffer_load_dwordx4 v[32:35], v18, s[4:7], s70 offen offset:3072
s_mov_b64 exec, 0xff07
buffer_load_dword v80, v79, s[12:15], 0 offen
s_mov_b64 exec, -1
s_waitcnt vmcnt(20)
s_barrier
s_add_u32 m0, s77, 81920
s_nop 0
buffer_load_dwordx4 v12, s[8:11], s75 offen offset:0 lds
buffer_load_dwordx4 v13, s[8:11], s75 offen offset:1024 lds
buffer_load_dwordx4 v14, s[8:11], s75 offen offset:2048 lds
buffer_load_dwordx4 v15, s[8:11], s75 offen offset:3072 lds
s_add_u32 m0, s77, 86016
s_nop 0
buffer_load_dwordx4 v16, s[8:11], s75 offen offset:0 lds
buffer_load_dwordx4 v17, s[8:11], s75 offen offset:1024 lds
s_add_u32 s75, s75, 393216
s_cmp_eq_u32 s75, 6291456
s_cselect_b32 s75, 0, s75
s_add_u32 m0, s76, 106496
s_nop 0
buffer_load_dwordx4 v8, s[4:7], s74 offen offset:0 lds
buffer_load_dwordx4 v9, s[4:7], s74 offen offset:1024 lds
buffer_load_dwordx4 v10, s[4:7], s74 offen offset:2048 lds
buffer_load_dwordx4 v11, s[4:7], s74 offen offset:3072 lds
s_add_u32 s74, s74, 128
s_and_b32 s74, s74, 2047
s_lshl_b32 s70, s60, 10
s_add_u32 s70, s70, s80
buffer_store_dwordx4 v[72:75], v18, s[12:15], s70 offen sc1
s_add_u32 s70, s81, 0
buffer_store_dwordx4 v[72:75], v18, s[12:15], s70 offen sc1
s_waitcnt vmcnt(22)
s_barrier
s_add_u32 m0, s77, 40960
s_nop 0
buffer_load_dwordx4 v12, s[8:11], s75 offen offset:0 lds
s_waitcnt vmcnt(14)
v_readfirstlane_b32 s68, v19
s_nop 0
s_add_u32 s68, s68, 1
v_lshlrev_b32 v36, 16, v20
v_and_b32 v37, 0xffff0000, v20
buffer_load_dwordx4 v13, s[8:11], s75 offen offset:1024 lds
v_lshlrev_b32 v38, 16, v21
v_and_b32 v39, 0xffff0000, v21
v_lshlrev_b32 v40, 16, v22
v_and_b32 v41, 0xffff0000, v22
buffer_load_dwordx4 v14, s[8:11], s75 offen offset:2048 lds
v_lshlrev_b32 v42, 16, v23
v_and_b32 v43, 0xffff0000, v23
v_lshlrev_b32 v44, 16, v24
v_and_b32 v45, 0xffff0000, v24
buffer_load_dwordx4 v15, s[8:11], s75 offen offset:3072 lds
v_lshlrev_b32 v46, 16, v25
v_and_b32 v47, 0xffff0000, v25
v_lshlrev_b32 v48, 16, v26
v_and_b32 v49, 0xffff0000, v26
s_add_u32 m0, s77, 45056
s_nop 0
buffer_load_dwordx4 v16, s[8:11], s75 offen offset:0 lds
v_lshlrev_b32 v50, 16, v27
v_and_b32 v51, 0xffff0000, v27
v_lshlrev_b32 v52, 16, v28
v_and_b32 v53, 0xffff0000, v28
buffer_load_dwordx4 v17, s[8:11], s75 offen offset:1024 lds
s_add_u32 s75, s75, 393216
s_cmp_eq_u32 s75, 6291456
s_cselect_b32 s75, 0, s75
v_lshlrev_b32 v54, 16, v29
v_and_b32 v55, 0xffff0000, v29
v_lshlrev_b32 v56, 16, v30
v_and_b32 v57, 0xffff0000, v30
s_add_u32 m0, s76, 65536
s_nop 0
buffer_load_dwordx4 v8, s[4:7], s74 offen offset:0 lds
v_lshlrev_b32 v58, 16, v31
v_and_b32 v59, 0xffff0000, v31
v_lshlrev_b32 v60, 16, v32
v_and_b32 v61, 0xffff0000, v32
buffer_load_dwordx4 v9, s[4:7], s74 offen offset:1024 lds
v_lshlrev_b32 v62, 16, v33
v_and_b32 v63, 0xffff0000, v33
v_lshlrev_b32 v64, 16, v34
v_and_b32 v65, 0xffff0000, v34
buffer_load_dwordx4 v10, s[4:7], s74 offen offset:2048 lds
v_lshlrev_b32 v66, 16, v35
v_and_b32 v67, 0xffff0000, v35
v_pk_add_f32 v[20:21], v[36:37], v[38:39]
buffer_load_dwordx4 v11, s[4:7], s74 offen offset:3072 lds
s_add_u32 s74, s74, 128
s_and_b32 s74, s74, 2047
s_add_u32 s70, s81, 32768
buffer_store_dwordx4 v[72:75], v18, s[12:15], s70 offen sc1
s_add_u32 s70, s81, 65536
buffer_store_dwordx4 v[72:75], v18, s[12:15], s70 offen sc1
s_waitcnt vmcnt(18)
s_barrier
s_add_u32 m0, s77, 0
s_nop 0
buffer_load_dwordx4 v12, s[8:11], s75 offen offset:0 lds
v_pk_add_f32 v[22:23], v[40:41], v[42:43]
v_pk_add_f32 v[24:25], v[44:45], v[46:47]
v_pk_add_f32 v[26:27], v[48:49], v[50:51]
v_pk_add_f32 v[20:21], v[20:21], v[22:23]
buffer_load_dwordx4 v13, s[8:11], s75 offen offset:1024 lds
v_pk_add_f32 v[24:25], v[24:25], v[26:27]
v_pk_add_f32 v[20:21], v[20:21], v[24:25]
v_add_f32 v2, v20, v21
v_pk_add_f32 v[28:29], v[52:53], v[54:55]
buffer_load_dwordx4 v14, s[8:11], s75 offen offset:2048 lds
v_pk_add_f32 v[30:31], v[56:57], v[58:59]
v_pk_add_f32 v[32:33], v[60:61], v[62:63]
v_pk_add_f32 v[34:35], v[64:65], v[66:67]
v_pk_add_f32 v[28:29], v[28:29], v[30:31]
buffer_load_dwordx4 v15, s[8:11], s75 offen offset:3072 lds
v_pk_add_f32 v[32:33], v[32:33], v[34:35]
v_pk_add_f32 v[28:29], v[28:29], v[32:33]
v_add_f32 v4, v28, v29
v_add_f32_dpp v2, v2, v2 row_ror:1 row_mask:0xf bank_mask:0xf
s_add_u32 m0, s77, 4096
s_nop 0
buffer_load_dwordx4 v16, s[8:11], s75 offen offset:0 lds
v_add_f32_dpp v4, v4, v4 row_ror:1 row_mask:0xf bank_mask:0xf
v_add_f32_dpp v2, v2, v2 row_ror:2 row_mask:0xf bank_mask:0xf
s_nop 0
v_add_f32_dpp v4, v4, v4 row_ror:2 row_mask:0xf bank_mask:0xf
v_add_f32_dpp v2, v2, v2 row_ror:4 row_mask:0xf bank_mask:0xf
buffer_load_dwordx4 v17, s[8:11], s75 offen offset:1024 lds
s_add_u32 s75, s75, 393216
s_cmp_eq_u32 s75, 6291456
s_cselect_b32 s75, 0, s75
v_add_f32_dpp v4, v4, v4 row_ror:4 row_mask:0xf bank_mask:0xf
v_add_f32_dpp v2, v2, v2 row_ror:8 row_mask:0xf bank_mask:0xf
s_nop 0
v_add_f32_dpp v4, v4, v4 row_ror:8 row_mask:0xf bank_mask:0xf
v_mov_b32 v6, v2
s_add_u32 m0, s76, 24576
s_nop 0
buffer_load_dwordx4 v8, s[4:7], s74 offen offset:0 lds
v_mov_b32 v7, v4
v_permlane16_swap_b32 v2, v6
s_nop 0
v_permlane16_swap_b32 v4, v7
v_add_f32 v2, v2, v6
buffer_load_dwordx4 v9, s[4:7], s74 offen offset:1024 lds
v_add_f32 v4, v4, v7
v_mov_b32 v6, v2
v_mov_b32 v7, v4
s_nop 0
v_permlane32_swap_b32 v2, v6
buffer_load_dwordx4 v10, s[4:7], s74 offen offset:2048 lds
v_permlane32_swap_b32 v4, v7
v_add_f32 v2, v2, v6
v_add_f32 v4, v4, v7
buffer_load_dwordx4 v11, s[4:7], s74 offen offset:3072 lds
s_add_u32 s74, s74, 128
s_and_b32 s74, s74, 2047
s_add_u32 s70, s81, 98304
buffer_store_dwordx4 v[72:75], v18, s[12:15], s70 offen sc1
s_lshl_b32 s70, s60, 6
s_add_u32 s70, s70, s80
s_add_u32 s70, s70, 4096
s_mov_b64 exec, 0xf
buffer_store_dwordx4 v[72:75], v18, s[12:15], s70 offen sc1
s_mov_b64 exec, -1
s_lshl_b32 s70, s64, 12
s_lshl_b32 s71, s66, 11
s_add_u32 s70, s70, s71
s_lshl_b32 s71, s65, 7
s_add_u32 s70, s70, s71
s_lshl_b32 s71, s67, 6
s_add_u32 s70, s70, s71
s_add_u32 s70, s70, 6881280
s_mov_b64 exec, 0xf
buffer_store_dwordx4 v[72:75], v18, s[12:15], s70 offen sc1
s_mov_b64 exec, -1
s_waitcnt vmcnt(19)
s_barrier
s_add_u32 m0, s77, 81920
s_nop 0
buffer_load_dwordx4 v12, s[8:11], s75 offen offset:0 lds
v_mul_f32 v2, 0xba800000, v2
v_mul_f32 v4, 0xba800000, v4
v_pk_add_f32 v[36:37], v[36:37], v[2:3] op_sel_hi:[1,0]
v_pk_add_f32 v[38:39], v[38:39], v[2:3] op_sel_hi:[1,0]
buffer_load_dwordx4 v13, s[8:11], s75 offen offset:1024 lds
v_pk_add_f32 v[40:41], v[40:41], v[2:3] op_sel_hi:[1,0]
v_pk_add_f32 v[42:43], v[42:43], v[2:3] op_sel_hi:[1,0]
v_pk_add_f32 v[44:45], v[44:45], v[2:3] op_sel_hi:[1,0]
v_pk_add_f32 v[46:47], v[46:47], v[2:3] op_sel_hi:[1,0]
buffer_load_dwordx4 v14, s[8:11], s75 offen offset:2048 lds
v_pk_add_f32 v[48:49], v[48:49], v[2:3] op_sel_hi:[1,0]
v_pk_add_f32 v[50:51], v[50:51], v[2:3] op_sel_hi:[1,0]
v_pk_mul_f32 v[20:21], v[36:37], v[36:37]
v_pk_mul_f32 v[22:23], v[38:39], v[38:39]
buffer_load_dwordx4 v15, s[8:11], s75 offen offset:3072 lds
v_pk_fma_f32 v[20:21], v[40:41], v[40:41], v[20:21]
v_pk_fma_f32 v[22:23], v[42:43], v[42:43], v[22:23]
v_pk_fma_f32 v[20:21], v[44:45], v[44:45], v[20:21]
v_pk_fma_f32 v[22:23], v[46:47], v[46:47], v[22:23]
s_add_u32 m0, s77, 86016
s_nop 0
buffer_load_dwordx4 v16, s[8:11], s75 offen offset:0 lds
v_pk_fma_f32 v[20:21], v[48:49], v[48:49], v[20:21]
v_pk_fma_f32 v[22:23], v[50:51], v[50:51], v[22:23]
v_pk_add_f32 v[20:21], v[20:21], v[22:23]
v_add_f32 v3, v20, v21
buffer_load_dwordx4 v17, s[8:11], s75 offen offset:1024 lds
s_add_u32 s75, s75, 393216
s_cmp_eq_u32 s75, 6291456
s_cselect_b32 s75, 0, s75
v_pk_add_f32 v[52:53], v[52:53], v[4:5] op_sel_hi:[1,0]
v_pk_add_f32 v[54:55], v[54:55], v[4:5] op_sel_hi:[1,0]
v_pk_add_f32 v[56:57], v[56:57], v[4:5] op_sel_hi:[1,0]
v_pk_add_f32 v[58:59], v[58:59], v[4:5] op_sel_hi:[1,0]
s_add_u32 m0, s76, 122880
s_nop 0
buffer_load_dwordx4 v8, s[4:7], s74 offen offset:0 lds
v_pk_add_f32 v[60:61], v[60:61], v[4:5] op_sel_hi:[1,0]
v_pk_add_f32 v[62:63], v[62:63], v[4:5] op_sel_hi:[1,0]
v_pk_add_f32 v[64:65], v[64:65], v[4:5] op_sel_hi:[1,0]
v_pk_add_f32 v[66:67], v[66:67], v[4:5] op_sel_hi:[1,0]
buffer_load_dwordx4 v9, s[4:7], s74 offen offset:1024 lds
v_pk_mul_f32 v[28:29], v[52:53], v[52:53]
v_pk_mul_f32 v[30:31], v[54:55], v[54:55]
v_pk_fma_f32 v[28:29], v[56:57], v[56:57], v[28:29]
v_pk_fma_f32 v[30:31], v[58:59], v[58:59], v[30:31]
buffer_load_dwordx4 v10, s[4:7], s74 offen offset:2048 lds
v_pk_fma_f32 v[28:29], v[60:61], v[60:61], v[28:29]
v_pk_fma_f32 v[30:31], v[62:63], v[62:63], v[30:31]
v_pk_fma_f32 v[28:29], v[64:65], v[64:65], v[28:29]
buffer_load_dwordx4 v11, s[4:7], s74 offen offset:3072 lds
s_add_u32 s74, s74, 128
s_and_b32 s74, s74, 2047
s_lshl_b32 s70, s79, 13
s_lshl_b32 s71, s60, 11
s_add_u32 s70, s70, s71
s_add_u32 s70, s70, 7340032
buffer_store_dwordx4 v[72:75], v18, s[12:15], s70 offen offset:0 sc1
s_lshl_b32 s70, s79, 13
s_lshl_b32 s71, s60, 11
s_add_u32 s70, s70, s71
s_add_u32 s70, s70, 7340032
buffer_store_dwordx4 v[72:75], v18, s[12:15], s70 offen offset:1024 sc1
s_waitcnt vmcnt(19)
s_barrier
s_add_u32 m0, s77, 40960
s_nop 0
buffer_load_dwordx4 v12, s[8:11], s75 offen offset:0 lds
v_pk_fma_f32 v[30:31], v[66:67], v[66:67], v[30:31]
v_pk_add_f32 v[28:29], v[28:29], v[30:31]
v_add_f32 v5, v28, v29
v_add_f32_dpp v3, v3, v3 row_ror:1 row_mask:0xf bank_mask:0xf
buffer_load_dwordx4 v13, s[8:11], s75 offen offset:1024 lds
v_add_f32_dpp v5, v5, v5 row_ror:1 row_mask:0xf bank_mask:0xf
v_add_f32_dpp v3, v3, v3 row_ror:2 row_mask:0xf bank_mask:0xf
s_nop 0
v_add_f32_dpp v5, v5, v5 row_ror:2 row_mask:0xf bank_mask:0xf
v_add_f32_dpp v3, v3, v3 row_ror:4 row_mask:0xf bank_mask:0xf
buffer_load_dwordx4 v14, s[8:11], s75 offen offset:2048 lds
v_add_f32_dpp v5, v5, v5 row_ror:4 row_mask:0xf bank_mask:0xf
v_add_f32_dpp v3, v3, v3 row_ror:8 row_mask:0xf bank_mask:0xf
s_nop 0
v_add_f32_dpp v5, v5, v5 row_ror:8 row_mask:0xf bank_mask:0xf
v_mov_b32 v6, v3
buffer_load_dwordx4 v15, s[8:11], s75 offen offset:3072 lds
v_mov_b32 v7, v5
v_permlane16_swap_b32 v3, v6
s_nop 0
v_permlane16_swap_b32 v5, v7
v_add_f32 v3, v3, v6
s_add_u32 m0, s77, 45056
s_nop 0
buffer_load_dwordx4 v16, s[8:11], s75 offen offset:0 lds
v_add_f32 v5, v5, v7
v_mov_b32 v6, v3
v_mov_b32 v7, v5
s_nop 0
v_permlane32_swap_b32 v3, v6
buffer_load_dwordx4 v17, s[8:11], s75 offen offset:1024 lds
s_add_u32 s75, s75, 393216
s_cmp_eq_u32 s75, 6291456
s_cselect_b32 s75, 0, s75
v_permlane32_swap_b32 v5, v7
v_add_f32 v3, v3, v6
v_add_f32 v5, v5, v7
v_mov_b32 v6, 0x3727c5ac
s_add_u32 m0, s76, 106496
s_nop 0
buffer_load_dwordx4 v8, s[4:7], s74 offen offset:0 lds
v_fmac_f32 v6, 0x3a800000, v3
v_rsq_f32 v3, v6
v_mov_b32 v6, 0x3727c5ac
v_fmac_f32 v6, 0x3a800000, v5
buffer_load_dwordx4 v9, s[4:7], s74 offen offset:1024 lds
v_rsq_f32 v5, v6
v_cmp_eq_u32 vcc, 1, v1
s_nop 1
v_cndmask_b32 v20, v2, v4, vcc
v_cndmask_b32 v21, v3, v5, vcc
buffer_load_dwordx4 v10, s[4:7], s74 offen offset:2048 lds
v_mov_b32 v22, 0
v_mov_b32 v23, s68
buffer_load_dwordx4 v11, s[4:7], s74 offen offset:3072 lds
s_add_u32 s74, s74, 128
s_and_b32 s74, s74, 2047
buffer_load_dwordx4 a[0:3], v76, s[24:27], s85 offen
buffer_load_dwordx4 a[32:35], v76, s[28:31], s85 offen
s_add_u32 s85, s85, 57344
buffer_load_dwordx4 a[4:7], v76, s[24:27], s85 offen
s_lshl_b32 s70, s87, 4
s_add_u32 s70, s70, 8192
s_mov_b64 exec, 3
buffer_store_dwordx4 v[20:23], v18, s[12:15], s70 offen sc1
s_mov_b64 exec, -1
s_waitcnt vmcnt(20)
s_barrier
s_add_u32 m0, s77, 0
s_nop 0
buffer_load_dwordx4 v12, s[8:11], s75 offen offset:0 lds
buffer_load_dwordx4 v13, s[8:11], s75 offen offset:1024 lds
buffer_load_dwordx4 v14, s[8:11], s75 offen offset:2048 lds
buffer_load_dwordx4 v15, s[8:11], s75 offen offset:3072 lds
s_add_u32 m0, s77, 4096
s_nop 0
buffer_load_dwordx4 v16, s[8:11], s75 offen offset:0 lds
buffer_load_dwordx4 v17, s[8:11], s75 offen offset:1024 lds
s_add_u32 s75, s75, 393216
s_cmp_eq_u32 s75, 6291456
s_cselect_b32 s75, 0, s75
s_add_u32 m0, s76, 65536
s_nop 0
buffer_load_dwordx4 v8, s[4:7], s74 offen offset:0 lds
buffer_load_dwordx4 v9, s[4:7], s74 offen offset:1024 lds
buffer_load_dwordx4 v10, s[4:7], s74 offen offset:2048 lds
buffer_load_dwordx4 v11, s[4:7], s74 offen offset:3072 lds
s_add_u32 s74, s74, 128
s_and_b32 s74, s74, 2047
buffer_load_dwordx4 a[36:39], v76, s[28:31], s85 offen
s_add_u32 s85, s85, 57344
buffer_load_dwordx4 a[8:11], v76, s[24:27], s85 offen
buffer_load_dwordx4 a[40:43], v76, s[28:31], s85 offen
s_add_u32 s85, s85, 57344
s_waitcnt vmcnt(21)
s_barrier
s_add_u32 m0, s77, 81920
s_nop 0
buffer_load_dwordx4 v12, s[8:11], s75 offen offset:0 lds
s_getreg_b32 s71, hwreg(HW_REG_XCC_ID, 0, 4)
v_mov_b32 v84, s71
buffer_load_dwordx4 v13, s[8:11], s75 offen offset:1024 lds
v_mov_b32 v85, 0
buffer_load_dwordx4 v14, s[8:11], s75 offen offset:2048 lds
v_mov_b32 v86, 0
buffer_load_dwordx4 v15, s[8:11], s75 offen offset:3072 lds
v_mov_b32 v87, s68
s_add_u32 m0, s77, 86016
s_nop 0
buffer_load_dwordx4 v16, s[8:11], s75 offen offset:0 lds
buffer_load_dwordx4 v17, s[8:11], s75 offen offset:1024 lds
s_add_u32 s75, s75, 393216
s_cmp_eq_u32 s75, 6291456
s_cselect_b32 s75, 0, s75
s_add_u32 m0, s76, 24576
s_nop 0
buffer_load_dwordx4 v8, s[4:7], s74 offen offset:0 lds
buffer_load_dwordx4 v9, s[4:7], s74 offen offset:1024 lds
buffer_load_dwordx4 v10, s[4:7], s74 offen offset:2048 lds
buffer_load_dwordx4 v11, s[4:7], s74 offen offset:3072 lds
s_add_u32 s74, s74, 128
s_and_b32 s74, s74, 2047
buffer_load_dwordx4 a[12:15], v76, s[24:27], s85 offen
buffer_load_dwordx4 a[44:47], v76, s[28:31], s85 offen
s_add_u32 s85, s85, 57344
buffer_load_dwordx4 a[16:19], v76, s[24:27], s85 offen
s_lshl_b32 s70, s79, 4
s_add_u32 s70, s70, 4096
s_mov_b64 exec, 1
buffer_store_dwordx4 v[84:87], v18, s[12:15], s70 offen sc1
s_mov_b64 exec, -1
s_waitcnt vmcnt(21)
s_barrier
s_add_u32 m0, s77, 40960
s_nop 0
buffer_load_dwordx4 v12, s[8:11], s75 offen offset:0 lds
buffer_load_dwordx4 v13, s[8:11], s75 offen offset:1024 lds
buffer_load_dwordx4 v14, s[8:11], s75 offen offset:2048 lds
buffer_load_dwordx4 v15, s[8:11], s75 offen offset:3072 lds
s_add_u32 m0, s77, 45056
s_nop 0
buffer_load_dwordx4 v16, s[8:11], s75 offen offset:0 lds
buffer_load_dwordx4 v17, s[8:11], s75 offen offset:1024 lds
s_add_u32 s75, s75, 393216
s_cmp_eq_u32 s75, 6291456
s_cselect_b32 s75, 0, s75
s_add_u32 m0, s76, 122880
s_nop 0
buffer_load_dwordx4 v8, s[4:7], s74 offen offset:0 lds
buffer_load_dwordx4 v9, s[4:7], s74 offen offset:1024 lds
buffer_load_dwordx4 v10, s[4:7], s74 offen offset:2048 lds
buffer_load_dwordx4 v11, s[4:7], s74 offen offset:3072 lds
s_add_u32 s74, s74, 128
s_and_b32 s74, s74, 2047
buffer_load_dwordx4 a[48:51], v76, s[28:31], s85 offen
s_add_u32 s85, s85, 57344
buffer_load_dwordx4 a[20:23], v76, s[24:27], s85 offen
buffer_load_dwordx4 a[52:55], v76, s[28:31], s85 offen
s_add_u32 s85, s85, 57344
s_waitcnt vmcnt(21)
s_barrier
s_add_u32 m0, s77, 0
s_nop 0
buffer_load_dwordx4 v12, s[8:11], s75 offen offset:0 lds
buffer_load_dwordx4 v13, s[8:11], s75 offen offset:1024 lds
buffer_load_dwordx4 v14, s[8:11], s75 offen offset:2048 lds
buffer_load_dwordx4 v15, s[8:11], s75 offen offset:3072 lds
s_add_u32 m0, s77, 4096
s_nop 0
buffer_load_dwordx4 v16, s[8:11], s75 offen offset:0 lds
buffer_load_dwordx4 v17, s[8:11], s75 offen offset:1024 lds
s_add_u32 s75, s75, 393216
s_cmp_eq_u32 s75, 6291456
s_cselect_b32 s75, 0, s75
s_add_u32 m0, s76, 106496
s_nop 0
buffer_load_dwordx4 v8, s[4:7], s74 offen offset:0 lds
buffer_load_dwordx4 v9, s[4:7], s74 offen offset:1024 lds
buffer_load_dwordx4 v10, s[4:7], s74 offen offset:2048 lds
buffer_load_dwordx4 v11, s[4:7], s74 offen offset:3072 lds
s_add_u32 s74, s74, 128
s_and_b32 s74, s74, 2047
buffer_load_dwordx4 a[24:27], v76, s[24:27], s85 offen
buffer_load_dwordx4 a[56:59], v76, s[28:31], s85 offen
s_add_u32 s85, s85, 57344
buffer_load_dwordx4 a[28:31], v76, s[24:27], s85 offen
buffer_load_dwordx4 a[60:63], v76, s[28:31], s85 offen
s_add_u32 s85, s85, 57344
s_waitcnt vmcnt(21)
s_barrier
s_add_u32 m0, s77, 81920
s_nop 0
buffer_load_dwordx4 v12, s[8:11], s75 offen offset:0 lds
v_lshrrev_b32 v2, 4, v1
v_and_b32 v3, 15, v1
buffer_load_dwordx4 v13, s[8:11], s75 offen offset:1024 lds
v_lshlrev_b32 v44, 10, v2
v_lshl_add_u32 v44, v3, 4, v44
buffer_load_dwordx4 v14, s[8:11], s75 offen offset:2048 lds
s_lshl_b32 s70, s60, 8
v_add_u32 v44, s70, v44
s_lshl_b32 s87, s64, 14
s_add_u32 s87, s87, 65536
buffer_load_dwordx4 v15, s[8:11], s75 offen offset:3072 lds
v_and_b32 v45, 31, v1
v_lshlrev_b32 v45, 4, v45
s_add_u32 m0, s77, 86016
s_nop 0
buffer_load_dwordx4 v16, s[8:11], s75 offen offset:0 lds
s_lshl_b32 s88, s65, 11
s_lshl_b32 s70, s60, 9
s_add_u32 s88, s88, s70
s_add_u32 s88, s88, 8192
s_lshl_b32 s70, s64, 8
s_add_u32 s70, s70, 4096
v_lshlrev_b32 v4, 4, v3
v_add_u32 v4, s70, v4
buffer_load_dwordx4 v17, s[8:11], s75 offen offset:1024 lds
s_add_u32 s75, s75, 393216
s_cmp_eq_u32 s75, 6291456
s_cselect_b32 s75, 0, s75
s_lshl_b32 s70, s64, 4
s_add_u32 s70, s70, 4096
v_lshlrev_b32 v5, 8, v3
v_add_u32 v5, s70, v5
v_and_b32 v6, 1, v2
s_add_u32 m0, s76, 65536
s_nop 0
buffer_load_dwordx4 v8, s[4:7], s74 offen offset:0 lds
v_cmp_eq_u32 vcc, 1, v6
s_nop 1
v_cndmask_b32 v46, v4, v5, vcc
buffer_load_dwordx4 v9, s[4:7], s74 offen offset:1024 lds
buffer_load_dwordx4 v10, s[4:7], s74 offen offset:2048 lds
buffer_load_dwordx4 v11, s[4:7], s74 offen offset:3072 lds
s_add_u32 s74, s74, 128
s_and_b32 s74, s74, 2047
s_add_u32 s70, s87, 0
buffer_load_dwordx4 v[20:23], v44, s[12:15], s70 offen sc1
s_add_u32 s70, s87, 4096
buffer_load_dwordx4 v[24:27], v44, s[12:15], s70 offen sc1
s_add_u32 s70, s87, 8192
buffer_load_dwordx4 v[28:31], v44, s[12:15], s70 offen sc1
s_add_u32 s70, s87, 12288
buffer_load_dwordx4 v[32:35], v44, s[12:15], s70 offen sc1
buffer_load_dwordx4 v[36:39], v45, s[12:15], s88 offen sc1
buffer_load_dwordx4 v[40:43], v46, s[12:15], 0 offen offset:0 sc1
buffer_load_dwordx4 a[64:67], v77, s[32:35], s86 offen offset:0
buffer_load_dwordx4 a[68:71], v77, s[32:35], s86 offen offset:2048
buffer_load_dwordx4 a[72:75], v78, s[32:35], s86 offen offset:0
s_waitcnt vmcnt(27)
s_barrier
s_add_u32 m0, s77, 40960
s_nop 0
buffer_load_dwordx4 v12, s[8:11], s75 offen offset:0 lds
buffer_load_dwordx4 v13, s[8:11], s75 offen offset:1024 lds
buffer_load_dwordx4 v14, s[8:11], s75 offen offset:2048 lds
buffer_load_dwordx4 v15, s[8:11], s75 offen offset:3072 lds
s_add_u32 m0, s77, 45056
s_nop 0
buffer_load_dwordx4 v16, s[8:11], s75 offen offset:0 lds
buffer_load_dwordx4 v17, s[8:11], s75 offen offset:1024 lds
s_add_u32 s75, s75, 393216
s_cmp_eq_u32 s75, 6291456
s_cselect_b32 s75, 0, s75
s_add_u32 m0, s76, 24576
s_nop 0
buffer_load_dwordx4 v8, s[4:7], s74 offen offset:0 lds
buffer_load_dwordx4 v9, s[4:7], s74 offen offset:1024 lds
buffer_load_dwordx4 v10, s[4:7], s74 offen offset:2048 lds
buffer_load_dwordx4 v11, s[4:7], s74 offen offset:3072 lds
s_add_u32 s74, s74, 128
s_and_b32 s74, s74, 2047
buffer_load_dwordx4 a[76:79], v78, s[32:35], s86 offen offset:2048
buffer_load_dwordx4 a[80:83], v77, s[32:35], s86 offen offset:256
buffer_load_dwordx4 a[84:87], v77, s[32:35], s86 offen offset:2304
buffer_load_dwordx4 a[88:91], v78, s[32:35], s86 offen offset:256
buffer_load_dwordx4 a[92:95], v78, s[32:35], s86 offen offset:2304
s_waitcnt vmcnt(28)
s_barrier
s_add_u32 m0, s77, 0
s_nop 0
buffer_load_dwordx4 v12, s[8:11], s75 offen offset:0 lds
s_waitcnt vmcnt(19)
L_eg_chk:
v_xor_b32 v2, s68, v23
v_xor_b32 v3, s68, v27
v_xor_b32 v4, s68, v31
v_or3_b32 v2, v2, v3, v4
v_xor_b32 v3, s68, v35
v_xor_b32 v4, s68, v39
v_or3_b32 v2, v2, v3, v4
v_xor_b32 v3, s68, v43
v_or_b32 v2, v2, v3
v_cmp_ne_u32 vcc, 0, v2
s_cbranch_vccnz L_eg_rt
L_eg_ok:
v_add_f32 v20, v20, v24
buffer_load_dwordx4 v13, s[8:11], s75 offen offset:1024 lds
v_add_f32 v28, v28, v32
v_add_f32 v21, v21, v25
buffer_load_dwordx4 v14, s[8:11], s75 offen offset:2048 lds
v_add_f32 v29, v29, v33
v_add_f32 v22, v22, v26
buffer_load_dwordx4 v15, s[8:11], s75 offen offset:3072 lds
v_add_f32 v30, v30, v34
v_add_f32 v20, v20, v28
s_add_u32 m0, s77, 4096
s_nop 0
buffer_load_dwordx4 v16, s[8:11], s75 offen offset:0 lds
v_add_f32 v21, v21, v29
v_add_f32 v22, v22, v30
buffer_load_dwordx4 v17, s[8:11], s75 offen offset:1024 lds
s_add_u32 s75, s75, 393216
s_cmp_eq_u32 s75, 6291456
s_cselect_b32 s75, 0, s75
v_mov_b32 v24, v20
v_mov_b32 v25, v21
s_mul_i32 s70, s60, 9
s_add_u32 s70, s70, 92
s_lshl_b32 s82, s70, 14
s_lshl_b32 s70, s70, 10
s_add_u32 m0, s70, 28672
s_nop 0
buffer_load_dwordx4 v68, s[16:19], s82 offen offset:0 lds
v_mov_b32 v26, v22
v_permlane16_swap_b32 v20, v24
buffer_load_dwordx4 v69, s[16:19], s82 offen offset:1024 lds
v_permlane16_swap_b32 v21, v25
v_permlane16_swap_b32 v22, v26
buffer_load_dwordx4 v70, s[16:19], s82 offen offset:2048 lds
v_add_f32 v20, v20, v24
v_add_f32 v21, v21, v25
buffer_load_dwordx4 v71, s[16:19], s82 offen offset:3072 lds
v_add_f32 v22, v22, v26
v_mov_b32 v24, v20
s_add_u32 m0, m0, 4096
s_add_u32 s82, s82, 65536
buffer_load_dwordx4 v68, s[16:19], s82 offen offset:0 lds
v_mov_b32 v25, v21
buffer_load_dwordx4 v69, s[16:19], s82 offen offset:1024 lds
buffer_load_dwordx4 v70, s[16:19], s82 offen offset:2048 lds
buffer_load_dwordx4 v71, s[16:19], s82 offen offset:3072 lds
s_add_u32 m0, m0, 4096
s_add_u32 s82, s82, 65536
buffer_load_dwordx4 v68, s[16:19], s82 offen offset:0 lds
s_waitcnt vmcnt(24)
s_barrier
s_mul_i32 s70, s60, 10
s_add_u32 s70, s70, 52
s_lshl_b32 s82, s70, 14
s_lshl_b32 s70, s70, 10
s_add_u32 m0, s70, 28672
s_nop 0
buffer_load_dwordx4 v68, s[16:19], s82 offen offset:0 lds
v_mov_b32 v26, v22
v_permlane32_swap_b32 v20, v24
v_permlane32_swap_b32 v21, v25
buffer_load_dwordx4 v69, s[16:19], s82 offen offset:1024 lds
v_permlane32_swap_b32 v22, v26
v_add_f32 v20, v20, v24
v_add_f32 v21, v21, v25
buffer_load_dwordx4 v70, s[16:19], s82 offen offset:2048 lds
v_add_f32 v22, v22, v26
v_and_b32 v3, 15, v1
v_lshlrev_b32 v3, 2, v3
buffer_load_dwordx4 v71, s[16:19], s82 offen offset:3072 lds
s_lshl_b32 s70, s60, 6
s_add_u32 s70, s70, 160768
v_add_u32 v3, s70, v3
ds_write_b32 v3, v20 offset:0
ds_write_b32 v3, v21 offset:256
s_add_u32 m0, m0, 4096
s_add_u32 s82, s82, 65536
buffer_load_dwordx4 v68, s[16:19], s82 offen offset:0 lds
ds_write_b32 v3, v22 offset:512
v_lshrrev_b32 v4, 2, v45
s_lshl_b32 s70, s60, 7
s_add_u32 s70, s70, 159744
v_add_u32 v4, s70, v4
buffer_load_dwordx4 v69, s[16:19], s82 offen offset:1024 lds
ds_write_b32 v4, v36
ds_write_b32 v4, v37 offset:512
s_getreg_b32 s71, hwreg(HW_REG_XCC_ID, 0, 4)
v_cmp_ne_u32 vcc, s71, v40
s_nop 0
s_and_b32 s70, vcc_lo, 0xffff
s_cselect_b32 s69, 0, 1
buffer_load_dwordx4 v70, s[16:19], s82 offen offset:2048 lds
v_mov_b32 v5, s69
v_mov_b32 v6, 161536
ds_write_b32 v6, v5
buffer_load_dwordx4 v71, s[16:19], s82 offen offset:3072 lds
s_add_u32 m0, m0, 4096
s_add_u32 s82, s82, 65536
buffer_load_dwordx4 v68, s[16:19], s82 offen offset:0 lds
buffer_load_dwordx4 v69, s[16:19], s82 offen offset:1024 lds
s_waitcnt vmcnt(19)
s_barrier
s_mul_i32 s70, s60, 10
s_add_u32 s70, s70, 12
s_lshl_b32 s82, s70, 14
s_lshl_b32 s70, s70, 10
s_add_u32 m0, s70, 28672
s_nop 0
buffer_load_dwordx4 v68, s[16:19], s82 offen offset:0 lds
buffer_load_dwordx4 v69, s[16:19], s82 offen offset:1024 lds
buffer_load_dwordx4 v70, s[16:19], s82 offen offset:2048 lds
buffer_load_dwordx4 v71, s[16:19], s82 offen offset:3072 lds
s_add_u32 m0, m0, 4096
s_add_u32 s82, s82, 65536
buffer_load_dwordx4 v68, s[16:19], s82 offen offset:0 lds
buffer_load_dwordx4 v69, s[16:19], s82 offen offset:1024 lds
buffer_load_dwordx4 v70, s[16:19], s82 offen offset:2048 lds
buffer_load_dwordx4 v71, s[16:19], s82 offen offset:3072 lds
s_add_u32 m0, m0, 4096
s_add_u32 s82, s82, 65536
buffer_load_dwordx4 v68, s[16:19], s82 offen offset:0 lds
buffer_load_dwordx4 v69, s[16:19], s82 offen offset:1024 lds
s_setprio 0
s_waitcnt lgkmcnt(0)
s_barrier
s_mul_i32 s70, s60, 3
s_add_u32 s70, s70, 0
s_lshl_b32 s82, s70, 14
s_lshl_b32 s70, s70, 10
s_add_u32 m0, s70, 28672
s_nop 0
buffer_load_dwordx4 v68, s[16:19], s82 offen offset:0 lds
buffer_load_dwordx4 v69, s[16:19], s82 offen offset:1024 lds
buffer_load_dwordx4 v70, s[16:19], s82 offen offset:2048 lds
s_sub_i32 s70, s64, s65
s_lshl_b32 s70, s70, 18
v_add_u32 v8, s70, v8
v_add_u32 v9, s70, v9
v_add_u32 v10, s70, v10
v_add_u32 v11, s70, v11
s_lshl_b32 s70, s65, 7
s_mov_b32 m0, s76
s_nop 0
buffer_load_dwordx4 v8, s[4:7], s70 offen offset:0 lds
buffer_load_dwordx4 v9, s[4:7], s70 offen offset:1024 lds
buffer_load_dwordx4 v10, s[4:7], s70 offen offset:2048 lds
buffer_load_dwordx4 v11, s[4:7], s70 offen offset:3072 lds
v_lshrrev_b32 v2, 4, v1
v_bfe_u32 v3, v1, 2, 2
v_and_b32 v4, 1, v1
v_lshlrev_b32 v4, 4, v4
v_mov_b32 v5, 0x3f80
v_lshlrev_b32 v4, v4, v5
v_cmp_eq_u32 vcc, v2, v3
s_nop 1
v_cndmask_b32 v4, 0, v4, vcc
v_and_b32 v5, 2, v1
v_cmp_eq_u32 vcc, 0, v5
s_nop 1
v_cndmask_b32 v58, 0, v4, vcc
v_cndmask_b32_e64 v59, v4, 0, vcc
v_mov_b32 v56, 0
v_mov_b32 v57, 0
v_mov_b32 v60, 0
v_mov_b32 v61, 0
v_and_b32 v3, 15, v1
v_mul_u32_u24 v55, 4352, v3
v_lshrrev_b32 v2, 4, v1
v_lshl_add_u32 v55, v2, 5, v55
s_mul_i32 s87, s64, 69632
s_add_u32 s87, s87, 524288
s_lshl_b32 s70, s66, 7
s_lshl_b32 s71, s67, 4
s_add_u32 s88, s70, s71
s_add_u32 s88, s88, s87
s_add_u32 s88, s88, 4096
s_lshl_b32 s70, s60, 10
s_add_u32 s87, s87, s70
s_barrier
s_add_u32 s70, s65, 1
s_and_b32 s70, s70, 15
s_mul_i32 s70, s70, 4352
s_add_u32 s70, s70, s87
buffer_load_dwordx4 v[84:87], v18, s[12:15], s70 offen sc1
s_add_u32 s70, s65, 2
s_and_b32 s70, s70, 15
s_mul_i32 s70, s70, 4352
s_add_u32 s70, s70, s87
buffer_load_dwordx4 v[88:91], v18, s[12:15], s70 offen sc1
s_add_u32 s70, s65, 3
s_and_b32 s70, s70, 15
s_mul_i32 s70, s70, 4352
s_add_u32 s70, s70, s87
buffer_load_dwordx4 v[92:95], v18, s[12:15], s70 offen sc1
s_add_u32 s70, s65, 4
s_and_b32 s70, s70, 15
s_mul_i32 s70, s70, 4352
s_add_u32 s70, s70, s87
buffer_load_dwordx4 v[96:99], v18, s[12:15], s70 offen sc1
s_add_u32 s70, s65, 5
s_and_b32 s70, s70, 15
s_mul_i32 s70, s70, 4352
s_add_u32 s70, s70, s87
buffer_load_dwordx4 v[100:103], v18, s[12:15], s70 offen sc1
s_add_u32 s70, s65, 6
s_and_b32 s70, s70, 15
s_mul_i32 s70, s70, 4352
s_add_u32 s70, s70, s87
buffer_load_dwordx4 v[104:107], v18, s[12:15], s70 offen sc1
s_add_u32 s70, s65, 7
s_and_b32 s70, s70, 15
s_mul_i32 s70, s70, 4352
s_add_u32 s70, s70, s87
buffer_load_dwordx4 v[108:111], v18, s[12:15], s70 offen sc1
s_add_u32 s70, s65, 8
s_and_b32 s70, s70, 15
s_mul_i32 s70, s70, 4352
s_add_u32 s70, s70, s87
buffer_load_dwordx4 v[112:115], v18, s[12:15], s70 offen sc1
s_add_u32 s70, s65, 9
s_and_b32 s70, s70, 15
s_mul_i32 s70, s70, 4352
s_add_u32 s70, s70, s87
buffer_load_dwordx4 v[116:119], v18, s[12:15], s70 offen sc1
s_add_u32 s70, s65, 10
s_and_b32 s70, s70, 15
s_mul_i32 s70, s70, 4352
s_add_u32 s70, s70, s87
buffer_load_dwordx4 v[120:123], v18, s[12:15], s70 offen sc1
s_add_u32 s70, s65, 11
s_and_b32 s70, s70, 15
s_mul_i32 s70, s70, 4352
s_add_u32 s70, s70, s87
buffer_load_dwordx4 v[124:127], v18, s[12:15], s70 offen sc1
s_add_u32 s70, s65, 12
s_and_b32 s70, s70, 15
s_mul_i32 s70, s70, 4352
s_add_u32 s70, s70, s87
buffer_load_dwordx4 v[128:131], v18, s[12:15], s70 offen sc1
s_add_u32 s70, s65, 13
s_and_b32 s70, s70, 15
s_mul_i32 s70, s70, 4352
s_add_u32 s70, s70, s87
buffer_load_dwordx4 v[132:135], v18, s[12:15], s70 offen sc1
s_add_u32 s70, s65, 14
s_and_b32 s70, s70, 15
s_mul_i32 s70, s70, 4352
s_add_u32 s70, s70, s87
buffer_load_dwordx4 v[136:139], v18, s[12:15], s70 offen sc1
s_add_u32 s70, s65, 15
s_and_b32 s70, s70, 15
s_mul_i32 s70, s70, 4352
s_add_u32 s70, s70, s87
buffer_load_dwordx4 v[140:143], v18, s[12:15], s70 offen sc1
s_add_u32 s70, s65, 16
s_and_b32 s70, s70, 15
s_mul_i32 s70, s70, 4352
s_add_u32 s70, s70, s87
buffer_load_dwordx4 v[144:147], v18, s[12:15], s70 offen sc1
buffer_load_dwordx4 v[148:151], v55, s[12:15], s88 offen sc1
s_waitcnt vmcnt(13)
L_kv0_chk:
v_max3_u32 v2, v84, v88, v92
v_max_u32 v2, v2, v96
v_cmp_eq_u32 vcc, -1, v2
s_cbranch_vccnz L_kv0_rt
L_kv0_ok:
v_mfma_f32_16x16x32_bf16 v[68:71], v[58:61], v[84:87], 0
v_mfma_f32_16x16x32_bf16 v[72:75], v[56:59], v[84:87], 0
v_mfma_f32_16x16x32_bf16 v[68:71], v[58:61], v[88:91], v[68:71]
v_mfma_f32_16x16x32_bf16 v[72:75], v[56:59], v[88:91], v[72:75]
v_mfma_f32_16x16x32_bf16 v[68:71], v[58:61], v[92:95], v[68:71]
v_mfma_f32_16x16x32_bf16 v[72:75], v[56:59], v[92:95], v[72:75]
v_mfma_f32_16x16x32_bf16 v[68:71], v[58:61], v[96:99], v[68:71]
v_mfma_f32_16x16x32_bf16 v[72:75], v[56:59], v[96:99], v[72:75]
s_waitcnt vmcnt(9)
L_kv1_chk:
v_max3_u32 v2, v100, v104, v108
v_max_u32 v2, v2, v112
v_cmp_eq_u32 vcc, -1, v2
s_cbranch_vccnz L_kv1_rt
L_kv1_ok:
v_mfma_f32_16x16x32_bf16 v[68:71], v[58:61], v[100:103], v[68:71]
v_mfma_f32_16x16x32_bf16 v[72:75], v[56:59], v[100:103], v[72:75]
v_mfma_f32_16x16x32_bf16 v[68:71], v[58:61], v[104:107], v[68:71]
v_mfma_f32_16x16x32_bf16 v[72:75], v[56:59], v[104:107], v[72:75]
v_mfma_f32_16x16x32_bf16 v[68:71], v[58:61], v[108:111], v[68:71]
v_mfma_f32_16x16x32_bf16 v[72:75], v[56:59], v[108:111], v[72:75]
v_mfma_f32_16x16x32_bf16 v[68:71], v[58:61], v[112:115], v[68:71]
v_mfma_f32_16x16x32_bf16 v[72:75], v[56:59], v[112:115], v[72:75]
s_waitcnt vmcnt(5)
L_kv2_chk:
v_max3_u32 v2, v116, v120, v124
v_max_u32 v2, v2, v128
v_cmp_eq_u32 vcc, -1, v2
s_cbranch_vccnz L_kv2_rt
L_kv2_ok:
v_mfma_f32_16x16x32_bf16 v[68:71], v[58:61], v[116:119], v[68:71]
v_mfma_f32_16x16x32_bf16 v[72:75], v[56:59], v[116:119], v[72:75]
v_mfma_f32_16x16x32_bf16 v[68:71], v[58:61], v[120:123], v[68:71]
v_mfma_f32_16x16x32_bf16 v[72:75], v[56:59], v[120:123], v[72:75]
v_mfma_f32_16x16x32_bf16 v[68:71], v[58:61], v[124:127], v[68:71]
v_mfma_f32_16x16x32_bf16 v[72:75], v[56:59], v[124:127], v[72:75]
v_mfma_f32_16x16x32_bf16 v[68:71], v[58:61], v[128:131], v[68:71]
v_mfma_f32_16x16x32_bf16 v[72:75], v[56:59], v[128:131], v[72:75]
s_waitcnt vmcnt(1)
L_kv3_chk:
v_max3_u32 v2, v132, v136, v140
v_max_u32 v2, v2, v144
v_cmp_eq_u32 vcc, -1, v2
s_cbranch_vccnz L_kv3_rt
L_kv3_ok:
v_mfma_f32_16x16x32_bf16 v[68:71], v[58:61], v[132:135], v[68:71]
v_mfma_f32_16x16x32_bf16 v[72:75], v[56:59], v[132:135], v[72:75]
v_mfma_f32_16x16x32_bf16 v[68:71], v[58:61], v[136:139], v[68:71]
v_mfma_f32_16x16x32_bf16 v[72:75], v[56:59], v[136:139], v[72:75]
v_mfma_f32_16x16x32_bf16 v[68:71], v[58:61], v[140:143], v[68:71]
v_mfma_f32_16x16x32_bf16 v[72:75], v[56:59], v[140:143], v[72:75]
v_mfma_f32_16x16x32_bf16 v[68:71], v[58:61], v[144:147], v[68:71]
v_mfma_f32_16x16x32_bf16 v[72:75], v[56:59], v[144:147], v[72:75]
s_waitcnt vmcnt(0)
L_z_chk:
v_cmp_eq_u32 vcc, -1, v148
s_cbranch_vccnz L_z_rt
L_z_ok:
v_add_f32_dpp v148, v148, v148 row_ror:1 row_mask:0xf bank_mask:0xf
v_add_f32_dpp v149, v149, v149 row_ror:1 row_mask:0xf bank_mask:0xf
v_add_f32_dpp v150, v150, v150 row_ror:1 row_mask:0xf bank_mask:0xf
v_add_f32_dpp v151, v151, v151 row_ror:1 row_mask:0xf bank_mask:0xf
v_add_f32_dpp v148, v148, v148 row_ror:2 row_mask:0xf bank_mask:0xf
v_add_f32_dpp v149, v149, v149 row_ror:2 row_mask:0xf bank_mask:0xf
v_add_f32_dpp v150, v150, v150 row_ror:2 row_mask:0xf bank_mask:0xf
v_add_f32_dpp v151, v151, v151 row_ror:2 row_mask:0xf bank_mask:0xf
v_add_f32_dpp v148, v148, v148 row_ror:4 row_mask:0xf bank_mask:0xf
v_add_f32_dpp v149, v149, v149 row_ror:4 row_mask:0xf bank_mask:0xf
v_add_f32_dpp v150, v150, v150 row_ror:4 row_mask:0xf bank_mask:0xf
v_add_f32_dpp v151, v151, v151 row_ror:4 row_mask:0xf bank_mask:0xf
v_add_f32_dpp v148, v148, v148 row_ror:8 row_mask:0xf bank_mask:0xf
v_add_f32_dpp v149, v149, v149 row_ror:8 row_mask:0xf bank_mask:0xf
v_add_f32_dpp v150, v150, v150 row_ror:8 row_mask:0xf bank_mask:0xf
v_add_f32_dpp v151, v151, v151 row_ror:8 row_mask:0xf bank_mask:0xf
v_cvt_pk_bf16_f32 v148, v148, v149
v_cvt_pk_bf16_f32 v149, v150, v151
s_lshl_b32 s70, s66, 6
s_lshl_b32 s71, s67, 3
s_add_u32 s70, s70, s71
s_add_u32 s70, s70, 161600
v_lshrrev_b32 v2, 4, v1
v_lshlrev_b32 v2, 4, v2
v_add_u32 v2, s70, v2
ds_write_b64 v2, v[148:149]
v_cvt_pk_bf16_f32 v68, v68, v69
v_cvt_pk_bf16_f32 v69, v70, v71
v_cvt_pk_bf16_f32 v70, v72, v73
v_cvt_pk_bf16_f32 v71, v74, v75
s_lshl_b32 s70, s60, 10
s_add_u32 s70, s70, 24576
v_add_u32 v3, s70, v18
ds_write_b128 v3, v[68:71]
s_waitcnt lgkmcnt(0)
s_barrier
s_barrier
s_cmp_ge_u32 s64, 14
s_cbranch_scc1 L_noprep0
v_lshrrev_b32 v2, 5, v1
v_lshlrev_b32 v2, 11, v2
v_bfe_u32 v3, v1, 3, 2
v_lshl_add_u32 v2, v3, 7, v2
v_bfe_u32 v3, v1, 4, 1
v_bfe_u32 v4, v1, 1, 2
v_xor_b32 v3, v3, v4
v_lshl_add_u32 v2, v3, 5, v2
v_and_b32 v3, 1, v1
v_lshl_add_u32 v2, v3, 4, v2
s_lshl_b32 s70, s60, 13
s_add_u32 s70, s70, 65536
v_add_u32 v2, s70, v2
v_xor_b32 v3, 64, v2
s_mov_b32 s94, 0x05040100
s_mov_b32 s95, 0x07060302
s_waitcnt vmcnt(0)
ds_write_b128 v2, a[0:3] offset:0
ds_write_b128 v3, a[4:7] offset:512
ds_write_b128 v2, a[8:11] offset:1024
ds_write_b128 v3, a[12:15] offset:1536
ds_write_b128 v2, a[16:19] offset:4096
ds_write_b128 v3, a[20:23] offset:4608
ds_write_b128 v2, a[24:27] offset:5120
ds_write_b128 v3, a[28:31] offset:5632
ds_write_b128 v2, a[32:35] offset:32768
ds_write_b128 v3, a[36:39] offset:33280
ds_write_b128 v2, a[40:43] offset:33792
ds_write_b128 v3, a[44:47] offset:34304
ds_write_b128 v2, a[48:51] offset:36864
ds_write_b128 v3, a[52:55] offset:37376
ds_write_b128 v2, a[56:59] offset:37888
ds_write_b128 v3, a[60:63] offset:38400
v_accvgpr_read_b32 v84, a64
v_accvgpr_read_b32 v85, a65
v_accvgpr_read_b32 v86, a66
v_accvgpr_read_b32 v87, a67
v_accvgpr_read_b32 v88, a68
v_accvgpr_read_b32 v89, a69
v_accvgpr_read_b32 v90, a70
v_accvgpr_read_b32 v91, a71
v_accvgpr_read_b32 v92, a72
v_accvgpr_read_b32 v93, a73
v_accvgpr_read_b32 v94, a74
v_accvgpr_read_b32 v95, a75
v_accvgpr_read_b32 v96, a76
v_accvgpr_read_b32 v97, a77
v_accvgpr_read_b32 v98, a78
v_accvgpr_read_b32 v99, a79
v_accvgpr_read_b32 v100, a80
v_accvgpr_read_b32 v101, a81
v_accvgpr_read_b32 v102, a82
v_accvgpr_read_b32 v103, a83
v_accvgpr_read_b32 v104, a84
v_accvgpr_read_b32 v105, a85
v_accvgpr_read_b32 v106, a86
v_accvgpr_read_b32 v107, a87
v_accvgpr_read_b32 v108, a88
v_accvgpr_read_b32 v109, a89
v_accvgpr_read_b32 v110, a90
v_accvgpr_read_b32 v111, a91
v_accvgpr_read_b32 v112, a92
v_accvgpr_read_b32 v113, a93
v_accvgpr_read_b32 v114, a94
v_accvgpr_read_b32 v115, a95
v_perm_b32 v116, v88, v84, s94
v_perm_b32 v117, v96, v92, s94
v_perm_b32 v118, v88, v84, s95
v_perm_b32 v119, v96, v92, s95
v_perm_b32 v120, v89, v85, s94
v_perm_b32 v121, v97, v93, s94
v_perm_b32 v122, v89, v85, s95
v_perm_b32 v123, v97, v93, s95
v_perm_b32 v124, v90, v86, s94
v_perm_b32 v125, v98, v94, s94
v_perm_b32 v126, v90, v86, s95
v_perm_b32 v127, v98, v94, s95
v_perm_b32 v128, v91, v87, s94
v_perm_b32 v129, v99, v95, s94
v_perm_b32 v130, v91, v87, s95
v_perm_b32 v131, v99, v95, s95
v_perm_b32 v132, v104, v100, s94
v_perm_b32 v133, v112, v108, s94
v_perm_b32 v134, v104, v100, s95
v_perm_b32 v135, v112, v108, s95
v_perm_b32 v136, v105, v101, s94
v_perm_b32 v137, v113, v109, s94
v_perm_b32 v138, v105, v101, s95
v_perm_b32 v139, v113, v109, s95
v_perm_b32 v140, v106, v102, s94
v_perm_b32 v141, v114, v110, s94
v_perm_b32 v142, v106, v102, s95
v_perm_b32 v143, v114, v110, s95
v_perm_b32 v144, v107, v103, s94
v_perm_b32 v145, v115, v111, s94
v_perm_b32 v146, v107, v103, s95
v_perm_b32 v147, v115, v111, s95
s_waitcnt lgkmcnt(0)
L_noprep0:
s_barrier
s_cmp_ge_u32 s64, 14
s_cbranch_scc1 L_noprep
v_lshrrev_b32 v2, 2, v1
v_bfe_u32 v3, v1, 3, 2
v_xor_b32 v3, s60, v3
v_lshlrev_b32 v3, 5, v3
v_lshl_add_u32 v3, v2, 7, v3
v_and_b32 v2, 3, v1
v_lshl_add_u32 v3, v2, 3, v3
v_add_u32 v3, 65536, v3
ds_read_b64_tr_b16 a[0:1], v3 offset:0
ds_read_b64_tr_b16 a[2:3], v3 offset:2048
ds_read_b64_tr_b16 a[32:33], v3 offset:32768
ds_read_b64_tr_b16 a[34:35], v3 offset:34816
ds_read_b64_tr_b16 a[4:5], v3 offset:4096
ds_read_b64_tr_b16 a[6:7], v3 offset:6144
ds_read_b64_tr_b16 a[36:37], v3 offset:36864
ds_read_b64_tr_b16 a[38:39], v3 offset:38912
ds_read_b64_tr_b16 a[8:9], v3 offset:8192
ds_read_b64_tr_b16 a[10:11], v3 offset:10240
ds_read_b64_tr_b16 a[40:41], v3 offset:40960
ds_read_b64_tr_b16 a[42:43], v3 offset:43008
ds_read_b64_tr_b16 a[12:13], v3 offset:12288
ds_read_b64_tr_b16 a[14:15], v3 offset:14336
ds_read_b64_tr_b16 a[44:45], v3 offset:45056
ds_read_b64_tr_b16 a[46:47], v3 offset:47104
ds_read_b64_tr_b16 a[16:17], v3 offset:16384
ds_read_b64_tr_b16 a[18:19], v3 offset:18432
ds_read_b64_tr_b16 a[48:49], v3 offset:49152
ds_read_b64_tr_b16 a[50:51], v3 offset:51200
ds_read_b64_tr_b16 a[20:21], v3 offset:20480
ds_read_b64_tr_b16 a[22:23], v3 offset:22528
ds_read_b64_tr_b16 a[52:53], v3 offset:53248
ds_read_b64_tr_b16 a[54:55], v3 offset:55296
ds_read_b64_tr_b16 a[24:25], v3 offset:24576
ds_read_b64_tr_b16 a[26:27], v3 offset:26624
ds_read_b64_tr_b16 a[56:57], v3 offset:57344
ds_read_b64_tr_b16 a[58:59], v3 offset:59392
ds_read_b64_tr_b16 a[28:29], v3 offset:28672
ds_read_b64_tr_b16 a[30:31], v3 offset:30720
ds_read_b64_tr_b16 a[60:61], v3 offset:61440
ds_read_b64_tr_b16 a[62:63], v3 offset:63488
v_mov_b32 v76, 0x3f803f80
v_mov_b32 v77, 0x3f803f80
v_mov_b32 v78, 0x3f803f80
v_mov_b32 v79, 0x3f803f80
s_waitcnt lgkmcnt(0)
s_nop 0
v_mfma_f32_16x16x32_bf16 v[68:71], a[0:3], v[76:79], 0
v_mfma_f32_16x16x32_bf16 v[72:75], a[32:35], v[76:79], 0
v_mfma_f32_16x16x32_bf16 v[68:71], a[4:7], v[76:79], v[68:71]
v_mfma_f32_16x16x32_bf16 v[72:75], a[36:39], v[76:79], v[72:75]
v_mfma_f32_16x16x32_bf16 v[68:71], a[8:11], v[76:79], v[68:71]
v_mfma_f32_16x16x32_bf16 v[72:75], a[40:43], v[76:79], v[72:75]
v_mfma_f32_16x16x32_bf16 v[68:71], a[12:15], v[76:79], v[68:71]
v_mfma_f32_16x16x32_bf16 v[72:75], a[44:47], v[76:79], v[72:75]
v_mfma_f32_16x16x32_bf16 v[68:71], a[16:19], v[76:79], v[68:71]
v_mfma_f32_16x16x32_bf16 v[72:75], a[48:51], v[76:79], v[72:75]
v_mfma_f32_16x16x32_bf16 v[68:71], a[20:23], v[76:79], v[68:71]
v_mfma_f32_16x16x32_bf16 v[72:75], a[52:55], v[76:79], v[72:75]
v_mfma_f32_16x16x32_bf16 v[68:71], a[24:27], v[76:79], v[68:71]
v_mfma_f32_16x16x32_bf16 v[72:75], a[56:59], v[76:79], v[72:75]
v_mfma_f32_16x16x32_bf16 v[68:71], a[28:31], v[76:79], v[68:71]
v_mfma_f32_16x16x32_bf16 v[72:75], a[60:63], v[76:79], v[72:75]
L_noprep:
v_and_b32 v2, 1, v1
v_lshlrev_b32 v56, 4, v2
v_add_u32 v56, 161856, v56
v_lshrrev_b32 v3, 4, v1
v_lshlrev_b32 v57, 4, v3
s_and_b32 s71, s65, 3
s_lshl_b32 s70, s71, 9
s_add_u32 s70, s70, 6881280
v_add_u32 v57, s70, v57
v_and_b32 v58, 3, v1
v_lshlrev_b32 v58, 6, v58
v_lshl_add_u32 v58, v3, 4, v58
s_sub_u32 s85, s79, s71
s_add_u32 s85, s85, s60
s_lshl_b32 s85, s85, 10
s_lshl_b32 s71, s71, 8
s_add_u32 s85, s85, s71
s_add_u32 s85, s85, 6946816
s_lshl_b32 s86, s79, 10
s_add_u32 s86, s86, 6946816
v_bfe_u32 v60, v1, 1, 3
v_mov_b32 v59, s68
s_movk_i32 s94, 0xff
s_barrier
ds_read_b128 v[20:23], v56
s_mov_b32 s92, 0x00030003
s_mov_b32 s93, 0x00030003
s_sub_u32 s88, s63, 24
s_lshl_b32 s70, s62, 3
s_add_u32 s88, s88, s70
s_waitcnt lgkmcnt(0)
s_cmp_ge_u32 s64, 14
s_cbranch_scc1 L_nomoe
v_lshl_add_u32 v57, v23, 11, v57
s_mov_b64 exec, s[92:93]
buffer_load_dwordx4 v[24:27], v57, s[12:15], 0 offen offset:0 sc1
buffer_load_dwordx4 v[28:31], v57, s[12:15], 0 offen offset:64 sc1
buffer_load_dwordx4 v[32:35], v57, s[12:15], 0 offen offset:128 sc1
buffer_load_dwordx4 v[36:39], v57, s[12:15], 0 offen offset:192 sc1
buffer_load_dwordx4 v[40:43], v57, s[12:15], 0 offen offset:256 sc1
buffer_load_dwordx4 v[44:47], v57, s[12:15], 0 offen offset:320 sc1
buffer_load_dwordx4 v[48:51], v57, s[12:15], 0 offen offset:384 sc1
buffer_load_dwordx4 v[52:55], v57, s[12:15], 0 offen offset:448 sc1
v_mul_f32_e64 v68, v68, -v21
v_mul_f32_e64 v69, v69, -v21
v_mul_f32_e64 v70, v70, -v21
v_mul_f32_e64 v71, v71, -v21
v_mul_f32_e64 v72, v72, -v21
v_mul_f32_e64 v73, v73, -v21
v_mul_f32_e64 v74, v74, -v21
v_mul_f32_e64 v75, v75, -v21
s_waitcnt vmcnt(0)
L_x_chk:
v_max3_u32 v2, v24, v28, v32
v_max3_u32 v3, v36, v40, v44
v_max3_u32 v2, v2, v48, v52
v_max_u32 v2, v2, v3
v_cmp_eq_u32 vcc, -1, v2
s_cbranch_vccnz L_x_rt
L_x_ok:
s_mov_b64 exec, -1
v_mfma_f32_16x16x32_bf16 v[68:71], a[0:3], v[24:27], v[68:71]
v_mfma_f32_16x16x32_bf16 v[72:75], a[32:35], v[24:27], v[72:75]
v_mfma_f32_16x16x32_bf16 v[68:71], a[4:7], v[28:31], v[68:71]
v_mfma_f32_16x16x32_bf16 v[72:75], a[36:39], v[28:31], v[72:75]
v_mfma_f32_16x16x32_bf16 v[68:71], a[8:11], v[32:35], v[68:71]
v_mfma_f32_16x16x32_bf16 v[72:75], a[40:43], v[32:35], v[72:75]
v_mfma_f32_16x16x32_bf16 v[68:71], a[12:15], v[36:39], v[68:71]
v_mfma_f32_16x16x32_bf16 v[72:75], a[44:47], v[36:39], v[72:75]
v_mfma_f32_16x16x32_bf16 v[68:71], a[16:19], v[40:43], v[68:71]
v_mfma_f32_16x16x32_bf16 v[72:75], a[48:51], v[40:43], v[72:75]
v_mfma_f32_16x16x32_bf16 v[68:71], a[20:23], v[44:47], v[68:71]
v_mfma_f32_16x16x32_bf16 v[72:75], a[52:55], v[44:47], v[72:75]
v_mfma_f32_16x16x32_bf16 v[68:71], a[24:27], v[48:51], v[68:71]
v_mfma_f32_16x16x32_bf16 v[72:75], a[56:59], v[48:51], v[72:75]
v_mfma_f32_16x16x32_bf16 v[68:71], a[28:31], v[52:55], v[68:71]
v_mfma_f32_16x16x32_bf16 v[72:75], a[60:63], v[52:55], v[72:75]
s_nop 6
v_bfi_b32 v68, s94, v59, v68
v_bfi_b32 v69, s94, v59, v69
v_bfi_b32 v70, s94, v59, v70
v_bfi_b32 v71, s94, v59, v71
v_bfi_b32 v72, s94, v59, v72
v_bfi_b32 v73, s94, v59, v73
v_bfi_b32 v74, s94, v59, v74
v_bfi_b32 v75, s94, v59, v75
s_mov_b64 exec, s[92:93]
s_cmp_eq_u32 s69, 0
s_cbranch_scc1 L_pxp_s
buffer_store_dwordx4 v[68:71], v58, s[12:15], s85 offen offset:0
buffer_store_dwordx4 v[72:75], v58, s[12:15], s85 offen offset:128
L_pxp_d:
s_mov_b64 exec, -1
buffer_load_dwordx4 v[24:27], v58, s[12:15], s86 offen offset:0 sc1
buffer_load_dwordx4 v[28:31], v58, s[12:15], s86 offen offset:256 sc1
buffer_load_dwordx4 v[32:35], v58, s[12:15], s86 offen offset:512 sc1
buffer_load_dwordx4 v[36:39], v58, s[12:15], s86 offen offset:768 sc1
s_waitcnt vmcnt(0)
L_px_chk:
v_xor_b32 v40, v59, v24
v_xor_b32 v41, v59, v25
v_xor_b32 v42, v59, v26
v_xor_b32 v43, v59, v27
v_xor_b32 v44, v59, v28
v_xor_b32 v45, v59, v29
v_xor_b32 v46, v59, v30
v_xor_b32 v47, v59, v31
v_xor_b32 v48, v59, v32
v_xor_b32 v49, v59, v33
v_xor_b32 v50, v59, v34
v_xor_b32 v51, v59, v35
v_xor_b32 v52, v59, v36
v_xor_b32 v53, v59, v37
v_xor_b32 v54, v59, v38
v_xor_b32 v55, v59, v39
v_or3_b32 v40, v40, v41, v42
v_or3_b32 v43, v43, v44, v45
v_or3_b32 v46, v46, v47, v48
v_or3_b32 v49, v49, v50, v51
v_or3_b32 v52, v52, v53, v54
v_or3_b32 v2, v40, v43, v46
v_or3_b32 v3, v49, v52, v55
v_or_b32 v2, v2, v3
v_and_b32 v2, 0xff, v2
v_cmp_ne_u32 vcc, 0, v2
s_cbranch_vccnz L_px_rt
L_px_ok:
v_pk_add_f32 v[24:25], v[24:25], v[28:29]
v_pk_add_f32 v[32:33], v[32:33], v[36:37]
v_pk_add_f32 v[26:27], v[26:27], v[30:31]
v_pk_add_f32 v[34:35], v[34:35], v[38:39]
v_pk_add_f32 v[24:25], v[24:25], v[32:33]
v_pk_add_f32 v[26:27], v[26:27], v[34:35]
v_pk_mul_f32 v[24:25], v[24:25], v[22:23] op_sel_hi:[1,0]
v_pk_mul_f32 v[26:27], v[26:27], v[22:23] op_sel_hi:[1,0]
v_mul_f32 v28, 0xbfb8aa3b, v24
v_mul_f32 v29, 0xbfb8aa3b, v25
v_mul_f32 v30, 0xbfb8aa3b, v26
v_mul_f32 v31, 0xbfb8aa3b, v27
v_exp_f32 v28, v28
v_exp_f32 v29, v29
v_exp_f32 v30, v30
v_exp_f32 v31, v31
v_mul_f32_dpp v32, v24, v24 quad_perm:[2,3,0,1] row_mask:0xf bank_mask:0xf
v_mul_f32_dpp v33, v25, v25 quad_perm:[2,3,0,1] row_mask:0xf bank_mask:0xf
v_mul_f32_dpp v34, v26, v26 quad_perm:[2,3,0,1] row_mask:0xf bank_mask:0xf
v_mul_f32_dpp v35, v27, v27 quad_perm:[2,3,0,1] row_mask:0xf bank_mask:0xf
v_add_f32 v28, 1.0, v28
v_add_f32 v29, 1.0, v29
v_add_f32 v30, 1.0, v30
v_add_f32 v31, 1.0, v31
v_rcp_f32 v28, v28
v_rcp_f32 v29, v29
v_rcp_f32 v30, v30
v_rcp_f32 v31, v31
v_mul_f32 v24, v32, v28
v_mul_f32 v25, v33, v29
v_mul_f32 v26, v34, v30
v_mul_f32 v27, v35, v31
v_cvt_pk_bf16_f32 v28, v24, v25
v_cvt_pk_bf16_f32 v29, v26, v27
s_nop 0
v_mov_b32_dpp v24, v28 quad_perm:[0,1,0,1] row_mask:0xf bank_mask:0xf
v_mov_b32_dpp v25, v29 quad_perm:[0,1,0,1] row_mask:0xf bank_mask:0xf
v_cmp_eq_u32 vcc, 0, v60
s_nop 1
v_cndmask_b32 v32, 0, v24, vcc
v_cndmask_b32 v33, 0, v25, vcc
v_cmp_eq_u32 vcc, 1, v60
s_nop 1
v_cndmask_b32 v34, 0, v24, vcc
v_cndmask_b32 v35, 0, v25, vcc
v_cmp_eq_u32 vcc, 2, v60
s_nop 1
v_cndmask_b32 v36, 0, v24, vcc
v_cndmask_b32 v37, 0, v25, vcc
v_cmp_eq_u32 vcc, 3, v60
s_nop 1
v_cndmask_b32 v38, 0, v24, vcc
v_cndmask_b32 v39, 0, v25, vcc
v_cmp_eq_u32 vcc, 4, v60
s_nop 1
v_cndmask_b32 v40, 0, v24, vcc
v_cndmask_b32 v41, 0, v25, vcc
v_cmp_eq_u32 vcc, 5, v60
s_nop 1
v_cndmask_b32 v42, 0, v24, vcc
v_cndmask_b32 v43, 0, v25, vcc
v_cmp_eq_u32 vcc, 6, v60
s_nop 1
v_cndmask_b32 v44, 0, v24, vcc
v_cndmask_b32 v45, 0, v25, vcc
v_cmp_eq_u32 vcc, 7, v60
s_nop 1
v_cndmask_b32 v46, 0, v24, vcc
v_cndmask_b32 v47, 0, v25, vcc
v_mfma_f32_16x16x32_bf16 v[68:71], v[116:119], v[32:35], 0
v_mfma_f32_16x16x32_bf16 v[72:75], v[132:135], v[32:35], 0
v_mfma_f32_16x16x32_bf16 v[68:71], v[120:123], v[36:39], v[68:71]
v_mfma_f32_16x16x32_bf16 v[72:75], v[136:139], v[36:39], v[72:75]
v_mfma_f32_16x16x32_bf16 v[68:71], v[124:127], v[40:43], v[68:71]
v_mfma_f32_16x16x32_bf16 v[72:75], v[140:143], v[40:43], v[72:75]
v_mfma_f32_16x16x32_bf16 v[68:71], v[128:131], v[44:47], v[68:71]
v_mfma_f32_16x16x32_bf16 v[72:75], v[144:147], v[44:47], v[72:75]
s_lshl_b32 s70, s79, 13
s_lshl_b32 s71, s60, 11
s_add_u32 s70, s70, s71
s_add_u32 s70, s70, 7340032
s_nop 2
buffer_store_dwordx4 v[68:71], v18, s[12:15], s70 offen offset:0 sc1
buffer_store_dwordx4 v[72:75], v18, s[12:15], s70 offen offset:1024 sc1
L_nomoe:
s_cmp_lt_u32 s63, 24
s_cbranch_scc1 L_ldone
v_lshrrev_b32 v2, 3, v1
v_and_b32 v3, 7, v1
v_lshlrev_b32 v62, 13, v2
v_lshl_add_u32 v62, v3, 4, v62
s_mul_i32 s87, s60, 458752
s_lshl_b32 s70, s88, 7
s_add_u32 s87, s87, s70
s_add_u32 s87, s87, 7340032
s_lshr_b32 s70, s88, 1
s_lshl_b32 s70, s70, 5
s_and_b32 s71, s88, 1
s_lshl_b32 s71, s71, 2
s_add_u32 s70, s70, s71
v_bfe_u32 v4, v1, 3, 2
v_lshlrev_b32 v4, 3, v4
v_bfe_u32 v5, v1, 1, 2
v_add3_u32 v63, v4, v5, s70
v_lshlrev_b32 v63, 1, v63
v_lshl_add_u32 v64, v23, 11, v63
s_mov_b32 s72, 6881280
buffer_load_ushort v61, v64, s[12:15], s72 offen sc1
s_add_u32 s70, s87, 0
buffer_load_dwordx4 v[24:27], v62, s[12:15], s70 offen sc1
s_add_u32 s70, s87, 65536
buffer_load_dwordx4 v[28:31], v62, s[12:15], s70 offen sc1
s_add_u32 s70, s87, 131072
buffer_load_dwordx4 v[32:35], v62, s[12:15], s70 offen sc1
s_add_u32 s70, s87, 196608
buffer_load_dwordx4 v[36:39], v62, s[12:15], s70 offen sc1
s_add_u32 s70, s87, 262144
buffer_load_dwordx4 v[40:43], v62, s[12:15], s70 offen sc1
s_add_u32 s70, s87, 327680
buffer_load_dwordx4 v[44:47], v62, s[12:15], s70 offen sc1
s_add_u32 s70, s87, 393216
buffer_load_dwordx4 v[48:51], v62, s[12:15], s70 offen sc1
v_and_b32 v65, 0xfffff800, v20
v_not_b32 v4, v65
v_ashrrev_i32 v4, 31, v4
v_or_b32 v4, 0x80000000, v4
v_xor_b32 v65, v65, v4
v_mul_f32 v65, 0xbfb8aa3b, v65
v_exp_f32 v65, v65
s_nop 0
v_add_f32 v65, 1.0, v65
v_rcp_f32 v65, v65
v_and_b32 v66, 0x7ff, v20
v_sub_u32 v66, 2047, v66
v_lshl_add_u32 v66, v66, 11, v63
v_add_f32 v67, 1.0, v22
v_mul_f32_e64 v21, -v21, v22
s_lshl_b32 s71, s60, 7
s_add_u32 s71, s71, 163072
v_lshlrev_b32 v6, 4, v3
v_add_u32 v6, s71, v6
v_bfe_u32 v4, v1, 3, 2
v_lshlrev_b32 v7, 4, v3
v_lshl_add_u32 v7, v4, 2, v7
v_add_u32 v7, 163072, v7
s_waitcnt vmcnt(0)
L_y_chk:
v_max3_u32 v2, v24, v28, v32
v_max3_u32 v4, v36, v40, v44
v_max3_u32 v2, v2, v4, v48
v_or_b32 v4, 0xffff0000, v61
v_max_u32 v2, v2, v4
v_cmp_eq_u32 vcc, -1, v2
s_cbranch_vccnz L_y_rt
L_y_ok:
v_pk_add_f32 v[24:25], v[24:25], v[28:29]
v_pk_add_f32 v[26:27], v[26:27], v[30:31]
v_pk_add_f32 v[32:33], v[32:33], v[36:37]
v_pk_add_f32 v[34:35], v[34:35], v[38:39]
v_pk_add_f32 v[40:41], v[40:41], v[44:45]
v_pk_add_f32 v[42:43], v[42:43], v[46:47]
v_pk_add_f32 v[24:25], v[24:25], v[32:33]
v_pk_add_f32 v[26:27], v[26:27], v[34:35]
v_pk_add_f32 v[40:41], v[40:41], v[48:49]
v_pk_add_f32 v[42:43], v[42:43], v[50:51]
v_pk_add_f32 v[24:25], v[24:25], v[40:41]
v_pk_add_f32 v[26:27], v[26:27], v[42:43]
s_nop 0
v_add_f32_dpp v24, v24, v24 row_ror:8 row_mask:0xf bank_mask:0xf
v_add_f32_dpp v25, v25, v25 row_ror:8 row_mask:0xf bank_mask:0xf
v_add_f32_dpp v26, v26, v26 row_ror:8 row_mask:0xf bank_mask:0xf
v_add_f32_dpp v27, v27, v27 row_ror:8 row_mask:0xf bank_mask:0xf
v_mov_b32 v28, v24
v_mov_b32 v29, v25
v_mov_b32 v30, v26
v_mov_b32 v31, v27
v_permlane16_swap_b32 v24, v28
v_permlane16_swap_b32 v25, v29
v_permlane16_swap_b32 v26, v30
v_permlane16_swap_b32 v27, v31
v_add_f32 v24, v24, v28
v_add_f32 v25, v25, v29
v_add_f32 v26, v26, v30
v_add_f32 v27, v27, v31
v_mov_b32 v28, v24
v_mov_b32 v29, v25
v_mov_b32 v30, v26
v_mov_b32 v31, v27
v_permlane32_swap_b32 v24, v28
v_permlane32_swap_b32 v25, v29
v_permlane32_swap_b32 v26, v30
v_permlane32_swap_b32 v27, v31
v_add_f32 v24, v24, v28
v_add_f32 v25, v25, v29
v_add_f32 v26, v26, v30
v_add_f32 v27, v27, v31
ds_write_b128 v6, v[24:27]
s_waitcnt lgkmcnt(0)
s_barrier
s_cmp_lg_u32 s60, 0
s_cbranch_scc1 L_ldone
ds_read_b32 v24, v7 offset:0
ds_read_b32 v25, v7 offset:128
ds_read_b32 v26, v7 offset:256
ds_read_b32 v27, v7 offset:384
v_lshlrev_b32 v61, 16, v61
v_fma_f32 v61, v61, v67, v21
s_waitcnt lgkmcnt(0)
v_add_f32 v24, v24, v25
v_add_f32 v26, v26, v27
v_add_f32 v24, v24, v26
v_fmac_f32 v61, v24, v65
v_cvt_pk_bf16_f32 v61, v61, v61
s_mov_b64 exec, 0xffffffff
buffer_store_short v61, v66, s[20:23], 0 offen sc1
L_ldone:
s_endpgm
L_compute:
v_and_b32 v2, 15, v1
v_lshrrev_b32 v4, 4, v1
v_lshrrev_b32 v3, 1, v2
v_xor_b32 v3, v3, v4
v_lshlrev_b32 v2, 7, v2
s_lshl_b32 s70, s66, 13
v_add_u32 v2, s70, v2
v_xor_b32 v5, 0, v3
v_lshl_add_u32 v8, v5, 4, v2
v_add_u32 v10, 65536, v8
v_xor_b32 v5, 4, v3
v_lshl_add_u32 v9, v5, 4, v2
v_add_u32 v11, 65536, v9
v_lshrrev_b32 v2, 5, v1
v_mul_u32_u24 v2, 6144, v2
v_bfe_u32 v3, v1, 4, 1
v_lshl_add_u32 v2, v3, 10, v2
v_bfe_u32 v4, v1, 2, 2
v_lshl_add_u32 v2, v4, 7, v2
v_lshlrev_b32 v3, 1, v3
v_bfe_u32 v4, v1, 3, 1
v_or_b32 v3, v3, v4
s_lshl_b32 s70, s67, 1
v_xor_b32 v3, s70, v3
v_and_b32 v4, 3, v1
v_lshl_add_u32 v2, v4, 3, v2
v_xor_b32 v4, 0, v3
v_lshl_add_u32 v12, v4, 5, v2
v_add_u32 v14, 65536, v12
v_xor_b32 v4, 1, v3
v_lshl_add_u32 v13, v4, 5, v2
v_add_u32 v15, 65536, v13
s_waitcnt lgkmcnt(0)
s_mov_b32 s12, s58
s_and_b32 s13, s59, 0xffff
s_mov_b32 s14, 268435456
s_mov_b32 s15, 0x20000
s_mov_b32 s36, s48
s_and_b32 s37, s49, 0xffff
s_mov_b32 s38, 2048
s_mov_b32 s39, 0x20000
s_mov_b32 s20, s56
s_and_b32 s21, s57, 0xffff
s_mov_b32 s22, 4194304
s_mov_b32 s23, 0x20000
s_lshl_b32 s87, s64, 4
s_add_u32 s87, s87, s65
s_mul_i32 s87, s87, 4352
s_add_u32 s87, s87, 524288
s_lshl_b32 s88, s65, 18
s_lshl_b32 s70, s66, 17
s_add_u32 s88, s88, s70
s_lshl_b32 s70, s64, 11
s_add_u32 s88, s88, s70
s_lshl_b32 s70, s67, 10
s_add_u32 s88, s88, s70
s_add_u32 s88, s88, 2097152
v_mov_b32 v2, 0
buffer_load_dword v19, v2, s[12:15], 0 offen sc1
buffer_load_dwordx4 v[24:27], v16, s[36:39], 0 offen
buffer_load_dwordx4 v[28:31], v16, s[36:39], 0 offen offset:1024
v_lshrrev_b32 v3, 4, v1
v_lshlrev_b32 v3, 3, v3
s_lshl_b32 s70, s65, 7
buffer_load_dwordx2 a[96:97], v3, s[36:39], s70 offen offset:0
buffer_load_dwordx2 a[98:99], v3, s[36:39], s70 offen offset:32
buffer_load_dwordx2 a[100:101], v3, s[36:39], s70 offen offset:64
buffer_load_dwordx2 a[102:103], v3, s[36:39], s70 offen offset:96
v_mov_b32 v32, 0
v_mov_b32 v33, 0
v_mov_b32 v34, 0
v_mov_b32 v35, 0
v_mov_b32 v36, 0
v_mov_b32 v37, 0
v_mov_b32 v38, 0
v_mov_b32 v39, 0
v_mov_b32 v40, 0
v_mov_b32 v41, 0
v_mov_b32 v42, 0
v_mov_b32 v43, 0
v_mov_b32 v44, 0
v_mov_b32 v45, 0
v_mov_b32 v46, 0
v_mov_b32 v47, 0
v_mov_b32 v48, 0
v_mov_b32 v49, 0
v_mov_b32 v50, 0
v_mov_b32 v51, 0
v_mov_b32 v52, 0
v_mov_b32 v53, 0
v_mov_b32 v54, 0
v_mov_b32 v55, 0
v_mov_b32 v56, 0
v_mov_b32 v57, 0
v_mov_b32 v58, 0
v_mov_b32 v59, 0
v_mov_b32 v60, 0
v_mov_b32 v61, 0
v_mov_b32 v62, 0
v_mov_b32 v63, 0
v_mov_b32 v64, 0
v_mov_b32 v65, 0
v_mov_b32 v66, 0
v_mov_b32 v67, 0
v_mov_b32 v68, 0
v_mov_b32 v69, 0
v_mov_b32 v70, 0
v_mov_b32 v71, 0
v_mov_b32 v72, 0
v_mov_b32 v73, 0
v_mov_b32 v74, 0
v_mov_b32 v75, 0
v_mov_b32 v76, 0
v_mov_b32 v77, 0
v_mov_b32 v78, 0
v_mov_b32 v79, 0
v_mov_b32 v80, 0
v_mov_b32 v81, 0
v_mov_b32 v82, 0
v_mov_b32 v83, 0
v_mov_b32 v84, 0
v_mov_b32 v85, 0
v_mov_b32 v86, 0
v_mov_b32 v87, 0
v_mov_b32 v88, 0
v_mov_b32 v89, 0
v_mov_b32 v90, 0
v_mov_b32 v91, 0
v_mov_b32 v92, 0
v_mov_b32 v93, 0
v_mov_b32 v94, 0
v_mov_b32 v95, 0
v_mov_b32 v96, 0
v_mov_b32 v97, 0
v_mov_b32 v98, 0
v_mov_b32 v99, 0
v_mov_b32 v100, 0
v_mov_b32 v101, 0
v_mov_b32 v102, 0
v_mov_b32 v103, 0
v_mov_b32 v104, 0
v_mov_b32 v105, 0
v_mov_b32 v106, 0
v_mov_b32 v107, 0
v_mov_b32 v108, 0
v_mov_b32 v109, 0
v_mov_b32 v110, 0
v_mov_b32 v111, 0
v_mov_b32 v112, 0
v_mov_b32 v113, 0
v_mov_b32 v114, 0
v_mov_b32 v115, 0
v_mov_b32 v116, 0
v_mov_b32 v117, 0
v_mov_b32 v118, 0
v_mov_b32 v119, 0
v_mov_b32 v120, 0
v_mov_b32 v121, 0
v_mov_b32 v122, 0
v_mov_b32 v123, 0
v_mov_b32 v124, 0
v_mov_b32 v125, 0
v_mov_b32 v126, 0
v_mov_b32 v127, 0
s_mov_b32 s70, 0x3f803f80
v_accvgpr_write_b32 a80, s70
v_accvgpr_write_b32 a81, s70
v_accvgpr_write_b32 a82, s70
v_accvgpr_write_b32 a83, s70
s_mov_b32 s80, 0x358637bd
s_mov_b32 s81, 0x358637bd
s_mov_b32 s82, 0x3f800008
s_mov_b32 s83, 0x3f800008
s_mov_b32 s90, 0x3fb8aa3b
s_mov_b32 s91, 0x3fb8aa3b
s_waitcnt vmcnt(4)
v_readfirstlane_b32 s68, v19
v_lshlrev_b32 v128, 16, v24
v_and_b32 v129, 0xffff0000, v24
v_lshlrev_b32 v130, 16, v25
v_and_b32 v131, 0xffff0000, v25
v_lshlrev_b32 v132, 16, v26
v_and_b32 v133, 0xffff0000, v26
v_lshlrev_b32 v134, 16, v27
v_and_b32 v135, 0xffff0000, v27
v_lshlrev_b32 v136, 16, v28
v_and_b32 v137, 0xffff0000, v28
v_lshlrev_b32 v138, 16, v29
v_and_b32 v139, 0xffff0000, v29
v_lshlrev_b32 v140, 16, v30
v_and_b32 v141, 0xffff0000, v30
v_lshlrev_b32 v142, 16, v31
v_and_b32 v143, 0xffff0000, v31
s_add_u32 s68, s68, 1
v_pk_add_f32 v[128:129], v[128:129], v[130:131]
v_pk_add_f32 v[132:133], v[132:133], v[134:135]
v_pk_add_f32 v[136:137], v[136:137], v[138:139]
v_pk_add_f32 v[140:141], v[140:141], v[142:143]
v_pk_add_f32 v[128:129], v[128:129], v[132:133]
v_pk_add_f32 v[136:137], v[136:137], v[140:141]
v_pk_add_f32 v[128:129], v[128:129], v[136:137]
v_add_f32 v2, v128, v129
s_nop 1
v_add_f32_dpp v2, v2, v2 row_ror:1 row_mask:0xf bank_mask:0xf
s_nop 1
v_add_f32_dpp v2, v2, v2 row_ror:2 row_mask:0xf bank_mask:0xf
s_nop 1
v_add_f32_dpp v2, v2, v2 row_ror:4 row_mask:0xf bank_mask:0xf
s_nop 1
v_add_f32_dpp v2, v2, v2 row_ror:8 row_mask:0xf bank_mask:0xf
v_mov_b32 v3, v2
s_nop 1
v_permlane16_swap_b32 v2, v3
v_add_f32 v2, v2, v3
v_mov_b32 v3, v2
s_nop 1
v_permlane32_swap_b32 v2, v3
v_add_f32 v2, v2, v3
s_nop 0
v_readfirstlane_b32 s84, v2
s_barrier
ds_read_b128 a[0:3], v10 offset:57344
ds_read_b64_tr_b16 a[32:33], v12 offset:0
ds_read_b64_tr_b16 a[34:35], v12 offset:512
ds_read_b128 a[4:7], v10 offset:59392
ds_read_b128 a[8:11], v10 offset:61440
ds_read_b128 a[12:15], v10 offset:63488
ds_read_b64_tr_b16 a[36:37], v13 offset:0
ds_read_b64_tr_b16 a[38:39], v13 offset:512
ds_read_b64_tr_b16 a[40:41], v12 offset:2048
ds_read_b64_tr_b16 a[42:43], v12 offset:2560
ds_read_b64_tr_b16 a[44:45], v13 offset:2048
ds_read_b64_tr_b16 a[46:47], v13 offset:2560
ds_read_b64_tr_b16 a[48:49], v12 offset:4096
ds_read_b64_tr_b16 a[50:51], v12 offset:4608
ds_read_b64_tr_b16 a[52:53], v13 offset:4096
ds_read_b64_tr_b16 a[54:55], v13 offset:4608
s_waitcnt lgkmcnt(0)
s_cmp_lg_u32 s66, 0
s_cbranch_scc1 L_nocs0
v_mfma_f32_16x16x32_bf16 v[128:131], a[80:83], a[32:35], 0
v_mfma_f32_16x16x32_bf16 v[132:135], a[80:83], a[36:39], 0
v_mfma_f32_16x16x32_bf16 v[136:139], a[80:83], a[40:43], 0
v_mfma_f32_16x16x32_bf16 v[140:143], a[80:83], a[44:47], 0
v_mfma_f32_16x16x32_bf16 v[144:147], a[80:83], a[48:51], 0
v_mfma_f32_16x16x32_bf16 v[148:151], a[80:83], a[52:55], 0
L_nocs0:
v_mfma_f32_16x16x32_bf16 v[32:35], a[32:35], a[0:3], v[32:35]
ds_read_b128 a[16:19], v11 offset:57344
v_mfma_f32_16x16x32_bf16 v[56:59], a[32:35], a[4:7], v[56:59]
ds_read_b64_tr_b16 a[56:57], v12 offset:12288
v_mfma_f32_16x16x32_bf16 v[80:83], a[32:35], a[8:11], v[80:83]
ds_read_b64_tr_b16 a[58:59], v12 offset:12800
v_mfma_f32_16x16x32_bf16 v[104:107], a[32:35], a[12:15], v[104:107]
ds_read_b128 a[20:23], v11 offset:59392
v_mfma_f32_16x16x32_bf16 v[36:39], a[36:39], a[0:3], v[36:39]
ds_read_b128 a[24:27], v11 offset:61440
v_mfma_f32_16x16x32_bf16 v[60:63], a[36:39], a[4:7], v[60:63]
ds_read_b128 a[28:31], v11 offset:63488
v_mfma_f32_16x16x32_bf16 v[84:87], a[36:39], a[8:11], v[84:87]
ds_read_b64_tr_b16 a[60:61], v13 offset:12288
v_mfma_f32_16x16x32_bf16 v[108:111], a[36:39], a[12:15], v[108:111]
ds_read_b64_tr_b16 a[62:63], v13 offset:12800
v_mfma_f32_16x16x32_bf16 v[40:43], a[0:3], a[40:43], v[40:43]
ds_read_b64_tr_b16 a[64:65], v12 offset:14336
v_mfma_f32_16x16x32_bf16 v[64:67], a[4:7], a[40:43], v[64:67]
ds_read_b64_tr_b16 a[66:67], v12 offset:14848
v_mfma_f32_16x16x32_bf16 v[88:91], a[8:11], a[40:43], v[88:91]
ds_read_b64_tr_b16 a[68:69], v13 offset:14336
v_mfma_f32_16x16x32_bf16 v[112:115], a[12:15], a[40:43], v[112:115]
ds_read_b64_tr_b16 a[70:71], v13 offset:14848
v_mfma_f32_16x16x32_bf16 v[44:47], a[0:3], a[44:47], v[44:47]
ds_read_b64_tr_b16 a[72:73], v12 offset:16384
v_mfma_f32_16x16x32_bf16 v[68:71], a[4:7], a[44:47], v[68:71]
ds_read_b64_tr_b16 a[74:75], v12 offset:16896
v_mfma_f32_16x16x32_bf16 v[92:95], a[8:11], a[44:47], v[92:95]
ds_read_b64_tr_b16 a[76:77], v13 offset:16384
v_mfma_f32_16x16x32_bf16 v[116:119], a[12:15], a[44:47], v[116:119]
ds_read_b64_tr_b16 a[78:79], v13 offset:16896
v_mfma_f32_16x16x32_bf16 v[48:51], a[0:3], a[48:51], v[48:51]
v_mfma_f32_16x16x32_bf16 v[72:75], a[4:7], a[48:51], v[72:75]
v_mfma_f32_16x16x32_bf16 v[96:99], a[8:11], a[48:51], v[96:99]
v_mfma_f32_16x16x32_bf16 v[120:123], a[12:15], a[48:51], v[120:123]
v_mfma_f32_16x16x32_bf16 v[52:55], a[0:3], a[52:55], v[52:55]
v_mfma_f32_16x16x32_bf16 v[76:79], a[4:7], a[52:55], v[76:79]
v_mfma_f32_16x16x32_bf16 v[100:103], a[8:11], a[52:55], v[100:103]
v_mfma_f32_16x16x32_bf16 v[124:127], a[12:15], a[52:55], v[124:127]
s_waitcnt lgkmcnt(0)
s_cmp_lg_u32 s66, 0
s_cbranch_scc1 L_nocs1
v_mfma_f32_16x16x32_bf16 v[128:131], a[80:83], a[56:59], v[128:131]
v_mfma_f32_16x16x32_bf16 v[132:135], a[80:83], a[60:63], v[132:135]
v_mfma_f32_16x16x32_bf16 v[136:139], a[80:83], a[64:67], v[136:139]
v_mfma_f32_16x16x32_bf16 v[140:143], a[80:83], a[68:71], v[140:143]
v_mfma_f32_16x16x32_bf16 v[144:147], a[80:83], a[72:75], v[144:147]
v_mfma_f32_16x16x32_bf16 v[148:151], a[80:83], a[76:79], v[148:151]
L_nocs1:
v_mfma_f32_16x16x32_bf16 v[32:35], a[56:59], a[16:19], v[32:35]
s_barrier
ds_read_b128 a[0:3], v10 offset:40960
v_mfma_f32_16x16x32_bf16 v[56:59], a[56:59], a[20:23], v[56:59]
ds_read_b64_tr_b16 a[32:33], v14 offset:16384
v_mfma_f32_16x16x32_bf16 v[80:83], a[56:59], a[24:27], v[80:83]
ds_read_b64_tr_b16 a[34:35], v14 offset:16896
v_mfma_f32_16x16x32_bf16 v[104:107], a[56:59], a[28:31], v[104:107]
ds_read_b128 a[4:7], v10 offset:43008
v_mfma_f32_16x16x32_bf16 v[36:39], a[60:63], a[16:19], v[36:39]
ds_read_b128 a[8:11], v10 offset:45056
v_mfma_f32_16x16x32_bf16 v[60:63], a[60:63], a[20:23], v[60:63]
ds_read_b128 a[12:15], v10 offset:47104
v_mfma_f32_16x16x32_bf16 v[84:87], a[60:63], a[24:27], v[84:87]
ds_read_b64_tr_b16 a[36:37], v15 offset:16384
v_mfma_f32_16x16x32_bf16 v[108:111], a[60:63], a[28:31], v[108:111]
ds_read_b64_tr_b16 a[38:39], v15 offset:16896
v_mfma_f32_16x16x32_bf16 v[40:43], a[16:19], a[64:67], v[40:43]
ds_read_b64_tr_b16 a[40:41], v14 offset:18432
v_mfma_f32_16x16x32_bf16 v[64:67], a[20:23], a[64:67], v[64:67]
ds_read_b64_tr_b16 a[42:43], v14 offset:18944
v_mfma_f32_16x16x32_bf16 v[88:91], a[24:27], a[64:67], v[88:91]
ds_read_b64_tr_b16 a[44:45], v15 offset:18432
v_mfma_f32_16x16x32_bf16 v[112:115], a[28:31], a[64:67], v[112:115]
ds_read_b64_tr_b16 a[46:47], v15 offset:18944
v_mfma_f32_16x16x32_bf16 v[44:47], a[16:19], a[68:71], v[44:47]
ds_read_b64_tr_b16 a[48:49], v14 offset:20480
v_mfma_f32_16x16x32_bf16 v[68:71], a[20:23], a[68:71], v[68:71]
ds_read_b64_tr_b16 a[50:51], v14 offset:20992
v_mfma_f32_16x16x32_bf16 v[92:95], a[24:27], a[68:71], v[92:95]
ds_read_b64_tr_b16 a[52:53], v15 offset:20480
v_mfma_f32_16x16x32_bf16 v[116:119], a[28:31], a[68:71], v[116:119]
ds_read_b64_tr_b16 a[54:55], v15 offset:20992
v_mfma_f32_16x16x32_bf16 v[48:51], a[16:19], a[72:75], v[48:51]
v_mfma_f32_16x16x32_bf16 v[72:75], a[20:23], a[72:75], v[72:75]
v_mfma_f32_16x16x32_bf16 v[96:99], a[24:27], a[72:75], v[96:99]
v_mfma_f32_16x16x32_bf16 v[120:123], a[28:31], a[72:75], v[120:123]
v_mfma_f32_16x16x32_bf16 v[52:55], a[16:19], a[76:79], v[52:55]
v_mfma_f32_16x16x32_bf16 v[76:79], a[20:23], a[76:79], v[76:79]
v_mfma_f32_16x16x32_bf16 v[100:103], a[24:27], a[76:79], v[100:103]
v_mfma_f32_16x16x32_bf16 v[124:127], a[28:31], a[76:79], v[124:127]
s_waitcnt lgkmcnt(0)
v_mfma_f32_16x16x32_bf16 v[32:35], a[32:35], a[0:3], v[32:35]
ds_read_b128 a[16:19], v11 offset:40960
v_mfma_f32_16x16x32_bf16 v[56:59], a[32:35], a[4:7], v[56:59]
ds_read_b64_tr_b16 a[56:57], v14 offset:28672
v_mfma_f32_16x16x32_bf16 v[80:83], a[32:35], a[8:11], v[80:83]
ds_read_b64_tr_b16 a[58:59], v14 offset:29184
v_mfma_f32_16x16x32_bf16 v[104:107], a[32:35], a[12:15], v[104:107]
ds_read_b128 a[20:23], v11 offset:43008
v_mfma_f32_16x16x32_bf16 v[36:39], a[36:39], a[0:3], v[36:39]
ds_read_b128 a[24:27], v11 offset:45056
v_mfma_f32_16x16x32_bf16 v[60:63], a[36:39], a[4:7], v[60:63]
ds_read_b128 a[28:31], v11 offset:47104
v_mfma_f32_16x16x32_bf16 v[84:87], a[36:39], a[8:11], v[84:87]
ds_read_b64_tr_b16 a[60:61], v15 offset:28672
v_mfma_f32_16x16x32_bf16 v[108:111], a[36:39], a[12:15], v[108:111]
ds_read_b64_tr_b16 a[62:63], v15 offset:29184
v_mfma_f32_16x16x32_bf16 v[40:43], a[0:3], a[40:43], v[40:43]
ds_read_b64_tr_b16 a[64:65], v14 offset:30720
v_mfma_f32_16x16x32_bf16 v[64:67], a[4:7], a[40:43], v[64:67]
ds_read_b64_tr_b16 a[66:67], v14 offset:31232
v_mfma_f32_16x16x32_bf16 v[88:91], a[8:11], a[40:43], v[88:91]
ds_read_b64_tr_b16 a[68:69], v15 offset:30720
v_mfma_f32_16x16x32_bf16 v[112:115], a[12:15], a[40:43], v[112:115]
ds_read_b64_tr_b16 a[70:71], v15 offset:31232
v_mfma_f32_16x16x32_bf16 v[44:47], a[0:3], a[44:47], v[44:47]
ds_read_b64_tr_b16 a[72:73], v14 offset:32768
v_mfma_f32_16x16x32_bf16 v[68:71], a[4:7], a[44:47], v[68:71]
ds_read_b64_tr_b16 a[74:75], v14 offset:33280
v_mfma_f32_16x16x32_bf16 v[92:95], a[8:11], a[44:47], v[92:95]
ds_read_b64_tr_b16 a[76:77], v15 offset:32768
v_mfma_f32_16x16x32_bf16 v[116:119], a[12:15], a[44:47], v[116:119]
ds_read_b64_tr_b16 a[78:79], v15 offset:33280
v_mfma_f32_16x16x32_bf16 v[48:51], a[0:3], a[48:51], v[48:51]
v_mfma_f32_16x16x32_bf16 v[72:75], a[4:7], a[48:51], v[72:75]
v_mfma_f32_16x16x32_bf16 v[96:99], a[8:11], a[48:51], v[96:99]
v_mfma_f32_16x16x32_bf16 v[120:123], a[12:15], a[48:51], v[120:123]
v_mfma_f32_16x16x32_bf16 v[52:55], a[0:3], a[52:55], v[52:55]
v_mfma_f32_16x16x32_bf16 v[76:79], a[4:7], a[52:55], v[76:79]
v_mfma_f32_16x16x32_bf16 v[100:103], a[8:11], a[52:55], v[100:103]
v_mfma_f32_16x16x32_bf16 v[124:127], a[12:15], a[52:55], v[124:127]
s_waitcnt lgkmcnt(0)
v_mfma_f32_16x16x32_bf16 v[32:35], a[56:59], a[16:19], v[32:35]
s_barrier
ds_read_b128 a[0:3], v10 offset:0
v_mfma_f32_16x16x32_bf16 v[56:59], a[56:59], a[20:23], v[56:59]
ds_read_b64_tr_b16 a[32:33], v12 offset:40960
v_mfma_f32_16x16x32_bf16 v[80:83], a[56:59], a[24:27], v[80:83]
ds_read_b64_tr_b16 a[34:35], v12 offset:41472
v_mfma_f32_16x16x32_bf16 v[104:107], a[56:59], a[28:31], v[104:107]
ds_read_b128 a[4:7], v10 offset:2048
v_mfma_f32_16x16x32_bf16 v[36:39], a[60:63], a[16:19], v[36:39]
ds_read_b128 a[8:11], v10 offset:4096
v_mfma_f32_16x16x32_bf16 v[60:63], a[60:63], a[20:23], v[60:63]
ds_read_b128 a[12:15], v10 offset:6144
v_mfma_f32_16x16x32_bf16 v[84:87], a[60:63], a[24:27], v[84:87]
ds_read_b64_tr_b16 a[36:37], v13 offset:40960
v_mfma_f32_16x16x32_bf16 v[108:111], a[60:63], a[28:31], v[108:111]
ds_read_b64_tr_b16 a[38:39], v13 offset:41472
v_mfma_f32_16x16x32_bf16 v[40:43], a[16:19], a[64:67], v[40:43]
ds_read_b64_tr_b16 a[40:41], v12 offset:43008
v_mfma_f32_16x16x32_bf16 v[64:67], a[20:23], a[64:67], v[64:67]
ds_read_b64_tr_b16 a[42:43], v12 offset:43520
v_mfma_f32_16x16x32_bf16 v[88:91], a[24:27], a[64:67], v[88:91]
ds_read_b64_tr_b16 a[44:45], v13 offset:43008
v_mfma_f32_16x16x32_bf16 v[112:115], a[28:31], a[64:67], v[112:115]
ds_read_b64_tr_b16 a[46:47], v13 offset:43520
v_mfma_f32_16x16x32_bf16 v[44:47], a[16:19], a[68:71], v[44:47]
ds_read_b64_tr_b16 a[48:49], v12 offset:45056
v_mfma_f32_16x16x32_bf16 v[68:71], a[20:23], a[68:71], v[68:71]
ds_read_b64_tr_b16 a[50:51], v12 offset:45568
v_mfma_f32_16x16x32_bf16 v[92:95], a[24:27], a[68:71], v[92:95]
ds_read_b64_tr_b16 a[52:53], v13 offset:45056
v_mfma_f32_16x16x32_bf16 v[116:119], a[28:31], a[68:71], v[116:119]
ds_read_b64_tr_b16 a[54:55], v13 offset:45568
v_mfma_f32_16x16x32_bf16 v[48:51], a[16:19], a[72:75], v[48:51]
v_mfma_f32_16x16x32_bf16 v[72:75], a[20:23], a[72:75], v[72:75]
v_mfma_f32_16x16x32_bf16 v[96:99], a[24:27], a[72:75], v[96:99]
v_mfma_f32_16x16x32_bf16 v[120:123], a[28:31], a[72:75], v[120:123]
v_mfma_f32_16x16x32_bf16 v[52:55], a[16:19], a[76:79], v[52:55]
v_mfma_f32_16x16x32_bf16 v[76:79], a[20:23], a[76:79], v[76:79]
v_mfma_f32_16x16x32_bf16 v[100:103], a[24:27], a[76:79], v[100:103]
v_mfma_f32_16x16x32_bf16 v[124:127], a[28:31], a[76:79], v[124:127]
s_waitcnt lgkmcnt(0)
v_mfma_f32_16x16x32_bf16 v[32:35], a[32:35], a[0:3], v[32:35]
ds_read_b128 a[16:19], v11 offset:0
v_mfma_f32_16x16x32_bf16 v[56:59], a[32:35], a[4:7], v[56:59]
ds_read_b64_tr_b16 a[56:57], v12 offset:53248
v_mfma_f32_16x16x32_bf16 v[80:83], a[32:35], a[8:11], v[80:83]
ds_read_b64_tr_b16 a[58:59], v12 offset:53760
v_mfma_f32_16x16x32_bf16 v[104:107], a[32:35], a[12:15], v[104:107]
ds_read_b128 a[20:23], v11 offset:2048
v_mfma_f32_16x16x32_bf16 v[36:39], a[36:39], a[0:3], v[36:39]
ds_read_b128 a[24:27], v11 offset:4096
v_mfma_f32_16x16x32_bf16 v[60:63], a[36:39], a[4:7], v[60:63]
ds_read_b128 a[28:31], v11 offset:6144
v_mfma_f32_16x16x32_bf16 v[84:87], a[36:39], a[8:11], v[84:87]
ds_read_b64_tr_b16 a[60:61], v13 offset:53248
v_mfma_f32_16x16x32_bf16 v[108:111], a[36:39], a[12:15], v[108:111]
ds_read_b64_tr_b16 a[62:63], v13 offset:53760
v_mfma_f32_16x16x32_bf16 v[40:43], a[0:3], a[40:43], v[40:43]
ds_read_b64_tr_b16 a[64:65], v12 offset:55296
v_mfma_f32_16x16x32_bf16 v[64:67], a[4:7], a[40:43], v[64:67]
ds_read_b64_tr_b16 a[66:67], v12 offset:55808
v_mfma_f32_16x16x32_bf16 v[88:91], a[8:11], a[40:43], v[88:91]
ds_read_b64_tr_b16 a[68:69], v13 offset:55296
v_mfma_f32_16x16x32_bf16 v[112:115], a[12:15], a[40:43], v[112:115]
ds_read_b64_tr_b16 a[70:71], v13 offset:55808
v_mfma_f32_16x16x32_bf16 v[44:47], a[0:3], a[44:47], v[44:47]
ds_read_b64_tr_b16 a[72:73], v12 offset:57344
v_mfma_f32_16x16x32_bf16 v[68:71], a[4:7], a[44:47], v[68:71]
ds_read_b64_tr_b16 a[74:75], v12 offset:57856
v_mfma_f32_16x16x32_bf16 v[92:95], a[8:11], a[44:47], v[92:95]
ds_read_b64_tr_b16 a[76:77], v13 offset:57344
v_mfma_f32_16x16x32_bf16 v[116:119], a[12:15], a[44:47], v[116:119]
ds_read_b64_tr_b16 a[78:79], v13 offset:57856
v_mfma_f32_16x16x32_bf16 v[48:51], a[0:3], a[48:51], v[48:51]
v_mfma_f32_16x16x32_bf16 v[72:75], a[4:7], a[48:51], v[72:75]
v_mfma_f32_16x16x32_bf16 v[96:99], a[8:11], a[48:51], v[96:99]
v_mfma_f32_16x16x32_bf16 v[120:123], a[12:15], a[48:51], v[120:123]
v_mfma_f32_16x16x32_bf16 v[52:55], a[0:3], a[52:55], v[52:55]
v_mfma_f32_16x16x32_bf16 v[76:79], a[4:7], a[52:55], v[76:79]
v_mfma_f32_16x16x32_bf16 v[100:103], a[8:11], a[52:55], v[100:103]
v_mfma_f32_16x16x32_bf16 v[124:127], a[12:15], a[52:55], v[124:127]
s_waitcnt lgkmcnt(0)
v_mfma_f32_16x16x32_bf16 v[32:35], a[56:59], a[16:19], v[32:35]
s_barrier
ds_read_b128 a[0:3], v8 offset:24576
v_mfma_f32_16x16x32_bf16 v[56:59], a[56:59], a[20:23], v[56:59]
ds_read_b64_tr_b16 a[32:33], v12 offset:0
v_mfma_f32_16x16x32_bf16 v[80:83], a[56:59], a[24:27], v[80:83]
ds_read_b64_tr_b16 a[34:35], v12 offset:512
v_mfma_f32_16x16x32_bf16 v[104:107], a[56:59], a[28:31], v[104:107]
ds_read_b128 a[4:7], v8 offset:26624
v_mfma_f32_16x16x32_bf16 v[36:39], a[60:63], a[16:19], v[36:39]
ds_read_b128 a[8:11], v8 offset:28672
v_mfma_f32_16x16x32_bf16 v[60:63], a[60:63], a[20:23], v[60:63]
ds_read_b128 a[12:15], v8 offset:30720
v_mfma_f32_16x16x32_bf16 v[84:87], a[60:63], a[24:27], v[84:87]
ds_read_b64_tr_b16 a[36:37], v13 offset:0
v_mfma_f32_16x16x32_bf16 v[108:111], a[60:63], a[28:31], v[108:111]
ds_read_b64_tr_b16 a[38:39], v13 offset:512
v_mfma_f32_16x16x32_bf16 v[40:43], a[16:19], a[64:67], v[40:43]
ds_read_b64_tr_b16 a[40:41], v12 offset:2048
v_mfma_f32_16x16x32_bf16 v[64:67], a[20:23], a[64:67], v[64:67]
ds_read_b64_tr_b16 a[42:43], v12 offset:2560
v_mfma_f32_16x16x32_bf16 v[88:91], a[24:27], a[64:67], v[88:91]
ds_read_b64_tr_b16 a[44:45], v13 offset:2048
v_mfma_f32_16x16x32_bf16 v[112:115], a[28:31], a[64:67], v[112:115]
ds_read_b64_tr_b16 a[46:47], v13 offset:2560
v_mfma_f32_16x16x32_bf16 v[44:47], a[16:19], a[68:71], v[44:47]
ds_read_b64_tr_b16 a[48:49], v12 offset:4096
v_mfma_f32_16x16x32_bf16 v[68:71], a[20:23], a[68:71], v[68:71]
ds_read_b64_tr_b16 a[50:51], v12 offset:4608
v_mfma_f32_16x16x32_bf16 v[92:95], a[24:27], a[68:71], v[92:95]
ds_read_b64_tr_b16 a[52:53], v13 offset:4096
v_mfma_f32_16x16x32_bf16 v[116:119], a[28:31], a[68:71], v[116:119]
ds_read_b64_tr_b16 a[54:55], v13 offset:4608
v_mfma_f32_16x16x32_bf16 v[48:51], a[16:19], a[72:75], v[48:51]
v_mfma_f32_16x16x32_bf16 v[72:75], a[20:23], a[72:75], v[72:75]
v_mfma_f32_16x16x32_bf16 v[96:99], a[24:27], a[72:75], v[96:99]
v_mfma_f32_16x16x32_bf16 v[120:123], a[28:31], a[72:75], v[120:123]
v_mfma_f32_16x16x32_bf16 v[52:55], a[16:19], a[76:79], v[52:55]
v_mfma_f32_16x16x32_bf16 v[76:79], a[20:23], a[76:79], v[76:79]
v_mfma_f32_16x16x32_bf16 v[100:103], a[24:27], a[76:79], v[100:103]
v_mfma_f32_16x16x32_bf16 v[124:127], a[28:31], a[76:79], v[124:127]
s_waitcnt lgkmcnt(0)
v_mfma_f32_16x16x32_bf16 v[32:35], a[32:35], a[0:3], v[32:35]
ds_read_b128 a[16:19], v9 offset:24576
v_mfma_f32_16x16x32_bf16 v[56:59], a[32:35], a[4:7], v[56:59]
ds_read_b64_tr_b16 a[56:57], v12 offset:12288
v_mfma_f32_16x16x32_bf16 v[80:83], a[32:35], a[8:11], v[80:83]
ds_read_b64_tr_b16 a[58:59], v12 offset:12800
v_mfma_f32_16x16x32_bf16 v[104:107], a[32:35], a[12:15], v[104:107]
ds_read_b128 a[20:23], v9 offset:26624
v_mfma_f32_16x16x32_bf16 v[36:39], a[36:39], a[0:3], v[36:39]
ds_read_b128 a[24:27], v9 offset:28672
v_mfma_f32_16x16x32_bf16 v[60:63], a[36:39], a[4:7], v[60:63]
ds_read_b128 a[28:31], v9 offset:30720
v_mfma_f32_16x16x32_bf16 v[84:87], a[36:39], a[8:11], v[84:87]
ds_read_b64_tr_b16 a[60:61], v13 offset:12288
v_mfma_f32_16x16x32_bf16 v[108:111], a[36:39], a[12:15], v[108:111]
ds_read_b64_tr_b16 a[62:63], v13 offset:12800
v_mfma_f32_16x16x32_bf16 v[40:43], a[0:3], a[40:43], v[40:43]
ds_read_b64_tr_b16 a[64:65], v12 offset:14336
v_mfma_f32_16x16x32_bf16 v[64:67], a[4:7], a[40:43], v[64:67]
ds_read_b64_tr_b16 a[66:67], v12 offset:14848
v_mfma_f32_16x16x32_bf16 v[88:91], a[8:11], a[40:43], v[88:91]
ds_read_b64_tr_b16 a[68:69], v13 offset:14336
v_mfma_f32_16x16x32_bf16 v[112:115], a[12:15], a[40:43], v[112:115]
ds_read_b64_tr_b16 a[70:71], v13 offset:14848
v_mfma_f32_16x16x32_bf16 v[44:47], a[0:3], a[44:47], v[44:47]
ds_read_b64_tr_b16 a[72:73], v12 offset:16384
v_mfma_f32_16x16x32_bf16 v[68:71], a[4:7], a[44:47], v[68:71]
ds_read_b64_tr_b16 a[74:75], v12 offset:16896
v_mfma_f32_16x16x32_bf16 v[92:95], a[8:11], a[44:47], v[92:95]
ds_read_b64_tr_b16 a[76:77], v13 offset:16384
v_mfma_f32_16x16x32_bf16 v[116:119], a[12:15], a[44:47], v[116:119]
ds_read_b64_tr_b16 a[78:79], v13 offset:16896
v_mfma_f32_16x16x32_bf16 v[48:51], a[0:3], a[48:51], v[48:51]
s_cmp_lg_u32 s66, 0
s_cbranch_scc1 L_nocsp
v_and_b32 v2, 16, v1
v_cmp_ne_u32 vcc, 0, v2
s_nop 1
v_cndmask_b32 v24, v128, v132, vcc
v_cndmask_b32 v25, v136, v140, vcc
v_cndmask_b32 v26, v144, v148, vcc
v_mov_b32 v27, s68
s_lshl_b32 s70, s64, 4
s_add_u32 s70, s70, s65
s_lshl_b32 s70, s70, 10
s_lshl_b32 s71, s67, 9
s_add_u32 s70, s70, s71
s_add_u32 s70, s70, 65536
s_mov_b64 exec, 0xffffffff
buffer_store_dwordx4 v[24:27], v16, s[12:15], s70 offen sc1
s_mov_b64 exec, -1
L_nocsp:
v_mfma_f32_16x16x32_bf16 v[72:75], a[4:7], a[48:51], v[72:75]
v_mfma_f32_16x16x32_bf16 v[96:99], a[8:11], a[48:51], v[96:99]
v_mfma_f32_16x16x32_bf16 v[120:123], a[12:15], a[48:51], v[120:123]
v_mfma_f32_16x16x32_bf16 v[52:55], a[0:3], a[52:55], v[52:55]
v_mfma_f32_16x16x32_bf16 v[76:79], a[4:7], a[52:55], v[76:79]
v_mfma_f32_16x16x32_bf16 v[100:103], a[8:11], a[52:55], v[100:103]
v_mfma_f32_16x16x32_bf16 v[124:127], a[12:15], a[52:55], v[124:127]
s_waitcnt lgkmcnt(0)
v_mfma_f32_16x16x32_bf16 v[32:35], a[56:59], a[16:19], v[32:35]
s_barrier
ds_read_b128 a[0:3], v10 offset:57344
v_mfma_f32_16x16x32_bf16 v[56:59], a[56:59], a[20:23], v[56:59]
ds_read_b64_tr_b16 a[32:33], v14 offset:16384
v_mfma_f32_16x16x32_bf16 v[80:83], a[56:59], a[24:27], v[80:83]
ds_read_b64_tr_b16 a[34:35], v14 offset:16896
v_mfma_f32_16x16x32_bf16 v[104:107], a[56:59], a[28:31], v[104:107]
ds_read_b128 a[4:7], v10 offset:59392
v_mfma_f32_16x16x32_bf16 v[36:39], a[60:63], a[16:19], v[36:39]
ds_read_b128 a[8:11], v10 offset:61440
v_mfma_f32_16x16x32_bf16 v[60:63], a[60:63], a[20:23], v[60:63]
ds_read_b128 a[12:15], v10 offset:63488
v_mfma_f32_16x16x32_bf16 v[84:87], a[60:63], a[24:27], v[84:87]
ds_read_b64_tr_b16 a[36:37], v15 offset:16384
v_mfma_f32_16x16x32_bf16 v[108:111], a[60:63], a[28:31], v[108:111]
ds_read_b64_tr_b16 a[38:39], v15 offset:16896
v_mfma_f32_16x16x32_bf16 v[40:43], a[16:19], a[64:67], v[40:43]
ds_read_b64_tr_b16 a[40:41], v14 offset:18432
v_mfma_f32_16x16x32_bf16 v[64:67], a[20:23], a[64:67], v[64:67]
ds_read_b64_tr_b16 a[42:43], v14 offset:18944
v_mfma_f32_16x16x32_bf16 v[88:91], a[24:27], a[64:67], v[88:91]
ds_read_b64_tr_b16 a[44:45], v15 offset:18432
v_mfma_f32_16x16x32_bf16 v[112:115], a[28:31], a[64:67], v[112:115]
ds_read_b64_tr_b16 a[46:47], v15 offset:18944
v_mfma_f32_16x16x32_bf16 v[44:47], a[16:19], a[68:71], v[44:47]
ds_read_b64_tr_b16 a[48:49], v14 offset:20480
v_mfma_f32_16x16x32_bf16 v[68:71], a[20:23], a[68:71], v[68:71]
ds_read_b64_tr_b16 a[50:51], v14 offset:20992
v_mfma_f32_16x16x32_bf16 v[92:95], a[24:27], a[68:71], v[92:95]
ds_read_b64_tr_b16 a[52:53], v15 offset:20480
v_mfma_f32_16x16x32_bf16 v[116:119], a[28:31], a[68:71], v[116:119]
ds_read_b64_tr_b16 a[54:55], v15 offset:20992
v_mfma_f32_16x16x32_bf16 v[48:51], a[16:19], a[72:75], v[48:51]
v_mfma_f32_16x16x32_bf16 v[72:75], a[20:23], a[72:75], v[72:75]
v_mfma_f32_16x16x32_bf16 v[96:99], a[24:27], a[72:75], v[96:99]
v_mfma_f32_16x16x32_bf16 v[120:123], a[28:31], a[72:75], v[120:123]
v_mfma_f32_16x16x32_bf16 v[52:55], a[16:19], a[76:79], v[52:55]
v_mfma_f32_16x16x32_bf16 v[76:79], a[20:23], a[76:79], v[76:79]
v_mfma_f32_16x16x32_bf16 v[100:103], a[24:27], a[76:79], v[100:103]
v_mfma_f32_16x16x32_bf16 v[124:127], a[28:31], a[76:79], v[124:127]
s_waitcnt lgkmcnt(0)
v_mfma_f32_16x16x32_bf16 v[32:35], a[32:35], a[0:3], v[32:35]
ds_read_b128 a[16:19], v11 offset:57344
v_mfma_f32_16x16x32_bf16 v[56:59], a[32:35], a[4:7], v[56:59]
ds_read_b64_tr_b16 a[56:57], v14 offset:28672
v_mfma_f32_16x16x32_bf16 v[80:83], a[32:35], a[8:11], v[80:83]
ds_read_b64_tr_b16 a[58:59], v14 offset:29184
v_mfma_f32_16x16x32_bf16 v[104:107], a[32:35], a[12:15], v[104:107]
ds_read_b128 a[20:23], v11 offset:59392
v_mfma_f32_16x16x32_bf16 v[36:39], a[36:39], a[0:3], v[36:39]
ds_read_b128 a[24:27], v11 offset:61440
v_mfma_f32_16x16x32_bf16 v[60:63], a[36:39], a[4:7], v[60:63]
ds_read_b128 a[28:31], v11 offset:63488
v_mfma_f32_16x16x32_bf16 v[84:87], a[36:39], a[8:11], v[84:87]
ds_read_b64_tr_b16 a[60:61], v15 offset:28672
v_mfma_f32_16x16x32_bf16 v[108:111], a[36:39], a[12:15], v[108:111]
ds_read_b64_tr_b16 a[62:63], v15 offset:29184
v_mfma_f32_16x16x32_bf16 v[40:43], a[0:3], a[40:43], v[40:43]
ds_read_b64_tr_b16 a[64:65], v14 offset:30720
v_mfma_f32_16x16x32_bf16 v[64:67], a[4:7], a[40:43], v[64:67]
ds_read_b64_tr_b16 a[66:67], v14 offset:31232
v_mfma_f32_16x16x32_bf16 v[88:91], a[8:11], a[40:43], v[88:91]
ds_read_b64_tr_b16 a[68:69], v15 offset:30720
v_mfma_f32_16x16x32_bf16 v[112:115], a[12:15], a[40:43], v[112:115]
ds_read_b64_tr_b16 a[70:71], v15 offset:31232
v_mfma_f32_16x16x32_bf16 v[44:47], a[0:3], a[44:47], v[44:47]
ds_read_b64_tr_b16 a[72:73], v14 offset:32768
v_mfma_f32_16x16x32_bf16 v[68:71], a[4:7], a[44:47], v[68:71]
ds_read_b64_tr_b16 a[74:75], v14 offset:33280
v_mfma_f32_16x16x32_bf16 v[92:95], a[8:11], a[44:47], v[92:95]
ds_read_b64_tr_b16 a[76:77], v15 offset:32768
v_mfma_f32_16x16x32_bf16 v[116:119], a[12:15], a[44:47], v[116:119]
ds_read_b64_tr_b16 a[78:79], v15 offset:33280
v_mfma_f32_16x16x32_bf16 v[48:51], a[0:3], a[48:51], v[48:51]
v_mfma_f32_16x16x32_bf16 v[72:75], a[4:7], a[48:51], v[72:75]
v_mfma_f32_16x16x32_bf16 v[96:99], a[8:11], a[48:51], v[96:99]
v_mfma_f32_16x16x32_bf16 v[120:123], a[12:15], a[48:51], v[120:123]
v_mfma_f32_16x16x32_bf16 v[52:55], a[0:3], a[52:55], v[52:55]
v_mfma_f32_16x16x32_bf16 v[76:79], a[4:7], a[52:55], v[76:79]
v_mfma_f32_16x16x32_bf16 v[100:103], a[8:11], a[52:55], v[100:103]
v_mfma_f32_16x16x32_bf16 v[124:127], a[12:15], a[52:55], v[124:127]
s_waitcnt lgkmcnt(0)
v_mfma_f32_16x16x32_bf16 v[32:35], a[56:59], a[16:19], v[32:35]
s_barrier
ds_read_b128 a[0:3], v10 offset:40960
v_mfma_f32_16x16x32_bf16 v[56:59], a[56:59], a[20:23], v[56:59]
ds_read_b64_tr_b16 a[32:33], v12 offset:40960
v_mfma_f32_16x16x32_bf16 v[80:83], a[56:59], a[24:27], v[80:83]
ds_read_b64_tr_b16 a[34:35], v12 offset:41472
v_mfma_f32_16x16x32_bf16 v[104:107], a[56:59], a[28:31], v[104:107]
ds_read_b128 a[4:7], v10 offset:43008
v_mfma_f32_16x16x32_bf16 v[36:39], a[60:63], a[16:19], v[36:39]
ds_read_b128 a[8:11], v10 offset:45056
v_mfma_f32_16x16x32_bf16 v[60:63], a[60:63], a[20:23], v[60:63]
ds_read_b128 a[12:15], v10 offset:47104
v_mfma_f32_16x16x32_bf16 v[84:87], a[60:63], a[24:27], v[84:87]
ds_read_b64_tr_b16 a[36:37], v13 offset:40960
v_mfma_f32_16x16x32_bf16 v[108:111], a[60:63], a[28:31], v[108:111]
ds_read_b64_tr_b16 a[38:39], v13 offset:41472
v_mfma_f32_16x16x32_bf16 v[40:43], a[16:19], a[64:67], v[40:43]
ds_read_b64_tr_b16 a[40:41], v12 offset:43008
v_mfma_f32_16x16x32_bf16 v[64:67], a[20:23], a[64:67], v[64:67]
ds_read_b64_tr_b16 a[42:43], v12 offset:43520
v_mfma_f32_16x16x32_bf16 v[88:91], a[24:27], a[64:67], v[88:91]
ds_read_b64_tr_b16 a[44:45], v13 offset:43008
v_mfma_f32_16x16x32_bf16 v[112:115], a[28:31], a[64:67], v[112:115]
ds_read_b64_tr_b16 a[46:47], v13 offset:43520
v_mfma_f32_16x16x32_bf16 v[44:47], a[16:19], a[68:71], v[44:47]
ds_read_b64_tr_b16 a[48:49], v12 offset:45056
v_mfma_f32_16x16x32_bf16 v[68:71], a[20:23], a[68:71], v[68:71]
ds_read_b64_tr_b16 a[50:51], v12 offset:45568
v_mfma_f32_16x16x32_bf16 v[92:95], a[24:27], a[68:71], v[92:95]
ds_read_b64_tr_b16 a[52:53], v13 offset:45056
v_mfma_f32_16x16x32_bf16 v[116:119], a[28:31], a[68:71], v[116:119]
ds_read_b64_tr_b16 a[54:55], v13 offset:45568
v_mfma_f32_16x16x32_bf16 v[48:51], a[16:19], a[72:75], v[48:51]
v_mfma_f32_16x16x32_bf16 v[72:75], a[20:23], a[72:75], v[72:75]
v_mfma_f32_16x16x32_bf16 v[96:99], a[24:27], a[72:75], v[96:99]
v_mfma_f32_16x16x32_bf16 v[120:123], a[28:31], a[72:75], v[120:123]
v_mfma_f32_16x16x32_bf16 v[52:55], a[16:19], a[76:79], v[52:55]
v_mfma_f32_16x16x32_bf16 v[76:79], a[20:23], a[76:79], v[76:79]
v_mfma_f32_16x16x32_bf16 v[100:103], a[24:27], a[76:79], v[100:103]
v_mfma_f32_16x16x32_bf16 v[124:127], a[28:31], a[76:79], v[124:127]
s_waitcnt lgkmcnt(0)
v_mfma_f32_16x16x32_bf16 v[32:35], a[32:35], a[0:3], v[32:35]
ds_read_b128 a[16:19], v11 offset:40960
v_mfma_f32_16x16x32_bf16 v[56:59], a[32:35], a[4:7], v[56:59]
ds_read_b64_tr_b16 a[56:57], v12 offset:53248
v_mfma_f32_16x16x32_bf16 v[80:83], a[32:35], a[8:11], v[80:83]
ds_read_b64_tr_b16 a[58:59], v12 offset:53760
v_mfma_f32_16x16x32_bf16 v[104:107], a[32:35], a[12:15], v[104:107]
ds_read_b128 a[20:23], v11 offset:43008
v_mfma_f32_16x16x32_bf16 v[36:39], a[36:39], a[0:3], v[36:39]
ds_read_b128 a[24:27], v11 offset:45056
v_mfma_f32_16x16x32_bf16 v[60:63], a[36:39], a[4:7], v[60:63]
ds_read_b128 a[28:31], v11 offset:47104
v_mfma_f32_16x16x32_bf16 v[84:87], a[36:39], a[8:11], v[84:87]
ds_read_b64_tr_b16 a[60:61], v13 offset:53248
v_mfma_f32_16x16x32_bf16 v[108:111], a[36:39], a[12:15], v[108:111]
ds_read_b64_tr_b16 a[62:63], v13 offset:53760
v_mfma_f32_16x16x32_bf16 v[40:43], a[0:3], a[40:43], v[40:43]
ds_read_b64_tr_b16 a[64:65], v12 offset:55296
v_mfma_f32_16x16x32_bf16 v[64:67], a[4:7], a[40:43], v[64:67]
ds_read_b64_tr_b16 a[66:67], v12 offset:55808
v_mfma_f32_16x16x32_bf16 v[88:91], a[8:11], a[40:43], v[88:91]
ds_read_b64_tr_b16 a[68:69], v13 offset:55296
v_mfma_f32_16x16x32_bf16 v[112:115], a[12:15], a[40:43], v[112:115]
ds_read_b64_tr_b16 a[70:71], v13 offset:55808
v_mfma_f32_16x16x32_bf16 v[44:47], a[0:3], a[44:47], v[44:47]
ds_read_b64_tr_b16 a[72:73], v12 offset:57344
v_mfma_f32_16x16x32_bf16 v[68:71], a[4:7], a[44:47], v[68:71]
ds_read_b64_tr_b16 a[74:75], v12 offset:57856
v_mfma_f32_16x16x32_bf16 v[92:95], a[8:11], a[44:47], v[92:95]
ds_read_b64_tr_b16 a[76:77], v13 offset:57344
v_mfma_f32_16x16x32_bf16 v[116:119], a[12:15], a[44:47], v[116:119]
ds_read_b64_tr_b16 a[78:79], v13 offset:57856
v_mfma_f32_16x16x32_bf16 v[48:51], a[0:3], a[48:51], v[48:51]
v_mfma_f32_16x16x32_bf16 v[72:75], a[4:7], a[48:51], v[72:75]
v_mfma_f32_16x16x32_bf16 v[96:99], a[8:11], a[48:51], v[96:99]
v_mfma_f32_16x16x32_bf16 v[120:123], a[12:15], a[48:51], v[120:123]
v_mfma_f32_16x16x32_bf16 v[52:55], a[0:3], a[52:55], v[52:55]
v_mfma_f32_16x16x32_bf16 v[76:79], a[4:7], a[52:55], v[76:79]
v_mfma_f32_16x16x32_bf16 v[100:103], a[8:11], a[52:55], v[100:103]
v_mfma_f32_16x16x32_bf16 v[124:127], a[12:15], a[52:55], v[124:127]
s_waitcnt lgkmcnt(0)
v_mfma_f32_16x16x32_bf16 v[32:35], a[56:59], a[16:19], v[32:35]
s_barrier
ds_read_b128 a[0:3], v10 offset:0
v_mfma_f32_16x16x32_bf16 v[56:59], a[56:59], a[20:23], v[56:59]
ds_read_b64_tr_b16 a[32:33], v12 offset:0
v_mfma_f32_16x16x32_bf16 v[80:83], a[56:59], a[24:27], v[80:83]
ds_read_b64_tr_b16 a[34:35], v12 offset:512
v_mfma_f32_16x16x32_bf16 v[104:107], a[56:59], a[28:31], v[104:107]
ds_read_b128 a[4:7], v10 offset:2048
v_mfma_f32_16x16x32_bf16 v[36:39], a[60:63], a[16:19], v[36:39]
ds_read_b128 a[8:11], v10 offset:4096
v_mfma_f32_16x16x32_bf16 v[60:63], a[60:63], a[20:23], v[60:63]
ds_read_b128 a[12:15], v10 offset:6144
v_mfma_f32_16x16x32_bf16 v[84:87], a[60:63], a[24:27], v[84:87]
ds_read_b64_tr_b16 a[36:37], v13 offset:0
v_mfma_f32_16x16x32_bf16 v[108:111], a[60:63], a[28:31], v[108:111]
ds_read_b64_tr_b16 a[38:39], v13 offset:512
v_mfma_f32_16x16x32_bf16 v[40:43], a[16:19], a[64:67], v[40:43]
ds_read_b64_tr_b16 a[40:41], v12 offset:2048
v_mfma_f32_16x16x32_bf16 v[64:67], a[20:23], a[64:67], v[64:67]
ds_read_b64_tr_b16 a[42:43], v12 offset:2560
v_mfma_f32_16x16x32_bf16 v[88:91], a[24:27], a[64:67], v[88:91]
ds_read_b64_tr_b16 a[44:45], v13 offset:2048
v_mfma_f32_16x16x32_bf16 v[112:115], a[28:31], a[64:67], v[112:115]
ds_read_b64_tr_b16 a[46:47], v13 offset:2560
v_mfma_f32_16x16x32_bf16 v[44:47], a[16:19], a[68:71], v[44:47]
ds_read_b64_tr_b16 a[48:49], v12 offset:4096
v_mfma_f32_16x16x32_bf16 v[68:71], a[20:23], a[68:71], v[68:71]
ds_read_b64_tr_b16 a[50:51], v12 offset:4608
v_mfma_f32_16x16x32_bf16 v[92:95], a[24:27], a[68:71], v[92:95]
ds_read_b64_tr_b16 a[52:53], v13 offset:4096
v_mfma_f32_16x16x32_bf16 v[116:119], a[28:31], a[68:71], v[116:119]
ds_read_b64_tr_b16 a[54:55], v13 offset:4608
v_mfma_f32_16x16x32_bf16 v[48:51], a[16:19], a[72:75], v[48:51]
v_mfma_f32_16x16x32_bf16 v[72:75], a[20:23], a[72:75], v[72:75]
v_mfma_f32_16x16x32_bf16 v[96:99], a[24:27], a[72:75], v[96:99]
v_mfma_f32_16x16x32_bf16 v[120:123], a[28:31], a[72:75], v[120:123]
v_mfma_f32_16x16x32_bf16 v[52:55], a[16:19], a[76:79], v[52:55]
v_mfma_f32_16x16x32_bf16 v[76:79], a[20:23], a[76:79], v[76:79]
v_mfma_f32_16x16x32_bf16 v[100:103], a[24:27], a[76:79], v[100:103]
v_mfma_f32_16x16x32_bf16 v[124:127], a[28:31], a[76:79], v[124:127]
s_waitcnt lgkmcnt(0)
v_mfma_f32_16x16x32_bf16 v[32:35], a[32:35], a[0:3], v[32:35]
ds_read_b128 a[16:19], v11 offset:0
v_mfma_f32_16x16x32_bf16 v[56:59], a[32:35], a[4:7], v[56:59]
ds_read_b64_tr_b16 a[56:57], v12 offset:12288
v_mfma_f32_16x16x32_bf16 v[80:83], a[32:35], a[8:11], v[80:83]
ds_read_b64_tr_b16 a[58:59], v12 offset:12800
v_mfma_f32_16x16x32_bf16 v[104:107], a[32:35], a[12:15], v[104:107]
ds_read_b128 a[20:23], v11 offset:2048
v_mfma_f32_16x16x32_bf16 v[36:39], a[36:39], a[0:3], v[36:39]
ds_read_b128 a[24:27], v11 offset:4096
v_mfma_f32_16x16x32_bf16 v[60:63], a[36:39], a[4:7], v[60:63]
ds_read_b128 a[28:31], v11 offset:6144
v_mfma_f32_16x16x32_bf16 v[84:87], a[36:39], a[8:11], v[84:87]
ds_read_b64_tr_b16 a[60:61], v13 offset:12288
v_mfma_f32_16x16x32_bf16 v[108:111], a[36:39], a[12:15], v[108:111]
ds_read_b64_tr_b16 a[62:63], v13 offset:12800
v_mfma_f32_16x16x32_bf16 v[40:43], a[0:3], a[40:43], v[40:43]
ds_read_b64_tr_b16 a[64:65], v12 offset:14336
v_mfma_f32_16x16x32_bf16 v[64:67], a[4:7], a[40:43], v[64:67]
ds_read_b64_tr_b16 a[66:67], v12 offset:14848
v_mfma_f32_16x16x32_bf16 v[88:91], a[8:11], a[40:43], v[88:91]
ds_read_b64_tr_b16 a[68:69], v13 offset:14336
v_mfma_f32_16x16x32_bf16 v[112:115], a[12:15], a[40:43], v[112:115]
ds_read_b64_tr_b16 a[70:71], v13 offset:14848
v_mfma_f32_16x16x32_bf16 v[44:47], a[0:3], a[44:47], v[44:47]
ds_read_b64_tr_b16 a[72:73], v12 offset:16384
v_mfma_f32_16x16x32_bf16 v[68:71], a[4:7], a[44:47], v[68:71]
ds_read_b64_tr_b16 a[74:75], v12 offset:16896
v_mfma_f32_16x16x32_bf16 v[92:95], a[8:11], a[44:47], v[92:95]
ds_read_b64_tr_b16 a[76:77], v13 offset:16384
v_mfma_f32_16x16x32_bf16 v[116:119], a[12:15], a[44:47], v[116:119]
ds_read_b64_tr_b16 a[78:79], v13 offset:16896
v_mfma_f32_16x16x32_bf16 v[48:51], a[0:3], a[48:51], v[48:51]
v_mfma_f32_16x16x32_bf16 v[72:75], a[4:7], a[48:51], v[72:75]
v_mfma_f32_16x16x32_bf16 v[96:99], a[8:11], a[48:51], v[96:99]
v_mfma_f32_16x16x32_bf16 v[120:123], a[12:15], a[48:51], v[120:123]
v_mfma_f32_16x16x32_bf16 v[52:55], a[0:3], a[52:55], v[52:55]
v_mfma_f32_16x16x32_bf16 v[76:79], a[4:7], a[52:55], v[76:79]
v_mfma_f32_16x16x32_bf16 v[100:103], a[8:11], a[52:55], v[100:103]
v_mfma_f32_16x16x32_bf16 v[124:127], a[12:15], a[52:55], v[124:127]
s_waitcnt lgkmcnt(0)
v_mfma_f32_16x16x32_bf16 v[32:35], a[56:59], a[16:19], v[32:35]
s_barrier
ds_read_b128 a[0:3], v8 offset:24576
v_mfma_f32_16x16x32_bf16 v[56:59], a[56:59], a[20:23], v[56:59]
ds_read_b64_tr_b16 a[32:33], v14 offset:16384
v_mfma_f32_16x16x32_bf16 v[80:83], a[56:59], a[24:27], v[80:83]
ds_read_b64_tr_b16 a[34:35], v14 offset:16896
v_mfma_f32_16x16x32_bf16 v[104:107], a[56:59], a[28:31], v[104:107]
ds_read_b128 a[4:7], v8 offset:26624
v_mfma_f32_16x16x32_bf16 v[36:39], a[60:63], a[16:19], v[36:39]
ds_read_b128 a[8:11], v8 offset:28672
v_mfma_f32_16x16x32_bf16 v[60:63], a[60:63], a[20:23], v[60:63]
ds_read_b128 a[12:15], v8 offset:30720
v_mfma_f32_16x16x32_bf16 v[84:87], a[60:63], a[24:27], v[84:87]
ds_read_b64_tr_b16 a[36:37], v15 offset:16384
v_mfma_f32_16x16x32_bf16 v[108:111], a[60:63], a[28:31], v[108:111]
ds_read_b64_tr_b16 a[38:39], v15 offset:16896
v_mfma_f32_16x16x32_bf16 v[40:43], a[16:19], a[64:67], v[40:43]
ds_read_b64_tr_b16 a[40:41], v14 offset:18432
v_mfma_f32_16x16x32_bf16 v[64:67], a[20:23], a[64:67], v[64:67]
ds_read_b64_tr_b16 a[42:43], v14 offset:18944
v_mfma_f32_16x16x32_bf16 v[88:91], a[24:27], a[64:67], v[88:91]
ds_read_b64_tr_b16 a[44:45], v15 offset:18432
v_mfma_f32_16x16x32_bf16 v[112:115], a[28:31], a[64:67], v[112:115]
ds_read_b64_tr_b16 a[46:47], v15 offset:18944
v_mfma_f32_16x16x32_bf16 v[44:47], a[16:19], a[68:71], v[44:47]
ds_read_b64_tr_b16 a[48:49], v14 offset:20480
v_mfma_f32_16x16x32_bf16 v[68:71], a[20:23], a[68:71], v[68:71]
ds_read_b64_tr_b16 a[50:51], v14 offset:20992
v_mfma_f32_16x16x32_bf16 v[92:95], a[24:27], a[68:71], v[92:95]
ds_read_b64_tr_b16 a[52:53], v15 offset:20480
v_mfma_f32_16x16x32_bf16 v[116:119], a[28:31], a[68:71], v[116:119]
ds_read_b64_tr_b16 a[54:55], v15 offset:20992
v_mfma_f32_16x16x32_bf16 v[48:51], a[16:19], a[72:75], v[48:51]
v_mfma_f32_16x16x32_bf16 v[72:75], a[20:23], a[72:75], v[72:75]
v_mfma_f32_16x16x32_bf16 v[96:99], a[24:27], a[72:75], v[96:99]
v_mfma_f32_16x16x32_bf16 v[120:123], a[28:31], a[72:75], v[120:123]
v_mfma_f32_16x16x32_bf16 v[52:55], a[16:19], a[76:79], v[52:55]
v_mfma_f32_16x16x32_bf16 v[76:79], a[20:23], a[76:79], v[76:79]
v_mfma_f32_16x16x32_bf16 v[100:103], a[24:27], a[76:79], v[100:103]
v_mfma_f32_16x16x32_bf16 v[124:127], a[28:31], a[76:79], v[124:127]
s_waitcnt lgkmcnt(0)
v_mfma_f32_16x16x32_bf16 v[32:35], a[32:35], a[0:3], v[32:35]
ds_read_b128 a[16:19], v9 offset:24576
v_mfma_f32_16x16x32_bf16 v[56:59], a[32:35], a[4:7], v[56:59]
ds_read_b64_tr_b16 a[56:57], v14 offset:28672
v_mfma_f32_16x16x32_bf16 v[80:83], a[32:35], a[8:11], v[80:83]
ds_read_b64_tr_b16 a[58:59], v14 offset:29184
v_mfma_f32_16x16x32_bf16 v[104:107], a[32:35], a[12:15], v[104:107]
ds_read_b128 a[20:23], v9 offset:26624
v_mfma_f32_16x16x32_bf16 v[36:39], a[36:39], a[0:3], v[36:39]
ds_read_b128 a[24:27], v9 offset:28672
v_mfma_f32_16x16x32_bf16 v[60:63], a[36:39], a[4:7], v[60:63]
ds_read_b128 a[28:31], v9 offset:30720
v_mfma_f32_16x16x32_bf16 v[84:87], a[36:39], a[8:11], v[84:87]
ds_read_b64_tr_b16 a[60:61], v15 offset:28672
v_mfma_f32_16x16x32_bf16 v[108:111], a[36:39], a[12:15], v[108:111]
ds_read_b64_tr_b16 a[62:63], v15 offset:29184
v_mfma_f32_16x16x32_bf16 v[40:43], a[0:3], a[40:43], v[40:43]
ds_read_b64_tr_b16 a[64:65], v14 offset:30720
v_mfma_f32_16x16x32_bf16 v[64:67], a[4:7], a[40:43], v[64:67]
ds_read_b64_tr_b16 a[66:67], v14 offset:31232
v_mfma_f32_16x16x32_bf16 v[88:91], a[8:11], a[40:43], v[88:91]
ds_read_b64_tr_b16 a[68:69], v15 offset:30720
v_mfma_f32_16x16x32_bf16 v[112:115], a[12:15], a[40:43], v[112:115]
ds_read_b64_tr_b16 a[70:71], v15 offset:31232
v_mfma_f32_16x16x32_bf16 v[44:47], a[0:3], a[44:47], v[44:47]
ds_read_b64_tr_b16 a[72:73], v14 offset:32768
v_mfma_f32_16x16x32_bf16 v[68:71], a[4:7], a[44:47], v[68:71]
ds_read_b64_tr_b16 a[74:75], v14 offset:33280
v_mfma_f32_16x16x32_bf16 v[92:95], a[8:11], a[44:47], v[92:95]
ds_read_b64_tr_b16 a[76:77], v15 offset:32768
v_mfma_f32_16x16x32_bf16 v[116:119], a[12:15], a[44:47], v[116:119]
ds_read_b64_tr_b16 a[78:79], v15 offset:33280
v_mfma_f32_16x16x32_bf16 v[48:51], a[0:3], a[48:51], v[48:51]
v_mfma_f32_16x16x32_bf16 v[72:75], a[4:7], a[48:51], v[72:75]
v_mfma_f32_16x16x32_bf16 v[96:99], a[8:11], a[48:51], v[96:99]
v_mfma_f32_16x16x32_bf16 v[120:123], a[12:15], a[48:51], v[120:123]
v_mfma_f32_16x16x32_bf16 v[52:55], a[0:3], a[52:55], v[52:55]
v_mfma_f32_16x16x32_bf16 v[76:79], a[4:7], a[52:55], v[76:79]
v_mfma_f32_16x16x32_bf16 v[100:103], a[8:11], a[52:55], v[100:103]
v_mfma_f32_16x16x32_bf16 v[124:127], a[12:15], a[52:55], v[124:127]
s_waitcnt lgkmcnt(0)
v_mfma_f32_16x16x32_bf16 v[32:35], a[56:59], a[16:19], v[32:35]
s_barrier
ds_read_b128 a[0:3], v10 offset:57344
v_mfma_f32_16x16x32_bf16 v[56:59], a[56:59], a[20:23], v[56:59]
ds_read_b64_tr_b16 a[32:33], v12 offset:40960
v_mfma_f32_16x16x32_bf16 v[80:83], a[56:59], a[24:27], v[80:83]
ds_read_b64_tr_b16 a[34:35], v12 offset:41472
v_mfma_f32_16x16x32_bf16 v[104:107], a[56:59], a[28:31], v[104:107]
ds_read_b128 a[4:7], v10 offset:59392
v_mfma_f32_16x16x32_bf16 v[36:39], a[60:63], a[16:19], v[36:39]
ds_read_b128 a[8:11], v10 offset:61440
v_mfma_f32_16x16x32_bf16 v[60:63], a[60:63], a[20:23], v[60:63]
ds_read_b128 a[12:15], v10 offset:63488
v_mfma_f32_16x16x32_bf16 v[84:87], a[60:63], a[24:27], v[84:87]
ds_read_b64_tr_b16 a[36:37], v13 offset:40960
v_mfma_f32_16x16x32_bf16 v[108:111], a[60:63], a[28:31], v[108:111]
ds_read_b64_tr_b16 a[38:39], v13 offset:41472
v_mfma_f32_16x16x32_bf16 v[40:43], a[16:19], a[64:67], v[40:43]
ds_read_b64_tr_b16 a[40:41], v12 offset:43008
v_mfma_f32_16x16x32_bf16 v[64:67], a[20:23], a[64:67], v[64:67]
ds_read_b64_tr_b16 a[42:43], v12 offset:43520
v_mfma_f32_16x16x32_bf16 v[88:91], a[24:27], a[64:67], v[88:91]
ds_read_b64_tr_b16 a[44:45], v13 offset:43008
v_mfma_f32_16x16x32_bf16 v[112:115], a[28:31], a[64:67], v[112:115]
ds_read_b64_tr_b16 a[46:47], v13 offset:43520
v_mfma_f32_16x16x32_bf16 v[44:47], a[16:19], a[68:71], v[44:47]
ds_read_b64_tr_b16 a[48:49], v12 offset:45056
v_mfma_f32_16x16x32_bf16 v[68:71], a[20:23], a[68:71], v[68:71]
ds_read_b64_tr_b16 a[50:51], v12 offset:45568
v_mfma_f32_16x16x32_bf16 v[92:95], a[24:27], a[68:71], v[92:95]
ds_read_b64_tr_b16 a[52:53], v13 offset:45056
v_mfma_f32_16x16x32_bf16 v[116:119], a[28:31], a[68:71], v[116:119]
ds_read_b64_tr_b16 a[54:55], v13 offset:45568
v_mfma_f32_16x16x32_bf16 v[48:51], a[16:19], a[72:75], v[48:51]
v_mfma_f32_16x16x32_bf16 v[72:75], a[20:23], a[72:75], v[72:75]
v_mfma_f32_16x16x32_bf16 v[96:99], a[24:27], a[72:75], v[96:99]
v_mfma_f32_16x16x32_bf16 v[120:123], a[28:31], a[72:75], v[120:123]
v_mfma_f32_16x16x32_bf16 v[52:55], a[16:19], a[76:79], v[52:55]
v_mfma_f32_16x16x32_bf16 v[76:79], a[20:23], a[76:79], v[76:79]
v_mfma_f32_16x16x32_bf16 v[100:103], a[24:27], a[76:79], v[100:103]
v_mfma_f32_16x16x32_bf16 v[124:127], a[28:31], a[76:79], v[124:127]
s_waitcnt lgkmcnt(0)
v_mfma_f32_16x16x32_bf16 v[32:35], a[32:35], a[0:3], v[32:35]
ds_read_b128 a[16:19], v11 offset:57344
v_mfma_f32_16x16x32_bf16 v[56:59], a[32:35], a[4:7], v[56:59]
ds_read_b64_tr_b16 a[56:57], v12 offset:53248
v_mfma_f32_16x16x32_bf16 v[80:83], a[32:35], a[8:11], v[80:83]
ds_read_b64_tr_b16 a[58:59], v12 offset:53760
v_mfma_f32_16x16x32_bf16 v[104:107], a[32:35], a[12:15], v[104:107]
ds_read_b128 a[20:23], v11 offset:59392
v_mfma_f32_16x16x32_bf16 v[36:39], a[36:39], a[0:3], v[36:39]
ds_read_b128 a[24:27], v11 offset:61440
v_mfma_f32_16x16x32_bf16 v[60:63], a[36:39], a[4:7], v[60:63]
ds_read_b128 a[28:31], v11 offset:63488
v_mfma_f32_16x16x32_bf16 v[84:87], a[36:39], a[8:11], v[84:87]
ds_read_b64_tr_b16 a[60:61], v13 offset:53248
v_mfma_f32_16x16x32_bf16 v[108:111], a[36:39], a[12:15], v[108:111]
ds_read_b64_tr_b16 a[62:63], v13 offset:53760
v_mfma_f32_16x16x32_bf16 v[40:43], a[0:3], a[40:43], v[40:43]
ds_read_b64_tr_b16 a[64:65], v12 offset:55296
v_mfma_f32_16x16x32_bf16 v[64:67], a[4:7], a[40:43], v[64:67]
ds_read_b64_tr_b16 a[66:67], v12 offset:55808
v_mfma_f32_16x16x32_bf16 v[88:91], a[8:11], a[40:43], v[88:91]
ds_read_b64_tr_b16 a[68:69], v13 offset:55296
v_mfma_f32_16x16x32_bf16 v[112:115], a[12:15], a[40:43], v[112:115]
ds_read_b64_tr_b16 a[70:71], v13 offset:55808
v_mfma_f32_16x16x32_bf16 v[44:47], a[0:3], a[44:47], v[44:47]
ds_read_b64_tr_b16 a[72:73], v12 offset:57344
v_mfma_f32_16x16x32_bf16 v[68:71], a[4:7], a[44:47], v[68:71]
ds_read_b64_tr_b16 a[74:75], v12 offset:57856
v_mfma_f32_16x16x32_bf16 v[92:95], a[8:11], a[44:47], v[92:95]
ds_read_b64_tr_b16 a[76:77], v13 offset:57344
v_mfma_f32_16x16x32_bf16 v[116:119], a[12:15], a[44:47], v[116:119]
ds_read_b64_tr_b16 a[78:79], v13 offset:57856
v_mfma_f32_16x16x32_bf16 v[48:51], a[0:3], a[48:51], v[48:51]
v_mfma_f32_16x16x32_bf16 v[72:75], a[4:7], a[48:51], v[72:75]
v_mfma_f32_16x16x32_bf16 v[96:99], a[8:11], a[48:51], v[96:99]
v_mfma_f32_16x16x32_bf16 v[120:123], a[12:15], a[48:51], v[120:123]
v_mfma_f32_16x16x32_bf16 v[52:55], a[0:3], a[52:55], v[52:55]
v_mfma_f32_16x16x32_bf16 v[76:79], a[4:7], a[52:55], v[76:79]
v_mfma_f32_16x16x32_bf16 v[100:103], a[8:11], a[52:55], v[100:103]
v_mfma_f32_16x16x32_bf16 v[124:127], a[12:15], a[52:55], v[124:127]
s_waitcnt lgkmcnt(0)
v_mfma_f32_16x16x32_bf16 v[32:35], a[56:59], a[16:19], v[32:35]
s_barrier
ds_read_b128 a[0:3], v10 offset:40960
v_mfma_f32_16x16x32_bf16 v[56:59], a[56:59], a[20:23], v[56:59]
ds_read_b64_tr_b16 a[32:33], v12 offset:0
v_mfma_f32_16x16x32_bf16 v[80:83], a[56:59], a[24:27], v[80:83]
ds_read_b64_tr_b16 a[34:35], v12 offset:512
v_mfma_f32_16x16x32_bf16 v[104:107], a[56:59], a[28:31], v[104:107]
ds_read_b128 a[4:7], v10 offset:43008
v_mfma_f32_16x16x32_bf16 v[36:39], a[60:63], a[16:19], v[36:39]
ds_read_b128 a[8:11], v10 offset:45056
v_mfma_f32_16x16x32_bf16 v[60:63], a[60:63], a[20:23], v[60:63]
ds_read_b128 a[12:15], v10 offset:47104
v_mfma_f32_16x16x32_bf16 v[84:87], a[60:63], a[24:27], v[84:87]
ds_read_b64_tr_b16 a[36:37], v13 offset:0
v_mfma_f32_16x16x32_bf16 v[108:111], a[60:63], a[28:31], v[108:111]
ds_read_b64_tr_b16 a[38:39], v13 offset:512
v_mfma_f32_16x16x32_bf16 v[40:43], a[16:19], a[64:67], v[40:43]
ds_read_b64_tr_b16 a[40:41], v12 offset:2048
v_mfma_f32_16x16x32_bf16 v[64:67], a[20:23], a[64:67], v[64:67]
ds_read_b64_tr_b16 a[42:43], v12 offset:2560
v_mfma_f32_16x16x32_bf16 v[88:91], a[24:27], a[64:67], v[88:91]
ds_read_b64_tr_b16 a[44:45], v13 offset:2048
v_mfma_f32_16x16x32_bf16 v[112:115], a[28:31], a[64:67], v[112:115]
ds_read_b64_tr_b16 a[46:47], v13 offset:2560
v_mfma_f32_16x16x32_bf16 v[44:47], a[16:19], a[68:71], v[44:47]
ds_read_b64_tr_b16 a[48:49], v12 offset:4096
v_mfma_f32_16x16x32_bf16 v[68:71], a[20:23], a[68:71], v[68:71]
ds_read_b64_tr_b16 a[50:51], v12 offset:4608
v_mfma_f32_16x16x32_bf16 v[92:95], a[24:27], a[68:71], v[92:95]
ds_read_b64_tr_b16 a[52:53], v13 offset:4096
v_mfma_f32_16x16x32_bf16 v[116:119], a[28:31], a[68:71], v[116:119]
ds_read_b64_tr_b16 a[54:55], v13 offset:4608
v_mfma_f32_16x16x32_bf16 v[48:51], a[16:19], a[72:75], v[48:51]
v_mfma_f32_16x16x32_bf16 v[72:75], a[20:23], a[72:75], v[72:75]
v_mfma_f32_16x16x32_bf16 v[96:99], a[24:27], a[72:75], v[96:99]
v_mfma_f32_16x16x32_bf16 v[120:123], a[28:31], a[72:75], v[120:123]
v_mfma_f32_16x16x32_bf16 v[52:55], a[16:19], a[76:79], v[52:55]
v_mfma_f32_16x16x32_bf16 v[76:79], a[20:23], a[76:79], v[76:79]
v_mfma_f32_16x16x32_bf16 v[100:103], a[24:27], a[76:79], v[100:103]
v_mfma_f32_16x16x32_bf16 v[124:127], a[28:31], a[76:79], v[124:127]
s_waitcnt lgkmcnt(0)
v_mfma_f32_16x16x32_bf16 v[32:35], a[32:35], a[0:3], v[32:35]
ds_read_b128 a[16:19], v11 offset:40960
v_mfma_f32_16x16x32_bf16 v[56:59], a[32:35], a[4:7], v[56:59]
ds_read_b64_tr_b16 a[56:57], v12 offset:12288
v_mfma_f32_16x16x32_bf16 v[80:83], a[32:35], a[8:11], v[80:83]
ds_read_b64_tr_b16 a[58:59], v12 offset:12800
v_mfma_f32_16x16x32_bf16 v[104:107], a[32:35], a[12:15], v[104:107]
ds_read_b128 a[20:23], v11 offset:43008
v_mfma_f32_16x16x32_bf16 v[36:39], a[36:39], a[0:3], v[36:39]
ds_read_b128 a[24:27], v11 offset:45056
v_mfma_f32_16x16x32_bf16 v[60:63], a[36:39], a[4:7], v[60:63]
ds_read_b128 a[28:31], v11 offset:47104
v_mfma_f32_16x16x32_bf16 v[84:87], a[36:39], a[8:11], v[84:87]
ds_read_b64_tr_b16 a[60:61], v13 offset:12288
v_mfma_f32_16x16x32_bf16 v[108:111], a[36:39], a[12:15], v[108:111]
ds_read_b64_tr_b16 a[62:63], v13 offset:12800
v_mfma_f32_16x16x32_bf16 v[40:43], a[0:3], a[40:43], v[40:43]
ds_read_b64_tr_b16 a[64:65], v12 offset:14336
v_mfma_f32_16x16x32_bf16 v[64:67], a[4:7], a[40:43], v[64:67]
ds_read_b64_tr_b16 a[66:67], v12 offset:14848
v_mfma_f32_16x16x32_bf16 v[88:91], a[8:11], a[40:43], v[88:91]
ds_read_b64_tr_b16 a[68:69], v13 offset:14336
v_mfma_f32_16x16x32_bf16 v[112:115], a[12:15], a[40:43], v[112:115]
ds_read_b64_tr_b16 a[70:71], v13 offset:14848
v_mfma_f32_16x16x32_bf16 v[44:47], a[0:3], a[44:47], v[44:47]
ds_read_b64_tr_b16 a[72:73], v12 offset:16384
v_mfma_f32_16x16x32_bf16 v[68:71], a[4:7], a[44:47], v[68:71]
ds_read_b64_tr_b16 a[74:75], v12 offset:16896
v_mfma_f32_16x16x32_bf16 v[92:95], a[8:11], a[44:47], v[92:95]
ds_read_b64_tr_b16 a[76:77], v13 offset:16384
v_mfma_f32_16x16x32_bf16 v[116:119], a[12:15], a[44:47], v[116:119]
ds_read_b64_tr_b16 a[78:79], v13 offset:16896
v_mfma_f32_16x16x32_bf16 v[48:51], a[0:3], a[48:51], v[48:51]
v_mfma_f32_16x16x32_bf16 v[72:75], a[4:7], a[48:51], v[72:75]
v_mfma_f32_16x16x32_bf16 v[96:99], a[8:11], a[48:51], v[96:99]
v_mfma_f32_16x16x32_bf16 v[120:123], a[12:15], a[48:51], v[120:123]
v_mfma_f32_16x16x32_bf16 v[52:55], a[0:3], a[52:55], v[52:55]
v_mfma_f32_16x16x32_bf16 v[76:79], a[4:7], a[52:55], v[76:79]
v_mfma_f32_16x16x32_bf16 v[100:103], a[8:11], a[52:55], v[100:103]
v_mfma_f32_16x16x32_bf16 v[124:127], a[12:15], a[52:55], v[124:127]
s_waitcnt lgkmcnt(0)
v_mfma_f32_16x16x32_bf16 v[32:35], a[56:59], a[16:19], v[32:35]
s_barrier
ds_read_b128 a[0:3], v10 offset:0
v_mfma_f32_16x16x32_bf16 v[56:59], a[56:59], a[20:23], v[56:59]
ds_read_b64_tr_b16 a[32:33], v14 offset:16384
v_mfma_f32_16x16x32_bf16 v[80:83], a[56:59], a[24:27], v[80:83]
ds_read_b64_tr_b16 a[34:35], v14 offset:16896
v_mfma_f32_16x16x32_bf16 v[104:107], a[56:59], a[28:31], v[104:107]
ds_read_b128 a[4:7], v10 offset:2048
v_mfma_f32_16x16x32_bf16 v[36:39], a[60:63], a[16:19], v[36:39]
ds_read_b128 a[8:11], v10 offset:4096
v_mfma_f32_16x16x32_bf16 v[60:63], a[60:63], a[20:23], v[60:63]
ds_read_b128 a[12:15], v10 offset:6144
v_mfma_f32_16x16x32_bf16 v[84:87], a[60:63], a[24:27], v[84:87]
ds_read_b64_tr_b16 a[36:37], v15 offset:16384
v_mfma_f32_16x16x32_bf16 v[108:111], a[60:63], a[28:31], v[108:111]
ds_read_b64_tr_b16 a[38:39], v15 offset:16896
v_mfma_f32_16x16x32_bf16 v[40:43], a[16:19], a[64:67], v[40:43]
ds_read_b64_tr_b16 a[40:41], v14 offset:18432
v_mfma_f32_16x16x32_bf16 v[64:67], a[20:23], a[64:67], v[64:67]
ds_read_b64_tr_b16 a[42:43], v14 offset:18944
v_mfma_f32_16x16x32_bf16 v[88:91], a[24:27], a[64:67], v[88:91]
ds_read_b64_tr_b16 a[44:45], v15 offset:18432
v_mfma_f32_16x16x32_bf16 v[112:115], a[28:31], a[64:67], v[112:115]
ds_read_b64_tr_b16 a[46:47], v15 offset:18944
v_mfma_f32_16x16x32_bf16 v[44:47], a[16:19], a[68:71], v[44:47]
ds_read_b64_tr_b16 a[48:49], v14 offset:20480
v_mfma_f32_16x16x32_bf16 v[68:71], a[20:23], a[68:71], v[68:71]
ds_read_b64_tr_b16 a[50:51], v14 offset:20992
v_mfma_f32_16x16x32_bf16 v[92:95], a[24:27], a[68:71], v[92:95]
ds_read_b64_tr_b16 a[52:53], v15 offset:20480
v_mfma_f32_16x16x32_bf16 v[116:119], a[28:31], a[68:71], v[116:119]
ds_read_b64_tr_b16 a[54:55], v15 offset:20992
v_mfma_f32_16x16x32_bf16 v[48:51], a[16:19], a[72:75], v[48:51]
v_mfma_f32_16x16x32_bf16 v[72:75], a[20:23], a[72:75], v[72:75]
v_mfma_f32_16x16x32_bf16 v[96:99], a[24:27], a[72:75], v[96:99]
v_mfma_f32_16x16x32_bf16 v[120:123], a[28:31], a[72:75], v[120:123]
v_mfma_f32_16x16x32_bf16 v[52:55], a[16:19], a[76:79], v[52:55]
v_mfma_f32_16x16x32_bf16 v[76:79], a[20:23], a[76:79], v[76:79]
v_mfma_f32_16x16x32_bf16 v[100:103], a[24:27], a[76:79], v[100:103]
v_mfma_f32_16x16x32_bf16 v[124:127], a[28:31], a[76:79], v[124:127]
s_waitcnt lgkmcnt(0)
v_mfma_f32_16x16x32_bf16 v[32:35], a[32:35], a[0:3], v[32:35]
ds_read_b128 a[16:19], v11 offset:0
v_mfma_f32_16x16x32_bf16 v[56:59], a[32:35], a[4:7], v[56:59]
ds_read_b64_tr_b16 a[56:57], v14 offset:28672
v_mfma_f32_16x16x32_bf16 v[80:83], a[32:35], a[8:11], v[80:83]
ds_read_b64_tr_b16 a[58:59], v14 offset:29184
v_mfma_f32_16x16x32_bf16 v[104:107], a[32:35], a[12:15], v[104:107]
ds_read_b128 a[20:23], v11 offset:2048
v_mfma_f32_16x16x32_bf16 v[36:39], a[36:39], a[0:3], v[36:39]
ds_read_b128 a[24:27], v11 offset:4096
v_mfma_f32_16x16x32_bf16 v[60:63], a[36:39], a[4:7], v[60:63]
ds_read_b128 a[28:31], v11 offset:6144
v_mfma_f32_16x16x32_bf16 v[84:87], a[36:39], a[8:11], v[84:87]
ds_read_b64_tr_b16 a[60:61], v15 offset:28672
v_mfma_f32_16x16x32_bf16 v[108:111], a[36:39], a[12:15], v[108:111]
ds_read_b64_tr_b16 a[62:63], v15 offset:29184
v_mfma_f32_16x16x32_bf16 v[40:43], a[0:3], a[40:43], v[40:43]
ds_read_b64_tr_b16 a[64:65], v14 offset:30720
v_mfma_f32_16x16x32_bf16 v[64:67], a[4:7], a[40:43], v[64:67]
ds_read_b64_tr_b16 a[66:67], v14 offset:31232
v_mfma_f32_16x16x32_bf16 v[88:91], a[8:11], a[40:43], v[88:91]
ds_read_b64_tr_b16 a[68:69], v15 offset:30720
v_mfma_f32_16x16x32_bf16 v[112:115], a[12:15], a[40:43], v[112:115]
ds_read_b64_tr_b16 a[70:71], v15 offset:31232
v_mfma_f32_16x16x32_bf16 v[44:47], a[0:3], a[44:47], v[44:47]
ds_read_b64_tr_b16 a[72:73], v14 offset:32768
v_mfma_f32_16x16x32_bf16 v[68:71], a[4:7], a[44:47], v[68:71]
ds_read_b64_tr_b16 a[74:75], v14 offset:33280
v_mfma_f32_16x16x32_bf16 v[92:95], a[8:11], a[44:47], v[92:95]
ds_read_b64_tr_b16 a[76:77], v15 offset:32768
v_mfma_f32_16x16x32_bf16 v[116:119], a[12:15], a[44:47], v[116:119]
ds_read_b64_tr_b16 a[78:79], v15 offset:33280
v_mfma_f32_16x16x32_bf16 v[48:51], a[0:3], a[48:51], v[48:51]
v_mfma_f32_16x16x32_bf16 v[72:75], a[4:7], a[48:51], v[72:75]
v_mfma_f32_16x16x32_bf16 v[96:99], a[8:11], a[48:51], v[96:99]
v_mfma_f32_16x16x32_bf16 v[120:123], a[12:15], a[48:51], v[120:123]
v_mfma_f32_16x16x32_bf16 v[52:55], a[0:3], a[52:55], v[52:55]
v_mfma_f32_16x16x32_bf16 v[76:79], a[4:7], a[52:55], v[76:79]
v_mfma_f32_16x16x32_bf16 v[100:103], a[8:11], a[52:55], v[100:103]
v_mfma_f32_16x16x32_bf16 v[124:127], a[12:15], a[52:55], v[124:127]
s_waitcnt lgkmcnt(0)
v_mfma_f32_16x16x32_bf16 v[32:35], a[56:59], a[16:19], v[32:35]
s_barrier
ds_read_b128 a[0:3], v8 offset:24576
v_mfma_f32_16x16x32_bf16 v[56:59], a[56:59], a[20:23], v[56:59]
ds_read_b64_tr_b16 a[32:33], v12 offset:40960
v_mfma_f32_16x16x32_bf16 v[80:83], a[56:59], a[24:27], v[80:83]
ds_read_b64_tr_b16 a[34:35], v12 offset:41472
v_mfma_f32_16x16x32_bf16 v[104:107], a[56:59], a[28:31], v[104:107]
ds_read_b128 a[4:7], v8 offset:26624
v_mfma_f32_16x16x32_bf16 v[36:39], a[60:63], a[16:19], v[36:39]
ds_read_b128 a[8:11], v8 offset:28672
v_mfma_f32_16x16x32_bf16 v[60:63], a[60:63], a[20:23], v[60:63]
ds_read_b128 a[12:15], v8 offset:30720
v_mfma_f32_16x16x32_bf16 v[84:87], a[60:63], a[24:27], v[84:87]
ds_read_b64_tr_b16 a[36:37], v13 offset:40960
v_mfma_f32_16x16x32_bf16 v[108:111], a[60:63], a[28:31], v[108:111]
ds_read_b64_tr_b16 a[38:39], v13 offset:41472
v_mfma_f32_16x16x32_bf16 v[40:43], a[16:19], a[64:67], v[40:43]
ds_read_b64_tr_b16 a[40:41], v12 offset:43008
v_mfma_f32_16x16x32_bf16 v[64:67], a[20:23], a[64:67], v[64:67]
ds_read_b64_tr_b16 a[42:43], v12 offset:43520
v_mfma_f32_16x16x32_bf16 v[88:91], a[24:27], a[64:67], v[88:91]
ds_read_b64_tr_b16 a[44:45], v13 offset:43008
v_mfma_f32_16x16x32_bf16 v[112:115], a[28:31], a[64:67], v[112:115]
ds_read_b64_tr_b16 a[46:47], v13 offset:43520
v_mfma_f32_16x16x32_bf16 v[44:47], a[16:19], a[68:71], v[44:47]
ds_read_b64_tr_b16 a[48:49], v12 offset:45056
v_mfma_f32_16x16x32_bf16 v[68:71], a[20:23], a[68:71], v[68:71]
ds_read_b64_tr_b16 a[50:51], v12 offset:45568
v_mfma_f32_16x16x32_bf16 v[92:95], a[24:27], a[68:71], v[92:95]
ds_read_b64_tr_b16 a[52:53], v13 offset:45056
v_mfma_f32_16x16x32_bf16 v[116:119], a[28:31], a[68:71], v[116:119]
ds_read_b64_tr_b16 a[54:55], v13 offset:45568
v_mfma_f32_16x16x32_bf16 v[48:51], a[16:19], a[72:75], v[48:51]
v_mfma_f32_16x16x32_bf16 v[72:75], a[20:23], a[72:75], v[72:75]
v_mfma_f32_16x16x32_bf16 v[96:99], a[24:27], a[72:75], v[96:99]
v_mfma_f32_16x16x32_bf16 v[120:123], a[28:31], a[72:75], v[120:123]
v_mfma_f32_16x16x32_bf16 v[52:55], a[16:19], a[76:79], v[52:55]
v_mfma_f32_16x16x32_bf16 v[76:79], a[20:23], a[76:79], v[76:79]
v_mfma_f32_16x16x32_bf16 v[100:103], a[24:27], a[76:79], v[100:103]
v_mfma_f32_16x16x32_bf16 v[124:127], a[28:31], a[76:79], v[124:127]
s_waitcnt lgkmcnt(0)
v_mfma_f32_16x16x32_bf16 v[32:35], a[32:35], a[0:3], v[32:35]
ds_read_b128 a[16:19], v9 offset:24576
v_mfma_f32_16x16x32_bf16 v[56:59], a[32:35], a[4:7], v[56:59]
ds_read_b64_tr_b16 a[56:57], v12 offset:53248
v_mfma_f32_16x16x32_bf16 v[80:83], a[32:35], a[8:11], v[80:83]
ds_read_b64_tr_b16 a[58:59], v12 offset:53760
v_mfma_f32_16x16x32_bf16 v[104:107], a[32:35], a[12:15], v[104:107]
ds_read_b128 a[20:23], v9 offset:26624
v_mfma_f32_16x16x32_bf16 v[36:39], a[36:39], a[0:3], v[36:39]
ds_read_b128 a[24:27], v9 offset:28672
v_mfma_f32_16x16x32_bf16 v[60:63], a[36:39], a[4:7], v[60:63]
ds_read_b128 a[28:31], v9 offset:30720
v_mfma_f32_16x16x32_bf16 v[84:87], a[36:39], a[8:11], v[84:87]
ds_read_b64_tr_b16 a[60:61], v13 offset:53248
v_mfma_f32_16x16x32_bf16 v[108:111], a[36:39], a[12:15], v[108:111]
ds_read_b64_tr_b16 a[62:63], v13 offset:53760
v_mfma_f32_16x16x32_bf16 v[40:43], a[0:3], a[40:43], v[40:43]
ds_read_b64_tr_b16 a[64:65], v12 offset:55296
v_mfma_f32_16x16x32_bf16 v[64:67], a[4:7], a[40:43], v[64:67]
ds_read_b64_tr_b16 a[66:67], v12 offset:55808
v_mfma_f32_16x16x32_bf16 v[88:91], a[8:11], a[40:43], v[88:91]
ds_read_b64_tr_b16 a[68:69], v13 offset:55296
v_mfma_f32_16x16x32_bf16 v[112:115], a[12:15], a[40:43], v[112:115]
ds_read_b64_tr_b16 a[70:71], v13 offset:55808
v_mfma_f32_16x16x32_bf16 v[44:47], a[0:3], a[44:47], v[44:47]
ds_read_b64_tr_b16 a[72:73], v12 offset:57344
v_mfma_f32_16x16x32_bf16 v[68:71], a[4:7], a[44:47], v[68:71]
ds_read_b64_tr_b16 a[74:75], v12 offset:57856
v_mfma_f32_16x16x32_bf16 v[92:95], a[8:11], a[44:47], v[92:95]
ds_read_b64_tr_b16 a[76:77], v13 offset:57344
v_mfma_f32_16x16x32_bf16 v[116:119], a[12:15], a[44:47], v[116:119]
ds_read_b64_tr_b16 a[78:79], v13 offset:57856
v_mfma_f32_16x16x32_bf16 v[48:51], a[0:3], a[48:51], v[48:51]
v_mfma_f32_16x16x32_bf16 v[72:75], a[4:7], a[48:51], v[72:75]
v_mfma_f32_16x16x32_bf16 v[96:99], a[8:11], a[48:51], v[96:99]
v_mfma_f32_16x16x32_bf16 v[120:123], a[12:15], a[48:51], v[120:123]
v_mfma_f32_16x16x32_bf16 v[52:55], a[0:3], a[52:55], v[52:55]
v_mfma_f32_16x16x32_bf16 v[76:79], a[4:7], a[52:55], v[76:79]
v_mfma_f32_16x16x32_bf16 v[100:103], a[8:11], a[52:55], v[100:103]
v_mfma_f32_16x16x32_bf16 v[124:127], a[12:15], a[52:55], v[124:127]
s_waitcnt lgkmcnt(0)
v_mfma_f32_16x16x32_bf16 v[32:35], a[56:59], a[16:19], v[32:35]
s_barrier
ds_read_b128 a[0:3], v10 offset:57344
v_mfma_f32_16x16x32_bf16 v[56:59], a[56:59], a[20:23], v[56:59]
ds_read_b64_tr_b16 a[32:33], v12 offset:0
v_mfma_f32_16x16x32_bf16 v[80:83], a[56:59], a[24:27], v[80:83]
ds_read_b64_tr_b16 a[34:35], v12 offset:512
v_mfma_f32_16x16x32_bf16 v[104:107], a[56:59], a[28:31], v[104:107]
ds_read_b128 a[4:7], v10 offset:59392
v_mfma_f32_16x16x32_bf16 v[36:39], a[60:63], a[16:19], v[36:39]
ds_read_b128 a[8:11], v10 offset:61440
v_mfma_f32_16x16x32_bf16 v[60:63], a[60:63], a[20:23], v[60:63]
ds_read_b128 a[12:15], v10 offset:63488
v_mfma_f32_16x16x32_bf16 v[84:87], a[60:63], a[24:27], v[84:87]
ds_read_b64_tr_b16 a[36:37], v13 offset:0
v_mfma_f32_16x16x32_bf16 v[108:111], a[60:63], a[28:31], v[108:111]
ds_read_b64_tr_b16 a[38:39], v13 offset:512
v_mfma_f32_16x16x32_bf16 v[40:43], a[16:19], a[64:67], v[40:43]
ds_read_b64_tr_b16 a[40:41], v12 offset:2048
v_mfma_f32_16x16x32_bf16 v[64:67], a[20:23], a[64:67], v[64:67]
ds_read_b64_tr_b16 a[42:43], v12 offset:2560
v_mfma_f32_16x16x32_bf16 v[88:91], a[24:27], a[64:67], v[88:91]
ds_read_b64_tr_b16 a[44:45], v13 offset:2048
v_mfma_f32_16x16x32_bf16 v[112:115], a[28:31], a[64:67], v[112:115]
ds_read_b64_tr_b16 a[46:47], v13 offset:2560
v_mfma_f32_16x16x32_bf16 v[44:47], a[16:19], a[68:71], v[44:47]
ds_read_b64_tr_b16 a[48:49], v12 offset:4096
v_mfma_f32_16x16x32_bf16 v[68:71], a[20:23], a[68:71], v[68:71]
ds_read_b64_tr_b16 a[50:51], v12 offset:4608
v_mfma_f32_16x16x32_bf16 v[92:95], a[24:27], a[68:71], v[92:95]
ds_read_b64_tr_b16 a[52:53], v13 offset:4096
v_mfma_f32_16x16x32_bf16 v[116:119], a[28:31], a[68:71], v[116:119]
ds_read_b64_tr_b16 a[54:55], v13 offset:4608
v_mfma_f32_16x16x32_bf16 v[48:51], a[16:19], a[72:75], v[48:51]
v_mfma_f32_16x16x32_bf16 v[72:75], a[20:23], a[72:75], v[72:75]
v_mfma_f32_16x16x32_bf16 v[96:99], a[24:27], a[72:75], v[96:99]
v_mfma_f32_16x16x32_bf16 v[120:123], a[28:31], a[72:75], v[120:123]
v_mfma_f32_16x16x32_bf16 v[52:55], a[16:19], a[76:79], v[52:55]
v_mfma_f32_16x16x32_bf16 v[76:79], a[20:23], a[76:79], v[76:79]
v_mfma_f32_16x16x32_bf16 v[100:103], a[24:27], a[76:79], v[100:103]
v_mfma_f32_16x16x32_bf16 v[124:127], a[28:31], a[76:79], v[124:127]
s_waitcnt lgkmcnt(0)
v_mfma_f32_16x16x32_bf16 v[32:35], a[32:35], a[0:3], v[32:35]
ds_read_b128 a[16:19], v11 offset:57344
v_mfma_f32_16x16x32_bf16 v[56:59], a[32:35], a[4:7], v[56:59]
ds_read_b64_tr_b16 a[56:57], v12 offset:12288
v_mfma_f32_16x16x32_bf16 v[80:83], a[32:35], a[8:11], v[80:83]
ds_read_b64_tr_b16 a[58:59], v12 offset:12800
v_mfma_f32_16x16x32_bf16 v[104:107], a[32:35], a[12:15], v[104:107]
ds_read_b128 a[20:23], v11 offset:59392
v_mfma_f32_16x16x32_bf16 v[36:39], a[36:39], a[0:3], v[36:39]
ds_read_b128 a[24:27], v11 offset:61440
v_mfma_f32_16x16x32_bf16 v[60:63], a[36:39], a[4:7], v[60:63]
ds_read_b128 a[28:31], v11 offset:63488
v_mfma_f32_16x16x32_bf16 v[84:87], a[36:39], a[8:11], v[84:87]
ds_read_b64_tr_b16 a[60:61], v13 offset:12288
v_mfma_f32_16x16x32_bf16 v[108:111], a[36:39], a[12:15], v[108:111]
ds_read_b64_tr_b16 a[62:63], v13 offset:12800
v_mfma_f32_16x16x32_bf16 v[40:43], a[0:3], a[40:43], v[40:43]
ds_read_b64_tr_b16 a[64:65], v12 offset:14336
v_mfma_f32_16x16x32_bf16 v[64:67], a[4:7], a[40:43], v[64:67]
ds_read_b64_tr_b16 a[66:67], v12 offset:14848
v_mfma_f32_16x16x32_bf16 v[88:91], a[8:11], a[40:43], v[88:91]
ds_read_b64_tr_b16 a[68:69], v13 offset:14336
v_mfma_f32_16x16x32_bf16 v[112:115], a[12:15], a[40:43], v[112:115]
ds_read_b64_tr_b16 a[70:71], v13 offset:14848
v_mfma_f32_16x16x32_bf16 v[44:47], a[0:3], a[44:47], v[44:47]
ds_read_b64_tr_b16 a[72:73], v12 offset:16384
v_mfma_f32_16x16x32_bf16 v[68:71], a[4:7], a[44:47], v[68:71]
ds_read_b64_tr_b16 a[74:75], v12 offset:16896
v_mfma_f32_16x16x32_bf16 v[92:95], a[8:11], a[44:47], v[92:95]
ds_read_b64_tr_b16 a[76:77], v13 offset:16384
v_mfma_f32_16x16x32_bf16 v[116:119], a[12:15], a[44:47], v[116:119]
ds_read_b64_tr_b16 a[78:79], v13 offset:16896
v_mfma_f32_16x16x32_bf16 v[48:51], a[0:3], a[48:51], v[48:51]
v_mfma_f32_16x16x32_bf16 v[72:75], a[4:7], a[48:51], v[72:75]
v_mfma_f32_16x16x32_bf16 v[96:99], a[8:11], a[48:51], v[96:99]
v_mfma_f32_16x16x32_bf16 v[120:123], a[12:15], a[48:51], v[120:123]
v_mfma_f32_16x16x32_bf16 v[52:55], a[0:3], a[52:55], v[52:55]
v_mfma_f32_16x16x32_bf16 v[76:79], a[4:7], a[52:55], v[76:79]
v_mfma_f32_16x16x32_bf16 v[100:103], a[8:11], a[52:55], v[100:103]
v_mfma_f32_16x16x32_bf16 v[124:127], a[12:15], a[52:55], v[124:127]
s_waitcnt lgkmcnt(0)
v_mfma_f32_16x16x32_bf16 v[32:35], a[56:59], a[16:19], v[32:35]
s_barrier
ds_read_b128 a[0:3], v10 offset:40960
v_mfma_f32_16x16x32_bf16 v[56:59], a[56:59], a[20:23], v[56:59]
ds_read_b64_tr_b16 a[32:33], v14 offset:16384
v_mfma_f32_16x16x32_bf16 v[80:83], a[56:59], a[24:27], v[80:83]
ds_read_b64_tr_b16 a[34:35], v14 offset:16896
v_mfma_f32_16x16x32_bf16 v[104:107], a[56:59], a[28:31], v[104:107]
ds_read_b128 a[4:7], v10 offset:43008
v_mfma_f32_16x16x32_bf16 v[36:39], a[60:63], a[16:19], v[36:39]
ds_read_b128 a[8:11], v10 offset:45056
v_mfma_f32_16x16x32_bf16 v[60:63], a[60:63], a[20:23], v[60:63]
ds_read_b128 a[12:15], v10 offset:47104
v_mfma_f32_16x16x32_bf16 v[84:87], a[60:63], a[24:27], v[84:87]
ds_read_b64_tr_b16 a[36:37], v15 offset:16384
v_mfma_f32_16x16x32_bf16 v[108:111], a[60:63], a[28:31], v[108:111]
ds_read_b64_tr_b16 a[38:39], v15 offset:16896
v_mfma_f32_16x16x32_bf16 v[40:43], a[16:19], a[64:67], v[40:43]
ds_read_b64_tr_b16 a[40:41], v14 offset:18432
v_mfma_f32_16x16x32_bf16 v[64:67], a[20:23], a[64:67], v[64:67]
ds_read_b64_tr_b16 a[42:43], v14 offset:18944
v_mfma_f32_16x16x32_bf16 v[88:91], a[24:27], a[64:67], v[88:91]
ds_read_b64_tr_b16 a[44:45], v15 offset:18432
v_mfma_f32_16x16x32_bf16 v[112:115], a[28:31], a[64:67], v[112:115]
ds_read_b64_tr_b16 a[46:47], v15 offset:18944
v_mfma_f32_16x16x32_bf16 v[44:47], a[16:19], a[68:71], v[44:47]
ds_read_b64_tr_b16 a[48:49], v14 offset:20480
v_mfma_f32_16x16x32_bf16 v[68:71], a[20:23], a[68:71], v[68:71]
ds_read_b64_tr_b16 a[50:51], v14 offset:20992
v_mfma_f32_16x16x32_bf16 v[92:95], a[24:27], a[68:71], v[92:95]
ds_read_b64_tr_b16 a[52:53], v15 offset:20480
v_mfma_f32_16x16x32_bf16 v[116:119], a[28:31], a[68:71], v[116:119]
ds_read_b64_tr_b16 a[54:55], v15 offset:20992
v_mfma_f32_16x16x32_bf16 v[48:51], a[16:19], a[72:75], v[48:51]
v_mfma_f32_16x16x32_bf16 v[72:75], a[20:23], a[72:75], v[72:75]
v_mfma_f32_16x16x32_bf16 v[96:99], a[24:27], a[72:75], v[96:99]
v_mfma_f32_16x16x32_bf16 v[120:123], a[28:31], a[72:75], v[120:123]
v_mfma_f32_16x16x32_bf16 v[52:55], a[16:19], a[76:79], v[52:55]
v_mfma_f32_16x16x32_bf16 v[76:79], a[20:23], a[76:79], v[76:79]
v_mfma_f32_16x16x32_bf16 v[100:103], a[24:27], a[76:79], v[100:103]
v_mfma_f32_16x16x32_bf16 v[124:127], a[28:31], a[76:79], v[124:127]
s_waitcnt lgkmcnt(0)
v_mfma_f32_16x16x32_bf16 v[32:35], a[32:35], a[0:3], v[32:35]
ds_read_b128 a[16:19], v11 offset:40960
v_mfma_f32_16x16x32_bf16 v[56:59], a[32:35], a[4:7], v[56:59]
ds_read_b64_tr_b16 a[56:57], v14 offset:28672
v_mfma_f32_16x16x32_bf16 v[80:83], a[32:35], a[8:11], v[80:83]
ds_read_b64_tr_b16 a[58:59], v14 offset:29184
v_mfma_f32_16x16x32_bf16 v[104:107], a[32:35], a[12:15], v[104:107]
ds_read_b128 a[20:23], v11 offset:43008
v_mfma_f32_16x16x32_bf16 v[36:39], a[36:39], a[0:3], v[36:39]
ds_read_b128 a[24:27], v11 offset:45056
v_mfma_f32_16x16x32_bf16 v[60:63], a[36:39], a[4:7], v[60:63]
ds_read_b128 a[28:31], v11 offset:47104
v_mfma_f32_16x16x32_bf16 v[84:87], a[36:39], a[8:11], v[84:87]
ds_read_b64_tr_b16 a[60:61], v15 offset:28672
v_mfma_f32_16x16x32_bf16 v[108:111], a[36:39], a[12:15], v[108:111]
ds_read_b64_tr_b16 a[62:63], v15 offset:29184
v_mfma_f32_16x16x32_bf16 v[40:43], a[0:3], a[40:43], v[40:43]
ds_read_b64_tr_b16 a[64:65], v14 offset:30720
v_mfma_f32_16x16x32_bf16 v[64:67], a[4:7], a[40:43], v[64:67]
ds_read_b64_tr_b16 a[66:67], v14 offset:31232
v_mfma_f32_16x16x32_bf16 v[88:91], a[8:11], a[40:43], v[88:91]
ds_read_b64_tr_b16 a[68:69], v15 offset:30720
v_mfma_f32_16x16x32_bf16 v[112:115], a[12:15], a[40:43], v[112:115]
ds_read_b64_tr_b16 a[70:71], v15 offset:31232
v_mfma_f32_16x16x32_bf16 v[44:47], a[0:3], a[44:47], v[44:47]
ds_read_b64_tr_b16 a[72:73], v14 offset:32768
v_mfma_f32_16x16x32_bf16 v[68:71], a[4:7], a[44:47], v[68:71]
ds_read_b64_tr_b16 a[74:75], v14 offset:33280
v_mfma_f32_16x16x32_bf16 v[92:95], a[8:11], a[44:47], v[92:95]
ds_read_b64_tr_b16 a[76:77], v15 offset:32768
v_mfma_f32_16x16x32_bf16 v[116:119], a[12:15], a[44:47], v[116:119]
ds_read_b64_tr_b16 a[78:79], v15 offset:33280
v_mfma_f32_16x16x32_bf16 v[48:51], a[0:3], a[48:51], v[48:51]
v_mfma_f32_16x16x32_bf16 v[72:75], a[4:7], a[48:51], v[72:75]
v_mfma_f32_16x16x32_bf16 v[96:99], a[8:11], a[48:51], v[96:99]
v_mfma_f32_16x16x32_bf16 v[120:123], a[12:15], a[48:51], v[120:123]
v_mfma_f32_16x16x32_bf16 v[52:55], a[0:3], a[52:55], v[52:55]
v_mfma_f32_16x16x32_bf16 v[76:79], a[4:7], a[52:55], v[76:79]
v_mfma_f32_16x16x32_bf16 v[100:103], a[8:11], a[52:55], v[100:103]
v_mfma_f32_16x16x32_bf16 v[124:127], a[12:15], a[52:55], v[124:127]
s_waitcnt lgkmcnt(0)
v_mfma_f32_16x16x32_bf16 v[32:35], a[56:59], a[16:19], v[32:35]
s_barrier
ds_read_b128 a[0:3], v10 offset:0
v_mfma_f32_16x16x32_bf16 v[56:59], a[56:59], a[20:23], v[56:59]
ds_read_b64_tr_b16 a[32:33], v12 offset:40960
v_mfma_f32_16x16x32_bf16 v[80:83], a[56:59], a[24:27], v[80:83]
ds_read_b64_tr_b16 a[34:35], v12 offset:41472
v_mfma_f32_16x16x32_bf16 v[104:107], a[56:59], a[28:31], v[104:107]
ds_read_b128 a[4:7], v10 offset:2048
v_mfma_f32_16x16x32_bf16 v[36:39], a[60:63], a[16:19], v[36:39]
ds_read_b128 a[8:11], v10 offset:4096
v_mfma_f32_16x16x32_bf16 v[60:63], a[60:63], a[20:23], v[60:63]
ds_read_b128 a[12:15], v10 offset:6144
v_mfma_f32_16x16x32_bf16 v[84:87], a[60:63], a[24:27], v[84:87]
ds_read_b64_tr_b16 a[36:37], v13 offset:40960
v_mfma_f32_16x16x32_bf16 v[108:111], a[60:63], a[28:31], v[108:111]
ds_read_b64_tr_b16 a[38:39], v13 offset:41472
v_mfma_f32_16x16x32_bf16 v[40:43], a[16:19], a[64:67], v[40:43]
ds_read_b64_tr_b16 a[40:41], v12 offset:43008
v_mfma_f32_16x16x32_bf16 v[64:67], a[20:23], a[64:67], v[64:67]
ds_read_b64_tr_b16 a[42:43], v12 offset:43520
v_mfma_f32_16x16x32_bf16 v[88:91], a[24:27], a[64:67], v[88:91]
ds_read_b64_tr_b16 a[44:45], v13 offset:43008
v_mfma_f32_16x16x32_bf16 v[112:115], a[28:31], a[64:67], v[112:115]
ds_read_b64_tr_b16 a[46:47], v13 offset:43520
v_mfma_f32_16x16x32_bf16 v[44:47], a[16:19], a[68:71], v[44:47]
ds_read_b64_tr_b16 a[48:49], v12 offset:45056
v_mfma_f32_16x16x32_bf16 v[68:71], a[20:23], a[68:71], v[68:71]
ds_read_b64_tr_b16 a[50:51], v12 offset:45568
v_mfma_f32_16x16x32_bf16 v[92:95], a[24:27], a[68:71], v[92:95]
ds_read_b64_tr_b16 a[52:53], v13 offset:45056
v_mfma_f32_16x16x32_bf16 v[116:119], a[28:31], a[68:71], v[116:119]
ds_read_b64_tr_b16 a[54:55], v13 offset:45568
v_mfma_f32_16x16x32_bf16 v[48:51], a[16:19], a[72:75], v[48:51]
v_mfma_f32_16x16x32_bf16 v[72:75], a[20:23], a[72:75], v[72:75]
v_mfma_f32_16x16x32_bf16 v[96:99], a[24:27], a[72:75], v[96:99]
v_mfma_f32_16x16x32_bf16 v[120:123], a[28:31], a[72:75], v[120:123]
v_mfma_f32_16x16x32_bf16 v[52:55], a[16:19], a[76:79], v[52:55]
v_mfma_f32_16x16x32_bf16 v[76:79], a[20:23], a[76:79], v[76:79]
v_mfma_f32_16x16x32_bf16 v[100:103], a[24:27], a[76:79], v[100:103]
v_mfma_f32_16x16x32_bf16 v[124:127], a[28:31], a[76:79], v[124:127]
s_waitcnt lgkmcnt(0)
v_mfma_f32_16x16x32_bf16 v[32:35], a[32:35], a[0:3], v[32:35]
ds_read_b128 a[16:19], v11 offset:0
v_mfma_f32_16x16x32_bf16 v[56:59], a[32:35], a[4:7], v[56:59]
ds_read_b64_tr_b16 a[56:57], v12 offset:53248
v_mfma_f32_16x16x32_bf16 v[80:83], a[32:35], a[8:11], v[80:83]
ds_read_b64_tr_b16 a[58:59], v12 offset:53760
v_mfma_f32_16x16x32_bf16 v[104:107], a[32:35], a[12:15], v[104:107]
ds_read_b128 a[20:23], v11 offset:2048
v_mfma_f32_16x16x32_bf16 v[36:39], a[36:39], a[0:3], v[36:39]
ds_read_b128 a[24:27], v11 offset:4096
v_mfma_f32_16x16x32_bf16 v[60:63], a[36:39], a[4:7], v[60:63]
ds_read_b128 a[28:31], v11 offset:6144
v_mfma_f32_16x16x32_bf16 v[84:87], a[36:39], a[8:11], v[84:87]
ds_read_b64_tr_b16 a[60:61], v13 offset:53248
v_mfma_f32_16x16x32_bf16 v[108:111], a[36:39], a[12:15], v[108:111]
ds_read_b64_tr_b16 a[62:63], v13 offset:53760
v_mfma_f32_16x16x32_bf16 v[40:43], a[0:3], a[40:43], v[40:43]
ds_read_b64_tr_b16 a[64:65], v12 offset:55296
v_mfma_f32_16x16x32_bf16 v[64:67], a[4:7], a[40:43], v[64:67]
ds_read_b64_tr_b16 a[66:67], v12 offset:55808
v_mfma_f32_16x16x32_bf16 v[88:91], a[8:11], a[40:43], v[88:91]
ds_read_b64_tr_b16 a[68:69], v13 offset:55296
v_mfma_f32_16x16x32_bf16 v[112:115], a[12:15], a[40:43], v[112:115]
ds_read_b64_tr_b16 a[70:71], v13 offset:55808
v_mfma_f32_16x16x32_bf16 v[44:47], a[0:3], a[44:47], v[44:47]
ds_read_b64_tr_b16 a[72:73], v12 offset:57344
v_mfma_f32_16x16x32_bf16 v[68:71], a[4:7], a[44:47], v[68:71]
ds_read_b64_tr_b16 a[74:75], v12 offset:57856
v_mfma_f32_16x16x32_bf16 v[92:95], a[8:11], a[44:47], v[92:95]
ds_read_b64_tr_b16 a[76:77], v13 offset:57344
v_mfma_f32_16x16x32_bf16 v[116:119], a[12:15], a[44:47], v[116:119]
ds_read_b64_tr_b16 a[78:79], v13 offset:57856
v_mfma_f32_16x16x32_bf16 v[48:51], a[0:3], a[48:51], v[48:51]
v_lshrrev_b32 v2, 4, v1
v_lshlrev_b32 v2, 4, v2
s_lshl_b32 s70, s66, 8
s_add_u32 s70, s70, 159744
v_add_u32 v17, s70, v2
v_mfma_f32_16x16x32_bf16 v[72:75], a[4:7], a[48:51], v[72:75]
v_mfma_f32_16x16x32_bf16 v[96:99], a[8:11], a[48:51], v[96:99]
v_and_b32 v2, 15, v1
v_lshlrev_b32 v2, 2, v2
s_lshl_b32 s70, s67, 7
s_add_u32 s70, s70, 160768
v_add_u32 v18, s70, v2
v_mfma_f32_16x16x32_bf16 v[120:123], a[12:15], a[48:51], v[120:123]
v_mfma_f32_16x16x32_bf16 v[52:55], a[0:3], a[52:55], v[52:55]
v_mfma_f32_16x16x32_bf16 v[76:79], a[4:7], a[52:55], v[76:79]
v_mfma_f32_16x16x32_bf16 v[100:103], a[8:11], a[52:55], v[100:103]
v_mfma_f32_16x16x32_bf16 v[124:127], a[12:15], a[52:55], v[124:127]
s_waitcnt lgkmcnt(0)
v_mfma_f32_16x16x32_bf16 v[32:35], a[56:59], a[16:19], v[32:35]
s_barrier
ds_read_b128 a[0:3], v8 offset:24576
v_mfma_f32_16x16x32_bf16 v[56:59], a[56:59], a[20:23], v[56:59]
ds_read_b64_tr_b16 a[32:33], v12 offset:0
v_mfma_f32_16x16x32_bf16 v[80:83], a[56:59], a[24:27], v[80:83]
ds_read_b64_tr_b16 a[34:35], v12 offset:512
v_mfma_f32_16x16x32_bf16 v[104:107], a[56:59], a[28:31], v[104:107]
ds_read_b128 a[4:7], v8 offset:26624
v_mfma_f32_16x16x32_bf16 v[36:39], a[60:63], a[16:19], v[36:39]
ds_read_b128 a[8:11], v8 offset:28672
v_mfma_f32_16x16x32_bf16 v[60:63], a[60:63], a[20:23], v[60:63]
ds_read_b128 a[12:15], v8 offset:30720
v_mfma_f32_16x16x32_bf16 v[84:87], a[60:63], a[24:27], v[84:87]
ds_read_b64_tr_b16 a[36:37], v13 offset:0
v_mfma_f32_16x16x32_bf16 v[108:111], a[60:63], a[28:31], v[108:111]
ds_read_b64_tr_b16 a[38:39], v13 offset:512
v_mfma_f32_16x16x32_bf16 v[40:43], a[16:19], a[64:67], v[40:43]
ds_read_b64_tr_b16 a[40:41], v12 offset:2048
v_mfma_f32_16x16x32_bf16 v[64:67], a[20:23], a[64:67], v[64:67]
ds_read_b64_tr_b16 a[42:43], v12 offset:2560
v_mfma_f32_16x16x32_bf16 v[88:91], a[24:27], a[64:67], v[88:91]
ds_read_b64_tr_b16 a[44:45], v13 offset:2048
v_mfma_f32_16x16x32_bf16 v[112:115], a[28:31], a[64:67], v[112:115]
ds_read_b64_tr_b16 a[46:47], v13 offset:2560
v_mfma_f32_16x16x32_bf16 v[44:47], a[16:19], a[68:71], v[44:47]
ds_read_b64_tr_b16 a[48:49], v12 offset:4096
v_mfma_f32_16x16x32_bf16 v[68:71], a[20:23], a[68:71], v[68:71]
ds_read_b64_tr_b16 a[50:51], v12 offset:4608
v_mfma_f32_16x16x32_bf16 v[92:95], a[24:27], a[68:71], v[92:95]
ds_read_b64_tr_b16 a[52:53], v13 offset:4096
v_mfma_f32_16x16x32_bf16 v[116:119], a[28:31], a[68:71], v[116:119]
ds_read_b64_tr_b16 a[54:55], v13 offset:4608
v_mfma_f32_16x16x32_bf16 v[48:51], a[16:19], a[72:75], v[48:51]
v_mfma_f32_16x16x32_bf16 v[72:75], a[20:23], a[72:75], v[72:75]
v_mfma_f32_16x16x32_bf16 v[96:99], a[24:27], a[72:75], v[96:99]
v_mfma_f32_16x16x32_bf16 v[120:123], a[28:31], a[72:75], v[120:123]
v_mfma_f32_16x16x32_bf16 v[52:55], a[16:19], a[76:79], v[52:55]
v_mfma_f32_16x16x32_bf16 v[76:79], a[20:23], a[76:79], v[76:79]
v_mfma_f32_16x16x32_bf16 v[100:103], a[24:27], a[76:79], v[100:103]
v_mfma_f32_16x16x32_bf16 v[124:127], a[28:31], a[76:79], v[124:127]
s_waitcnt lgkmcnt(0)
v_mfma_f32_16x16x32_bf16 v[32:35], a[32:35], a[0:3], v[32:35]
ds_read_b128 a[16:19], v9 offset:24576
v_mfma_f32_16x16x32_bf16 v[56:59], a[32:35], a[4:7], v[56:59]
ds_read_b64_tr_b16 a[56:57], v12 offset:12288
v_mfma_f32_16x16x32_bf16 v[80:83], a[32:35], a[8:11], v[80:83]
ds_read_b64_tr_b16 a[58:59], v12 offset:12800
v_mfma_f32_16x16x32_bf16 v[104:107], a[32:35], a[12:15], v[104:107]
ds_read_b128 a[20:23], v9 offset:26624
v_mfma_f32_16x16x32_bf16 v[36:39], a[36:39], a[0:3], v[36:39]
ds_read_b128 a[24:27], v9 offset:28672
v_mfma_f32_16x16x32_bf16 v[60:63], a[36:39], a[4:7], v[60:63]
ds_read_b128 a[28:31], v9 offset:30720
v_mfma_f32_16x16x32_bf16 v[84:87], a[36:39], a[8:11], v[84:87]
ds_read_b64_tr_b16 a[60:61], v13 offset:12288
v_mfma_f32_16x16x32_bf16 v[108:111], a[36:39], a[12:15], v[108:111]
ds_read_b64_tr_b16 a[62:63], v13 offset:12800
v_mfma_f32_16x16x32_bf16 v[40:43], a[0:3], a[40:43], v[40:43]
ds_read_b64_tr_b16 a[64:65], v12 offset:14336
v_mfma_f32_16x16x32_bf16 v[64:67], a[4:7], a[40:43], v[64:67]
ds_read_b64_tr_b16 a[66:67], v12 offset:14848
v_mfma_f32_16x16x32_bf16 v[88:91], a[8:11], a[40:43], v[88:91]
ds_read_b64_tr_b16 a[68:69], v13 offset:14336
v_mfma_f32_16x16x32_bf16 v[112:115], a[12:15], a[40:43], v[112:115]
ds_read_b64_tr_b16 a[70:71], v13 offset:14848
v_mfma_f32_16x16x32_bf16 v[44:47], a[0:3], a[44:47], v[44:47]
ds_read_b64_tr_b16 a[72:73], v12 offset:16384
v_mfma_f32_16x16x32_bf16 v[68:71], a[4:7], a[44:47], v[68:71]
ds_read_b64_tr_b16 a[74:75], v12 offset:16896
v_mfma_f32_16x16x32_bf16 v[92:95], a[8:11], a[44:47], v[92:95]
ds_read_b64_tr_b16 a[76:77], v13 offset:16384
v_mfma_f32_16x16x32_bf16 v[116:119], a[12:15], a[44:47], v[116:119]
ds_read_b64_tr_b16 a[78:79], v13 offset:16896
v_mfma_f32_16x16x32_bf16 v[48:51], a[0:3], a[48:51], v[48:51]
v_mfma_f32_16x16x32_bf16 v[72:75], a[4:7], a[48:51], v[72:75]
v_mfma_f32_16x16x32_bf16 v[96:99], a[8:11], a[48:51], v[96:99]
v_mfma_f32_16x16x32_bf16 v[120:123], a[12:15], a[48:51], v[120:123]
v_mfma_f32_16x16x32_bf16 v[52:55], a[0:3], a[52:55], v[52:55]
v_mfma_f32_16x16x32_bf16 v[76:79], a[4:7], a[52:55], v[76:79]
v_mfma_f32_16x16x32_bf16 v[100:103], a[8:11], a[52:55], v[100:103]
v_mfma_f32_16x16x32_bf16 v[124:127], a[12:15], a[52:55], v[124:127]
s_waitcnt lgkmcnt(0)
v_mfma_f32_16x16x32_bf16 v[40:43], a[16:19], a[64:67], v[40:43]
s_barrier
ds_read_b128 v[20:23], v17 offset:0
v_mfma_f32_16x16x32_bf16 v[64:67], a[20:23], a[64:67], v[64:67]
ds_read_b128 v[24:27], v17 offset:512
v_mfma_f32_16x16x32_bf16 v[88:91], a[24:27], a[64:67], v[88:91]
ds_read_b32 v6, v18 offset:256
v_mfma_f32_16x16x32_bf16 v[112:115], a[28:31], a[64:67], v[112:115]
ds_read_b32 v8, v18 offset:320
v_mfma_f32_16x16x32_bf16 v[44:47], a[16:19], a[68:71], v[44:47]
ds_read_b32 v10, v18 offset:512
v_mfma_f32_16x16x32_bf16 v[68:71], a[20:23], a[68:71], v[68:71]
ds_read_b32 v18, v18 offset:576
v_mfma_f32_16x16x32_bf16 v[92:95], a[24:27], a[68:71], v[92:95]
v_mov_b32 v19, 161536
ds_read_b32 v19, v19
v_mfma_f32_16x16x32_bf16 v[116:119], a[28:31], a[68:71], v[116:119]
ds_read_b128 v[128:131], v17 offset:64
v_mfma_f32_16x16x32_bf16 v[48:51], a[16:19], a[72:75], v[48:51]
ds_read_b128 v[132:135], v17 offset:576
v_mfma_f32_16x16x32_bf16 v[72:75], a[20:23], a[72:75], v[72:75]
ds_read_b128 v[136:139], v17 offset:128
v_mfma_f32_16x16x32_bf16 v[96:99], a[24:27], a[72:75], v[96:99]
ds_read_b128 v[140:143], v17 offset:640
v_mfma_f32_16x16x32_bf16 v[120:123], a[28:31], a[72:75], v[120:123]
ds_read_b128 v[144:147], v17 offset:192
v_mfma_f32_16x16x32_bf16 v[52:55], a[16:19], a[76:79], v[52:55]
ds_read_b128 v[148:151], v17 offset:704
v_mfma_f32_16x16x32_bf16 v[76:79], a[20:23], a[76:79], v[76:79]
v_mfma_f32_16x16x32_bf16 v[100:103], a[24:27], a[76:79], v[100:103]
v_mfma_f32_16x16x32_bf16 v[124:127], a[28:31], a[76:79], v[124:127]
v_mfma_f32_16x16x32_bf16 v[32:35], a[56:59], a[16:19], v[32:35]
v_mfma_f32_16x16x32_bf16 v[56:59], a[56:59], a[20:23], v[56:59]
v_mfma_f32_16x16x32_bf16 v[80:83], a[56:59], a[24:27], v[80:83]
v_mfma_f32_16x16x32_bf16 v[104:107], a[56:59], a[28:31], v[104:107]
v_mfma_f32_16x16x32_bf16 v[36:39], a[60:63], a[16:19], v[36:39]
v_mfma_f32_16x16x32_bf16 v[60:63], a[60:63], a[20:23], v[60:63]
v_mfma_f32_16x16x32_bf16 v[84:87], a[60:63], a[24:27], v[84:87]
v_mfma_f32_16x16x32_bf16 v[108:111], a[60:63], a[28:31], v[108:111]
s_waitcnt lgkmcnt(0)
v_readfirstlane_b32 s69, v19
v_pk_mul_f32 v[28:29], v[24:25], s[90:91]
v_pk_mul_f32 v[30:31], v[26:27], s[90:91]
v_pk_fma_f32 v[40:41], v[20:21], v[6:7], v[40:41] op_sel:[0,0,0] op_sel_hi:[1,0,1]
v_pk_fma_f32 v[44:45], v[20:21], v[8:9], v[44:45] op_sel:[0,0,0] op_sel_hi:[1,0,1]
v_pk_fma_f32 v[42:43], v[22:23], v[6:7], v[42:43] op_sel:[0,0,0] op_sel_hi:[1,0,1]
v_pk_fma_f32 v[46:47], v[22:23], v[8:9], v[46:47] op_sel:[0,0,0] op_sel_hi:[1,0,1]
v_pk_mul_f32 v[2:3], v[40:41], v[28:29]
v_pk_mul_f32 v[12:13], v[44:45], v[28:29]
v_pk_mul_f32 v[4:5], v[42:43], v[30:31]
v_pk_mul_f32 v[14:15], v[46:47], v[30:31]
v_pk_fma_f32 v[40:41], v[40:41], v[24:25], s[82:83]
v_pk_fma_f32 v[44:45], v[44:45], v[24:25], s[82:83]
v_pk_fma_f32 v[42:43], v[42:43], v[26:27], s[82:83]
v_pk_fma_f32 v[46:47], v[46:47], v[26:27], s[82:83]
v_exp_f32_e64 v2, v2 clamp
v_exp_f32_e64 v12, v12 clamp
v_exp_f32_e64 v3, v3 clamp
v_exp_f32_e64 v13, v13 clamp
v_exp_f32_e64 v4, v4 clamp
v_exp_f32_e64 v14, v14 clamp
v_exp_f32_e64 v5, v5 clamp
v_exp_f32_e64 v15, v15 clamp
v_pk_add_f32 v[2:3], v[2:3], s[80:81]
v_pk_add_f32 v[12:13], v[12:13], s[80:81]
v_pk_add_f32 v[4:5], v[4:5], s[80:81]
v_pk_add_f32 v[14:15], v[14:15], s[80:81]
v_max_f32 v40, v40, v2
v_max_f32 v44, v44, v12
v_max_f32 v41, v41, v3
v_max_f32 v45, v45, v13
v_max_f32 v42, v42, v4
v_max_f32 v46, v46, v14
v_max_f32 v43, v43, v5
v_max_f32 v47, v47, v15
v_cvt_pk_bf16_f32 v40, v40, v41
v_cvt_pk_bf16_f32 v44, v44, v45
v_cvt_pk_bf16_f32 v41, v42, v43
v_cvt_pk_bf16_f32 v45, v46, v47
v_pk_fma_f32 v[48:49], v[20:21], v[10:11], v[48:49] op_sel:[0,0,0] op_sel_hi:[1,0,1]
v_pk_fma_f32 v[52:53], v[20:21], v[18:19], v[52:53] op_sel:[0,0,0] op_sel_hi:[1,0,1]
v_pk_fma_f32 v[50:51], v[22:23], v[10:11], v[50:51] op_sel:[0,0,0] op_sel_hi:[1,0,1]
v_pk_fma_f32 v[54:55], v[22:23], v[18:19], v[54:55] op_sel:[0,0,0] op_sel_hi:[1,0,1]
v_pk_mul_f32 v[48:49], v[48:49], v[24:25]
v_pk_mul_f32 v[52:53], v[52:53], v[24:25]
v_pk_mul_f32 v[50:51], v[50:51], v[26:27]
v_pk_mul_f32 v[54:55], v[54:55], v[26:27]
v_cvt_pk_bf16_f32 v48, v48, v49
v_cvt_pk_bf16_f32 v52, v52, v53
v_cvt_pk_bf16_f32 v49, v50, v51
v_cvt_pk_bf16_f32 v53, v54, v55
v_pk_mul_f32 v[28:29], v[132:133], s[90:91]
v_pk_mul_f32 v[30:31], v[134:135], s[90:91]
v_pk_fma_f32 v[64:65], v[128:129], v[6:7], v[64:65] op_sel:[0,0,0] op_sel_hi:[1,0,1]
v_pk_fma_f32 v[68:69], v[128:129], v[8:9], v[68:69] op_sel:[0,0,0] op_sel_hi:[1,0,1]
v_pk_fma_f32 v[66:67], v[130:131], v[6:7], v[66:67] op_sel:[0,0,0] op_sel_hi:[1,0,1]
v_pk_fma_f32 v[70:71], v[130:131], v[8:9], v[70:71] op_sel:[0,0,0] op_sel_hi:[1,0,1]
v_pk_mul_f32 v[2:3], v[64:65], v[28:29]
v_pk_mul_f32 v[12:13], v[68:69], v[28:29]
v_pk_mul_f32 v[4:5], v[66:67], v[30:31]
v_pk_mul_f32 v[14:15], v[70:71], v[30:31]
v_pk_fma_f32 v[64:65], v[64:65], v[132:133], s[82:83]
v_pk_fma_f32 v[68:69], v[68:69], v[132:133], s[82:83]
v_pk_fma_f32 v[66:67], v[66:67], v[134:135], s[82:83]
v_pk_fma_f32 v[70:71], v[70:71], v[134:135], s[82:83]
v_exp_f32_e64 v2, v2 clamp
v_exp_f32_e64 v12, v12 clamp
v_exp_f32_e64 v3, v3 clamp
v_exp_f32_e64 v13, v13 clamp
v_exp_f32_e64 v4, v4 clamp
v_exp_f32_e64 v14, v14 clamp
v_exp_f32_e64 v5, v5 clamp
v_exp_f32_e64 v15, v15 clamp
v_pk_add_f32 v[2:3], v[2:3], s[80:81]
v_pk_add_f32 v[12:13], v[12:13], s[80:81]
v_pk_add_f32 v[4:5], v[4:5], s[80:81]
v_pk_add_f32 v[14:15], v[14:15], s[80:81]
v_max_f32 v64, v64, v2
v_max_f32 v68, v68, v12
v_max_f32 v65, v65, v3
v_max_f32 v69, v69, v13
v_max_f32 v66, v66, v4
v_max_f32 v70, v70, v14
v_max_f32 v67, v67, v5
v_max_f32 v71, v71, v15
v_cvt_pk_bf16_f32 v42, v64, v65
v_cvt_pk_bf16_f32 v46, v68, v69
v_cvt_pk_bf16_f32 v43, v66, v67
v_cvt_pk_bf16_f32 v47, v70, v71
v_pk_fma_f32 v[72:73], v[128:129], v[10:11], v[72:73] op_sel:[0,0,0] op_sel_hi:[1,0,1]
v_pk_fma_f32 v[76:77], v[128:129], v[18:19], v[76:77] op_sel:[0,0,0] op_sel_hi:[1,0,1]
v_pk_fma_f32 v[74:75], v[130:131], v[10:11], v[74:75] op_sel:[0,0,0] op_sel_hi:[1,0,1]
v_pk_fma_f32 v[78:79], v[130:131], v[18:19], v[78:79] op_sel:[0,0,0] op_sel_hi:[1,0,1]
v_pk_mul_f32 v[72:73], v[72:73], v[132:133]
v_pk_mul_f32 v[76:77], v[76:77], v[132:133]
v_pk_mul_f32 v[74:75], v[74:75], v[134:135]
v_pk_mul_f32 v[78:79], v[78:79], v[134:135]
v_cvt_pk_bf16_f32 v50, v72, v73
v_cvt_pk_bf16_f32 v54, v76, v77
v_cvt_pk_bf16_f32 v51, v74, v75
v_cvt_pk_bf16_f32 v55, v78, v79
s_nop 0
v_mfma_f32_16x16x32_bf16 v[64:67], v[40:43], v[48:51], 0
v_mfma_f32_16x16x32_bf16 v[68:71], v[40:43], v[52:55], 0
v_mfma_f32_16x16x32_bf16 v[20:23], v[40:43], a[80:83], 0
v_mfma_f32_16x16x32_bf16 v[72:75], v[44:47], v[48:51], 0
v_mfma_f32_16x16x32_bf16 v[76:79], v[44:47], v[52:55], 0
v_mfma_f32_16x16x32_bf16 v[24:27], v[44:47], a[80:83], 0
v_pk_mul_f32 v[28:29], v[140:141], s[90:91]
v_pk_mul_f32 v[30:31], v[142:143], s[90:91]
v_pk_fma_f32 v[88:89], v[136:137], v[6:7], v[88:89] op_sel:[0,0,0] op_sel_hi:[1,0,1]
v_pk_fma_f32 v[92:93], v[136:137], v[8:9], v[92:93] op_sel:[0,0,0] op_sel_hi:[1,0,1]
v_pk_fma_f32 v[90:91], v[138:139], v[6:7], v[90:91] op_sel:[0,0,0] op_sel_hi:[1,0,1]
v_pk_fma_f32 v[94:95], v[138:139], v[8:9], v[94:95] op_sel:[0,0,0] op_sel_hi:[1,0,1]
v_pk_mul_f32 v[2:3], v[88:89], v[28:29]
v_pk_mul_f32 v[12:13], v[92:93], v[28:29]
v_pk_mul_f32 v[4:5], v[90:91], v[30:31]
v_pk_mul_f32 v[14:15], v[94:95], v[30:31]
v_pk_fma_f32 v[88:89], v[88:89], v[140:141], s[82:83]
v_pk_fma_f32 v[92:93], v[92:93], v[140:141], s[82:83]
v_pk_fma_f32 v[90:91], v[90:91], v[142:143], s[82:83]
v_pk_fma_f32 v[94:95], v[94:95], v[142:143], s[82:83]
v_exp_f32_e64 v2, v2 clamp
v_exp_f32_e64 v12, v12 clamp
v_exp_f32_e64 v3, v3 clamp
v_exp_f32_e64 v13, v13 clamp
v_exp_f32_e64 v4, v4 clamp
v_exp_f32_e64 v14, v14 clamp
v_exp_f32_e64 v5, v5 clamp
v_exp_f32_e64 v15, v15 clamp
v_pk_add_f32 v[2:3], v[2:3], s[80:81]
v_pk_add_f32 v[12:13], v[12:13], s[80:81]
v_pk_add_f32 v[4:5], v[4:5], s[80:81]
v_pk_add_f32 v[14:15], v[14:15], s[80:81]
v_max_f32 v88, v88, v2
v_max_f32 v92, v92, v12
v_max_f32 v89, v89, v3
v_max_f32 v93, v93, v13
v_max_f32 v90, v90, v4
v_max_f32 v94, v94, v14
v_max_f32 v91, v91, v5
v_max_f32 v95, v95, v15
v_cvt_pk_bf16_f32 v88, v88, v89
v_cvt_pk_bf16_f32 v92, v92, v93
v_cvt_pk_bf16_f32 v89, v90, v91
v_cvt_pk_bf16_f32 v93, v94, v95
v_pk_fma_f32 v[96:97], v[136:137], v[10:11], v[96:97] op_sel:[0,0,0] op_sel_hi:[1,0,1]
v_pk_fma_f32 v[100:101], v[136:137], v[18:19], v[100:101] op_sel:[0,0,0] op_sel_hi:[1,0,1]
v_pk_fma_f32 v[98:99], v[138:139], v[10:11], v[98:99] op_sel:[0,0,0] op_sel_hi:[1,0,1]
v_pk_fma_f32 v[102:103], v[138:139], v[18:19], v[102:103] op_sel:[0,0,0] op_sel_hi:[1,0,1]
v_pk_mul_f32 v[96:97], v[96:97], v[140:141]
v_pk_mul_f32 v[100:101], v[100:101], v[140:141]
v_pk_mul_f32 v[98:99], v[98:99], v[142:143]
v_pk_mul_f32 v[102:103], v[102:103], v[142:143]
v_cvt_pk_bf16_f32 v96, v96, v97
v_cvt_pk_bf16_f32 v100, v100, v101
v_cvt_pk_bf16_f32 v97, v98, v99
v_cvt_pk_bf16_f32 v101, v102, v103
v_pk_mul_f32 v[28:29], v[148:149], s[90:91]
v_pk_mul_f32 v[30:31], v[150:151], s[90:91]
v_pk_fma_f32 v[112:113], v[144:145], v[6:7], v[112:113] op_sel:[0,0,0] op_sel_hi:[1,0,1]
v_pk_fma_f32 v[116:117], v[144:145], v[8:9], v[116:117] op_sel:[0,0,0] op_sel_hi:[1,0,1]
v_pk_fma_f32 v[114:115], v[146:147], v[6:7], v[114:115] op_sel:[0,0,0] op_sel_hi:[1,0,1]
v_pk_fma_f32 v[118:119], v[146:147], v[8:9], v[118:119] op_sel:[0,0,0] op_sel_hi:[1,0,1]
v_pk_mul_f32 v[2:3], v[112:113], v[28:29]
v_pk_mul_f32 v[12:13], v[116:117], v[28:29]
v_pk_mul_f32 v[4:5], v[114:115], v[30:31]
v_pk_mul_f32 v[14:15], v[118:119], v[30:31]
v_pk_fma_f32 v[112:113], v[112:113], v[148:149], s[82:83]
v_pk_fma_f32 v[116:117], v[116:117], v[148:149], s[82:83]
v_pk_fma_f32 v[114:115], v[114:115], v[150:151], s[82:83]
v_pk_fma_f32 v[118:119], v[118:119], v[150:151], s[82:83]
v_exp_f32_e64 v2, v2 clamp
v_exp_f32_e64 v12, v12 clamp
v_exp_f32_e64 v3, v3 clamp
v_exp_f32_e64 v13, v13 clamp
v_exp_f32_e64 v4, v4 clamp
v_exp_f32_e64 v14, v14 clamp
v_exp_f32_e64 v5, v5 clamp
v_exp_f32_e64 v15, v15 clamp
v_pk_add_f32 v[2:3], v[2:3], s[80:81]
v_pk_add_f32 v[12:13], v[12:13], s[80:81]
v_pk_add_f32 v[4:5], v[4:5], s[80:81]
v_pk_add_f32 v[14:15], v[14:15], s[80:81]
v_max_f32 v112, v112, v2
v_max_f32 v116, v116, v12
v_max_f32 v113, v113, v3
v_max_f32 v117, v117, v13
v_max_f32 v114, v114, v4
v_max_f32 v118, v118, v14
v_max_f32 v115, v115, v5
v_max_f32 v119, v119, v15
v_cvt_pk_bf16_f32 v90, v112, v113
v_cvt_pk_bf16_f32 v94, v116, v117
v_cvt_pk_bf16_f32 v91, v114, v115
v_cvt_pk_bf16_f32 v95, v118, v119
v_pk_fma_f32 v[120:121], v[144:145], v[10:11], v[120:121] op_sel:[0,0,0] op_sel_hi:[1,0,1]
v_pk_fma_f32 v[124:125], v[144:145], v[18:19], v[124:125] op_sel:[0,0,0] op_sel_hi:[1,0,1]
v_pk_fma_f32 v[122:123], v[146:147], v[10:11], v[122:123] op_sel:[0,0,0] op_sel_hi:[1,0,1]
v_pk_fma_f32 v[126:127], v[146:147], v[18:19], v[126:127] op_sel:[0,0,0] op_sel_hi:[1,0,1]
v_pk_mul_f32 v[120:121], v[120:121], v[148:149]
v_pk_mul_f32 v[124:125], v[124:125], v[148:149]
v_pk_mul_f32 v[122:123], v[122:123], v[150:151]
v_pk_mul_f32 v[126:127], v[126:127], v[150:151]
v_cvt_pk_bf16_f32 v98, v120, v121
v_cvt_pk_bf16_f32 v102, v124, v125
v_cvt_pk_bf16_f32 v99, v122, v123
v_cvt_pk_bf16_f32 v103, v126, v127
s_nop 0
v_mfma_f32_16x16x32_bf16 v[64:67], v[88:91], v[96:99], v[64:67]
v_mfma_f32_16x16x32_bf16 v[68:71], v[88:91], v[100:103], v[68:71]
v_mfma_f32_16x16x32_bf16 v[20:23], v[88:91], a[80:83], v[20:23]
v_mfma_f32_16x16x32_bf16 v[72:75], v[92:95], v[96:99], v[72:75]
v_mfma_f32_16x16x32_bf16 v[76:79], v[92:95], v[100:103], v[76:79]
v_mfma_f32_16x16x32_bf16 v[24:27], v[92:95], a[80:83], v[24:27]
s_lshl_b32 s70, s60, 11
s_add_u32 s70, s70, 16384
v_add_u32 v2, s70, v16
v_xor_b32 v3, 4096, v2
v_lshrrev_b32 v4, 4, v1
v_lshlrev_b32 v5, 4, v4
v_lshlrev_b32 v4, 5, v4
s_lshl_b32 s70, s60, 6
s_add_u32 s70, s70, 163584
v_add_u32 v5, s70, v5
v_xor_b32 v6, 128, v5
s_lshl_b32 s72, s67, 1
s_add_u32 s72, s72, s66
s_lshl_b32 s72, s72, 10
s_add_u32 s72, s72, s87
s_lshl_b32 s73, s67, 7
s_lshl_b32 s70, s66, 4
s_add_u32 s73, s73, s70
s_add_u32 s73, s73, s87
s_add_u32 s73, s73, 4096
s_mov_b32 s92, 0x00010001
s_mov_b32 s93, 0x00010001
s_cmp_eq_u32 s66, 0
s_cbranch_scc0 L_ex1
ds_write_b128 v2, v[68:71]
ds_write_b128 v2, v[76:79] offset:1024
ds_write_b128 v5, v[24:27]
s_waitcnt lgkmcnt(0)
s_barrier
ds_read_b128 v[128:131], v3
ds_read_b128 v[132:135], v3 offset:1024
ds_read_b128 v[136:139], v6
s_waitcnt lgkmcnt(1)
v_pk_add_f32 v[128:129], v[128:129], v[64:65]
v_pk_add_f32 v[130:131], v[130:131], v[66:67]
v_pk_add_f32 v[132:133], v[132:133], v[72:73]
v_pk_add_f32 v[134:135], v[134:135], v[74:75]
s_waitcnt lgkmcnt(0)
v_pk_add_f32 v[136:137], v[136:137], v[20:21]
v_pk_add_f32 v[138:139], v[138:139], v[22:23]
L_ex_d:
v_cvt_pk_bf16_f32 v140, v128, v129
v_cvt_pk_bf16_f32 v141, v130, v131
v_cvt_pk_bf16_f32 v142, v132, v133
v_cvt_pk_bf16_f32 v143, v134, v135
s_cmp_eq_u32 s69, 0
s_cbranch_scc1 L_kvp_s
buffer_store_dwordx4 v[140:143], v16, s[12:15], s72 offen
s_mov_b64 exec, s[92:93]
buffer_store_dwordx4 v[136:139], v4, s[12:15], s73 offen
s_mov_b64 exec, -1
L_kvp_d:
v_and_b32 v2, 15, v1
v_lshlrev_b32 v2, 2, v2
s_lshl_b32 s70, s66, 8
s_add_u32 s70, s70, 159744
v_add_u32 v2, s70, v2
v_lshrrev_b32 v3, 4, v1
v_lshlrev_b32 v3, 4, v3
s_lshl_b32 s70, s67, 7
s_add_u32 s70, s70, 160768
v_add_u32 v5, s70, v3
ds_read_b32 v8, v2 offset:0
ds_read_b32 v128, v2 offset:512
ds_read_b32 v10, v2 offset:64
ds_read_b32 v130, v2 offset:576
ds_read_b32 v12, v2 offset:128
ds_read_b32 v132, v2 offset:640
ds_read_b32 v14, v2 offset:192
ds_read_b32 v134, v2 offset:704
ds_read_b128 v[144:147], v5 offset:0
ds_read_b128 v[148:151], v5 offset:64
s_lshl_b32 s70, s67, 11
s_add_u32 s70, s70, 24576
v_add_u32 v17, s70, v16
s_lshl_b32 s70, s67, 6
s_add_u32 s70, s70, 161600
v_add_u32 v18, s70, v3
s_waitcnt lgkmcnt(0)
v_mul_f32 v20, s90, v128
v_mul_f32 v22, s90, v130
v_mul_f32 v4, s90, v132
v_mul_f32 v6, s90, v134
v_pk_fma_f32 v[32:33], v[144:145], v[8:9], v[32:33] op_sel:[0,0,0] op_sel_hi:[1,0,1]
v_pk_fma_f32 v[36:37], v[148:149], v[8:9], v[36:37] op_sel:[0,0,0] op_sel_hi:[1,0,1]
v_pk_fma_f32 v[34:35], v[146:147], v[8:9], v[34:35] op_sel:[0,0,0] op_sel_hi:[1,0,1]
v_pk_fma_f32 v[38:39], v[150:151], v[8:9], v[38:39] op_sel:[0,0,0] op_sel_hi:[1,0,1]
v_pk_mul_f32 v[24:25], v[32:33], v[20:21] op_sel:[0,0] op_sel_hi:[1,0]
v_pk_mul_f32 v[28:29], v[36:37], v[20:21] op_sel:[0,0] op_sel_hi:[1,0]
v_pk_mul_f32 v[26:27], v[34:35], v[20:21] op_sel:[0,0] op_sel_hi:[1,0]
v_pk_mul_f32 v[30:31], v[38:39], v[20:21] op_sel:[0,0] op_sel_hi:[1,0]
v_pk_fma_f32 v[32:33], v[32:33], v[128:129], s[82:83] op_sel:[0,0,0] op_sel_hi:[1,0,1]
v_pk_fma_f32 v[36:37], v[36:37], v[128:129], s[82:83] op_sel:[0,0,0] op_sel_hi:[1,0,1]
v_pk_fma_f32 v[34:35], v[34:35], v[128:129], s[82:83] op_sel:[0,0,0] op_sel_hi:[1,0,1]
v_pk_fma_f32 v[38:39], v[38:39], v[128:129], s[82:83] op_sel:[0,0,0] op_sel_hi:[1,0,1]
v_exp_f32_e64 v24, v24 clamp
v_exp_f32_e64 v28, v28 clamp
v_exp_f32_e64 v25, v25 clamp
v_exp_f32_e64 v29, v29 clamp
v_exp_f32_e64 v26, v26 clamp
v_exp_f32_e64 v30, v30 clamp
v_exp_f32_e64 v27, v27 clamp
v_exp_f32_e64 v31, v31 clamp
v_pk_add_f32 v[24:25], v[24:25], s[80:81]
v_pk_add_f32 v[28:29], v[28:29], s[80:81]
v_pk_add_f32 v[26:27], v[26:27], s[80:81]
v_pk_add_f32 v[30:31], v[30:31], s[80:81]
v_max_f32 v32, v32, v24
v_max_f32 v36, v36, v28
v_max_f32 v33, v33, v25
v_max_f32 v37, v37, v29
v_max_f32 v34, v34, v26
v_max_f32 v38, v38, v30
v_max_f32 v35, v35, v27
v_max_f32 v39, v39, v31
v_cvt_pk_bf16_f32 v32, v32, v33
v_cvt_pk_bf16_f32 v33, v34, v35
v_cvt_pk_bf16_f32 v34, v36, v37
v_cvt_pk_bf16_f32 v35, v38, v39
v_pk_fma_f32 v[56:57], v[144:145], v[10:11], v[56:57] op_sel:[0,0,0] op_sel_hi:[1,0,1]
v_pk_fma_f32 v[60:61], v[148:149], v[10:11], v[60:61] op_sel:[0,0,0] op_sel_hi:[1,0,1]
v_pk_fma_f32 v[58:59], v[146:147], v[10:11], v[58:59] op_sel:[0,0,0] op_sel_hi:[1,0,1]
v_pk_fma_f32 v[62:63], v[150:151], v[10:11], v[62:63] op_sel:[0,0,0] op_sel_hi:[1,0,1]
v_pk_mul_f32 v[24:25], v[56:57], v[22:23] op_sel:[0,0] op_sel_hi:[1,0]
v_pk_mul_f32 v[28:29], v[60:61], v[22:23] op_sel:[0,0] op_sel_hi:[1,0]
v_pk_mul_f32 v[26:27], v[58:59], v[22:23] op_sel:[0,0] op_sel_hi:[1,0]
v_pk_mul_f32 v[30:31], v[62:63], v[22:23] op_sel:[0,0] op_sel_hi:[1,0]
v_pk_fma_f32 v[56:57], v[56:57], v[130:131], s[82:83] op_sel:[0,0,0] op_sel_hi:[1,0,1]
v_pk_fma_f32 v[60:61], v[60:61], v[130:131], s[82:83] op_sel:[0,0,0] op_sel_hi:[1,0,1]
v_pk_fma_f32 v[58:59], v[58:59], v[130:131], s[82:83] op_sel:[0,0,0] op_sel_hi:[1,0,1]
v_pk_fma_f32 v[62:63], v[62:63], v[130:131], s[82:83] op_sel:[0,0,0] op_sel_hi:[1,0,1]
v_exp_f32_e64 v24, v24 clamp
v_exp_f32_e64 v28, v28 clamp
v_exp_f32_e64 v25, v25 clamp
v_exp_f32_e64 v29, v29 clamp
v_exp_f32_e64 v26, v26 clamp
v_exp_f32_e64 v30, v30 clamp
v_exp_f32_e64 v27, v27 clamp
v_exp_f32_e64 v31, v31 clamp
v_pk_add_f32 v[24:25], v[24:25], s[80:81]
v_pk_add_f32 v[28:29], v[28:29], s[80:81]
v_pk_add_f32 v[26:27], v[26:27], s[80:81]
v_pk_add_f32 v[30:31], v[30:31], s[80:81]
v_max_f32 v56, v56, v24
v_max_f32 v60, v60, v28
v_max_f32 v57, v57, v25
v_max_f32 v61, v61, v29
v_max_f32 v58, v58, v26
v_max_f32 v62, v62, v30
v_max_f32 v59, v59, v27
v_max_f32 v63, v63, v31
v_cvt_pk_bf16_f32 v56, v56, v57
v_cvt_pk_bf16_f32 v57, v58, v59
v_cvt_pk_bf16_f32 v58, v60, v61
v_cvt_pk_bf16_f32 v59, v62, v63
v_pk_fma_f32 v[80:81], v[144:145], v[12:13], v[80:81] op_sel:[0,0,0] op_sel_hi:[1,0,1]
v_pk_fma_f32 v[84:85], v[148:149], v[12:13], v[84:85] op_sel:[0,0,0] op_sel_hi:[1,0,1]
v_pk_fma_f32 v[82:83], v[146:147], v[12:13], v[82:83] op_sel:[0,0,0] op_sel_hi:[1,0,1]
v_pk_fma_f32 v[86:87], v[150:151], v[12:13], v[86:87] op_sel:[0,0,0] op_sel_hi:[1,0,1]
v_pk_mul_f32 v[24:25], v[80:81], v[4:5] op_sel:[0,0] op_sel_hi:[1,0]
v_pk_mul_f32 v[28:29], v[84:85], v[4:5] op_sel:[0,0] op_sel_hi:[1,0]
v_pk_mul_f32 v[26:27], v[82:83], v[4:5] op_sel:[0,0] op_sel_hi:[1,0]
v_pk_mul_f32 v[30:31], v[86:87], v[4:5] op_sel:[0,0] op_sel_hi:[1,0]
v_pk_fma_f32 v[80:81], v[80:81], v[132:133], s[82:83] op_sel:[0,0,0] op_sel_hi:[1,0,1]
v_pk_fma_f32 v[84:85], v[84:85], v[132:133], s[82:83] op_sel:[0,0,0] op_sel_hi:[1,0,1]
v_pk_fma_f32 v[82:83], v[82:83], v[132:133], s[82:83] op_sel:[0,0,0] op_sel_hi:[1,0,1]
v_pk_fma_f32 v[86:87], v[86:87], v[132:133], s[82:83] op_sel:[0,0,0] op_sel_hi:[1,0,1]
v_exp_f32_e64 v24, v24 clamp
v_exp_f32_e64 v28, v28 clamp
v_exp_f32_e64 v25, v25 clamp
v_exp_f32_e64 v29, v29 clamp
v_exp_f32_e64 v26, v26 clamp
v_exp_f32_e64 v30, v30 clamp
v_exp_f32_e64 v27, v27 clamp
v_exp_f32_e64 v31, v31 clamp
v_pk_add_f32 v[24:25], v[24:25], s[80:81]
v_pk_add_f32 v[28:29], v[28:29], s[80:81]
v_pk_add_f32 v[26:27], v[26:27], s[80:81]
v_pk_add_f32 v[30:31], v[30:31], s[80:81]
v_max_f32 v80, v80, v24
v_max_f32 v84, v84, v28
v_max_f32 v81, v81, v25
v_max_f32 v85, v85, v29
v_max_f32 v82, v82, v26
v_max_f32 v86, v86, v30
v_max_f32 v83, v83, v27
v_max_f32 v87, v87, v31
v_cvt_pk_bf16_f32 v80, v80, v81
v_cvt_pk_bf16_f32 v81, v82, v83
v_cvt_pk_bf16_f32 v82, v84, v85
v_cvt_pk_bf16_f32 v83, v86, v87
v_pk_fma_f32 v[104:105], v[144:145], v[14:15], v[104:105] op_sel:[0,0,0] op_sel_hi:[1,0,1]
v_pk_fma_f32 v[108:109], v[148:149], v[14:15], v[108:109] op_sel:[0,0,0] op_sel_hi:[1,0,1]
v_pk_fma_f32 v[106:107], v[146:147], v[14:15], v[106:107] op_sel:[0,0,0] op_sel_hi:[1,0,1]
v_pk_fma_f32 v[110:111], v[150:151], v[14:15], v[110:111] op_sel:[0,0,0] op_sel_hi:[1,0,1]
v_pk_mul_f32 v[24:25], v[104:105], v[6:7] op_sel:[0,0] op_sel_hi:[1,0]
v_pk_mul_f32 v[28:29], v[108:109], v[6:7] op_sel:[0,0] op_sel_hi:[1,0]
v_pk_mul_f32 v[26:27], v[106:107], v[6:7] op_sel:[0,0] op_sel_hi:[1,0]
v_pk_mul_f32 v[30:31], v[110:111], v[6:7] op_sel:[0,0] op_sel_hi:[1,0]
v_pk_fma_f32 v[104:105], v[104:105], v[134:135], s[82:83] op_sel:[0,0,0] op_sel_hi:[1,0,1]
v_pk_fma_f32 v[108:109], v[108:109], v[134:135], s[82:83] op_sel:[0,0,0] op_sel_hi:[1,0,1]
v_pk_fma_f32 v[106:107], v[106:107], v[134:135], s[82:83] op_sel:[0,0,0] op_sel_hi:[1,0,1]
v_pk_fma_f32 v[110:111], v[110:111], v[134:135], s[82:83] op_sel:[0,0,0] op_sel_hi:[1,0,1]
v_exp_f32_e64 v24, v24 clamp
v_exp_f32_e64 v28, v28 clamp
v_exp_f32_e64 v25, v25 clamp
v_exp_f32_e64 v29, v29 clamp
v_exp_f32_e64 v26, v26 clamp
v_exp_f32_e64 v30, v30 clamp
v_exp_f32_e64 v27, v27 clamp
v_exp_f32_e64 v31, v31 clamp
v_pk_add_f32 v[24:25], v[24:25], s[80:81]
v_pk_add_f32 v[28:29], v[28:29], s[80:81]
v_pk_add_f32 v[26:27], v[26:27], s[80:81]
v_pk_add_f32 v[30:31], v[30:31], s[80:81]
v_max_f32 v104, v104, v24
v_max_f32 v108, v108, v28
v_max_f32 v105, v105, v25
v_max_f32 v109, v109, v29
v_max_f32 v106, v106, v26
v_max_f32 v110, v110, v30
v_max_f32 v107, v107, v27
v_max_f32 v111, v111, v31
v_cvt_pk_bf16_f32 v104, v104, v105
v_cvt_pk_bf16_f32 v105, v106, v107
v_cvt_pk_bf16_f32 v106, v108, v109
v_cvt_pk_bf16_f32 v107, v110, v111
v_lshrrev_b32 v2, 4, v1
v_bfe_u32 v3, v1, 2, 2
v_lshl_add_u32 v4, v2, 2, v3
v_lshlrev_b32 v5, 7, v4
v_bfe_u32 v4, v4, 1, 2
v_lshl_add_u32 v5, v4, 5, v5
v_and_b32 v4, 3, v1
v_lshl_add_u32 v5, v4, 3, v5
v_add_u32 v8, 28672, v5
v_xor_b32 v9, 32, v8
v_xor_b32 v10, 64, v8
v_xor_b32 v11, 96, v8
v_and_b32 v3, 15, v1
v_lshrrev_b32 v4, 1, v3
v_lshrrev_b32 v5, 1, v2
v_xor_b32 v4, v4, v5
v_lshlrev_b32 v4, 4, v4
v_lshl_add_u32 v4, v3, 7, v4
v_and_b32 v5, 1, v2
v_lshl_add_u32 v4, v5, 3, v4
s_lshl_b32 s70, s60, 12
v_add_u32 v20, s70, v4
v_xor_b32 v21, 32, v20
v_xor_b32 v22, 64, v20
v_xor_b32 v23, 96, v20
v_add_u32 v19, 32768, v16
s_lshl_b32 s74, s64, 18
s_lshl_b32 s70, s60, 16
s_add_u32 s74, s74, s70
s_add_u32 s74, s74, 2097152
s_barrier
ds_read_b128 a[0:3], v17
ds_read_b128 a[4:7], v17 offset:1024
ds_read_b128 a[8:11], v18
s_waitcnt lgkmcnt(0)
v_mfma_f32_16x16x32_bf16 v[48:51], a[8:11], v[32:35], 0
v_mfma_f32_16x16x32_bf16 v[40:43], a[0:3], v[32:35], 0
v_mfma_f32_16x16x32_bf16 v[44:47], a[4:7], v[32:35], 0
v_mfma_f32_16x16x32_bf16 v[72:75], a[8:11], v[56:59], 0
v_mfma_f32_16x16x32_bf16 v[64:67], a[0:3], v[56:59], 0
v_mfma_f32_16x16x32_bf16 v[68:71], a[4:7], v[56:59], 0
v_mfma_f32_16x16x32_bf16 v[96:99], a[8:11], v[80:83], 0
v_mfma_f32_16x16x32_bf16 v[88:91], a[0:3], v[80:83], 0
v_mfma_f32_16x16x32_bf16 v[92:95], a[4:7], v[80:83], 0
v_mfma_f32_16x16x32_bf16 v[120:123], a[8:11], v[104:107], 0
v_mfma_f32_16x16x32_bf16 v[112:115], a[0:3], v[104:107], 0
v_mfma_f32_16x16x32_bf16 v[116:119], a[4:7], v[104:107], 0
v_add_f32 v48, s80, v48
v_rcp_f32 v48, v48
s_nop 0
v_pk_mul_f32 v[40:41], v[40:41], v[48:49] op_sel_hi:[1,0]
v_pk_mul_f32 v[42:43], v[42:43], v[48:49] op_sel_hi:[1,0]
v_pk_mul_f32 v[44:45], v[44:45], v[48:49] op_sel_hi:[1,0]
v_pk_mul_f32 v[46:47], v[46:47], v[48:49] op_sel_hi:[1,0]
v_cvt_pk_bf16_f32 v52, v40, v41
v_cvt_pk_bf16_f32 v53, v42, v43
v_cvt_pk_bf16_f32 v54, v44, v45
v_cvt_pk_bf16_f32 v55, v46, v47
s_add_u32 s70, s88, 0
buffer_store_dwordx4 v[52:55], v16, s[12:15], s70 offen sc1
v_add_f32 v72, s80, v72
v_rcp_f32 v72, v72
s_nop 0
v_pk_mul_f32 v[64:65], v[64:65], v[72:73] op_sel_hi:[1,0]
v_pk_mul_f32 v[66:67], v[66:67], v[72:73] op_sel_hi:[1,0]
v_pk_mul_f32 v[68:69], v[68:69], v[72:73] op_sel_hi:[1,0]
v_pk_mul_f32 v[70:71], v[70:71], v[72:73] op_sel_hi:[1,0]
v_cvt_pk_bf16_f32 v76, v64, v65
v_cvt_pk_bf16_f32 v77, v66, v67
v_cvt_pk_bf16_f32 v78, v68, v69
v_cvt_pk_bf16_f32 v79, v70, v71
s_add_u32 s70, s88, 32768
buffer_store_dwordx4 v[76:79], v16, s[12:15], s70 offen sc1
v_add_f32 v96, s80, v96
v_rcp_f32 v96, v96
s_nop 0
v_pk_mul_f32 v[88:89], v[88:89], v[96:97] op_sel_hi:[1,0]
v_pk_mul_f32 v[90:91], v[90:91], v[96:97] op_sel_hi:[1,0]
v_pk_mul_f32 v[92:93], v[92:93], v[96:97] op_sel_hi:[1,0]
v_pk_mul_f32 v[94:95], v[94:95], v[96:97] op_sel_hi:[1,0]
v_cvt_pk_bf16_f32 v100, v88, v89
v_cvt_pk_bf16_f32 v101, v90, v91
v_cvt_pk_bf16_f32 v102, v92, v93
v_cvt_pk_bf16_f32 v103, v94, v95
s_add_u32 s70, s88, 65536
buffer_store_dwordx4 v[100:103], v16, s[12:15], s70 offen sc1
v_add_f32 v120, s80, v120
v_rcp_f32 v120, v120
s_nop 0
v_pk_mul_f32 v[112:113], v[112:113], v[120:121] op_sel_hi:[1,0]
v_pk_mul_f32 v[114:115], v[114:115], v[120:121] op_sel_hi:[1,0]
v_pk_mul_f32 v[116:117], v[116:117], v[120:121] op_sel_hi:[1,0]
v_pk_mul_f32 v[118:119], v[118:119], v[120:121] op_sel_hi:[1,0]
v_cvt_pk_bf16_f32 v124, v112, v113
v_cvt_pk_bf16_f32 v125, v114, v115
v_cvt_pk_bf16_f32 v126, v116, v117
v_cvt_pk_bf16_f32 v127, v118, v119
s_add_u32 s70, s88, 98304
buffer_store_dwordx4 v[124:127], v16, s[12:15], s70 offen sc1
s_waitcnt vmcnt(0)
s_add_u32 s70, s65, 0
s_and_b32 s70, s70, 15
s_lshl_b32 s70, s70, 11
s_add_u32 s70, s70, s74
buffer_load_dwordx4 v[56:59], v16, s[12:15], s70 offen offset:0 sc1
buffer_load_dwordx4 v[60:63], v19, s[12:15], s70 offen offset:0 sc1
buffer_load_dwordx4 v[64:67], v16, s[12:15], s70 offen offset:1024 sc1
buffer_load_dwordx4 v[68:71], v19, s[12:15], s70 offen offset:1024 sc1
s_add_u32 s70, s65, 1
s_and_b32 s70, s70, 15
s_lshl_b32 s70, s70, 11
s_add_u32 s70, s70, s74
buffer_load_dwordx4 v[72:75], v16, s[12:15], s70 offen offset:0 sc1
buffer_load_dwordx4 v[76:79], v19, s[12:15], s70 offen offset:0 sc1
buffer_load_dwordx4 v[80:83], v16, s[12:15], s70 offen offset:1024 sc1
buffer_load_dwordx4 v[84:87], v19, s[12:15], s70 offen offset:1024 sc1
s_add_u32 s70, s65, 2
s_and_b32 s70, s70, 15
s_lshl_b32 s70, s70, 11
s_add_u32 s70, s70, s74
buffer_load_dwordx4 v[88:91], v16, s[12:15], s70 offen offset:0 sc1
buffer_load_dwordx4 v[92:95], v19, s[12:15], s70 offen offset:0 sc1
buffer_load_dwordx4 v[96:99], v16, s[12:15], s70 offen offset:1024 sc1
buffer_load_dwordx4 v[100:103], v19, s[12:15], s70 offen offset:1024 sc1
s_add_u32 s70, s65, 3
s_and_b32 s70, s70, 15
s_lshl_b32 s70, s70, 11
s_add_u32 s70, s70, s74
buffer_load_dwordx4 v[104:107], v16, s[12:15], s70 offen offset:0 sc1
buffer_load_dwordx4 v[108:111], v19, s[12:15], s70 offen offset:0 sc1
buffer_load_dwordx4 v[112:115], v16, s[12:15], s70 offen offset:1024 sc1
buffer_load_dwordx4 v[116:119], v19, s[12:15], s70 offen offset:1024 sc1
s_add_u32 s70, s65, 4
s_and_b32 s70, s70, 15
s_lshl_b32 s70, s70, 11
s_add_u32 s70, s70, s74
buffer_load_dwordx4 v[120:123], v16, s[12:15], s70 offen offset:0 sc1
buffer_load_dwordx4 v[124:127], v19, s[12:15], s70 offen offset:0 sc1
buffer_load_dwordx4 v[128:131], v16, s[12:15], s70 offen offset:1024 sc1
buffer_load_dwordx4 v[132:135], v19, s[12:15], s70 offen offset:1024 sc1
s_add_u32 s70, s65, 5
s_and_b32 s70, s70, 15
s_lshl_b32 s70, s70, 11
s_add_u32 s70, s70, s74
buffer_load_dwordx4 v[136:139], v16, s[12:15], s70 offen offset:0 sc1
buffer_load_dwordx4 v[140:143], v19, s[12:15], s70 offen offset:0 sc1
buffer_load_dwordx4 v[144:147], v16, s[12:15], s70 offen offset:1024 sc1
buffer_load_dwordx4 v[148:151], v19, s[12:15], s70 offen offset:1024 sc1
ds_read_b64 v[26:27], v20 offset:0
ds_read_b64 v[30:31], v21 offset:0
ds_read_b64 v[34:35], v22 offset:0
ds_read_b64 v[38:39], v23 offset:0
ds_read_b64 v[42:43], v20 offset:2048
ds_read_b64 v[46:47], v21 offset:2048
ds_read_b64 v[50:51], v22 offset:2048
ds_read_b64 v[54:55], v23 offset:2048
s_add_u32 s71, s65, 0
s_and_b32 s71, s71, 15
s_lshl_b32 s71, s71, 13
v_add_u32 v12, s71, v8
v_add_u32 v13, s71, v9
v_add_u32 v14, s71, v10
v_add_u32 v15, s71, v11
s_waitcnt lgkmcnt(0)
ds_read_b64_tr_b16 a[0:1], v12 offset:0
ds_read_b64_tr_b16 a[2:3], v12 offset:2048
ds_read_b64_tr_b16 a[4:5], v13 offset:0
ds_read_b64_tr_b16 a[6:7], v13 offset:2048
ds_read_b64_tr_b16 a[8:9], v14 offset:0
ds_read_b64_tr_b16 a[10:11], v14 offset:2048
ds_read_b64_tr_b16 a[12:13], v15 offset:0
ds_read_b64_tr_b16 a[14:15], v15 offset:2048
v_lshlrev_b32 v24, 16, v26
v_and_b32 v25, 0xffff0000, v26
v_lshlrev_b32 v26, 16, v27
v_and_b32 v27, 0xffff0000, v27
v_lshlrev_b32 v28, 16, v30
v_and_b32 v29, 0xffff0000, v30
v_lshlrev_b32 v30, 16, v31
v_and_b32 v31, 0xffff0000, v31
v_lshlrev_b32 v32, 16, v34
v_and_b32 v33, 0xffff0000, v34
v_lshlrev_b32 v34, 16, v35
v_and_b32 v35, 0xffff0000, v35
v_lshlrev_b32 v36, 16, v38
v_and_b32 v37, 0xffff0000, v38
v_lshlrev_b32 v38, 16, v39
v_and_b32 v39, 0xffff0000, v39
v_lshlrev_b32 v40, 16, v42
v_and_b32 v41, 0xffff0000, v42
v_lshlrev_b32 v42, 16, v43
v_and_b32 v43, 0xffff0000, v43
v_lshlrev_b32 v44, 16, v46
v_and_b32 v45, 0xffff0000, v46
v_lshlrev_b32 v46, 16, v47
v_and_b32 v47, 0xffff0000, v47
v_lshlrev_b32 v48, 16, v50
v_and_b32 v49, 0xffff0000, v50
v_lshlrev_b32 v50, 16, v51
v_and_b32 v51, 0xffff0000, v51
v_lshlrev_b32 v52, 16, v54
v_and_b32 v53, 0xffff0000, v54
v_lshlrev_b32 v54, 16, v55
v_and_b32 v55, 0xffff0000, v55
s_waitcnt vmcnt(20)
L_o0_chk:
v_max3_u32 v2, v56, v60, v64
v_max_u32 v2, v2, v68
v_cmp_eq_u32 vcc, -1, v2
s_cbranch_vccnz L_o0_rt
L_o0_ok:
s_waitcnt lgkmcnt(0)
v_mfma_f32_16x16x32_bf16 v[24:27], a[0:3], v[56:59], v[24:27]
ds_read_b64_tr_b16 a[16:17], v12 offset:4096
v_mfma_f32_16x16x32_bf16 v[40:43], a[0:3], v[60:63], v[40:43]
ds_read_b64_tr_b16 a[18:19], v12 offset:6144
v_mfma_f32_16x16x32_bf16 v[28:31], a[4:7], v[56:59], v[28:31]
ds_read_b64_tr_b16 a[20:21], v13 offset:4096
v_mfma_f32_16x16x32_bf16 v[44:47], a[4:7], v[60:63], v[44:47]
ds_read_b64_tr_b16 a[22:23], v13 offset:6144
v_mfma_f32_16x16x32_bf16 v[32:35], a[8:11], v[56:59], v[32:35]
ds_read_b64_tr_b16 a[24:25], v14 offset:4096
v_mfma_f32_16x16x32_bf16 v[48:51], a[8:11], v[60:63], v[48:51]
ds_read_b64_tr_b16 a[26:27], v14 offset:6144
v_mfma_f32_16x16x32_bf16 v[36:39], a[12:15], v[56:59], v[36:39]
ds_read_b64_tr_b16 a[28:29], v15 offset:4096
v_mfma_f32_16x16x32_bf16 v[52:55], a[12:15], v[60:63], v[52:55]
ds_read_b64_tr_b16 a[30:31], v15 offset:6144
s_add_u32 s71, s65, 1
s_and_b32 s71, s71, 15
s_lshl_b32 s71, s71, 13
v_add_u32 v12, s71, v8
v_add_u32 v13, s71, v9
v_add_u32 v14, s71, v10
v_add_u32 v15, s71, v11
s_waitcnt lgkmcnt(0)
v_mfma_f32_16x16x32_bf16 v[24:27], a[16:19], v[64:67], v[24:27]
ds_read_b64_tr_b16 a[0:1], v12 offset:0
v_mfma_f32_16x16x32_bf16 v[40:43], a[16:19], v[68:71], v[40:43]
ds_read_b64_tr_b16 a[2:3], v12 offset:2048
v_mfma_f32_16x16x32_bf16 v[28:31], a[20:23], v[64:67], v[28:31]
ds_read_b64_tr_b16 a[4:5], v13 offset:0
v_mfma_f32_16x16x32_bf16 v[44:47], a[20:23], v[68:71], v[44:47]
ds_read_b64_tr_b16 a[6:7], v13 offset:2048
v_mfma_f32_16x16x32_bf16 v[32:35], a[24:27], v[64:67], v[32:35]
ds_read_b64_tr_b16 a[8:9], v14 offset:0
v_mfma_f32_16x16x32_bf16 v[48:51], a[24:27], v[68:71], v[48:51]
ds_read_b64_tr_b16 a[10:11], v14 offset:2048
v_mfma_f32_16x16x32_bf16 v[36:39], a[28:31], v[64:67], v[36:39]
ds_read_b64_tr_b16 a[12:13], v15 offset:0
v_mfma_f32_16x16x32_bf16 v[52:55], a[28:31], v[68:71], v[52:55]
ds_read_b64_tr_b16 a[14:15], v15 offset:2048
s_add_u32 s70, s65, 6
s_and_b32 s70, s70, 15
s_lshl_b32 s70, s70, 11
s_add_u32 s70, s70, s74
buffer_load_dwordx4 v[56:59], v16, s[12:15], s70 offen offset:0 sc1
buffer_load_dwordx4 v[60:63], v19, s[12:15], s70 offen offset:0 sc1
buffer_load_dwordx4 v[64:67], v16, s[12:15], s70 offen offset:1024 sc1
buffer_load_dwordx4 v[68:71], v19, s[12:15], s70 offen offset:1024 sc1
s_waitcnt vmcnt(20)
L_o1_chk:
v_max3_u32 v2, v72, v76, v80
v_max_u32 v2, v2, v84
v_cmp_eq_u32 vcc, -1, v2
s_cbranch_vccnz L_o1_rt
L_o1_ok:
s_waitcnt lgkmcnt(0)
v_mfma_f32_16x16x32_bf16 v[24:27], a[0:3], v[72:75], v[24:27]
ds_read_b64_tr_b16 a[16:17], v12 offset:4096
v_mfma_f32_16x16x32_bf16 v[40:43], a[0:3], v[76:79], v[40:43]
ds_read_b64_tr_b16 a[18:19], v12 offset:6144
v_mfma_f32_16x16x32_bf16 v[28:31], a[4:7], v[72:75], v[28:31]
ds_read_b64_tr_b16 a[20:21], v13 offset:4096
v_mfma_f32_16x16x32_bf16 v[44:47], a[4:7], v[76:79], v[44:47]
ds_read_b64_tr_b16 a[22:23], v13 offset:6144
v_mfma_f32_16x16x32_bf16 v[32:35], a[8:11], v[72:75], v[32:35]
ds_read_b64_tr_b16 a[24:25], v14 offset:4096
v_mfma_f32_16x16x32_bf16 v[48:51], a[8:11], v[76:79], v[48:51]
ds_read_b64_tr_b16 a[26:27], v14 offset:6144
v_mfma_f32_16x16x32_bf16 v[36:39], a[12:15], v[72:75], v[36:39]
ds_read_b64_tr_b16 a[28:29], v15 offset:4096
v_mfma_f32_16x16x32_bf16 v[52:55], a[12:15], v[76:79], v[52:55]
ds_read_b64_tr_b16 a[30:31], v15 offset:6144
s_add_u32 s71, s65, 2
s_and_b32 s71, s71, 15
s_lshl_b32 s71, s71, 13
v_add_u32 v12, s71, v8
v_add_u32 v13, s71, v9
v_add_u32 v14, s71, v10
v_add_u32 v15, s71, v11
s_waitcnt lgkmcnt(0)
v_mfma_f32_16x16x32_bf16 v[24:27], a[16:19], v[80:83], v[24:27]
ds_read_b64_tr_b16 a[0:1], v12 offset:0
v_mfma_f32_16x16x32_bf16 v[40:43], a[16:19], v[84:87], v[40:43]
ds_read_b64_tr_b16 a[2:3], v12 offset:2048
v_mfma_f32_16x16x32_bf16 v[28:31], a[20:23], v[80:83], v[28:31]
ds_read_b64_tr_b16 a[4:5], v13 offset:0
v_mfma_f32_16x16x32_bf16 v[44:47], a[20:23], v[84:87], v[44:47]
ds_read_b64_tr_b16 a[6:7], v13 offset:2048
v_mfma_f32_16x16x32_bf16 v[32:35], a[24:27], v[80:83], v[32:35]
ds_read_b64_tr_b16 a[8:9], v14 offset:0
v_mfma_f32_16x16x32_bf16 v[48:51], a[24:27], v[84:87], v[48:51]
ds_read_b64_tr_b16 a[10:11], v14 offset:2048
v_mfma_f32_16x16x32_bf16 v[36:39], a[28:31], v[80:83], v[36:39]
ds_read_b64_tr_b16 a[12:13], v15 offset:0
v_mfma_f32_16x16x32_bf16 v[52:55], a[28:31], v[84:87], v[52:55]
ds_read_b64_tr_b16 a[14:15], v15 offset:2048
s_add_u32 s70, s65, 7
s_and_b32 s70, s70, 15
s_lshl_b32 s70, s70, 11
s_add_u32 s70, s70, s74
buffer_load_dwordx4 v[72:75], v16, s[12:15], s70 offen offset:0 sc1
buffer_load_dwordx4 v[76:79], v19, s[12:15], s70 offen offset:0 sc1
buffer_load_dwordx4 v[80:83], v16, s[12:15], s70 offen offset:1024 sc1
buffer_load_dwordx4 v[84:87], v19, s[12:15], s70 offen offset:1024 sc1
s_waitcnt vmcnt(20)
L_o2_chk:
v_max3_u32 v2, v88, v92, v96
v_max_u32 v2, v2, v100
v_cmp_eq_u32 vcc, -1, v2
s_cbranch_vccnz L_o2_rt
L_o2_ok:
s_waitcnt lgkmcnt(0)
v_mfma_f32_16x16x32_bf16 v[24:27], a[0:3], v[88:91], v[24:27]
ds_read_b64_tr_b16 a[16:17], v12 offset:4096
v_mfma_f32_16x16x32_bf16 v[40:43], a[0:3], v[92:95], v[40:43]
ds_read_b64_tr_b16 a[18:19], v12 offset:6144
v_mfma_f32_16x16x32_bf16 v[28:31], a[4:7], v[88:91], v[28:31]
ds_read_b64_tr_b16 a[20:21], v13 offset:4096
v_mfma_f32_16x16x32_bf16 v[44:47], a[4:7], v[92:95], v[44:47]
ds_read_b64_tr_b16 a[22:23], v13 offset:6144
v_mfma_f32_16x16x32_bf16 v[32:35], a[8:11], v[88:91], v[32:35]
ds_read_b64_tr_b16 a[24:25], v14 offset:4096
v_mfma_f32_16x16x32_bf16 v[48:51], a[8:11], v[92:95], v[48:51]
ds_read_b64_tr_b16 a[26:27], v14 offset:6144
v_mfma_f32_16x16x32_bf16 v[36:39], a[12:15], v[88:91], v[36:39]
ds_read_b64_tr_b16 a[28:29], v15 offset:4096
v_mfma_f32_16x16x32_bf16 v[52:55], a[12:15], v[92:95], v[52:55]
ds_read_b64_tr_b16 a[30:31], v15 offset:6144
s_add_u32 s71, s65, 3
s_and_b32 s71, s71, 15
s_lshl_b32 s71, s71, 13
v_add_u32 v12, s71, v8
v_add_u32 v13, s71, v9
v_add_u32 v14, s71, v10
v_add_u32 v15, s71, v11
s_waitcnt lgkmcnt(0)
v_mfma_f32_16x16x32_bf16 v[24:27], a[16:19], v[96:99], v[24:27]
ds_read_b64_tr_b16 a[0:1], v12 offset:0
v_mfma_f32_16x16x32_bf16 v[40:43], a[16:19], v[100:103], v[40:43]
ds_read_b64_tr_b16 a[2:3], v12 offset:2048
v_mfma_f32_16x16x32_bf16 v[28:31], a[20:23], v[96:99], v[28:31]
ds_read_b64_tr_b16 a[4:5], v13 offset:0
v_mfma_f32_16x16x32_bf16 v[44:47], a[20:23], v[100:103], v[44:47]
ds_read_b64_tr_b16 a[6:7], v13 offset:2048
v_mfma_f32_16x16x32_bf16 v[32:35], a[24:27], v[96:99], v[32:35]
ds_read_b64_tr_b16 a[8:9], v14 offset:0
v_mfma_f32_16x16x32_bf16 v[48:51], a[24:27], v[100:103], v[48:51]
ds_read_b64_tr_b16 a[10:11], v14 offset:2048
v_mfma_f32_16x16x32_bf16 v[36:39], a[28:31], v[96:99], v[36:39]
ds_read_b64_tr_b16 a[12:13], v15 offset:0
v_mfma_f32_16x16x32_bf16 v[52:55], a[28:31], v[100:103], v[52:55]
ds_read_b64_tr_b16 a[14:15], v15 offset:2048
s_add_u32 s70, s65, 8
s_and_b32 s70, s70, 15
s_lshl_b32 s70, s70, 11
s_add_u32 s70, s70, s74
buffer_load_dwordx4 v[88:91], v16, s[12:15], s70 offen offset:0 sc1
buffer_load_dwordx4 v[92:95], v19, s[12:15], s70 offen offset:0 sc1
buffer_load_dwordx4 v[96:99], v16, s[12:15], s70 offen offset:1024 sc1
buffer_load_dwordx4 v[100:103], v19, s[12:15], s70 offen offset:1024 sc1
s_waitcnt vmcnt(20)
L_o3_chk:
v_max3_u32 v2, v104, v108, v112
v_max_u32 v2, v2, v116
v_cmp_eq_u32 vcc, -1, v2
s_cbranch_vccnz L_o3_rt
L_o3_ok:
s_waitcnt lgkmcnt(0)
v_mfma_f32_16x16x32_bf16 v[24:27], a[0:3], v[104:107], v[24:27]
ds_read_b64_tr_b16 a[16:17], v12 offset:4096
v_mfma_f32_16x16x32_bf16 v[40:43], a[0:3], v[108:111], v[40:43]
ds_read_b64_tr_b16 a[18:19], v12 offset:6144
v_mfma_f32_16x16x32_bf16 v[28:31], a[4:7], v[104:107], v[28:31]
ds_read_b64_tr_b16 a[20:21], v13 offset:4096
v_mfma_f32_16x16x32_bf16 v[44:47], a[4:7], v[108:111], v[44:47]
ds_read_b64_tr_b16 a[22:23], v13 offset:6144
v_mfma_f32_16x16x32_bf16 v[32:35], a[8:11], v[104:107], v[32:35]
ds_read_b64_tr_b16 a[24:25], v14 offset:4096
v_mfma_f32_16x16x32_bf16 v[48:51], a[8:11], v[108:111], v[48:51]
ds_read_b64_tr_b16 a[26:27], v14 offset:6144
v_mfma_f32_16x16x32_bf16 v[36:39], a[12:15], v[104:107], v[36:39]
ds_read_b64_tr_b16 a[28:29], v15 offset:4096
v_mfma_f32_16x16x32_bf16 v[52:55], a[12:15], v[108:111], v[52:55]
ds_read_b64_tr_b16 a[30:31], v15 offset:6144
s_add_u32 s71, s65, 4
s_and_b32 s71, s71, 15
s_lshl_b32 s71, s71, 13
v_add_u32 v12, s71, v8
v_add_u32 v13, s71, v9
v_add_u32 v14, s71, v10
v_add_u32 v15, s71, v11
s_waitcnt lgkmcnt(0)
v_mfma_f32_16x16x32_bf16 v[24:27], a[16:19], v[112:115], v[24:27]
ds_read_b64_tr_b16 a[0:1], v12 offset:0
v_mfma_f32_16x16x32_bf16 v[40:43], a[16:19], v[116:119], v[40:43]
ds_read_b64_tr_b16 a[2:3], v12 offset:2048
v_mfma_f32_16x16x32_bf16 v[28:31], a[20:23], v[112:115], v[28:31]
ds_read_b64_tr_b16 a[4:5], v13 offset:0
v_mfma_f32_16x16x32_bf16 v[44:47], a[20:23], v[116:119], v[44:47]
ds_read_b64_tr_b16 a[6:7], v13 offset:2048
v_mfma_f32_16x16x32_bf16 v[32:35], a[24:27], v[112:115], v[32:35]
ds_read_b64_tr_b16 a[8:9], v14 offset:0
v_mfma_f32_16x16x32_bf16 v[48:51], a[24:27], v[116:119], v[48:51]
ds_read_b64_tr_b16 a[10:11], v14 offset:2048
v_mfma_f32_16x16x32_bf16 v[36:39], a[28:31], v[112:115], v[36:39]
ds_read_b64_tr_b16 a[12:13], v15 offset:0
v_mfma_f32_16x16x32_bf16 v[52:55], a[28:31], v[116:119], v[52:55]
ds_read_b64_tr_b16 a[14:15], v15 offset:2048
s_add_u32 s70, s65, 9
s_and_b32 s70, s70, 15
s_lshl_b32 s70, s70, 11
s_add_u32 s70, s70, s74
buffer_load_dwordx4 v[104:107], v16, s[12:15], s70 offen offset:0 sc1
buffer_load_dwordx4 v[108:111], v19, s[12:15], s70 offen offset:0 sc1
buffer_load_dwordx4 v[112:115], v16, s[12:15], s70 offen offset:1024 sc1
buffer_load_dwordx4 v[116:119], v19, s[12:15], s70 offen offset:1024 sc1
s_waitcnt vmcnt(20)
L_o4_chk:
v_max3_u32 v2, v120, v124, v128
v_max_u32 v2, v2, v132
v_cmp_eq_u32 vcc, -1, v2
s_cbranch_vccnz L_o4_rt
L_o4_ok:
s_waitcnt lgkmcnt(0)
v_mfma_f32_16x16x32_bf16 v[24:27], a[0:3], v[120:123], v[24:27]
ds_read_b64_tr_b16 a[16:17], v12 offset:4096
v_mfma_f32_16x16x32_bf16 v[40:43], a[0:3], v[124:127], v[40:43]
ds_read_b64_tr_b16 a[18:19], v12 offset:6144
v_mfma_f32_16x16x32_bf16 v[28:31], a[4:7], v[120:123], v[28:31]
ds_read_b64_tr_b16 a[20:21], v13 offset:4096
v_mfma_f32_16x16x32_bf16 v[44:47], a[4:7], v[124:127], v[44:47]
ds_read_b64_tr_b16 a[22:23], v13 offset:6144
v_mfma_f32_16x16x32_bf16 v[32:35], a[8:11], v[120:123], v[32:35]
ds_read_b64_tr_b16 a[24:25], v14 offset:4096
v_mfma_f32_16x16x32_bf16 v[48:51], a[8:11], v[124:127], v[48:51]
ds_read_b64_tr_b16 a[26:27], v14 offset:6144
v_mfma_f32_16x16x32_bf16 v[36:39], a[12:15], v[120:123], v[36:39]
ds_read_b64_tr_b16 a[28:29], v15 offset:4096
v_mfma_f32_16x16x32_bf16 v[52:55], a[12:15], v[124:127], v[52:55]
ds_read_b64_tr_b16 a[30:31], v15 offset:6144
s_add_u32 s71, s65, 5
s_and_b32 s71, s71, 15
s_lshl_b32 s71, s71, 13
v_add_u32 v12, s71, v8
v_add_u32 v13, s71, v9
v_add_u32 v14, s71, v10
v_add_u32 v15, s71, v11
s_waitcnt lgkmcnt(0)
v_mfma_f32_16x16x32_bf16 v[24:27], a[16:19], v[128:131], v[24:27]
ds_read_b64_tr_b16 a[0:1], v12 offset:0
v_mfma_f32_16x16x32_bf16 v[40:43], a[16:19], v[132:135], v[40:43]
ds_read_b64_tr_b16 a[2:3], v12 offset:2048
v_mfma_f32_16x16x32_bf16 v[28:31], a[20:23], v[128:131], v[28:31]
ds_read_b64_tr_b16 a[4:5], v13 offset:0
v_mfma_f32_16x16x32_bf16 v[44:47], a[20:23], v[132:135], v[44:47]
ds_read_b64_tr_b16 a[6:7], v13 offset:2048
v_mfma_f32_16x16x32_bf16 v[32:35], a[24:27], v[128:131], v[32:35]
ds_read_b64_tr_b16 a[8:9], v14 offset:0
v_mfma_f32_16x16x32_bf16 v[48:51], a[24:27], v[132:135], v[48:51]
ds_read_b64_tr_b16 a[10:11], v14 offset:2048
v_mfma_f32_16x16x32_bf16 v[36:39], a[28:31], v[128:131], v[36:39]
ds_read_b64_tr_b16 a[12:13], v15 offset:0
v_mfma_f32_16x16x32_bf16 v[52:55], a[28:31], v[132:135], v[52:55]
ds_read_b64_tr_b16 a[14:15], v15 offset:2048
s_add_u32 s70, s65, 10
s_and_b32 s70, s70, 15
s_lshl_b32 s70, s70, 11
s_add_u32 s70, s70, s74
buffer_load_dwordx4 v[120:123], v16, s[12:15], s70 offen offset:0 sc1
buffer_load_dwordx4 v[124:127], v19, s[12:15], s70 offen offset:0 sc1
buffer_load_dwordx4 v[128:131], v16, s[12:15], s70 offen offset:1024 sc1
buffer_load_dwordx4 v[132:135], v19, s[12:15], s70 offen offset:1024 sc1
s_waitcnt vmcnt(20)
L_o5_chk:
v_max3_u32 v2, v136, v140, v144
v_max_u32 v2, v2, v148
v_cmp_eq_u32 vcc, -1, v2
s_cbranch_vccnz L_o5_rt
L_o5_ok:
s_waitcnt lgkmcnt(0)
v_mfma_f32_16x16x32_bf16 v[24:27], a[0:3], v[136:139], v[24:27]
ds_read_b64_tr_b16 a[16:17], v12 offset:4096
v_mfma_f32_16x16x32_bf16 v[40:43], a[0:3], v[140:143], v[40:43]
ds_read_b64_tr_b16 a[18:19], v12 offset:6144
v_mfma_f32_16x16x32_bf16 v[28:31], a[4:7], v[136:139], v[28:31]
ds_read_b64_tr_b16 a[20:21], v13 offset:4096
v_mfma_f32_16x16x32_bf16 v[44:47], a[4:7], v[140:143], v[44:47]
ds_read_b64_tr_b16 a[22:23], v13 offset:6144
v_mfma_f32_16x16x32_bf16 v[32:35], a[8:11], v[136:139], v[32:35]
ds_read_b64_tr_b16 a[24:25], v14 offset:4096
v_mfma_f32_16x16x32_bf16 v[48:51], a[8:11], v[140:143], v[48:51]
ds_read_b64_tr_b16 a[26:27], v14 offset:6144
v_mfma_f32_16x16x32_bf16 v[36:39], a[12:15], v[136:139], v[36:39]
ds_read_b64_tr_b16 a[28:29], v15 offset:4096
v_mfma_f32_16x16x32_bf16 v[52:55], a[12:15], v[140:143], v[52:55]
ds_read_b64_tr_b16 a[30:31], v15 offset:6144
s_add_u32 s71, s65, 6
s_and_b32 s71, s71, 15
s_lshl_b32 s71, s71, 13
v_add_u32 v12, s71, v8
v_add_u32 v13, s71, v9
v_add_u32 v14, s71, v10
v_add_u32 v15, s71, v11
s_waitcnt lgkmcnt(0)
v_mfma_f32_16x16x32_bf16 v[24:27], a[16:19], v[144:147], v[24:27]
ds_read_b64_tr_b16 a[0:1], v12 offset:0
v_mfma_f32_16x16x32_bf16 v[40:43], a[16:19], v[148:151], v[40:43]
ds_read_b64_tr_b16 a[2:3], v12 offset:2048
v_mfma_f32_16x16x32_bf16 v[28:31], a[20:23], v[144:147], v[28:31]
ds_read_b64_tr_b16 a[4:5], v13 offset:0
v_mfma_f32_16x16x32_bf16 v[44:47], a[20:23], v[148:151], v[44:47]
ds_read_b64_tr_b16 a[6:7], v13 offset:2048
v_mfma_f32_16x16x32_bf16 v[32:35], a[24:27], v[144:147], v[32:35]
ds_read_b64_tr_b16 a[8:9], v14 offset:0
v_mfma_f32_16x16x32_bf16 v[48:51], a[24:27], v[148:151], v[48:51]
ds_read_b64_tr_b16 a[10:11], v14 offset:2048
v_mfma_f32_16x16x32_bf16 v[36:39], a[28:31], v[144:147], v[36:39]
ds_read_b64_tr_b16 a[12:13], v15 offset:0
v_mfma_f32_16x16x32_bf16 v[52:55], a[28:31], v[148:151], v[52:55]
ds_read_b64_tr_b16 a[14:15], v15 offset:2048
s_add_u32 s70, s65, 11
s_and_b32 s70, s70, 15
s_lshl_b32 s70, s70, 11
s_add_u32 s70, s70, s74
buffer_load_dwordx4 v[136:139], v16, s[12:15], s70 offen offset:0 sc1
buffer_load_dwordx4 v[140:143], v19, s[12:15], s70 offen offset:0 sc1
buffer_load_dwordx4 v[144:147], v16, s[12:15], s70 offen offset:1024 sc1
buffer_load_dwordx4 v[148:151], v19, s[12:15], s70 offen offset:1024 sc1
s_waitcnt vmcnt(20)
L_o6_chk:
v_max3_u32 v2, v56, v60, v64
v_max_u32 v2, v2, v68
v_cmp_eq_u32 vcc, -1, v2
s_cbranch_vccnz L_o6_rt
L_o6_ok:
s_waitcnt lgkmcnt(0)
v_mfma_f32_16x16x32_bf16 v[24:27], a[0:3], v[56:59], v[24:27]
ds_read_b64_tr_b16 a[16:17], v12 offset:4096
v_mfma_f32_16x16x32_bf16 v[40:43], a[0:3], v[60:63], v[40:43]
ds_read_b64_tr_b16 a[18:19], v12 offset:6144
v_mfma_f32_16x16x32_bf16 v[28:31], a[4:7], v[56:59], v[28:31]
ds_read_b64_tr_b16 a[20:21], v13 offset:4096
v_mfma_f32_16x16x32_bf16 v[44:47], a[4:7], v[60:63], v[44:47]
ds_read_b64_tr_b16 a[22:23], v13 offset:6144
v_mfma_f32_16x16x32_bf16 v[32:35], a[8:11], v[56:59], v[32:35]
ds_read_b64_tr_b16 a[24:25], v14 offset:4096
v_mfma_f32_16x16x32_bf16 v[48:51], a[8:11], v[60:63], v[48:51]
ds_read_b64_tr_b16 a[26:27], v14 offset:6144
v_mfma_f32_16x16x32_bf16 v[36:39], a[12:15], v[56:59], v[36:39]
ds_read_b64_tr_b16 a[28:29], v15 offset:4096
v_mfma_f32_16x16x32_bf16 v[52:55], a[12:15], v[60:63], v[52:55]
ds_read_b64_tr_b16 a[30:31], v15 offset:6144
s_add_u32 s71, s65, 7
s_and_b32 s71, s71, 15
s_lshl_b32 s71, s71, 13
v_add_u32 v12, s71, v8
v_add_u32 v13, s71, v9
v_add_u32 v14, s71, v10
v_add_u32 v15, s71, v11
s_waitcnt lgkmcnt(0)
v_mfma_f32_16x16x32_bf16 v[24:27], a[16:19], v[64:67], v[24:27]
ds_read_b64_tr_b16 a[0:1], v12 offset:0
v_mfma_f32_16x16x32_bf16 v[40:43], a[16:19], v[68:71], v[40:43]
ds_read_b64_tr_b16 a[2:3], v12 offset:2048
v_mfma_f32_16x16x32_bf16 v[28:31], a[20:23], v[64:67], v[28:31]
ds_read_b64_tr_b16 a[4:5], v13 offset:0
v_mfma_f32_16x16x32_bf16 v[44:47], a[20:23], v[68:71], v[44:47]
ds_read_b64_tr_b16 a[6:7], v13 offset:2048
v_mfma_f32_16x16x32_bf16 v[32:35], a[24:27], v[64:67], v[32:35]
ds_read_b64_tr_b16 a[8:9], v14 offset:0
v_mfma_f32_16x16x32_bf16 v[48:51], a[24:27], v[68:71], v[48:51]
ds_read_b64_tr_b16 a[10:11], v14 offset:2048
v_mfma_f32_16x16x32_bf16 v[36:39], a[28:31], v[64:67], v[36:39]
ds_read_b64_tr_b16 a[12:13], v15 offset:0
v_mfma_f32_16x16x32_bf16 v[52:55], a[28:31], v[68:71], v[52:55]
ds_read_b64_tr_b16 a[14:15], v15 offset:2048
s_add_u32 s70, s65, 12
s_and_b32 s70, s70, 15
s_lshl_b32 s70, s70, 11
s_add_u32 s70, s70, s74
buffer_load_dwordx4 v[56:59], v16, s[12:15], s70 offen offset:0 sc1
buffer_load_dwordx4 v[60:63], v19, s[12:15], s70 offen offset:0 sc1
buffer_load_dwordx4 v[64:67], v16, s[12:15], s70 offen offset:1024 sc1
buffer_load_dwordx4 v[68:71], v19, s[12:15], s70 offen offset:1024 sc1
s_waitcnt vmcnt(20)
L_o7_chk:
v_max3_u32 v2, v72, v76, v80
v_max_u32 v2, v2, v84
v_cmp_eq_u32 vcc, -1, v2
s_cbranch_vccnz L_o7_rt
L_o7_ok:
s_waitcnt lgkmcnt(0)
v_mfma_f32_16x16x32_bf16 v[24:27], a[0:3], v[72:75], v[24:27]
ds_read_b64_tr_b16 a[16:17], v12 offset:4096
v_mfma_f32_16x16x32_bf16 v[40:43], a[0:3], v[76:79], v[40:43]
ds_read_b64_tr_b16 a[18:19], v12 offset:6144
v_mfma_f32_16x16x32_bf16 v[28:31], a[4:7], v[72:75], v[28:31]
ds_read_b64_tr_b16 a[20:21], v13 offset:4096
v_mfma_f32_16x16x32_bf16 v[44:47], a[4:7], v[76:79], v[44:47]
ds_read_b64_tr_b16 a[22:23], v13 offset:6144
v_mfma_f32_16x16x32_bf16 v[32:35], a[8:11], v[72:75], v[32:35]
ds_read_b64_tr_b16 a[24:25], v14 offset:4096
v_mfma_f32_16x16x32_bf16 v[48:51], a[8:11], v[76:79], v[48:51]
ds_read_b64_tr_b16 a[26:27], v14 offset:6144
v_mfma_f32_16x16x32_bf16 v[36:39], a[12:15], v[72:75], v[36:39]
ds_read_b64_tr_b16 a[28:29], v15 offset:4096
v_mfma_f32_16x16x32_bf16 v[52:55], a[12:15], v[76:79], v[52:55]
ds_read_b64_tr_b16 a[30:31], v15 offset:6144
s_add_u32 s71, s65, 8
s_and_b32 s71, s71, 15
s_lshl_b32 s71, s71, 13
v_add_u32 v12, s71, v8
v_add_u32 v13, s71, v9
v_add_u32 v14, s71, v10
v_add_u32 v15, s71, v11
s_waitcnt lgkmcnt(0)
v_mfma_f32_16x16x32_bf16 v[24:27], a[16:19], v[80:83], v[24:27]
ds_read_b64_tr_b16 a[0:1], v12 offset:0
v_mfma_f32_16x16x32_bf16 v[40:43], a[16:19], v[84:87], v[40:43]
ds_read_b64_tr_b16 a[2:3], v12 offset:2048
v_mfma_f32_16x16x32_bf16 v[28:31], a[20:23], v[80:83], v[28:31]
ds_read_b64_tr_b16 a[4:5], v13 offset:0
v_mfma_f32_16x16x32_bf16 v[44:47], a[20:23], v[84:87], v[44:47]
ds_read_b64_tr_b16 a[6:7], v13 offset:2048
v_mfma_f32_16x16x32_bf16 v[32:35], a[24:27], v[80:83], v[32:35]
ds_read_b64_tr_b16 a[8:9], v14 offset:0
v_mfma_f32_16x16x32_bf16 v[48:51], a[24:27], v[84:87], v[48:51]
ds_read_b64_tr_b16 a[10:11], v14 offset:2048
v_mfma_f32_16x16x32_bf16 v[36:39], a[28:31], v[80:83], v[36:39]
ds_read_b64_tr_b16 a[12:13], v15 offset:0
v_mfma_f32_16x16x32_bf16 v[52:55], a[28:31], v[84:87], v[52:55]
ds_read_b64_tr_b16 a[14:15], v15 offset:2048
s_add_u32 s70, s65, 13
s_and_b32 s70, s70, 15
s_lshl_b32 s70, s70, 11
s_add_u32 s70, s70, s74
buffer_load_dwordx4 v[72:75], v16, s[12:15], s70 offen offset:0 sc1
buffer_load_dwordx4 v[76:79], v19, s[12:15], s70 offen offset:0 sc1
buffer_load_dwordx4 v[80:83], v16, s[12:15], s70 offen offset:1024 sc1
buffer_load_dwordx4 v[84:87], v19, s[12:15], s70 offen offset:1024 sc1
s_waitcnt vmcnt(20)
L_o8_chk:
v_max3_u32 v2, v88, v92, v96
v_max_u32 v2, v2, v100
v_cmp_eq_u32 vcc, -1, v2
s_cbranch_vccnz L_o8_rt
L_o8_ok:
s_waitcnt lgkmcnt(0)
v_mfma_f32_16x16x32_bf16 v[24:27], a[0:3], v[88:91], v[24:27]
ds_read_b64_tr_b16 a[16:17], v12 offset:4096
v_mfma_f32_16x16x32_bf16 v[40:43], a[0:3], v[92:95], v[40:43]
ds_read_b64_tr_b16 a[18:19], v12 offset:6144
v_mfma_f32_16x16x32_bf16 v[28:31], a[4:7], v[88:91], v[28:31]
ds_read_b64_tr_b16 a[20:21], v13 offset:4096
v_mfma_f32_16x16x32_bf16 v[44:47], a[4:7], v[92:95], v[44:47]
ds_read_b64_tr_b16 a[22:23], v13 offset:6144
v_mfma_f32_16x16x32_bf16 v[32:35], a[8:11], v[88:91], v[32:35]
ds_read_b64_tr_b16 a[24:25], v14 offset:4096
v_mfma_f32_16x16x32_bf16 v[48:51], a[8:11], v[92:95], v[48:51]
ds_read_b64_tr_b16 a[26:27], v14 offset:6144
v_mfma_f32_16x16x32_bf16 v[36:39], a[12:15], v[88:91], v[36:39]
ds_read_b64_tr_b16 a[28:29], v15 offset:4096
v_mfma_f32_16x16x32_bf16 v[52:55], a[12:15], v[92:95], v[52:55]
ds_read_b64_tr_b16 a[30:31], v15 offset:6144
s_add_u32 s71, s65, 9
s_and_b32 s71, s71, 15
s_lshl_b32 s71, s71, 13
v_add_u32 v12, s71, v8
v_add_u32 v13, s71, v9
v_add_u32 v14, s71, v10
v_add_u32 v15, s71, v11
s_waitcnt lgkmcnt(0)
v_mfma_f32_16x16x32_bf16 v[24:27], a[16:19], v[96:99], v[24:27]
ds_read_b64_tr_b16 a[0:1], v12 offset:0
v_mfma_f32_16x16x32_bf16 v[40:43], a[16:19], v[100:103], v[40:43]
ds_read_b64_tr_b16 a[2:3], v12 offset:2048
v_mfma_f32_16x16x32_bf16 v[28:31], a[20:23], v[96:99], v[28:31]
ds_read_b64_tr_b16 a[4:5], v13 offset:0
v_mfma_f32_16x16x32_bf16 v[44:47], a[20:23], v[100:103], v[44:47]
ds_read_b64_tr_b16 a[6:7], v13 offset:2048
v_mfma_f32_16x16x32_bf16 v[32:35], a[24:27], v[96:99], v[32:35]
ds_read_b64_tr_b16 a[8:9], v14 offset:0
v_mfma_f32_16x16x32_bf16 v[48:51], a[24:27], v[100:103], v[48:51]
ds_read_b64_tr_b16 a[10:11], v14 offset:2048
v_mfma_f32_16x16x32_bf16 v[36:39], a[28:31], v[96:99], v[36:39]
ds_read_b64_tr_b16 a[12:13], v15 offset:0
v_mfma_f32_16x16x32_bf16 v[52:55], a[28:31], v[100:103], v[52:55]
ds_read_b64_tr_b16 a[14:15], v15 offset:2048
s_add_u32 s70, s65, 14
s_and_b32 s70, s70, 15
s_lshl_b32 s70, s70, 11
s_add_u32 s70, s70, s74
buffer_load_dwordx4 v[88:91], v16, s[12:15], s70 offen offset:0 sc1
buffer_load_dwordx4 v[92:95], v19, s[12:15], s70 offen offset:0 sc1
buffer_load_dwordx4 v[96:99], v16, s[12:15], s70 offen offset:1024 sc1
buffer_load_dwordx4 v[100:103], v19, s[12:15], s70 offen offset:1024 sc1
s_waitcnt vmcnt(20)
L_o9_chk:
v_max3_u32 v2, v104, v108, v112
v_max_u32 v2, v2, v116
v_cmp_eq_u32 vcc, -1, v2
s_cbranch_vccnz L_o9_rt
L_o9_ok:
s_waitcnt lgkmcnt(0)
v_mfma_f32_16x16x32_bf16 v[24:27], a[0:3], v[104:107], v[24:27]
ds_read_b64_tr_b16 a[16:17], v12 offset:4096
v_mfma_f32_16x16x32_bf16 v[40:43], a[0:3], v[108:111], v[40:43]
ds_read_b64_tr_b16 a[18:19], v12 offset:6144
v_mfma_f32_16x16x32_bf16 v[28:31], a[4:7], v[104:107], v[28:31]
ds_read_b64_tr_b16 a[20:21], v13 offset:4096
v_mfma_f32_16x16x32_bf16 v[44:47], a[4:7], v[108:111], v[44:47]
ds_read_b64_tr_b16 a[22:23], v13 offset:6144
v_mfma_f32_16x16x32_bf16 v[32:35], a[8:11], v[104:107], v[32:35]
ds_read_b64_tr_b16 a[24:25], v14 offset:4096
v_mfma_f32_16x16x32_bf16 v[48:51], a[8:11], v[108:111], v[48:51]
ds_read_b64_tr_b16 a[26:27], v14 offset:6144
v_mfma_f32_16x16x32_bf16 v[36:39], a[12:15], v[104:107], v[36:39]
ds_read_b64_tr_b16 a[28:29], v15 offset:4096
v_mfma_f32_16x16x32_bf16 v[52:55], a[12:15], v[108:111], v[52:55]
ds_read_b64_tr_b16 a[30:31], v15 offset:6144
s_add_u32 s71, s65, 10
s_and_b32 s71, s71, 15
s_lshl_b32 s71, s71, 13
v_add_u32 v12, s71, v8
v_add_u32 v13, s71, v9
v_add_u32 v14, s71, v10
v_add_u32 v15, s71, v11
s_waitcnt lgkmcnt(0)
v_mfma_f32_16x16x32_bf16 v[24:27], a[16:19], v[112:115], v[24:27]
ds_read_b64_tr_b16 a[0:1], v12 offset:0
v_mfma_f32_16x16x32_bf16 v[40:43], a[16:19], v[116:119], v[40:43]
ds_read_b64_tr_b16 a[2:3], v12 offset:2048
v_mfma_f32_16x16x32_bf16 v[28:31], a[20:23], v[112:115], v[28:31]
ds_read_b64_tr_b16 a[4:5], v13 offset:0
v_mfma_f32_16x16x32_bf16 v[44:47], a[20:23], v[116:119], v[44:47]
ds_read_b64_tr_b16 a[6:7], v13 offset:2048
v_mfma_f32_16x16x32_bf16 v[32:35], a[24:27], v[112:115], v[32:35]
ds_read_b64_tr_b16 a[8:9], v14 offset:0
v_mfma_f32_16x16x32_bf16 v[48:51], a[24:27], v[116:119], v[48:51]
ds_read_b64_tr_b16 a[10:11], v14 offset:2048
v_mfma_f32_16x16x32_bf16 v[36:39], a[28:31], v[112:115], v[36:39]
ds_read_b64_tr_b16 a[12:13], v15 offset:0
v_mfma_f32_16x16x32_bf16 v[52:55], a[28:31], v[116:119], v[52:55]
ds_read_b64_tr_b16 a[14:15], v15 offset:2048
s_add_u32 s70, s65, 15
s_and_b32 s70, s70, 15
s_lshl_b32 s70, s70, 11
s_add_u32 s70, s70, s74
buffer_load_dwordx4 v[104:107], v16, s[12:15], s70 offen offset:0 sc1
buffer_load_dwordx4 v[108:111], v19, s[12:15], s70 offen offset:0 sc1
buffer_load_dwordx4 v[112:115], v16, s[12:15], s70 offen offset:1024 sc1
buffer_load_dwordx4 v[116:119], v19, s[12:15], s70 offen offset:1024 sc1
s_waitcnt vmcnt(20)
L_o10_chk:
v_max3_u32 v2, v120, v124, v128
v_max_u32 v2, v2, v132
v_cmp_eq_u32 vcc, -1, v2
s_cbranch_vccnz L_o10_rt
L_o10_ok:
s_waitcnt lgkmcnt(0)
v_mfma_f32_16x16x32_bf16 v[24:27], a[0:3], v[120:123], v[24:27]
ds_read_b64_tr_b16 a[16:17], v12 offset:4096
v_mfma_f32_16x16x32_bf16 v[40:43], a[0:3], v[124:127], v[40:43]
ds_read_b64_tr_b16 a[18:19], v12 offset:6144
v_mfma_f32_16x16x32_bf16 v[28:31], a[4:7], v[120:123], v[28:31]
ds_read_b64_tr_b16 a[20:21], v13 offset:4096
v_mfma_f32_16x16x32_bf16 v[44:47], a[4:7], v[124:127], v[44:47]
ds_read_b64_tr_b16 a[22:23], v13 offset:6144
v_mfma_f32_16x16x32_bf16 v[32:35], a[8:11], v[120:123], v[32:35]
ds_read_b64_tr_b16 a[24:25], v14 offset:4096
v_mfma_f32_16x16x32_bf16 v[48:51], a[8:11], v[124:127], v[48:51]
ds_read_b64_tr_b16 a[26:27], v14 offset:6144
v_mfma_f32_16x16x32_bf16 v[36:39], a[12:15], v[120:123], v[36:39]
ds_read_b64_tr_b16 a[28:29], v15 offset:4096
v_mfma_f32_16x16x32_bf16 v[52:55], a[12:15], v[124:127], v[52:55]
ds_read_b64_tr_b16 a[30:31], v15 offset:6144
s_add_u32 s71, s65, 11
s_and_b32 s71, s71, 15
s_lshl_b32 s71, s71, 13
v_add_u32 v12, s71, v8
v_add_u32 v13, s71, v9
v_add_u32 v14, s71, v10
v_add_u32 v15, s71, v11
s_waitcnt lgkmcnt(0)
v_mfma_f32_16x16x32_bf16 v[24:27], a[16:19], v[128:131], v[24:27]
ds_read_b64_tr_b16 a[0:1], v12 offset:0
v_mfma_f32_16x16x32_bf16 v[40:43], a[16:19], v[132:135], v[40:43]
ds_read_b64_tr_b16 a[2:3], v12 offset:2048
v_mfma_f32_16x16x32_bf16 v[28:31], a[20:23], v[128:131], v[28:31]
ds_read_b64_tr_b16 a[4:5], v13 offset:0
v_mfma_f32_16x16x32_bf16 v[44:47], a[20:23], v[132:135], v[44:47]
ds_read_b64_tr_b16 a[6:7], v13 offset:2048
v_mfma_f32_16x16x32_bf16 v[32:35], a[24:27], v[128:131], v[32:35]
ds_read_b64_tr_b16 a[8:9], v14 offset:0
v_mfma_f32_16x16x32_bf16 v[48:51], a[24:27], v[132:135], v[48:51]
ds_read_b64_tr_b16 a[10:11], v14 offset:2048
v_mfma_f32_16x16x32_bf16 v[36:39], a[28:31], v[128:131], v[36:39]
ds_read_b64_tr_b16 a[12:13], v15 offset:0
v_mfma_f32_16x16x32_bf16 v[52:55], a[28:31], v[132:135], v[52:55]
ds_read_b64_tr_b16 a[14:15], v15 offset:2048
s_waitcnt vmcnt(16)
L_o11_chk:
v_max3_u32 v2, v136, v140, v144
v_max_u32 v2, v2, v148
v_cmp_eq_u32 vcc, -1, v2
s_cbranch_vccnz L_o11_rt
L_o11_ok:
s_waitcnt lgkmcnt(0)
v_mfma_f32_16x16x32_bf16 v[24:27], a[0:3], v[136:139], v[24:27]
ds_read_b64_tr_b16 a[16:17], v12 offset:4096
v_mfma_f32_16x16x32_bf16 v[40:43], a[0:3], v[140:143], v[40:43]
ds_read_b64_tr_b16 a[18:19], v12 offset:6144
v_mfma_f32_16x16x32_bf16 v[28:31], a[4:7], v[136:139], v[28:31]
ds_read_b64_tr_b16 a[20:21], v13 offset:4096
v_mfma_f32_16x16x32_bf16 v[44:47], a[4:7], v[140:143], v[44:47]
ds_read_b64_tr_b16 a[22:23], v13 offset:6144
v_mfma_f32_16x16x32_bf16 v[32:35], a[8:11], v[136:139], v[32:35]
ds_read_b64_tr_b16 a[24:25], v14 offset:4096
v_mfma_f32_16x16x32_bf16 v[48:51], a[8:11], v[140:143], v[48:51]
ds_read_b64_tr_b16 a[26:27], v14 offset:6144
v_mfma_f32_16x16x32_bf16 v[36:39], a[12:15], v[136:139], v[36:39]
ds_read_b64_tr_b16 a[28:29], v15 offset:4096
v_mfma_f32_16x16x32_bf16 v[52:55], a[12:15], v[140:143], v[52:55]
ds_read_b64_tr_b16 a[30:31], v15 offset:6144
s_add_u32 s71, s65, 12
s_and_b32 s71, s71, 15
s_lshl_b32 s71, s71, 13
v_add_u32 v12, s71, v8
v_add_u32 v13, s71, v9
v_add_u32 v14, s71, v10
v_add_u32 v15, s71, v11
s_waitcnt lgkmcnt(0)
v_mfma_f32_16x16x32_bf16 v[24:27], a[16:19], v[144:147], v[24:27]
ds_read_b64_tr_b16 a[0:1], v12 offset:0
v_mfma_f32_16x16x32_bf16 v[40:43], a[16:19], v[148:151], v[40:43]
ds_read_b64_tr_b16 a[2:3], v12 offset:2048
v_mfma_f32_16x16x32_bf16 v[28:31], a[20:23], v[144:147], v[28:31]
ds_read_b64_tr_b16 a[4:5], v13 offset:0
v_mfma_f32_16x16x32_bf16 v[44:47], a[20:23], v[148:151], v[44:47]
ds_read_b64_tr_b16 a[6:7], v13 offset:2048
v_mfma_f32_16x16x32_bf16 v[32:35], a[24:27], v[144:147], v[32:35]
ds_read_b64_tr_b16 a[8:9], v14 offset:0
v_mfma_f32_16x16x32_bf16 v[48:51], a[24:27], v[148:151], v[48:51]
ds_read_b64_tr_b16 a[10:11], v14 offset:2048
v_mfma_f32_16x16x32_bf16 v[36:39], a[28:31], v[144:147], v[36:39]
ds_read_b64_tr_b16 a[12:13], v15 offset:0
v_mfma_f32_16x16x32_bf16 v[52:55], a[28:31], v[148:151], v[52:55]
ds_read_b64_tr_b16 a[14:15], v15 offset:2048
s_waitcnt vmcnt(12)
L_o12_chk:
v_max3_u32 v2, v56, v60, v64
v_max_u32 v2, v2, v68
v_cmp_eq_u32 vcc, -1, v2
s_cbranch_vccnz L_o12_rt
L_o12_ok:
s_waitcnt lgkmcnt(0)
v_mfma_f32_16x16x32_bf16 v[24:27], a[0:3], v[56:59], v[24:27]
ds_read_b64_tr_b16 a[16:17], v12 offset:4096
v_mfma_f32_16x16x32_bf16 v[40:43], a[0:3], v[60:63], v[40:43]
ds_read_b64_tr_b16 a[18:19], v12 offset:6144
v_mfma_f32_16x16x32_bf16 v[28:31], a[4:7], v[56:59], v[28:31]
ds_read_b64_tr_b16 a[20:21], v13 offset:4096
v_mfma_f32_16x16x32_bf16 v[44:47], a[4:7], v[60:63], v[44:47]
ds_read_b64_tr_b16 a[22:23], v13 offset:6144
v_mfma_f32_16x16x32_bf16 v[32:35], a[8:11], v[56:59], v[32:35]
ds_read_b64_tr_b16 a[24:25], v14 offset:4096
v_mfma_f32_16x16x32_bf16 v[48:51], a[8:11], v[60:63], v[48:51]
ds_read_b64_tr_b16 a[26:27], v14 offset:6144
v_mfma_f32_16x16x32_bf16 v[36:39], a[12:15], v[56:59], v[36:39]
ds_read_b64_tr_b16 a[28:29], v15 offset:4096
v_mfma_f32_16x16x32_bf16 v[52:55], a[12:15], v[60:63], v[52:55]
ds_read_b64_tr_b16 a[30:31], v15 offset:6144
s_add_u32 s71, s65, 13
s_and_b32 s71, s71, 15
s_lshl_b32 s71, s71, 13
v_add_u32 v12, s71, v8
v_add_u32 v13, s71, v9
v_add_u32 v14, s71, v10
v_add_u32 v15, s71, v11
s_waitcnt lgkmcnt(0)
v_mfma_f32_16x16x32_bf16 v[24:27], a[16:19], v[64:67], v[24:27]
ds_read_b64_tr_b16 a[0:1], v12 offset:0
v_mfma_f32_16x16x32_bf16 v[40:43], a[16:19], v[68:71], v[40:43]
ds_read_b64_tr_b16 a[2:3], v12 offset:2048
v_mfma_f32_16x16x32_bf16 v[28:31], a[20:23], v[64:67], v[28:31]
ds_read_b64_tr_b16 a[4:5], v13 offset:0
v_mfma_f32_16x16x32_bf16 v[44:47], a[20:23], v[68:71], v[44:47]
ds_read_b64_tr_b16 a[6:7], v13 offset:2048
v_mfma_f32_16x16x32_bf16 v[32:35], a[24:27], v[64:67], v[32:35]
ds_read_b64_tr_b16 a[8:9], v14 offset:0
v_mfma_f32_16x16x32_bf16 v[48:51], a[24:27], v[68:71], v[48:51]
ds_read_b64_tr_b16 a[10:11], v14 offset:2048
v_mfma_f32_16x16x32_bf16 v[36:39], a[28:31], v[64:67], v[36:39]
ds_read_b64_tr_b16 a[12:13], v15 offset:0
v_mfma_f32_16x16x32_bf16 v[52:55], a[28:31], v[68:71], v[52:55]
ds_read_b64_tr_b16 a[14:15], v15 offset:2048
s_waitcnt vmcnt(8)
L_o13_chk:
v_max3_u32 v2, v72, v76, v80
v_max_u32 v2, v2, v84
v_cmp_eq_u32 vcc, -1, v2
s_cbranch_vccnz L_o13_rt
L_o13_ok:
s_waitcnt lgkmcnt(0)
v_mfma_f32_16x16x32_bf16 v[24:27], a[0:3], v[72:75], v[24:27]
ds_read_b64_tr_b16 a[16:17], v12 offset:4096
v_mfma_f32_16x16x32_bf16 v[40:43], a[0:3], v[76:79], v[40:43]
ds_read_b64_tr_b16 a[18:19], v12 offset:6144
v_mfma_f32_16x16x32_bf16 v[28:31], a[4:7], v[72:75], v[28:31]
ds_read_b64_tr_b16 a[20:21], v13 offset:4096
v_mfma_f32_16x16x32_bf16 v[44:47], a[4:7], v[76:79], v[44:47]
ds_read_b64_tr_b16 a[22:23], v13 offset:6144
v_mfma_f32_16x16x32_bf16 v[32:35], a[8:11], v[72:75], v[32:35]
ds_read_b64_tr_b16 a[24:25], v14 offset:4096
v_mfma_f32_16x16x32_bf16 v[48:51], a[8:11], v[76:79], v[48:51]
ds_read_b64_tr_b16 a[26:27], v14 offset:6144
v_mfma_f32_16x16x32_bf16 v[36:39], a[12:15], v[72:75], v[36:39]
ds_read_b64_tr_b16 a[28:29], v15 offset:4096
v_mfma_f32_16x16x32_bf16 v[52:55], a[12:15], v[76:79], v[52:55]
ds_read_b64_tr_b16 a[30:31], v15 offset:6144
s_add_u32 s71, s65, 14
s_and_b32 s71, s71, 15
s_lshl_b32 s71, s71, 13
v_add_u32 v12, s71, v8
v_add_u32 v13, s71, v9
v_add_u32 v14, s71, v10
v_add_u32 v15, s71, v11
s_waitcnt lgkmcnt(0)
v_mfma_f32_16x16x32_bf16 v[24:27], a[16:19], v[80:83], v[24:27]
ds_read_b64_tr_b16 a[0:1], v12 offset:0
v_mfma_f32_16x16x32_bf16 v[40:43], a[16:19], v[84:87], v[40:43]
ds_read_b64_tr_b16 a[2:3], v12 offset:2048
v_mfma_f32_16x16x32_bf16 v[28:31], a[20:23], v[80:83], v[28:31]
ds_read_b64_tr_b16 a[4:5], v13 offset:0
v_mfma_f32_16x16x32_bf16 v[44:47], a[20:23], v[84:87], v[44:47]
ds_read_b64_tr_b16 a[6:7], v13 offset:2048
v_mfma_f32_16x16x32_bf16 v[32:35], a[24:27], v[80:83], v[32:35]
ds_read_b64_tr_b16 a[8:9], v14 offset:0
v_mfma_f32_16x16x32_bf16 v[48:51], a[24:27], v[84:87], v[48:51]
ds_read_b64_tr_b16 a[10:11], v14 offset:2048
v_mfma_f32_16x16x32_bf16 v[36:39], a[28:31], v[80:83], v[36:39]
ds_read_b64_tr_b16 a[12:13], v15 offset:0
v_mfma_f32_16x16x32_bf16 v[52:55], a[28:31], v[84:87], v[52:55]
ds_read_b64_tr_b16 a[14:15], v15 offset:2048
s_waitcnt vmcnt(4)
L_o14_chk:
v_max3_u32 v2, v88, v92, v96
v_max_u32 v2, v2, v100
v_cmp_eq_u32 vcc, -1, v2
s_cbranch_vccnz L_o14_rt
L_o14_ok:
s_waitcnt lgkmcnt(0)
v_mfma_f32_16x16x32_bf16 v[24:27], a[0:3], v[88:91], v[24:27]
ds_read_b64_tr_b16 a[16:17], v12 offset:4096
v_mfma_f32_16x16x32_bf16 v[40:43], a[0:3], v[92:95], v[40:43]
ds_read_b64_tr_b16 a[18:19], v12 offset:6144
v_mfma_f32_16x16x32_bf16 v[28:31], a[4:7], v[88:91], v[28:31]
ds_read_b64_tr_b16 a[20:21], v13 offset:4096
v_mfma_f32_16x16x32_bf16 v[44:47], a[4:7], v[92:95], v[44:47]
ds_read_b64_tr_b16 a[22:23], v13 offset:6144
v_mfma_f32_16x16x32_bf16 v[32:35], a[8:11], v[88:91], v[32:35]
ds_read_b64_tr_b16 a[24:25], v14 offset:4096
v_mfma_f32_16x16x32_bf16 v[48:51], a[8:11], v[92:95], v[48:51]
ds_read_b64_tr_b16 a[26:27], v14 offset:6144
v_mfma_f32_16x16x32_bf16 v[36:39], a[12:15], v[88:91], v[36:39]
ds_read_b64_tr_b16 a[28:29], v15 offset:4096
v_mfma_f32_16x16x32_bf16 v[52:55], a[12:15], v[92:95], v[52:55]
ds_read_b64_tr_b16 a[30:31], v15 offset:6144
s_add_u32 s71, s65, 15
s_and_b32 s71, s71, 15
s_lshl_b32 s71, s71, 13
v_add_u32 v12, s71, v8
v_add_u32 v13, s71, v9
v_add_u32 v14, s71, v10
v_add_u32 v15, s71, v11
s_waitcnt lgkmcnt(0)
v_mfma_f32_16x16x32_bf16 v[24:27], a[16:19], v[96:99], v[24:27]
ds_read_b64_tr_b16 a[0:1], v12 offset:0
v_mfma_f32_16x16x32_bf16 v[40:43], a[16:19], v[100:103], v[40:43]
ds_read_b64_tr_b16 a[2:3], v12 offset:2048
v_mfma_f32_16x16x32_bf16 v[28:31], a[20:23], v[96:99], v[28:31]
ds_read_b64_tr_b16 a[4:5], v13 offset:0
v_mfma_f32_16x16x32_bf16 v[44:47], a[20:23], v[100:103], v[44:47]
ds_read_b64_tr_b16 a[6:7], v13 offset:2048
v_mfma_f32_16x16x32_bf16 v[32:35], a[24:27], v[96:99], v[32:35]
ds_read_b64_tr_b16 a[8:9], v14 offset:0
v_mfma_f32_16x16x32_bf16 v[48:51], a[24:27], v[100:103], v[48:51]
ds_read_b64_tr_b16 a[10:11], v14 offset:2048
v_mfma_f32_16x16x32_bf16 v[36:39], a[28:31], v[96:99], v[36:39]
ds_read_b64_tr_b16 a[12:13], v15 offset:0
v_mfma_f32_16x16x32_bf16 v[52:55], a[28:31], v[100:103], v[52:55]
ds_read_b64_tr_b16 a[14:15], v15 offset:2048
s_waitcnt vmcnt(0)
L_o15_chk:
v_max3_u32 v2, v104, v108, v112
v_max_u32 v2, v2, v116
v_cmp_eq_u32 vcc, -1, v2
s_cbranch_vccnz L_o15_rt
L_o15_ok:
s_waitcnt lgkmcnt(0)
v_mfma_f32_16x16x32_bf16 v[24:27], a[0:3], v[104:107], v[24:27]
ds_read_b64_tr_b16 a[16:17], v12 offset:4096
v_mfma_f32_16x16x32_bf16 v[40:43], a[0:3], v[108:111], v[40:43]
ds_read_b64_tr_b16 a[18:19], v12 offset:6144
v_mfma_f32_16x16x32_bf16 v[28:31], a[4:7], v[104:107], v[28:31]
ds_read_b64_tr_b16 a[20:21], v13 offset:4096
v_mfma_f32_16x16x32_bf16 v[44:47], a[4:7], v[108:111], v[44:47]
ds_read_b64_tr_b16 a[22:23], v13 offset:6144
v_mfma_f32_16x16x32_bf16 v[32:35], a[8:11], v[104:107], v[32:35]
ds_read_b64_tr_b16 a[24:25], v14 offset:4096
v_mfma_f32_16x16x32_bf16 v[48:51], a[8:11], v[108:111], v[48:51]
ds_read_b64_tr_b16 a[26:27], v14 offset:6144
v_mfma_f32_16x16x32_bf16 v[36:39], a[12:15], v[104:107], v[36:39]
ds_read_b64_tr_b16 a[28:29], v15 offset:4096
v_mfma_f32_16x16x32_bf16 v[52:55], a[12:15], v[108:111], v[52:55]
ds_read_b64_tr_b16 a[30:31], v15 offset:6144
s_waitcnt lgkmcnt(0)
v_mfma_f32_16x16x32_bf16 v[24:27], a[16:19], v[112:115], v[24:27]
v_mfma_f32_16x16x32_bf16 v[40:43], a[16:19], v[116:119], v[40:43]
v_mfma_f32_16x16x32_bf16 v[28:31], a[20:23], v[112:115], v[28:31]
v_mfma_f32_16x16x32_bf16 v[44:47], a[20:23], v[116:119], v[44:47]
v_mfma_f32_16x16x32_bf16 v[32:35], a[24:27], v[112:115], v[32:35]
v_mfma_f32_16x16x32_bf16 v[48:51], a[24:27], v[116:119], v[48:51]
v_mfma_f32_16x16x32_bf16 v[36:39], a[28:31], v[112:115], v[36:39]
v_mfma_f32_16x16x32_bf16 v[52:55], a[28:31], v[116:119], v[52:55]
s_barrier
v_accvgpr_read_b32 v88, a96
v_accvgpr_read_b32 v89, a97
v_accvgpr_read_b32 v90, a98
v_accvgpr_read_b32 v91, a99
v_accvgpr_read_b32 v92, a100
v_accvgpr_read_b32 v93, a101
v_accvgpr_read_b32 v94, a102
v_accvgpr_read_b32 v95, a103
v_lshlrev_b32 v56, 16, v88
v_and_b32 v57, 0xffff0000, v88
v_lshlrev_b32 v58, 16, v89
v_and_b32 v59, 0xffff0000, v89
v_lshlrev_b32 v60, 16, v90
v_and_b32 v61, 0xffff0000, v90
v_lshlrev_b32 v62, 16, v91
v_and_b32 v63, 0xffff0000, v91
v_lshlrev_b32 v64, 16, v92
v_and_b32 v65, 0xffff0000, v92
v_lshlrev_b32 v66, 16, v93
v_and_b32 v67, 0xffff0000, v93
v_lshlrev_b32 v68, 16, v94
v_and_b32 v69, 0xffff0000, v94
v_lshlrev_b32 v70, 16, v95
v_and_b32 v71, 0xffff0000, v95
v_pk_add_f32 v[72:73], v[24:25], v[26:27]
v_pk_mul_f32 v[74:75], v[24:25], v[24:25]
v_pk_mul_f32 v[76:77], v[24:25], v[56:57]
v_pk_fma_f32 v[74:75], v[26:27], v[26:27], v[74:75]
v_pk_fma_f32 v[76:77], v[26:27], v[58:59], v[76:77]
v_pk_add_f32 v[72:73], v[72:73], v[28:29]
v_pk_fma_f32 v[74:75], v[28:29], v[28:29], v[74:75]
v_pk_fma_f32 v[76:77], v[28:29], v[60:61], v[76:77]
v_pk_add_f32 v[72:73], v[72:73], v[30:31]
v_pk_fma_f32 v[74:75], v[30:31], v[30:31], v[74:75]
v_pk_fma_f32 v[76:77], v[30:31], v[62:63], v[76:77]
v_pk_add_f32 v[72:73], v[72:73], v[32:33]
v_pk_fma_f32 v[74:75], v[32:33], v[32:33], v[74:75]
v_pk_fma_f32 v[76:77], v[32:33], v[64:65], v[76:77]
v_pk_add_f32 v[72:73], v[72:73], v[34:35]
v_pk_fma_f32 v[74:75], v[34:35], v[34:35], v[74:75]
v_pk_fma_f32 v[76:77], v[34:35], v[66:67], v[76:77]
v_pk_add_f32 v[72:73], v[72:73], v[36:37]
v_pk_fma_f32 v[74:75], v[36:37], v[36:37], v[74:75]
v_pk_fma_f32 v[76:77], v[36:37], v[68:69], v[76:77]
v_pk_add_f32 v[72:73], v[72:73], v[38:39]
v_pk_fma_f32 v[74:75], v[38:39], v[38:39], v[74:75]
v_pk_fma_f32 v[76:77], v[38:39], v[70:71], v[76:77]
v_add_f32 v72, v72, v73
v_add_f32 v73, v74, v75
v_add_f32 v74, v76, v77
v_pk_add_f32 v[80:81], v[40:41], v[42:43]
v_pk_mul_f32 v[82:83], v[40:41], v[40:41]
v_pk_mul_f32 v[84:85], v[40:41], v[56:57]
v_pk_fma_f32 v[82:83], v[42:43], v[42:43], v[82:83]
v_pk_fma_f32 v[84:85], v[42:43], v[58:59], v[84:85]
v_pk_add_f32 v[80:81], v[80:81], v[44:45]
v_pk_fma_f32 v[82:83], v[44:45], v[44:45], v[82:83]
v_pk_fma_f32 v[84:85], v[44:45], v[60:61], v[84:85]
v_pk_add_f32 v[80:81], v[80:81], v[46:47]
v_pk_fma_f32 v[82:83], v[46:47], v[46:47], v[82:83]
v_pk_fma_f32 v[84:85], v[46:47], v[62:63], v[84:85]
v_pk_add_f32 v[80:81], v[80:81], v[48:49]
v_pk_fma_f32 v[82:83], v[48:49], v[48:49], v[82:83]
v_pk_fma_f32 v[84:85], v[48:49], v[64:65], v[84:85]
v_pk_add_f32 v[80:81], v[80:81], v[50:51]
v_pk_fma_f32 v[82:83], v[50:51], v[50:51], v[82:83]
v_pk_fma_f32 v[84:85], v[50:51], v[66:67], v[84:85]
v_pk_add_f32 v[80:81], v[80:81], v[52:53]
v_pk_fma_f32 v[82:83], v[52:53], v[52:53], v[82:83]
v_pk_fma_f32 v[84:85], v[52:53], v[68:69], v[84:85]
v_pk_add_f32 v[80:81], v[80:81], v[54:55]
v_pk_fma_f32 v[82:83], v[54:55], v[54:55], v[82:83]
v_pk_fma_f32 v[84:85], v[54:55], v[70:71], v[84:85]
v_add_f32 v80, v80, v81
v_add_f32 v81, v82, v83
v_add_f32 v82, v84, v85
v_permlane32_swap_b32 v72, v80
v_permlane32_swap_b32 v73, v81
v_permlane32_swap_b32 v74, v82
v_add_f32 v72, v72, v80
v_add_f32 v73, v73, v81
v_add_f32 v74, v74, v82
v_mov_b32 v80, v72
v_mov_b32 v81, v73
v_mov_b32 v82, v74
v_permlane16_swap_b32 v72, v80
v_permlane16_swap_b32 v73, v81
v_permlane16_swap_b32 v74, v82
v_add_f32 v72, v72, v80
v_add_f32 v73, v73, v81
v_add_f32 v74, v74, v82
v_mov_b32 v75, s68
v_and_b32 v2, 15, v1
v_lshrrev_b32 v3, 5, v1
v_lshlrev_b32 v4, 4, v2
v_lshl_add_u32 v4, v3, 8, v4
s_lshl_b32 s75, s64, 15
s_lshl_b32 s70, s60, 9
s_add_u32 s75, s75, s70
s_add_u32 s75, s75, 6291456
s_lshl_b32 s70, s65, 11
s_add_u32 s72, s75, s70
s_mov_b32 s92, 0xffff
s_mov_b32 s93, 0xffff
s_mov_b64 exec, s[92:93]
s_cmp_eq_u32 s69, 0
s_cbranch_scc1 L_stp_s
buffer_store_dwordx4 v[72:75], v4, s[12:15], s72 offen
L_stp_d:
s_mov_b64 exec, -1
v_and_b32 v2, 31, v1
v_lshlrev_b32 v5, 4, v2
v_lshl_add_u32 v5, v3, 11, v5
s_add_u32 s70, s75, 0
buffer_load_dwordx4 v[96:99], v5, s[12:15], s70 offen sc1
s_add_u32 s70, s75, 4096
buffer_load_dwordx4 v[100:103], v5, s[12:15], s70 offen sc1
s_add_u32 s70, s75, 8192
buffer_load_dwordx4 v[104:107], v5, s[12:15], s70 offen sc1
s_add_u32 s70, s75, 12288
buffer_load_dwordx4 v[108:111], v5, s[12:15], s70 offen sc1
s_add_u32 s70, s75, 16384
buffer_load_dwordx4 v[112:115], v5, s[12:15], s70 offen sc1
s_add_u32 s70, s75, 20480
buffer_load_dwordx4 v[116:119], v5, s[12:15], s70 offen sc1
s_add_u32 s70, s75, 24576
buffer_load_dwordx4 v[120:123], v5, s[12:15], s70 offen sc1
s_add_u32 s70, s75, 28672
buffer_load_dwordx4 v[124:127], v5, s[12:15], s70 offen sc1
v_cvt_pk_bf16_f32 v128, v24, v25
v_cvt_pk_bf16_f32 v129, v26, v27
ds_write_b64 v20, v[128:129] offset:0
v_cvt_pk_bf16_f32 v130, v28, v29
v_cvt_pk_bf16_f32 v131, v30, v31
ds_write_b64 v21, v[130:131] offset:0
v_cvt_pk_bf16_f32 v132, v32, v33
v_cvt_pk_bf16_f32 v133, v34, v35
ds_write_b64 v22, v[132:133] offset:0
v_cvt_pk_bf16_f32 v134, v36, v37
v_cvt_pk_bf16_f32 v135, v38, v39
ds_write_b64 v23, v[134:135] offset:0
v_cvt_pk_bf16_f32 v136, v40, v41
v_cvt_pk_bf16_f32 v137, v42, v43
ds_write_b64 v20, v[136:137] offset:2048
v_cvt_pk_bf16_f32 v138, v44, v45
v_cvt_pk_bf16_f32 v139, v46, v47
ds_write_b64 v21, v[138:139] offset:2048
v_cvt_pk_bf16_f32 v140, v48, v49
v_cvt_pk_bf16_f32 v141, v50, v51
ds_write_b64 v22, v[140:141] offset:2048
v_cvt_pk_bf16_f32 v142, v52, v53
v_cvt_pk_bf16_f32 v143, v54, v55
ds_write_b64 v23, v[142:143] offset:2048
s_lshl_b32 s70, s64, 7
s_lshl_b32 s71, s60, 5
s_add_u32 s70, s70, s71
s_sub_u32 s70, 2047, s70
v_sub_u32 v6, s70, v2
s_lshl_b32 s70, s60, 9
s_add_u32 s70, s70, 49152
v_lshlrev_b32 v7, 4, v2
v_add_u32 v7, s70, v7
s_waitcnt vmcnt(0)
L_st_chk:
v_xor_b32 v88, s68, v99
v_xor_b32 v89, s68, v103
v_xor_b32 v90, s68, v107
v_xor_b32 v91, s68, v111
v_xor_b32 v92, s68, v115
v_xor_b32 v93, s68, v119
v_xor_b32 v94, s68, v123
v_xor_b32 v95, s68, v127
v_or3_b32 v88, v88, v89, v90
v_or3_b32 v91, v91, v92, v93
v_or3_b32 v88, v88, v94, v95
v_or_b32 v88, v88, v91
v_cmp_ne_u32 vcc, 0, v88
s_cbranch_vccnz L_st_rt
L_st_ok:
v_pk_add_f32 v[96:97], v[96:97], v[100:101]
v_add_f32 v98, v98, v102
v_pk_add_f32 v[104:105], v[104:105], v[108:109]
v_add_f32 v106, v106, v110
v_pk_add_f32 v[112:113], v[112:113], v[116:117]
v_add_f32 v114, v114, v118
v_pk_add_f32 v[120:121], v[120:121], v[124:125]
v_add_f32 v122, v122, v126
v_pk_add_f32 v[96:97], v[96:97], v[104:105]
v_add_f32 v98, v98, v106
v_pk_add_f32 v[112:113], v[112:113], v[120:121]
v_add_f32 v114, v114, v122
v_pk_add_f32 v[96:97], v[96:97], v[112:113]
v_add_f32 v98, v98, v114
v_mov_b32 v100, v96
v_mov_b32 v101, v97
v_mov_b32 v102, v98
v_permlane32_swap_b32 v96, v100
v_permlane32_swap_b32 v97, v101
v_permlane32_swap_b32 v98, v102
v_add_f32 v96, v96, v100
v_add_f32 v97, v97, v101
v_add_f32 v98, v98, v102
v_mul_f32 v73, 0x3a800000, v96
v_mul_f32 v97, 0x3a800000, v97
v_fma_f32 v97, -v73, v73, v97
v_fma_f32 v98, -v73, s84, v98
v_max_f32 v97, 0, v97
v_add_f32 v97, 0x3727c5ac, v97
v_rsq_f32 v74, v97
v_mov_b32 v75, s68
v_mul_f32 v98, v98, v74
v_ashrrev_i32 v99, 31, v98
v_or_b32 v99, 0x80000000, v99
v_xor_b32 v98, v98, v99
s_mov_b32 s70, 0xfffff800
v_and_or_b32 v72, v98, s70, v6
ds_write_b128 v7, v[72:75]
s_nop 0
v_mov_b32_dpp v78, v72 row_ror:1 row_mask:0xf bank_mask:0xf
v_max_u32 v76, v72, v78
v_min_u32 v77, v72, v78
s_nop 0
v_mov_b32_dpp v78, v76 row_ror:2 row_mask:0xf bank_mask:0xf
v_max_u32_dpp v79, v77, v77 row_ror:2 row_mask:0xf bank_mask:0xf
v_med3_u32 v77, v76, v78, v79
v_max_u32 v76, v76, v78
s_nop 1
v_mov_b32_dpp v78, v76 row_ror:4 row_mask:0xf bank_mask:0xf
v_max_u32_dpp v79, v77, v77 row_ror:4 row_mask:0xf bank_mask:0xf
v_med3_u32 v77, v76, v78, v79
v_max_u32 v76, v76, v78
s_nop 1
v_mov_b32_dpp v78, v76 row_ror:8 row_mask:0xf bank_mask:0xf
v_max_u32_dpp v79, v77, v77 row_ror:8 row_mask:0xf bank_mask:0xf
v_med3_u32 v77, v76, v78, v79
v_max_u32 v76, v76, v78
v_mov_b32 v78, v76
v_mov_b32 v79, v77
s_nop 0
v_permlane16_swap_b32 v76, v78
v_permlane16_swap_b32 v77, v79
v_max_u32 v79, v77, v79
v_med3_u32 v77, v76, v78, v79
v_max_u32 v76, v76, v78
s_lshl_b32 s70, s60, 3
s_add_u32 s70, s70, 161792
v_mov_b32 v2, s70
ds_write_b64 v2, v[76:77]
v_mov_b32 v2, 161792
v_add_f32 v80, 1.0, v74
v_mul_f32_e64 v56, -v73, v74
v_mov_b32 v82, v80
v_mov_b32 v58, v56
s_nop 0
v_permlane16_swap_b32 v80, v82
v_permlane16_swap_b32 v56, v58
s_waitcnt lgkmcnt(0)
s_barrier
ds_read_b128 v[88:91], v2
ds_read_b128 v[92:95], v2 offset:16
s_waitcnt lgkmcnt(0)
v_max_u32 v89, v89, v91
v_max_u32 v93, v93, v95
v_med3_u32 v89, v88, v90, v89
v_med3_u32 v93, v92, v94, v93
v_max_u32 v88, v88, v90
v_max_u32 v92, v92, v94
v_max_u32 v89, v89, v93
v_med3_u32 v89, v88, v92, v89
v_max_u32 v88, v88, v92
v_readfirstlane_b32 s86, v89
v_readfirstlane_b32 s85, v88
s_not_b32 s95, s86
s_and_b32 s95, s95, 127
s_not_b32 s94, s85
s_and_b32 s94, s94, 127
s_cmp_lg_u32 s60, 0
s_cbranch_scc1 L_nocand
v_mov_b32 v2, s94
v_mov_b32 v3, s95
v_and_b32 v4, 8, v1
v_cmp_ne_u32 vcc, 0, v4
s_nop 1
v_cndmask_b32 v5, v2, v3, vcc
v_bfe_u32 v6, v5, 1, 3
v_and_b32 v7, 7, v1
v_xor_b32 v6, v6, v7
v_lshlrev_b32 v6, 4, v6
v_lshl_add_u32 v6, v5, 7, v6
ds_read_b128 v[88:91], v6
v_cmp_eq_u32 vcc, 1, v1
s_nop 1
v_cndmask_b32 v5, v2, v3, vcc
v_lshlrev_b32 v5, 4, v5
v_add_u32 v5, 49152, v5
ds_read_b128 v[92:95], v5
v_lshlrev_b32 v4, 8, v4
v_lshl_add_u32 v4, v7, 4, v4
s_lshl_b32 s70, s64, 12
s_lshl_b32 s71, s65, 7
s_add_u32 s70, s70, s71
s_add_u32 s70, s70, 6881280
s_lshl_b32 s71, s64, 7
s_add_u32 s71, s71, 6815744
s_mov_b64 exec, 0xffff
s_waitcnt lgkmcnt(1)
buffer_store_dwordx4 v[88:91], v4, s[12:15], s70 offen sc1
s_cmp_lg_u32 s64, s65
s_cbranch_scc1 L_norec
s_mov_b64 exec, 3
s_waitcnt lgkmcnt(0)
buffer_store_dwordx4 v[92:95], v16, s[12:15], s71 offen sc1
L_norec:
s_mov_b64 exec, -1
L_nocand:
v_bfe_u32 v8, v1, 1, 4
v_lshlrev_b32 v8, 7, v8
v_and_b32 v2, 1, v1
v_lshl_add_u32 v8, v2, 4, v8
s_mov_b32 s75, 6815744
v_pk_fma_f32 v[24:25], v[24:25], v[80:81], v[56:57] op_sel_hi:[1,0,0]
v_pk_fma_f32 v[26:27], v[26:27], v[80:81], v[56:57] op_sel_hi:[1,0,0]
v_cvt_pk_bf16_f32 v128, v24, v25
v_cvt_pk_bf16_f32 v129, v26, v27
ds_write_b64 v20, v[128:129] offset:32768
v_pk_fma_f32 v[28:29], v[28:29], v[80:81], v[56:57] op_sel_hi:[1,0,0]
v_pk_fma_f32 v[30:31], v[30:31], v[80:81], v[56:57] op_sel_hi:[1,0,0]
v_cvt_pk_bf16_f32 v130, v28, v29
v_cvt_pk_bf16_f32 v131, v30, v31
ds_write_b64 v21, v[130:131] offset:32768
v_pk_fma_f32 v[32:33], v[32:33], v[80:81], v[56:57] op_sel_hi:[1,0,0]
v_pk_fma_f32 v[34:35], v[34:35], v[80:81], v[56:57] op_sel_hi:[1,0,0]
v_cvt_pk_bf16_f32 v132, v32, v33
v_cvt_pk_bf16_f32 v133, v34, v35
ds_write_b64 v22, v[132:133] offset:32768
v_pk_fma_f32 v[36:37], v[36:37], v[80:81], v[56:57] op_sel_hi:[1,0,0]
v_pk_fma_f32 v[38:39], v[38:39], v[80:81], v[56:57] op_sel_hi:[1,0,0]
v_cvt_pk_bf16_f32 v134, v36, v37
v_cvt_pk_bf16_f32 v135, v38, v39
ds_write_b64 v23, v[134:135] offset:32768
v_pk_fma_f32 v[40:41], v[40:41], v[82:83], v[58:59] op_sel_hi:[1,0,0]
v_pk_fma_f32 v[42:43], v[42:43], v[82:83], v[58:59] op_sel_hi:[1,0,0]
v_cvt_pk_bf16_f32 v136, v40, v41
v_cvt_pk_bf16_f32 v137, v42, v43
ds_write_b64 v20, v[136:137] offset:34816
v_pk_fma_f32 v[44:45], v[44:45], v[82:83], v[58:59] op_sel_hi:[1,0,0]
v_pk_fma_f32 v[46:47], v[46:47], v[82:83], v[58:59] op_sel_hi:[1,0,0]
v_cvt_pk_bf16_f32 v138, v44, v45
v_cvt_pk_bf16_f32 v139, v46, v47
ds_write_b64 v21, v[138:139] offset:34816
v_pk_fma_f32 v[48:49], v[48:49], v[82:83], v[58:59] op_sel_hi:[1,0,0]
v_pk_fma_f32 v[50:51], v[50:51], v[82:83], v[58:59] op_sel_hi:[1,0,0]
v_cvt_pk_bf16_f32 v140, v48, v49
v_cvt_pk_bf16_f32 v141, v50, v51
ds_write_b64 v22, v[140:141] offset:34816
v_pk_fma_f32 v[52:53], v[52:53], v[82:83], v[58:59] op_sel_hi:[1,0,0]
v_pk_fma_f32 v[54:55], v[54:55], v[82:83], v[58:59] op_sel_hi:[1,0,0]
v_cvt_pk_bf16_f32 v142, v52, v53
v_cvt_pk_bf16_f32 v143, v54, v55
ds_write_b64 v23, v[142:143] offset:34816
v_lshrrev_b32 v2, 3, v1
v_lshrrev_b32 v3, 4, v1
v_and_b32 v4, 7, v1
v_xor_b32 v3, v3, v4
v_lshlrev_b32 v3, 4, v3
v_lshl_add_u32 v3, v2, 7, v3
s_lshl_b32 s70, s60, 12
v_add_u32 v9, s70, v3
v_xor_b32 v10, 64, v9
v_lshlrev_b32 v11, 11, v2
v_lshl_add_u32 v11, v4, 4, v11
s_lshl_b32 s70, s60, 5
v_add_u32 v12, s70, v2
s_lshl_b32 s87, s64, 18
s_lshl_b32 s70, s60, 16
s_add_u32 s87, s87, s70
s_lshl_b32 s70, s65, 7
s_add_u32 s87, s87, s70
s_waitcnt lgkmcnt(0)
ds_read_b128 v[96:99], v9 offset:32768
ds_read_b128 v[100:103], v10 offset:33792
ds_read_b128 v[104:107], v9 offset:34816
ds_read_b128 v[108:111], v10 offset:35840
v_add_u32 v2, 0, v12
v_cmp_ne_u32 vcc, s94, v2
v_cmp_ne_u32_e64 s[92:93], s95, v2
s_add_u32 s70, s87, 0
s_waitcnt lgkmcnt(3)
s_and_b64 exec, vcc, s[92:93]
buffer_store_dwordx4 v[96:99], v11, s[20:23], s70 offen
s_mov_b64 exec, -1
v_add_u32 v2, 8, v12
v_cmp_ne_u32 vcc, s94, v2
v_cmp_ne_u32_e64 s[92:93], s95, v2
s_add_u32 s70, s87, 16384
s_waitcnt lgkmcnt(2)
s_and_b64 exec, vcc, s[92:93]
buffer_store_dwordx4 v[100:103], v11, s[20:23], s70 offen
s_mov_b64 exec, -1
v_add_u32 v2, 16, v12
v_cmp_ne_u32 vcc, s94, v2
v_cmp_ne_u32_e64 s[92:93], s95, v2
s_add_u32 s70, s87, 32768
s_waitcnt lgkmcnt(1)
s_and_b64 exec, vcc, s[92:93]
buffer_store_dwordx4 v[104:107], v11, s[20:23], s70 offen
s_mov_b64 exec, -1
v_add_u32 v2, 24, v12
v_cmp_ne_u32 vcc, s94, v2
v_cmp_ne_u32_e64 s[92:93], s95, v2
s_add_u32 s70, s87, 49152
s_waitcnt lgkmcnt(0)
s_and_b64 exec, vcc, s[92:93]
buffer_store_dwordx4 v[108:111], v11, s[20:23], s70 offen
s_mov_b64 exec, -1
s_cmp_lg_u32 s60, 1
s_cbranch_scc1 L_nopick
buffer_load_dwordx4 v[84:87], v8, s[12:15], s75 offen sc1
s_waitcnt vmcnt(0)
L_rec_chk:
v_cmp_ne_u32 vcc, s68, v87
s_cbranch_vccnz L_rec_rt
L_rec_ok:
v_mov_b32_dpp v78, v84 row_ror:1 row_mask:0xf bank_mask:0xf
v_max_u32 v76, v84, v78
v_min_u32 v77, v84, v78
s_nop 0
v_mov_b32_dpp v78, v76 row_ror:2 row_mask:0xf bank_mask:0xf
v_max_u32_dpp v79, v77, v77 row_ror:2 row_mask:0xf bank_mask:0xf
v_med3_u32 v77, v76, v78, v79
v_max_u32 v76, v76, v78
s_nop 1
v_mov_b32_dpp v78, v76 row_ror:4 row_mask:0xf bank_mask:0xf
v_max_u32_dpp v79, v77, v77 row_ror:4 row_mask:0xf bank_mask:0xf
v_med3_u32 v77, v76, v78, v79
v_max_u32 v76, v76, v78
s_nop 1
v_mov_b32_dpp v78, v76 row_ror:8 row_mask:0xf bank_mask:0xf
v_max_u32_dpp v79, v77, v77 row_ror:8 row_mask:0xf bank_mask:0xf
v_med3_u32 v77, v76, v78, v79
v_max_u32 v76, v76, v78
v_mov_b32 v78, v76
v_mov_b32 v79, v77
s_nop 0
v_permlane16_swap_b32 v76, v78
v_permlane16_swap_b32 v77, v79
v_max_u32 v79, v77, v79
v_med3_u32 v77, v76, v78, v79
v_max_u32 v76, v76, v78
v_cmp_eq_u32 vcc, v84, v77
v_cmp_eq_u32_e64 s[92:93], v84, v76
v_and_b32 v87, 31, v1
v_mov_b32 v2, 161856
v_mov_b32 v3, 161872
v_cndmask_b32 v2, v2, v3, vcc
s_or_b64 exec, vcc, s[92:93]
ds_write_b128 v2, v[84:87]
s_mov_b64 exec, -1
s_cmp_lg_u32 s2, 0
s_cbranch_scc1 L_nopick
v_mov_b32 v2, s68
v_mov_b32 v3, 0
s_mov_b64 exec, 1
buffer_store_dword v2, v3, s[12:15], 0 offen sc1
s_mov_b64 exec, -1
L_nopick:
v_mov_b32 v2, 161856
s_waitcnt lgkmcnt(0)
s_barrier
ds_read_b32 v3, v2
ds_read_b32 v4, v2 offset:16
s_waitcnt lgkmcnt(0)
v_readfirstlane_b32 s72, v3
v_readfirstlane_b32 s73, v4
s_cmp_eq_u32 s85, s72
s_cselect_b32 s94, 255, s94
s_cmp_eq_u32 s85, s73
s_cselect_b32 s94, 255, s94
s_cmp_eq_u32 s86, s72
s_cselect_b32 s95, 255, s95
s_cmp_eq_u32 s86, s73
s_cselect_b32 s95, 255, s95
v_add_u32 v2, 0, v12
v_cmp_eq_u32 vcc, s94, v2
v_cmp_eq_u32_e64 s[92:93], s95, v2
s_add_u32 s70, s87, 0
s_or_b64 exec, vcc, s[92:93]
s_cbranch_execz L_nodef0
buffer_store_dwordx4 v[96:99], v11, s[20:23], s70 offen
L_nodef0:
s_mov_b64 exec, -1
v_add_u32 v2, 8, v12
v_cmp_eq_u32 vcc, s94, v2
v_cmp_eq_u32_e64 s[92:93], s95, v2
s_add_u32 s70, s87, 16384
s_or_b64 exec, vcc, s[92:93]
s_cbranch_execz L_nodef1
buffer_store_dwordx4 v[100:103], v11, s[20:23], s70 offen
L_nodef1:
s_mov_b64 exec, -1
v_add_u32 v2, 16, v12
v_cmp_eq_u32 vcc, s94, v2
v_cmp_eq_u32_e64 s[92:93], s95, v2
s_add_u32 s70, s87, 32768
s_or_b64 exec, vcc, s[92:93]
s_cbranch_execz L_nodef2
buffer_store_dwordx4 v[104:107], v11, s[20:23], s70 offen
L_nodef2:
s_mov_b64 exec, -1
v_add_u32 v2, 24, v12
v_cmp_eq_u32 vcc, s94, v2
v_cmp_eq_u32_e64 s[92:93], s95, v2
s_add_u32 s70, s87, 49152
s_or_b64 exec, vcc, s[92:93]
s_cbranch_execz L_nodef3
buffer_store_dwordx4 v[108:111], v11, s[20:23], s70 offen
L_nodef3:
s_mov_b64 exec, -1
L_end:
s_endpgm
L_eg_rt:
s_add_u32 s78, s78, 1
s_cmp_gt_u32 s78, 65536
s_cbranch_scc1 L_eg_ok
s_add_u32 s70, s87, 0
buffer_load_dwordx4 v[20:23], v44, s[12:15], s70 offen sc1
s_add_u32 s70, s87, 4096
buffer_load_dwordx4 v[24:27], v44, s[12:15], s70 offen sc1
s_add_u32 s70, s87, 8192
buffer_load_dwordx4 v[28:31], v44, s[12:15], s70 offen sc1
s_add_u32 s70, s87, 12288
buffer_load_dwordx4 v[32:35], v44, s[12:15], s70 offen sc1
buffer_load_dwordx4 v[36:39], v45, s[12:15], s88 offen sc1
buffer_load_dwordx4 v[40:43], v46, s[12:15], 0 offen offset:0 sc1
s_waitcnt vmcnt(0)
s_branch L_eg_chk
L_kv0_rt:
s_add_u32 s78, s78, 1
s_cmp_gt_u32 s78, 65536
s_cbranch_scc1 L_kv0_ok
s_add_u32 s70, s65, 1
s_and_b32 s70, s70, 15
s_mul_i32 s70, s70, 4352
s_add_u32 s70, s70, s87
buffer_load_dwordx4 v[84:87], v18, s[12:15], s70 offen sc1
s_add_u32 s70, s65, 2
s_and_b32 s70, s70, 15
s_mul_i32 s70, s70, 4352
s_add_u32 s70, s70, s87
buffer_load_dwordx4 v[88:91], v18, s[12:15], s70 offen sc1
s_add_u32 s70, s65, 3
s_and_b32 s70, s70, 15
s_mul_i32 s70, s70, 4352
s_add_u32 s70, s70, s87
buffer_load_dwordx4 v[92:95], v18, s[12:15], s70 offen sc1
s_add_u32 s70, s65, 4
s_and_b32 s70, s70, 15
s_mul_i32 s70, s70, 4352
s_add_u32 s70, s70, s87
buffer_load_dwordx4 v[96:99], v18, s[12:15], s70 offen sc1
s_waitcnt vmcnt(0)
s_branch L_kv0_chk
L_kv1_rt:
s_add_u32 s78, s78, 1
s_cmp_gt_u32 s78, 65536
s_cbranch_scc1 L_kv1_ok
s_add_u32 s70, s65, 5
s_and_b32 s70, s70, 15
s_mul_i32 s70, s70, 4352
s_add_u32 s70, s70, s87
buffer_load_dwordx4 v[100:103], v18, s[12:15], s70 offen sc1
s_add_u32 s70, s65, 6
s_and_b32 s70, s70, 15
s_mul_i32 s70, s70, 4352
s_add_u32 s70, s70, s87
buffer_load_dwordx4 v[104:107], v18, s[12:15], s70 offen sc1
s_add_u32 s70, s65, 7
s_and_b32 s70, s70, 15
s_mul_i32 s70, s70, 4352
s_add_u32 s70, s70, s87
buffer_load_dwordx4 v[108:111], v18, s[12:15], s70 offen sc1
s_add_u32 s70, s65, 8
s_and_b32 s70, s70, 15
s_mul_i32 s70, s70, 4352
s_add_u32 s70, s70, s87
buffer_load_dwordx4 v[112:115], v18, s[12:15], s70 offen sc1
s_waitcnt vmcnt(0)
s_branch L_kv1_chk
L_kv2_rt:
s_add_u32 s78, s78, 1
s_cmp_gt_u32 s78, 65536
s_cbranch_scc1 L_kv2_ok
s_add_u32 s70, s65, 9
s_and_b32 s70, s70, 15
s_mul_i32 s70, s70, 4352
s_add_u32 s70, s70, s87
buffer_load_dwordx4 v[116:119], v18, s[12:15], s70 offen sc1
s_add_u32 s70, s65, 10
s_and_b32 s70, s70, 15
s_mul_i32 s70, s70, 4352
s_add_u32 s70, s70, s87
buffer_load_dwordx4 v[120:123], v18, s[12:15], s70 offen sc1
s_add_u32 s70, s65, 11
s_and_b32 s70, s70, 15
s_mul_i32 s70, s70, 4352
s_add_u32 s70, s70, s87
buffer_load_dwordx4 v[124:127], v18, s[12:15], s70 offen sc1
s_add_u32 s70, s65, 12
s_and_b32 s70, s70, 15
s_mul_i32 s70, s70, 4352
s_add_u32 s70, s70, s87
buffer_load_dwordx4 v[128:131], v18, s[12:15], s70 offen sc1
s_waitcnt vmcnt(0)
s_branch L_kv2_chk
L_kv3_rt:
s_add_u32 s78, s78, 1
s_cmp_gt_u32 s78, 65536
s_cbranch_scc1 L_kv3_ok
s_add_u32 s70, s65, 13
s_and_b32 s70, s70, 15
s_mul_i32 s70, s70, 4352
s_add_u32 s70, s70, s87
buffer_load_dwordx4 v[132:135], v18, s[12:15], s70 offen sc1
s_add_u32 s70, s65, 14
s_and_b32 s70, s70, 15
s_mul_i32 s70, s70, 4352
s_add_u32 s70, s70, s87
buffer_load_dwordx4 v[136:139], v18, s[12:15], s70 offen sc1
s_add_u32 s70, s65, 15
s_and_b32 s70, s70, 15
s_mul_i32 s70, s70, 4352
s_add_u32 s70, s70, s87
buffer_load_dwordx4 v[140:143], v18, s[12:15], s70 offen sc1
s_add_u32 s70, s65, 16
s_and_b32 s70, s70, 15
s_mul_i32 s70, s70, 4352
s_add_u32 s70, s70, s87
buffer_load_dwordx4 v[144:147], v18, s[12:15], s70 offen sc1
s_waitcnt vmcnt(0)
s_branch L_kv3_chk
L_z_rt:
s_add_u32 s78, s78, 1
s_cmp_gt_u32 s78, 65536
s_cbranch_scc1 L_z_ok
buffer_load_dwordx4 v[148:151], v55, s[12:15], s88 offen sc1
s_waitcnt vmcnt(0)
s_branch L_z_chk
L_x_rt:
s_add_u32 s78, s78, 1
s_cmp_gt_u32 s78, 65536
s_cbranch_scc1 L_x_ok
buffer_load_dwordx4 v[24:27], v57, s[12:15], 0 offen offset:0 sc1
buffer_load_dwordx4 v[28:31], v57, s[12:15], 0 offen offset:64 sc1
buffer_load_dwordx4 v[32:35], v57, s[12:15], 0 offen offset:128 sc1
buffer_load_dwordx4 v[36:39], v57, s[12:15], 0 offen offset:192 sc1
buffer_load_dwordx4 v[40:43], v57, s[12:15], 0 offen offset:256 sc1
buffer_load_dwordx4 v[44:47], v57, s[12:15], 0 offen offset:320 sc1
buffer_load_dwordx4 v[48:51], v57, s[12:15], 0 offen offset:384 sc1
buffer_load_dwordx4 v[52:55], v57, s[12:15], 0 offen offset:448 sc1
s_waitcnt vmcnt(0)
s_branch L_x_chk
L_pxp_s:
buffer_store_dwordx4 v[68:71], v58, s[12:15], s85 offen offset:0 sc1
buffer_store_dwordx4 v[72:75], v58, s[12:15], s85 offen offset:128 sc1
s_branch L_pxp_d
L_px_rt:
s_add_u32 s78, s78, 1
s_cmp_gt_u32 s78, 65536
s_cbranch_scc1 L_px_ok
buffer_load_dwordx4 v[24:27], v58, s[12:15], s86 offen offset:0 sc1
buffer_load_dwordx4 v[28:31], v58, s[12:15], s86 offen offset:256 sc1
buffer_load_dwordx4 v[32:35], v58, s[12:15], s86 offen offset:512 sc1
buffer_load_dwordx4 v[36:39], v58, s[12:15], s86 offen offset:768 sc1
s_waitcnt vmcnt(0)
s_branch L_px_chk
L_y_rt:
s_add_u32 s78, s78, 1
s_cmp_gt_u32 s78, 65536
s_cbranch_scc1 L_y_ok
buffer_load_ushort v61, v64, s[12:15], s72 offen sc1
s_add_u32 s70, s87, 0
buffer_load_dwordx4 v[24:27], v62, s[12:15], s70 offen sc1
s_add_u32 s70, s87, 65536
buffer_load_dwordx4 v[28:31], v62, s[12:15], s70 offen sc1
s_add_u32 s70, s87, 131072
buffer_load_dwordx4 v[32:35], v62, s[12:15], s70 offen sc1
s_add_u32 s70, s87, 196608
buffer_load_dwordx4 v[36:39], v62, s[12:15], s70 offen sc1
s_add_u32 s70, s87, 262144
buffer_load_dwordx4 v[40:43], v62, s[12:15], s70 offen sc1
s_add_u32 s70, s87, 327680
buffer_load_dwordx4 v[44:47], v62, s[12:15], s70 offen sc1
s_add_u32 s70, s87, 393216
buffer_load_dwordx4 v[48:51], v62, s[12:15], s70 offen sc1
s_waitcnt vmcnt(0)
s_branch L_y_chk
L_ex1:
ds_write_b128 v2, v[64:67]
ds_write_b128 v2, v[72:75] offset:1024
ds_write_b128 v5, v[20:23]
s_waitcnt lgkmcnt(0)
s_barrier
ds_read_b128 v[128:131], v3
ds_read_b128 v[132:135], v3 offset:1024
ds_read_b128 v[136:139], v6
s_waitcnt lgkmcnt(1)
v_pk_add_f32 v[128:129], v[128:129], v[68:69]
v_pk_add_f32 v[130:131], v[130:131], v[70:71]
v_pk_add_f32 v[132:133], v[132:133], v[76:77]
v_pk_add_f32 v[134:135], v[134:135], v[78:79]
s_waitcnt lgkmcnt(0)
v_pk_add_f32 v[136:137], v[136:137], v[24:25]
v_pk_add_f32 v[138:139], v[138:139], v[26:27]
s_branch L_ex_d
L_kvp_s:
buffer_store_dwordx4 v[140:143], v16, s[12:15], s72 offen sc1
s_mov_b64 exec, s[92:93]
buffer_store_dwordx4 v[136:139], v4, s[12:15], s73 offen sc1
s_mov_b64 exec, -1
s_branch L_kvp_d
L_o0_rt:
s_add_u32 s78, s78, 1
s_cmp_gt_u32 s78, 65536
s_cbranch_scc1 L_o0_ok
s_add_u32 s70, s65, 0
s_and_b32 s70, s70, 15
s_lshl_b32 s70, s70, 11
s_add_u32 s70, s70, s74
buffer_load_dwordx4 v[56:59], v16, s[12:15], s70 offen offset:0 sc1
buffer_load_dwordx4 v[60:63], v19, s[12:15], s70 offen offset:0 sc1
buffer_load_dwordx4 v[64:67], v16, s[12:15], s70 offen offset:1024 sc1
buffer_load_dwordx4 v[68:71], v19, s[12:15], s70 offen offset:1024 sc1
s_waitcnt vmcnt(0)
s_branch L_o0_chk
L_o1_rt:
s_add_u32 s78, s78, 1
s_cmp_gt_u32 s78, 65536
s_cbranch_scc1 L_o1_ok
s_add_u32 s70, s65, 1
s_and_b32 s70, s70, 15
s_lshl_b32 s70, s70, 11
s_add_u32 s70, s70, s74
buffer_load_dwordx4 v[72:75], v16, s[12:15], s70 offen offset:0 sc1
buffer_load_dwordx4 v[76:79], v19, s[12:15], s70 offen offset:0 sc1
buffer_load_dwordx4 v[80:83], v16, s[12:15], s70 offen offset:1024 sc1
buffer_load_dwordx4 v[84:87], v19, s[12:15], s70 offen offset:1024 sc1
s_waitcnt vmcnt(0)
s_branch L_o1_chk
L_o2_rt:
s_add_u32 s78, s78, 1
s_cmp_gt_u32 s78, 65536
s_cbranch_scc1 L_o2_ok
s_add_u32 s70, s65, 2
s_and_b32 s70, s70, 15
s_lshl_b32 s70, s70, 11
s_add_u32 s70, s70, s74
buffer_load_dwordx4 v[88:91], v16, s[12:15], s70 offen offset:0 sc1
buffer_load_dwordx4 v[92:95], v19, s[12:15], s70 offen offset:0 sc1
buffer_load_dwordx4 v[96:99], v16, s[12:15], s70 offen offset:1024 sc1
buffer_load_dwordx4 v[100:103], v19, s[12:15], s70 offen offset:1024 sc1
s_waitcnt vmcnt(0)
s_branch L_o2_chk
L_o3_rt:
s_add_u32 s78, s78, 1
s_cmp_gt_u32 s78, 65536
s_cbranch_scc1 L_o3_ok
s_add_u32 s70, s65, 3
s_and_b32 s70, s70, 15
s_lshl_b32 s70, s70, 11
s_add_u32 s70, s70, s74
buffer_load_dwordx4 v[104:107], v16, s[12:15], s70 offen offset:0 sc1
buffer_load_dwordx4 v[108:111], v19, s[12:15], s70 offen offset:0 sc1
buffer_load_dwordx4 v[112:115], v16, s[12:15], s70 offen offset:1024 sc1
buffer_load_dwordx4 v[116:119], v19, s[12:15], s70 offen offset:1024 sc1
s_waitcnt vmcnt(0)
s_branch L_o3_chk
L_o4_rt:
s_add_u32 s78, s78, 1
s_cmp_gt_u32 s78, 65536
s_cbranch_scc1 L_o4_ok
s_add_u32 s70, s65, 4
s_and_b32 s70, s70, 15
s_lshl_b32 s70, s70, 11
s_add_u32 s70, s70, s74
buffer_load_dwordx4 v[120:123], v16, s[12:15], s70 offen offset:0 sc1
buffer_load_dwordx4 v[124:127], v19, s[12:15], s70 offen offset:0 sc1
buffer_load_dwordx4 v[128:131], v16, s[12:15], s70 offen offset:1024 sc1
buffer_load_dwordx4 v[132:135], v19, s[12:15], s70 offen offset:1024 sc1
s_waitcnt vmcnt(0)
s_branch L_o4_chk
L_o5_rt:
s_add_u32 s78, s78, 1
s_cmp_gt_u32 s78, 65536
s_cbranch_scc1 L_o5_ok
s_add_u32 s70, s65, 5
s_and_b32 s70, s70, 15
s_lshl_b32 s70, s70, 11
s_add_u32 s70, s70, s74
buffer_load_dwordx4 v[136:139], v16, s[12:15], s70 offen offset:0 sc1
buffer_load_dwordx4 v[140:143], v19, s[12:15], s70 offen offset:0 sc1
buffer_load_dwordx4 v[144:147], v16, s[12:15], s70 offen offset:1024 sc1
buffer_load_dwordx4 v[148:151], v19, s[12:15], s70 offen offset:1024 sc1
s_waitcnt vmcnt(0)
s_branch L_o5_chk
L_o6_rt:
s_add_u32 s78, s78, 1
s_cmp_gt_u32 s78, 65536
s_cbranch_scc1 L_o6_ok
s_add_u32 s70, s65, 6
s_and_b32 s70, s70, 15
s_lshl_b32 s70, s70, 11
s_add_u32 s70, s70, s74
buffer_load_dwordx4 v[56:59], v16, s[12:15], s70 offen offset:0 sc1
buffer_load_dwordx4 v[60:63], v19, s[12:15], s70 offen offset:0 sc1
buffer_load_dwordx4 v[64:67], v16, s[12:15], s70 offen offset:1024 sc1
buffer_load_dwordx4 v[68:71], v19, s[12:15], s70 offen offset:1024 sc1
s_waitcnt vmcnt(0)
s_branch L_o6_chk
L_o7_rt:
s_add_u32 s78, s78, 1
s_cmp_gt_u32 s78, 65536
s_cbranch_scc1 L_o7_ok
s_add_u32 s70, s65, 7
s_and_b32 s70, s70, 15
s_lshl_b32 s70, s70, 11
s_add_u32 s70, s70, s74
buffer_load_dwordx4 v[72:75], v16, s[12:15], s70 offen offset:0 sc1
buffer_load_dwordx4 v[76:79], v19, s[12:15], s70 offen offset:0 sc1
buffer_load_dwordx4 v[80:83], v16, s[12:15], s70 offen offset:1024 sc1
buffer_load_dwordx4 v[84:87], v19, s[12:15], s70 offen offset:1024 sc1
s_waitcnt vmcnt(0)
s_branch L_o7_chk
L_o8_rt:
s_add_u32 s78, s78, 1
s_cmp_gt_u32 s78, 65536
s_cbranch_scc1 L_o8_ok
s_add_u32 s70, s65, 8
s_and_b32 s70, s70, 15
s_lshl_b32 s70, s70, 11
s_add_u32 s70, s70, s74
buffer_load_dwordx4 v[88:91], v16, s[12:15], s70 offen offset:0 sc1
buffer_load_dwordx4 v[92:95], v19, s[12:15], s70 offen offset:0 sc1
buffer_load_dwordx4 v[96:99], v16, s[12:15], s70 offen offset:1024 sc1
buffer_load_dwordx4 v[100:103], v19, s[12:15], s70 offen offset:1024 sc1
s_waitcnt vmcnt(0)
s_branch L_o8_chk
L_o9_rt:
s_add_u32 s78, s78, 1
s_cmp_gt_u32 s78, 65536
s_cbranch_scc1 L_o9_ok
s_add_u32 s70, s65, 9
s_and_b32 s70, s70, 15
s_lshl_b32 s70, s70, 11
s_add_u32 s70, s70, s74
buffer_load_dwordx4 v[104:107], v16, s[12:15], s70 offen offset:0 sc1
buffer_load_dwordx4 v[108:111], v19, s[12:15], s70 offen offset:0 sc1
buffer_load_dwordx4 v[112:115], v16, s[12:15], s70 offen offset:1024 sc1
buffer_load_dwordx4 v[116:119], v19, s[12:15], s70 offen offset:1024 sc1
s_waitcnt vmcnt(0)
s_branch L_o9_chk
L_o10_rt:
s_add_u32 s78, s78, 1
s_cmp_gt_u32 s78, 65536
s_cbranch_scc1 L_o10_ok
s_add_u32 s70, s65, 10
s_and_b32 s70, s70, 15
s_lshl_b32 s70, s70, 11
s_add_u32 s70, s70, s74
buffer_load_dwordx4 v[120:123], v16, s[12:15], s70 offen offset:0 sc1
buffer_load_dwordx4 v[124:127], v19, s[12:15], s70 offen offset:0 sc1
buffer_load_dwordx4 v[128:131], v16, s[12:15], s70 offen offset:1024 sc1
buffer_load_dwordx4 v[132:135], v19, s[12:15], s70 offen offset:1024 sc1
s_waitcnt vmcnt(0)
s_branch L_o10_chk
L_o11_rt:
s_add_u32 s78, s78, 1
s_cmp_gt_u32 s78, 65536
s_cbranch_scc1 L_o11_ok
s_add_u32 s70, s65, 11
s_and_b32 s70, s70, 15
s_lshl_b32 s70, s70, 11
s_add_u32 s70, s70, s74
buffer_load_dwordx4 v[136:139], v16, s[12:15], s70 offen offset:0 sc1
buffer_load_dwordx4 v[140:143], v19, s[12:15], s70 offen offset:0 sc1
buffer_load_dwordx4 v[144:147], v16, s[12:15], s70 offen offset:1024 sc1
buffer_load_dwordx4 v[148:151], v19, s[12:15], s70 offen offset:1024 sc1
s_waitcnt vmcnt(0)
s_branch L_o11_chk
L_o12_rt:
s_add_u32 s78, s78, 1
s_cmp_gt_u32 s78, 65536
s_cbranch_scc1 L_o12_ok
s_add_u32 s70, s65, 12
s_and_b32 s70, s70, 15
s_lshl_b32 s70, s70, 11
s_add_u32 s70, s70, s74
buffer_load_dwordx4 v[56:59], v16, s[12:15], s70 offen offset:0 sc1
buffer_load_dwordx4 v[60:63], v19, s[12:15], s70 offen offset:0 sc1
buffer_load_dwordx4 v[64:67], v16, s[12:15], s70 offen offset:1024 sc1
buffer_load_dwordx4 v[68:71], v19, s[12:15], s70 offen offset:1024 sc1
s_waitcnt vmcnt(0)
s_branch L_o12_chk
L_o13_rt:
s_add_u32 s78, s78, 1
s_cmp_gt_u32 s78, 65536
s_cbranch_scc1 L_o13_ok
s_add_u32 s70, s65, 13
s_and_b32 s70, s70, 15
s_lshl_b32 s70, s70, 11
s_add_u32 s70, s70, s74
buffer_load_dwordx4 v[72:75], v16, s[12:15], s70 offen offset:0 sc1
buffer_load_dwordx4 v[76:79], v19, s[12:15], s70 offen offset:0 sc1
buffer_load_dwordx4 v[80:83], v16, s[12:15], s70 offen offset:1024 sc1
buffer_load_dwordx4 v[84:87], v19, s[12:15], s70 offen offset:1024 sc1
s_waitcnt vmcnt(0)
s_branch L_o13_chk
L_o14_rt:
s_add_u32 s78, s78, 1
s_cmp_gt_u32 s78, 65536
s_cbranch_scc1 L_o14_ok
s_add_u32 s70, s65, 14
s_and_b32 s70, s70, 15
s_lshl_b32 s70, s70, 11
s_add_u32 s70, s70, s74
buffer_load_dwordx4 v[88:91], v16, s[12:15], s70 offen offset:0 sc1
buffer_load_dwordx4 v[92:95], v19, s[12:15], s70 offen offset:0 sc1
buffer_load_dwordx4 v[96:99], v16, s[12:15], s70 offen offset:1024 sc1
buffer_load_dwordx4 v[100:103], v19, s[12:15], s70 offen offset:1024 sc1
s_waitcnt vmcnt(0)
s_branch L_o14_chk
L_o15_rt:
s_add_u32 s78, s78, 1
s_cmp_gt_u32 s78, 65536
s_cbranch_scc1 L_o15_ok
s_add_u32 s70, s65, 15
s_and_b32 s70, s70, 15
s_lshl_b32 s70, s70, 11
s_add_u32 s70, s70, s74
buffer_load_dwordx4 v[104:107], v16, s[12:15], s70 offen offset:0 sc1
buffer_load_dwordx4 v[108:111], v19, s[12:15], s70 offen offset:0 sc1
buffer_load_dwordx4 v[112:115], v16, s[12:15], s70 offen offset:1024 sc1
buffer_load_dwordx4 v[116:119], v19, s[12:15], s70 offen offset:1024 sc1
s_waitcnt vmcnt(0)
s_branch L_o15_chk
L_stp_s:
buffer_store_dwordx4 v[72:75], v4, s[12:15], s72 offen sc1
s_branch L_stp_d
L_st_rt:
s_add_u32 s78, s78, 1
s_cmp_gt_u32 s78, 65536
s_cbranch_scc1 L_st_ok
s_add_u32 s70, s75, 0
buffer_load_dwordx4 v[96:99], v5, s[12:15], s70 offen sc1
s_add_u32 s70, s75, 4096
buffer_load_dwordx4 v[100:103], v5, s[12:15], s70 offen sc1
s_add_u32 s70, s75, 8192
buffer_load_dwordx4 v[104:107], v5, s[12:15], s70 offen sc1
s_add_u32 s70, s75, 12288
buffer_load_dwordx4 v[108:111], v5, s[12:15], s70 offen sc1
s_add_u32 s70, s75, 16384
buffer_load_dwordx4 v[112:115], v5, s[12:15], s70 offen sc1
s_add_u32 s70, s75, 20480
buffer_load_dwordx4 v[116:119], v5, s[12:15], s70 offen sc1
s_add_u32 s70, s75, 24576
buffer_load_dwordx4 v[120:123], v5, s[12:15], s70 offen sc1
s_add_u32 s70, s75, 28672
buffer_load_dwordx4 v[124:127], v5, s[12:15], s70 offen sc1
s_waitcnt vmcnt(0)
s_branch L_st_chk
L_rec_rt:
s_add_u32 s78, s78, 1
s_cmp_gt_u32 s78, 65536
s_cbranch_scc1 L_rec_ok
buffer_load_dwordx4 v[84:87], v8, s[12:15], s75 offen sc1
s_waitcnt vmcnt(0)
s_branch L_rec_chk
.section .rodata,"a"
.p2align 6
.amdhsa_kernel sequential_preLN__linear_attn_block__moe_arch_mod__prompt_kernel
  .amdhsa_next_free_vgpr 256
  .amdhsa_next_free_sgpr 102
  .amdhsa_accum_offset 152
  .amdhsa_group_segment_fixed_size 0
  .amdhsa_kernarg_size 88
  .amdhsa_user_sgpr_count 2
  .amdhsa_user_sgpr_kernarg_segment_ptr 1
  .amdhsa_system_sgpr_workgroup_id_x 1
  .amdhsa_float_denorm_mode_32 3
.end_amdhsa_kernel
```

```asm
; @launch grid=(256,1,1) block=(512,1,1) lds=163840
.amdgcn_target "amdgcn-amd-amdhsa--gfx950"
.text
.globl sequential_preLN__linear_attn_block__moe_arch_mod__prompt_kernel
.p2align 8
.type sequential_preLN__linear_attn_block__moe_arch_mod__prompt_kernel,@function
sequential_preLN__linear_attn_block__moe_arch_mod__prompt_kernel:
s_cmp_ge_u32 s2, 256
s_cbranch_scc1 L_end
s_load_dwordx16 s[40:55], s[0:1], 0
s_load_dwordx2 s[56:57], s[0:1], 64
s_load_dwordx2 s[58:59], s[0:1], 80
v_lshrrev_b32 v2, 6, v0
v_and_b32 v1, 63, v0
v_readfirstlane_b32 s60, v2
s_and_b32 s62, s2, 7
s_lshr_b32 s63, s2, 3
s_lshl_b32 s64, s62, 1
s_and_b32 s70, s63, 1
s_add_u32 s64, s64, s70
s_lshr_b32 s65, s63, 1
s_lshl_b32 s79, s64, 4
s_add_u32 s79, s79, s65
s_mov_b32 s78, 0
s_mov_b32 s89, s65
s_lshr_b32 s61, s60, 2
s_and_b32 s60, s60, 3
s_lshr_b32 s66, s60, 1
s_and_b32 s67, s60, 1
v_lshlrev_b32 v16, 4, v1
s_cmp_eq_u32 s61, 0
s_cbranch_scc1 L_compute
s_setprio 1
v_mov_b32 v18, v16
s_lshl_b32 s70, s65, 2
s_add_u32 s70, s70, s60
s_lshl_b32 s70, s70, 16
v_lshrrev_b32 v2, 3, v1
v_lshlrev_b32 v5, 11, v2
v_add_u32 v5, s70, v5
v_lshrrev_b32 v3, 4, v1
v_and_b32 v4, 7, v1
v_xor_b32 v3, v3, v4
v_xor_b32 v6, 0, v3
v_lshl_add_u32 v6, v6, 4, v5
v_add_u32 v8, 0, v6
v_xor_b32 v6, 4, v3
v_lshl_add_u32 v6, v6, 4, v5
v_add_u32 v9, 15360, v6
v_xor_b32 v6, 0, v3
v_lshl_add_u32 v6, v6, 4, v5
v_add_u32 v10, 30720, v6
v_xor_b32 v6, 4, v3
v_lshl_add_u32 v6, v6, 4, v5
v_add_u32 v11, 46080, v6
s_lshl_b32 s70, s60, 4
v_add_u32 v5, s70, v2
v_mul_u32_u24 v5, 6144, v5
s_lshl_b32 s70, s64, 7
v_add_u32 v5, s70, v5
v_bfe_u32 v3, v1, 4, 1
v_lshlrev_b32 v3, 1, v3
v_xor_b32 v3, v3, v4
v_xor_b32 v6, 0, v3
v_lshl_add_u32 v6, v6, 4, v5
v_add_u32 v12, 0, v6
v_xor_b32 v6, 4, v3
v_lshl_add_u32 v6, v6, 4, v5
v_add_u32 v13, 48128, v6
v_xor_b32 v6, 0, v3
v_lshl_add_u32 v6, v6, 4, v5
v_add_u32 v14, 0, v6
v_xor_b32 v6, 4, v3
v_lshl_add_u32 v6, v6, 4, v5
v_add_u32 v15, 48128, v6
v_xor_b32 v6, 0, v3
v_lshl_add_u32 v6, v6, 4, v5
v_add_u32 v16, 4096, v6
v_xor_b32 v6, 4, v3
v_lshl_add_u32 v6, v6, 4, v5
v_add_u32 v17, 52224, v6
s_lshl_b32 s76, s60, 12
s_mul_i32 s77, s60, 6144
s_and_b32 s70, s64, 1
s_lshl_b32 s70, s70, 3
s_mov_b32 s70, 0
s_add_u32 s70, s70, s65
s_and_b32 s70, s70, 15
s_mul_i32 s75, s70, 393216
s_lshl_b32 s74, s70, 7
s_waitcnt lgkmcnt(0)
s_mov_b32 s4, s40
s_and_b32 s5, s41, 0xffff
s_mov_b32 s6, 4194304
s_mov_b32 s7, 0x20000
s_mov_b32 s8, s42
s_and_b32 s9, s43, 0xffff
s_mov_b32 s10, 6291456
s_mov_b32 s11, 0x20000
s_add_u32 m0, s76, 122880
s_nop 0
buffer_load_dwordx4 v8, s[4:7], s74 offen offset:0 lds
buffer_load_dwordx4 v9, s[4:7], s74 offen offset:1024 lds
buffer_load_dwordx4 v10, s[4:7], s74 offen offset:2048 lds
buffer_load_dwordx4 v11, s[4:7], s74 offen offset:3072 lds
s_add_u32 s74, s74, 128
s_and_b32 s74, s74, 2047
s_add_u32 m0, s77, 0
s_nop 0
buffer_load_dwordx4 v12, s[8:11], s75 offen offset:0 lds
buffer_load_dwordx4 v13, s[8:11], s75 offen offset:1024 lds
buffer_load_dwordx4 v14, s[8:11], s75 offen offset:2048 lds
buffer_load_dwordx4 v15, s[8:11], s75 offen offset:3072 lds
s_add_u32 m0, s77, 4096
s_nop 0
buffer_load_dwordx4 v16, s[8:11], s75 offen offset:0 lds
buffer_load_dwordx4 v17, s[8:11], s75 offen offset:1024 lds
s_add_u32 s75, s75, 393216
s_cmp_eq_u32 s75, 6291456
s_cselect_b32 s75, 0, s75
s_add_u32 m0, s76, 106496
s_nop 0
buffer_load_dwordx4 v8, s[4:7], s74 offen offset:0 lds
buffer_load_dwordx4 v9, s[4:7], s74 offen offset:1024 lds
buffer_load_dwordx4 v10, s[4:7], s74 offen offset:2048 lds
buffer_load_dwordx4 v11, s[4:7], s74 offen offset:3072 lds
s_add_u32 s74, s74, 128
s_and_b32 s74, s74, 2047
s_add_u32 m0, s77, 81920
s_nop 0
buffer_load_dwordx4 v12, s[8:11], s75 offen offset:0 lds
buffer_load_dwordx4 v13, s[8:11], s75 offen offset:1024 lds
buffer_load_dwordx4 v14, s[8:11], s75 offen offset:2048 lds
buffer_load_dwordx4 v15, s[8:11], s75 offen offset:3072 lds
s_add_u32 m0, s77, 86016
s_nop 0
buffer_load_dwordx4 v16, s[8:11], s75 offen offset:0 lds
buffer_load_dwordx4 v17, s[8:11], s75 offen offset:1024 lds
s_add_u32 s75, s75, 393216
s_cmp_eq_u32 s75, 6291456
s_cselect_b32 s75, 0, s75
s_mov_b32 s12, s58
s_and_b32 s13, s59, 0xffff
s_mov_b32 s14, 268435456
s_mov_b32 s15, 0x20000
s_mov_b32 s16, s44
s_and_b32 s17, s45, 0xffff
s_mov_b32 s18, 2097152
s_mov_b32 s19, 0x20000
s_mov_b32 s20, s56
s_and_b32 s21, s57, 0xffff
s_mov_b32 s22, 4194304
s_mov_b32 s23, 0x20000
s_mov_b32 s24, s50
s_and_b32 s25, s51, 0xffff
s_mov_b32 s26, 7340032
s_mov_b32 s27, 0x20000
s_mov_b32 s28, s52
s_and_b32 s29, s53, 0xffff
s_mov_b32 s30, 7340032
s_mov_b32 s31, 0x20000
s_mov_b32 s32, s54
s_and_b32 s33, s55, 0xffff
s_mov_b32 s34, 7340032
s_mov_b32 s35, 0x20000
s_lshl_b32 s70, s65, 7
s_lshl_b32 s71, s64, 3
s_add_u32 s70, s70, s71
s_lshl_b32 s71, s60, 1
s_add_u32 s87, s70, s71
v_lshrrev_b32 v2, 3, v1
v_lshlrev_b32 v3, 11, v2
v_bfe_u32 v5, v1, 4, 2
v_lshlrev_b32 v5, 1, v5
v_and_b32 v4, 7, v1
v_xor_b32 v5, v5, v4
v_lshl_add_u32 v3, v5, 4, v3
s_lshl_b32 s70, s65, 7
v_add_u32 v80, s70, v3
v_mov_b32 v72, -1
v_mov_b32 v73, -1
v_mov_b32 v74, -1
v_mov_b32 v75, -1
s_mul_i32 s80, s79, 4352
s_add_u32 s80, s80, 524288
s_lshl_b32 s81, s65, 18
s_lshl_b32 s70, s66, 17
s_add_u32 s81, s81, s70
s_lshl_b32 s70, s64, 11
s_add_u32 s81, s81, s70
s_lshl_b32 s70, s67, 10
s_add_u32 s81, s81, s70
s_add_u32 s81, s81, 2097152
v_mul_u32_u24 v76, 7168, v2
v_lshl_add_u32 v76, v4, 4, v76
v_lshrrev_b32 v2, 4, v1
v_and_b32 v3, 15, v1
v_lshlrev_b32 v77, 13, v2
v_lshl_add_u32 v77, v3, 4, v77
v_add_u32 v78, 4096, v77
s_and_b32 s70, s65, 3
s_lshl_b32 s70, s70, 2
s_add_u32 s70, s70, s60
s_mul_i32 s85, s70, 458752
s_lshr_b32 s70, s79, 2
s_lshl_b32 s70, s70, 7
s_add_u32 s85, s85, s70
s_lshl_b32 s86, s79, 15
s_lshl_b32 s70, s60, 9
s_add_u32 s86, s86, s70
s_cmp_lt_u32 s64, 14
s_cselect_b32 s26, s26, 0
s_cselect_b32 s30, s30, 0
s_cselect_b32 s34, s34, 0
s_mov_b32 s90, 0x10001
s_movk_i32 s91, 0xff
v_mov_b32 v79, 0
s_lshl_b32 s70, s87, 4
s_add_u32 s70, s70, 8192
v_writelane_b32 v79, s70, 0
s_lshl_b32 s70, s79, 4
s_add_u32 s70, s70, 4096
v_writelane_b32 v79, s70, 1
s_lshl_b32 s70, s64, 7
s_add_u32 s70, s70, 6815744
v_writelane_b32 v79, s70, 2
s_lshl_b32 s70, s79, 10
s_add_u32 s70, s70, 65536
v_writelane_b32 v79, s70, 3
s_lshl_b32 s70, s60, 10
s_add_u32 s70, s70, s80
v_writelane_b32 v79, s70, 4
s_lshl_b32 s70, s67, 7
s_add_u32 s70, s70, s80
s_add_u32 s70, s70, 4096
v_writelane_b32 v79, s70, 5
s_lshl_b32 s71, s79, 2
s_add_u32 s71, s71, s60
s_lshl_b32 s70, s71, 11
s_add_u32 s70, s70, 7340032
v_writelane_b32 v79, s70, 6
s_lshl_b32 s71, s79, 2
s_add_u32 s71, s71, s60
s_lshl_b32 s70, s71, 9
s_add_u32 s70, s70, 6291456
v_writelane_b32 v79, s70, 7
s_and_b32 s71, s65, 3
s_sub_u32 s70, s79, s71
s_add_u32 s70, s70, s60
s_lshl_b32 s70, s70, 2
s_add_u32 s70, s70, s71
s_lshl_b32 s70, s70, 8
s_add_u32 s70, s70, 6946816
v_writelane_b32 v79, s70, 8
s_add_u32 s70, s81, 0
v_writelane_b32 v79, s70, 9
s_add_u32 s70, s81, 32768
v_writelane_b32 v79, s70, 10
s_add_u32 s70, s81, 65536
v_writelane_b32 v79, s70, 11
s_add_u32 s70, s81, 98304
v_writelane_b32 v79, s70, 12
v_and_b32 v2, 7, v1
v_lshlrev_b32 v2, 7, v2
v_lshrrev_b32 v3, 3, v1
v_lshl_add_u32 v83, v3, 15, v2
v_add_u32 v83, s81, v83
s_mov_b32 exec_lo, 0
s_lshl_b32 s71, s79, 2
s_add_u32 s71, s71, s60
s_lshl_b32 s70, s71, 11
s_add_u32 s70, s70, 7340032
s_mov_b32 exec_hi, 0xffff
v_and_b32 v2, 15, v1
v_lshl_add_u32 v83, v2, 7, s70
s_lshl_b32 s70, s60, 10
s_add_u32 s70, s70, s80
s_mov_b32 exec_hi, 0xff0000
v_and_b32 v2, 7, v1
v_lshl_add_u32 v83, v2, 7, s70
s_lshl_b32 s71, s79, 2
s_add_u32 s71, s71, s60
s_lshl_b32 s70, s71, 9
s_add_u32 s70, s70, 6291456
s_mov_b32 exec_hi, 0xf000000
v_and_b32 v2, 3, v1
v_lshl_add_u32 v83, v2, 7, s70
s_and_b32 s71, s65, 3
s_sub_u32 s70, s79, s71
s_add_u32 s70, s70, s60
s_lshl_b32 s70, s70, 2
s_add_u32 s70, s70, s71
s_lshl_b32 s70, s70, 8
s_add_u32 s70, s70, 6946816
s_mov_b32 exec_hi, 0x30000000
v_and_b32 v2, 1, v1
v_lshl_add_u32 v83, v2, 7, s70
s_lshl_b32 s70, s67, 7
s_add_u32 s70, s70, s80
s_add_u32 s70, s70, 4096
s_mov_b32 exec_hi, 0xc0000000
v_and_b32 v2, 0, v1
v_lshl_add_u32 v83, v2, 7, s70
s_mov_b64 exec, -1
s_waitcnt vmcnt(10)
s_barrier
s_add_u32 m0, s76, 65536
s_nop 0
buffer_load_dwordx4 v8, s[4:7], s74 offen offset:0 lds
buffer_load_dwordx4 v9, s[4:7], s74 offen offset:1024 lds
buffer_load_dwordx4 v10, s[4:7], s74 offen offset:2048 lds
buffer_load_dwordx4 v11, s[4:7], s74 offen offset:3072 lds
s_add_u32 s74, s74, 128
s_and_b32 s74, s74, 2047
s_add_u32 m0, s77, 40960
s_nop 0
buffer_load_dwordx4 v12, s[8:11], s75 offen offset:0 lds
buffer_load_dwordx4 v13, s[8:11], s75 offen offset:1024 lds
buffer_load_dwordx4 v14, s[8:11], s75 offen offset:2048 lds
buffer_load_dwordx4 v15, s[8:11], s75 offen offset:3072 lds
s_add_u32 m0, s77, 45056
s_nop 0
buffer_load_dwordx4 v16, s[8:11], s75 offen offset:0 lds
buffer_load_dwordx4 v17, s[8:11], s75 offen offset:1024 lds
s_add_u32 s75, s75, 393216
s_cmp_eq_u32 s75, 6291456
s_cselect_b32 s75, 0, s75
s_add_u32 m0, s76, 24576
s_nop 0
buffer_load_dwordx4 v8, s[4:7], s74 offen offset:0 lds
buffer_load_dwordx4 v9, s[4:7], s74 offen offset:1024 lds
buffer_load_dwordx4 v10, s[4:7], s74 offen offset:2048 lds
buffer_load_dwordx4 v11, s[4:7], s74 offen offset:3072 lds
s_add_u32 s74, s74, 128
s_and_b32 s74, s74, 2047
s_waitcnt vmcnt(14)
s_barrier
s_add_u32 m0, s77, 0
s_nop 0
buffer_load_dwordx4 v12, s[8:11], s75 offen offset:0 lds
buffer_load_dwordx4 v13, s[8:11], s75 offen offset:1024 lds
buffer_load_dwordx4 v14, s[8:11], s75 offen offset:2048 lds
buffer_load_dwordx4 v15, s[8:11], s75 offen offset:3072 lds
s_add_u32 m0, s77, 4096
s_nop 0
buffer_load_dwordx4 v16, s[8:11], s75 offen offset:0 lds
buffer_load_dwordx4 v17, s[8:11], s75 offen offset:1024 lds
s_add_u32 s75, s75, 393216
s_cmp_eq_u32 s75, 6291456
s_cselect_b32 s75, 0, s75
s_add_u32 m0, s76, 122880
s_nop 0
buffer_load_dwordx4 v8, s[4:7], s74 offen offset:0 lds
buffer_load_dwordx4 v9, s[4:7], s74 offen offset:1024 lds
buffer_load_dwordx4 v10, s[4:7], s74 offen offset:2048 lds
buffer_load_dwordx4 v11, s[4:7], s74 offen offset:3072 lds
s_add_u32 s74, s74, 128
s_and_b32 s74, s74, 2047
v_mov_b32 v2, 0
buffer_load_dword v19, v2, s[12:15], 0 offen sc1
s_lshl_b32 s70, s87, 11
buffer_load_dwordx4 v[20:23], v18, s[4:7], s70 offen offset:0
s_lshl_b32 s70, s87, 11
buffer_load_dwordx4 v[24:27], v18, s[4:7], s70 offen offset:1024
s_lshl_b32 s70, s87, 11
buffer_load_dwordx4 v[28:31], v18, s[4:7], s70 offen offset:2048
s_lshl_b32 s70, s87, 11
buffer_load_dwordx4 v[32:35], v18, s[4:7], s70 offen offset:3072
s_mov_b64 exec, 0x1fff
buffer_load_dword v81, v79, s[12:15], 0 offen
s_mov_b64 exec, -1
s_lshl_b32 s70, s64, 12
s_lshl_b32 s71, s66, 11
s_add_u32 s70, s70, s71
s_lshl_b32 s71, s65, 7
s_add_u32 s70, s70, s71
s_lshl_b32 s71, s67, 6
s_add_u32 s70, s70, s71
s_add_u32 s70, s70, 6881280
s_mov_b64 exec, 0xf
buffer_store_dwordx4 v[72:75], v18, s[12:15], s70 offen sc1
s_mov_b64 exec, -1
s_waitcnt vmcnt(21)
s_barrier
s_add_u32 m0, s77, 81920
s_nop 0
buffer_load_dwordx4 v12, s[8:11], s75 offen offset:0 lds
buffer_load_dwordx4 v13, s[8:11], s75 offen offset:1024 lds
buffer_load_dwordx4 v14, s[8:11], s75 offen offset:2048 lds
buffer_load_dwordx4 v15, s[8:11], s75 offen offset:3072 lds
s_add_u32 m0, s77, 86016
s_nop 0
buffer_load_dwordx4 v16, s[8:11], s75 offen offset:0 lds
buffer_load_dwordx4 v17, s[8:11], s75 offen offset:1024 lds
s_add_u32 s75, s75, 393216
s_cmp_eq_u32 s75, 6291456
s_cselect_b32 s75, 0, s75
s_add_u32 m0, s76, 106496
s_nop 0
buffer_load_dwordx4 v8, s[4:7], s74 offen offset:0 lds
buffer_load_dwordx4 v9, s[4:7], s74 offen offset:1024 lds
buffer_load_dwordx4 v10, s[4:7], s74 offen offset:2048 lds
buffer_load_dwordx4 v11, s[4:7], s74 offen offset:3072 lds
s_add_u32 s74, s74, 128
s_and_b32 s74, s74, 2047
s_waitcnt vmcnt(21)
s_barrier
s_add_u32 m0, s77, 40960
s_nop 0
buffer_load_dwordx4 v12, s[8:11], s75 offen offset:0 lds
s_waitcnt vmcnt(13)
v_readfirstlane_b32 s68, v19
s_nop 0
s_add_u32 s68, s68, 1
s_and_b32 s84, s68, 0xff
s_not_b32 s70, s68
v_and_b32 v82, 3, v1
v_lshrrev_b32_e64 v82, v82, s70
v_and_b32 v82, 1, v82
v_mul_u32_u24 v82, 0x10001, v82
buffer_load_dwordx4 v13, s[8:11], s75 offen offset:1024 lds
v_lshlrev_b32 v36, 16, v20
v_and_b32 v37, 0xffff0000, v20
v_lshlrev_b32 v38, 16, v21
v_and_b32 v39, 0xffff0000, v21
v_lshlrev_b32 v40, 16, v22
buffer_load_dwordx4 v14, s[8:11], s75 offen offset:2048 lds
v_and_b32 v41, 0xffff0000, v22
v_lshlrev_b32 v42, 16, v23
v_and_b32 v43, 0xffff0000, v23
v_lshlrev_b32 v44, 16, v24
v_and_b32 v45, 0xffff0000, v24
buffer_load_dwordx4 v15, s[8:11], s75 offen offset:3072 lds
v_lshlrev_b32 v46, 16, v25
v_and_b32 v47, 0xffff0000, v25
v_lshlrev_b32 v48, 16, v26
v_and_b32 v49, 0xffff0000, v26
v_lshlrev_b32 v50, 16, v27
s_add_u32 m0, s77, 45056
s_nop 0
buffer_load_dwordx4 v16, s[8:11], s75 offen offset:0 lds
v_and_b32 v51, 0xffff0000, v27
v_lshlrev_b32 v52, 16, v28
v_and_b32 v53, 0xffff0000, v28
v_lshlrev_b32 v54, 16, v29
v_and_b32 v55, 0xffff0000, v29
buffer_load_dwordx4 v17, s[8:11], s75 offen offset:1024 lds
s_add_u32 s75, s75, 393216
s_cmp_eq_u32 s75, 6291456
s_cselect_b32 s75, 0, s75
v_lshlrev_b32 v56, 16, v30
v_and_b32 v57, 0xffff0000, v30
v_lshlrev_b32 v58, 16, v31
v_and_b32 v59, 0xffff0000, v31
v_lshlrev_b32 v60, 16, v32
s_add_u32 m0, s76, 65536
s_nop 0
buffer_load_dwordx4 v8, s[4:7], s74 offen offset:0 lds
v_and_b32 v61, 0xffff0000, v32
v_lshlrev_b32 v62, 16, v33
v_and_b32 v63, 0xffff0000, v33
v_lshlrev_b32 v64, 16, v34
v_and_b32 v65, 0xffff0000, v34
buffer_load_dwordx4 v9, s[4:7], s74 offen offset:1024 lds
v_lshlrev_b32 v66, 16, v35
v_and_b32 v67, 0xffff0000, v35
v_add_f32 v20, v36, v40
v_add_f32 v28, v52, v56
v_add_f32 v21, v37, v41
buffer_load_dwordx4 v10, s[4:7], s74 offen offset:2048 lds
v_add_f32 v29, v53, v57
v_add_f32 v22, v38, v42
v_add_f32 v30, v54, v58
v_add_f32 v23, v39, v43
v_add_f32 v31, v55, v59
buffer_load_dwordx4 v11, s[4:7], s74 offen offset:3072 lds
s_add_u32 s74, s74, 128
s_and_b32 s74, s74, 2047
v_add_f32 v20, v20, v44
v_add_f32 v28, v28, v60
s_waitcnt vmcnt(14)
s_barrier
s_add_u32 m0, s77, 0
s_nop 0
buffer_load_dwordx4 v12, s[8:11], s75 offen offset:0 lds
v_add_f32 v21, v21, v45
v_add_f32 v29, v29, v61
v_add_f32 v22, v22, v46
v_add_f32 v30, v30, v62
v_add_f32 v23, v23, v47
buffer_load_dwordx4 v13, s[8:11], s75 offen offset:1024 lds
v_add_f32 v31, v31, v63
v_add_f32 v20, v20, v48
v_add_f32 v28, v28, v64
v_add_f32 v21, v21, v49
v_add_f32 v29, v29, v65
buffer_load_dwordx4 v14, s[8:11], s75 offen offset:2048 lds
v_add_f32 v22, v22, v50
v_add_f32 v30, v30, v66
v_add_f32 v23, v23, v51
v_add_f32 v31, v31, v67
v_add_f32 v20, v20, v21
buffer_load_dwordx4 v15, s[8:11], s75 offen offset:3072 lds
v_add_f32 v22, v22, v23
v_add_f32 v28, v28, v29
v_add_f32 v30, v30, v31
v_add_f32 v2, v20, v22
v_add_f32 v4, v28, v30
s_add_u32 m0, s77, 4096
s_nop 0
buffer_load_dwordx4 v16, s[8:11], s75 offen offset:0 lds
v_add_f32_dpp v2, v2, v2 row_ror:1 row_mask:0xf bank_mask:0xf
v_add_f32_dpp v4, v4, v4 row_ror:1 row_mask:0xf bank_mask:0xf
s_nop 0
v_add_f32_dpp v2, v2, v2 row_ror:2 row_mask:0xf bank_mask:0xf
v_add_f32_dpp v4, v4, v4 row_ror:2 row_mask:0xf bank_mask:0xf
s_nop 0
v_add_f32_dpp v2, v2, v2 row_ror:4 row_mask:0xf bank_mask:0xf
buffer_load_dwordx4 v17, s[8:11], s75 offen offset:1024 lds
s_add_u32 s75, s75, 393216
s_cmp_eq_u32 s75, 6291456
s_cselect_b32 s75, 0, s75
v_add_f32_dpp v4, v4, v4 row_ror:4 row_mask:0xf bank_mask:0xf
v_add_f32_dpp v2, v2, v2 row_ror:8 row_mask:0xf bank_mask:0xf
s_nop 0
v_add_f32_dpp v4, v4, v4 row_ror:8 row_mask:0xf bank_mask:0xf
v_mov_b32 v6, v2
v_mov_b32 v7, v4
s_add_u32 m0, s76, 24576
s_nop 0
buffer_load_dwordx4 v8, s[4:7], s74 offen offset:0 lds
v_permlane16_swap_b32 v2, v6
v_permlane16_swap_b32 v4, v7
v_add_f32 v2, v2, v6
v_add_f32 v4, v4, v7
v_mov_b32 v6, v2
buffer_load_dwordx4 v9, s[4:7], s74 offen offset:1024 lds
v_mov_b32 v7, v4
v_permlane32_swap_b32 v2, v6
s_nop 0
v_permlane32_swap_b32 v4, v7
v_add_f32 v2, v2, v6
v_add_f32 v4, v4, v7
buffer_load_dwordx4 v10, s[4:7], s74 offen offset:2048 lds
v_mul_f32 v2, 0xba800000, v2
v_mul_f32 v4, 0xba800000, v4
v_add_f32 v36, v36, v2
v_add_f32 v52, v52, v4
v_add_f32 v37, v37, v2
buffer_load_dwordx4 v11, s[4:7], s74 offen offset:3072 lds
s_add_u32 s74, s74, 128
s_and_b32 s74, s74, 2047
v_add_f32 v53, v53, v4
v_add_f32 v38, v38, v2
s_waitcnt vmcnt(14)
s_barrier
s_add_u32 m0, s77, 81920
s_nop 0
buffer_load_dwordx4 v12, s[8:11], s75 offen offset:0 lds
v_add_f32 v54, v54, v4
v_add_f32 v39, v39, v2
v_add_f32 v55, v55, v4
v_add_f32 v40, v40, v2
v_add_f32 v56, v56, v4
buffer_load_dwordx4 v13, s[8:11], s75 offen offset:1024 lds
v_add_f32 v41, v41, v2
v_add_f32 v57, v57, v4
v_add_f32 v42, v42, v2
v_add_f32 v58, v58, v4
v_add_f32 v43, v43, v2
buffer_load_dwordx4 v14, s[8:11], s75 offen offset:2048 lds
v_add_f32 v59, v59, v4
v_add_f32 v44, v44, v2
v_add_f32 v60, v60, v4
v_add_f32 v45, v45, v2
v_add_f32 v61, v61, v4
buffer_load_dwordx4 v15, s[8:11], s75 offen offset:3072 lds
v_add_f32 v46, v46, v2
v_add_f32 v62, v62, v4
v_add_f32 v47, v47, v2
v_add_f32 v63, v63, v4
v_add_f32 v48, v48, v2
s_add_u32 m0, s77, 86016
s_nop 0
buffer_load_dwordx4 v16, s[8:11], s75 offen offset:0 lds
v_add_f32 v64, v64, v4
v_add_f32 v49, v49, v2
v_add_f32 v65, v65, v4
v_add_f32 v50, v50, v2
v_add_f32 v66, v66, v4
buffer_load_dwordx4 v17, s[8:11], s75 offen offset:1024 lds
s_add_u32 s75, s75, 393216
s_cmp_eq_u32 s75, 6291456
s_cselect_b32 s75, 0, s75
v_add_f32 v51, v51, v2
v_add_f32 v67, v67, v4
v_mul_f32 v20, v36, v36
v_mul_f32 v28, v52, v52
v_mul_f32 v21, v37, v37
s_add_u32 m0, s76, 122880
s_nop 0
buffer_load_dwordx4 v8, s[4:7], s74 offen offset:0 lds
v_mul_f32 v29, v53, v53
v_fmac_f32 v20, v38, v38
v_fmac_f32 v28, v54, v54
v_fmac_f32 v21, v39, v39
v_fmac_f32 v29, v55, v55
buffer_load_dwordx4 v9, s[4:7], s74 offen offset:1024 lds
v_fmac_f32 v20, v40, v40
v_fmac_f32 v28, v56, v56
v_fmac_f32 v21, v41, v41
v_fmac_f32 v29, v57, v57
v_fmac_f32 v20, v42, v42
buffer_load_dwordx4 v10, s[4:7], s74 offen offset:2048 lds
v_fmac_f32 v28, v58, v58
v_fmac_f32 v21, v43, v43
v_fmac_f32 v29, v59, v59
v_fmac_f32 v20, v44, v44
v_fmac_f32 v28, v60, v60
buffer_load_dwordx4 v11, s[4:7], s74 offen offset:3072 lds
s_add_u32 s74, s74, 128
s_and_b32 s74, s74, 2047
v_fmac_f32 v21, v45, v45
v_fmac_f32 v29, v61, v61
s_waitcnt vmcnt(14)
s_barrier
s_add_u32 m0, s77, 40960
s_nop 0
buffer_load_dwordx4 v12, s[8:11], s75 offen offset:0 lds
v_fmac_f32 v20, v46, v46
v_fmac_f32 v28, v62, v62
v_fmac_f32 v21, v47, v47
v_fmac_f32 v29, v63, v63
v_fmac_f32 v20, v48, v48
buffer_load_dwordx4 v13, s[8:11], s75 offen offset:1024 lds
v_fmac_f32 v28, v64, v64
v_fmac_f32 v21, v49, v49
v_fmac_f32 v29, v65, v65
v_fmac_f32 v20, v50, v50
v_fmac_f32 v28, v66, v66
buffer_load_dwordx4 v14, s[8:11], s75 offen offset:2048 lds
v_fmac_f32 v21, v51, v51
v_fmac_f32 v29, v67, v67
v_add_f32 v3, v20, v21
v_add_f32 v5, v28, v29
s_nop 0
v_add_f32_dpp v3, v3, v3 row_ror:1 row_mask:0xf bank_mask:0xf
buffer_load_dwordx4 v15, s[8:11], s75 offen offset:3072 lds
v_add_f32_dpp v5, v5, v5 row_ror:1 row_mask:0xf bank_mask:0xf
v_add_f32_dpp v3, v3, v3 row_ror:2 row_mask:0xf bank_mask:0xf
s_nop 0
v_add_f32_dpp v5, v5, v5 row_ror:2 row_mask:0xf bank_mask:0xf
v_add_f32_dpp v3, v3, v3 row_ror:4 row_mask:0xf bank_mask:0xf
s_nop 0
v_add_f32_dpp v5, v5, v5 row_ror:4 row_mask:0xf bank_mask:0xf
s_add_u32 m0, s77, 45056
s_nop 0
buffer_load_dwordx4 v16, s[8:11], s75 offen offset:0 lds
v_add_f32_dpp v3, v3, v3 row_ror:8 row_mask:0xf bank_mask:0xf
v_add_f32_dpp v5, v5, v5 row_ror:8 row_mask:0xf bank_mask:0xf
v_mov_b32 v6, v3
v_mov_b32 v7, v5
s_nop 0
v_permlane16_swap_b32 v3, v6
buffer_load_dwordx4 v17, s[8:11], s75 offen offset:1024 lds
s_add_u32 s75, s75, 393216
s_cmp_eq_u32 s75, 6291456
s_cselect_b32 s75, 0, s75
v_permlane16_swap_b32 v5, v7
v_add_f32 v3, v3, v6
v_add_f32 v5, v5, v7
v_mov_b32 v6, v3
v_mov_b32 v7, v5
s_add_u32 m0, s76, 106496
s_nop 0
buffer_load_dwordx4 v8, s[4:7], s74 offen offset:0 lds
v_permlane32_swap_b32 v3, v6
v_permlane32_swap_b32 v5, v7
v_add_f32 v3, v3, v6
v_add_f32 v5, v5, v7
v_mov_b32 v6, 0x3727c5ac
buffer_load_dwordx4 v9, s[4:7], s74 offen offset:1024 lds
v_fmac_f32 v6, 0x3a800000, v3
v_rsq_f32 v3, v6
v_mov_b32 v6, 0x3727c5ac
v_fmac_f32 v6, 0x3a800000, v5
v_rsq_f32 v5, v6
buffer_load_dwordx4 v10, s[4:7], s74 offen offset:2048 lds
v_cmp_eq_u32 vcc, 1, v1
s_nop 1
v_cndmask_b32 v20, v2, v4, vcc
v_cndmask_b32 v21, v3, v5, vcc
v_mov_b32 v22, 0
v_mov_b32 v23, s68
buffer_load_dwordx4 v11, s[4:7], s74 offen offset:3072 lds
s_add_u32 s74, s74, 128
s_and_b32 s74, s74, 2047
buffer_load_dwordx4 a[0:3], v76, s[24:27], s85 offen nt
buffer_load_dwordx4 a[32:35], v76, s[28:31], s85 offen nt
s_add_u32 s85, s85, 57344
buffer_load_dwordx4 a[4:7], v76, s[24:27], s85 offen nt
s_lshl_b32 s70, s87, 4
s_add_u32 s70, s70, 8192
s_mov_b64 exec, 3
buffer_store_dwordx4 v[20:23], v18, s[12:15], s70 offen sc1
s_mov_b64 exec, -1
s_waitcnt vmcnt(18)
s_barrier
s_add_u32 m0, s77, 0
s_nop 0
buffer_load_dwordx4 v12, s[8:11], s75 offen offset:0 lds
buffer_load_dwordx4 v13, s[8:11], s75 offen offset:1024 lds
buffer_load_dwordx4 v14, s[8:11], s75 offen offset:2048 lds
buffer_load_dwordx4 v15, s[8:11], s75 offen offset:3072 lds
s_add_u32 m0, s77, 4096
s_nop 0
buffer_load_dwordx4 v16, s[8:11], s75 offen offset:0 lds
buffer_load_dwordx4 v17, s[8:11], s75 offen offset:1024 lds
s_add_u32 s75, s75, 393216
s_cmp_eq_u32 s75, 6291456
s_cselect_b32 s75, 0, s75
s_add_u32 m0, s76, 65536
s_nop 0
buffer_load_dwordx4 v8, s[4:7], s74 offen offset:0 lds
buffer_load_dwordx4 v9, s[4:7], s74 offen offset:1024 lds
buffer_load_dwordx4 v10, s[4:7], s74 offen offset:2048 lds
buffer_load_dwordx4 v11, s[4:7], s74 offen offset:3072 lds
s_add_u32 s74, s74, 128
s_and_b32 s74, s74, 2047
buffer_load_dwordx4 a[36:39], v76, s[28:31], s85 offen nt
s_add_u32 s85, s85, 57344
buffer_load_dwordx4 a[8:11], v76, s[24:27], s85 offen nt
buffer_load_dwordx4 a[40:43], v76, s[28:31], s85 offen nt
s_add_u32 s85, s85, 57344
s_waitcnt vmcnt(21)
s_barrier
s_add_u32 m0, s77, 81920
s_nop 0
buffer_load_dwordx4 v12, s[8:11], s75 offen offset:0 lds
s_getreg_b32 s71, hwreg(HW_REG_XCC_ID, 0, 4)
v_mov_b32 v84, s71
buffer_load_dwordx4 v13, s[8:11], s75 offen offset:1024 lds
v_mov_b32 v85, 0
buffer_load_dwordx4 v14, s[8:11], s75 offen offset:2048 lds
v_mov_b32 v86, 0
buffer_load_dwordx4 v15, s[8:11], s75 offen offset:3072 lds
v_mov_b32 v87, s68
s_add_u32 m0, s77, 86016
s_nop 0
buffer_load_dwordx4 v16, s[8:11], s75 offen offset:0 lds
buffer_load_dwordx4 v17, s[8:11], s75 offen offset:1024 lds
s_add_u32 s75, s75, 393216
s_cmp_eq_u32 s75, 6291456
s_cselect_b32 s75, 0, s75
s_add_u32 m0, s76, 24576
s_nop 0
buffer_load_dwordx4 v8, s[4:7], s74 offen offset:0 lds
buffer_load_dwordx4 v9, s[4:7], s74 offen offset:1024 lds
buffer_load_dwordx4 v10, s[4:7], s74 offen offset:2048 lds
buffer_load_dwordx4 v11, s[4:7], s74 offen offset:3072 lds
s_add_u32 s74, s74, 128
s_and_b32 s74, s74, 2047
buffer_load_dwordx4 a[12:15], v76, s[24:27], s85 offen nt
buffer_load_dwordx4 a[44:47], v76, s[28:31], s85 offen nt
s_add_u32 s85, s85, 57344
buffer_load_dwordx4 a[16:19], v76, s[24:27], s85 offen nt
s_lshl_b32 s70, s79, 4
s_add_u32 s70, s70, 4096
s_mov_b64 exec, 1
buffer_store_dwordx4 v[84:87], v18, s[12:15], s70 offen sc1
s_mov_b64 exec, -1
s_waitcnt vmcnt(21)
s_barrier
s_add_u32 m0, s77, 40960
s_nop 0
buffer_load_dwordx4 v12, s[8:11], s75 offen offset:0 lds
buffer_load_dwordx4 v13, s[8:11], s75 offen offset:1024 lds
buffer_load_dwordx4 v14, s[8:11], s75 offen offset:2048 lds
buffer_load_dwordx4 v15, s[8:11], s75 offen offset:3072 lds
s_add_u32 m0, s77, 45056
s_nop 0
buffer_load_dwordx4 v16, s[8:11], s75 offen offset:0 lds
buffer_load_dwordx4 v17, s[8:11], s75 offen offset:1024 lds
s_add_u32 s75, s75, 393216
s_cmp_eq_u32 s75, 6291456
s_cselect_b32 s75, 0, s75
s_add_u32 m0, s76, 122880
s_nop 0
buffer_load_dwordx4 v8, s[4:7], s74 offen offset:0 lds
buffer_load_dwordx4 v9, s[4:7], s74 offen offset:1024 lds
buffer_load_dwordx4 v10, s[4:7], s74 offen offset:2048 lds
buffer_load_dwordx4 v11, s[4:7], s74 offen offset:3072 lds
s_add_u32 s74, s74, 128
s_and_b32 s74, s74, 2047
buffer_load_dwordx4 a[48:51], v76, s[28:31], s85 offen nt
s_add_u32 s85, s85, 57344
buffer_load_dwordx4 a[20:23], v76, s[24:27], s85 offen nt
buffer_load_dwordx4 a[52:55], v76, s[28:31], s85 offen nt
s_add_u32 s85, s85, 57344
s_waitcnt vmcnt(21)
s_barrier
s_add_u32 m0, s77, 0
s_nop 0
buffer_load_dwordx4 v12, s[8:11], s75 offen offset:0 lds
buffer_load_dwordx4 v13, s[8:11], s75 offen offset:1024 lds
buffer_load_dwordx4 v14, s[8:11], s75 offen offset:2048 lds
buffer_load_dwordx4 v15, s[8:11], s75 offen offset:3072 lds
s_add_u32 m0, s77, 4096
s_nop 0
buffer_load_dwordx4 v16, s[8:11], s75 offen offset:0 lds
buffer_load_dwordx4 v17, s[8:11], s75 offen offset:1024 lds
s_add_u32 s75, s75, 393216
s_cmp_eq_u32 s75, 6291456
s_cselect_b32 s75, 0, s75
s_add_u32 m0, s76, 106496
s_nop 0
buffer_load_dwordx4 v8, s[4:7], s74 offen offset:0 lds
buffer_load_dwordx4 v9, s[4:7], s74 offen offset:1024 lds
buffer_load_dwordx4 v10, s[4:7], s74 offen offset:2048 lds
buffer_load_dwordx4 v11, s[4:7], s74 offen offset:3072 lds
s_add_u32 s74, s74, 128
s_and_b32 s74, s74, 2047
buffer_load_dwordx4 a[24:27], v76, s[24:27], s85 offen nt
buffer_load_dwordx4 a[56:59], v76, s[28:31], s85 offen nt
s_add_u32 s85, s85, 57344
buffer_load_dwordx4 a[28:31], v76, s[24:27], s85 offen nt
buffer_load_dwordx4 a[60:63], v76, s[28:31], s85 offen nt
s_add_u32 s85, s85, 57344
s_waitcnt vmcnt(21)
s_barrier
s_add_u32 m0, s77, 81920
s_nop 0
buffer_load_dwordx4 v12, s[8:11], s75 offen offset:0 lds
v_lshrrev_b32 v2, 4, v1
v_and_b32 v3, 15, v1
buffer_load_dwordx4 v13, s[8:11], s75 offen offset:1024 lds
v_lshlrev_b32 v44, 10, v2
v_lshl_add_u32 v44, v3, 4, v44
buffer_load_dwordx4 v14, s[8:11], s75 offen offset:2048 lds
s_lshl_b32 s70, s60, 8
v_add_u32 v44, s70, v44
s_lshl_b32 s87, s64, 14
s_add_u32 s87, s87, 65536
buffer_load_dwordx4 v15, s[8:11], s75 offen offset:3072 lds
v_and_b32 v45, 31, v1
v_lshlrev_b32 v45, 4, v45
s_add_u32 m0, s77, 86016
s_nop 0
buffer_load_dwordx4 v16, s[8:11], s75 offen offset:0 lds
s_lshl_b32 s88, s65, 11
s_lshl_b32 s70, s60, 9
s_add_u32 s88, s88, s70
s_add_u32 s88, s88, 8192
s_lshl_b32 s70, s64, 8
s_add_u32 s70, s70, 4096
v_lshlrev_b32 v4, 4, v3
v_add_u32 v4, s70, v4
buffer_load_dwordx4 v17, s[8:11], s75 offen offset:1024 lds
s_add_u32 s75, s75, 393216
s_cmp_eq_u32 s75, 6291456
s_cselect_b32 s75, 0, s75
s_lshl_b32 s70, s64, 4
s_add_u32 s70, s70, 4096
v_lshlrev_b32 v5, 8, v3
v_add_u32 v5, s70, v5
v_and_b32 v6, 1, v2
s_add_u32 m0, s76, 65536
s_nop 0
buffer_load_dwordx4 v8, s[4:7], s74 offen offset:0 lds
v_cmp_eq_u32 vcc, 1, v6
s_nop 1
v_cndmask_b32 v46, v4, v5, vcc
buffer_load_dwordx4 v9, s[4:7], s74 offen offset:1024 lds
buffer_load_dwordx4 v10, s[4:7], s74 offen offset:2048 lds
buffer_load_dwordx4 v11, s[4:7], s74 offen offset:3072 lds
s_add_u32 s74, s74, 128
s_and_b32 s74, s74, 2047
s_add_u32 s70, s87, 0
buffer_load_dwordx4 v[20:23], v44, s[12:15], s70 offen sc1
s_add_u32 s70, s87, 4096
buffer_load_dwordx4 v[24:27], v44, s[12:15], s70 offen sc1
s_add_u32 s70, s87, 8192
buffer_load_dwordx4 v[28:31], v44, s[12:15], s70 offen sc1
s_add_u32 s70, s87, 12288
buffer_load_dwordx4 v[32:35], v44, s[12:15], s70 offen sc1
buffer_load_dwordx4 v[36:39], v45, s[12:15], s88 offen sc1
buffer_load_dwordx4 v[40:43], v46, s[12:15], 0 offen offset:0 sc1
buffer_load_dwordx4 a[64:67], v77, s[32:35], s86 offen offset:0 nt
buffer_load_dwordx4 a[68:71], v77, s[32:35], s86 offen offset:2048 nt
buffer_load_dwordx4 a[72:75], v78, s[32:35], s86 offen offset:0 nt
s_waitcnt vmcnt(27)
s_barrier
s_add_u32 m0, s77, 40960
s_nop 0
buffer_load_dwordx4 v12, s[8:11], s75 offen offset:0 lds
buffer_load_dwordx4 v13, s[8:11], s75 offen offset:1024 lds
buffer_load_dwordx4 v14, s[8:11], s75 offen offset:2048 lds
buffer_load_dwordx4 v15, s[8:11], s75 offen offset:3072 lds
s_add_u32 m0, s77, 45056
s_nop 0
buffer_load_dwordx4 v16, s[8:11], s75 offen offset:0 lds
buffer_load_dwordx4 v17, s[8:11], s75 offen offset:1024 lds
s_add_u32 s75, s75, 393216
s_cmp_eq_u32 s75, 6291456
s_cselect_b32 s75, 0, s75
s_add_u32 m0, s76, 24576
s_nop 0
buffer_load_dwordx4 v8, s[4:7], s74 offen offset:0 lds
buffer_load_dwordx4 v9, s[4:7], s74 offen offset:1024 lds
buffer_load_dwordx4 v10, s[4:7], s74 offen offset:2048 lds
buffer_load_dwordx4 v11, s[4:7], s74 offen offset:3072 lds
s_add_u32 s74, s74, 128
s_and_b32 s74, s74, 2047
buffer_load_dwordx4 a[76:79], v78, s[32:35], s86 offen offset:2048 nt
buffer_load_dwordx4 a[80:83], v77, s[32:35], s86 offen offset:256 nt
buffer_load_dwordx4 a[84:87], v77, s[32:35], s86 offen offset:2304 nt
buffer_load_dwordx4 a[88:91], v78, s[32:35], s86 offen offset:256 nt
buffer_load_dwordx4 a[92:95], v78, s[32:35], s86 offen offset:2304 nt
s_waitcnt vmcnt(28)
s_barrier
s_add_u32 m0, s77, 0
s_nop 0
buffer_load_dwordx4 v12, s[8:11], s75 offen offset:0 lds
s_waitcnt vmcnt(19)
L_eg_chk:
v_xor_b32 v2, s68, v23
v_xor_b32 v3, s68, v27
v_xor_b32 v4, s68, v31
v_or3_b32 v2, v2, v3, v4
v_xor_b32 v3, s68, v35
v_xor_b32 v4, s68, v39
v_or3_b32 v2, v2, v3, v4
v_xor_b32 v3, s68, v43
v_or_b32 v2, v2, v3
v_cmp_ne_u32 vcc, 0, v2
s_cbranch_vccnz L_eg_rt
L_eg_ok:
v_add_f32 v20, v20, v24
buffer_load_dwordx4 v13, s[8:11], s75 offen offset:1024 lds
v_add_f32 v28, v28, v32
v_add_f32 v21, v21, v25
buffer_load_dwordx4 v14, s[8:11], s75 offen offset:2048 lds
v_add_f32 v29, v29, v33
v_add_f32 v22, v22, v26
buffer_load_dwordx4 v15, s[8:11], s75 offen offset:3072 lds
v_add_f32 v30, v30, v34
v_add_f32 v20, v20, v28
s_add_u32 m0, s77, 4096
s_nop 0
buffer_load_dwordx4 v16, s[8:11], s75 offen offset:0 lds
v_add_f32 v21, v21, v29
v_add_f32 v22, v22, v30
buffer_load_dwordx4 v17, s[8:11], s75 offen offset:1024 lds
s_add_u32 s75, s75, 393216
s_cmp_eq_u32 s75, 6291456
s_cselect_b32 s75, 0, s75
v_mov_b32 v24, v20
v_mov_b32 v25, v21
s_mul_i32 s70, s60, 9
s_add_u32 s70, s70, 92
s_lshl_b32 s82, s89, 3
s_add_u32 s82, s82, s70
s_lshl_b32 s70, s70, 10
s_add_u32 m0, s70, 28672
s_and_b32 s82, s82, 127
s_lshl_b32 s82, s82, 14
buffer_load_dwordx4 v80, s[16:19], s82 offen lds
v_mov_b32 v26, v22
v_permlane16_swap_b32 v20, v24
s_add_u32 m0, m0, 1024
s_add_u32 s82, s82, 16384
s_and_b32 s82, s82, 0x1fffff
buffer_load_dwordx4 v80, s[16:19], s82 offen lds
v_permlane16_swap_b32 v21, v25
v_permlane16_swap_b32 v22, v26
s_add_u32 m0, m0, 1024
s_add_u32 s82, s82, 16384
s_and_b32 s82, s82, 0x1fffff
buffer_load_dwordx4 v80, s[16:19], s82 offen lds
v_add_f32 v20, v20, v24
v_add_f32 v21, v21, v25
s_add_u32 m0, m0, 1024
s_add_u32 s82, s82, 16384
s_and_b32 s82, s82, 0x1fffff
buffer_load_dwordx4 v80, s[16:19], s82 offen lds
v_add_f32 v22, v22, v26
v_mov_b32 v24, v20
s_add_u32 m0, m0, 1024
s_add_u32 s82, s82, 16384
s_and_b32 s82, s82, 0x1fffff
buffer_load_dwordx4 v80, s[16:19], s82 offen lds
v_mov_b32 v25, v21
s_add_u32 m0, m0, 1024
s_add_u32 s82, s82, 16384
s_and_b32 s82, s82, 0x1fffff
buffer_load_dwordx4 v80, s[16:19], s82 offen lds
s_add_u32 m0, m0, 1024
s_add_u32 s82, s82, 16384
s_and_b32 s82, s82, 0x1fffff
buffer_load_dwordx4 v80, s[16:19], s82 offen lds
s_add_u32 m0, m0, 1024
s_add_u32 s82, s82, 16384
s_and_b32 s82, s82, 0x1fffff
buffer_load_dwordx4 v80, s[16:19], s82 offen lds
s_add_u32 m0, m0, 1024
s_add_u32 s82, s82, 16384
s_and_b32 s82, s82, 0x1fffff
buffer_load_dwordx4 v80, s[16:19], s82 offen lds
s_waitcnt vmcnt(24)
s_barrier
s_mul_i32 s70, s60, 10
s_add_u32 s70, s70, 52
s_lshl_b32 s82, s89, 3
s_add_u32 s82, s82, s70
s_lshl_b32 s70, s70, 10
s_add_u32 m0, s70, 28672
s_and_b32 s82, s82, 127
s_lshl_b32 s82, s82, 14
buffer_load_dwordx4 v80, s[16:19], s82 offen lds
v_mov_b32 v26, v22
v_permlane32_swap_b32 v20, v24
v_permlane32_swap_b32 v21, v25
s_add_u32 m0, m0, 1024
s_add_u32 s82, s82, 16384
s_and_b32 s82, s82, 0x1fffff
buffer_load_dwordx4 v80, s[16:19], s82 offen lds
v_permlane32_swap_b32 v22, v26
v_add_f32 v20, v20, v24
v_add_f32 v21, v21, v25
s_add_u32 m0, m0, 1024
s_add_u32 s82, s82, 16384
s_and_b32 s82, s82, 0x1fffff
buffer_load_dwordx4 v80, s[16:19], s82 offen lds
v_add_f32 v22, v22, v26
v_and_b32 v3, 15, v1
v_lshlrev_b32 v3, 2, v3
s_add_u32 m0, m0, 1024
s_add_u32 s82, s82, 16384
s_and_b32 s82, s82, 0x1fffff
buffer_load_dwordx4 v80, s[16:19], s82 offen lds
s_lshl_b32 s70, s60, 6
s_add_u32 s70, s70, 160768
v_add_u32 v3, s70, v3
ds_write_b32 v3, v20 offset:0
ds_write_b32 v3, v21 offset:256
s_add_u32 m0, m0, 1024
s_add_u32 s82, s82, 16384
s_and_b32 s82, s82, 0x1fffff
buffer_load_dwordx4 v80, s[16:19], s82 offen lds
ds_write_b32 v3, v22 offset:512
v_lshrrev_b32 v4, 2, v45
s_lshl_b32 s70, s60, 7
s_add_u32 s70, s70, 159744
v_add_u32 v4, s70, v4
s_add_u32 m0, m0, 1024
s_add_u32 s82, s82, 16384
s_and_b32 s82, s82, 0x1fffff
buffer_load_dwordx4 v80, s[16:19], s82 offen lds
ds_write_b32 v4, v36
ds_write_b32 v4, v37 offset:512
s_getreg_b32 s71, hwreg(HW_REG_XCC_ID, 0, 4)
v_cmp_ne_u32 vcc, s71, v40
s_nop 0
s_and_b32 s70, vcc_lo, 0xffff
s_cselect_b32 s69, 0, 1
s_add_u32 m0, m0, 1024
s_add_u32 s82, s82, 16384
s_and_b32 s82, s82, 0x1fffff
buffer_load_dwordx4 v80, s[16:19], s82 offen lds
v_mov_b32 v5, s69
v_mov_b32 v6, 161536
ds_write_b32 v6, v5
s_add_u32 m0, m0, 1024
s_add_u32 s82, s82, 16384
s_and_b32 s82, s82, 0x1fffff
buffer_load_dwordx4 v80, s[16:19], s82 offen lds
s_add_u32 m0, m0, 1024
s_add_u32 s82, s82, 16384
s_and_b32 s82, s82, 0x1fffff
buffer_load_dwordx4 v80, s[16:19], s82 offen lds
s_add_u32 m0, m0, 1024
s_add_u32 s82, s82, 16384
s_and_b32 s82, s82, 0x1fffff
buffer_load_dwordx4 v80, s[16:19], s82 offen lds
s_waitcnt vmcnt(19)
s_barrier
s_mul_i32 s70, s60, 10
s_add_u32 s70, s70, 12
s_lshl_b32 s82, s89, 3
s_add_u32 s82, s82, s70
s_lshl_b32 s70, s70, 10
s_add_u32 m0, s70, 28672
s_and_b32 s82, s82, 127
s_lshl_b32 s82, s82, 14
buffer_load_dwordx4 v80, s[16:19], s82 offen lds
s_add_u32 m0, m0, 1024
s_add_u32 s82, s82, 16384
s_and_b32 s82, s82, 0x1fffff
buffer_load_dwordx4 v80, s[16:19], s82 offen lds
s_add_u32 m0, m0, 1024
s_add_u32 s82, s82, 16384
s_and_b32 s82, s82, 0x1fffff
buffer_load_dwordx4 v80, s[16:19], s82 offen lds
s_add_u32 m0, m0, 1024
s_add_u32 s82, s82, 16384
s_and_b32 s82, s82, 0x1fffff
buffer_load_dwordx4 v80, s[16:19], s82 offen lds
s_add_u32 m0, m0, 1024
s_add_u32 s82, s82, 16384
s_and_b32 s82, s82, 0x1fffff
buffer_load_dwordx4 v80, s[16:19], s82 offen lds
s_add_u32 m0, m0, 1024
s_add_u32 s82, s82, 16384
s_and_b32 s82, s82, 0x1fffff
buffer_load_dwordx4 v80, s[16:19], s82 offen lds
s_add_u32 m0, m0, 1024
s_add_u32 s82, s82, 16384
s_and_b32 s82, s82, 0x1fffff
buffer_load_dwordx4 v80, s[16:19], s82 offen lds
s_add_u32 m0, m0, 1024
s_add_u32 s82, s82, 16384
s_and_b32 s82, s82, 0x1fffff
buffer_load_dwordx4 v80, s[16:19], s82 offen lds
s_add_u32 m0, m0, 1024
s_add_u32 s82, s82, 16384
s_and_b32 s82, s82, 0x1fffff
buffer_load_dwordx4 v80, s[16:19], s82 offen lds
s_add_u32 m0, m0, 1024
s_add_u32 s82, s82, 16384
s_and_b32 s82, s82, 0x1fffff
buffer_load_dwordx4 v80, s[16:19], s82 offen lds
s_setprio 0
s_waitcnt lgkmcnt(0)
s_barrier
s_mul_i32 s70, s60, 3
s_add_u32 s70, s70, 0
s_lshl_b32 s82, s89, 3
s_add_u32 s82, s82, s70
s_lshl_b32 s70, s70, 10
s_add_u32 m0, s70, 28672
s_and_b32 s82, s82, 127
s_lshl_b32 s82, s82, 14
buffer_load_dwordx4 v80, s[16:19], s82 offen lds
s_add_u32 m0, m0, 1024
s_add_u32 s82, s82, 16384
s_and_b32 s82, s82, 0x1fffff
buffer_load_dwordx4 v80, s[16:19], s82 offen lds
s_add_u32 m0, m0, 1024
s_add_u32 s82, s82, 16384
s_and_b32 s82, s82, 0x1fffff
buffer_load_dwordx4 v80, s[16:19], s82 offen lds
s_sub_i32 s70, s64, s65
s_lshl_b32 s70, s70, 18
v_add_u32 v8, s70, v8
v_add_u32 v9, s70, v9
v_add_u32 v10, s70, v10
v_add_u32 v11, s70, v11
s_lshl_b32 s70, s65, 7
s_mov_b32 m0, s76
s_nop 0
buffer_load_dwordx4 v8, s[4:7], s70 offen offset:0 lds
buffer_load_dwordx4 v9, s[4:7], s70 offen offset:1024 lds
buffer_load_dwordx4 v10, s[4:7], s70 offen offset:2048 lds
buffer_load_dwordx4 v11, s[4:7], s70 offen offset:3072 lds
v_lshrrev_b32 v2, 4, v1
v_bfe_u32 v3, v1, 2, 2
v_and_b32 v4, 1, v1
v_lshlrev_b32 v4, 4, v4
v_mov_b32 v5, 0x3f80
v_lshlrev_b32 v4, v4, v5
v_cmp_eq_u32 vcc, v2, v3
s_nop 1
v_cndmask_b32 v4, 0, v4, vcc
v_and_b32 v5, 2, v1
v_cmp_eq_u32 vcc, 0, v5
s_nop 1
v_cndmask_b32 v58, 0, v4, vcc
v_cndmask_b32_e64 v59, v4, 0, vcc
v_mov_b32 v56, 0
v_mov_b32 v57, 0
v_mov_b32 v60, 0
v_mov_b32 v61, 0
v_and_b32 v3, 15, v1
v_mul_u32_u24 v55, 4352, v3
v_lshrrev_b32 v2, 4, v1
v_lshl_add_u32 v55, v2, 5, v55
s_mul_i32 s87, s64, 69632
s_add_u32 s87, s87, 524288
s_lshl_b32 s70, s66, 7
s_lshl_b32 s71, s67, 4
s_add_u32 s88, s70, s71
s_add_u32 s88, s88, s87
s_add_u32 s88, s88, 4096
s_lshl_b32 s70, s60, 10
s_add_u32 s87, s87, s70
s_barrier
s_add_u32 s70, s65, 1
s_and_b32 s70, s70, 15
s_mul_i32 s70, s70, 4352
s_add_u32 s70, s70, s87
buffer_load_dwordx4 v[84:87], v18, s[12:15], s70 offen sc1
s_add_u32 s70, s65, 2
s_and_b32 s70, s70, 15
s_mul_i32 s70, s70, 4352
s_add_u32 s70, s70, s87
buffer_load_dwordx4 v[88:91], v18, s[12:15], s70 offen sc1
s_add_u32 s70, s65, 3
s_and_b32 s70, s70, 15
s_mul_i32 s70, s70, 4352
s_add_u32 s70, s70, s87
buffer_load_dwordx4 v[92:95], v18, s[12:15], s70 offen sc1
s_add_u32 s70, s65, 4
s_and_b32 s70, s70, 15
s_mul_i32 s70, s70, 4352
s_add_u32 s70, s70, s87
buffer_load_dwordx4 v[96:99], v18, s[12:15], s70 offen sc1
s_add_u32 s70, s65, 5
s_and_b32 s70, s70, 15
s_mul_i32 s70, s70, 4352
s_add_u32 s70, s70, s87
buffer_load_dwordx4 v[100:103], v18, s[12:15], s70 offen sc1
s_add_u32 s70, s65, 6
s_and_b32 s70, s70, 15
s_mul_i32 s70, s70, 4352
s_add_u32 s70, s70, s87
buffer_load_dwordx4 v[104:107], v18, s[12:15], s70 offen sc1
s_add_u32 s70, s65, 7
s_and_b32 s70, s70, 15
s_mul_i32 s70, s70, 4352
s_add_u32 s70, s70, s87
buffer_load_dwordx4 v[108:111], v18, s[12:15], s70 offen sc1
s_add_u32 s70, s65, 8
s_and_b32 s70, s70, 15
s_mul_i32 s70, s70, 4352
s_add_u32 s70, s70, s87
buffer_load_dwordx4 v[112:115], v18, s[12:15], s70 offen sc1
s_add_u32 s70, s65, 9
s_and_b32 s70, s70, 15
s_mul_i32 s70, s70, 4352
s_add_u32 s70, s70, s87
buffer_load_dwordx4 v[116:119], v18, s[12:15], s70 offen sc1
s_add_u32 s70, s65, 10
s_and_b32 s70, s70, 15
s_mul_i32 s70, s70, 4352
s_add_u32 s70, s70, s87
buffer_load_dwordx4 v[120:123], v18, s[12:15], s70 offen sc1
s_add_u32 s70, s65, 11
s_and_b32 s70, s70, 15
s_mul_i32 s70, s70, 4352
s_add_u32 s70, s70, s87
buffer_load_dwordx4 v[124:127], v18, s[12:15], s70 offen sc1
s_add_u32 s70, s65, 12
s_and_b32 s70, s70, 15
s_mul_i32 s70, s70, 4352
s_add_u32 s70, s70, s87
buffer_load_dwordx4 v[128:131], v18, s[12:15], s70 offen sc1
s_add_u32 s70, s65, 13
s_and_b32 s70, s70, 15
s_mul_i32 s70, s70, 4352
s_add_u32 s70, s70, s87
buffer_load_dwordx4 v[132:135], v18, s[12:15], s70 offen sc1
s_add_u32 s70, s65, 14
s_and_b32 s70, s70, 15
s_mul_i32 s70, s70, 4352
s_add_u32 s70, s70, s87
buffer_load_dwordx4 v[136:139], v18, s[12:15], s70 offen sc1
s_add_u32 s70, s65, 15
s_and_b32 s70, s70, 15
s_mul_i32 s70, s70, 4352
s_add_u32 s70, s70, s87
buffer_load_dwordx4 v[140:143], v18, s[12:15], s70 offen sc1
s_add_u32 s70, s65, 16
s_and_b32 s70, s70, 15
s_mul_i32 s70, s70, 4352
s_add_u32 s70, s70, s87
buffer_load_dwordx4 v[144:147], v18, s[12:15], s70 offen sc1
buffer_load_dwordx4 v[148:151], v55, s[12:15], s88 offen sc1
s_lshl_b32 s70, s66, 6
s_lshl_b32 s71, s67, 3
s_add_u32 s70, s70, s71
s_add_u32 s70, s70, 161600
v_lshrrev_b32 v4, 4, v1
v_lshlrev_b32 v4, 4, v4
v_add_u32 v4, s70, v4
s_lshl_b32 s70, s60, 10
s_add_u32 s70, s70, 24576
v_add_u32 v3, s70, v18
s_mov_b32 s73, 31
L_kvr:
s_bitcmp1_b32 s73, 0
s_cbranch_scc0 L_kvs0
s_waitcnt vmcnt(13)
v_max3_u32 v2, v84, v88, v92
v_max_u32 v2, v2, v96
v_cmp_eq_u32 vcc, -1, v2
s_cbranch_vccnz L_kvs0
s_bitset0_b32 s73, 0
v_mfma_f32_16x16x32_bf16 v[20:23], v[58:61], v[84:87], 0
v_mfma_f32_16x16x32_bf16 v[24:27], v[56:59], v[84:87], 0
v_mfma_f32_16x16x32_bf16 v[20:23], v[58:61], v[88:91], v[20:23]
v_mfma_f32_16x16x32_bf16 v[24:27], v[56:59], v[88:91], v[24:27]
v_mfma_f32_16x16x32_bf16 v[20:23], v[58:61], v[92:95], v[20:23]
v_mfma_f32_16x16x32_bf16 v[24:27], v[56:59], v[92:95], v[24:27]
v_mfma_f32_16x16x32_bf16 v[20:23], v[58:61], v[96:99], v[20:23]
v_mfma_f32_16x16x32_bf16 v[24:27], v[56:59], v[96:99], v[24:27]
L_kvs0:
s_bitcmp1_b32 s73, 1
s_cbranch_scc0 L_kvs1
s_waitcnt vmcnt(9)
v_max3_u32 v2, v100, v104, v108
v_max_u32 v2, v2, v112
v_cmp_eq_u32 vcc, -1, v2
s_cbranch_vccnz L_kvs1
s_bitset0_b32 s73, 1
v_mfma_f32_16x16x32_bf16 v[28:31], v[58:61], v[100:103], 0
v_mfma_f32_16x16x32_bf16 v[32:35], v[56:59], v[100:103], 0
v_mfma_f32_16x16x32_bf16 v[28:31], v[58:61], v[104:107], v[28:31]
v_mfma_f32_16x16x32_bf16 v[32:35], v[56:59], v[104:107], v[32:35]
v_mfma_f32_16x16x32_bf16 v[28:31], v[58:61], v[108:111], v[28:31]
v_mfma_f32_16x16x32_bf16 v[32:35], v[56:59], v[108:111], v[32:35]
v_mfma_f32_16x16x32_bf16 v[28:31], v[58:61], v[112:115], v[28:31]
v_mfma_f32_16x16x32_bf16 v[32:35], v[56:59], v[112:115], v[32:35]
L_kvs1:
s_bitcmp1_b32 s73, 2
s_cbranch_scc0 L_kvs2
s_waitcnt vmcnt(5)
v_max3_u32 v2, v116, v120, v124
v_max_u32 v2, v2, v128
v_cmp_eq_u32 vcc, -1, v2
s_cbranch_vccnz L_kvs2
s_bitset0_b32 s73, 2
v_mfma_f32_16x16x32_bf16 v[36:39], v[58:61], v[116:119], 0
v_mfma_f32_16x16x32_bf16 v[40:43], v[56:59], v[116:119], 0
v_mfma_f32_16x16x32_bf16 v[36:39], v[58:61], v[120:123], v[36:39]
v_mfma_f32_16x16x32_bf16 v[40:43], v[56:59], v[120:123], v[40:43]
v_mfma_f32_16x16x32_bf16 v[36:39], v[58:61], v[124:127], v[36:39]
v_mfma_f32_16x16x32_bf16 v[40:43], v[56:59], v[124:127], v[40:43]
v_mfma_f32_16x16x32_bf16 v[36:39], v[58:61], v[128:131], v[36:39]
v_mfma_f32_16x16x32_bf16 v[40:43], v[56:59], v[128:131], v[40:43]
L_kvs2:
s_bitcmp1_b32 s73, 3
s_cbranch_scc0 L_kvs3
s_waitcnt vmcnt(1)
v_max3_u32 v2, v132, v136, v140
v_max_u32 v2, v2, v144
v_cmp_eq_u32 vcc, -1, v2
s_cbranch_vccnz L_kvs3
s_bitset0_b32 s73, 3
v_mfma_f32_16x16x32_bf16 v[44:47], v[58:61], v[132:135], 0
v_mfma_f32_16x16x32_bf16 v[48:51], v[56:59], v[132:135], 0
v_mfma_f32_16x16x32_bf16 v[44:47], v[58:61], v[136:139], v[44:47]
v_mfma_f32_16x16x32_bf16 v[48:51], v[56:59], v[136:139], v[48:51]
v_mfma_f32_16x16x32_bf16 v[44:47], v[58:61], v[140:143], v[44:47]
v_mfma_f32_16x16x32_bf16 v[48:51], v[56:59], v[140:143], v[48:51]
v_mfma_f32_16x16x32_bf16 v[44:47], v[58:61], v[144:147], v[44:47]
v_mfma_f32_16x16x32_bf16 v[48:51], v[56:59], v[144:147], v[48:51]
L_kvs3:
s_bitcmp1_b32 s73, 4
s_cbranch_scc0 L_kvs4
s_waitcnt vmcnt(0)
v_xor_b32 v148, s84, v148
v_xor_b32 v149, s84, v149
v_xor_b32 v150, s84, v150
v_xor_b32 v151, s84, v151
v_or3_b32 v2, v148, v149, v150
v_bitop3_b32 v2, v2, v151, s91 bitop3:0xa8
v_cmp_ne_u32 vcc, 0, v2
s_cbranch_vccnz L_kvs4
s_bitset0_b32 s73, 4
v_add_f32_dpp v148, v148, v148 row_ror:1 row_mask:0xf bank_mask:0xf
v_add_f32_dpp v149, v149, v149 row_ror:1 row_mask:0xf bank_mask:0xf
v_add_f32_dpp v150, v150, v150 row_ror:1 row_mask:0xf bank_mask:0xf
v_add_f32_dpp v151, v151, v151 row_ror:1 row_mask:0xf bank_mask:0xf
v_add_f32_dpp v148, v148, v148 row_ror:2 row_mask:0xf bank_mask:0xf
v_add_f32_dpp v149, v149, v149 row_ror:2 row_mask:0xf bank_mask:0xf
v_add_f32_dpp v150, v150, v150 row_ror:2 row_mask:0xf bank_mask:0xf
v_add_f32_dpp v151, v151, v151 row_ror:2 row_mask:0xf bank_mask:0xf
v_add_f32_dpp v148, v148, v148 row_ror:4 row_mask:0xf bank_mask:0xf
v_add_f32_dpp v149, v149, v149 row_ror:4 row_mask:0xf bank_mask:0xf
v_add_f32_dpp v150, v150, v150 row_ror:4 row_mask:0xf bank_mask:0xf
v_add_f32_dpp v151, v151, v151 row_ror:4 row_mask:0xf bank_mask:0xf
v_add_f32_dpp v148, v148, v148 row_ror:8 row_mask:0xf bank_mask:0xf
v_add_f32_dpp v149, v149, v149 row_ror:8 row_mask:0xf bank_mask:0xf
v_add_f32_dpp v150, v150, v150 row_ror:8 row_mask:0xf bank_mask:0xf
v_add_f32_dpp v151, v151, v151 row_ror:8 row_mask:0xf bank_mask:0xf
v_cvt_pk_bf16_f32 v148, v148, v149
v_cvt_pk_bf16_f32 v149, v150, v151
ds_write_b64 v4, v[148:149]
L_kvs4:
s_cmp_lg_u32 s73, 0
s_cbranch_scc1 L_kvrt
L_kvok:
s_nop 3
v_pk_add_f32 v[20:21], v[20:21], v[28:29]
v_pk_add_f32 v[22:23], v[22:23], v[30:31]
v_pk_add_f32 v[24:25], v[24:25], v[32:33]
v_pk_add_f32 v[26:27], v[26:27], v[34:35]
v_pk_add_f32 v[36:37], v[36:37], v[44:45]
v_pk_add_f32 v[38:39], v[38:39], v[46:47]
v_pk_add_f32 v[40:41], v[40:41], v[48:49]
v_pk_add_f32 v[42:43], v[42:43], v[50:51]
v_pk_add_f32 v[20:21], v[20:21], v[36:37]
v_pk_add_f32 v[22:23], v[22:23], v[38:39]
v_pk_add_f32 v[24:25], v[24:25], v[40:41]
v_pk_add_f32 v[26:27], v[26:27], v[42:43]
v_cvt_pk_bf16_f32 v20, v20, v21
v_cvt_pk_bf16_f32 v21, v22, v23
v_cvt_pk_bf16_f32 v22, v24, v25
v_cvt_pk_bf16_f32 v23, v26, v27
ds_write_b128 v3, v[20:23]
s_waitcnt lgkmcnt(0)
s_barrier
s_barrier
s_cmp_ge_u32 s64, 14
s_cbranch_scc1 L_noprep0
v_lshrrev_b32 v2, 5, v1
v_lshlrev_b32 v2, 11, v2
v_bfe_u32 v3, v1, 3, 2
v_lshl_add_u32 v2, v3, 7, v2
v_bfe_u32 v3, v1, 4, 1
v_bfe_u32 v4, v1, 1, 2
v_xor_b32 v3, v3, v4
v_lshl_add_u32 v2, v3, 5, v2
v_and_b32 v3, 1, v1
v_lshl_add_u32 v2, v3, 4, v2
s_lshl_b32 s70, s60, 13
s_add_u32 s70, s70, 65536
v_add_u32 v2, s70, v2
v_xor_b32 v3, 64, v2
s_mov_b32 s94, 0x05040100
s_mov_b32 s95, 0x07060302
s_waitcnt vmcnt(0)
ds_write_b128 v2, a[0:3] offset:0
ds_write_b128 v3, a[4:7] offset:512
ds_write_b128 v2, a[8:11] offset:1024
ds_write_b128 v3, a[12:15] offset:1536
ds_write_b128 v2, a[16:19] offset:4096
ds_write_b128 v3, a[20:23] offset:4608
ds_write_b128 v2, a[24:27] offset:5120
ds_write_b128 v3, a[28:31] offset:5632
ds_write_b128 v2, a[32:35] offset:32768
ds_write_b128 v3, a[36:39] offset:33280
ds_write_b128 v2, a[40:43] offset:33792
ds_write_b128 v3, a[44:47] offset:34304
ds_write_b128 v2, a[48:51] offset:36864
ds_write_b128 v3, a[52:55] offset:37376
ds_write_b128 v2, a[56:59] offset:37888
ds_write_b128 v3, a[60:63] offset:38400
v_accvgpr_read_b32 v84, a64
v_accvgpr_read_b32 v85, a65
v_accvgpr_read_b32 v86, a66
v_accvgpr_read_b32 v87, a67
v_accvgpr_read_b32 v88, a68
v_accvgpr_read_b32 v89, a69
v_accvgpr_read_b32 v90, a70
v_accvgpr_read_b32 v91, a71
v_accvgpr_read_b32 v92, a72
v_accvgpr_read_b32 v93, a73
v_accvgpr_read_b32 v94, a74
v_accvgpr_read_b32 v95, a75
v_accvgpr_read_b32 v96, a76
v_accvgpr_read_b32 v97, a77
v_accvgpr_read_b32 v98, a78
v_accvgpr_read_b32 v99, a79
v_accvgpr_read_b32 v100, a80
v_accvgpr_read_b32 v101, a81
v_accvgpr_read_b32 v102, a82
v_accvgpr_read_b32 v103, a83
v_accvgpr_read_b32 v104, a84
v_accvgpr_read_b32 v105, a85
v_accvgpr_read_b32 v106, a86
v_accvgpr_read_b32 v107, a87
v_accvgpr_read_b32 v108, a88
v_accvgpr_read_b32 v109, a89
v_accvgpr_read_b32 v110, a90
v_accvgpr_read_b32 v111, a91
v_accvgpr_read_b32 v112, a92
v_accvgpr_read_b32 v113, a93
v_accvgpr_read_b32 v114, a94
v_accvgpr_read_b32 v115, a95
v_perm_b32 v116, v88, v84, s94
v_perm_b32 v117, v96, v92, s94
v_perm_b32 v118, v88, v84, s95
v_perm_b32 v119, v96, v92, s95
v_perm_b32 v120, v89, v85, s94
v_perm_b32 v121, v97, v93, s94
v_perm_b32 v122, v89, v85, s95
v_perm_b32 v123, v97, v93, s95
v_perm_b32 v124, v90, v86, s94
v_perm_b32 v125, v98, v94, s94
v_perm_b32 v126, v90, v86, s95
v_perm_b32 v127, v98, v94, s95
v_perm_b32 v128, v91, v87, s94
v_perm_b32 v129, v99, v95, s94
v_perm_b32 v130, v91, v87, s95
v_perm_b32 v131, v99, v95, s95
v_perm_b32 v132, v104, v100, s94
v_perm_b32 v133, v112, v108, s94
v_perm_b32 v134, v104, v100, s95
v_perm_b32 v135, v112, v108, s95
v_perm_b32 v136, v105, v101, s94
v_perm_b32 v137, v113, v109, s94
v_perm_b32 v138, v105, v101, s95
v_perm_b32 v139, v113, v109, s95
v_perm_b32 v140, v106, v102, s94
v_perm_b32 v141, v114, v110, s94
v_perm_b32 v142, v106, v102, s95
v_perm_b32 v143, v114, v110, s95
v_perm_b32 v144, v107, v103, s94
v_perm_b32 v145, v115, v111, s94
v_perm_b32 v146, v107, v103, s95
v_perm_b32 v147, v115, v111, s95
s_waitcnt lgkmcnt(0)
L_noprep0:
s_barrier
s_cmp_ge_u32 s64, 14
s_cbranch_scc1 L_noprep
v_lshrrev_b32 v2, 2, v1
v_bfe_u32 v3, v1, 3, 2
v_xor_b32 v3, s60, v3
v_lshlrev_b32 v3, 5, v3
v_lshl_add_u32 v3, v2, 7, v3
v_and_b32 v2, 3, v1
v_lshl_add_u32 v3, v2, 3, v3
v_add_u32 v3, 65536, v3
ds_read_b64_tr_b16 a[0:1], v3 offset:0
ds_read_b64_tr_b16 a[2:3], v3 offset:2048
ds_read_b64_tr_b16 a[32:33], v3 offset:32768
ds_read_b64_tr_b16 a[34:35], v3 offset:34816
ds_read_b64_tr_b16 a[4:5], v3 offset:4096
ds_read_b64_tr_b16 a[6:7], v3 offset:6144
ds_read_b64_tr_b16 a[36:37], v3 offset:36864
ds_read_b64_tr_b16 a[38:39], v3 offset:38912
ds_read_b64_tr_b16 a[8:9], v3 offset:8192
ds_read_b64_tr_b16 a[10:11], v3 offset:10240
ds_read_b64_tr_b16 a[40:41], v3 offset:40960
ds_read_b64_tr_b16 a[42:43], v3 offset:43008
ds_read_b64_tr_b16 a[12:13], v3 offset:12288
ds_read_b64_tr_b16 a[14:15], v3 offset:14336
ds_read_b64_tr_b16 a[44:45], v3 offset:45056
ds_read_b64_tr_b16 a[46:47], v3 offset:47104
ds_read_b64_tr_b16 a[16:17], v3 offset:16384
ds_read_b64_tr_b16 a[18:19], v3 offset:18432
ds_read_b64_tr_b16 a[48:49], v3 offset:49152
ds_read_b64_tr_b16 a[50:51], v3 offset:51200
ds_read_b64_tr_b16 a[20:21], v3 offset:20480
ds_read_b64_tr_b16 a[22:23], v3 offset:22528
ds_read_b64_tr_b16 a[52:53], v3 offset:53248
ds_read_b64_tr_b16 a[54:55], v3 offset:55296
ds_read_b64_tr_b16 a[24:25], v3 offset:24576
ds_read_b64_tr_b16 a[26:27], v3 offset:26624
ds_read_b64_tr_b16 a[56:57], v3 offset:57344
ds_read_b64_tr_b16 a[58:59], v3 offset:59392
ds_read_b64_tr_b16 a[28:29], v3 offset:28672
ds_read_b64_tr_b16 a[30:31], v3 offset:30720
ds_read_b64_tr_b16 a[60:61], v3 offset:61440
ds_read_b64_tr_b16 a[62:63], v3 offset:63488
v_mov_b32 v64, 0x3f803f80
v_mov_b32 v65, 0x3f803f80
v_mov_b32 v66, 0x3f803f80
v_mov_b32 v67, 0x3f803f80
s_waitcnt lgkmcnt(0)
s_nop 0
v_mfma_f32_16x16x32_bf16 v[68:71], a[0:3], v[64:67], 0
v_mfma_f32_16x16x32_bf16 v[72:75], a[32:35], v[64:67], 0
v_mfma_f32_16x16x32_bf16 v[68:71], a[4:7], v[64:67], v[68:71]
v_mfma_f32_16x16x32_bf16 v[72:75], a[36:39], v[64:67], v[72:75]
v_mfma_f32_16x16x32_bf16 v[68:71], a[8:11], v[64:67], v[68:71]
v_mfma_f32_16x16x32_bf16 v[72:75], a[40:43], v[64:67], v[72:75]
v_mfma_f32_16x16x32_bf16 v[68:71], a[12:15], v[64:67], v[68:71]
v_mfma_f32_16x16x32_bf16 v[72:75], a[44:47], v[64:67], v[72:75]
v_mfma_f32_16x16x32_bf16 v[68:71], a[16:19], v[64:67], v[68:71]
v_mfma_f32_16x16x32_bf16 v[72:75], a[48:51], v[64:67], v[72:75]
v_mfma_f32_16x16x32_bf16 v[68:71], a[20:23], v[64:67], v[68:71]
v_mfma_f32_16x16x32_bf16 v[72:75], a[52:55], v[64:67], v[72:75]
v_mfma_f32_16x16x32_bf16 v[68:71], a[24:27], v[64:67], v[68:71]
v_mfma_f32_16x16x32_bf16 v[72:75], a[56:59], v[64:67], v[72:75]
v_mfma_f32_16x16x32_bf16 v[68:71], a[28:31], v[64:67], v[68:71]
v_mfma_f32_16x16x32_bf16 v[72:75], a[60:63], v[64:67], v[72:75]
s_mov_b32 exec_lo, 0x0
s_mov_b32 exec_hi, 0xffff
buffer_load_dword v81, v83, s[12:15], 0 offen
s_mov_b64 exec, -1
L_noprep:
v_and_b32 v2, 1, v1
v_lshlrev_b32 v56, 4, v2
v_add_u32 v56, 161856, v56
v_lshrrev_b32 v3, 4, v1
v_lshlrev_b32 v57, 4, v3
s_and_b32 s71, s65, 3
s_lshl_b32 s70, s71, 9
s_add_u32 s70, s70, 6881280
v_add_u32 v57, s70, v57
v_and_b32 v58, 3, v1
v_lshlrev_b32 v58, 6, v58
v_lshl_add_u32 v58, v3, 4, v58
s_sub_u32 s85, s79, s71
s_add_u32 s85, s85, s60
s_lshl_b32 s85, s85, 10
s_lshl_b32 s71, s71, 8
s_add_u32 s85, s85, s71
s_add_u32 s85, s85, 6946816
s_lshl_b32 s86, s79, 10
s_add_u32 s86, s86, 6946816
v_bfe_u32 v60, v1, 1, 3
v_mov_b32 v59, s68
s_barrier
ds_read_b128 v[20:23], v56
s_mov_b32 s92, 0x00030003
s_mov_b32 s93, 0x00030003
s_sub_u32 s88, s63, 24
s_lshl_b32 s70, s62, 3
s_add_u32 s88, s88, s70
s_waitcnt lgkmcnt(0)
s_cmp_ge_u32 s64, 14
s_cbranch_scc1 L_nomoe
v_lshl_add_u32 v57, v23, 11, v57
s_mov_b64 exec, s[92:93]
buffer_load_dwordx4 v[24:27], v57, s[12:15], 0 offen offset:0 sc1
buffer_load_dwordx4 v[28:31], v57, s[12:15], 0 offen offset:64 sc1
buffer_load_dwordx4 v[32:35], v57, s[12:15], 0 offen offset:128 sc1
buffer_load_dwordx4 v[36:39], v57, s[12:15], 0 offen offset:192 sc1
buffer_load_dwordx4 v[40:43], v57, s[12:15], 0 offen offset:256 sc1
buffer_load_dwordx4 v[44:47], v57, s[12:15], 0 offen offset:320 sc1
buffer_load_dwordx4 v[48:51], v57, s[12:15], 0 offen offset:384 sc1
buffer_load_dwordx4 v[52:55], v57, s[12:15], 0 offen offset:448 sc1
v_mul_f32_e64 v68, v68, -v21
v_mul_f32_e64 v69, v69, -v21
v_mul_f32_e64 v70, v70, -v21
v_mul_f32_e64 v71, v71, -v21
v_mul_f32_e64 v72, v72, -v21
v_mul_f32_e64 v73, v73, -v21
v_mul_f32_e64 v74, v74, -v21
v_mul_f32_e64 v75, v75, -v21
s_waitcnt vmcnt(0)
L_x_chk:
v_max3_u32 v2, v24, v28, v32
v_max3_u32 v3, v36, v40, v44
v_max3_u32 v2, v2, v48, v52
v_max_u32 v2, v2, v3
v_cmp_eq_u32 vcc, -1, v2
s_cbranch_vccnz L_x_rt
L_x_ok:
s_mov_b64 exec, -1
v_mfma_f32_16x16x32_bf16 v[68:71], a[0:3], v[24:27], v[68:71]
v_mfma_f32_16x16x32_bf16 v[72:75], a[32:35], v[24:27], v[72:75]
v_mfma_f32_16x16x32_bf16 v[68:71], a[4:7], v[28:31], v[68:71]
v_mfma_f32_16x16x32_bf16 v[72:75], a[36:39], v[28:31], v[72:75]
v_mfma_f32_16x16x32_bf16 v[68:71], a[8:11], v[32:35], v[68:71]
v_mfma_f32_16x16x32_bf16 v[72:75], a[40:43], v[32:35], v[72:75]
v_mfma_f32_16x16x32_bf16 v[68:71], a[12:15], v[36:39], v[68:71]
v_mfma_f32_16x16x32_bf16 v[72:75], a[44:47], v[36:39], v[72:75]
v_mfma_f32_16x16x32_bf16 v[68:71], a[16:19], v[40:43], v[68:71]
v_mfma_f32_16x16x32_bf16 v[72:75], a[48:51], v[40:43], v[72:75]
v_mfma_f32_16x16x32_bf16 v[68:71], a[20:23], v[44:47], v[68:71]
v_mfma_f32_16x16x32_bf16 v[72:75], a[52:55], v[44:47], v[72:75]
v_mfma_f32_16x16x32_bf16 v[68:71], a[24:27], v[48:51], v[68:71]
v_mfma_f32_16x16x32_bf16 v[72:75], a[56:59], v[48:51], v[72:75]
v_mfma_f32_16x16x32_bf16 v[68:71], a[28:31], v[52:55], v[68:71]
v_mfma_f32_16x16x32_bf16 v[72:75], a[60:63], v[52:55], v[72:75]
s_nop 6
v_bfi_b32 v68, s91, v59, v68
v_bfi_b32 v69, s91, v59, v69
v_bfi_b32 v70, s91, v59, v70
v_bfi_b32 v71, s91, v59, v71
v_bfi_b32 v72, s91, v59, v72
v_bfi_b32 v73, s91, v59, v73
v_bfi_b32 v74, s91, v59, v74
v_bfi_b32 v75, s91, v59, v75
s_mov_b64 exec, s[92:93]
s_cmp_eq_u32 s69, 0
s_cbranch_scc1 L_pxp_s
buffer_store_dwordx4 v[68:71], v58, s[12:15], s85 offen offset:0
buffer_store_dwordx4 v[72:75], v58, s[12:15], s85 offen offset:128
L_pxp_d:
s_mov_b64 exec, -1
buffer_load_dwordx4 v[24:27], v58, s[12:15], s86 offen offset:0 sc1
buffer_load_dwordx4 v[28:31], v58, s[12:15], s86 offen offset:256 sc1
buffer_load_dwordx4 v[32:35], v58, s[12:15], s86 offen offset:512 sc1
buffer_load_dwordx4 v[36:39], v58, s[12:15], s86 offen offset:768 sc1
s_waitcnt vmcnt(0)
L_px_chk:
v_xor_b32 v24, s84, v24
v_xor_b32 v25, s84, v25
v_xor_b32 v26, s84, v26
v_xor_b32 v27, s84, v27
v_or3_b32 v2, v24, v25, v26
v_xor_b32 v28, s84, v28
v_xor_b32 v29, s84, v29
v_or3_b32 v2, v2, v27, v28
v_xor_b32 v30, s84, v30
v_xor_b32 v31, s84, v31
v_or3_b32 v2, v2, v29, v30
v_xor_b32 v32, s84, v32
v_xor_b32 v33, s84, v33
v_or3_b32 v2, v2, v31, v32
v_xor_b32 v34, s84, v34
v_xor_b32 v35, s84, v35
v_or3_b32 v2, v2, v33, v34
v_xor_b32 v36, s84, v36
v_xor_b32 v37, s84, v37
v_or3_b32 v2, v2, v35, v36
v_xor_b32 v38, s84, v38
v_xor_b32 v39, s84, v39
v_or3_b32 v2, v2, v37, v38
v_bitop3_b32 v2, v2, v39, s91 bitop3:0xa8
v_cmp_ne_u32 vcc, 0, v2
s_cbranch_vccnz L_px_rt
L_px_ok:
v_pk_add_f32 v[24:25], v[24:25], v[28:29]
v_pk_add_f32 v[32:33], v[32:33], v[36:37]
v_pk_add_f32 v[26:27], v[26:27], v[30:31]
v_pk_add_f32 v[34:35], v[34:35], v[38:39]
v_pk_add_f32 v[24:25], v[24:25], v[32:33]
v_pk_add_f32 v[26:27], v[26:27], v[34:35]
v_pk_mul_f32 v[24:25], v[24:25], v[22:23] op_sel_hi:[1,0]
v_pk_mul_f32 v[26:27], v[26:27], v[22:23] op_sel_hi:[1,0]
v_mul_f32 v28, 0xbfb8aa3b, v24
v_mul_f32 v29, 0xbfb8aa3b, v25
v_mul_f32 v30, 0xbfb8aa3b, v26
v_mul_f32 v31, 0xbfb8aa3b, v27
v_exp_f32 v28, v28
v_exp_f32 v29, v29
v_exp_f32 v30, v30
v_exp_f32 v31, v31
v_mul_f32_dpp v32, v24, v24 quad_perm:[2,3,0,1] row_mask:0xf bank_mask:0xf
v_mul_f32_dpp v33, v25, v25 quad_perm:[2,3,0,1] row_mask:0xf bank_mask:0xf
v_mul_f32_dpp v34, v26, v26 quad_perm:[2,3,0,1] row_mask:0xf bank_mask:0xf
v_mul_f32_dpp v35, v27, v27 quad_perm:[2,3,0,1] row_mask:0xf bank_mask:0xf
v_add_f32 v28, 1.0, v28
v_add_f32 v29, 1.0, v29
v_add_f32 v30, 1.0, v30
v_add_f32 v31, 1.0, v31
v_rcp_f32 v28, v28
v_rcp_f32 v29, v29
v_rcp_f32 v30, v30
v_rcp_f32 v31, v31
v_mul_f32 v24, v32, v28
v_mul_f32 v25, v33, v29
v_mul_f32 v26, v34, v30
v_mul_f32 v27, v35, v31
v_cvt_pk_bf16_f32 v28, v24, v25
v_cvt_pk_bf16_f32 v29, v26, v27
s_nop 0
v_mov_b32_dpp v24, v28 quad_perm:[0,1,0,1] row_mask:0xf bank_mask:0xf
v_mov_b32_dpp v25, v29 quad_perm:[0,1,0,1] row_mask:0xf bank_mask:0xf
v_cmp_eq_u32 vcc, 0, v60
s_nop 1
v_cndmask_b32 v32, 0, v24, vcc
v_cndmask_b32 v33, 0, v25, vcc
v_cmp_eq_u32 vcc, 1, v60
s_nop 1
v_cndmask_b32 v34, 0, v24, vcc
v_cndmask_b32 v35, 0, v25, vcc
v_cmp_eq_u32 vcc, 2, v60
s_nop 1
v_cndmask_b32 v36, 0, v24, vcc
v_cndmask_b32 v37, 0, v25, vcc
v_cmp_eq_u32 vcc, 3, v60
s_nop 1
v_cndmask_b32 v38, 0, v24, vcc
v_cndmask_b32 v39, 0, v25, vcc
v_cmp_eq_u32 vcc, 4, v60
s_nop 1
v_cndmask_b32 v40, 0, v24, vcc
v_cndmask_b32 v41, 0, v25, vcc
v_cmp_eq_u32 vcc, 5, v60
s_nop 1
v_cndmask_b32 v42, 0, v24, vcc
v_cndmask_b32 v43, 0, v25, vcc
v_cmp_eq_u32 vcc, 6, v60
s_nop 1
v_cndmask_b32 v44, 0, v24, vcc
v_cndmask_b32 v45, 0, v25, vcc
v_cmp_eq_u32 vcc, 7, v60
s_nop 1
v_cndmask_b32 v46, 0, v24, vcc
v_cndmask_b32 v47, 0, v25, vcc
v_mfma_f32_16x16x32_bf16 v[68:71], v[116:119], v[32:35], 0
v_mfma_f32_16x16x32_bf16 v[72:75], v[132:135], v[32:35], 0
v_mfma_f32_16x16x32_bf16 v[68:71], v[120:123], v[36:39], v[68:71]
v_mfma_f32_16x16x32_bf16 v[72:75], v[136:139], v[36:39], v[72:75]
v_mfma_f32_16x16x32_bf16 v[68:71], v[124:127], v[40:43], v[68:71]
v_mfma_f32_16x16x32_bf16 v[72:75], v[140:143], v[40:43], v[72:75]
v_mfma_f32_16x16x32_bf16 v[68:71], v[128:131], v[44:47], v[68:71]
v_mfma_f32_16x16x32_bf16 v[72:75], v[144:147], v[44:47], v[72:75]
s_lshl_b32 s70, s79, 13
s_lshl_b32 s71, s60, 11
s_add_u32 s70, s70, s71
s_add_u32 s70, s70, 7340032
s_nop 2
v_bfi_b32 v68, s91, v59, v68
v_bfi_b32 v72, s91, v59, v72
buffer_store_dwordx4 v[68:71], v18, s[12:15], s70 offen offset:0 sc1
buffer_store_dwordx4 v[72:75], v18, s[12:15], s70 offen offset:1024 sc1
L_nomoe:
s_cmp_lt_u32 s63, 24
s_cbranch_scc1 L_ldone
v_lshrrev_b32 v2, 3, v1
v_and_b32 v3, 7, v1
v_lshlrev_b32 v62, 13, v2
v_lshl_add_u32 v62, v3, 4, v62
s_mul_i32 s87, s60, 458752
s_lshl_b32 s70, s88, 7
s_add_u32 s87, s87, s70
s_add_u32 s87, s87, 7340032
s_lshr_b32 s70, s88, 1
s_lshl_b32 s70, s70, 5
s_and_b32 s71, s88, 1
s_lshl_b32 s71, s71, 2
s_add_u32 s70, s70, s71
v_bfe_u32 v4, v1, 3, 2
v_lshlrev_b32 v4, 3, v4
v_bfe_u32 v5, v1, 1, 2
v_add3_u32 v63, v4, v5, s70
v_lshlrev_b32 v63, 1, v63
v_lshl_add_u32 v64, v23, 11, v63
s_mov_b32 s72, 6881280
buffer_load_ushort v61, v64, s[12:15], s72 offen sc1
s_add_u32 s70, s87, 0
buffer_load_dwordx4 v[24:27], v62, s[12:15], s70 offen sc1
s_add_u32 s70, s87, 65536
buffer_load_dwordx4 v[28:31], v62, s[12:15], s70 offen sc1
s_add_u32 s70, s87, 131072
buffer_load_dwordx4 v[32:35], v62, s[12:15], s70 offen sc1
s_add_u32 s70, s87, 196608
buffer_load_dwordx4 v[36:39], v62, s[12:15], s70 offen sc1
s_add_u32 s70, s87, 262144
buffer_load_dwordx4 v[40:43], v62, s[12:15], s70 offen sc1
s_add_u32 s70, s87, 327680
buffer_load_dwordx4 v[44:47], v62, s[12:15], s70 offen sc1
s_add_u32 s70, s87, 393216
buffer_load_dwordx4 v[48:51], v62, s[12:15], s70 offen sc1
v_and_b32 v65, 0xfffff800, v20
v_not_b32 v4, v65
v_ashrrev_i32 v4, 31, v4
v_or_b32 v4, 0x80000000, v4
v_xor_b32 v65, v65, v4
v_mul_f32 v65, 0xbfb8aa3b, v65
v_exp_f32 v65, v65
s_nop 0
v_add_f32 v65, 1.0, v65
v_rcp_f32 v65, v65
v_and_b32 v66, 0x7ff, v20
v_sub_u32 v66, 2047, v66
v_lshl_add_u32 v66, v66, 11, v63
v_add_f32 v67, 1.0, v22
v_mul_f32_e64 v21, -v21, v22
s_lshl_b32 s71, s60, 7
s_add_u32 s71, s71, 163072
v_lshlrev_b32 v6, 4, v3
v_add_u32 v6, s71, v6
v_bfe_u32 v4, v1, 3, 2
v_lshlrev_b32 v7, 4, v3
v_lshl_add_u32 v7, v4, 2, v7
v_add_u32 v7, 163072, v7
s_waitcnt vmcnt(0)
L_y_chk:
v_add_u32 v8, 1, v61
v_lshrrev_b32 v8, 16, v8
v_xor_b32 v8, s84, v8
v_xor_b32 v24, s84, v24
v_xor_b32 v28, s84, v28
v_xor_b32 v32, s84, v32
v_xor_b32 v36, s84, v36
v_or3_b32 v2, v24, v28, v32
v_xor_b32 v40, s84, v40
v_xor_b32 v44, s84, v44
v_or3_b32 v2, v2, v36, v40
v_xor_b32 v48, s84, v48
v_xor_b32 v8, s84, v8
v_or3_b32 v2, v2, v44, v48
v_bitop3_b32 v2, v2, v8, s91 bitop3:0xa8
v_cmp_ne_u32 vcc, 0, v2
s_cbranch_vccnz L_y_rt
L_y_ok:
v_pk_add_f32 v[24:25], v[24:25], v[28:29]
v_pk_add_f32 v[26:27], v[26:27], v[30:31]
v_pk_add_f32 v[32:33], v[32:33], v[36:37]
v_pk_add_f32 v[34:35], v[34:35], v[38:39]
v_pk_add_f32 v[40:41], v[40:41], v[44:45]
v_pk_add_f32 v[42:43], v[42:43], v[46:47]
v_pk_add_f32 v[24:25], v[24:25], v[32:33]
v_pk_add_f32 v[26:27], v[26:27], v[34:35]
v_pk_add_f32 v[40:41], v[40:41], v[48:49]
v_pk_add_f32 v[42:43], v[42:43], v[50:51]
v_pk_add_f32 v[24:25], v[24:25], v[40:41]
v_pk_add_f32 v[26:27], v[26:27], v[42:43]
s_nop 0
v_add_f32_dpp v24, v24, v24 row_ror:8 row_mask:0xf bank_mask:0xf
v_add_f32_dpp v25, v25, v25 row_ror:8 row_mask:0xf bank_mask:0xf
v_add_f32_dpp v26, v26, v26 row_ror:8 row_mask:0xf bank_mask:0xf
v_add_f32_dpp v27, v27, v27 row_ror:8 row_mask:0xf bank_mask:0xf
v_mov_b32 v28, v24
v_mov_b32 v29, v25
v_mov_b32 v30, v26
v_mov_b32 v31, v27
v_permlane16_swap_b32 v24, v28
v_permlane16_swap_b32 v25, v29
v_permlane16_swap_b32 v26, v30
v_permlane16_swap_b32 v27, v31
v_add_f32 v24, v24, v28
v_add_f32 v25, v25, v29
v_add_f32 v26, v26, v30
v_add_f32 v27, v27, v31
v_mov_b32 v28, v24
v_mov_b32 v29, v25
v_mov_b32 v30, v26
v_mov_b32 v31, v27
v_permlane32_swap_b32 v24, v28
v_permlane32_swap_b32 v25, v29
v_permlane32_swap_b32 v26, v30
v_permlane32_swap_b32 v27, v31
v_add_f32 v24, v24, v28
v_add_f32 v25, v25, v29
v_add_f32 v26, v26, v30
v_add_f32 v27, v27, v31
ds_write_b128 v6, v[24:27]
s_waitcnt lgkmcnt(0)
s_barrier
s_cmp_lg_u32 s60, 0
s_cbranch_scc1 L_ldone
ds_read_b32 v24, v7 offset:0
ds_read_b32 v25, v7 offset:128
ds_read_b32 v26, v7 offset:256
ds_read_b32 v27, v7 offset:384
v_lshlrev_b32 v61, 16, v61
v_fma_f32 v61, v61, v67, v21
s_waitcnt lgkmcnt(0)
v_add_f32 v24, v24, v25
v_add_f32 v26, v26, v27
v_add_f32 v24, v24, v26
v_fmac_f32 v61, v24, v65
v_cvt_pk_bf16_f32 v61, v61, v61
s_mov_b64 exec, 0xffffffff
buffer_store_short v61, v66, s[20:23], 0 offen sc1
L_ldone:
s_endpgm
L_compute:
v_and_b32 v2, 15, v1
v_lshrrev_b32 v4, 4, v1
v_lshrrev_b32 v3, 1, v2
v_xor_b32 v3, v3, v4
v_lshlrev_b32 v2, 7, v2
s_lshl_b32 s70, s66, 13
v_add_u32 v2, s70, v2
v_xor_b32 v5, 0, v3
v_lshl_add_u32 v8, v5, 4, v2
v_add_u32 v10, 65536, v8
v_xor_b32 v5, 4, v3
v_lshl_add_u32 v9, v5, 4, v2
v_add_u32 v11, 65536, v9
v_lshrrev_b32 v2, 5, v1
v_mul_u32_u24 v2, 6144, v2
v_bfe_u32 v3, v1, 4, 1
v_lshl_add_u32 v2, v3, 10, v2
v_bfe_u32 v4, v1, 2, 2
v_lshl_add_u32 v2, v4, 7, v2
v_lshlrev_b32 v3, 1, v3
v_bfe_u32 v4, v1, 3, 1
v_or_b32 v3, v3, v4
s_lshl_b32 s70, s67, 1
v_xor_b32 v3, s70, v3
v_and_b32 v4, 3, v1
v_lshl_add_u32 v2, v4, 3, v2
v_xor_b32 v4, 0, v3
v_lshl_add_u32 v12, v4, 5, v2
v_add_u32 v14, 65536, v12
v_xor_b32 v4, 1, v3
v_lshl_add_u32 v13, v4, 5, v2
v_add_u32 v15, 65536, v13
s_waitcnt lgkmcnt(0)
s_mov_b32 s12, s58
s_and_b32 s13, s59, 0xffff
s_mov_b32 s14, 268435456
s_mov_b32 s15, 0x20000
s_mov_b32 s36, s48
s_and_b32 s37, s49, 0xffff
s_mov_b32 s38, 2048
s_mov_b32 s39, 0x20000
s_mov_b32 s20, s56
s_and_b32 s21, s57, 0xffff
s_mov_b32 s22, 4194304
s_mov_b32 s23, 0x20000
s_lshl_b32 s87, s64, 4
s_add_u32 s87, s87, s65
s_mul_i32 s87, s87, 4352
s_add_u32 s87, s87, 524288
s_lshl_b32 s88, s65, 18
s_lshl_b32 s70, s66, 17
s_add_u32 s88, s88, s70
s_lshl_b32 s70, s64, 11
s_add_u32 s88, s88, s70
s_lshl_b32 s70, s67, 10
s_add_u32 s88, s88, s70
s_add_u32 s88, s88, 2097152
v_mov_b32 v2, 0
buffer_load_dword v19, v2, s[12:15], 0 offen sc1
buffer_load_dwordx4 v[24:27], v16, s[36:39], 0 offen
buffer_load_dwordx4 v[28:31], v16, s[36:39], 0 offen offset:1024
v_lshrrev_b32 v3, 4, v1
v_lshlrev_b32 v3, 3, v3
s_lshl_b32 s70, s65, 7
buffer_load_dwordx2 a[96:97], v3, s[36:39], s70 offen offset:0
buffer_load_dwordx2 a[98:99], v3, s[36:39], s70 offen offset:32
buffer_load_dwordx2 a[100:101], v3, s[36:39], s70 offen offset:64
buffer_load_dwordx2 a[102:103], v3, s[36:39], s70 offen offset:96
v_mov_b32 v32, 0
v_mov_b32 v33, 0
v_mov_b32 v34, 0
v_mov_b32 v35, 0
v_mov_b32 v36, 0
v_mov_b32 v37, 0
v_mov_b32 v38, 0
v_mov_b32 v39, 0
v_mov_b32 v40, 0
v_mov_b32 v41, 0
v_mov_b32 v42, 0
v_mov_b32 v43, 0
v_mov_b32 v44, 0
v_mov_b32 v45, 0
v_mov_b32 v46, 0
v_mov_b32 v47, 0
v_mov_b32 v48, 0
v_mov_b32 v49, 0
v_mov_b32 v50, 0
v_mov_b32 v51, 0
v_mov_b32 v52, 0
v_mov_b32 v53, 0
v_mov_b32 v54, 0
v_mov_b32 v55, 0
v_mov_b32 v56, 0
v_mov_b32 v57, 0
v_mov_b32 v58, 0
v_mov_b32 v59, 0
v_mov_b32 v60, 0
v_mov_b32 v61, 0
v_mov_b32 v62, 0
v_mov_b32 v63, 0
v_mov_b32 v64, 0
v_mov_b32 v65, 0
v_mov_b32 v66, 0
v_mov_b32 v67, 0
v_mov_b32 v68, 0
v_mov_b32 v69, 0
v_mov_b32 v70, 0
v_mov_b32 v71, 0
v_mov_b32 v72, 0
v_mov_b32 v73, 0
v_mov_b32 v74, 0
v_mov_b32 v75, 0
v_mov_b32 v76, 0
v_mov_b32 v77, 0
v_mov_b32 v78, 0
v_mov_b32 v79, 0
v_mov_b32 v80, 0
v_mov_b32 v81, 0
v_mov_b32 v82, 0
v_mov_b32 v83, 0
v_mov_b32 v84, 0
v_mov_b32 v85, 0
v_mov_b32 v86, 0
v_mov_b32 v87, 0
v_mov_b32 v88, 0
v_mov_b32 v89, 0
v_mov_b32 v90, 0
v_mov_b32 v91, 0
v_mov_b32 v92, 0
v_mov_b32 v93, 0
v_mov_b32 v94, 0
v_mov_b32 v95, 0
v_mov_b32 v96, 0
v_mov_b32 v97, 0
v_mov_b32 v98, 0
v_mov_b32 v99, 0
v_mov_b32 v100, 0
v_mov_b32 v101, 0
v_mov_b32 v102, 0
v_mov_b32 v103, 0
v_mov_b32 v104, 0
v_mov_b32 v105, 0
v_mov_b32 v106, 0
v_mov_b32 v107, 0
v_mov_b32 v108, 0
v_mov_b32 v109, 0
v_mov_b32 v110, 0
v_mov_b32 v111, 0
v_mov_b32 v112, 0
v_mov_b32 v113, 0
v_mov_b32 v114, 0
v_mov_b32 v115, 0
v_mov_b32 v116, 0
v_mov_b32 v117, 0
v_mov_b32 v118, 0
v_mov_b32 v119, 0
v_mov_b32 v120, 0
v_mov_b32 v121, 0
v_mov_b32 v122, 0
v_mov_b32 v123, 0
v_mov_b32 v124, 0
v_mov_b32 v125, 0
v_mov_b32 v126, 0
v_mov_b32 v127, 0
s_mov_b32 s70, 0x3f803f80
v_accvgpr_write_b32 a80, s70
v_accvgpr_write_b32 a81, s70
v_accvgpr_write_b32 a82, s70
v_accvgpr_write_b32 a83, s70
s_mov_b32 s80, 0x358637bd
s_mov_b32 s81, 0x358637bd
s_mov_b32 s82, 0x3f800008
s_mov_b32 s83, 0x3f800008
s_mov_b32 s90, 0x3fb8aa3b
s_mov_b32 s91, 0x3fb8aa3b
s_waitcnt vmcnt(4)
v_readfirstlane_b32 s68, v19
v_lshlrev_b32 v128, 16, v24
v_and_b32 v129, 0xffff0000, v24
v_lshlrev_b32 v130, 16, v25
v_and_b32 v131, 0xffff0000, v25
v_lshlrev_b32 v132, 16, v26
v_and_b32 v133, 0xffff0000, v26
v_lshlrev_b32 v134, 16, v27
v_and_b32 v135, 0xffff0000, v27
v_lshlrev_b32 v136, 16, v28
v_and_b32 v137, 0xffff0000, v28
v_lshlrev_b32 v138, 16, v29
v_and_b32 v139, 0xffff0000, v29
v_lshlrev_b32 v140, 16, v30
v_and_b32 v141, 0xffff0000, v30
v_lshlrev_b32 v142, 16, v31
v_and_b32 v143, 0xffff0000, v31
s_add_u32 s68, s68, 1
v_pk_add_f32 v[128:129], v[128:129], v[130:131]
v_pk_add_f32 v[132:133], v[132:133], v[134:135]
v_pk_add_f32 v[136:137], v[136:137], v[138:139]
v_pk_add_f32 v[140:141], v[140:141], v[142:143]
v_pk_add_f32 v[128:129], v[128:129], v[132:133]
v_pk_add_f32 v[136:137], v[136:137], v[140:141]
v_pk_add_f32 v[128:129], v[128:129], v[136:137]
v_add_f32 v2, v128, v129
s_nop 1
v_add_f32_dpp v2, v2, v2 row_ror:1 row_mask:0xf bank_mask:0xf
s_nop 1
v_add_f32_dpp v2, v2, v2 row_ror:2 row_mask:0xf bank_mask:0xf
s_nop 1
v_add_f32_dpp v2, v2, v2 row_ror:4 row_mask:0xf bank_mask:0xf
s_nop 1
v_add_f32_dpp v2, v2, v2 row_ror:8 row_mask:0xf bank_mask:0xf
v_mov_b32 v3, v2
s_nop 1
v_permlane16_swap_b32 v2, v3
v_add_f32 v2, v2, v3
v_mov_b32 v3, v2
s_nop 1
v_permlane32_swap_b32 v2, v3
v_add_f32 v2, v2, v3
s_nop 0
v_readfirstlane_b32 s84, v2
v_and_b32 v7, 3, v1
v_lshrrev_b32_e64 v7, v7, s68
v_and_b32 v7, 1, v7
v_mul_u32_u24 v7, 0x10001, v7
s_mov_b32 s76, 0x10001
s_mov_b32 s77, 0x07060302
s_movk_i32 s85, 0xff
v_mov_b32 v28, -1
v_mov_b32 v29, -1
v_mov_b32 v30, -1
v_mov_b32 v31, -1
s_barrier
ds_read_b128 a[0:3], v10 offset:57344
ds_read_b64_tr_b16 a[32:33], v12 offset:0
ds_read_b64_tr_b16 a[34:35], v12 offset:512
ds_read_b128 a[4:7], v10 offset:59392
ds_read_b128 a[8:11], v10 offset:61440
ds_read_b128 a[12:15], v10 offset:63488
ds_read_b64_tr_b16 a[36:37], v13 offset:0
ds_read_b64_tr_b16 a[38:39], v13 offset:512
ds_read_b64_tr_b16 a[40:41], v12 offset:2048
ds_read_b64_tr_b16 a[42:43], v12 offset:2560
ds_read_b64_tr_b16 a[44:45], v13 offset:2048
ds_read_b64_tr_b16 a[46:47], v13 offset:2560
ds_read_b64_tr_b16 a[48:49], v12 offset:4096
ds_read_b64_tr_b16 a[50:51], v12 offset:4608
ds_read_b64_tr_b16 a[52:53], v13 offset:4096
ds_read_b64_tr_b16 a[54:55], v13 offset:4608
s_waitcnt lgkmcnt(0)
s_cmp_lg_u32 s66, 0
s_cbranch_scc1 L_nocs0
v_mfma_f32_16x16x32_bf16 v[128:131], a[80:83], a[32:35], 0
v_mfma_f32_16x16x32_bf16 v[132:135], a[80:83], a[36:39], 0
v_mfma_f32_16x16x32_bf16 v[136:139], a[80:83], a[40:43], 0
v_mfma_f32_16x16x32_bf16 v[140:143], a[80:83], a[44:47], 0
v_mfma_f32_16x16x32_bf16 v[144:147], a[80:83], a[48:51], 0
v_mfma_f32_16x16x32_bf16 v[148:151], a[80:83], a[52:55], 0
L_nocs0:
v_mfma_f32_16x16x32_bf16 v[32:35], a[32:35], a[0:3], v[32:35]
ds_read_b128 a[16:19], v11 offset:57344
v_mfma_f32_16x16x32_bf16 v[56:59], a[32:35], a[4:7], v[56:59]
ds_read_b64_tr_b16 a[56:57], v12 offset:12288
v_mfma_f32_16x16x32_bf16 v[80:83], a[32:35], a[8:11], v[80:83]
ds_read_b64_tr_b16 a[58:59], v12 offset:12800
v_mfma_f32_16x16x32_bf16 v[104:107], a[32:35], a[12:15], v[104:107]
ds_read_b128 a[20:23], v11 offset:59392
v_mfma_f32_16x16x32_bf16 v[36:39], a[36:39], a[0:3], v[36:39]
ds_read_b128 a[24:27], v11 offset:61440
v_mfma_f32_16x16x32_bf16 v[60:63], a[36:39], a[4:7], v[60:63]
ds_read_b128 a[28:31], v11 offset:63488
v_mfma_f32_16x16x32_bf16 v[84:87], a[36:39], a[8:11], v[84:87]
ds_read_b64_tr_b16 a[60:61], v13 offset:12288
v_mfma_f32_16x16x32_bf16 v[108:111], a[36:39], a[12:15], v[108:111]
ds_read_b64_tr_b16 a[62:63], v13 offset:12800
v_mfma_f32_16x16x32_bf16 v[40:43], a[0:3], a[40:43], v[40:43]
ds_read_b64_tr_b16 a[64:65], v12 offset:14336
v_mfma_f32_16x16x32_bf16 v[64:67], a[4:7], a[40:43], v[64:67]
ds_read_b64_tr_b16 a[66:67], v12 offset:14848
v_mfma_f32_16x16x32_bf16 v[88:91], a[8:11], a[40:43], v[88:91]
ds_read_b64_tr_b16 a[68:69], v13 offset:14336
v_mfma_f32_16x16x32_bf16 v[112:115], a[12:15], a[40:43], v[112:115]
ds_read_b64_tr_b16 a[70:71], v13 offset:14848
v_mfma_f32_16x16x32_bf16 v[44:47], a[0:3], a[44:47], v[44:47]
ds_read_b64_tr_b16 a[72:73], v12 offset:16384
v_mfma_f32_16x16x32_bf16 v[68:71], a[4:7], a[44:47], v[68:71]
ds_read_b64_tr_b16 a[74:75], v12 offset:16896
v_mfma_f32_16x16x32_bf16 v[92:95], a[8:11], a[44:47], v[92:95]
ds_read_b64_tr_b16 a[76:77], v13 offset:16384
v_mfma_f32_16x16x32_bf16 v[116:119], a[12:15], a[44:47], v[116:119]
ds_read_b64_tr_b16 a[78:79], v13 offset:16896
v_mfma_f32_16x16x32_bf16 v[48:51], a[0:3], a[48:51], v[48:51]
v_mfma_f32_16x16x32_bf16 v[72:75], a[4:7], a[48:51], v[72:75]
v_mfma_f32_16x16x32_bf16 v[96:99], a[8:11], a[48:51], v[96:99]
v_mfma_f32_16x16x32_bf16 v[120:123], a[12:15], a[48:51], v[120:123]
v_mfma_f32_16x16x32_bf16 v[52:55], a[0:3], a[52:55], v[52:55]
v_mfma_f32_16x16x32_bf16 v[76:79], a[4:7], a[52:55], v[76:79]
v_mfma_f32_16x16x32_bf16 v[100:103], a[8:11], a[52:55], v[100:103]
v_mfma_f32_16x16x32_bf16 v[124:127], a[12:15], a[52:55], v[124:127]
s_waitcnt lgkmcnt(0)
s_cmp_lg_u32 s66, 0
s_cbranch_scc1 L_nocs1
v_mfma_f32_16x16x32_bf16 v[128:131], a[80:83], a[56:59], v[128:131]
v_mfma_f32_16x16x32_bf16 v[132:135], a[80:83], a[60:63], v[132:135]
v_mfma_f32_16x16x32_bf16 v[136:139], a[80:83], a[64:67], v[136:139]
v_mfma_f32_16x16x32_bf16 v[140:143], a[80:83], a[68:71], v[140:143]
v_mfma_f32_16x16x32_bf16 v[144:147], a[80:83], a[72:75], v[144:147]
v_mfma_f32_16x16x32_bf16 v[148:151], a[80:83], a[76:79], v[148:151]
L_nocs1:
v_mfma_f32_16x16x32_bf16 v[32:35], a[56:59], a[16:19], v[32:35]
s_barrier
ds_read_b128 a[0:3], v10 offset:40960
v_mfma_f32_16x16x32_bf16 v[56:59], a[56:59], a[20:23], v[56:59]
ds_read_b64_tr_b16 a[32:33], v14 offset:16384
v_mfma_f32_16x16x32_bf16 v[80:83], a[56:59], a[24:27], v[80:83]
ds_read_b64_tr_b16 a[34:35], v14 offset:16896
v_mfma_f32_16x16x32_bf16 v[104:107], a[56:59], a[28:31], v[104:107]
ds_read_b128 a[4:7], v10 offset:43008
v_mfma_f32_16x16x32_bf16 v[36:39], a[60:63], a[16:19], v[36:39]
ds_read_b128 a[8:11], v10 offset:45056
v_mfma_f32_16x16x32_bf16 v[60:63], a[60:63], a[20:23], v[60:63]
ds_read_b128 a[12:15], v10 offset:47104
v_mfma_f32_16x16x32_bf16 v[84:87], a[60:63], a[24:27], v[84:87]
ds_read_b64_tr_b16 a[36:37], v15 offset:16384
v_mfma_f32_16x16x32_bf16 v[108:111], a[60:63], a[28:31], v[108:111]
ds_read_b64_tr_b16 a[38:39], v15 offset:16896
v_mfma_f32_16x16x32_bf16 v[40:43], a[16:19], a[64:67], v[40:43]
ds_read_b64_tr_b16 a[40:41], v14 offset:18432
v_mfma_f32_16x16x32_bf16 v[64:67], a[20:23], a[64:67], v[64:67]
ds_read_b64_tr_b16 a[42:43], v14 offset:18944
v_mfma_f32_16x16x32_bf16 v[88:91], a[24:27], a[64:67], v[88:91]
ds_read_b64_tr_b16 a[44:45], v15 offset:18432
v_mfma_f32_16x16x32_bf16 v[112:115], a[28:31], a[64:67], v[112:115]
ds_read_b64_tr_b16 a[46:47], v15 offset:18944
v_mfma_f32_16x16x32_bf16 v[44:47], a[16:19], a[68:71], v[44:47]
ds_read_b64_tr_b16 a[48:49], v14 offset:20480
v_mfma_f32_16x16x32_bf16 v[68:71], a[20:23], a[68:71], v[68:71]
ds_read_b64_tr_b16 a[50:51], v14 offset:20992
v_mfma_f32_16x16x32_bf16 v[92:95], a[24:27], a[68:71], v[92:95]
ds_read_b64_tr_b16 a[52:53], v15 offset:20480
v_mfma_f32_16x16x32_bf16 v[116:119], a[28:31], a[68:71], v[116:119]
ds_read_b64_tr_b16 a[54:55], v15 offset:20992
v_mfma_f32_16x16x32_bf16 v[48:51], a[16:19], a[72:75], v[48:51]
v_mfma_f32_16x16x32_bf16 v[72:75], a[20:23], a[72:75], v[72:75]
v_mfma_f32_16x16x32_bf16 v[96:99], a[24:27], a[72:75], v[96:99]
v_mfma_f32_16x16x32_bf16 v[120:123], a[28:31], a[72:75], v[120:123]
v_mfma_f32_16x16x32_bf16 v[52:55], a[16:19], a[76:79], v[52:55]
v_mfma_f32_16x16x32_bf16 v[76:79], a[20:23], a[76:79], v[76:79]
v_mfma_f32_16x16x32_bf16 v[100:103], a[24:27], a[76:79], v[100:103]
v_mfma_f32_16x16x32_bf16 v[124:127], a[28:31], a[76:79], v[124:127]
s_waitcnt lgkmcnt(0)
v_mfma_f32_16x16x32_bf16 v[32:35], a[32:35], a[0:3], v[32:35]
ds_read_b128 a[16:19], v11 offset:40960
v_mfma_f32_16x16x32_bf16 v[56:59], a[32:35], a[4:7], v[56:59]
ds_read_b64_tr_b16 a[56:57], v14 offset:28672
v_mfma_f32_16x16x32_bf16 v[80:83], a[32:35], a[8:11], v[80:83]
ds_read_b64_tr_b16 a[58:59], v14 offset:29184
v_mfma_f32_16x16x32_bf16 v[104:107], a[32:35], a[12:15], v[104:107]
ds_read_b128 a[20:23], v11 offset:43008
v_mfma_f32_16x16x32_bf16 v[36:39], a[36:39], a[0:3], v[36:39]
ds_read_b128 a[24:27], v11 offset:45056
v_mfma_f32_16x16x32_bf16 v[60:63], a[36:39], a[4:7], v[60:63]
ds_read_b128 a[28:31], v11 offset:47104
v_mfma_f32_16x16x32_bf16 v[84:87], a[36:39], a[8:11], v[84:87]
ds_read_b64_tr_b16 a[60:61], v15 offset:28672
v_mfma_f32_16x16x32_bf16 v[108:111], a[36:39], a[12:15], v[108:111]
ds_read_b64_tr_b16 a[62:63], v15 offset:29184
v_mfma_f32_16x16x32_bf16 v[40:43], a[0:3], a[40:43], v[40:43]
ds_read_b64_tr_b16 a[64:65], v14 offset:30720
v_mfma_f32_16x16x32_bf16 v[64:67], a[4:7], a[40:43], v[64:67]
ds_read_b64_tr_b16 a[66:67], v14 offset:31232
v_mfma_f32_16x16x32_bf16 v[88:91], a[8:11], a[40:43], v[88:91]
ds_read_b64_tr_b16 a[68:69], v15 offset:30720
v_mfma_f32_16x16x32_bf16 v[112:115], a[12:15], a[40:43], v[112:115]
ds_read_b64_tr_b16 a[70:71], v15 offset:31232
v_mfma_f32_16x16x32_bf16 v[44:47], a[0:3], a[44:47], v[44:47]
ds_read_b64_tr_b16 a[72:73], v14 offset:32768
v_mfma_f32_16x16x32_bf16 v[68:71], a[4:7], a[44:47], v[68:71]
ds_read_b64_tr_b16 a[74:75], v14 offset:33280
v_mfma_f32_16x16x32_bf16 v[92:95], a[8:11], a[44:47], v[92:95]
ds_read_b64_tr_b16 a[76:77], v15 offset:32768
v_mfma_f32_16x16x32_bf16 v[116:119], a[12:15], a[44:47], v[116:119]
ds_read_b64_tr_b16 a[78:79], v15 offset:33280
v_mfma_f32_16x16x32_bf16 v[48:51], a[0:3], a[48:51], v[48:51]
v_mfma_f32_16x16x32_bf16 v[72:75], a[4:7], a[48:51], v[72:75]
v_mfma_f32_16x16x32_bf16 v[96:99], a[8:11], a[48:51], v[96:99]
v_mfma_f32_16x16x32_bf16 v[120:123], a[12:15], a[48:51], v[120:123]
v_mfma_f32_16x16x32_bf16 v[52:55], a[0:3], a[52:55], v[52:55]
v_mfma_f32_16x16x32_bf16 v[76:79], a[4:7], a[52:55], v[76:79]
v_mfma_f32_16x16x32_bf16 v[100:103], a[8:11], a[52:55], v[100:103]
v_mfma_f32_16x16x32_bf16 v[124:127], a[12:15], a[52:55], v[124:127]
s_waitcnt lgkmcnt(0)
v_mfma_f32_16x16x32_bf16 v[32:35], a[56:59], a[16:19], v[32:35]
s_barrier
ds_read_b128 a[0:3], v10 offset:0
v_mfma_f32_16x16x32_bf16 v[56:59], a[56:59], a[20:23], v[56:59]
ds_read_b64_tr_b16 a[32:33], v12 offset:40960
v_mfma_f32_16x16x32_bf16 v[80:83], a[56:59], a[24:27], v[80:83]
ds_read_b64_tr_b16 a[34:35], v12 offset:41472
v_mfma_f32_16x16x32_bf16 v[104:107], a[56:59], a[28:31], v[104:107]
ds_read_b128 a[4:7], v10 offset:2048
v_mfma_f32_16x16x32_bf16 v[36:39], a[60:63], a[16:19], v[36:39]
ds_read_b128 a[8:11], v10 offset:4096
v_mfma_f32_16x16x32_bf16 v[60:63], a[60:63], a[20:23], v[60:63]
ds_read_b128 a[12:15], v10 offset:6144
v_mfma_f32_16x16x32_bf16 v[84:87], a[60:63], a[24:27], v[84:87]
ds_read_b64_tr_b16 a[36:37], v13 offset:40960
v_mfma_f32_16x16x32_bf16 v[108:111], a[60:63], a[28:31], v[108:111]
ds_read_b64_tr_b16 a[38:39], v13 offset:41472
v_mfma_f32_16x16x32_bf16 v[40:43], a[16:19], a[64:67], v[40:43]
ds_read_b64_tr_b16 a[40:41], v12 offset:43008
v_mfma_f32_16x16x32_bf16 v[64:67], a[20:23], a[64:67], v[64:67]
ds_read_b64_tr_b16 a[42:43], v12 offset:43520
v_mfma_f32_16x16x32_bf16 v[88:91], a[24:27], a[64:67], v[88:91]
ds_read_b64_tr_b16 a[44:45], v13 offset:43008
v_mfma_f32_16x16x32_bf16 v[112:115], a[28:31], a[64:67], v[112:115]
ds_read_b64_tr_b16 a[46:47], v13 offset:43520
v_mfma_f32_16x16x32_bf16 v[44:47], a[16:19], a[68:71], v[44:47]
ds_read_b64_tr_b16 a[48:49], v12 offset:45056
v_mfma_f32_16x16x32_bf16 v[68:71], a[20:23], a[68:71], v[68:71]
ds_read_b64_tr_b16 a[50:51], v12 offset:45568
v_mfma_f32_16x16x32_bf16 v[92:95], a[24:27], a[68:71], v[92:95]
ds_read_b64_tr_b16 a[52:53], v13 offset:45056
v_mfma_f32_16x16x32_bf16 v[116:119], a[28:31], a[68:71], v[116:119]
ds_read_b64_tr_b16 a[54:55], v13 offset:45568
v_mfma_f32_16x16x32_bf16 v[48:51], a[16:19], a[72:75], v[48:51]
v_mfma_f32_16x16x32_bf16 v[72:75], a[20:23], a[72:75], v[72:75]
v_mfma_f32_16x16x32_bf16 v[96:99], a[24:27], a[72:75], v[96:99]
v_mfma_f32_16x16x32_bf16 v[120:123], a[28:31], a[72:75], v[120:123]
v_mfma_f32_16x16x32_bf16 v[52:55], a[16:19], a[76:79], v[52:55]
v_mfma_f32_16x16x32_bf16 v[76:79], a[20:23], a[76:79], v[76:79]
v_mfma_f32_16x16x32_bf16 v[100:103], a[24:27], a[76:79], v[100:103]
v_mfma_f32_16x16x32_bf16 v[124:127], a[28:31], a[76:79], v[124:127]
s_waitcnt lgkmcnt(0)
v_mfma_f32_16x16x32_bf16 v[32:35], a[32:35], a[0:3], v[32:35]
ds_read_b128 a[16:19], v11 offset:0
v_mfma_f32_16x16x32_bf16 v[56:59], a[32:35], a[4:7], v[56:59]
ds_read_b64_tr_b16 a[56:57], v12 offset:53248
v_mfma_f32_16x16x32_bf16 v[80:83], a[32:35], a[8:11], v[80:83]
ds_read_b64_tr_b16 a[58:59], v12 offset:53760
v_mfma_f32_16x16x32_bf16 v[104:107], a[32:35], a[12:15], v[104:107]
ds_read_b128 a[20:23], v11 offset:2048
v_mfma_f32_16x16x32_bf16 v[36:39], a[36:39], a[0:3], v[36:39]
ds_read_b128 a[24:27], v11 offset:4096
v_mfma_f32_16x16x32_bf16 v[60:63], a[36:39], a[4:7], v[60:63]
ds_read_b128 a[28:31], v11 offset:6144
v_mfma_f32_16x16x32_bf16 v[84:87], a[36:39], a[8:11], v[84:87]
ds_read_b64_tr_b16 a[60:61], v13 offset:53248
v_mfma_f32_16x16x32_bf16 v[108:111], a[36:39], a[12:15], v[108:111]
ds_read_b64_tr_b16 a[62:63], v13 offset:53760
v_mfma_f32_16x16x32_bf16 v[40:43], a[0:3], a[40:43], v[40:43]
ds_read_b64_tr_b16 a[64:65], v12 offset:55296
v_mfma_f32_16x16x32_bf16 v[64:67], a[4:7], a[40:43], v[64:67]
ds_read_b64_tr_b16 a[66:67], v12 offset:55808
v_mfma_f32_16x16x32_bf16 v[88:91], a[8:11], a[40:43], v[88:91]
ds_read_b64_tr_b16 a[68:69], v13 offset:55296
v_mfma_f32_16x16x32_bf16 v[112:115], a[12:15], a[40:43], v[112:115]
ds_read_b64_tr_b16 a[70:71], v13 offset:55808
v_mfma_f32_16x16x32_bf16 v[44:47], a[0:3], a[44:47], v[44:47]
ds_read_b64_tr_b16 a[72:73], v12 offset:57344
v_mfma_f32_16x16x32_bf16 v[68:71], a[4:7], a[44:47], v[68:71]
ds_read_b64_tr_b16 a[74:75], v12 offset:57856
v_mfma_f32_16x16x32_bf16 v[92:95], a[8:11], a[44:47], v[92:95]
ds_read_b64_tr_b16 a[76:77], v13 offset:57344
v_mfma_f32_16x16x32_bf16 v[116:119], a[12:15], a[44:47], v[116:119]
ds_read_b64_tr_b16 a[78:79], v13 offset:57856
v_mfma_f32_16x16x32_bf16 v[48:51], a[0:3], a[48:51], v[48:51]
s_lshl_b32 s70, s60, 10
s_add_u32 s70, s70, s87
buffer_store_dwordx4 v[28:31], v16, s[12:15], s70 offen sc1
v_mfma_f32_16x16x32_bf16 v[72:75], a[4:7], a[48:51], v[72:75]
v_mfma_f32_16x16x32_bf16 v[96:99], a[8:11], a[48:51], v[96:99]
v_mfma_f32_16x16x32_bf16 v[120:123], a[12:15], a[48:51], v[120:123]
v_mfma_f32_16x16x32_bf16 v[52:55], a[0:3], a[52:55], v[52:55]
v_mfma_f32_16x16x32_bf16 v[76:79], a[4:7], a[52:55], v[76:79]
v_mfma_f32_16x16x32_bf16 v[100:103], a[8:11], a[52:55], v[100:103]
v_mfma_f32_16x16x32_bf16 v[124:127], a[12:15], a[52:55], v[124:127]
s_waitcnt lgkmcnt(0)
v_mfma_f32_16x16x32_bf16 v[32:35], a[56:59], a[16:19], v[32:35]
s_barrier
ds_read_b128 a[0:3], v8 offset:24576
v_mfma_f32_16x16x32_bf16 v[56:59], a[56:59], a[20:23], v[56:59]
ds_read_b64_tr_b16 a[32:33], v12 offset:0
v_mfma_f32_16x16x32_bf16 v[80:83], a[56:59], a[24:27], v[80:83]
ds_read_b64_tr_b16 a[34:35], v12 offset:512
v_mfma_f32_16x16x32_bf16 v[104:107], a[56:59], a[28:31], v[104:107]
ds_read_b128 a[4:7], v8 offset:26624
v_mfma_f32_16x16x32_bf16 v[36:39], a[60:63], a[16:19], v[36:39]
ds_read_b128 a[8:11], v8 offset:28672
v_mfma_f32_16x16x32_bf16 v[60:63], a[60:63], a[20:23], v[60:63]
ds_read_b128 a[12:15], v8 offset:30720
v_mfma_f32_16x16x32_bf16 v[84:87], a[60:63], a[24:27], v[84:87]
ds_read_b64_tr_b16 a[36:37], v13 offset:0
v_mfma_f32_16x16x32_bf16 v[108:111], a[60:63], a[28:31], v[108:111]
ds_read_b64_tr_b16 a[38:39], v13 offset:512
v_mfma_f32_16x16x32_bf16 v[40:43], a[16:19], a[64:67], v[40:43]
ds_read_b64_tr_b16 a[40:41], v12 offset:2048
v_mfma_f32_16x16x32_bf16 v[64:67], a[20:23], a[64:67], v[64:67]
ds_read_b64_tr_b16 a[42:43], v12 offset:2560
v_mfma_f32_16x16x32_bf16 v[88:91], a[24:27], a[64:67], v[88:91]
ds_read_b64_tr_b16 a[44:45], v13 offset:2048
v_mfma_f32_16x16x32_bf16 v[112:115], a[28:31], a[64:67], v[112:115]
ds_read_b64_tr_b16 a[46:47], v13 offset:2560
v_mfma_f32_16x16x32_bf16 v[44:47], a[16:19], a[68:71], v[44:47]
ds_read_b64_tr_b16 a[48:49], v12 offset:4096
v_mfma_f32_16x16x32_bf16 v[68:71], a[20:23], a[68:71], v[68:71]
ds_read_b64_tr_b16 a[50:51], v12 offset:4608
v_mfma_f32_16x16x32_bf16 v[92:95], a[24:27], a[68:71], v[92:95]
ds_read_b64_tr_b16 a[52:53], v13 offset:4096
v_mfma_f32_16x16x32_bf16 v[116:119], a[28:31], a[68:71], v[116:119]
ds_read_b64_tr_b16 a[54:55], v13 offset:4608
v_mfma_f32_16x16x32_bf16 v[48:51], a[16:19], a[72:75], v[48:51]
v_mfma_f32_16x16x32_bf16 v[72:75], a[20:23], a[72:75], v[72:75]
v_mfma_f32_16x16x32_bf16 v[96:99], a[24:27], a[72:75], v[96:99]
v_mfma_f32_16x16x32_bf16 v[120:123], a[28:31], a[72:75], v[120:123]
v_mfma_f32_16x16x32_bf16 v[52:55], a[16:19], a[76:79], v[52:55]
v_mfma_f32_16x16x32_bf16 v[76:79], a[20:23], a[76:79], v[76:79]
v_mfma_f32_16x16x32_bf16 v[100:103], a[24:27], a[76:79], v[100:103]
v_mfma_f32_16x16x32_bf16 v[124:127], a[28:31], a[76:79], v[124:127]
s_waitcnt lgkmcnt(0)
v_mfma_f32_16x16x32_bf16 v[32:35], a[32:35], a[0:3], v[32:35]
ds_read_b128 a[16:19], v9 offset:24576
v_mfma_f32_16x16x32_bf16 v[56:59], a[32:35], a[4:7], v[56:59]
ds_read_b64_tr_b16 a[56:57], v12 offset:12288
v_mfma_f32_16x16x32_bf16 v[80:83], a[32:35], a[8:11], v[80:83]
ds_read_b64_tr_b16 a[58:59], v12 offset:12800
v_mfma_f32_16x16x32_bf16 v[104:107], a[32:35], a[12:15], v[104:107]
ds_read_b128 a[20:23], v9 offset:26624
v_mfma_f32_16x16x32_bf16 v[36:39], a[36:39], a[0:3], v[36:39]
ds_read_b128 a[24:27], v9 offset:28672
v_mfma_f32_16x16x32_bf16 v[60:63], a[36:39], a[4:7], v[60:63]
ds_read_b128 a[28:31], v9 offset:30720
v_mfma_f32_16x16x32_bf16 v[84:87], a[36:39], a[8:11], v[84:87]
ds_read_b64_tr_b16 a[60:61], v13 offset:12288
v_mfma_f32_16x16x32_bf16 v[108:111], a[36:39], a[12:15], v[108:111]
ds_read_b64_tr_b16 a[62:63], v13 offset:12800
v_mfma_f32_16x16x32_bf16 v[40:43], a[0:3], a[40:43], v[40:43]
ds_read_b64_tr_b16 a[64:65], v12 offset:14336
v_mfma_f32_16x16x32_bf16 v[64:67], a[4:7], a[40:43], v[64:67]
ds_read_b64_tr_b16 a[66:67], v12 offset:14848
v_mfma_f32_16x16x32_bf16 v[88:91], a[8:11], a[40:43], v[88:91]
ds_read_b64_tr_b16 a[68:69], v13 offset:14336
v_mfma_f32_16x16x32_bf16 v[112:115], a[12:15], a[40:43], v[112:115]
ds_read_b64_tr_b16 a[70:71], v13 offset:14848
v_mfma_f32_16x16x32_bf16 v[44:47], a[0:3], a[44:47], v[44:47]
ds_read_b64_tr_b16 a[72:73], v12 offset:16384
v_mfma_f32_16x16x32_bf16 v[68:71], a[4:7], a[44:47], v[68:71]
ds_read_b64_tr_b16 a[74:75], v12 offset:16896
v_mfma_f32_16x16x32_bf16 v[92:95], a[8:11], a[44:47], v[92:95]
ds_read_b64_tr_b16 a[76:77], v13 offset:16384
v_mfma_f32_16x16x32_bf16 v[116:119], a[12:15], a[44:47], v[116:119]
ds_read_b64_tr_b16 a[78:79], v13 offset:16896
v_mfma_f32_16x16x32_bf16 v[48:51], a[0:3], a[48:51], v[48:51]
s_cmp_lg_u32 s66, 0
s_cbranch_scc1 L_nocsp
v_and_b32 v2, 16, v1
v_cmp_ne_u32 vcc, 0, v2
s_nop 1
v_cndmask_b32 v24, v128, v132, vcc
v_cndmask_b32 v25, v136, v140, vcc
v_cndmask_b32 v26, v144, v148, vcc
v_mov_b32 v27, s68
s_lshl_b32 s70, s64, 4
s_add_u32 s70, s70, s65
s_lshl_b32 s70, s70, 10
s_lshl_b32 s71, s67, 9
s_add_u32 s70, s70, s71
s_add_u32 s70, s70, 65536
s_mov_b64 exec, 0xffffffff
buffer_store_dwordx4 v[24:27], v16, s[12:15], s70 offen sc1
s_mov_b64 exec, -1
L_nocsp:
v_mfma_f32_16x16x32_bf16 v[72:75], a[4:7], a[48:51], v[72:75]
v_mfma_f32_16x16x32_bf16 v[96:99], a[8:11], a[48:51], v[96:99]
v_mfma_f32_16x16x32_bf16 v[120:123], a[12:15], a[48:51], v[120:123]
v_mfma_f32_16x16x32_bf16 v[52:55], a[0:3], a[52:55], v[52:55]
v_mfma_f32_16x16x32_bf16 v[76:79], a[4:7], a[52:55], v[76:79]
v_mfma_f32_16x16x32_bf16 v[100:103], a[8:11], a[52:55], v[100:103]
v_mfma_f32_16x16x32_bf16 v[124:127], a[12:15], a[52:55], v[124:127]
s_waitcnt lgkmcnt(0)
v_mfma_f32_16x16x32_bf16 v[32:35], a[56:59], a[16:19], v[32:35]
s_barrier
ds_read_b128 a[0:3], v10 offset:57344
v_mfma_f32_16x16x32_bf16 v[56:59], a[56:59], a[20:23], v[56:59]
ds_read_b64_tr_b16 a[32:33], v14 offset:16384
v_mfma_f32_16x16x32_bf16 v[80:83], a[56:59], a[24:27], v[80:83]
ds_read_b64_tr_b16 a[34:35], v14 offset:16896
v_mfma_f32_16x16x32_bf16 v[104:107], a[56:59], a[28:31], v[104:107]
ds_read_b128 a[4:7], v10 offset:59392
v_mfma_f32_16x16x32_bf16 v[36:39], a[60:63], a[16:19], v[36:39]
ds_read_b128 a[8:11], v10 offset:61440
v_mfma_f32_16x16x32_bf16 v[60:63], a[60:63], a[20:23], v[60:63]
ds_read_b128 a[12:15], v10 offset:63488
v_mfma_f32_16x16x32_bf16 v[84:87], a[60:63], a[24:27], v[84:87]
ds_read_b64_tr_b16 a[36:37], v15 offset:16384
v_mfma_f32_16x16x32_bf16 v[108:111], a[60:63], a[28:31], v[108:111]
ds_read_b64_tr_b16 a[38:39], v15 offset:16896
v_mfma_f32_16x16x32_bf16 v[40:43], a[16:19], a[64:67], v[40:43]
ds_read_b64_tr_b16 a[40:41], v14 offset:18432
v_mfma_f32_16x16x32_bf16 v[64:67], a[20:23], a[64:67], v[64:67]
ds_read_b64_tr_b16 a[42:43], v14 offset:18944
v_mfma_f32_16x16x32_bf16 v[88:91], a[24:27], a[64:67], v[88:91]
ds_read_b64_tr_b16 a[44:45], v15 offset:18432
v_mfma_f32_16x16x32_bf16 v[112:115], a[28:31], a[64:67], v[112:115]
ds_read_b64_tr_b16 a[46:47], v15 offset:18944
v_mfma_f32_16x16x32_bf16 v[44:47], a[16:19], a[68:71], v[44:47]
ds_read_b64_tr_b16 a[48:49], v14 offset:20480
v_mfma_f32_16x16x32_bf16 v[68:71], a[20:23], a[68:71], v[68:71]
ds_read_b64_tr_b16 a[50:51], v14 offset:20992
v_mfma_f32_16x16x32_bf16 v[92:95], a[24:27], a[68:71], v[92:95]
ds_read_b64_tr_b16 a[52:53], v15 offset:20480
v_mfma_f32_16x16x32_bf16 v[116:119], a[28:31], a[68:71], v[116:119]
ds_read_b64_tr_b16 a[54:55], v15 offset:20992
v_mfma_f32_16x16x32_bf16 v[48:51], a[16:19], a[72:75], v[48:51]
v_mfma_f32_16x16x32_bf16 v[72:75], a[20:23], a[72:75], v[72:75]
v_mfma_f32_16x16x32_bf16 v[96:99], a[24:27], a[72:75], v[96:99]
v_mfma_f32_16x16x32_bf16 v[120:123], a[28:31], a[72:75], v[120:123]
v_mfma_f32_16x16x32_bf16 v[52:55], a[16:19], a[76:79], v[52:55]
v_mfma_f32_16x16x32_bf16 v[76:79], a[20:23], a[76:79], v[76:79]
v_mfma_f32_16x16x32_bf16 v[100:103], a[24:27], a[76:79], v[100:103]
v_mfma_f32_16x16x32_bf16 v[124:127], a[28:31], a[76:79], v[124:127]
s_waitcnt lgkmcnt(0)
v_mfma_f32_16x16x32_bf16 v[32:35], a[32:35], a[0:3], v[32:35]
ds_read_b128 a[16:19], v11 offset:57344
v_mfma_f32_16x16x32_bf16 v[56:59], a[32:35], a[4:7], v[56:59]
ds_read_b64_tr_b16 a[56:57], v14 offset:28672
v_mfma_f32_16x16x32_bf16 v[80:83], a[32:35], a[8:11], v[80:83]
ds_read_b64_tr_b16 a[58:59], v14 offset:29184
v_mfma_f32_16x16x32_bf16 v[104:107], a[32:35], a[12:15], v[104:107]
ds_read_b128 a[20:23], v11 offset:59392
v_mfma_f32_16x16x32_bf16 v[36:39], a[36:39], a[0:3], v[36:39]
ds_read_b128 a[24:27], v11 offset:61440
v_mfma_f32_16x16x32_bf16 v[60:63], a[36:39], a[4:7], v[60:63]
ds_read_b128 a[28:31], v11 offset:63488
v_mfma_f32_16x16x32_bf16 v[84:87], a[36:39], a[8:11], v[84:87]
ds_read_b64_tr_b16 a[60:61], v15 offset:28672
v_mfma_f32_16x16x32_bf16 v[108:111], a[36:39], a[12:15], v[108:111]
ds_read_b64_tr_b16 a[62:63], v15 offset:29184
v_mfma_f32_16x16x32_bf16 v[40:43], a[0:3], a[40:43], v[40:43]
ds_read_b64_tr_b16 a[64:65], v14 offset:30720
v_mfma_f32_16x16x32_bf16 v[64:67], a[4:7], a[40:43], v[64:67]
ds_read_b64_tr_b16 a[66:67], v14 offset:31232
v_mfma_f32_16x16x32_bf16 v[88:91], a[8:11], a[40:43], v[88:91]
ds_read_b64_tr_b16 a[68:69], v15 offset:30720
v_mfma_f32_16x16x32_bf16 v[112:115], a[12:15], a[40:43], v[112:115]
ds_read_b64_tr_b16 a[70:71], v15 offset:31232
v_mfma_f32_16x16x32_bf16 v[44:47], a[0:3], a[44:47], v[44:47]
ds_read_b64_tr_b16 a[72:73], v14 offset:32768
v_mfma_f32_16x16x32_bf16 v[68:71], a[4:7], a[44:47], v[68:71]
ds_read_b64_tr_b16 a[74:75], v14 offset:33280
v_mfma_f32_16x16x32_bf16 v[92:95], a[8:11], a[44:47], v[92:95]
ds_read_b64_tr_b16 a[76:77], v15 offset:32768
v_mfma_f32_16x16x32_bf16 v[116:119], a[12:15], a[44:47], v[116:119]
ds_read_b64_tr_b16 a[78:79], v15 offset:33280
v_mfma_f32_16x16x32_bf16 v[48:51], a[0:3], a[48:51], v[48:51]
s_add_u32 s70, s88, 0
buffer_store_dwordx4 v[28:31], v16, s[12:15], s70 offen sc1
v_mfma_f32_16x16x32_bf16 v[72:75], a[4:7], a[48:51], v[72:75]
v_mfma_f32_16x16x32_bf16 v[96:99], a[8:11], a[48:51], v[96:99]
s_add_u32 s70, s88, 32768
buffer_store_dwordx4 v[28:31], v16, s[12:15], s70 offen sc1
v_mfma_f32_16x16x32_bf16 v[120:123], a[12:15], a[48:51], v[120:123]
v_mfma_f32_16x16x32_bf16 v[52:55], a[0:3], a[52:55], v[52:55]
v_mfma_f32_16x16x32_bf16 v[76:79], a[4:7], a[52:55], v[76:79]
v_mfma_f32_16x16x32_bf16 v[100:103], a[8:11], a[52:55], v[100:103]
v_mfma_f32_16x16x32_bf16 v[124:127], a[12:15], a[52:55], v[124:127]
s_waitcnt lgkmcnt(0)
v_mfma_f32_16x16x32_bf16 v[32:35], a[56:59], a[16:19], v[32:35]
s_barrier
ds_read_b128 a[0:3], v10 offset:40960
v_mfma_f32_16x16x32_bf16 v[56:59], a[56:59], a[20:23], v[56:59]
ds_read_b64_tr_b16 a[32:33], v12 offset:40960
v_mfma_f32_16x16x32_bf16 v[80:83], a[56:59], a[24:27], v[80:83]
ds_read_b64_tr_b16 a[34:35], v12 offset:41472
v_mfma_f32_16x16x32_bf16 v[104:107], a[56:59], a[28:31], v[104:107]
ds_read_b128 a[4:7], v10 offset:43008
v_mfma_f32_16x16x32_bf16 v[36:39], a[60:63], a[16:19], v[36:39]
ds_read_b128 a[8:11], v10 offset:45056
v_mfma_f32_16x16x32_bf16 v[60:63], a[60:63], a[20:23], v[60:63]
ds_read_b128 a[12:15], v10 offset:47104
v_mfma_f32_16x16x32_bf16 v[84:87], a[60:63], a[24:27], v[84:87]
ds_read_b64_tr_b16 a[36:37], v13 offset:40960
v_mfma_f32_16x16x32_bf16 v[108:111], a[60:63], a[28:31], v[108:111]
ds_read_b64_tr_b16 a[38:39], v13 offset:41472
v_mfma_f32_16x16x32_bf16 v[40:43], a[16:19], a[64:67], v[40:43]
ds_read_b64_tr_b16 a[40:41], v12 offset:43008
v_mfma_f32_16x16x32_bf16 v[64:67], a[20:23], a[64:67], v[64:67]
ds_read_b64_tr_b16 a[42:43], v12 offset:43520
v_mfma_f32_16x16x32_bf16 v[88:91], a[24:27], a[64:67], v[88:91]
ds_read_b64_tr_b16 a[44:45], v13 offset:43008
v_mfma_f32_16x16x32_bf16 v[112:115], a[28:31], a[64:67], v[112:115]
ds_read_b64_tr_b16 a[46:47], v13 offset:43520
v_mfma_f32_16x16x32_bf16 v[44:47], a[16:19], a[68:71], v[44:47]
ds_read_b64_tr_b16 a[48:49], v12 offset:45056
v_mfma_f32_16x16x32_bf16 v[68:71], a[20:23], a[68:71], v[68:71]
ds_read_b64_tr_b16 a[50:51], v12 offset:45568
v_mfma_f32_16x16x32_bf16 v[92:95], a[24:27], a[68:71], v[92:95]
ds_read_b64_tr_b16 a[52:53], v13 offset:45056
v_mfma_f32_16x16x32_bf16 v[116:119], a[28:31], a[68:71], v[116:119]
ds_read_b64_tr_b16 a[54:55], v13 offset:45568
v_mfma_f32_16x16x32_bf16 v[48:51], a[16:19], a[72:75], v[48:51]
v_mfma_f32_16x16x32_bf16 v[72:75], a[20:23], a[72:75], v[72:75]
v_mfma_f32_16x16x32_bf16 v[96:99], a[24:27], a[72:75], v[96:99]
v_mfma_f32_16x16x32_bf16 v[120:123], a[28:31], a[72:75], v[120:123]
v_mfma_f32_16x16x32_bf16 v[52:55], a[16:19], a[76:79], v[52:55]
v_mfma_f32_16x16x32_bf16 v[76:79], a[20:23], a[76:79], v[76:79]
v_mfma_f32_16x16x32_bf16 v[100:103], a[24:27], a[76:79], v[100:103]
v_mfma_f32_16x16x32_bf16 v[124:127], a[28:31], a[76:79], v[124:127]
s_waitcnt lgkmcnt(0)
v_mfma_f32_16x16x32_bf16 v[32:35], a[32:35], a[0:3], v[32:35]
ds_read_b128 a[16:19], v11 offset:40960
v_mfma_f32_16x16x32_bf16 v[56:59], a[32:35], a[4:7], v[56:59]
ds_read_b64_tr_b16 a[56:57], v12 offset:53248
v_mfma_f32_16x16x32_bf16 v[80:83], a[32:35], a[8:11], v[80:83]
ds_read_b64_tr_b16 a[58:59], v12 offset:53760
v_mfma_f32_16x16x32_bf16 v[104:107], a[32:35], a[12:15], v[104:107]
ds_read_b128 a[20:23], v11 offset:43008
v_mfma_f32_16x16x32_bf16 v[36:39], a[36:39], a[0:3], v[36:39]
ds_read_b128 a[24:27], v11 offset:45056
v_mfma_f32_16x16x32_bf16 v[60:63], a[36:39], a[4:7], v[60:63]
ds_read_b128 a[28:31], v11 offset:47104
v_mfma_f32_16x16x32_bf16 v[84:87], a[36:39], a[8:11], v[84:87]
ds_read_b64_tr_b16 a[60:61], v13 offset:53248
v_mfma_f32_16x16x32_bf16 v[108:111], a[36:39], a[12:15], v[108:111]
ds_read_b64_tr_b16 a[62:63], v13 offset:53760
v_mfma_f32_16x16x32_bf16 v[40:43], a[0:3], a[40:43], v[40:43]
ds_read_b64_tr_b16 a[64:65], v12 offset:55296
v_mfma_f32_16x16x32_bf16 v[64:67], a[4:7], a[40:43], v[64:67]
ds_read_b64_tr_b16 a[66:67], v12 offset:55808
v_mfma_f32_16x16x32_bf16 v[88:91], a[8:11], a[40:43], v[88:91]
ds_read_b64_tr_b16 a[68:69], v13 offset:55296
v_mfma_f32_16x16x32_bf16 v[112:115], a[12:15], a[40:43], v[112:115]
ds_read_b64_tr_b16 a[70:71], v13 offset:55808
v_mfma_f32_16x16x32_bf16 v[44:47], a[0:3], a[44:47], v[44:47]
ds_read_b64_tr_b16 a[72:73], v12 offset:57344
v_mfma_f32_16x16x32_bf16 v[68:71], a[4:7], a[44:47], v[68:71]
ds_read_b64_tr_b16 a[74:75], v12 offset:57856
v_mfma_f32_16x16x32_bf16 v[92:95], a[8:11], a[44:47], v[92:95]
ds_read_b64_tr_b16 a[76:77], v13 offset:57344
v_mfma_f32_16x16x32_bf16 v[116:119], a[12:15], a[44:47], v[116:119]
ds_read_b64_tr_b16 a[78:79], v13 offset:57856
v_mfma_f32_16x16x32_bf16 v[48:51], a[0:3], a[48:51], v[48:51]
s_add_u32 s70, s88, 65536
buffer_store_dwordx4 v[28:31], v16, s[12:15], s70 offen sc1
v_mfma_f32_16x16x32_bf16 v[72:75], a[4:7], a[48:51], v[72:75]
v_mfma_f32_16x16x32_bf16 v[96:99], a[8:11], a[48:51], v[96:99]
s_add_u32 s70, s88, 98304
buffer_store_dwordx4 v[28:31], v16, s[12:15], s70 offen sc1
v_mfma_f32_16x16x32_bf16 v[120:123], a[12:15], a[48:51], v[120:123]
v_mfma_f32_16x16x32_bf16 v[52:55], a[0:3], a[52:55], v[52:55]
v_mfma_f32_16x16x32_bf16 v[76:79], a[4:7], a[52:55], v[76:79]
v_mfma_f32_16x16x32_bf16 v[100:103], a[8:11], a[52:55], v[100:103]
v_mfma_f32_16x16x32_bf16 v[124:127], a[12:15], a[52:55], v[124:127]
s_waitcnt lgkmcnt(0)
v_mfma_f32_16x16x32_bf16 v[32:35], a[56:59], a[16:19], v[32:35]
s_barrier
ds_read_b128 a[0:3], v10 offset:0
v_mfma_f32_16x16x32_bf16 v[56:59], a[56:59], a[20:23], v[56:59]
ds_read_b64_tr_b16 a[32:33], v12 offset:0
v_mfma_f32_16x16x32_bf16 v[80:83], a[56:59], a[24:27], v[80:83]
ds_read_b64_tr_b16 a[34:35], v12 offset:512
v_mfma_f32_16x16x32_bf16 v[104:107], a[56:59], a[28:31], v[104:107]
ds_read_b128 a[4:7], v10 offset:2048
v_mfma_f32_16x16x32_bf16 v[36:39], a[60:63], a[16:19], v[36:39]
ds_read_b128 a[8:11], v10 offset:4096
v_mfma_f32_16x16x32_bf16 v[60:63], a[60:63], a[20:23], v[60:63]
ds_read_b128 a[12:15], v10 offset:6144
v_mfma_f32_16x16x32_bf16 v[84:87], a[60:63], a[24:27], v[84:87]
ds_read_b64_tr_b16 a[36:37], v13 offset:0
v_mfma_f32_16x16x32_bf16 v[108:111], a[60:63], a[28:31], v[108:111]
ds_read_b64_tr_b16 a[38:39], v13 offset:512
v_mfma_f32_16x16x32_bf16 v[40:43], a[16:19], a[64:67], v[40:43]
ds_read_b64_tr_b16 a[40:41], v12 offset:2048
v_mfma_f32_16x16x32_bf16 v[64:67], a[20:23], a[64:67], v[64:67]
ds_read_b64_tr_b16 a[42:43], v12 offset:2560
v_mfma_f32_16x16x32_bf16 v[88:91], a[24:27], a[64:67], v[88:91]
ds_read_b64_tr_b16 a[44:45], v13 offset:2048
v_mfma_f32_16x16x32_bf16 v[112:115], a[28:31], a[64:67], v[112:115]
ds_read_b64_tr_b16 a[46:47], v13 offset:2560
v_mfma_f32_16x16x32_bf16 v[44:47], a[16:19], a[68:71], v[44:47]
ds_read_b64_tr_b16 a[48:49], v12 offset:4096
v_mfma_f32_16x16x32_bf16 v[68:71], a[20:23], a[68:71], v[68:71]
ds_read_b64_tr_b16 a[50:51], v12 offset:4608
v_mfma_f32_16x16x32_bf16 v[92:95], a[24:27], a[68:71], v[92:95]
ds_read_b64_tr_b16 a[52:53], v13 offset:4096
v_mfma_f32_16x16x32_bf16 v[116:119], a[28:31], a[68:71], v[116:119]
ds_read_b64_tr_b16 a[54:55], v13 offset:4608
v_mfma_f32_16x16x32_bf16 v[48:51], a[16:19], a[72:75], v[48:51]
v_mfma_f32_16x16x32_bf16 v[72:75], a[20:23], a[72:75], v[72:75]
v_mfma_f32_16x16x32_bf16 v[96:99], a[24:27], a[72:75], v[96:99]
v_mfma_f32_16x16x32_bf16 v[120:123], a[28:31], a[72:75], v[120:123]
v_mfma_f32_16x16x32_bf16 v[52:55], a[16:19], a[76:79], v[52:55]
v_mfma_f32_16x16x32_bf16 v[76:79], a[20:23], a[76:79], v[76:79]
v_mfma_f32_16x16x32_bf16 v[100:103], a[24:27], a[76:79], v[100:103]
v_mfma_f32_16x16x32_bf16 v[124:127], a[28:31], a[76:79], v[124:127]
s_waitcnt lgkmcnt(0)
v_mfma_f32_16x16x32_bf16 v[32:35], a[32:35], a[0:3], v[32:35]
ds_read_b128 a[16:19], v11 offset:0
v_mfma_f32_16x16x32_bf16 v[56:59], a[32:35], a[4:7], v[56:59]
ds_read_b64_tr_b16 a[56:57], v12 offset:12288
v_mfma_f32_16x16x32_bf16 v[80:83], a[32:35], a[8:11], v[80:83]
ds_read_b64_tr_b16 a[58:59], v12 offset:12800
v_mfma_f32_16x16x32_bf16 v[104:107], a[32:35], a[12:15], v[104:107]
ds_read_b128 a[20:23], v11 offset:2048
v_mfma_f32_16x16x32_bf16 v[36:39], a[36:39], a[0:3], v[36:39]
ds_read_b128 a[24:27], v11 offset:4096
v_mfma_f32_16x16x32_bf16 v[60:63], a[36:39], a[4:7], v[60:63]
ds_read_b128 a[28:31], v11 offset:6144
v_mfma_f32_16x16x32_bf16 v[84:87], a[36:39], a[8:11], v[84:87]
ds_read_b64_tr_b16 a[60:61], v13 offset:12288
v_mfma_f32_16x16x32_bf16 v[108:111], a[36:39], a[12:15], v[108:111]
ds_read_b64_tr_b16 a[62:63], v13 offset:12800
v_mfma_f32_16x16x32_bf16 v[40:43], a[0:3], a[40:43], v[40:43]
ds_read_b64_tr_b16 a[64:65], v12 offset:14336
v_mfma_f32_16x16x32_bf16 v[64:67], a[4:7], a[40:43], v[64:67]
ds_read_b64_tr_b16 a[66:67], v12 offset:14848
v_mfma_f32_16x16x32_bf16 v[88:91], a[8:11], a[40:43], v[88:91]
ds_read_b64_tr_b16 a[68:69], v13 offset:14336
v_mfma_f32_16x16x32_bf16 v[112:115], a[12:15], a[40:43], v[112:115]
ds_read_b64_tr_b16 a[70:71], v13 offset:14848
v_mfma_f32_16x16x32_bf16 v[44:47], a[0:3], a[44:47], v[44:47]
ds_read_b64_tr_b16 a[72:73], v12 offset:16384
v_mfma_f32_16x16x32_bf16 v[68:71], a[4:7], a[44:47], v[68:71]
ds_read_b64_tr_b16 a[74:75], v12 offset:16896
v_mfma_f32_16x16x32_bf16 v[92:95], a[8:11], a[44:47], v[92:95]
ds_read_b64_tr_b16 a[76:77], v13 offset:16384
v_mfma_f32_16x16x32_bf16 v[116:119], a[12:15], a[44:47], v[116:119]
ds_read_b64_tr_b16 a[78:79], v13 offset:16896
v_mfma_f32_16x16x32_bf16 v[48:51], a[0:3], a[48:51], v[48:51]
v_mfma_f32_16x16x32_bf16 v[72:75], a[4:7], a[48:51], v[72:75]
v_mfma_f32_16x16x32_bf16 v[96:99], a[8:11], a[48:51], v[96:99]
v_mfma_f32_16x16x32_bf16 v[120:123], a[12:15], a[48:51], v[120:123]
v_mfma_f32_16x16x32_bf16 v[52:55], a[0:3], a[52:55], v[52:55]
v_mfma_f32_16x16x32_bf16 v[76:79], a[4:7], a[52:55], v[76:79]
v_mfma_f32_16x16x32_bf16 v[100:103], a[8:11], a[52:55], v[100:103]
v_mfma_f32_16x16x32_bf16 v[124:127], a[12:15], a[52:55], v[124:127]
s_waitcnt lgkmcnt(0)
v_mfma_f32_16x16x32_bf16 v[32:35], a[56:59], a[16:19], v[32:35]
s_barrier
ds_read_b128 a[0:3], v8 offset:24576
v_mfma_f32_16x16x32_bf16 v[56:59], a[56:59], a[20:23], v[56:59]
ds_read_b64_tr_b16 a[32:33], v14 offset:16384
v_mfma_f32_16x16x32_bf16 v[80:83], a[56:59], a[24:27], v[80:83]
ds_read_b64_tr_b16 a[34:35], v14 offset:16896
v_mfma_f32_16x16x32_bf16 v[104:107], a[56:59], a[28:31], v[104:107]
ds_read_b128 a[4:7], v8 offset:26624
v_mfma_f32_16x16x32_bf16 v[36:39], a[60:63], a[16:19], v[36:39]
ds_read_b128 a[8:11], v8 offset:28672
v_mfma_f32_16x16x32_bf16 v[60:63], a[60:63], a[20:23], v[60:63]
ds_read_b128 a[12:15], v8 offset:30720
v_mfma_f32_16x16x32_bf16 v[84:87], a[60:63], a[24:27], v[84:87]
ds_read_b64_tr_b16 a[36:37], v15 offset:16384
v_mfma_f32_16x16x32_bf16 v[108:111], a[60:63], a[28:31], v[108:111]
ds_read_b64_tr_b16 a[38:39], v15 offset:16896
v_mfma_f32_16x16x32_bf16 v[40:43], a[16:19], a[64:67], v[40:43]
ds_read_b64_tr_b16 a[40:41], v14 offset:18432
v_mfma_f32_16x16x32_bf16 v[64:67], a[20:23], a[64:67], v[64:67]
ds_read_b64_tr_b16 a[42:43], v14 offset:18944
v_mfma_f32_16x16x32_bf16 v[88:91], a[24:27], a[64:67], v[88:91]
ds_read_b64_tr_b16 a[44:45], v15 offset:18432
v_mfma_f32_16x16x32_bf16 v[112:115], a[28:31], a[64:67], v[112:115]
ds_read_b64_tr_b16 a[46:47], v15 offset:18944
v_mfma_f32_16x16x32_bf16 v[44:47], a[16:19], a[68:71], v[44:47]
ds_read_b64_tr_b16 a[48:49], v14 offset:20480
v_mfma_f32_16x16x32_bf16 v[68:71], a[20:23], a[68:71], v[68:71]
ds_read_b64_tr_b16 a[50:51], v14 offset:20992
v_mfma_f32_16x16x32_bf16 v[92:95], a[24:27], a[68:71], v[92:95]
ds_read_b64_tr_b16 a[52:53], v15 offset:20480
v_mfma_f32_16x16x32_bf16 v[116:119], a[28:31], a[68:71], v[116:119]
ds_read_b64_tr_b16 a[54:55], v15 offset:20992
v_mfma_f32_16x16x32_bf16 v[48:51], a[16:19], a[72:75], v[48:51]
v_mfma_f32_16x16x32_bf16 v[72:75], a[20:23], a[72:75], v[72:75]
v_mfma_f32_16x16x32_bf16 v[96:99], a[24:27], a[72:75], v[96:99]
v_mfma_f32_16x16x32_bf16 v[120:123], a[28:31], a[72:75], v[120:123]
v_mfma_f32_16x16x32_bf16 v[52:55], a[16:19], a[76:79], v[52:55]
v_mfma_f32_16x16x32_bf16 v[76:79], a[20:23], a[76:79], v[76:79]
v_mfma_f32_16x16x32_bf16 v[100:103], a[24:27], a[76:79], v[100:103]
v_mfma_f32_16x16x32_bf16 v[124:127], a[28:31], a[76:79], v[124:127]
s_waitcnt lgkmcnt(0)
v_mfma_f32_16x16x32_bf16 v[32:35], a[32:35], a[0:3], v[32:35]
ds_read_b128 a[16:19], v9 offset:24576
v_mfma_f32_16x16x32_bf16 v[56:59], a[32:35], a[4:7], v[56:59]
ds_read_b64_tr_b16 a[56:57], v14 offset:28672
v_mfma_f32_16x16x32_bf16 v[80:83], a[32:35], a[8:11], v[80:83]
ds_read_b64_tr_b16 a[58:59], v14 offset:29184
v_mfma_f32_16x16x32_bf16 v[104:107], a[32:35], a[12:15], v[104:107]
ds_read_b128 a[20:23], v9 offset:26624
v_mfma_f32_16x16x32_bf16 v[36:39], a[36:39], a[0:3], v[36:39]
ds_read_b128 a[24:27], v9 offset:28672
v_mfma_f32_16x16x32_bf16 v[60:63], a[36:39], a[4:7], v[60:63]
ds_read_b128 a[28:31], v9 offset:30720
v_mfma_f32_16x16x32_bf16 v[84:87], a[36:39], a[8:11], v[84:87]
ds_read_b64_tr_b16 a[60:61], v15 offset:28672
v_mfma_f32_16x16x32_bf16 v[108:111], a[36:39], a[12:15], v[108:111]
ds_read_b64_tr_b16 a[62:63], v15 offset:29184
v_mfma_f32_16x16x32_bf16 v[40:43], a[0:3], a[40:43], v[40:43]
ds_read_b64_tr_b16 a[64:65], v14 offset:30720
v_mfma_f32_16x16x32_bf16 v[64:67], a[4:7], a[40:43], v[64:67]
ds_read_b64_tr_b16 a[66:67], v14 offset:31232
v_mfma_f32_16x16x32_bf16 v[88:91], a[8:11], a[40:43], v[88:91]
ds_read_b64_tr_b16 a[68:69], v15 offset:30720
v_mfma_f32_16x16x32_bf16 v[112:115], a[12:15], a[40:43], v[112:115]
ds_read_b64_tr_b16 a[70:71], v15 offset:31232
v_mfma_f32_16x16x32_bf16 v[44:47], a[0:3], a[44:47], v[44:47]
ds_read_b64_tr_b16 a[72:73], v14 offset:32768
v_mfma_f32_16x16x32_bf16 v[68:71], a[4:7], a[44:47], v[68:71]
ds_read_b64_tr_b16 a[74:75], v14 offset:33280
v_mfma_f32_16x16x32_bf16 v[92:95], a[8:11], a[44:47], v[92:95]
ds_read_b64_tr_b16 a[76:77], v15 offset:32768
v_mfma_f32_16x16x32_bf16 v[116:119], a[12:15], a[44:47], v[116:119]
ds_read_b64_tr_b16 a[78:79], v15 offset:33280
v_mfma_f32_16x16x32_bf16 v[48:51], a[0:3], a[48:51], v[48:51]
s_waitcnt vmcnt(0)
v_mfma_f32_16x16x32_bf16 v[72:75], a[4:7], a[48:51], v[72:75]
v_mfma_f32_16x16x32_bf16 v[96:99], a[8:11], a[48:51], v[96:99]
v_mfma_f32_16x16x32_bf16 v[120:123], a[12:15], a[48:51], v[120:123]
v_mfma_f32_16x16x32_bf16 v[52:55], a[0:3], a[52:55], v[52:55]
v_mfma_f32_16x16x32_bf16 v[76:79], a[4:7], a[52:55], v[76:79]
v_mfma_f32_16x16x32_bf16 v[100:103], a[8:11], a[52:55], v[100:103]
v_mfma_f32_16x16x32_bf16 v[124:127], a[12:15], a[52:55], v[124:127]
s_waitcnt lgkmcnt(0)
v_mfma_f32_16x16x32_bf16 v[32:35], a[56:59], a[16:19], v[32:35]
s_barrier
ds_read_b128 a[0:3], v10 offset:57344
v_mfma_f32_16x16x32_bf16 v[56:59], a[56:59], a[20:23], v[56:59]
ds_read_b64_tr_b16 a[32:33], v12 offset:40960
v_mfma_f32_16x16x32_bf16 v[80:83], a[56:59], a[24:27], v[80:83]
ds_read_b64_tr_b16 a[34:35], v12 offset:41472
v_mfma_f32_16x16x32_bf16 v[104:107], a[56:59], a[28:31], v[104:107]
ds_read_b128 a[4:7], v10 offset:59392
v_mfma_f32_16x16x32_bf16 v[36:39], a[60:63], a[16:19], v[36:39]
ds_read_b128 a[8:11], v10 offset:61440
v_mfma_f32_16x16x32_bf16 v[60:63], a[60:63], a[20:23], v[60:63]
ds_read_b128 a[12:15], v10 offset:63488
v_mfma_f32_16x16x32_bf16 v[84:87], a[60:63], a[24:27], v[84:87]
ds_read_b64_tr_b16 a[36:37], v13 offset:40960
v_mfma_f32_16x16x32_bf16 v[108:111], a[60:63], a[28:31], v[108:111]
ds_read_b64_tr_b16 a[38:39], v13 offset:41472
v_mfma_f32_16x16x32_bf16 v[40:43], a[16:19], a[64:67], v[40:43]
ds_read_b64_tr_b16 a[40:41], v12 offset:43008
v_mfma_f32_16x16x32_bf16 v[64:67], a[20:23], a[64:67], v[64:67]
ds_read_b64_tr_b16 a[42:43], v12 offset:43520
v_mfma_f32_16x16x32_bf16 v[88:91], a[24:27], a[64:67], v[88:91]
ds_read_b64_tr_b16 a[44:45], v13 offset:43008
v_mfma_f32_16x16x32_bf16 v[112:115], a[28:31], a[64:67], v[112:115]
ds_read_b64_tr_b16 a[46:47], v13 offset:43520
v_mfma_f32_16x16x32_bf16 v[44:47], a[16:19], a[68:71], v[44:47]
ds_read_b64_tr_b16 a[48:49], v12 offset:45056
v_mfma_f32_16x16x32_bf16 v[68:71], a[20:23], a[68:71], v[68:71]
ds_read_b64_tr_b16 a[50:51], v12 offset:45568
v_mfma_f32_16x16x32_bf16 v[92:95], a[24:27], a[68:71], v[92:95]
ds_read_b64_tr_b16 a[52:53], v13 offset:45056
v_mfma_f32_16x16x32_bf16 v[116:119], a[28:31], a[68:71], v[116:119]
ds_read_b64_tr_b16 a[54:55], v13 offset:45568
v_mfma_f32_16x16x32_bf16 v[48:51], a[16:19], a[72:75], v[48:51]
v_mfma_f32_16x16x32_bf16 v[72:75], a[20:23], a[72:75], v[72:75]
v_mfma_f32_16x16x32_bf16 v[96:99], a[24:27], a[72:75], v[96:99]
v_mfma_f32_16x16x32_bf16 v[120:123], a[28:31], a[72:75], v[120:123]
v_mfma_f32_16x16x32_bf16 v[52:55], a[16:19], a[76:79], v[52:55]
v_mfma_f32_16x16x32_bf16 v[76:79], a[20:23], a[76:79], v[76:79]
v_mfma_f32_16x16x32_bf16 v[100:103], a[24:27], a[76:79], v[100:103]
v_mfma_f32_16x16x32_bf16 v[124:127], a[28:31], a[76:79], v[124:127]
s_waitcnt lgkmcnt(0)
v_mfma_f32_16x16x32_bf16 v[32:35], a[32:35], a[0:3], v[32:35]
ds_read_b128 a[16:19], v11 offset:57344
v_mfma_f32_16x16x32_bf16 v[56:59], a[32:35], a[4:7], v[56:59]
ds_read_b64_tr_b16 a[56:57], v12 offset:53248
v_mfma_f32_16x16x32_bf16 v[80:83], a[32:35], a[8:11], v[80:83]
ds_read_b64_tr_b16 a[58:59], v12 offset:53760
v_mfma_f32_16x16x32_bf16 v[104:107], a[32:35], a[12:15], v[104:107]
ds_read_b128 a[20:23], v11 offset:59392
v_mfma_f32_16x16x32_bf16 v[36:39], a[36:39], a[0:3], v[36:39]
ds_read_b128 a[24:27], v11 offset:61440
v_mfma_f32_16x16x32_bf16 v[60:63], a[36:39], a[4:7], v[60:63]
ds_read_b128 a[28:31], v11 offset:63488
v_mfma_f32_16x16x32_bf16 v[84:87], a[36:39], a[8:11], v[84:87]
ds_read_b64_tr_b16 a[60:61], v13 offset:53248
v_mfma_f32_16x16x32_bf16 v[108:111], a[36:39], a[12:15], v[108:111]
ds_read_b64_tr_b16 a[62:63], v13 offset:53760
v_mfma_f32_16x16x32_bf16 v[40:43], a[0:3], a[40:43], v[40:43]
ds_read_b64_tr_b16 a[64:65], v12 offset:55296
v_mfma_f32_16x16x32_bf16 v[64:67], a[4:7], a[40:43], v[64:67]
ds_read_b64_tr_b16 a[66:67], v12 offset:55808
v_mfma_f32_16x16x32_bf16 v[88:91], a[8:11], a[40:43], v[88:91]
ds_read_b64_tr_b16 a[68:69], v13 offset:55296
v_mfma_f32_16x16x32_bf16 v[112:115], a[12:15], a[40:43], v[112:115]
ds_read_b64_tr_b16 a[70:71], v13 offset:55808
v_mfma_f32_16x16x32_bf16 v[44:47], a[0:3], a[44:47], v[44:47]
ds_read_b64_tr_b16 a[72:73], v12 offset:57344
v_mfma_f32_16x16x32_bf16 v[68:71], a[4:7], a[44:47], v[68:71]
ds_read_b64_tr_b16 a[74:75], v12 offset:57856
v_mfma_f32_16x16x32_bf16 v[92:95], a[8:11], a[44:47], v[92:95]
ds_read_b64_tr_b16 a[76:77], v13 offset:57344
v_mfma_f32_16x16x32_bf16 v[116:119], a[12:15], a[44:47], v[116:119]
ds_read_b64_tr_b16 a[78:79], v13 offset:57856
v_mfma_f32_16x16x32_bf16 v[48:51], a[0:3], a[48:51], v[48:51]
v_mfma_f32_16x16x32_bf16 v[72:75], a[4:7], a[48:51], v[72:75]
v_mfma_f32_16x16x32_bf16 v[96:99], a[8:11], a[48:51], v[96:99]
v_mfma_f32_16x16x32_bf16 v[120:123], a[12:15], a[48:51], v[120:123]
v_mfma_f32_16x16x32_bf16 v[52:55], a[0:3], a[52:55], v[52:55]
v_mfma_f32_16x16x32_bf16 v[76:79], a[4:7], a[52:55], v[76:79]
v_mfma_f32_16x16x32_bf16 v[100:103], a[8:11], a[52:55], v[100:103]
v_mfma_f32_16x16x32_bf16 v[124:127], a[12:15], a[52:55], v[124:127]
s_waitcnt lgkmcnt(0)
v_mfma_f32_16x16x32_bf16 v[32:35], a[56:59], a[16:19], v[32:35]
s_barrier
ds_read_b128 a[0:3], v10 offset:40960
v_mfma_f32_16x16x32_bf16 v[56:59], a[56:59], a[20:23], v[56:59]
ds_read_b64_tr_b16 a[32:33], v12 offset:0
v_mfma_f32_16x16x32_bf16 v[80:83], a[56:59], a[24:27], v[80:83]
ds_read_b64_tr_b16 a[34:35], v12 offset:512
v_mfma_f32_16x16x32_bf16 v[104:107], a[56:59], a[28:31], v[104:107]
ds_read_b128 a[4:7], v10 offset:43008
v_mfma_f32_16x16x32_bf16 v[36:39], a[60:63], a[16:19], v[36:39]
ds_read_b128 a[8:11], v10 offset:45056
v_mfma_f32_16x16x32_bf16 v[60:63], a[60:63], a[20:23], v[60:63]
ds_read_b128 a[12:15], v10 offset:47104
v_mfma_f32_16x16x32_bf16 v[84:87], a[60:63], a[24:27], v[84:87]
ds_read_b64_tr_b16 a[36:37], v13 offset:0
v_mfma_f32_16x16x32_bf16 v[108:111], a[60:63], a[28:31], v[108:111]
ds_read_b64_tr_b16 a[38:39], v13 offset:512
v_mfma_f32_16x16x32_bf16 v[40:43], a[16:19], a[64:67], v[40:43]
ds_read_b64_tr_b16 a[40:41], v12 offset:2048
v_mfma_f32_16x16x32_bf16 v[64:67], a[20:23], a[64:67], v[64:67]
ds_read_b64_tr_b16 a[42:43], v12 offset:2560
v_mfma_f32_16x16x32_bf16 v[88:91], a[24:27], a[64:67], v[88:91]
ds_read_b64_tr_b16 a[44:45], v13 offset:2048
v_mfma_f32_16x16x32_bf16 v[112:115], a[28:31], a[64:67], v[112:115]
ds_read_b64_tr_b16 a[46:47], v13 offset:2560
v_mfma_f32_16x16x32_bf16 v[44:47], a[16:19], a[68:71], v[44:47]
ds_read_b64_tr_b16 a[48:49], v12 offset:4096
v_mfma_f32_16x16x32_bf16 v[68:71], a[20:23], a[68:71], v[68:71]
ds_read_b64_tr_b16 a[50:51], v12 offset:4608
v_mfma_f32_16x16x32_bf16 v[92:95], a[24:27], a[68:71], v[92:95]
ds_read_b64_tr_b16 a[52:53], v13 offset:4096
v_mfma_f32_16x16x32_bf16 v[116:119], a[28:31], a[68:71], v[116:119]
ds_read_b64_tr_b16 a[54:55], v13 offset:4608
v_mfma_f32_16x16x32_bf16 v[48:51], a[16:19], a[72:75], v[48:51]
v_mfma_f32_16x16x32_bf16 v[72:75], a[20:23], a[72:75], v[72:75]
v_mfma_f32_16x16x32_bf16 v[96:99], a[24:27], a[72:75], v[96:99]
v_mfma_f32_16x16x32_bf16 v[120:123], a[28:31], a[72:75], v[120:123]
v_mfma_f32_16x16x32_bf16 v[52:55], a[16:19], a[76:79], v[52:55]
v_mfma_f32_16x16x32_bf16 v[76:79], a[20:23], a[76:79], v[76:79]
v_mfma_f32_16x16x32_bf16 v[100:103], a[24:27], a[76:79], v[100:103]
v_mfma_f32_16x16x32_bf16 v[124:127], a[28:31], a[76:79], v[124:127]
s_waitcnt lgkmcnt(0)
v_mfma_f32_16x16x32_bf16 v[32:35], a[32:35], a[0:3], v[32:35]
ds_read_b128 a[16:19], v11 offset:40960
v_mfma_f32_16x16x32_bf16 v[56:59], a[32:35], a[4:7], v[56:59]
ds_read_b64_tr_b16 a[56:57], v12 offset:12288
v_mfma_f32_16x16x32_bf16 v[80:83], a[32:35], a[8:11], v[80:83]
ds_read_b64_tr_b16 a[58:59], v12 offset:12800
v_mfma_f32_16x16x32_bf16 v[104:107], a[32:35], a[12:15], v[104:107]
ds_read_b128 a[20:23], v11 offset:43008
v_mfma_f32_16x16x32_bf16 v[36:39], a[36:39], a[0:3], v[36:39]
ds_read_b128 a[24:27], v11 offset:45056
v_mfma_f32_16x16x32_bf16 v[60:63], a[36:39], a[4:7], v[60:63]
ds_read_b128 a[28:31], v11 offset:47104
v_mfma_f32_16x16x32_bf16 v[84:87], a[36:39], a[8:11], v[84:87]
ds_read_b64_tr_b16 a[60:61], v13 offset:12288
v_mfma_f32_16x16x32_bf16 v[108:111], a[36:39], a[12:15], v[108:111]
ds_read_b64_tr_b16 a[62:63], v13 offset:12800
v_mfma_f32_16x16x32_bf16 v[40:43], a[0:3], a[40:43], v[40:43]
ds_read_b64_tr_b16 a[64:65], v12 offset:14336
v_mfma_f32_16x16x32_bf16 v[64:67], a[4:7], a[40:43], v[64:67]
ds_read_b64_tr_b16 a[66:67], v12 offset:14848
v_mfma_f32_16x16x32_bf16 v[88:91], a[8:11], a[40:43], v[88:91]
ds_read_b64_tr_b16 a[68:69], v13 offset:14336
v_mfma_f32_16x16x32_bf16 v[112:115], a[12:15], a[40:43], v[112:115]
ds_read_b64_tr_b16 a[70:71], v13 offset:14848
v_mfma_f32_16x16x32_bf16 v[44:47], a[0:3], a[44:47], v[44:47]
ds_read_b64_tr_b16 a[72:73], v12 offset:16384
v_mfma_f32_16x16x32_bf16 v[68:71], a[4:7], a[44:47], v[68:71]
ds_read_b64_tr_b16 a[74:75], v12 offset:16896
v_mfma_f32_16x16x32_bf16 v[92:95], a[8:11], a[44:47], v[92:95]
ds_read_b64_tr_b16 a[76:77], v13 offset:16384
v_mfma_f32_16x16x32_bf16 v[116:119], a[12:15], a[44:47], v[116:119]
ds_read_b64_tr_b16 a[78:79], v13 offset:16896
v_mfma_f32_16x16x32_bf16 v[48:51], a[0:3], a[48:51], v[48:51]
v_mfma_f32_16x16x32_bf16 v[72:75], a[4:7], a[48:51], v[72:75]
v_mfma_f32_16x16x32_bf16 v[96:99], a[8:11], a[48:51], v[96:99]
v_mfma_f32_16x16x32_bf16 v[120:123], a[12:15], a[48:51], v[120:123]
v_mfma_f32_16x16x32_bf16 v[52:55], a[0:3], a[52:55], v[52:55]
v_mfma_f32_16x16x32_bf16 v[76:79], a[4:7], a[52:55], v[76:79]
v_mfma_f32_16x16x32_bf16 v[100:103], a[8:11], a[52:55], v[100:103]
v_mfma_f32_16x16x32_bf16 v[124:127], a[12:15], a[52:55], v[124:127]
s_waitcnt lgkmcnt(0)
v_mfma_f32_16x16x32_bf16 v[32:35], a[56:59], a[16:19], v[32:35]
s_barrier
ds_read_b128 a[0:3], v10 offset:0
v_mfma_f32_16x16x32_bf16 v[56:59], a[56:59], a[20:23], v[56:59]
ds_read_b64_tr_b16 a[32:33], v14 offset:16384
v_mfma_f32_16x16x32_bf16 v[80:83], a[56:59], a[24:27], v[80:83]
ds_read_b64_tr_b16 a[34:35], v14 offset:16896
v_mfma_f32_16x16x32_bf16 v[104:107], a[56:59], a[28:31], v[104:107]
ds_read_b128 a[4:7], v10 offset:2048
v_mfma_f32_16x16x32_bf16 v[36:39], a[60:63], a[16:19], v[36:39]
ds_read_b128 a[8:11], v10 offset:4096
v_mfma_f32_16x16x32_bf16 v[60:63], a[60:63], a[20:23], v[60:63]
ds_read_b128 a[12:15], v10 offset:6144
v_mfma_f32_16x16x32_bf16 v[84:87], a[60:63], a[24:27], v[84:87]
ds_read_b64_tr_b16 a[36:37], v15 offset:16384
v_mfma_f32_16x16x32_bf16 v[108:111], a[60:63], a[28:31], v[108:111]
ds_read_b64_tr_b16 a[38:39], v15 offset:16896
v_mfma_f32_16x16x32_bf16 v[40:43], a[16:19], a[64:67], v[40:43]
ds_read_b64_tr_b16 a[40:41], v14 offset:18432
v_mfma_f32_16x16x32_bf16 v[64:67], a[20:23], a[64:67], v[64:67]
ds_read_b64_tr_b16 a[42:43], v14 offset:18944
v_mfma_f32_16x16x32_bf16 v[88:91], a[24:27], a[64:67], v[88:91]
ds_read_b64_tr_b16 a[44:45], v15 offset:18432
v_mfma_f32_16x16x32_bf16 v[112:115], a[28:31], a[64:67], v[112:115]
ds_read_b64_tr_b16 a[46:47], v15 offset:18944
v_mfma_f32_16x16x32_bf16 v[44:47], a[16:19], a[68:71], v[44:47]
ds_read_b64_tr_b16 a[48:49], v14 offset:20480
v_mfma_f32_16x16x32_bf16 v[68:71], a[20:23], a[68:71], v[68:71]
ds_read_b64_tr_b16 a[50:51], v14 offset:20992
v_mfma_f32_16x16x32_bf16 v[92:95], a[24:27], a[68:71], v[92:95]
ds_read_b64_tr_b16 a[52:53], v15 offset:20480
v_mfma_f32_16x16x32_bf16 v[116:119], a[28:31], a[68:71], v[116:119]
ds_read_b64_tr_b16 a[54:55], v15 offset:20992
v_mfma_f32_16x16x32_bf16 v[48:51], a[16:19], a[72:75], v[48:51]
v_mfma_f32_16x16x32_bf16 v[72:75], a[20:23], a[72:75], v[72:75]
v_mfma_f32_16x16x32_bf16 v[96:99], a[24:27], a[72:75], v[96:99]
v_mfma_f32_16x16x32_bf16 v[120:123], a[28:31], a[72:75], v[120:123]
v_mfma_f32_16x16x32_bf16 v[52:55], a[16:19], a[76:79], v[52:55]
v_mfma_f32_16x16x32_bf16 v[76:79], a[20:23], a[76:79], v[76:79]
v_mfma_f32_16x16x32_bf16 v[100:103], a[24:27], a[76:79], v[100:103]
v_mfma_f32_16x16x32_bf16 v[124:127], a[28:31], a[76:79], v[124:127]
s_waitcnt lgkmcnt(0)
v_mfma_f32_16x16x32_bf16 v[32:35], a[32:35], a[0:3], v[32:35]
ds_read_b128 a[16:19], v11 offset:0
v_mfma_f32_16x16x32_bf16 v[56:59], a[32:35], a[4:7], v[56:59]
ds_read_b64_tr_b16 a[56:57], v14 offset:28672
v_mfma_f32_16x16x32_bf16 v[80:83], a[32:35], a[8:11], v[80:83]
ds_read_b64_tr_b16 a[58:59], v14 offset:29184
v_mfma_f32_16x16x32_bf16 v[104:107], a[32:35], a[12:15], v[104:107]
ds_read_b128 a[20:23], v11 offset:2048
v_mfma_f32_16x16x32_bf16 v[36:39], a[36:39], a[0:3], v[36:39]
ds_read_b128 a[24:27], v11 offset:4096
v_mfma_f32_16x16x32_bf16 v[60:63], a[36:39], a[4:7], v[60:63]
ds_read_b128 a[28:31], v11 offset:6144
v_mfma_f32_16x16x32_bf16 v[84:87], a[36:39], a[8:11], v[84:87]
ds_read_b64_tr_b16 a[60:61], v15 offset:28672
v_mfma_f32_16x16x32_bf16 v[108:111], a[36:39], a[12:15], v[108:111]
ds_read_b64_tr_b16 a[62:63], v15 offset:29184
v_mfma_f32_16x16x32_bf16 v[40:43], a[0:3], a[40:43], v[40:43]
ds_read_b64_tr_b16 a[64:65], v14 offset:30720
v_mfma_f32_16x16x32_bf16 v[64:67], a[4:7], a[40:43], v[64:67]
ds_read_b64_tr_b16 a[66:67], v14 offset:31232
v_mfma_f32_16x16x32_bf16 v[88:91], a[8:11], a[40:43], v[88:91]
ds_read_b64_tr_b16 a[68:69], v15 offset:30720
v_mfma_f32_16x16x32_bf16 v[112:115], a[12:15], a[40:43], v[112:115]
ds_read_b64_tr_b16 a[70:71], v15 offset:31232
v_mfma_f32_16x16x32_bf16 v[44:47], a[0:3], a[44:47], v[44:47]
ds_read_b64_tr_b16 a[72:73], v14 offset:32768
v_mfma_f32_16x16x32_bf16 v[68:71], a[4:7], a[44:47], v[68:71]
ds_read_b64_tr_b16 a[74:75], v14 offset:33280
v_mfma_f32_16x16x32_bf16 v[92:95], a[8:11], a[44:47], v[92:95]
ds_read_b64_tr_b16 a[76:77], v15 offset:32768
v_mfma_f32_16x16x32_bf16 v[116:119], a[12:15], a[44:47], v[116:119]
ds_read_b64_tr_b16 a[78:79], v15 offset:33280
v_mfma_f32_16x16x32_bf16 v[48:51], a[0:3], a[48:51], v[48:51]
v_mfma_f32_16x16x32_bf16 v[72:75], a[4:7], a[48:51], v[72:75]
v_mfma_f32_16x16x32_bf16 v[96:99], a[8:11], a[48:51], v[96:99]
v_mfma_f32_16x16x32_bf16 v[120:123], a[12:15], a[48:51], v[120:123]
v_mfma_f32_16x16x32_bf16 v[52:55], a[0:3], a[52:55], v[52:55]
v_mfma_f32_16x16x32_bf16 v[76:79], a[4:7], a[52:55], v[76:79]
v_mfma_f32_16x16x32_bf16 v[100:103], a[8:11], a[52:55], v[100:103]
v_mfma_f32_16x16x32_bf16 v[124:127], a[12:15], a[52:55], v[124:127]
s_waitcnt lgkmcnt(0)
v_mfma_f32_16x16x32_bf16 v[32:35], a[56:59], a[16:19], v[32:35]
s_barrier
ds_read_b128 a[0:3], v8 offset:24576
v_mfma_f32_16x16x32_bf16 v[56:59], a[56:59], a[20:23], v[56:59]
ds_read_b64_tr_b16 a[32:33], v12 offset:40960
v_mfma_f32_16x16x32_bf16 v[80:83], a[56:59], a[24:27], v[80:83]
ds_read_b64_tr_b16 a[34:35], v12 offset:41472
v_mfma_f32_16x16x32_bf16 v[104:107], a[56:59], a[28:31], v[104:107]
ds_read_b128 a[4:7], v8 offset:26624
v_mfma_f32_16x16x32_bf16 v[36:39], a[60:63], a[16:19], v[36:39]
ds_read_b128 a[8:11], v8 offset:28672
v_mfma_f32_16x16x32_bf16 v[60:63], a[60:63], a[20:23], v[60:63]
ds_read_b128 a[12:15], v8 offset:30720
v_mfma_f32_16x16x32_bf16 v[84:87], a[60:63], a[24:27], v[84:87]
ds_read_b64_tr_b16 a[36:37], v13 offset:40960
v_mfma_f32_16x16x32_bf16 v[108:111], a[60:63], a[28:31], v[108:111]
ds_read_b64_tr_b16 a[38:39], v13 offset:41472
v_mfma_f32_16x16x32_bf16 v[40:43], a[16:19], a[64:67], v[40:43]
ds_read_b64_tr_b16 a[40:41], v12 offset:43008
v_mfma_f32_16x16x32_bf16 v[64:67], a[20:23], a[64:67], v[64:67]
ds_read_b64_tr_b16 a[42:43], v12 offset:43520
v_mfma_f32_16x16x32_bf16 v[88:91], a[24:27], a[64:67], v[88:91]
ds_read_b64_tr_b16 a[44:45], v13 offset:43008
v_mfma_f32_16x16x32_bf16 v[112:115], a[28:31], a[64:67], v[112:115]
ds_read_b64_tr_b16 a[46:47], v13 offset:43520
v_mfma_f32_16x16x32_bf16 v[44:47], a[16:19], a[68:71], v[44:47]
ds_read_b64_tr_b16 a[48:49], v12 offset:45056
v_mfma_f32_16x16x32_bf16 v[68:71], a[20:23], a[68:71], v[68:71]
ds_read_b64_tr_b16 a[50:51], v12 offset:45568
v_mfma_f32_16x16x32_bf16 v[92:95], a[24:27], a[68:71], v[92:95]
ds_read_b64_tr_b16 a[52:53], v13 offset:45056
v_mfma_f32_16x16x32_bf16 v[116:119], a[28:31], a[68:71], v[116:119]
ds_read_b64_tr_b16 a[54:55], v13 offset:45568
v_mfma_f32_16x16x32_bf16 v[48:51], a[16:19], a[72:75], v[48:51]
v_mfma_f32_16x16x32_bf16 v[72:75], a[20:23], a[72:75], v[72:75]
v_mfma_f32_16x16x32_bf16 v[96:99], a[24:27], a[72:75], v[96:99]
v_mfma_f32_16x16x32_bf16 v[120:123], a[28:31], a[72:75], v[120:123]
v_mfma_f32_16x16x32_bf16 v[52:55], a[16:19], a[76:79], v[52:55]
v_mfma_f32_16x16x32_bf16 v[76:79], a[20:23], a[76:79], v[76:79]
v_mfma_f32_16x16x32_bf16 v[100:103], a[24:27], a[76:79], v[100:103]
v_mfma_f32_16x16x32_bf16 v[124:127], a[28:31], a[76:79], v[124:127]
s_waitcnt lgkmcnt(0)
v_mfma_f32_16x16x32_bf16 v[32:35], a[32:35], a[0:3], v[32:35]
ds_read_b128 a[16:19], v9 offset:24576
v_mfma_f32_16x16x32_bf16 v[56:59], a[32:35], a[4:7], v[56:59]
ds_read_b64_tr_b16 a[56:57], v12 offset:53248
v_mfma_f32_16x16x32_bf16 v[80:83], a[32:35], a[8:11], v[80:83]
ds_read_b64_tr_b16 a[58:59], v12 offset:53760
v_mfma_f32_16x16x32_bf16 v[104:107], a[32:35], a[12:15], v[104:107]
ds_read_b128 a[20:23], v9 offset:26624
v_mfma_f32_16x16x32_bf16 v[36:39], a[36:39], a[0:3], v[36:39]
ds_read_b128 a[24:27], v9 offset:28672
v_mfma_f32_16x16x32_bf16 v[60:63], a[36:39], a[4:7], v[60:63]
ds_read_b128 a[28:31], v9 offset:30720
v_mfma_f32_16x16x32_bf16 v[84:87], a[36:39], a[8:11], v[84:87]
ds_read_b64_tr_b16 a[60:61], v13 offset:53248
v_mfma_f32_16x16x32_bf16 v[108:111], a[36:39], a[12:15], v[108:111]
ds_read_b64_tr_b16 a[62:63], v13 offset:53760
v_mfma_f32_16x16x32_bf16 v[40:43], a[0:3], a[40:43], v[40:43]
ds_read_b64_tr_b16 a[64:65], v12 offset:55296
v_mfma_f32_16x16x32_bf16 v[64:67], a[4:7], a[40:43], v[64:67]
ds_read_b64_tr_b16 a[66:67], v12 offset:55808
v_mfma_f32_16x16x32_bf16 v[88:91], a[8:11], a[40:43], v[88:91]
ds_read_b64_tr_b16 a[68:69], v13 offset:55296
v_mfma_f32_16x16x32_bf16 v[112:115], a[12:15], a[40:43], v[112:115]
ds_read_b64_tr_b16 a[70:71], v13 offset:55808
v_mfma_f32_16x16x32_bf16 v[44:47], a[0:3], a[44:47], v[44:47]
ds_read_b64_tr_b16 a[72:73], v12 offset:57344
v_mfma_f32_16x16x32_bf16 v[68:71], a[4:7], a[44:47], v[68:71]
ds_read_b64_tr_b16 a[74:75], v12 offset:57856
v_mfma_f32_16x16x32_bf16 v[92:95], a[8:11], a[44:47], v[92:95]
ds_read_b64_tr_b16 a[76:77], v13 offset:57344
v_mfma_f32_16x16x32_bf16 v[116:119], a[12:15], a[44:47], v[116:119]
ds_read_b64_tr_b16 a[78:79], v13 offset:57856
v_mfma_f32_16x16x32_bf16 v[48:51], a[0:3], a[48:51], v[48:51]
v_mfma_f32_16x16x32_bf16 v[72:75], a[4:7], a[48:51], v[72:75]
v_mfma_f32_16x16x32_bf16 v[96:99], a[8:11], a[48:51], v[96:99]
v_mfma_f32_16x16x32_bf16 v[120:123], a[12:15], a[48:51], v[120:123]
v_mfma_f32_16x16x32_bf16 v[52:55], a[0:3], a[52:55], v[52:55]
v_mfma_f32_16x16x32_bf16 v[76:79], a[4:7], a[52:55], v[76:79]
v_mfma_f32_16x16x32_bf16 v[100:103], a[8:11], a[52:55], v[100:103]
v_mfma_f32_16x16x32_bf16 v[124:127], a[12:15], a[52:55], v[124:127]
s_waitcnt lgkmcnt(0)
v_mfma_f32_16x16x32_bf16 v[32:35], a[56:59], a[16:19], v[32:35]
s_barrier
ds_read_b128 a[0:3], v10 offset:57344
v_mfma_f32_16x16x32_bf16 v[56:59], a[56:59], a[20:23], v[56:59]
ds_read_b64_tr_b16 a[32:33], v12 offset:0
v_mfma_f32_16x16x32_bf16 v[80:83], a[56:59], a[24:27], v[80:83]
ds_read_b64_tr_b16 a[34:35], v12 offset:512
v_mfma_f32_16x16x32_bf16 v[104:107], a[56:59], a[28:31], v[104:107]
ds_read_b128 a[4:7], v10 offset:59392
v_mfma_f32_16x16x32_bf16 v[36:39], a[60:63], a[16:19], v[36:39]
ds_read_b128 a[8:11], v10 offset:61440
v_mfma_f32_16x16x32_bf16 v[60:63], a[60:63], a[20:23], v[60:63]
ds_read_b128 a[12:15], v10 offset:63488
v_mfma_f32_16x16x32_bf16 v[84:87], a[60:63], a[24:27], v[84:87]
ds_read_b64_tr_b16 a[36:37], v13 offset:0
v_mfma_f32_16x16x32_bf16 v[108:111], a[60:63], a[28:31], v[108:111]
ds_read_b64_tr_b16 a[38:39], v13 offset:512
v_mfma_f32_16x16x32_bf16 v[40:43], a[16:19], a[64:67], v[40:43]
ds_read_b64_tr_b16 a[40:41], v12 offset:2048
v_mfma_f32_16x16x32_bf16 v[64:67], a[20:23], a[64:67], v[64:67]
ds_read_b64_tr_b16 a[42:43], v12 offset:2560
v_mfma_f32_16x16x32_bf16 v[88:91], a[24:27], a[64:67], v[88:91]
ds_read_b64_tr_b16 a[44:45], v13 offset:2048
v_mfma_f32_16x16x32_bf16 v[112:115], a[28:31], a[64:67], v[112:115]
ds_read_b64_tr_b16 a[46:47], v13 offset:2560
v_mfma_f32_16x16x32_bf16 v[44:47], a[16:19], a[68:71], v[44:47]
ds_read_b64_tr_b16 a[48:49], v12 offset:4096
v_mfma_f32_16x16x32_bf16 v[68:71], a[20:23], a[68:71], v[68:71]
ds_read_b64_tr_b16 a[50:51], v12 offset:4608
v_mfma_f32_16x16x32_bf16 v[92:95], a[24:27], a[68:71], v[92:95]
ds_read_b64_tr_b16 a[52:53], v13 offset:4096
v_mfma_f32_16x16x32_bf16 v[116:119], a[28:31], a[68:71], v[116:119]
ds_read_b64_tr_b16 a[54:55], v13 offset:4608
v_mfma_f32_16x16x32_bf16 v[48:51], a[16:19], a[72:75], v[48:51]
v_mfma_f32_16x16x32_bf16 v[72:75], a[20:23], a[72:75], v[72:75]
v_mfma_f32_16x16x32_bf16 v[96:99], a[24:27], a[72:75], v[96:99]
v_mfma_f32_16x16x32_bf16 v[120:123], a[28:31], a[72:75], v[120:123]
v_mfma_f32_16x16x32_bf16 v[52:55], a[16:19], a[76:79], v[52:55]
v_mfma_f32_16x16x32_bf16 v[76:79], a[20:23], a[76:79], v[76:79]
v_mfma_f32_16x16x32_bf16 v[100:103], a[24:27], a[76:79], v[100:103]
v_mfma_f32_16x16x32_bf16 v[124:127], a[28:31], a[76:79], v[124:127]
s_waitcnt lgkmcnt(0)
v_mfma_f32_16x16x32_bf16 v[32:35], a[32:35], a[0:3], v[32:35]
ds_read_b128 a[16:19], v11 offset:57344
v_mfma_f32_16x16x32_bf16 v[56:59], a[32:35], a[4:7], v[56:59]
ds_read_b64_tr_b16 a[56:57], v12 offset:12288
v_mfma_f32_16x16x32_bf16 v[80:83], a[32:35], a[8:11], v[80:83]
ds_read_b64_tr_b16 a[58:59], v12 offset:12800
v_mfma_f32_16x16x32_bf16 v[104:107], a[32:35], a[12:15], v[104:107]
ds_read_b128 a[20:23], v11 offset:59392
v_mfma_f32_16x16x32_bf16 v[36:39], a[36:39], a[0:3], v[36:39]
ds_read_b128 a[24:27], v11 offset:61440
v_mfma_f32_16x16x32_bf16 v[60:63], a[36:39], a[4:7], v[60:63]
ds_read_b128 a[28:31], v11 offset:63488
v_mfma_f32_16x16x32_bf16 v[84:87], a[36:39], a[8:11], v[84:87]
ds_read_b64_tr_b16 a[60:61], v13 offset:12288
v_mfma_f32_16x16x32_bf16 v[108:111], a[36:39], a[12:15], v[108:111]
ds_read_b64_tr_b16 a[62:63], v13 offset:12800
v_mfma_f32_16x16x32_bf16 v[40:43], a[0:3], a[40:43], v[40:43]
ds_read_b64_tr_b16 a[64:65], v12 offset:14336
v_mfma_f32_16x16x32_bf16 v[64:67], a[4:7], a[40:43], v[64:67]
ds_read_b64_tr_b16 a[66:67], v12 offset:14848
v_mfma_f32_16x16x32_bf16 v[88:91], a[8:11], a[40:43], v[88:91]
ds_read_b64_tr_b16 a[68:69], v13 offset:14336
v_mfma_f32_16x16x32_bf16 v[112:115], a[12:15], a[40:43], v[112:115]
ds_read_b64_tr_b16 a[70:71], v13 offset:14848
v_mfma_f32_16x16x32_bf16 v[44:47], a[0:3], a[44:47], v[44:47]
ds_read_b64_tr_b16 a[72:73], v12 offset:16384
v_mfma_f32_16x16x32_bf16 v[68:71], a[4:7], a[44:47], v[68:71]
ds_read_b64_tr_b16 a[74:75], v12 offset:16896
v_mfma_f32_16x16x32_bf16 v[92:95], a[8:11], a[44:47], v[92:95]
ds_read_b64_tr_b16 a[76:77], v13 offset:16384
v_mfma_f32_16x16x32_bf16 v[116:119], a[12:15], a[44:47], v[116:119]
ds_read_b64_tr_b16 a[78:79], v13 offset:16896
v_mfma_f32_16x16x32_bf16 v[48:51], a[0:3], a[48:51], v[48:51]
v_mfma_f32_16x16x32_bf16 v[72:75], a[4:7], a[48:51], v[72:75]
v_mfma_f32_16x16x32_bf16 v[96:99], a[8:11], a[48:51], v[96:99]
v_mfma_f32_16x16x32_bf16 v[120:123], a[12:15], a[48:51], v[120:123]
v_mfma_f32_16x16x32_bf16 v[52:55], a[0:3], a[52:55], v[52:55]
v_mfma_f32_16x16x32_bf16 v[76:79], a[4:7], a[52:55], v[76:79]
v_mfma_f32_16x16x32_bf16 v[100:103], a[8:11], a[52:55], v[100:103]
v_mfma_f32_16x16x32_bf16 v[124:127], a[12:15], a[52:55], v[124:127]
s_waitcnt lgkmcnt(0)
v_mfma_f32_16x16x32_bf16 v[32:35], a[56:59], a[16:19], v[32:35]
s_barrier
ds_read_b128 a[0:3], v10 offset:40960
v_mfma_f32_16x16x32_bf16 v[56:59], a[56:59], a[20:23], v[56:59]
ds_read_b64_tr_b16 a[32:33], v14 offset:16384
v_mfma_f32_16x16x32_bf16 v[80:83], a[56:59], a[24:27], v[80:83]
ds_read_b64_tr_b16 a[34:35], v14 offset:16896
v_mfma_f32_16x16x32_bf16 v[104:107], a[56:59], a[28:31], v[104:107]
ds_read_b128 a[4:7], v10 offset:43008
v_mfma_f32_16x16x32_bf16 v[36:39], a[60:63], a[16:19], v[36:39]
ds_read_b128 a[8:11], v10 offset:45056
v_mfma_f32_16x16x32_bf16 v[60:63], a[60:63], a[20:23], v[60:63]
ds_read_b128 a[12:15], v10 offset:47104
v_mfma_f32_16x16x32_bf16 v[84:87], a[60:63], a[24:27], v[84:87]
ds_read_b64_tr_b16 a[36:37], v15 offset:16384
v_mfma_f32_16x16x32_bf16 v[108:111], a[60:63], a[28:31], v[108:111]
ds_read_b64_tr_b16 a[38:39], v15 offset:16896
v_mfma_f32_16x16x32_bf16 v[40:43], a[16:19], a[64:67], v[40:43]
ds_read_b64_tr_b16 a[40:41], v14 offset:18432
v_mfma_f32_16x16x32_bf16 v[64:67], a[20:23], a[64:67], v[64:67]
ds_read_b64_tr_b16 a[42:43], v14 offset:18944
v_mfma_f32_16x16x32_bf16 v[88:91], a[24:27], a[64:67], v[88:91]
ds_read_b64_tr_b16 a[44:45], v15 offset:18432
v_mfma_f32_16x16x32_bf16 v[112:115], a[28:31], a[64:67], v[112:115]
ds_read_b64_tr_b16 a[46:47], v15 offset:18944
v_mfma_f32_16x16x32_bf16 v[44:47], a[16:19], a[68:71], v[44:47]
ds_read_b64_tr_b16 a[48:49], v14 offset:20480
v_mfma_f32_16x16x32_bf16 v[68:71], a[20:23], a[68:71], v[68:71]
ds_read_b64_tr_b16 a[50:51], v14 offset:20992
v_mfma_f32_16x16x32_bf16 v[92:95], a[24:27], a[68:71], v[92:95]
ds_read_b64_tr_b16 a[52:53], v15 offset:20480
v_mfma_f32_16x16x32_bf16 v[116:119], a[28:31], a[68:71], v[116:119]
ds_read_b64_tr_b16 a[54:55], v15 offset:20992
v_mfma_f32_16x16x32_bf16 v[48:51], a[16:19], a[72:75], v[48:51]
v_mfma_f32_16x16x32_bf16 v[72:75], a[20:23], a[72:75], v[72:75]
v_mfma_f32_16x16x32_bf16 v[96:99], a[24:27], a[72:75], v[96:99]
v_mfma_f32_16x16x32_bf16 v[120:123], a[28:31], a[72:75], v[120:123]
v_mfma_f32_16x16x32_bf16 v[52:55], a[16:19], a[76:79], v[52:55]
v_mfma_f32_16x16x32_bf16 v[76:79], a[20:23], a[76:79], v[76:79]
v_mfma_f32_16x16x32_bf16 v[100:103], a[24:27], a[76:79], v[100:103]
v_mfma_f32_16x16x32_bf16 v[124:127], a[28:31], a[76:79], v[124:127]
s_waitcnt lgkmcnt(0)
v_mfma_f32_16x16x32_bf16 v[32:35], a[32:35], a[0:3], v[32:35]
ds_read_b128 a[16:19], v11 offset:40960
v_mfma_f32_16x16x32_bf16 v[56:59], a[32:35], a[4:7], v[56:59]
ds_read_b64_tr_b16 a[56:57], v14 offset:28672
v_mfma_f32_16x16x32_bf16 v[80:83], a[32:35], a[8:11], v[80:83]
ds_read_b64_tr_b16 a[58:59], v14 offset:29184
v_mfma_f32_16x16x32_bf16 v[104:107], a[32:35], a[12:15], v[104:107]
ds_read_b128 a[20:23], v11 offset:43008
v_mfma_f32_16x16x32_bf16 v[36:39], a[36:39], a[0:3], v[36:39]
ds_read_b128 a[24:27], v11 offset:45056
v_mfma_f32_16x16x32_bf16 v[60:63], a[36:39], a[4:7], v[60:63]
ds_read_b128 a[28:31], v11 offset:47104
v_mfma_f32_16x16x32_bf16 v[84:87], a[36:39], a[8:11], v[84:87]
ds_read_b64_tr_b16 a[60:61], v15 offset:28672
v_mfma_f32_16x16x32_bf16 v[108:111], a[36:39], a[12:15], v[108:111]
ds_read_b64_tr_b16 a[62:63], v15 offset:29184
v_mfma_f32_16x16x32_bf16 v[40:43], a[0:3], a[40:43], v[40:43]
ds_read_b64_tr_b16 a[64:65], v14 offset:30720
v_mfma_f32_16x16x32_bf16 v[64:67], a[4:7], a[40:43], v[64:67]
ds_read_b64_tr_b16 a[66:67], v14 offset:31232
v_mfma_f32_16x16x32_bf16 v[88:91], a[8:11], a[40:43], v[88:91]
ds_read_b64_tr_b16 a[68:69], v15 offset:30720
v_mfma_f32_16x16x32_bf16 v[112:115], a[12:15], a[40:43], v[112:115]
ds_read_b64_tr_b16 a[70:71], v15 offset:31232
v_mfma_f32_16x16x32_bf16 v[44:47], a[0:3], a[44:47], v[44:47]
ds_read_b64_tr_b16 a[72:73], v14 offset:32768
v_mfma_f32_16x16x32_bf16 v[68:71], a[4:7], a[44:47], v[68:71]
ds_read_b64_tr_b16 a[74:75], v14 offset:33280
v_mfma_f32_16x16x32_bf16 v[92:95], a[8:11], a[44:47], v[92:95]
ds_read_b64_tr_b16 a[76:77], v15 offset:32768
v_mfma_f32_16x16x32_bf16 v[116:119], a[12:15], a[44:47], v[116:119]
ds_read_b64_tr_b16 a[78:79], v15 offset:33280
v_mfma_f32_16x16x32_bf16 v[48:51], a[0:3], a[48:51], v[48:51]
v_mfma_f32_16x16x32_bf16 v[72:75], a[4:7], a[48:51], v[72:75]
v_mfma_f32_16x16x32_bf16 v[96:99], a[8:11], a[48:51], v[96:99]
v_mfma_f32_16x16x32_bf16 v[120:123], a[12:15], a[48:51], v[120:123]
v_mfma_f32_16x16x32_bf16 v[52:55], a[0:3], a[52:55], v[52:55]
v_mfma_f32_16x16x32_bf16 v[76:79], a[4:7], a[52:55], v[76:79]
v_mfma_f32_16x16x32_bf16 v[100:103], a[8:11], a[52:55], v[100:103]
v_mfma_f32_16x16x32_bf16 v[124:127], a[12:15], a[52:55], v[124:127]
s_waitcnt lgkmcnt(0)
v_mfma_f32_16x16x32_bf16 v[32:35], a[56:59], a[16:19], v[32:35]
s_barrier
ds_read_b128 a[0:3], v10 offset:0
v_mfma_f32_16x16x32_bf16 v[56:59], a[56:59], a[20:23], v[56:59]
ds_read_b64_tr_b16 a[32:33], v12 offset:40960
v_mfma_f32_16x16x32_bf16 v[80:83], a[56:59], a[24:27], v[80:83]
ds_read_b64_tr_b16 a[34:35], v12 offset:41472
v_mfma_f32_16x16x32_bf16 v[104:107], a[56:59], a[28:31], v[104:107]
ds_read_b128 a[4:7], v10 offset:2048
v_mfma_f32_16x16x32_bf16 v[36:39], a[60:63], a[16:19], v[36:39]
ds_read_b128 a[8:11], v10 offset:4096
v_mfma_f32_16x16x32_bf16 v[60:63], a[60:63], a[20:23], v[60:63]
ds_read_b128 a[12:15], v10 offset:6144
v_mfma_f32_16x16x32_bf16 v[84:87], a[60:63], a[24:27], v[84:87]
ds_read_b64_tr_b16 a[36:37], v13 offset:40960
v_mfma_f32_16x16x32_bf16 v[108:111], a[60:63], a[28:31], v[108:111]
ds_read_b64_tr_b16 a[38:39], v13 offset:41472
v_mfma_f32_16x16x32_bf16 v[40:43], a[16:19], a[64:67], v[40:43]
ds_read_b64_tr_b16 a[40:41], v12 offset:43008
v_mfma_f32_16x16x32_bf16 v[64:67], a[20:23], a[64:67], v[64:67]
ds_read_b64_tr_b16 a[42:43], v12 offset:43520
v_mfma_f32_16x16x32_bf16 v[88:91], a[24:27], a[64:67], v[88:91]
ds_read_b64_tr_b16 a[44:45], v13 offset:43008
v_mfma_f32_16x16x32_bf16 v[112:115], a[28:31], a[64:67], v[112:115]
ds_read_b64_tr_b16 a[46:47], v13 offset:43520
v_mfma_f32_16x16x32_bf16 v[44:47], a[16:19], a[68:71], v[44:47]
ds_read_b64_tr_b16 a[48:49], v12 offset:45056
v_mfma_f32_16x16x32_bf16 v[68:71], a[20:23], a[68:71], v[68:71]
ds_read_b64_tr_b16 a[50:51], v12 offset:45568
v_mfma_f32_16x16x32_bf16 v[92:95], a[24:27], a[68:71], v[92:95]
ds_read_b64_tr_b16 a[52:53], v13 offset:45056
v_mfma_f32_16x16x32_bf16 v[116:119], a[28:31], a[68:71], v[116:119]
ds_read_b64_tr_b16 a[54:55], v13 offset:45568
v_mfma_f32_16x16x32_bf16 v[48:51], a[16:19], a[72:75], v[48:51]
v_mfma_f32_16x16x32_bf16 v[72:75], a[20:23], a[72:75], v[72:75]
v_mfma_f32_16x16x32_bf16 v[96:99], a[24:27], a[72:75], v[96:99]
v_mfma_f32_16x16x32_bf16 v[120:123], a[28:31], a[72:75], v[120:123]
v_mfma_f32_16x16x32_bf16 v[52:55], a[16:19], a[76:79], v[52:55]
v_mfma_f32_16x16x32_bf16 v[76:79], a[20:23], a[76:79], v[76:79]
v_mfma_f32_16x16x32_bf16 v[100:103], a[24:27], a[76:79], v[100:103]
v_mfma_f32_16x16x32_bf16 v[124:127], a[28:31], a[76:79], v[124:127]
s_waitcnt lgkmcnt(0)
v_mfma_f32_16x16x32_bf16 v[32:35], a[32:35], a[0:3], v[32:35]
ds_read_b128 a[16:19], v11 offset:0
v_mfma_f32_16x16x32_bf16 v[56:59], a[32:35], a[4:7], v[56:59]
ds_read_b64_tr_b16 a[56:57], v12 offset:53248
v_mfma_f32_16x16x32_bf16 v[80:83], a[32:35], a[8:11], v[80:83]
ds_read_b64_tr_b16 a[58:59], v12 offset:53760
v_mfma_f32_16x16x32_bf16 v[104:107], a[32:35], a[12:15], v[104:107]
ds_read_b128 a[20:23], v11 offset:2048
v_mfma_f32_16x16x32_bf16 v[36:39], a[36:39], a[0:3], v[36:39]
ds_read_b128 a[24:27], v11 offset:4096
v_mfma_f32_16x16x32_bf16 v[60:63], a[36:39], a[4:7], v[60:63]
ds_read_b128 a[28:31], v11 offset:6144
v_mfma_f32_16x16x32_bf16 v[84:87], a[36:39], a[8:11], v[84:87]
ds_read_b64_tr_b16 a[60:61], v13 offset:53248
v_mfma_f32_16x16x32_bf16 v[108:111], a[36:39], a[12:15], v[108:111]
ds_read_b64_tr_b16 a[62:63], v13 offset:53760
v_mfma_f32_16x16x32_bf16 v[40:43], a[0:3], a[40:43], v[40:43]
ds_read_b64_tr_b16 a[64:65], v12 offset:55296
v_mfma_f32_16x16x32_bf16 v[64:67], a[4:7], a[40:43], v[64:67]
ds_read_b64_tr_b16 a[66:67], v12 offset:55808
v_mfma_f32_16x16x32_bf16 v[88:91], a[8:11], a[40:43], v[88:91]
ds_read_b64_tr_b16 a[68:69], v13 offset:55296
v_mfma_f32_16x16x32_bf16 v[112:115], a[12:15], a[40:43], v[112:115]
ds_read_b64_tr_b16 a[70:71], v13 offset:55808
v_mfma_f32_16x16x32_bf16 v[44:47], a[0:3], a[44:47], v[44:47]
ds_read_b64_tr_b16 a[72:73], v12 offset:57344
v_mfma_f32_16x16x32_bf16 v[68:71], a[4:7], a[44:47], v[68:71]
ds_read_b64_tr_b16 a[74:75], v12 offset:57856
v_mfma_f32_16x16x32_bf16 v[92:95], a[8:11], a[44:47], v[92:95]
ds_read_b64_tr_b16 a[76:77], v13 offset:57344
v_mfma_f32_16x16x32_bf16 v[116:119], a[12:15], a[44:47], v[116:119]
ds_read_b64_tr_b16 a[78:79], v13 offset:57856
v_mfma_f32_16x16x32_bf16 v[48:51], a[0:3], a[48:51], v[48:51]
v_lshrrev_b32 v2, 4, v1
v_lshlrev_b32 v2, 4, v2
s_lshl_b32 s70, s66, 8
s_add_u32 s70, s70, 159744
v_add_u32 v17, s70, v2
v_mfma_f32_16x16x32_bf16 v[72:75], a[4:7], a[48:51], v[72:75]
v_mfma_f32_16x16x32_bf16 v[96:99], a[8:11], a[48:51], v[96:99]
v_and_b32 v2, 15, v1
v_lshlrev_b32 v2, 2, v2
s_lshl_b32 s70, s67, 7
s_add_u32 s70, s70, 160768
v_add_u32 v18, s70, v2
v_mfma_f32_16x16x32_bf16 v[120:123], a[12:15], a[48:51], v[120:123]
v_mfma_f32_16x16x32_bf16 v[52:55], a[0:3], a[52:55], v[52:55]
v_mfma_f32_16x16x32_bf16 v[76:79], a[4:7], a[52:55], v[76:79]
v_mfma_f32_16x16x32_bf16 v[100:103], a[8:11], a[52:55], v[100:103]
v_mfma_f32_16x16x32_bf16 v[124:127], a[12:15], a[52:55], v[124:127]
s_waitcnt lgkmcnt(0)
v_mfma_f32_16x16x32_bf16 v[32:35], a[56:59], a[16:19], v[32:35]
s_barrier
ds_read_b128 a[0:3], v8 offset:24576
v_mfma_f32_16x16x32_bf16 v[56:59], a[56:59], a[20:23], v[56:59]
ds_read_b64_tr_b16 a[32:33], v12 offset:0
v_mfma_f32_16x16x32_bf16 v[80:83], a[56:59], a[24:27], v[80:83]
ds_read_b64_tr_b16 a[34:35], v12 offset:512
v_mfma_f32_16x16x32_bf16 v[104:107], a[56:59], a[28:31], v[104:107]
ds_read_b128 a[4:7], v8 offset:26624
v_mfma_f32_16x16x32_bf16 v[36:39], a[60:63], a[16:19], v[36:39]
ds_read_b128 a[8:11], v8 offset:28672
v_mfma_f32_16x16x32_bf16 v[60:63], a[60:63], a[20:23], v[60:63]
ds_read_b128 a[12:15], v8 offset:30720
v_mfma_f32_16x16x32_bf16 v[84:87], a[60:63], a[24:27], v[84:87]
ds_read_b64_tr_b16 a[36:37], v13 offset:0
v_mfma_f32_16x16x32_bf16 v[108:111], a[60:63], a[28:31], v[108:111]
ds_read_b64_tr_b16 a[38:39], v13 offset:512
v_mfma_f32_16x16x32_bf16 v[40:43], a[16:19], a[64:67], v[40:43]
ds_read_b64_tr_b16 a[40:41], v12 offset:2048
v_mfma_f32_16x16x32_bf16 v[64:67], a[20:23], a[64:67], v[64:67]
ds_read_b64_tr_b16 a[42:43], v12 offset:2560
v_mfma_f32_16x16x32_bf16 v[88:91], a[24:27], a[64:67], v[88:91]
ds_read_b64_tr_b16 a[44:45], v13 offset:2048
v_mfma_f32_16x16x32_bf16 v[112:115], a[28:31], a[64:67], v[112:115]
ds_read_b64_tr_b16 a[46:47], v13 offset:2560
v_mfma_f32_16x16x32_bf16 v[44:47], a[16:19], a[68:71], v[44:47]
ds_read_b64_tr_b16 a[48:49], v12 offset:4096
v_mfma_f32_16x16x32_bf16 v[68:71], a[20:23], a[68:71], v[68:71]
ds_read_b64_tr_b16 a[50:51], v12 offset:4608
v_mfma_f32_16x16x32_bf16 v[92:95], a[24:27], a[68:71], v[92:95]
ds_read_b64_tr_b16 a[52:53], v13 offset:4096
v_mfma_f32_16x16x32_bf16 v[116:119], a[28:31], a[68:71], v[116:119]
ds_read_b64_tr_b16 a[54:55], v13 offset:4608
v_mfma_f32_16x16x32_bf16 v[48:51], a[16:19], a[72:75], v[48:51]
v_mfma_f32_16x16x32_bf16 v[72:75], a[20:23], a[72:75], v[72:75]
v_mfma_f32_16x16x32_bf16 v[96:99], a[24:27], a[72:75], v[96:99]
v_mfma_f32_16x16x32_bf16 v[120:123], a[28:31], a[72:75], v[120:123]
v_mfma_f32_16x16x32_bf16 v[52:55], a[16:19], a[76:79], v[52:55]
v_mfma_f32_16x16x32_bf16 v[76:79], a[20:23], a[76:79], v[76:79]
v_mfma_f32_16x16x32_bf16 v[100:103], a[24:27], a[76:79], v[100:103]
v_mfma_f32_16x16x32_bf16 v[124:127], a[28:31], a[76:79], v[124:127]
s_waitcnt lgkmcnt(0)
v_mfma_f32_16x16x32_bf16 v[32:35], a[32:35], a[0:3], v[32:35]
ds_read_b128 a[16:19], v9 offset:24576
v_mfma_f32_16x16x32_bf16 v[56:59], a[32:35], a[4:7], v[56:59]
ds_read_b64_tr_b16 a[56:57], v12 offset:12288
v_mfma_f32_16x16x32_bf16 v[80:83], a[32:35], a[8:11], v[80:83]
ds_read_b64_tr_b16 a[58:59], v12 offset:12800
v_mfma_f32_16x16x32_bf16 v[104:107], a[32:35], a[12:15], v[104:107]
ds_read_b128 a[20:23], v9 offset:26624
v_mfma_f32_16x16x32_bf16 v[36:39], a[36:39], a[0:3], v[36:39]
ds_read_b128 a[24:27], v9 offset:28672
v_mfma_f32_16x16x32_bf16 v[60:63], a[36:39], a[4:7], v[60:63]
ds_read_b128 a[28:31], v9 offset:30720
v_mfma_f32_16x16x32_bf16 v[84:87], a[36:39], a[8:11], v[84:87]
ds_read_b64_tr_b16 a[60:61], v13 offset:12288
v_mfma_f32_16x16x32_bf16 v[108:111], a[36:39], a[12:15], v[108:111]
ds_read_b64_tr_b16 a[62:63], v13 offset:12800
v_mfma_f32_16x16x32_bf16 v[40:43], a[0:3], a[40:43], v[40:43]
ds_read_b64_tr_b16 a[64:65], v12 offset:14336
v_mfma_f32_16x16x32_bf16 v[64:67], a[4:7], a[40:43], v[64:67]
ds_read_b64_tr_b16 a[66:67], v12 offset:14848
v_mfma_f32_16x16x32_bf16 v[88:91], a[8:11], a[40:43], v[88:91]
ds_read_b64_tr_b16 a[68:69], v13 offset:14336
v_mfma_f32_16x16x32_bf16 v[112:115], a[12:15], a[40:43], v[112:115]
ds_read_b64_tr_b16 a[70:71], v13 offset:14848
v_mfma_f32_16x16x32_bf16 v[44:47], a[0:3], a[44:47], v[44:47]
ds_read_b64_tr_b16 a[72:73], v12 offset:16384
v_mfma_f32_16x16x32_bf16 v[68:71], a[4:7], a[44:47], v[68:71]
ds_read_b64_tr_b16 a[74:75], v12 offset:16896
v_mfma_f32_16x16x32_bf16 v[92:95], a[8:11], a[44:47], v[92:95]
ds_read_b64_tr_b16 a[76:77], v13 offset:16384
v_mfma_f32_16x16x32_bf16 v[116:119], a[12:15], a[44:47], v[116:119]
ds_read_b64_tr_b16 a[78:79], v13 offset:16896
v_mfma_f32_16x16x32_bf16 v[48:51], a[0:3], a[48:51], v[48:51]
v_mfma_f32_16x16x32_bf16 v[72:75], a[4:7], a[48:51], v[72:75]
v_mfma_f32_16x16x32_bf16 v[96:99], a[8:11], a[48:51], v[96:99]
v_mfma_f32_16x16x32_bf16 v[120:123], a[12:15], a[48:51], v[120:123]
v_mfma_f32_16x16x32_bf16 v[52:55], a[0:3], a[52:55], v[52:55]
v_mfma_f32_16x16x32_bf16 v[76:79], a[4:7], a[52:55], v[76:79]
v_mfma_f32_16x16x32_bf16 v[100:103], a[8:11], a[52:55], v[100:103]
v_mfma_f32_16x16x32_bf16 v[124:127], a[12:15], a[52:55], v[124:127]
s_waitcnt lgkmcnt(0)
v_mfma_f32_16x16x32_bf16 v[40:43], a[16:19], a[64:67], v[40:43]
s_barrier
ds_read_b128 v[20:23], v17 offset:0
v_mfma_f32_16x16x32_bf16 v[64:67], a[20:23], a[64:67], v[64:67]
ds_read_b128 v[24:27], v17 offset:512
v_mfma_f32_16x16x32_bf16 v[88:91], a[24:27], a[64:67], v[88:91]
ds_read_b32 v6, v18 offset:256
v_mfma_f32_16x16x32_bf16 v[112:115], a[28:31], a[64:67], v[112:115]
ds_read_b32 v8, v18 offset:320
v_mfma_f32_16x16x32_bf16 v[44:47], a[16:19], a[68:71], v[44:47]
ds_read_b32 v10, v18 offset:512
v_mfma_f32_16x16x32_bf16 v[68:71], a[20:23], a[68:71], v[68:71]
ds_read_b32 v18, v18 offset:576
v_mfma_f32_16x16x32_bf16 v[92:95], a[24:27], a[68:71], v[92:95]
v_mov_b32 v19, 161536
ds_read_b32 v19, v19
v_mfma_f32_16x16x32_bf16 v[116:119], a[28:31], a[68:71], v[116:119]
ds_read_b128 v[128:131], v17 offset:64
v_mfma_f32_16x16x32_bf16 v[48:51], a[16:19], a[72:75], v[48:51]
ds_read_b128 v[132:135], v17 offset:576
v_mfma_f32_16x16x32_bf16 v[72:75], a[20:23], a[72:75], v[72:75]
ds_read_b128 v[136:139], v17 offset:128
v_mfma_f32_16x16x32_bf16 v[96:99], a[24:27], a[72:75], v[96:99]
ds_read_b128 v[140:143], v17 offset:640
v_mfma_f32_16x16x32_bf16 v[120:123], a[28:31], a[72:75], v[120:123]
ds_read_b128 v[144:147], v17 offset:192
v_mfma_f32_16x16x32_bf16 v[52:55], a[16:19], a[76:79], v[52:55]
ds_read_b128 v[148:151], v17 offset:704
v_mfma_f32_16x16x32_bf16 v[76:79], a[20:23], a[76:79], v[76:79]
v_mfma_f32_16x16x32_bf16 v[100:103], a[24:27], a[76:79], v[100:103]
v_mfma_f32_16x16x32_bf16 v[124:127], a[28:31], a[76:79], v[124:127]
v_mfma_f32_16x16x32_bf16 v[32:35], a[56:59], a[16:19], v[32:35]
v_mfma_f32_16x16x32_bf16 v[56:59], a[56:59], a[20:23], v[56:59]
v_mfma_f32_16x16x32_bf16 v[80:83], a[56:59], a[24:27], v[80:83]
v_mfma_f32_16x16x32_bf16 v[104:107], a[56:59], a[28:31], v[104:107]
v_mfma_f32_16x16x32_bf16 v[36:39], a[60:63], a[16:19], v[36:39]
v_mfma_f32_16x16x32_bf16 v[60:63], a[60:63], a[20:23], v[60:63]
v_mfma_f32_16x16x32_bf16 v[84:87], a[60:63], a[24:27], v[84:87]
v_mfma_f32_16x16x32_bf16 v[108:111], a[60:63], a[28:31], v[108:111]
s_waitcnt lgkmcnt(0)
v_readfirstlane_b32 s69, v19
v_pk_mul_f32 v[28:29], v[24:25], s[90:91]
v_pk_mul_f32 v[30:31], v[26:27], s[90:91]
v_pk_fma_f32 v[40:41], v[20:21], v[6:7], v[40:41] op_sel:[0,0,0] op_sel_hi:[1,0,1]
v_pk_fma_f32 v[44:45], v[20:21], v[8:9], v[44:45] op_sel:[0,0,0] op_sel_hi:[1,0,1]
v_pk_fma_f32 v[42:43], v[22:23], v[6:7], v[42:43] op_sel:[0,0,0] op_sel_hi:[1,0,1]
v_pk_fma_f32 v[46:47], v[22:23], v[8:9], v[46:47] op_sel:[0,0,0] op_sel_hi:[1,0,1]
v_pk_mul_f32 v[2:3], v[40:41], v[28:29]
v_pk_mul_f32 v[12:13], v[44:45], v[28:29]
v_pk_mul_f32 v[4:5], v[42:43], v[30:31]
v_pk_mul_f32 v[14:15], v[46:47], v[30:31]
v_pk_fma_f32 v[40:41], v[40:41], v[24:25], s[82:83]
v_pk_fma_f32 v[44:45], v[44:45], v[24:25], s[82:83]
v_pk_fma_f32 v[42:43], v[42:43], v[26:27], s[82:83]
v_pk_fma_f32 v[46:47], v[46:47], v[26:27], s[82:83]
v_exp_f32_e64 v2, v2 clamp
v_exp_f32_e64 v12, v12 clamp
v_exp_f32_e64 v3, v3 clamp
v_exp_f32_e64 v13, v13 clamp
v_exp_f32_e64 v4, v4 clamp
v_exp_f32_e64 v14, v14 clamp
v_exp_f32_e64 v5, v5 clamp
v_exp_f32_e64 v15, v15 clamp
v_pk_add_f32 v[2:3], v[2:3], s[80:81]
v_pk_add_f32 v[12:13], v[12:13], s[80:81]
v_pk_add_f32 v[4:5], v[4:5], s[80:81]
v_pk_add_f32 v[14:15], v[14:15], s[80:81]
v_max_f32 v40, v40, v2
v_max_f32 v44, v44, v12
v_max_f32 v41, v41, v3
v_max_f32 v45, v45, v13
v_max_f32 v42, v42, v4
v_max_f32 v46, v46, v14
v_max_f32 v43, v43, v5
v_max_f32 v47, v47, v15
v_cvt_pk_bf16_f32 v40, v40, v41
v_cvt_pk_bf16_f32 v44, v44, v45
v_cvt_pk_bf16_f32 v41, v42, v43
v_cvt_pk_bf16_f32 v45, v46, v47
v_pk_fma_f32 v[48:49], v[20:21], v[10:11], v[48:49] op_sel:[0,0,0] op_sel_hi:[1,0,1]
v_pk_fma_f32 v[52:53], v[20:21], v[18:19], v[52:53] op_sel:[0,0,0] op_sel_hi:[1,0,1]
v_pk_fma_f32 v[50:51], v[22:23], v[10:11], v[50:51] op_sel:[0,0,0] op_sel_hi:[1,0,1]
v_pk_fma_f32 v[54:55], v[22:23], v[18:19], v[54:55] op_sel:[0,0,0] op_sel_hi:[1,0,1]
v_pk_mul_f32 v[48:49], v[48:49], v[24:25]
v_pk_mul_f32 v[52:53], v[52:53], v[24:25]
v_pk_mul_f32 v[50:51], v[50:51], v[26:27]
v_pk_mul_f32 v[54:55], v[54:55], v[26:27]
v_cvt_pk_bf16_f32 v48, v48, v49
v_cvt_pk_bf16_f32 v52, v52, v53
v_cvt_pk_bf16_f32 v49, v50, v51
v_cvt_pk_bf16_f32 v53, v54, v55
v_pk_mul_f32 v[28:29], v[132:133], s[90:91]
v_pk_mul_f32 v[30:31], v[134:135], s[90:91]
v_pk_fma_f32 v[64:65], v[128:129], v[6:7], v[64:65] op_sel:[0,0,0] op_sel_hi:[1,0,1]
v_pk_fma_f32 v[68:69], v[128:129], v[8:9], v[68:69] op_sel:[0,0,0] op_sel_hi:[1,0,1]
v_pk_fma_f32 v[66:67], v[130:131], v[6:7], v[66:67] op_sel:[0,0,0] op_sel_hi:[1,0,1]
v_pk_fma_f32 v[70:71], v[130:131], v[8:9], v[70:71] op_sel:[0,0,0] op_sel_hi:[1,0,1]
v_pk_mul_f32 v[2:3], v[64:65], v[28:29]
v_pk_mul_f32 v[12:13], v[68:69], v[28:29]
v_pk_mul_f32 v[4:5], v[66:67], v[30:31]
v_pk_mul_f32 v[14:15], v[70:71], v[30:31]
v_pk_fma_f32 v[64:65], v[64:65], v[132:133], s[82:83]
v_pk_fma_f32 v[68:69], v[68:69], v[132:133], s[82:83]
v_pk_fma_f32 v[66:67], v[66:67], v[134:135], s[82:83]
v_pk_fma_f32 v[70:71], v[70:71], v[134:135], s[82:83]
v_exp_f32_e64 v2, v2 clamp
v_exp_f32_e64 v12, v12 clamp
v_exp_f32_e64 v3, v3 clamp
v_exp_f32_e64 v13, v13 clamp
v_exp_f32_e64 v4, v4 clamp
v_exp_f32_e64 v14, v14 clamp
v_exp_f32_e64 v5, v5 clamp
v_exp_f32_e64 v15, v15 clamp
v_pk_add_f32 v[2:3], v[2:3], s[80:81]
v_pk_add_f32 v[12:13], v[12:13], s[80:81]
v_pk_add_f32 v[4:5], v[4:5], s[80:81]
v_pk_add_f32 v[14:15], v[14:15], s[80:81]
v_max_f32 v64, v64, v2
v_max_f32 v68, v68, v12
v_max_f32 v65, v65, v3
v_max_f32 v69, v69, v13
v_max_f32 v66, v66, v4
v_max_f32 v70, v70, v14
v_max_f32 v67, v67, v5
v_max_f32 v71, v71, v15
v_cvt_pk_bf16_f32 v42, v64, v65
v_cvt_pk_bf16_f32 v46, v68, v69
v_cvt_pk_bf16_f32 v43, v66, v67
v_cvt_pk_bf16_f32 v47, v70, v71
v_pk_fma_f32 v[72:73], v[128:129], v[10:11], v[72:73] op_sel:[0,0,0] op_sel_hi:[1,0,1]
v_pk_fma_f32 v[76:77], v[128:129], v[18:19], v[76:77] op_sel:[0,0,0] op_sel_hi:[1,0,1]
v_pk_fma_f32 v[74:75], v[130:131], v[10:11], v[74:75] op_sel:[0,0,0] op_sel_hi:[1,0,1]
v_pk_fma_f32 v[78:79], v[130:131], v[18:19], v[78:79] op_sel:[0,0,0] op_sel_hi:[1,0,1]
v_pk_mul_f32 v[72:73], v[72:73], v[132:133]
v_pk_mul_f32 v[76:77], v[76:77], v[132:133]
v_pk_mul_f32 v[74:75], v[74:75], v[134:135]
v_pk_mul_f32 v[78:79], v[78:79], v[134:135]
v_cvt_pk_bf16_f32 v50, v72, v73
v_cvt_pk_bf16_f32 v54, v76, v77
v_cvt_pk_bf16_f32 v51, v74, v75
v_cvt_pk_bf16_f32 v55, v78, v79
s_nop 0
v_mfma_f32_16x16x32_bf16 v[64:67], v[40:43], v[48:51], 0
v_mfma_f32_16x16x32_bf16 v[68:71], v[40:43], v[52:55], 0
v_mfma_f32_16x16x32_bf16 v[20:23], v[40:43], a[80:83], 0
v_mfma_f32_16x16x32_bf16 v[72:75], v[44:47], v[48:51], 0
v_mfma_f32_16x16x32_bf16 v[76:79], v[44:47], v[52:55], 0
v_mfma_f32_16x16x32_bf16 v[24:27], v[44:47], a[80:83], 0
v_pk_mul_f32 v[28:29], v[140:141], s[90:91]
v_pk_mul_f32 v[30:31], v[142:143], s[90:91]
v_pk_fma_f32 v[88:89], v[136:137], v[6:7], v[88:89] op_sel:[0,0,0] op_sel_hi:[1,0,1]
v_pk_fma_f32 v[92:93], v[136:137], v[8:9], v[92:93] op_sel:[0,0,0] op_sel_hi:[1,0,1]
v_pk_fma_f32 v[90:91], v[138:139], v[6:7], v[90:91] op_sel:[0,0,0] op_sel_hi:[1,0,1]
v_pk_fma_f32 v[94:95], v[138:139], v[8:9], v[94:95] op_sel:[0,0,0] op_sel_hi:[1,0,1]
v_pk_mul_f32 v[2:3], v[88:89], v[28:29]
v_pk_mul_f32 v[12:13], v[92:93], v[28:29]
v_pk_mul_f32 v[4:5], v[90:91], v[30:31]
v_pk_mul_f32 v[14:15], v[94:95], v[30:31]
v_pk_fma_f32 v[88:89], v[88:89], v[140:141], s[82:83]
v_pk_fma_f32 v[92:93], v[92:93], v[140:141], s[82:83]
v_pk_fma_f32 v[90:91], v[90:91], v[142:143], s[82:83]
v_pk_fma_f32 v[94:95], v[94:95], v[142:143], s[82:83]
v_exp_f32_e64 v2, v2 clamp
v_exp_f32_e64 v12, v12 clamp
v_exp_f32_e64 v3, v3 clamp
v_exp_f32_e64 v13, v13 clamp
v_exp_f32_e64 v4, v4 clamp
v_exp_f32_e64 v14, v14 clamp
v_exp_f32_e64 v5, v5 clamp
v_exp_f32_e64 v15, v15 clamp
v_pk_add_f32 v[2:3], v[2:3], s[80:81]
v_pk_add_f32 v[12:13], v[12:13], s[80:81]
v_pk_add_f32 v[4:5], v[4:5], s[80:81]
v_pk_add_f32 v[14:15], v[14:15], s[80:81]
v_max_f32 v88, v88, v2
v_max_f32 v92, v92, v12
v_max_f32 v89, v89, v3
v_max_f32 v93, v93, v13
v_max_f32 v90, v90, v4
v_max_f32 v94, v94, v14
v_max_f32 v91, v91, v5
v_max_f32 v95, v95, v15
v_cvt_pk_bf16_f32 v88, v88, v89
v_cvt_pk_bf16_f32 v92, v92, v93
v_cvt_pk_bf16_f32 v89, v90, v91
v_cvt_pk_bf16_f32 v93, v94, v95
v_pk_fma_f32 v[96:97], v[136:137], v[10:11], v[96:97] op_sel:[0,0,0] op_sel_hi:[1,0,1]
v_pk_fma_f32 v[100:101], v[136:137], v[18:19], v[100:101] op_sel:[0,0,0] op_sel_hi:[1,0,1]
v_pk_fma_f32 v[98:99], v[138:139], v[10:11], v[98:99] op_sel:[0,0,0] op_sel_hi:[1,0,1]
v_pk_fma_f32 v[102:103], v[138:139], v[18:19], v[102:103] op_sel:[0,0,0] op_sel_hi:[1,0,1]
v_pk_mul_f32 v[96:97], v[96:97], v[140:141]
v_pk_mul_f32 v[100:101], v[100:101], v[140:141]
v_pk_mul_f32 v[98:99], v[98:99], v[142:143]
v_pk_mul_f32 v[102:103], v[102:103], v[142:143]
v_cvt_pk_bf16_f32 v96, v96, v97
v_cvt_pk_bf16_f32 v100, v100, v101
v_cvt_pk_bf16_f32 v97, v98, v99
v_cvt_pk_bf16_f32 v101, v102, v103
v_pk_mul_f32 v[28:29], v[148:149], s[90:91]
v_pk_mul_f32 v[30:31], v[150:151], s[90:91]
v_pk_fma_f32 v[112:113], v[144:145], v[6:7], v[112:113] op_sel:[0,0,0] op_sel_hi:[1,0,1]
v_pk_fma_f32 v[116:117], v[144:145], v[8:9], v[116:117] op_sel:[0,0,0] op_sel_hi:[1,0,1]
v_pk_fma_f32 v[114:115], v[146:147], v[6:7], v[114:115] op_sel:[0,0,0] op_sel_hi:[1,0,1]
v_pk_fma_f32 v[118:119], v[146:147], v[8:9], v[118:119] op_sel:[0,0,0] op_sel_hi:[1,0,1]
v_pk_mul_f32 v[2:3], v[112:113], v[28:29]
v_pk_mul_f32 v[12:13], v[116:117], v[28:29]
v_pk_mul_f32 v[4:5], v[114:115], v[30:31]
v_pk_mul_f32 v[14:15], v[118:119], v[30:31]
v_pk_fma_f32 v[112:113], v[112:113], v[148:149], s[82:83]
v_pk_fma_f32 v[116:117], v[116:117], v[148:149], s[82:83]
v_pk_fma_f32 v[114:115], v[114:115], v[150:151], s[82:83]
v_pk_fma_f32 v[118:119], v[118:119], v[150:151], s[82:83]
v_exp_f32_e64 v2, v2 clamp
v_exp_f32_e64 v12, v12 clamp
v_exp_f32_e64 v3, v3 clamp
v_exp_f32_e64 v13, v13 clamp
v_exp_f32_e64 v4, v4 clamp
v_exp_f32_e64 v14, v14 clamp
v_exp_f32_e64 v5, v5 clamp
v_exp_f32_e64 v15, v15 clamp
v_pk_add_f32 v[2:3], v[2:3], s[80:81]
v_pk_add_f32 v[12:13], v[12:13], s[80:81]
v_pk_add_f32 v[4:5], v[4:5], s[80:81]
v_pk_add_f32 v[14:15], v[14:15], s[80:81]
v_max_f32 v112, v112, v2
v_max_f32 v116, v116, v12
v_max_f32 v113, v113, v3
v_max_f32 v117, v117, v13
v_max_f32 v114, v114, v4
v_max_f32 v118, v118, v14
v_max_f32 v115, v115, v5
v_max_f32 v119, v119, v15
v_cvt_pk_bf16_f32 v90, v112, v113
v_cvt_pk_bf16_f32 v94, v116, v117
v_cvt_pk_bf16_f32 v91, v114, v115
v_cvt_pk_bf16_f32 v95, v118, v119
v_pk_fma_f32 v[120:121], v[144:145], v[10:11], v[120:121] op_sel:[0,0,0] op_sel_hi:[1,0,1]
v_pk_fma_f32 v[124:125], v[144:145], v[18:19], v[124:125] op_sel:[0,0,0] op_sel_hi:[1,0,1]
v_pk_fma_f32 v[122:123], v[146:147], v[10:11], v[122:123] op_sel:[0,0,0] op_sel_hi:[1,0,1]
v_pk_fma_f32 v[126:127], v[146:147], v[18:19], v[126:127] op_sel:[0,0,0] op_sel_hi:[1,0,1]
v_pk_mul_f32 v[120:121], v[120:121], v[148:149]
v_pk_mul_f32 v[124:125], v[124:125], v[148:149]
v_pk_mul_f32 v[122:123], v[122:123], v[150:151]
v_pk_mul_f32 v[126:127], v[126:127], v[150:151]
v_cvt_pk_bf16_f32 v98, v120, v121
v_cvt_pk_bf16_f32 v102, v124, v125
v_cvt_pk_bf16_f32 v99, v122, v123
v_cvt_pk_bf16_f32 v103, v126, v127
s_nop 0
v_mfma_f32_16x16x32_bf16 v[64:67], v[88:91], v[96:99], v[64:67]
v_mfma_f32_16x16x32_bf16 v[68:71], v[88:91], v[100:103], v[68:71]
v_mfma_f32_16x16x32_bf16 v[20:23], v[88:91], a[80:83], v[20:23]
v_mfma_f32_16x16x32_bf16 v[72:75], v[92:95], v[96:99], v[72:75]
v_mfma_f32_16x16x32_bf16 v[76:79], v[92:95], v[100:103], v[76:79]
v_mfma_f32_16x16x32_bf16 v[24:27], v[92:95], a[80:83], v[24:27]
s_lshl_b32 s70, s60, 11
s_add_u32 s70, s70, 16384
v_add_u32 v2, s70, v16
v_xor_b32 v3, 4096, v2
v_lshrrev_b32 v4, 4, v1
v_lshlrev_b32 v5, 4, v4
v_lshlrev_b32 v4, 5, v4
s_lshl_b32 s70, s60, 6
s_add_u32 s70, s70, 163584
v_add_u32 v5, s70, v5
v_xor_b32 v6, 128, v5
s_lshl_b32 s72, s67, 1
s_add_u32 s72, s72, s66
s_lshl_b32 s72, s72, 10
s_add_u32 s72, s72, s87
s_lshl_b32 s73, s67, 7
s_lshl_b32 s70, s66, 4
s_add_u32 s73, s73, s70
s_add_u32 s73, s73, s87
s_add_u32 s73, s73, 4096
s_mov_b32 s92, 0x00010001
s_mov_b32 s93, 0x00010001
v_mov_b32 v15, s68
s_cmp_eq_u32 s66, 0
s_cbranch_scc0 L_ex1
ds_write_b128 v2, v[68:71]
ds_write_b128 v2, v[76:79] offset:1024
ds_write_b128 v5, v[24:27]
s_waitcnt lgkmcnt(0)
s_barrier
ds_read_b128 v[128:131], v3
ds_read_b128 v[132:135], v3 offset:1024
ds_read_b128 v[136:139], v6
s_waitcnt lgkmcnt(1)
v_pk_add_f32 v[128:129], v[128:129], v[64:65]
v_pk_add_f32 v[130:131], v[130:131], v[66:67]
v_pk_add_f32 v[132:133], v[132:133], v[72:73]
v_pk_add_f32 v[134:135], v[134:135], v[74:75]
s_waitcnt lgkmcnt(0)
v_pk_add_f32 v[136:137], v[136:137], v[20:21]
v_pk_add_f32 v[138:139], v[138:139], v[22:23]
L_ex_d:
v_cvt_pk_bf16_f32 v140, v128, v129
v_cvt_pk_bf16_f32 v141, v130, v131
v_cvt_pk_bf16_f32 v142, v132, v133
v_cvt_pk_bf16_f32 v143, v134, v135
v_bfi_b32 v136, s85, v15, v136
v_bfi_b32 v137, s85, v15, v137
v_bfi_b32 v138, s85, v15, v138
v_bfi_b32 v139, s85, v15, v139
s_cmp_eq_u32 s69, 0
s_cbranch_scc1 L_kvp_s
buffer_store_dwordx4 v[140:143], v16, s[12:15], s72 offen
s_mov_b64 exec, s[92:93]
buffer_store_dwordx4 v[136:139], v4, s[12:15], s73 offen
s_mov_b64 exec, -1
L_kvp_d:
v_and_b32 v2, 15, v1
v_lshlrev_b32 v2, 2, v2
s_lshl_b32 s70, s66, 8
s_add_u32 s70, s70, 159744
v_add_u32 v2, s70, v2
v_lshrrev_b32 v3, 4, v1
v_lshlrev_b32 v3, 4, v3
s_lshl_b32 s70, s67, 7
s_add_u32 s70, s70, 160768
v_add_u32 v5, s70, v3
ds_read_b32 v8, v2 offset:0
ds_read_b32 v128, v2 offset:512
ds_read_b32 v10, v2 offset:64
ds_read_b32 v130, v2 offset:576
ds_read_b32 v12, v2 offset:128
ds_read_b32 v132, v2 offset:640
ds_read_b32 v14, v2 offset:192
ds_read_b32 v134, v2 offset:704
ds_read_b128 v[144:147], v5 offset:0
ds_read_b128 v[148:151], v5 offset:64
s_lshl_b32 s70, s67, 11
s_add_u32 s70, s70, 24576
v_add_u32 v17, s70, v16
s_lshl_b32 s70, s67, 6
s_add_u32 s70, s70, 161600
v_add_u32 v18, s70, v3
s_waitcnt lgkmcnt(0)
v_mul_f32 v20, s90, v128
v_mul_f32 v22, s90, v130
v_mul_f32 v4, s90, v132
v_mul_f32 v6, s90, v134
v_pk_fma_f32 v[32:33], v[144:145], v[8:9], v[32:33] op_sel:[0,0,0] op_sel_hi:[1,0,1]
v_pk_fma_f32 v[36:37], v[148:149], v[8:9], v[36:37] op_sel:[0,0,0] op_sel_hi:[1,0,1]
v_pk_fma_f32 v[34:35], v[146:147], v[8:9], v[34:35] op_sel:[0,0,0] op_sel_hi:[1,0,1]
v_pk_fma_f32 v[38:39], v[150:151], v[8:9], v[38:39] op_sel:[0,0,0] op_sel_hi:[1,0,1]
v_pk_mul_f32 v[24:25], v[32:33], v[20:21] op_sel:[0,0] op_sel_hi:[1,0]
v_pk_mul_f32 v[28:29], v[36:37], v[20:21] op_sel:[0,0] op_sel_hi:[1,0]
v_pk_mul_f32 v[26:27], v[34:35], v[20:21] op_sel:[0,0] op_sel_hi:[1,0]
v_pk_mul_f32 v[30:31], v[38:39], v[20:21] op_sel:[0,0] op_sel_hi:[1,0]
v_pk_fma_f32 v[32:33], v[32:33], v[128:129], s[82:83] op_sel:[0,0,0] op_sel_hi:[1,0,1]
v_pk_fma_f32 v[36:37], v[36:37], v[128:129], s[82:83] op_sel:[0,0,0] op_sel_hi:[1,0,1]
v_pk_fma_f32 v[34:35], v[34:35], v[128:129], s[82:83] op_sel:[0,0,0] op_sel_hi:[1,0,1]
v_pk_fma_f32 v[38:39], v[38:39], v[128:129], s[82:83] op_sel:[0,0,0] op_sel_hi:[1,0,1]
v_exp_f32_e64 v24, v24 clamp
v_exp_f32_e64 v28, v28 clamp
v_exp_f32_e64 v25, v25 clamp
v_exp_f32_e64 v29, v29 clamp
v_exp_f32_e64 v26, v26 clamp
v_exp_f32_e64 v30, v30 clamp
v_exp_f32_e64 v27, v27 clamp
v_exp_f32_e64 v31, v31 clamp
v_pk_add_f32 v[24:25], v[24:25], s[80:81]
v_pk_add_f32 v[28:29], v[28:29], s[80:81]
v_pk_add_f32 v[26:27], v[26:27], s[80:81]
v_pk_add_f32 v[30:31], v[30:31], s[80:81]
v_max_f32 v32, v32, v24
v_max_f32 v36, v36, v28
v_max_f32 v33, v33, v25
v_max_f32 v37, v37, v29
v_max_f32 v34, v34, v26
v_max_f32 v38, v38, v30
v_max_f32 v35, v35, v27
v_max_f32 v39, v39, v31
v_cvt_pk_bf16_f32 v32, v32, v33
v_cvt_pk_bf16_f32 v33, v34, v35
v_cvt_pk_bf16_f32 v34, v36, v37
v_cvt_pk_bf16_f32 v35, v38, v39
v_pk_fma_f32 v[56:57], v[144:145], v[10:11], v[56:57] op_sel:[0,0,0] op_sel_hi:[1,0,1]
v_pk_fma_f32 v[60:61], v[148:149], v[10:11], v[60:61] op_sel:[0,0,0] op_sel_hi:[1,0,1]
v_pk_fma_f32 v[58:59], v[146:147], v[10:11], v[58:59] op_sel:[0,0,0] op_sel_hi:[1,0,1]
v_pk_fma_f32 v[62:63], v[150:151], v[10:11], v[62:63] op_sel:[0,0,0] op_sel_hi:[1,0,1]
v_pk_mul_f32 v[24:25], v[56:57], v[22:23] op_sel:[0,0] op_sel_hi:[1,0]
v_pk_mul_f32 v[28:29], v[60:61], v[22:23] op_sel:[0,0] op_sel_hi:[1,0]
v_pk_mul_f32 v[26:27], v[58:59], v[22:23] op_sel:[0,0] op_sel_hi:[1,0]
v_pk_mul_f32 v[30:31], v[62:63], v[22:23] op_sel:[0,0] op_sel_hi:[1,0]
v_pk_fma_f32 v[56:57], v[56:57], v[130:131], s[82:83] op_sel:[0,0,0] op_sel_hi:[1,0,1]
v_pk_fma_f32 v[60:61], v[60:61], v[130:131], s[82:83] op_sel:[0,0,0] op_sel_hi:[1,0,1]
v_pk_fma_f32 v[58:59], v[58:59], v[130:131], s[82:83] op_sel:[0,0,0] op_sel_hi:[1,0,1]
v_pk_fma_f32 v[62:63], v[62:63], v[130:131], s[82:83] op_sel:[0,0,0] op_sel_hi:[1,0,1]
v_exp_f32_e64 v24, v24 clamp
v_exp_f32_e64 v28, v28 clamp
v_exp_f32_e64 v25, v25 clamp
v_exp_f32_e64 v29, v29 clamp
v_exp_f32_e64 v26, v26 clamp
v_exp_f32_e64 v30, v30 clamp
v_exp_f32_e64 v27, v27 clamp
v_exp_f32_e64 v31, v31 clamp
v_pk_add_f32 v[24:25], v[24:25], s[80:81]
v_pk_add_f32 v[28:29], v[28:29], s[80:81]
v_pk_add_f32 v[26:27], v[26:27], s[80:81]
v_pk_add_f32 v[30:31], v[30:31], s[80:81]
v_max_f32 v56, v56, v24
v_max_f32 v60, v60, v28
v_max_f32 v57, v57, v25
v_max_f32 v61, v61, v29
v_max_f32 v58, v58, v26
v_max_f32 v62, v62, v30
v_max_f32 v59, v59, v27
v_max_f32 v63, v63, v31
v_cvt_pk_bf16_f32 v56, v56, v57
v_cvt_pk_bf16_f32 v57, v58, v59
v_cvt_pk_bf16_f32 v58, v60, v61
v_cvt_pk_bf16_f32 v59, v62, v63
v_pk_fma_f32 v[80:81], v[144:145], v[12:13], v[80:81] op_sel:[0,0,0] op_sel_hi:[1,0,1]
v_pk_fma_f32 v[84:85], v[148:149], v[12:13], v[84:85] op_sel:[0,0,0] op_sel_hi:[1,0,1]
v_pk_fma_f32 v[82:83], v[146:147], v[12:13], v[82:83] op_sel:[0,0,0] op_sel_hi:[1,0,1]
v_pk_fma_f32 v[86:87], v[150:151], v[12:13], v[86:87] op_sel:[0,0,0] op_sel_hi:[1,0,1]
v_pk_mul_f32 v[24:25], v[80:81], v[4:5] op_sel:[0,0] op_sel_hi:[1,0]
v_pk_mul_f32 v[28:29], v[84:85], v[4:5] op_sel:[0,0] op_sel_hi:[1,0]
v_pk_mul_f32 v[26:27], v[82:83], v[4:5] op_sel:[0,0] op_sel_hi:[1,0]
v_pk_mul_f32 v[30:31], v[86:87], v[4:5] op_sel:[0,0] op_sel_hi:[1,0]
v_pk_fma_f32 v[80:81], v[80:81], v[132:133], s[82:83] op_sel:[0,0,0] op_sel_hi:[1,0,1]
v_pk_fma_f32 v[84:85], v[84:85], v[132:133], s[82:83] op_sel:[0,0,0] op_sel_hi:[1,0,1]
v_pk_fma_f32 v[82:83], v[82:83], v[132:133], s[82:83] op_sel:[0,0,0] op_sel_hi:[1,0,1]
v_pk_fma_f32 v[86:87], v[86:87], v[132:133], s[82:83] op_sel:[0,0,0] op_sel_hi:[1,0,1]
v_exp_f32_e64 v24, v24 clamp
v_exp_f32_e64 v28, v28 clamp
v_exp_f32_e64 v25, v25 clamp
v_exp_f32_e64 v29, v29 clamp
v_exp_f32_e64 v26, v26 clamp
v_exp_f32_e64 v30, v30 clamp
v_exp_f32_e64 v27, v27 clamp
v_exp_f32_e64 v31, v31 clamp
v_pk_add_f32 v[24:25], v[24:25], s[80:81]
v_pk_add_f32 v[28:29], v[28:29], s[80:81]
v_pk_add_f32 v[26:27], v[26:27], s[80:81]
v_pk_add_f32 v[30:31], v[30:31], s[80:81]
v_max_f32 v80, v80, v24
v_max_f32 v84, v84, v28
v_max_f32 v81, v81, v25
v_max_f32 v85, v85, v29
v_max_f32 v82, v82, v26
v_max_f32 v86, v86, v30
v_max_f32 v83, v83, v27
v_max_f32 v87, v87, v31
v_cvt_pk_bf16_f32 v80, v80, v81
v_cvt_pk_bf16_f32 v81, v82, v83
v_cvt_pk_bf16_f32 v82, v84, v85
v_cvt_pk_bf16_f32 v83, v86, v87
v_pk_fma_f32 v[104:105], v[144:145], v[14:15], v[104:105] op_sel:[0,0,0] op_sel_hi:[1,0,1]
v_pk_fma_f32 v[108:109], v[148:149], v[14:15], v[108:109] op_sel:[0,0,0] op_sel_hi:[1,0,1]
v_pk_fma_f32 v[106:107], v[146:147], v[14:15], v[106:107] op_sel:[0,0,0] op_sel_hi:[1,0,1]
v_pk_fma_f32 v[110:111], v[150:151], v[14:15], v[110:111] op_sel:[0,0,0] op_sel_hi:[1,0,1]
v_pk_mul_f32 v[24:25], v[104:105], v[6:7] op_sel:[0,0] op_sel_hi:[1,0]
v_pk_mul_f32 v[28:29], v[108:109], v[6:7] op_sel:[0,0] op_sel_hi:[1,0]
v_pk_mul_f32 v[26:27], v[106:107], v[6:7] op_sel:[0,0] op_sel_hi:[1,0]
v_pk_mul_f32 v[30:31], v[110:111], v[6:7] op_sel:[0,0] op_sel_hi:[1,0]
v_pk_fma_f32 v[104:105], v[104:105], v[134:135], s[82:83] op_sel:[0,0,0] op_sel_hi:[1,0,1]
v_pk_fma_f32 v[108:109], v[108:109], v[134:135], s[82:83] op_sel:[0,0,0] op_sel_hi:[1,0,1]
v_pk_fma_f32 v[106:107], v[106:107], v[134:135], s[82:83] op_sel:[0,0,0] op_sel_hi:[1,0,1]
v_pk_fma_f32 v[110:111], v[110:111], v[134:135], s[82:83] op_sel:[0,0,0] op_sel_hi:[1,0,1]
v_exp_f32_e64 v24, v24 clamp
v_exp_f32_e64 v28, v28 clamp
v_exp_f32_e64 v25, v25 clamp
v_exp_f32_e64 v29, v29 clamp
v_exp_f32_e64 v26, v26 clamp
v_exp_f32_e64 v30, v30 clamp
v_exp_f32_e64 v27, v27 clamp
v_exp_f32_e64 v31, v31 clamp
v_pk_add_f32 v[24:25], v[24:25], s[80:81]
v_pk_add_f32 v[28:29], v[28:29], s[80:81]
v_pk_add_f32 v[26:27], v[26:27], s[80:81]
v_pk_add_f32 v[30:31], v[30:31], s[80:81]
v_max_f32 v104, v104, v24
v_max_f32 v108, v108, v28
v_max_f32 v105, v105, v25
v_max_f32 v109, v109, v29
v_max_f32 v106, v106, v26
v_max_f32 v110, v110, v30
v_max_f32 v107, v107, v27
v_max_f32 v111, v111, v31
v_cvt_pk_bf16_f32 v104, v104, v105
v_cvt_pk_bf16_f32 v105, v106, v107
v_cvt_pk_bf16_f32 v106, v108, v109
v_cvt_pk_bf16_f32 v107, v110, v111
v_lshrrev_b32 v2, 4, v1
v_bfe_u32 v3, v1, 2, 2
v_lshl_add_u32 v4, v2, 2, v3
v_lshlrev_b32 v5, 7, v4
v_bfe_u32 v4, v4, 1, 2
v_lshl_add_u32 v5, v4, 5, v5
v_and_b32 v4, 3, v1
v_lshl_add_u32 v5, v4, 3, v5
v_add_u32 v8, 28672, v5
v_xor_b32 v9, 32, v8
v_xor_b32 v10, 64, v8
v_xor_b32 v11, 96, v8
v_add_u32 v12, 65536, v8
v_add_u32 v13, 65536, v9
v_add_u32 v14, 65536, v10
v_add_u32 v15, 65536, v11
v_and_b32 v3, 15, v1
v_lshrrev_b32 v4, 1, v3
v_lshrrev_b32 v5, 1, v2
v_xor_b32 v4, v4, v5
v_lshlrev_b32 v4, 4, v4
v_lshl_add_u32 v4, v3, 7, v4
v_and_b32 v5, 1, v2
v_lshl_add_u32 v4, v5, 3, v4
s_lshl_b32 s70, s60, 12
v_add_u32 v20, s70, v4
v_xor_b32 v21, 32, v20
v_xor_b32 v22, 64, v20
v_xor_b32 v23, 96, v20
s_lshl_b32 s74, s64, 18
s_lshl_b32 s70, s60, 16
s_add_u32 s74, s74, s70
s_add_u32 s74, s74, 2097152
v_add_u32 v6, s74, v16
v_add_u32 v19, 32768, v6
s_lshl_b32 s74, s89, 11
s_barrier
ds_read_b128 a[0:3], v17
ds_read_b128 a[4:7], v17 offset:1024
ds_read_b128 a[8:11], v18
s_waitcnt lgkmcnt(0)
v_mfma_f32_16x16x32_bf16 v[48:51], a[8:11], v[32:35], 0
v_mfma_f32_16x16x32_bf16 v[40:43], a[0:3], v[32:35], 0
v_mfma_f32_16x16x32_bf16 v[44:47], a[4:7], v[32:35], 0
v_mfma_f32_16x16x32_bf16 v[72:75], a[8:11], v[56:59], 0
v_mfma_f32_16x16x32_bf16 v[64:67], a[0:3], v[56:59], 0
v_mfma_f32_16x16x32_bf16 v[68:71], a[4:7], v[56:59], 0
v_mfma_f32_16x16x32_bf16 v[96:99], a[8:11], v[80:83], 0
v_mfma_f32_16x16x32_bf16 v[88:91], a[0:3], v[80:83], 0
v_mfma_f32_16x16x32_bf16 v[92:95], a[4:7], v[80:83], 0
v_mfma_f32_16x16x32_bf16 v[120:123], a[8:11], v[104:107], 0
v_mfma_f32_16x16x32_bf16 v[112:115], a[0:3], v[104:107], 0
v_mfma_f32_16x16x32_bf16 v[116:119], a[4:7], v[104:107], 0
v_add_f32 v48, s80, v48
v_rcp_f32 v48, v48
s_nop 0
v_pk_mul_f32 v[40:41], v[40:41], v[48:49] op_sel_hi:[1,0]
v_pk_mul_f32 v[42:43], v[42:43], v[48:49] op_sel_hi:[1,0]
v_pk_mul_f32 v[44:45], v[44:45], v[48:49] op_sel_hi:[1,0]
v_pk_mul_f32 v[46:47], v[46:47], v[48:49] op_sel_hi:[1,0]
v_cvt_pk_bf16_f32 v52, v40, v41
v_cvt_pk_bf16_f32 v53, v42, v43
v_cvt_pk_bf16_f32 v54, v44, v45
v_cvt_pk_bf16_f32 v55, v46, v47
s_add_u32 s70, s88, 0
buffer_store_dwordx4 v[52:55], v16, s[12:15], s70 offen sc1
v_add_f32 v72, s80, v72
v_rcp_f32 v72, v72
s_nop 0
v_pk_mul_f32 v[64:65], v[64:65], v[72:73] op_sel_hi:[1,0]
v_pk_mul_f32 v[66:67], v[66:67], v[72:73] op_sel_hi:[1,0]
v_pk_mul_f32 v[68:69], v[68:69], v[72:73] op_sel_hi:[1,0]
v_pk_mul_f32 v[70:71], v[70:71], v[72:73] op_sel_hi:[1,0]
v_cvt_pk_bf16_f32 v76, v64, v65
v_cvt_pk_bf16_f32 v77, v66, v67
v_cvt_pk_bf16_f32 v78, v68, v69
v_cvt_pk_bf16_f32 v79, v70, v71
s_add_u32 s70, s88, 32768
buffer_store_dwordx4 v[76:79], v16, s[12:15], s70 offen sc1
v_add_f32 v96, s80, v96
v_rcp_f32 v96, v96
s_nop 0
v_pk_mul_f32 v[88:89], v[88:89], v[96:97] op_sel_hi:[1,0]
v_pk_mul_f32 v[90:91], v[90:91], v[96:97] op_sel_hi:[1,0]
v_pk_mul_f32 v[92:93], v[92:93], v[96:97] op_sel_hi:[1,0]
v_pk_mul_f32 v[94:95], v[94:95], v[96:97] op_sel_hi:[1,0]
v_cvt_pk_bf16_f32 v100, v88, v89
v_cvt_pk_bf16_f32 v101, v90, v91
v_cvt_pk_bf16_f32 v102, v92, v93
v_cvt_pk_bf16_f32 v103, v94, v95
s_add_u32 s70, s88, 65536
buffer_store_dwordx4 v[100:103], v16, s[12:15], s70 offen sc1
v_add_f32 v120, s80, v120
v_rcp_f32 v120, v120
s_nop 0
v_pk_mul_f32 v[112:113], v[112:113], v[120:121] op_sel_hi:[1,0]
v_pk_mul_f32 v[114:115], v[114:115], v[120:121] op_sel_hi:[1,0]
v_pk_mul_f32 v[116:117], v[116:117], v[120:121] op_sel_hi:[1,0]
v_pk_mul_f32 v[118:119], v[118:119], v[120:121] op_sel_hi:[1,0]
v_cvt_pk_bf16_f32 v124, v112, v113
v_cvt_pk_bf16_f32 v125, v114, v115
v_cvt_pk_bf16_f32 v126, v116, v117
v_cvt_pk_bf16_f32 v127, v118, v119
s_add_u32 s70, s88, 98304
buffer_store_dwordx4 v[124:127], v16, s[12:15], s70 offen sc1
v_xor_b32 v7, s76, v7
ds_read_b64 v[26:27], v20 offset:0
ds_read_b64 v[30:31], v21 offset:0
ds_read_b64 v[34:35], v22 offset:0
ds_read_b64 v[38:39], v23 offset:0
ds_read_b64 v[42:43], v20 offset:2048
ds_read_b64 v[46:47], v21 offset:2048
ds_read_b64 v[50:51], v22 offset:2048
ds_read_b64 v[54:55], v23 offset:2048
s_waitcnt lgkmcnt(0)
ds_read_b64_tr_b16 a[0:1], v8 offset:0
ds_read_b64_tr_b16 a[2:3], v8 offset:2048
ds_read_b64_tr_b16 a[4:5], v9 offset:0
ds_read_b64_tr_b16 a[6:7], v9 offset:2048
ds_read_b64_tr_b16 a[8:9], v10 offset:0
ds_read_b64_tr_b16 a[10:11], v10 offset:2048
ds_read_b64_tr_b16 a[12:13], v11 offset:0
ds_read_b64_tr_b16 a[14:15], v11 offset:2048
ds_read_b64_tr_b16 a[16:17], v8 offset:4096
ds_read_b64_tr_b16 a[18:19], v8 offset:6144
ds_read_b64_tr_b16 a[20:21], v9 offset:4096
ds_read_b64_tr_b16 a[22:23], v9 offset:6144
ds_read_b64_tr_b16 a[24:25], v10 offset:4096
ds_read_b64_tr_b16 a[26:27], v10 offset:6144
ds_read_b64_tr_b16 a[28:29], v11 offset:4096
ds_read_b64_tr_b16 a[30:31], v11 offset:6144
v_lshlrev_b32 v24, 16, v26
v_and_b32 v25, 0xffff0000, v26
v_lshlrev_b32 v26, 16, v27
v_and_b32 v27, 0xffff0000, v27
v_lshlrev_b32 v28, 16, v30
v_and_b32 v29, 0xffff0000, v30
v_lshlrev_b32 v30, 16, v31
v_and_b32 v31, 0xffff0000, v31
v_lshlrev_b32 v32, 16, v34
v_and_b32 v33, 0xffff0000, v34
v_lshlrev_b32 v34, 16, v35
v_and_b32 v35, 0xffff0000, v35
v_lshlrev_b32 v36, 16, v38
v_and_b32 v37, 0xffff0000, v38
v_lshlrev_b32 v38, 16, v39
v_and_b32 v39, 0xffff0000, v39
v_lshlrev_b32 v40, 16, v42
v_and_b32 v41, 0xffff0000, v42
v_lshlrev_b32 v42, 16, v43
v_and_b32 v43, 0xffff0000, v43
v_lshlrev_b32 v44, 16, v46
v_and_b32 v45, 0xffff0000, v46
v_lshlrev_b32 v46, 16, v47
v_and_b32 v47, 0xffff0000, v47
v_lshlrev_b32 v48, 16, v50
v_and_b32 v49, 0xffff0000, v50
v_lshlrev_b32 v50, 16, v51
v_and_b32 v51, 0xffff0000, v51
v_lshlrev_b32 v52, 16, v54
v_and_b32 v53, 0xffff0000, v54
v_lshlrev_b32 v54, 16, v55
v_and_b32 v55, 0xffff0000, v55
s_waitcnt vmcnt(0)
buffer_load_dwordx4 v[56:59], v6, s[12:15], s74 offen offset:0 sc1
buffer_load_dwordx4 v[60:63], v19, s[12:15], s74 offen offset:0 sc1
buffer_load_dwordx4 v[64:67], v6, s[12:15], s74 offen offset:1024 sc1
buffer_load_dwordx4 v[68:71], v19, s[12:15], s74 offen offset:1024 sc1
s_add_u32 s74, s74, 2048
s_and_b32 s74, s74, 0x7fff
buffer_load_dwordx4 v[72:75], v6, s[12:15], s74 offen offset:0 sc1
buffer_load_dwordx4 v[76:79], v19, s[12:15], s74 offen offset:0 sc1
buffer_load_dwordx4 v[80:83], v6, s[12:15], s74 offen offset:1024 sc1
buffer_load_dwordx4 v[84:87], v19, s[12:15], s74 offen offset:1024 sc1
s_add_u32 s74, s74, 2048
s_and_b32 s74, s74, 0x7fff
buffer_load_dwordx4 v[88:91], v6, s[12:15], s74 offen offset:0 sc1
buffer_load_dwordx4 v[92:95], v19, s[12:15], s74 offen offset:0 sc1
buffer_load_dwordx4 v[96:99], v6, s[12:15], s74 offen offset:1024 sc1
buffer_load_dwordx4 v[100:103], v19, s[12:15], s74 offen offset:1024 sc1
s_add_u32 s74, s74, 2048
s_and_b32 s74, s74, 0x7fff
s_waitcnt vmcnt(8)
L_o0_chk:
v_max3_u32 v2, v56, v60, v64
v_max_u32 v2, v2, v68
v_cmp_eq_u32 vcc, -1, v2
s_cbranch_vccnz L_o0_rt
L_o0_ok:
s_waitcnt lgkmcnt(8)
v_mfma_f32_16x16x32_bf16 v[24:27], a[0:3], v[56:59], v[24:27]
ds_read_b64_tr_b16 a[32:33], v8 offset:8192
buffer_load_dwordx4 v[104:107], v6, s[12:15], s74 offen offset:0 sc1
v_mfma_f32_16x16x32_bf16 v[40:43], a[0:3], v[60:63], v[40:43]
ds_read_b64_tr_b16 a[34:35], v8 offset:10240
buffer_load_dwordx4 v[108:111], v19, s[12:15], s74 offen offset:0 sc1
v_mfma_f32_16x16x32_bf16 v[28:31], a[4:7], v[56:59], v[28:31]
ds_read_b64_tr_b16 a[36:37], v9 offset:8192
v_mfma_f32_16x16x32_bf16 v[44:47], a[4:7], v[60:63], v[44:47]
ds_read_b64_tr_b16 a[38:39], v9 offset:10240
buffer_load_dwordx4 v[112:115], v6, s[12:15], s74 offen offset:1024 sc1
v_mfma_f32_16x16x32_bf16 v[32:35], a[8:11], v[56:59], v[32:35]
ds_read_b64_tr_b16 a[40:41], v10 offset:8192
buffer_load_dwordx4 v[116:119], v19, s[12:15], s74 offen offset:1024 sc1
v_mfma_f32_16x16x32_bf16 v[48:51], a[8:11], v[60:63], v[48:51]
ds_read_b64_tr_b16 a[42:43], v10 offset:10240
v_mfma_f32_16x16x32_bf16 v[36:39], a[12:15], v[56:59], v[36:39]
ds_read_b64_tr_b16 a[44:45], v11 offset:8192
s_add_u32 s74, s74, 2048
v_mfma_f32_16x16x32_bf16 v[52:55], a[12:15], v[60:63], v[52:55]
ds_read_b64_tr_b16 a[46:47], v11 offset:10240
s_waitcnt lgkmcnt(8)
v_mfma_f32_16x16x32_bf16 v[24:27], a[16:19], v[64:67], v[24:27]
ds_read_b64_tr_b16 a[0:1], v8 offset:12288
s_and_b32 s74, s74, 0x7fff
v_mfma_f32_16x16x32_bf16 v[40:43], a[16:19], v[68:71], v[40:43]
ds_read_b64_tr_b16 a[2:3], v8 offset:14336
s_waitcnt vmcnt(8)
v_mfma_f32_16x16x32_bf16 v[28:31], a[20:23], v[64:67], v[28:31]
ds_read_b64_tr_b16 a[4:5], v9 offset:12288
v_mfma_f32_16x16x32_bf16 v[44:47], a[20:23], v[68:71], v[44:47]
ds_read_b64_tr_b16 a[6:7], v9 offset:14336
v_max3_u32 v2, v72, v76, v80
v_mfma_f32_16x16x32_bf16 v[32:35], a[24:27], v[64:67], v[32:35]
ds_read_b64_tr_b16 a[8:9], v10 offset:12288
v_max_u32 v2, v2, v84
v_mfma_f32_16x16x32_bf16 v[48:51], a[24:27], v[68:71], v[48:51]
ds_read_b64_tr_b16 a[10:11], v10 offset:14336
v_mfma_f32_16x16x32_bf16 v[36:39], a[28:31], v[64:67], v[36:39]
ds_read_b64_tr_b16 a[12:13], v11 offset:12288
v_cmp_eq_u32 vcc, -1, v2
v_mfma_f32_16x16x32_bf16 v[52:55], a[28:31], v[68:71], v[52:55]
ds_read_b64_tr_b16 a[14:15], v11 offset:14336
s_cbranch_vccnz L_o1_rt
L_o1_ok:
s_waitcnt lgkmcnt(8)
v_mfma_f32_16x16x32_bf16 v[24:27], a[32:35], v[72:75], v[24:27]
ds_read_b64_tr_b16 a[16:17], v8 offset:16384
buffer_load_dwordx4 v[56:59], v6, s[12:15], s74 offen offset:0 sc1
v_mfma_f32_16x16x32_bf16 v[40:43], a[32:35], v[76:79], v[40:43]
ds_read_b64_tr_b16 a[18:19], v8 offset:18432
buffer_load_dwordx4 v[60:63], v19, s[12:15], s74 offen offset:0 sc1
v_mfma_f32_16x16x32_bf16 v[28:31], a[36:39], v[72:75], v[28:31]
ds_read_b64_tr_b16 a[20:21], v9 offset:16384
v_mfma_f32_16x16x32_bf16 v[44:47], a[36:39], v[76:79], v[44:47]
ds_read_b64_tr_b16 a[22:23], v9 offset:18432
buffer_load_dwordx4 v[64:67], v6, s[12:15], s74 offen offset:1024 sc1
v_mfma_f32_16x16x32_bf16 v[32:35], a[40:43], v[72:75], v[32:35]
ds_read_b64_tr_b16 a[24:25], v10 offset:16384
buffer_load_dwordx4 v[68:71], v19, s[12:15], s74 offen offset:1024 sc1
v_mfma_f32_16x16x32_bf16 v[48:51], a[40:43], v[76:79], v[48:51]
ds_read_b64_tr_b16 a[26:27], v10 offset:18432
v_mfma_f32_16x16x32_bf16 v[36:39], a[44:47], v[72:75], v[36:39]
ds_read_b64_tr_b16 a[28:29], v11 offset:16384
s_add_u32 s74, s74, 2048
v_mfma_f32_16x16x32_bf16 v[52:55], a[44:47], v[76:79], v[52:55]
ds_read_b64_tr_b16 a[30:31], v11 offset:18432
s_waitcnt lgkmcnt(8)
v_mfma_f32_16x16x32_bf16 v[24:27], a[0:3], v[80:83], v[24:27]
ds_read_b64_tr_b16 a[32:33], v8 offset:20480
s_and_b32 s74, s74, 0x7fff
v_mfma_f32_16x16x32_bf16 v[40:43], a[0:3], v[84:87], v[40:43]
ds_read_b64_tr_b16 a[34:35], v8 offset:22528
s_waitcnt vmcnt(8)
v_mfma_f32_16x16x32_bf16 v[28:31], a[4:7], v[80:83], v[28:31]
ds_read_b64_tr_b16 a[36:37], v9 offset:20480
v_mfma_f32_16x16x32_bf16 v[44:47], a[4:7], v[84:87], v[44:47]
ds_read_b64_tr_b16 a[38:39], v9 offset:22528
v_max3_u32 v2, v88, v92, v96
v_mfma_f32_16x16x32_bf16 v[32:35], a[8:11], v[80:83], v[32:35]
ds_read_b64_tr_b16 a[40:41], v10 offset:20480
v_max_u32 v2, v2, v100
v_mfma_f32_16x16x32_bf16 v[48:51], a[8:11], v[84:87], v[48:51]
ds_read_b64_tr_b16 a[42:43], v10 offset:22528
v_mfma_f32_16x16x32_bf16 v[36:39], a[12:15], v[80:83], v[36:39]
ds_read_b64_tr_b16 a[44:45], v11 offset:20480
v_cmp_eq_u32 vcc, -1, v2
v_mfma_f32_16x16x32_bf16 v[52:55], a[12:15], v[84:87], v[52:55]
ds_read_b64_tr_b16 a[46:47], v11 offset:22528
s_cbranch_vccnz L_o2_rt
L_o2_ok:
s_waitcnt lgkmcnt(8)
v_mfma_f32_16x16x32_bf16 v[24:27], a[16:19], v[88:91], v[24:27]
ds_read_b64_tr_b16 a[0:1], v8 offset:24576
buffer_load_dwordx4 v[72:75], v6, s[12:15], s74 offen offset:0 sc1
v_mfma_f32_16x16x32_bf16 v[40:43], a[16:19], v[92:95], v[40:43]
ds_read_b64_tr_b16 a[2:3], v8 offset:26624
buffer_load_dwordx4 v[76:79], v19, s[12:15], s74 offen offset:0 sc1
v_mfma_f32_16x16x32_bf16 v[28:31], a[20:23], v[88:91], v[28:31]
ds_read_b64_tr_b16 a[4:5], v9 offset:24576
v_mfma_f32_16x16x32_bf16 v[44:47], a[20:23], v[92:95], v[44:47]
ds_read_b64_tr_b16 a[6:7], v9 offset:26624
buffer_load_dwordx4 v[80:83], v6, s[12:15], s74 offen offset:1024 sc1
v_mfma_f32_16x16x32_bf16 v[32:35], a[24:27], v[88:91], v[32:35]
ds_read_b64_tr_b16 a[8:9], v10 offset:24576
buffer_load_dwordx4 v[84:87], v19, s[12:15], s74 offen offset:1024 sc1
v_mfma_f32_16x16x32_bf16 v[48:51], a[24:27], v[92:95], v[48:51]
ds_read_b64_tr_b16 a[10:11], v10 offset:26624
v_mfma_f32_16x16x32_bf16 v[36:39], a[28:31], v[88:91], v[36:39]
ds_read_b64_tr_b16 a[12:13], v11 offset:24576
s_add_u32 s74, s74, 2048
v_mfma_f32_16x16x32_bf16 v[52:55], a[28:31], v[92:95], v[52:55]
ds_read_b64_tr_b16 a[14:15], v11 offset:26624
s_waitcnt lgkmcnt(8)
v_mfma_f32_16x16x32_bf16 v[24:27], a[32:35], v[96:99], v[24:27]
ds_read_b64_tr_b16 a[16:17], v8 offset:28672
s_and_b32 s74, s74, 0x7fff
v_mfma_f32_16x16x32_bf16 v[40:43], a[32:35], v[100:103], v[40:43]
ds_read_b64_tr_b16 a[18:19], v8 offset:30720
s_waitcnt vmcnt(8)
v_mfma_f32_16x16x32_bf16 v[28:31], a[36:39], v[96:99], v[28:31]
ds_read_b64_tr_b16 a[20:21], v9 offset:28672
v_mfma_f32_16x16x32_bf16 v[44:47], a[36:39], v[100:103], v[44:47]
ds_read_b64_tr_b16 a[22:23], v9 offset:30720
v_max3_u32 v2, v104, v108, v112
v_mfma_f32_16x16x32_bf16 v[32:35], a[40:43], v[96:99], v[32:35]
ds_read_b64_tr_b16 a[24:25], v10 offset:28672
v_max_u32 v2, v2, v116
v_mfma_f32_16x16x32_bf16 v[48:51], a[40:43], v[100:103], v[48:51]
ds_read_b64_tr_b16 a[26:27], v10 offset:30720
v_mfma_f32_16x16x32_bf16 v[36:39], a[44:47], v[96:99], v[36:39]
ds_read_b64_tr_b16 a[28:29], v11 offset:28672
v_cmp_eq_u32 vcc, -1, v2
v_mfma_f32_16x16x32_bf16 v[52:55], a[44:47], v[100:103], v[52:55]
ds_read_b64_tr_b16 a[30:31], v11 offset:30720
s_cbranch_vccnz L_o3_rt
L_o3_ok:
s_waitcnt lgkmcnt(8)
v_mfma_f32_16x16x32_bf16 v[24:27], a[0:3], v[104:107], v[24:27]
ds_read_b64_tr_b16 a[32:33], v8 offset:32768
buffer_load_dwordx4 v[88:91], v6, s[12:15], s74 offen offset:0 sc1
v_mfma_f32_16x16x32_bf16 v[40:43], a[0:3], v[108:111], v[40:43]
ds_read_b64_tr_b16 a[34:35], v8 offset:34816
buffer_load_dwordx4 v[92:95], v19, s[12:15], s74 offen offset:0 sc1
v_mfma_f32_16x16x32_bf16 v[28:31], a[4:7], v[104:107], v[28:31]
ds_read_b64_tr_b16 a[36:37], v9 offset:32768
v_mfma_f32_16x16x32_bf16 v[44:47], a[4:7], v[108:111], v[44:47]
ds_read_b64_tr_b16 a[38:39], v9 offset:34816
buffer_load_dwordx4 v[96:99], v6, s[12:15], s74 offen offset:1024 sc1
v_mfma_f32_16x16x32_bf16 v[32:35], a[8:11], v[104:107], v[32:35]
ds_read_b64_tr_b16 a[40:41], v10 offset:32768
buffer_load_dwordx4 v[100:103], v19, s[12:15], s74 offen offset:1024 sc1
v_mfma_f32_16x16x32_bf16 v[48:51], a[8:11], v[108:111], v[48:51]
ds_read_b64_tr_b16 a[42:43], v10 offset:34816
v_mfma_f32_16x16x32_bf16 v[36:39], a[12:15], v[104:107], v[36:39]
ds_read_b64_tr_b16 a[44:45], v11 offset:32768
s_add_u32 s74, s74, 2048
v_mfma_f32_16x16x32_bf16 v[52:55], a[12:15], v[108:111], v[52:55]
ds_read_b64_tr_b16 a[46:47], v11 offset:34816
s_waitcnt lgkmcnt(8)
v_mfma_f32_16x16x32_bf16 v[24:27], a[16:19], v[112:115], v[24:27]
ds_read_b64_tr_b16 a[0:1], v8 offset:36864
s_and_b32 s74, s74, 0x7fff
v_mfma_f32_16x16x32_bf16 v[40:43], a[16:19], v[116:119], v[40:43]
ds_read_b64_tr_b16 a[2:3], v8 offset:38912
s_waitcnt vmcnt(8)
v_mfma_f32_16x16x32_bf16 v[28:31], a[20:23], v[112:115], v[28:31]
ds_read_b64_tr_b16 a[4:5], v9 offset:36864
v_mfma_f32_16x16x32_bf16 v[44:47], a[20:23], v[116:119], v[44:47]
ds_read_b64_tr_b16 a[6:7], v9 offset:38912
v_max3_u32 v2, v56, v60, v64
v_mfma_f32_16x16x32_bf16 v[32:35], a[24:27], v[112:115], v[32:35]
ds_read_b64_tr_b16 a[8:9], v10 offset:36864
v_max_u32 v2, v2, v68
v_mfma_f32_16x16x32_bf16 v[48:51], a[24:27], v[116:119], v[48:51]
ds_read_b64_tr_b16 a[10:11], v10 offset:38912
v_mfma_f32_16x16x32_bf16 v[36:39], a[28:31], v[112:115], v[36:39]
ds_read_b64_tr_b16 a[12:13], v11 offset:36864
v_cmp_eq_u32 vcc, -1, v2
v_mfma_f32_16x16x32_bf16 v[52:55], a[28:31], v[116:119], v[52:55]
ds_read_b64_tr_b16 a[14:15], v11 offset:38912
s_cbranch_vccnz L_o4_rt
L_o4_ok:
s_waitcnt lgkmcnt(8)
v_mfma_f32_16x16x32_bf16 v[24:27], a[32:35], v[56:59], v[24:27]
ds_read_b64_tr_b16 a[16:17], v8 offset:40960
buffer_load_dwordx4 v[104:107], v6, s[12:15], s74 offen offset:0 sc1
v_mfma_f32_16x16x32_bf16 v[40:43], a[32:35], v[60:63], v[40:43]
ds_read_b64_tr_b16 a[18:19], v8 offset:43008
buffer_load_dwordx4 v[108:111], v19, s[12:15], s74 offen offset:0 sc1
v_mfma_f32_16x16x32_bf16 v[28:31], a[36:39], v[56:59], v[28:31]
ds_read_b64_tr_b16 a[20:21], v9 offset:40960
v_mfma_f32_16x16x32_bf16 v[44:47], a[36:39], v[60:63], v[44:47]
ds_read_b64_tr_b16 a[22:23], v9 offset:43008
buffer_load_dwordx4 v[112:115], v6, s[12:15], s74 offen offset:1024 sc1
v_mfma_f32_16x16x32_bf16 v[32:35], a[40:43], v[56:59], v[32:35]
ds_read_b64_tr_b16 a[24:25], v10 offset:40960
buffer_load_dwordx4 v[116:119], v19, s[12:15], s74 offen offset:1024 sc1
v_mfma_f32_16x16x32_bf16 v[48:51], a[40:43], v[60:63], v[48:51]
ds_read_b64_tr_b16 a[26:27], v10 offset:43008
v_mfma_f32_16x16x32_bf16 v[36:39], a[44:47], v[56:59], v[36:39]
ds_read_b64_tr_b16 a[28:29], v11 offset:40960
s_add_u32 s74, s74, 2048
v_mfma_f32_16x16x32_bf16 v[52:55], a[44:47], v[60:63], v[52:55]
ds_read_b64_tr_b16 a[30:31], v11 offset:43008
s_waitcnt lgkmcnt(8)
v_mfma_f32_16x16x32_bf16 v[24:27], a[0:3], v[64:67], v[24:27]
ds_read_b64_tr_b16 a[32:33], v8 offset:45056
s_and_b32 s74, s74, 0x7fff
v_mfma_f32_16x16x32_bf16 v[40:43], a[0:3], v[68:71], v[40:43]
ds_read_b64_tr_b16 a[34:35], v8 offset:47104
s_waitcnt vmcnt(8)
v_mfma_f32_16x16x32_bf16 v[28:31], a[4:7], v[64:67], v[28:31]
ds_read_b64_tr_b16 a[36:37], v9 offset:45056
v_mfma_f32_16x16x32_bf16 v[44:47], a[4:7], v[68:71], v[44:47]
ds_read_b64_tr_b16 a[38:39], v9 offset:47104
v_max3_u32 v2, v72, v76, v80
v_mfma_f32_16x16x32_bf16 v[32:35], a[8:11], v[64:67], v[32:35]
ds_read_b64_tr_b16 a[40:41], v10 offset:45056
v_max_u32 v2, v2, v84
v_mfma_f32_16x16x32_bf16 v[48:51], a[8:11], v[68:71], v[48:51]
ds_read_b64_tr_b16 a[42:43], v10 offset:47104
v_mfma_f32_16x16x32_bf16 v[36:39], a[12:15], v[64:67], v[36:39]
ds_read_b64_tr_b16 a[44:45], v11 offset:45056
v_cmp_eq_u32 vcc, -1, v2
v_mfma_f32_16x16x32_bf16 v[52:55], a[12:15], v[68:71], v[52:55]
ds_read_b64_tr_b16 a[46:47], v11 offset:47104
s_cbranch_vccnz L_o5_rt
L_o5_ok:
s_waitcnt lgkmcnt(8)
v_mfma_f32_16x16x32_bf16 v[24:27], a[16:19], v[72:75], v[24:27]
ds_read_b64_tr_b16 a[0:1], v8 offset:49152
buffer_load_dwordx4 v[56:59], v6, s[12:15], s74 offen offset:0 sc1
v_mfma_f32_16x16x32_bf16 v[40:43], a[16:19], v[76:79], v[40:43]
ds_read_b64_tr_b16 a[2:3], v8 offset:51200
buffer_load_dwordx4 v[60:63], v19, s[12:15], s74 offen offset:0 sc1
v_mfma_f32_16x16x32_bf16 v[28:31], a[20:23], v[72:75], v[28:31]
ds_read_b64_tr_b16 a[4:5], v9 offset:49152
v_mfma_f32_16x16x32_bf16 v[44:47], a[20:23], v[76:79], v[44:47]
ds_read_b64_tr_b16 a[6:7], v9 offset:51200
buffer_load_dwordx4 v[64:67], v6, s[12:15], s74 offen offset:1024 sc1
v_mfma_f32_16x16x32_bf16 v[32:35], a[24:27], v[72:75], v[32:35]
ds_read_b64_tr_b16 a[8:9], v10 offset:49152
buffer_load_dwordx4 v[68:71], v19, s[12:15], s74 offen offset:1024 sc1
v_mfma_f32_16x16x32_bf16 v[48:51], a[24:27], v[76:79], v[48:51]
ds_read_b64_tr_b16 a[10:11], v10 offset:51200
v_mfma_f32_16x16x32_bf16 v[36:39], a[28:31], v[72:75], v[36:39]
ds_read_b64_tr_b16 a[12:13], v11 offset:49152
s_add_u32 s74, s74, 2048
v_mfma_f32_16x16x32_bf16 v[52:55], a[28:31], v[76:79], v[52:55]
ds_read_b64_tr_b16 a[14:15], v11 offset:51200
s_waitcnt lgkmcnt(8)
v_mfma_f32_16x16x32_bf16 v[24:27], a[32:35], v[80:83], v[24:27]
ds_read_b64_tr_b16 a[16:17], v8 offset:53248
s_and_b32 s74, s74, 0x7fff
v_mfma_f32_16x16x32_bf16 v[40:43], a[32:35], v[84:87], v[40:43]
ds_read_b64_tr_b16 a[18:19], v8 offset:55296
s_waitcnt vmcnt(8)
v_mfma_f32_16x16x32_bf16 v[28:31], a[36:39], v[80:83], v[28:31]
ds_read_b64_tr_b16 a[20:21], v9 offset:53248
v_mfma_f32_16x16x32_bf16 v[44:47], a[36:39], v[84:87], v[44:47]
ds_read_b64_tr_b16 a[22:23], v9 offset:55296
v_max3_u32 v2, v88, v92, v96
v_mfma_f32_16x16x32_bf16 v[32:35], a[40:43], v[80:83], v[32:35]
ds_read_b64_tr_b16 a[24:25], v10 offset:53248
v_max_u32 v2, v2, v100
v_mfma_f32_16x16x32_bf16 v[48:51], a[40:43], v[84:87], v[48:51]
ds_read_b64_tr_b16 a[26:27], v10 offset:55296
v_mfma_f32_16x16x32_bf16 v[36:39], a[44:47], v[80:83], v[36:39]
ds_read_b64_tr_b16 a[28:29], v11 offset:53248
v_cmp_eq_u32 vcc, -1, v2
v_mfma_f32_16x16x32_bf16 v[52:55], a[44:47], v[84:87], v[52:55]
ds_read_b64_tr_b16 a[30:31], v11 offset:55296
s_cbranch_vccnz L_o6_rt
L_o6_ok:
s_waitcnt lgkmcnt(8)
v_mfma_f32_16x16x32_bf16 v[24:27], a[0:3], v[88:91], v[24:27]
ds_read_b64_tr_b16 a[32:33], v8 offset:57344
buffer_load_dwordx4 v[72:75], v6, s[12:15], s74 offen offset:0 sc1
v_mfma_f32_16x16x32_bf16 v[40:43], a[0:3], v[92:95], v[40:43]
ds_read_b64_tr_b16 a[34:35], v8 offset:59392
buffer_load_dwordx4 v[76:79], v19, s[12:15], s74 offen offset:0 sc1
v_mfma_f32_16x16x32_bf16 v[28:31], a[4:7], v[88:91], v[28:31]
ds_read_b64_tr_b16 a[36:37], v9 offset:57344
v_mfma_f32_16x16x32_bf16 v[44:47], a[4:7], v[92:95], v[44:47]
ds_read_b64_tr_b16 a[38:39], v9 offset:59392
buffer_load_dwordx4 v[80:83], v6, s[12:15], s74 offen offset:1024 sc1
v_mfma_f32_16x16x32_bf16 v[32:35], a[8:11], v[88:91], v[32:35]
ds_read_b64_tr_b16 a[40:41], v10 offset:57344
buffer_load_dwordx4 v[84:87], v19, s[12:15], s74 offen offset:1024 sc1
v_mfma_f32_16x16x32_bf16 v[48:51], a[8:11], v[92:95], v[48:51]
ds_read_b64_tr_b16 a[42:43], v10 offset:59392
v_mfma_f32_16x16x32_bf16 v[36:39], a[12:15], v[88:91], v[36:39]
ds_read_b64_tr_b16 a[44:45], v11 offset:57344
s_add_u32 s74, s74, 2048
v_mfma_f32_16x16x32_bf16 v[52:55], a[12:15], v[92:95], v[52:55]
ds_read_b64_tr_b16 a[46:47], v11 offset:59392
s_waitcnt lgkmcnt(8)
v_mfma_f32_16x16x32_bf16 v[24:27], a[16:19], v[96:99], v[24:27]
ds_read_b64_tr_b16 a[0:1], v8 offset:61440
s_and_b32 s74, s74, 0x7fff
v_mfma_f32_16x16x32_bf16 v[40:43], a[16:19], v[100:103], v[40:43]
ds_read_b64_tr_b16 a[2:3], v8 offset:63488
s_waitcnt vmcnt(8)
v_mfma_f32_16x16x32_bf16 v[28:31], a[20:23], v[96:99], v[28:31]
ds_read_b64_tr_b16 a[4:5], v9 offset:61440
v_mfma_f32_16x16x32_bf16 v[44:47], a[20:23], v[100:103], v[44:47]
ds_read_b64_tr_b16 a[6:7], v9 offset:63488
v_max3_u32 v2, v104, v108, v112
v_mfma_f32_16x16x32_bf16 v[32:35], a[24:27], v[96:99], v[32:35]
ds_read_b64_tr_b16 a[8:9], v10 offset:61440
v_max_u32 v2, v2, v116
v_mfma_f32_16x16x32_bf16 v[48:51], a[24:27], v[100:103], v[48:51]
ds_read_b64_tr_b16 a[10:11], v10 offset:63488
v_mfma_f32_16x16x32_bf16 v[36:39], a[28:31], v[96:99], v[36:39]
ds_read_b64_tr_b16 a[12:13], v11 offset:61440
v_cmp_eq_u32 vcc, -1, v2
v_mfma_f32_16x16x32_bf16 v[52:55], a[28:31], v[100:103], v[52:55]
ds_read_b64_tr_b16 a[14:15], v11 offset:63488
s_cbranch_vccnz L_o7_rt
L_o7_ok:
s_waitcnt lgkmcnt(8)
v_mfma_f32_16x16x32_bf16 v[24:27], a[32:35], v[104:107], v[24:27]
ds_read_b64_tr_b16 a[16:17], v12 offset:0
buffer_load_dwordx4 v[88:91], v6, s[12:15], s74 offen offset:0 sc1
v_mfma_f32_16x16x32_bf16 v[40:43], a[32:35], v[108:111], v[40:43]
ds_read_b64_tr_b16 a[18:19], v12 offset:2048
buffer_load_dwordx4 v[92:95], v19, s[12:15], s74 offen offset:0 sc1
v_mfma_f32_16x16x32_bf16 v[28:31], a[36:39], v[104:107], v[28:31]
ds_read_b64_tr_b16 a[20:21], v13 offset:0
v_mfma_f32_16x16x32_bf16 v[44:47], a[36:39], v[108:111], v[44:47]
ds_read_b64_tr_b16 a[22:23], v13 offset:2048
buffer_load_dwordx4 v[96:99], v6, s[12:15], s74 offen offset:1024 sc1
v_mfma_f32_16x16x32_bf16 v[32:35], a[40:43], v[104:107], v[32:35]
ds_read_b64_tr_b16 a[24:25], v14 offset:0
buffer_load_dwordx4 v[100:103], v19, s[12:15], s74 offen offset:1024 sc1
v_mfma_f32_16x16x32_bf16 v[48:51], a[40:43], v[108:111], v[48:51]
ds_read_b64_tr_b16 a[26:27], v14 offset:2048
v_mfma_f32_16x16x32_bf16 v[36:39], a[44:47], v[104:107], v[36:39]
ds_read_b64_tr_b16 a[28:29], v15 offset:0
s_add_u32 s74, s74, 2048
v_mfma_f32_16x16x32_bf16 v[52:55], a[44:47], v[108:111], v[52:55]
ds_read_b64_tr_b16 a[30:31], v15 offset:2048
s_waitcnt lgkmcnt(8)
v_mfma_f32_16x16x32_bf16 v[24:27], a[0:3], v[112:115], v[24:27]
ds_read_b64_tr_b16 a[32:33], v12 offset:4096
s_and_b32 s74, s74, 0x7fff
v_mfma_f32_16x16x32_bf16 v[40:43], a[0:3], v[116:119], v[40:43]
ds_read_b64_tr_b16 a[34:35], v12 offset:6144
s_waitcnt vmcnt(8)
v_mfma_f32_16x16x32_bf16 v[28:31], a[4:7], v[112:115], v[28:31]
ds_read_b64_tr_b16 a[36:37], v13 offset:4096
v_mfma_f32_16x16x32_bf16 v[44:47], a[4:7], v[116:119], v[44:47]
ds_read_b64_tr_b16 a[38:39], v13 offset:6144
v_max3_u32 v2, v56, v60, v64
v_mfma_f32_16x16x32_bf16 v[32:35], a[8:11], v[112:115], v[32:35]
ds_read_b64_tr_b16 a[40:41], v14 offset:4096
v_max_u32 v2, v2, v68
v_mfma_f32_16x16x32_bf16 v[48:51], a[8:11], v[116:119], v[48:51]
ds_read_b64_tr_b16 a[42:43], v14 offset:6144
v_mfma_f32_16x16x32_bf16 v[36:39], a[12:15], v[112:115], v[36:39]
ds_read_b64_tr_b16 a[44:45], v15 offset:4096
v_cmp_eq_u32 vcc, -1, v2
v_mfma_f32_16x16x32_bf16 v[52:55], a[12:15], v[116:119], v[52:55]
ds_read_b64_tr_b16 a[46:47], v15 offset:6144
s_cbranch_vccnz L_o8_rt
L_o8_ok:
s_waitcnt lgkmcnt(8)
v_mfma_f32_16x16x32_bf16 v[24:27], a[16:19], v[56:59], v[24:27]
ds_read_b64_tr_b16 a[0:1], v12 offset:8192
buffer_load_dwordx4 v[104:107], v6, s[12:15], s74 offen offset:0 sc1
v_mfma_f32_16x16x32_bf16 v[40:43], a[16:19], v[60:63], v[40:43]
ds_read_b64_tr_b16 a[2:3], v12 offset:10240
buffer_load_dwordx4 v[108:111], v19, s[12:15], s74 offen offset:0 sc1
v_mfma_f32_16x16x32_bf16 v[28:31], a[20:23], v[56:59], v[28:31]
ds_read_b64_tr_b16 a[4:5], v13 offset:8192
v_mfma_f32_16x16x32_bf16 v[44:47], a[20:23], v[60:63], v[44:47]
ds_read_b64_tr_b16 a[6:7], v13 offset:10240
buffer_load_dwordx4 v[112:115], v6, s[12:15], s74 offen offset:1024 sc1
v_mfma_f32_16x16x32_bf16 v[32:35], a[24:27], v[56:59], v[32:35]
ds_read_b64_tr_b16 a[8:9], v14 offset:8192
buffer_load_dwordx4 v[116:119], v19, s[12:15], s74 offen offset:1024 sc1
v_mfma_f32_16x16x32_bf16 v[48:51], a[24:27], v[60:63], v[48:51]
ds_read_b64_tr_b16 a[10:11], v14 offset:10240
v_mfma_f32_16x16x32_bf16 v[36:39], a[28:31], v[56:59], v[36:39]
ds_read_b64_tr_b16 a[12:13], v15 offset:8192
s_add_u32 s74, s74, 2048
v_mfma_f32_16x16x32_bf16 v[52:55], a[28:31], v[60:63], v[52:55]
ds_read_b64_tr_b16 a[14:15], v15 offset:10240
s_waitcnt lgkmcnt(8)
v_mfma_f32_16x16x32_bf16 v[24:27], a[32:35], v[64:67], v[24:27]
ds_read_b64_tr_b16 a[16:17], v12 offset:12288
s_and_b32 s74, s74, 0x7fff
v_mfma_f32_16x16x32_bf16 v[40:43], a[32:35], v[68:71], v[40:43]
ds_read_b64_tr_b16 a[18:19], v12 offset:14336
s_waitcnt vmcnt(8)
v_mfma_f32_16x16x32_bf16 v[28:31], a[36:39], v[64:67], v[28:31]
ds_read_b64_tr_b16 a[20:21], v13 offset:12288
v_mfma_f32_16x16x32_bf16 v[44:47], a[36:39], v[68:71], v[44:47]
ds_read_b64_tr_b16 a[22:23], v13 offset:14336
v_max3_u32 v2, v72, v76, v80
v_mfma_f32_16x16x32_bf16 v[32:35], a[40:43], v[64:67], v[32:35]
ds_read_b64_tr_b16 a[24:25], v14 offset:12288
v_max_u32 v2, v2, v84
v_mfma_f32_16x16x32_bf16 v[48:51], a[40:43], v[68:71], v[48:51]
ds_read_b64_tr_b16 a[26:27], v14 offset:14336
v_mfma_f32_16x16x32_bf16 v[36:39], a[44:47], v[64:67], v[36:39]
ds_read_b64_tr_b16 a[28:29], v15 offset:12288
v_cmp_eq_u32 vcc, -1, v2
v_mfma_f32_16x16x32_bf16 v[52:55], a[44:47], v[68:71], v[52:55]
ds_read_b64_tr_b16 a[30:31], v15 offset:14336
s_cbranch_vccnz L_o9_rt
L_o9_ok:
s_waitcnt lgkmcnt(8)
v_mfma_f32_16x16x32_bf16 v[24:27], a[0:3], v[72:75], v[24:27]
ds_read_b64_tr_b16 a[32:33], v12 offset:16384
buffer_load_dwordx4 v[56:59], v6, s[12:15], s74 offen offset:0 sc1
v_mfma_f32_16x16x32_bf16 v[40:43], a[0:3], v[76:79], v[40:43]
ds_read_b64_tr_b16 a[34:35], v12 offset:18432
buffer_load_dwordx4 v[60:63], v19, s[12:15], s74 offen offset:0 sc1
v_mfma_f32_16x16x32_bf16 v[28:31], a[4:7], v[72:75], v[28:31]
ds_read_b64_tr_b16 a[36:37], v13 offset:16384
v_mfma_f32_16x16x32_bf16 v[44:47], a[4:7], v[76:79], v[44:47]
ds_read_b64_tr_b16 a[38:39], v13 offset:18432
buffer_load_dwordx4 v[64:67], v6, s[12:15], s74 offen offset:1024 sc1
v_mfma_f32_16x16x32_bf16 v[32:35], a[8:11], v[72:75], v[32:35]
ds_read_b64_tr_b16 a[40:41], v14 offset:16384
buffer_load_dwordx4 v[68:71], v19, s[12:15], s74 offen offset:1024 sc1
v_mfma_f32_16x16x32_bf16 v[48:51], a[8:11], v[76:79], v[48:51]
ds_read_b64_tr_b16 a[42:43], v14 offset:18432
v_mfma_f32_16x16x32_bf16 v[36:39], a[12:15], v[72:75], v[36:39]
ds_read_b64_tr_b16 a[44:45], v15 offset:16384
s_add_u32 s74, s74, 2048
v_mfma_f32_16x16x32_bf16 v[52:55], a[12:15], v[76:79], v[52:55]
ds_read_b64_tr_b16 a[46:47], v15 offset:18432
s_waitcnt lgkmcnt(8)
v_mfma_f32_16x16x32_bf16 v[24:27], a[16:19], v[80:83], v[24:27]
ds_read_b64_tr_b16 a[0:1], v12 offset:20480
s_and_b32 s74, s74, 0x7fff
v_mfma_f32_16x16x32_bf16 v[40:43], a[16:19], v[84:87], v[40:43]
ds_read_b64_tr_b16 a[2:3], v12 offset:22528
s_waitcnt vmcnt(8)
v_mfma_f32_16x16x32_bf16 v[28:31], a[20:23], v[80:83], v[28:31]
ds_read_b64_tr_b16 a[4:5], v13 offset:20480
v_mfma_f32_16x16x32_bf16 v[44:47], a[20:23], v[84:87], v[44:47]
ds_read_b64_tr_b16 a[6:7], v13 offset:22528
v_max3_u32 v2, v88, v92, v96
v_mfma_f32_16x16x32_bf16 v[32:35], a[24:27], v[80:83], v[32:35]
ds_read_b64_tr_b16 a[8:9], v14 offset:20480
v_max_u32 v2, v2, v100
v_mfma_f32_16x16x32_bf16 v[48:51], a[24:27], v[84:87], v[48:51]
ds_read_b64_tr_b16 a[10:11], v14 offset:22528
v_mfma_f32_16x16x32_bf16 v[36:39], a[28:31], v[80:83], v[36:39]
ds_read_b64_tr_b16 a[12:13], v15 offset:20480
v_cmp_eq_u32 vcc, -1, v2
v_mfma_f32_16x16x32_bf16 v[52:55], a[28:31], v[84:87], v[52:55]
ds_read_b64_tr_b16 a[14:15], v15 offset:22528
s_cbranch_vccnz L_o10_rt
L_o10_ok:
s_waitcnt lgkmcnt(8)
v_mfma_f32_16x16x32_bf16 v[24:27], a[32:35], v[88:91], v[24:27]
ds_read_b64_tr_b16 a[16:17], v12 offset:24576
buffer_load_dwordx4 v[72:75], v6, s[12:15], s74 offen offset:0 sc1
v_mfma_f32_16x16x32_bf16 v[40:43], a[32:35], v[92:95], v[40:43]
ds_read_b64_tr_b16 a[18:19], v12 offset:26624
buffer_load_dwordx4 v[76:79], v19, s[12:15], s74 offen offset:0 sc1
v_mfma_f32_16x16x32_bf16 v[28:31], a[36:39], v[88:91], v[28:31]
ds_read_b64_tr_b16 a[20:21], v13 offset:24576
v_mfma_f32_16x16x32_bf16 v[44:47], a[36:39], v[92:95], v[44:47]
ds_read_b64_tr_b16 a[22:23], v13 offset:26624
buffer_load_dwordx4 v[80:83], v6, s[12:15], s74 offen offset:1024 sc1
v_mfma_f32_16x16x32_bf16 v[32:35], a[40:43], v[88:91], v[32:35]
ds_read_b64_tr_b16 a[24:25], v14 offset:24576
buffer_load_dwordx4 v[84:87], v19, s[12:15], s74 offen offset:1024 sc1
v_mfma_f32_16x16x32_bf16 v[48:51], a[40:43], v[92:95], v[48:51]
ds_read_b64_tr_b16 a[26:27], v14 offset:26624
v_mfma_f32_16x16x32_bf16 v[36:39], a[44:47], v[88:91], v[36:39]
ds_read_b64_tr_b16 a[28:29], v15 offset:24576
s_add_u32 s74, s74, 2048
v_mfma_f32_16x16x32_bf16 v[52:55], a[44:47], v[92:95], v[52:55]
ds_read_b64_tr_b16 a[30:31], v15 offset:26624
s_waitcnt lgkmcnt(8)
v_mfma_f32_16x16x32_bf16 v[24:27], a[0:3], v[96:99], v[24:27]
ds_read_b64_tr_b16 a[32:33], v12 offset:28672
s_and_b32 s74, s74, 0x7fff
v_mfma_f32_16x16x32_bf16 v[40:43], a[0:3], v[100:103], v[40:43]
ds_read_b64_tr_b16 a[34:35], v12 offset:30720
s_waitcnt vmcnt(8)
v_mfma_f32_16x16x32_bf16 v[28:31], a[4:7], v[96:99], v[28:31]
ds_read_b64_tr_b16 a[36:37], v13 offset:28672
v_mfma_f32_16x16x32_bf16 v[44:47], a[4:7], v[100:103], v[44:47]
ds_read_b64_tr_b16 a[38:39], v13 offset:30720
v_max3_u32 v2, v104, v108, v112
v_mfma_f32_16x16x32_bf16 v[32:35], a[8:11], v[96:99], v[32:35]
ds_read_b64_tr_b16 a[40:41], v14 offset:28672
v_max_u32 v2, v2, v116
v_mfma_f32_16x16x32_bf16 v[48:51], a[8:11], v[100:103], v[48:51]
ds_read_b64_tr_b16 a[42:43], v14 offset:30720
v_mfma_f32_16x16x32_bf16 v[36:39], a[12:15], v[96:99], v[36:39]
ds_read_b64_tr_b16 a[44:45], v15 offset:28672
v_cmp_eq_u32 vcc, -1, v2
v_mfma_f32_16x16x32_bf16 v[52:55], a[12:15], v[100:103], v[52:55]
ds_read_b64_tr_b16 a[46:47], v15 offset:30720
s_cbranch_vccnz L_o11_rt
L_o11_ok:
s_waitcnt lgkmcnt(8)
v_mfma_f32_16x16x32_bf16 v[24:27], a[16:19], v[104:107], v[24:27]
ds_read_b64_tr_b16 a[0:1], v12 offset:32768
buffer_load_dwordx4 v[88:91], v6, s[12:15], s74 offen offset:0 sc1
v_mfma_f32_16x16x32_bf16 v[40:43], a[16:19], v[108:111], v[40:43]
ds_read_b64_tr_b16 a[2:3], v12 offset:34816
buffer_load_dwordx4 v[92:95], v19, s[12:15], s74 offen offset:0 sc1
v_mfma_f32_16x16x32_bf16 v[28:31], a[20:23], v[104:107], v[28:31]
ds_read_b64_tr_b16 a[4:5], v13 offset:32768
v_mfma_f32_16x16x32_bf16 v[44:47], a[20:23], v[108:111], v[44:47]
ds_read_b64_tr_b16 a[6:7], v13 offset:34816
buffer_load_dwordx4 v[96:99], v6, s[12:15], s74 offen offset:1024 sc1
v_mfma_f32_16x16x32_bf16 v[32:35], a[24:27], v[104:107], v[32:35]
ds_read_b64_tr_b16 a[8:9], v14 offset:32768
buffer_load_dwordx4 v[100:103], v19, s[12:15], s74 offen offset:1024 sc1
v_mfma_f32_16x16x32_bf16 v[48:51], a[24:27], v[108:111], v[48:51]
ds_read_b64_tr_b16 a[10:11], v14 offset:34816
v_mfma_f32_16x16x32_bf16 v[36:39], a[28:31], v[104:107], v[36:39]
ds_read_b64_tr_b16 a[12:13], v15 offset:32768
s_add_u32 s74, s74, 2048
v_mfma_f32_16x16x32_bf16 v[52:55], a[28:31], v[108:111], v[52:55]
ds_read_b64_tr_b16 a[14:15], v15 offset:34816
s_waitcnt lgkmcnt(8)
v_mfma_f32_16x16x32_bf16 v[24:27], a[32:35], v[112:115], v[24:27]
ds_read_b64_tr_b16 a[16:17], v12 offset:36864
s_and_b32 s74, s74, 0x7fff
v_mfma_f32_16x16x32_bf16 v[40:43], a[32:35], v[116:119], v[40:43]
ds_read_b64_tr_b16 a[18:19], v12 offset:38912
s_waitcnt vmcnt(8)
v_mfma_f32_16x16x32_bf16 v[28:31], a[36:39], v[112:115], v[28:31]
ds_read_b64_tr_b16 a[20:21], v13 offset:36864
v_mfma_f32_16x16x32_bf16 v[44:47], a[36:39], v[116:119], v[44:47]
ds_read_b64_tr_b16 a[22:23], v13 offset:38912
v_max3_u32 v2, v56, v60, v64
v_mfma_f32_16x16x32_bf16 v[32:35], a[40:43], v[112:115], v[32:35]
ds_read_b64_tr_b16 a[24:25], v14 offset:36864
v_max_u32 v2, v2, v68
v_mfma_f32_16x16x32_bf16 v[48:51], a[40:43], v[116:119], v[48:51]
ds_read_b64_tr_b16 a[26:27], v14 offset:38912
v_mfma_f32_16x16x32_bf16 v[36:39], a[44:47], v[112:115], v[36:39]
ds_read_b64_tr_b16 a[28:29], v15 offset:36864
v_cmp_eq_u32 vcc, -1, v2
v_mfma_f32_16x16x32_bf16 v[52:55], a[44:47], v[116:119], v[52:55]
ds_read_b64_tr_b16 a[30:31], v15 offset:38912
s_cbranch_vccnz L_o12_rt
L_o12_ok:
s_waitcnt lgkmcnt(8)
v_mfma_f32_16x16x32_bf16 v[24:27], a[0:3], v[56:59], v[24:27]
ds_read_b64_tr_b16 a[32:33], v12 offset:40960
buffer_load_dwordx4 v[104:107], v6, s[12:15], s74 offen offset:0 sc1
v_mfma_f32_16x16x32_bf16 v[40:43], a[0:3], v[60:63], v[40:43]
ds_read_b64_tr_b16 a[34:35], v12 offset:43008
v_mfma_f32_16x16x32_bf16 v[28:31], a[4:7], v[56:59], v[28:31]
ds_read_b64_tr_b16 a[36:37], v13 offset:40960
buffer_load_dwordx4 v[108:111], v19, s[12:15], s74 offen offset:0 sc1
v_mfma_f32_16x16x32_bf16 v[44:47], a[4:7], v[60:63], v[44:47]
ds_read_b64_tr_b16 a[38:39], v13 offset:43008
v_mfma_f32_16x16x32_bf16 v[32:35], a[8:11], v[56:59], v[32:35]
ds_read_b64_tr_b16 a[40:41], v14 offset:40960
buffer_load_dwordx4 v[112:115], v6, s[12:15], s74 offen offset:1024 sc1
v_mfma_f32_16x16x32_bf16 v[48:51], a[8:11], v[60:63], v[48:51]
ds_read_b64_tr_b16 a[42:43], v14 offset:43008
v_mfma_f32_16x16x32_bf16 v[36:39], a[12:15], v[56:59], v[36:39]
ds_read_b64_tr_b16 a[44:45], v15 offset:40960
buffer_load_dwordx4 v[116:119], v19, s[12:15], s74 offen offset:1024 sc1
v_mfma_f32_16x16x32_bf16 v[52:55], a[12:15], v[60:63], v[52:55]
ds_read_b64_tr_b16 a[46:47], v15 offset:43008
s_waitcnt lgkmcnt(8)
v_mfma_f32_16x16x32_bf16 v[24:27], a[16:19], v[64:67], v[24:27]
ds_read_b64_tr_b16 a[0:1], v12 offset:45056
s_waitcnt vmcnt(8)
v_mfma_f32_16x16x32_bf16 v[40:43], a[16:19], v[68:71], v[40:43]
ds_read_b64_tr_b16 a[2:3], v12 offset:47104
v_mfma_f32_16x16x32_bf16 v[28:31], a[20:23], v[64:67], v[28:31]
ds_read_b64_tr_b16 a[4:5], v13 offset:45056
v_max3_u32 v2, v72, v76, v80
v_mfma_f32_16x16x32_bf16 v[44:47], a[20:23], v[68:71], v[44:47]
ds_read_b64_tr_b16 a[6:7], v13 offset:47104
v_mfma_f32_16x16x32_bf16 v[32:35], a[24:27], v[64:67], v[32:35]
ds_read_b64_tr_b16 a[8:9], v14 offset:45056
v_max_u32 v2, v2, v84
v_mfma_f32_16x16x32_bf16 v[48:51], a[24:27], v[68:71], v[48:51]
ds_read_b64_tr_b16 a[10:11], v14 offset:47104
v_mfma_f32_16x16x32_bf16 v[36:39], a[28:31], v[64:67], v[36:39]
ds_read_b64_tr_b16 a[12:13], v15 offset:45056
v_cmp_eq_u32 vcc, -1, v2
v_mfma_f32_16x16x32_bf16 v[52:55], a[28:31], v[68:71], v[52:55]
ds_read_b64_tr_b16 a[14:15], v15 offset:47104
s_cbranch_vccnz L_o13_rt
L_o13_ok:
s_waitcnt lgkmcnt(8)
v_mfma_f32_16x16x32_bf16 v[24:27], a[32:35], v[72:75], v[24:27]
ds_read_b64_tr_b16 a[16:17], v12 offset:49152
s_waitcnt vmcnt(4)
v_mfma_f32_16x16x32_bf16 v[40:43], a[32:35], v[76:79], v[40:43]
ds_read_b64_tr_b16 a[18:19], v12 offset:51200
v_mfma_f32_16x16x32_bf16 v[28:31], a[36:39], v[72:75], v[28:31]
ds_read_b64_tr_b16 a[20:21], v13 offset:49152
v_mfma_f32_16x16x32_bf16 v[44:47], a[36:39], v[76:79], v[44:47]
ds_read_b64_tr_b16 a[22:23], v13 offset:51200
v_mfma_f32_16x16x32_bf16 v[32:35], a[40:43], v[72:75], v[32:35]
ds_read_b64_tr_b16 a[24:25], v14 offset:49152
v_max3_u32 v2, v88, v92, v96
v_mfma_f32_16x16x32_bf16 v[48:51], a[40:43], v[76:79], v[48:51]
ds_read_b64_tr_b16 a[26:27], v14 offset:51200
v_mfma_f32_16x16x32_bf16 v[36:39], a[44:47], v[72:75], v[36:39]
ds_read_b64_tr_b16 a[28:29], v15 offset:49152
v_mfma_f32_16x16x32_bf16 v[52:55], a[44:47], v[76:79], v[52:55]
ds_read_b64_tr_b16 a[30:31], v15 offset:51200
s_waitcnt lgkmcnt(8)
v_mfma_f32_16x16x32_bf16 v[24:27], a[0:3], v[80:83], v[24:27]
ds_read_b64_tr_b16 a[32:33], v12 offset:53248
v_max_u32 v2, v2, v100
v_mfma_f32_16x16x32_bf16 v[40:43], a[0:3], v[84:87], v[40:43]
ds_read_b64_tr_b16 a[34:35], v12 offset:55296
v_mfma_f32_16x16x32_bf16 v[28:31], a[4:7], v[80:83], v[28:31]
ds_read_b64_tr_b16 a[36:37], v13 offset:53248
v_mfma_f32_16x16x32_bf16 v[44:47], a[4:7], v[84:87], v[44:47]
ds_read_b64_tr_b16 a[38:39], v13 offset:55296
v_mfma_f32_16x16x32_bf16 v[32:35], a[8:11], v[80:83], v[32:35]
ds_read_b64_tr_b16 a[40:41], v14 offset:53248
v_cmp_eq_u32 vcc, -1, v2
v_mfma_f32_16x16x32_bf16 v[48:51], a[8:11], v[84:87], v[48:51]
ds_read_b64_tr_b16 a[42:43], v14 offset:55296
v_mfma_f32_16x16x32_bf16 v[36:39], a[12:15], v[80:83], v[36:39]
ds_read_b64_tr_b16 a[44:45], v15 offset:53248
v_mfma_f32_16x16x32_bf16 v[52:55], a[12:15], v[84:87], v[52:55]
ds_read_b64_tr_b16 a[46:47], v15 offset:55296
s_cbranch_vccnz L_o14_rt
L_o14_ok:
s_waitcnt lgkmcnt(8)
v_mfma_f32_16x16x32_bf16 v[24:27], a[16:19], v[88:91], v[24:27]
ds_read_b64_tr_b16 a[0:1], v12 offset:57344
s_waitcnt vmcnt(0)
v_mfma_f32_16x16x32_bf16 v[40:43], a[16:19], v[92:95], v[40:43]
ds_read_b64_tr_b16 a[2:3], v12 offset:59392
v_mfma_f32_16x16x32_bf16 v[28:31], a[20:23], v[88:91], v[28:31]
ds_read_b64_tr_b16 a[4:5], v13 offset:57344
v_mfma_f32_16x16x32_bf16 v[44:47], a[20:23], v[92:95], v[44:47]
ds_read_b64_tr_b16 a[6:7], v13 offset:59392
v_mfma_f32_16x16x32_bf16 v[32:35], a[24:27], v[88:91], v[32:35]
ds_read_b64_tr_b16 a[8:9], v14 offset:57344
v_max3_u32 v2, v104, v108, v112
v_mfma_f32_16x16x32_bf16 v[48:51], a[24:27], v[92:95], v[48:51]
ds_read_b64_tr_b16 a[10:11], v14 offset:59392
v_mfma_f32_16x16x32_bf16 v[36:39], a[28:31], v[88:91], v[36:39]
ds_read_b64_tr_b16 a[12:13], v15 offset:57344
v_mfma_f32_16x16x32_bf16 v[52:55], a[28:31], v[92:95], v[52:55]
ds_read_b64_tr_b16 a[14:15], v15 offset:59392
s_waitcnt lgkmcnt(8)
v_mfma_f32_16x16x32_bf16 v[24:27], a[32:35], v[96:99], v[24:27]
ds_read_b64_tr_b16 a[16:17], v12 offset:61440
v_max_u32 v2, v2, v116
v_mfma_f32_16x16x32_bf16 v[40:43], a[32:35], v[100:103], v[40:43]
ds_read_b64_tr_b16 a[18:19], v12 offset:63488
v_mfma_f32_16x16x32_bf16 v[28:31], a[36:39], v[96:99], v[28:31]
ds_read_b64_tr_b16 a[20:21], v13 offset:61440
v_mfma_f32_16x16x32_bf16 v[44:47], a[36:39], v[100:103], v[44:47]
ds_read_b64_tr_b16 a[22:23], v13 offset:63488
v_mfma_f32_16x16x32_bf16 v[32:35], a[40:43], v[96:99], v[32:35]
ds_read_b64_tr_b16 a[24:25], v14 offset:61440
v_cmp_eq_u32 vcc, -1, v2
v_mfma_f32_16x16x32_bf16 v[48:51], a[40:43], v[100:103], v[48:51]
ds_read_b64_tr_b16 a[26:27], v14 offset:63488
v_mfma_f32_16x16x32_bf16 v[36:39], a[44:47], v[96:99], v[36:39]
ds_read_b64_tr_b16 a[28:29], v15 offset:61440
v_mfma_f32_16x16x32_bf16 v[52:55], a[44:47], v[100:103], v[52:55]
ds_read_b64_tr_b16 a[30:31], v15 offset:63488
s_cbranch_vccnz L_o15_rt
L_o15_ok:
s_waitcnt lgkmcnt(8)
v_mfma_f32_16x16x32_bf16 v[24:27], a[0:3], v[104:107], v[24:27]
v_mfma_f32_16x16x32_bf16 v[40:43], a[0:3], v[108:111], v[40:43]
v_mfma_f32_16x16x32_bf16 v[28:31], a[4:7], v[104:107], v[28:31]
v_mfma_f32_16x16x32_bf16 v[44:47], a[4:7], v[108:111], v[44:47]
v_mfma_f32_16x16x32_bf16 v[32:35], a[8:11], v[104:107], v[32:35]
v_mfma_f32_16x16x32_bf16 v[48:51], a[8:11], v[108:111], v[48:51]
v_mfma_f32_16x16x32_bf16 v[36:39], a[12:15], v[104:107], v[36:39]
v_mfma_f32_16x16x32_bf16 v[52:55], a[12:15], v[108:111], v[52:55]
s_waitcnt lgkmcnt(0)
v_mfma_f32_16x16x32_bf16 v[24:27], a[16:19], v[112:115], v[24:27]
v_mfma_f32_16x16x32_bf16 v[40:43], a[16:19], v[116:119], v[40:43]
v_mfma_f32_16x16x32_bf16 v[28:31], a[20:23], v[112:115], v[28:31]
v_mfma_f32_16x16x32_bf16 v[44:47], a[20:23], v[116:119], v[44:47]
v_mfma_f32_16x16x32_bf16 v[32:35], a[24:27], v[112:115], v[32:35]
v_mfma_f32_16x16x32_bf16 v[48:51], a[24:27], v[116:119], v[48:51]
v_mfma_f32_16x16x32_bf16 v[36:39], a[28:31], v[112:115], v[36:39]
v_mfma_f32_16x16x32_bf16 v[52:55], a[28:31], v[116:119], v[52:55]
s_barrier
v_accvgpr_read_b32 v88, a96
v_accvgpr_read_b32 v89, a97
v_accvgpr_read_b32 v90, a98
v_accvgpr_read_b32 v91, a99
v_accvgpr_read_b32 v92, a100
v_accvgpr_read_b32 v93, a101
v_accvgpr_read_b32 v94, a102
v_accvgpr_read_b32 v95, a103
v_lshlrev_b32 v56, 16, v88
v_and_b32 v57, 0xffff0000, v88
v_lshlrev_b32 v58, 16, v89
v_and_b32 v59, 0xffff0000, v89
v_lshlrev_b32 v60, 16, v90
v_and_b32 v61, 0xffff0000, v90
v_lshlrev_b32 v62, 16, v91
v_and_b32 v63, 0xffff0000, v91
v_lshlrev_b32 v64, 16, v92
v_and_b32 v65, 0xffff0000, v92
v_lshlrev_b32 v66, 16, v93
v_and_b32 v67, 0xffff0000, v93
v_lshlrev_b32 v68, 16, v94
v_and_b32 v69, 0xffff0000, v94
v_lshlrev_b32 v70, 16, v95
v_and_b32 v71, 0xffff0000, v95
v_pk_add_f32 v[72:73], v[24:25], v[26:27]
v_pk_mul_f32 v[74:75], v[24:25], v[24:25]
v_pk_mul_f32 v[76:77], v[24:25], v[56:57]
v_pk_fma_f32 v[74:75], v[26:27], v[26:27], v[74:75]
v_pk_fma_f32 v[76:77], v[26:27], v[58:59], v[76:77]
v_pk_add_f32 v[72:73], v[72:73], v[28:29]
v_pk_fma_f32 v[74:75], v[28:29], v[28:29], v[74:75]
v_pk_fma_f32 v[76:77], v[28:29], v[60:61], v[76:77]
v_pk_add_f32 v[72:73], v[72:73], v[30:31]
v_pk_fma_f32 v[74:75], v[30:31], v[30:31], v[74:75]
v_pk_fma_f32 v[76:77], v[30:31], v[62:63], v[76:77]
v_pk_add_f32 v[72:73], v[72:73], v[32:33]
v_pk_fma_f32 v[74:75], v[32:33], v[32:33], v[74:75]
v_pk_fma_f32 v[76:77], v[32:33], v[64:65], v[76:77]
v_pk_add_f32 v[72:73], v[72:73], v[34:35]
v_pk_fma_f32 v[74:75], v[34:35], v[34:35], v[74:75]
v_pk_fma_f32 v[76:77], v[34:35], v[66:67], v[76:77]
v_pk_add_f32 v[72:73], v[72:73], v[36:37]
v_pk_fma_f32 v[74:75], v[36:37], v[36:37], v[74:75]
v_pk_fma_f32 v[76:77], v[36:37], v[68:69], v[76:77]
v_pk_add_f32 v[72:73], v[72:73], v[38:39]
v_pk_fma_f32 v[74:75], v[38:39], v[38:39], v[74:75]
v_pk_fma_f32 v[76:77], v[38:39], v[70:71], v[76:77]
v_add_f32 v72, v72, v73
v_add_f32 v73, v74, v75
v_add_f32 v74, v76, v77
v_pk_add_f32 v[80:81], v[40:41], v[42:43]
v_pk_mul_f32 v[82:83], v[40:41], v[40:41]
v_pk_mul_f32 v[84:85], v[40:41], v[56:57]
v_pk_fma_f32 v[82:83], v[42:43], v[42:43], v[82:83]
v_pk_fma_f32 v[84:85], v[42:43], v[58:59], v[84:85]
v_pk_add_f32 v[80:81], v[80:81], v[44:45]
v_pk_fma_f32 v[82:83], v[44:45], v[44:45], v[82:83]
v_pk_fma_f32 v[84:85], v[44:45], v[60:61], v[84:85]
v_pk_add_f32 v[80:81], v[80:81], v[46:47]
v_pk_fma_f32 v[82:83], v[46:47], v[46:47], v[82:83]
v_pk_fma_f32 v[84:85], v[46:47], v[62:63], v[84:85]
v_pk_add_f32 v[80:81], v[80:81], v[48:49]
v_pk_fma_f32 v[82:83], v[48:49], v[48:49], v[82:83]
v_pk_fma_f32 v[84:85], v[48:49], v[64:65], v[84:85]
v_pk_add_f32 v[80:81], v[80:81], v[50:51]
v_pk_fma_f32 v[82:83], v[50:51], v[50:51], v[82:83]
v_pk_fma_f32 v[84:85], v[50:51], v[66:67], v[84:85]
v_pk_add_f32 v[80:81], v[80:81], v[52:53]
v_pk_fma_f32 v[82:83], v[52:53], v[52:53], v[82:83]
v_pk_fma_f32 v[84:85], v[52:53], v[68:69], v[84:85]
v_pk_add_f32 v[80:81], v[80:81], v[54:55]
v_pk_fma_f32 v[82:83], v[54:55], v[54:55], v[82:83]
v_pk_fma_f32 v[84:85], v[54:55], v[70:71], v[84:85]
v_add_f32 v80, v80, v81
v_add_f32 v81, v82, v83
v_add_f32 v82, v84, v85
v_permlane32_swap_b32 v72, v80
v_permlane32_swap_b32 v73, v81
v_permlane32_swap_b32 v74, v82
v_add_f32 v72, v72, v80
v_add_f32 v73, v73, v81
v_add_f32 v74, v74, v82
v_mov_b32 v80, v72
v_mov_b32 v81, v73
v_mov_b32 v82, v74
v_permlane16_swap_b32 v72, v80
v_permlane16_swap_b32 v73, v81
v_permlane16_swap_b32 v74, v82
v_add_f32 v72, v72, v80
v_add_f32 v73, v73, v81
v_add_f32 v74, v74, v82
v_mov_b32 v75, s68
v_and_b32 v2, 15, v1
v_lshrrev_b32 v3, 5, v1
v_lshlrev_b32 v4, 4, v2
v_lshl_add_u32 v4, v3, 8, v4
s_lshl_b32 s75, s64, 15
s_lshl_b32 s70, s60, 9
s_add_u32 s75, s75, s70
s_add_u32 s75, s75, 6291456
s_lshl_b32 s70, s65, 11
s_add_u32 s72, s75, s70
s_mov_b32 s92, 0xffff
s_mov_b32 s93, 0xffff
s_mov_b64 exec, s[92:93]
s_cmp_eq_u32 s69, 0
s_cbranch_scc1 L_stp_s
buffer_store_dwordx4 v[72:75], v4, s[12:15], s72 offen
L_stp_d:
s_mov_b64 exec, -1
v_and_b32 v2, 31, v1
v_lshlrev_b32 v5, 4, v2
v_lshl_add_u32 v5, v3, 11, v5
s_add_u32 s70, s75, 0
buffer_load_dwordx4 v[96:99], v5, s[12:15], s70 offen sc1
s_add_u32 s70, s75, 4096
buffer_load_dwordx4 v[100:103], v5, s[12:15], s70 offen sc1
s_add_u32 s70, s75, 8192
buffer_load_dwordx4 v[104:107], v5, s[12:15], s70 offen sc1
s_add_u32 s70, s75, 12288
buffer_load_dwordx4 v[108:111], v5, s[12:15], s70 offen sc1
s_add_u32 s70, s75, 16384
buffer_load_dwordx4 v[112:115], v5, s[12:15], s70 offen sc1
s_add_u32 s70, s75, 20480
buffer_load_dwordx4 v[116:119], v5, s[12:15], s70 offen sc1
s_add_u32 s70, s75, 24576
buffer_load_dwordx4 v[120:123], v5, s[12:15], s70 offen sc1
s_add_u32 s70, s75, 28672
buffer_load_dwordx4 v[124:127], v5, s[12:15], s70 offen sc1
v_cvt_pk_bf16_f32 v128, v24, v25
v_cvt_pk_bf16_f32 v129, v26, v27
ds_write_b64 v20, v[128:129] offset:0
v_cvt_pk_bf16_f32 v130, v28, v29
v_cvt_pk_bf16_f32 v131, v30, v31
ds_write_b64 v21, v[130:131] offset:0
v_cvt_pk_bf16_f32 v132, v32, v33
v_cvt_pk_bf16_f32 v133, v34, v35
ds_write_b64 v22, v[132:133] offset:0
v_cvt_pk_bf16_f32 v134, v36, v37
v_cvt_pk_bf16_f32 v135, v38, v39
ds_write_b64 v23, v[134:135] offset:0
v_cvt_pk_bf16_f32 v136, v40, v41
v_cvt_pk_bf16_f32 v137, v42, v43
ds_write_b64 v20, v[136:137] offset:2048
v_cvt_pk_bf16_f32 v138, v44, v45
v_cvt_pk_bf16_f32 v139, v46, v47
ds_write_b64 v21, v[138:139] offset:2048
v_cvt_pk_bf16_f32 v140, v48, v49
v_cvt_pk_bf16_f32 v141, v50, v51
ds_write_b64 v22, v[140:141] offset:2048
v_cvt_pk_bf16_f32 v142, v52, v53
v_cvt_pk_bf16_f32 v143, v54, v55
ds_write_b64 v23, v[142:143] offset:2048
s_lshl_b32 s70, s64, 7
s_lshl_b32 s71, s60, 5
s_add_u32 s70, s70, s71
s_sub_u32 s70, 2047, s70
v_sub_u32 v6, s70, v2
s_lshl_b32 s70, s60, 9
s_add_u32 s70, s70, 49152
v_lshlrev_b32 v7, 4, v2
v_add_u32 v7, s70, v7
s_waitcnt vmcnt(0)
L_st_chk:
v_xor_b32 v88, s68, v99
v_xor_b32 v89, s68, v103
v_xor_b32 v90, s68, v107
v_xor_b32 v91, s68, v111
v_xor_b32 v92, s68, v115
v_xor_b32 v93, s68, v119
v_xor_b32 v94, s68, v123
v_xor_b32 v95, s68, v127
v_or3_b32 v88, v88, v89, v90
v_or3_b32 v91, v91, v92, v93
v_or3_b32 v88, v88, v94, v95
v_or_b32 v88, v88, v91
v_cmp_ne_u32 vcc, 0, v88
s_cbranch_vccnz L_st_rt
L_st_ok:
v_pk_add_f32 v[96:97], v[96:97], v[100:101]
v_add_f32 v98, v98, v102
v_pk_add_f32 v[104:105], v[104:105], v[108:109]
v_add_f32 v106, v106, v110
v_pk_add_f32 v[112:113], v[112:113], v[116:117]
v_add_f32 v114, v114, v118
v_pk_add_f32 v[120:121], v[120:121], v[124:125]
v_add_f32 v122, v122, v126
v_pk_add_f32 v[96:97], v[96:97], v[104:105]
v_add_f32 v98, v98, v106
v_pk_add_f32 v[112:113], v[112:113], v[120:121]
v_add_f32 v114, v114, v122
v_pk_add_f32 v[96:97], v[96:97], v[112:113]
v_add_f32 v98, v98, v114
v_mov_b32 v100, v96
v_mov_b32 v101, v97
v_mov_b32 v102, v98
v_permlane32_swap_b32 v96, v100
v_permlane32_swap_b32 v97, v101
v_permlane32_swap_b32 v98, v102
v_add_f32 v96, v96, v100
v_add_f32 v97, v97, v101
v_add_f32 v98, v98, v102
v_mul_f32 v73, 0x3a800000, v96
v_mul_f32 v97, 0x3a800000, v97
v_fma_f32 v97, -v73, v73, v97
v_fma_f32 v98, -v73, s84, v98
v_max_f32 v97, 0, v97
v_add_f32 v97, 0x3727c5ac, v97
v_rsq_f32 v74, v97
v_mov_b32 v75, s68
v_mul_f32 v98, v98, v74
v_ashrrev_i32 v99, 31, v98
v_or_b32 v99, 0x80000000, v99
v_xor_b32 v98, v98, v99
s_mov_b32 s70, 0xfffff800
v_and_or_b32 v72, v98, s70, v6
ds_write_b128 v7, v[72:75]
s_nop 0
v_mov_b32_dpp v78, v72 row_ror:1 row_mask:0xf bank_mask:0xf
v_max_u32 v76, v72, v78
v_min_u32 v77, v72, v78
s_nop 0
v_mov_b32_dpp v78, v76 row_ror:2 row_mask:0xf bank_mask:0xf
v_max_u32_dpp v79, v77, v77 row_ror:2 row_mask:0xf bank_mask:0xf
v_med3_u32 v77, v76, v78, v79
v_max_u32 v76, v76, v78
s_nop 1
v_mov_b32_dpp v78, v76 row_ror:4 row_mask:0xf bank_mask:0xf
v_max_u32_dpp v79, v77, v77 row_ror:4 row_mask:0xf bank_mask:0xf
v_med3_u32 v77, v76, v78, v79
v_max_u32 v76, v76, v78
s_nop 1
v_mov_b32_dpp v78, v76 row_ror:8 row_mask:0xf bank_mask:0xf
v_max_u32_dpp v79, v77, v77 row_ror:8 row_mask:0xf bank_mask:0xf
v_med3_u32 v77, v76, v78, v79
v_max_u32 v76, v76, v78
v_mov_b32 v78, v76
v_mov_b32 v79, v77
s_nop 0
v_permlane16_swap_b32 v76, v78
v_permlane16_swap_b32 v77, v79
v_max_u32 v79, v77, v79
v_med3_u32 v77, v76, v78, v79
v_max_u32 v76, v76, v78
s_lshl_b32 s70, s60, 3
s_add_u32 s70, s70, 161792
v_mov_b32 v2, s70
ds_write_b64 v2, v[76:77]
v_mov_b32 v2, 161792
v_add_f32 v80, 1.0, v74
v_mul_f32_e64 v56, -v73, v74
v_mov_b32 v82, v80
v_mov_b32 v58, v56
s_nop 0
v_permlane16_swap_b32 v80, v82
v_permlane16_swap_b32 v56, v58
s_waitcnt lgkmcnt(0)
s_barrier
ds_read_b128 v[88:91], v2
ds_read_b128 v[92:95], v2 offset:16
s_waitcnt lgkmcnt(0)
v_max_u32 v89, v89, v91
v_max_u32 v93, v93, v95
v_med3_u32 v89, v88, v90, v89
v_med3_u32 v93, v92, v94, v93
v_max_u32 v88, v88, v90
v_max_u32 v92, v92, v94
v_max_u32 v89, v89, v93
v_med3_u32 v89, v88, v92, v89
v_max_u32 v88, v88, v92
v_readfirstlane_b32 s86, v89
v_readfirstlane_b32 s85, v88
s_not_b32 s95, s86
s_and_b32 s95, s95, 127
s_not_b32 s94, s85
s_and_b32 s94, s94, 127
s_cmp_lg_u32 s60, 0
s_cbranch_scc1 L_nocand
v_mov_b32 v2, s94
v_mov_b32 v3, s95
v_and_b32 v4, 8, v1
v_cmp_ne_u32 vcc, 0, v4
s_nop 1
v_cndmask_b32 v5, v2, v3, vcc
v_bfe_u32 v6, v5, 1, 3
v_and_b32 v7, 7, v1
v_xor_b32 v6, v6, v7
v_lshlrev_b32 v6, 4, v6
v_lshl_add_u32 v6, v5, 7, v6
ds_read_b128 v[88:91], v6
v_cmp_eq_u32 vcc, 1, v1
s_nop 1
v_cndmask_b32 v5, v2, v3, vcc
v_lshlrev_b32 v5, 4, v5
v_add_u32 v5, 49152, v5
ds_read_b128 v[92:95], v5
v_lshlrev_b32 v4, 8, v4
v_lshl_add_u32 v4, v7, 4, v4
s_lshl_b32 s70, s64, 12
s_lshl_b32 s71, s65, 7
s_add_u32 s70, s70, s71
s_add_u32 s70, s70, 6881280
s_lshl_b32 s71, s64, 7
s_add_u32 s71, s71, 6815744
s_mov_b64 exec, 0xffff
s_waitcnt lgkmcnt(1)
buffer_store_dwordx4 v[88:91], v4, s[12:15], s70 offen sc1
s_cmp_lg_u32 s64, s65
s_cbranch_scc1 L_norec
s_mov_b64 exec, 3
s_waitcnt lgkmcnt(0)
buffer_store_dwordx4 v[92:95], v16, s[12:15], s71 offen sc1
L_norec:
s_mov_b64 exec, -1
L_nocand:
v_bfe_u32 v8, v1, 1, 4
v_lshlrev_b32 v8, 7, v8
v_and_b32 v2, 1, v1
v_lshl_add_u32 v8, v2, 4, v8
s_mov_b32 s75, 6815744
v_pk_fma_f32 v[24:25], v[24:25], v[80:81], v[56:57] op_sel_hi:[1,0,0]
v_pk_fma_f32 v[26:27], v[26:27], v[80:81], v[56:57] op_sel_hi:[1,0,0]
v_cvt_pk_bf16_f32 v128, v24, v25
v_cvt_pk_bf16_f32 v129, v26, v27
ds_write_b64 v20, v[128:129] offset:32768
v_pk_fma_f32 v[28:29], v[28:29], v[80:81], v[56:57] op_sel_hi:[1,0,0]
v_pk_fma_f32 v[30:31], v[30:31], v[80:81], v[56:57] op_sel_hi:[1,0,0]
v_cvt_pk_bf16_f32 v130, v28, v29
v_cvt_pk_bf16_f32 v131, v30, v31
ds_write_b64 v21, v[130:131] offset:32768
v_pk_fma_f32 v[32:33], v[32:33], v[80:81], v[56:57] op_sel_hi:[1,0,0]
v_pk_fma_f32 v[34:35], v[34:35], v[80:81], v[56:57] op_sel_hi:[1,0,0]
v_cvt_pk_bf16_f32 v132, v32, v33
v_cvt_pk_bf16_f32 v133, v34, v35
ds_write_b64 v22, v[132:133] offset:32768
v_pk_fma_f32 v[36:37], v[36:37], v[80:81], v[56:57] op_sel_hi:[1,0,0]
v_pk_fma_f32 v[38:39], v[38:39], v[80:81], v[56:57] op_sel_hi:[1,0,0]
v_cvt_pk_bf16_f32 v134, v36, v37
v_cvt_pk_bf16_f32 v135, v38, v39
ds_write_b64 v23, v[134:135] offset:32768
v_pk_fma_f32 v[40:41], v[40:41], v[82:83], v[58:59] op_sel_hi:[1,0,0]
v_pk_fma_f32 v[42:43], v[42:43], v[82:83], v[58:59] op_sel_hi:[1,0,0]
v_cvt_pk_bf16_f32 v136, v40, v41
v_cvt_pk_bf16_f32 v137, v42, v43
ds_write_b64 v20, v[136:137] offset:34816
v_pk_fma_f32 v[44:45], v[44:45], v[82:83], v[58:59] op_sel_hi:[1,0,0]
v_pk_fma_f32 v[46:47], v[46:47], v[82:83], v[58:59] op_sel_hi:[1,0,0]
v_cvt_pk_bf16_f32 v138, v44, v45
v_cvt_pk_bf16_f32 v139, v46, v47
ds_write_b64 v21, v[138:139] offset:34816
v_pk_fma_f32 v[48:49], v[48:49], v[82:83], v[58:59] op_sel_hi:[1,0,0]
v_pk_fma_f32 v[50:51], v[50:51], v[82:83], v[58:59] op_sel_hi:[1,0,0]
v_cvt_pk_bf16_f32 v140, v48, v49
v_cvt_pk_bf16_f32 v141, v50, v51
ds_write_b64 v22, v[140:141] offset:34816
v_pk_fma_f32 v[52:53], v[52:53], v[82:83], v[58:59] op_sel_hi:[1,0,0]
v_pk_fma_f32 v[54:55], v[54:55], v[82:83], v[58:59] op_sel_hi:[1,0,0]
v_cvt_pk_bf16_f32 v142, v52, v53
v_cvt_pk_bf16_f32 v143, v54, v55
ds_write_b64 v23, v[142:143] offset:34816
v_lshrrev_b32 v2, 3, v1
v_lshrrev_b32 v3, 4, v1
v_and_b32 v4, 7, v1
v_xor_b32 v3, v3, v4
v_lshlrev_b32 v3, 4, v3
v_lshl_add_u32 v3, v2, 7, v3
s_lshl_b32 s70, s60, 12
v_add_u32 v9, s70, v3
v_xor_b32 v10, 64, v9
v_lshlrev_b32 v11, 11, v2
v_lshl_add_u32 v11, v4, 4, v11
s_lshl_b32 s70, s60, 5
v_add_u32 v12, s70, v2
s_lshl_b32 s87, s64, 18
s_lshl_b32 s70, s60, 16
s_add_u32 s87, s87, s70
s_lshl_b32 s70, s65, 7
s_add_u32 s87, s87, s70
s_waitcnt lgkmcnt(0)
ds_read_b128 v[96:99], v9 offset:32768
ds_read_b128 v[100:103], v10 offset:33792
ds_read_b128 v[104:107], v9 offset:34816
ds_read_b128 v[108:111], v10 offset:35840
v_add_u32 v2, 0, v12
v_cmp_ne_u32 vcc, s94, v2
v_cmp_ne_u32_e64 s[92:93], s95, v2
s_add_u32 s70, s87, 0
s_waitcnt lgkmcnt(3)
s_and_b64 exec, vcc, s[92:93]
buffer_store_dwordx4 v[96:99], v11, s[20:23], s70 offen
s_mov_b64 exec, -1
v_add_u32 v2, 8, v12
v_cmp_ne_u32 vcc, s94, v2
v_cmp_ne_u32_e64 s[92:93], s95, v2
s_add_u32 s70, s87, 16384
s_waitcnt lgkmcnt(2)
s_and_b64 exec, vcc, s[92:93]
buffer_store_dwordx4 v[100:103], v11, s[20:23], s70 offen
s_mov_b64 exec, -1
v_add_u32 v2, 16, v12
v_cmp_ne_u32 vcc, s94, v2
v_cmp_ne_u32_e64 s[92:93], s95, v2
s_add_u32 s70, s87, 32768
s_waitcnt lgkmcnt(1)
s_and_b64 exec, vcc, s[92:93]
buffer_store_dwordx4 v[104:107], v11, s[20:23], s70 offen
s_mov_b64 exec, -1
v_add_u32 v2, 24, v12
v_cmp_ne_u32 vcc, s94, v2
v_cmp_ne_u32_e64 s[92:93], s95, v2
s_add_u32 s70, s87, 49152
s_waitcnt lgkmcnt(0)
s_and_b64 exec, vcc, s[92:93]
buffer_store_dwordx4 v[108:111], v11, s[20:23], s70 offen
s_mov_b64 exec, -1
s_cmp_lg_u32 s60, 1
s_cbranch_scc1 L_nopick
buffer_load_dwordx4 v[84:87], v8, s[12:15], s75 offen sc1
s_waitcnt vmcnt(0)
L_rec_chk:
v_cmp_ne_u32 vcc, s68, v87
s_cbranch_vccnz L_rec_rt
L_rec_ok:
v_mov_b32_dpp v78, v84 row_ror:1 row_mask:0xf bank_mask:0xf
v_max_u32 v76, v84, v78
v_min_u32 v77, v84, v78
s_nop 0
v_mov_b32_dpp v78, v76 row_ror:2 row_mask:0xf bank_mask:0xf
v_max_u32_dpp v79, v77, v77 row_ror:2 row_mask:0xf bank_mask:0xf
v_med3_u32 v77, v76, v78, v79
v_max_u32 v76, v76, v78
s_nop 1
v_mov_b32_dpp v78, v76 row_ror:4 row_mask:0xf bank_mask:0xf
v_max_u32_dpp v79, v77, v77 row_ror:4 row_mask:0xf bank_mask:0xf
v_med3_u32 v77, v76, v78, v79
v_max_u32 v76, v76, v78
s_nop 1
v_mov_b32_dpp v78, v76 row_ror:8 row_mask:0xf bank_mask:0xf
v_max_u32_dpp v79, v77, v77 row_ror:8 row_mask:0xf bank_mask:0xf
v_med3_u32 v77, v76, v78, v79
v_max_u32 v76, v76, v78
v_mov_b32 v78, v76
v_mov_b32 v79, v77
s_nop 0
v_permlane16_swap_b32 v76, v78
v_permlane16_swap_b32 v77, v79
v_max_u32 v79, v77, v79
v_med3_u32 v77, v76, v78, v79
v_max_u32 v76, v76, v78
v_cmp_eq_u32 vcc, v84, v77
v_cmp_eq_u32_e64 s[92:93], v84, v76
v_and_b32 v87, 31, v1
v_mov_b32 v2, 161856
v_mov_b32 v3, 161872
v_cndmask_b32 v2, v2, v3, vcc
s_or_b64 exec, vcc, s[92:93]
ds_write_b128 v2, v[84:87]
s_mov_b64 exec, -1
s_cmp_lg_u32 s2, 0
s_cbranch_scc1 L_nopick
v_mov_b32 v2, s68
v_mov_b32 v3, 0
s_mov_b64 exec, 1
buffer_store_dword v2, v3, s[12:15], 0 offen sc1
s_mov_b64 exec, -1
L_nopick:
v_mov_b32 v2, 161856
s_waitcnt lgkmcnt(0)
s_barrier
ds_read_b32 v3, v2
ds_read_b32 v4, v2 offset:16
s_waitcnt lgkmcnt(0)
v_readfirstlane_b32 s72, v3
v_readfirstlane_b32 s73, v4
s_cmp_eq_u32 s85, s72
s_cselect_b32 s94, 255, s94
s_cmp_eq_u32 s85, s73
s_cselect_b32 s94, 255, s94
s_cmp_eq_u32 s86, s72
s_cselect_b32 s95, 255, s95
s_cmp_eq_u32 s86, s73
s_cselect_b32 s95, 255, s95
v_add_u32 v2, 0, v12
v_cmp_eq_u32 vcc, s94, v2
v_cmp_eq_u32_e64 s[92:93], s95, v2
s_add_u32 s70, s87, 0
s_or_b64 exec, vcc, s[92:93]
s_cbranch_execz L_nodef0
buffer_store_dwordx4 v[96:99], v11, s[20:23], s70 offen
L_nodef0:
s_mov_b64 exec, -1
v_add_u32 v2, 8, v12
v_cmp_eq_u32 vcc, s94, v2
v_cmp_eq_u32_e64 s[92:93], s95, v2
s_add_u32 s70, s87, 16384
s_or_b64 exec, vcc, s[92:93]
s_cbranch_execz L_nodef1
buffer_store_dwordx4 v[100:103], v11, s[20:23], s70 offen
L_nodef1:
s_mov_b64 exec, -1
v_add_u32 v2, 16, v12
v_cmp_eq_u32 vcc, s94, v2
v_cmp_eq_u32_e64 s[92:93], s95, v2
s_add_u32 s70, s87, 32768
s_or_b64 exec, vcc, s[92:93]
s_cbranch_execz L_nodef2
buffer_store_dwordx4 v[104:107], v11, s[20:23], s70 offen
L_nodef2:
s_mov_b64 exec, -1
v_add_u32 v2, 24, v12
v_cmp_eq_u32 vcc, s94, v2
v_cmp_eq_u32_e64 s[92:93], s95, v2
s_add_u32 s70, s87, 49152
s_or_b64 exec, vcc, s[92:93]
s_cbranch_execz L_nodef3
buffer_store_dwordx4 v[108:111], v11, s[20:23], s70 offen
L_nodef3:
s_mov_b64 exec, -1
L_end:
s_endpgm
L_eg_rt:
s_add_u32 s78, s78, 1
s_cmp_gt_u32 s78, 65536
s_cbranch_scc1 L_eg_ok
s_add_u32 s70, s87, 0
buffer_load_dwordx4 v[20:23], v44, s[12:15], s70 offen sc1
s_add_u32 s70, s87, 4096
buffer_load_dwordx4 v[24:27], v44, s[12:15], s70 offen sc1
s_add_u32 s70, s87, 8192
buffer_load_dwordx4 v[28:31], v44, s[12:15], s70 offen sc1
s_add_u32 s70, s87, 12288
buffer_load_dwordx4 v[32:35], v44, s[12:15], s70 offen sc1
buffer_load_dwordx4 v[36:39], v45, s[12:15], s88 offen sc1
buffer_load_dwordx4 v[40:43], v46, s[12:15], 0 offen offset:0 sc1
s_waitcnt vmcnt(0)
s_branch L_eg_chk
L_kvrt:
s_add_u32 s78, s78, 1
s_cmp_gt_u32 s78, 65536
s_cbranch_scc1 L_kvok
s_bitcmp1_b32 s73, 0
s_cbranch_scc0 L_kvn0
s_add_u32 s70, s65, 1
s_and_b32 s70, s70, 15
s_mul_i32 s70, s70, 4352
s_add_u32 s70, s70, s87
buffer_load_dwordx4 v[84:87], v18, s[12:15], s70 offen sc1
s_add_u32 s70, s65, 2
s_and_b32 s70, s70, 15
s_mul_i32 s70, s70, 4352
s_add_u32 s70, s70, s87
buffer_load_dwordx4 v[88:91], v18, s[12:15], s70 offen sc1
s_add_u32 s70, s65, 3
s_and_b32 s70, s70, 15
s_mul_i32 s70, s70, 4352
s_add_u32 s70, s70, s87
buffer_load_dwordx4 v[92:95], v18, s[12:15], s70 offen sc1
s_add_u32 s70, s65, 4
s_and_b32 s70, s70, 15
s_mul_i32 s70, s70, 4352
s_add_u32 s70, s70, s87
buffer_load_dwordx4 v[96:99], v18, s[12:15], s70 offen sc1
L_kvn0:
s_bitcmp1_b32 s73, 1
s_cbranch_scc0 L_kvn1
s_add_u32 s70, s65, 5
s_and_b32 s70, s70, 15
s_mul_i32 s70, s70, 4352
s_add_u32 s70, s70, s87
buffer_load_dwordx4 v[100:103], v18, s[12:15], s70 offen sc1
s_add_u32 s70, s65, 6
s_and_b32 s70, s70, 15
s_mul_i32 s70, s70, 4352
s_add_u32 s70, s70, s87
buffer_load_dwordx4 v[104:107], v18, s[12:15], s70 offen sc1
s_add_u32 s70, s65, 7
s_and_b32 s70, s70, 15
s_mul_i32 s70, s70, 4352
s_add_u32 s70, s70, s87
buffer_load_dwordx4 v[108:111], v18, s[12:15], s70 offen sc1
s_add_u32 s70, s65, 8
s_and_b32 s70, s70, 15
s_mul_i32 s70, s70, 4352
s_add_u32 s70, s70, s87
buffer_load_dwordx4 v[112:115], v18, s[12:15], s70 offen sc1
L_kvn1:
s_bitcmp1_b32 s73, 2
s_cbranch_scc0 L_kvn2
s_add_u32 s70, s65, 9
s_and_b32 s70, s70, 15
s_mul_i32 s70, s70, 4352
s_add_u32 s70, s70, s87
buffer_load_dwordx4 v[116:119], v18, s[12:15], s70 offen sc1
s_add_u32 s70, s65, 10
s_and_b32 s70, s70, 15
s_mul_i32 s70, s70, 4352
s_add_u32 s70, s70, s87
buffer_load_dwordx4 v[120:123], v18, s[12:15], s70 offen sc1
s_add_u32 s70, s65, 11
s_and_b32 s70, s70, 15
s_mul_i32 s70, s70, 4352
s_add_u32 s70, s70, s87
buffer_load_dwordx4 v[124:127], v18, s[12:15], s70 offen sc1
s_add_u32 s70, s65, 12
s_and_b32 s70, s70, 15
s_mul_i32 s70, s70, 4352
s_add_u32 s70, s70, s87
buffer_load_dwordx4 v[128:131], v18, s[12:15], s70 offen sc1
L_kvn2:
s_bitcmp1_b32 s73, 3
s_cbranch_scc0 L_kvn3
s_add_u32 s70, s65, 13
s_and_b32 s70, s70, 15
s_mul_i32 s70, s70, 4352
s_add_u32 s70, s70, s87
buffer_load_dwordx4 v[132:135], v18, s[12:15], s70 offen sc1
s_add_u32 s70, s65, 14
s_and_b32 s70, s70, 15
s_mul_i32 s70, s70, 4352
s_add_u32 s70, s70, s87
buffer_load_dwordx4 v[136:139], v18, s[12:15], s70 offen sc1
s_add_u32 s70, s65, 15
s_and_b32 s70, s70, 15
s_mul_i32 s70, s70, 4352
s_add_u32 s70, s70, s87
buffer_load_dwordx4 v[140:143], v18, s[12:15], s70 offen sc1
s_add_u32 s70, s65, 16
s_and_b32 s70, s70, 15
s_mul_i32 s70, s70, 4352
s_add_u32 s70, s70, s87
buffer_load_dwordx4 v[144:147], v18, s[12:15], s70 offen sc1
L_kvn3:
s_bitcmp1_b32 s73, 4
s_cbranch_scc0 L_kvn4
buffer_load_dwordx4 v[148:151], v55, s[12:15], s88 offen sc1
L_kvn4:
s_waitcnt vmcnt(0)
s_branch L_kvr
L_x_rt:
s_add_u32 s78, s78, 1
s_cmp_gt_u32 s78, 65536
s_cbranch_scc1 L_x_ok
buffer_load_dwordx4 v[24:27], v57, s[12:15], 0 offen offset:0 sc1
buffer_load_dwordx4 v[28:31], v57, s[12:15], 0 offen offset:64 sc1
buffer_load_dwordx4 v[32:35], v57, s[12:15], 0 offen offset:128 sc1
buffer_load_dwordx4 v[36:39], v57, s[12:15], 0 offen offset:192 sc1
buffer_load_dwordx4 v[40:43], v57, s[12:15], 0 offen offset:256 sc1
buffer_load_dwordx4 v[44:47], v57, s[12:15], 0 offen offset:320 sc1
buffer_load_dwordx4 v[48:51], v57, s[12:15], 0 offen offset:384 sc1
buffer_load_dwordx4 v[52:55], v57, s[12:15], 0 offen offset:448 sc1
s_waitcnt vmcnt(0)
s_branch L_x_chk
L_pxp_s:
buffer_store_dwordx4 v[68:71], v58, s[12:15], s85 offen offset:0 sc1
buffer_store_dwordx4 v[72:75], v58, s[12:15], s85 offen offset:128 sc1
s_branch L_pxp_d
L_px_rt:
s_add_u32 s78, s78, 1
s_cmp_gt_u32 s78, 65536
s_cbranch_scc1 L_px_ok
buffer_load_dwordx4 v[24:27], v58, s[12:15], s86 offen offset:0 sc1
buffer_load_dwordx4 v[28:31], v58, s[12:15], s86 offen offset:256 sc1
buffer_load_dwordx4 v[32:35], v58, s[12:15], s86 offen offset:512 sc1
buffer_load_dwordx4 v[36:39], v58, s[12:15], s86 offen offset:768 sc1
s_waitcnt vmcnt(0)
s_branch L_px_chk
L_y_rt:
s_add_u32 s78, s78, 1
s_cmp_gt_u32 s78, 65536
s_cbranch_scc1 L_y_ok
buffer_load_ushort v61, v64, s[12:15], s72 offen sc1
s_add_u32 s70, s87, 0
buffer_load_dwordx4 v[24:27], v62, s[12:15], s70 offen sc1
s_add_u32 s70, s87, 65536
buffer_load_dwordx4 v[28:31], v62, s[12:15], s70 offen sc1
s_add_u32 s70, s87, 131072
buffer_load_dwordx4 v[32:35], v62, s[12:15], s70 offen sc1
s_add_u32 s70, s87, 196608
buffer_load_dwordx4 v[36:39], v62, s[12:15], s70 offen sc1
s_add_u32 s70, s87, 262144
buffer_load_dwordx4 v[40:43], v62, s[12:15], s70 offen sc1
s_add_u32 s70, s87, 327680
buffer_load_dwordx4 v[44:47], v62, s[12:15], s70 offen sc1
s_add_u32 s70, s87, 393216
buffer_load_dwordx4 v[48:51], v62, s[12:15], s70 offen sc1
s_waitcnt vmcnt(0)
s_branch L_y_chk
L_ex1:
ds_write_b128 v2, v[64:67]
ds_write_b128 v2, v[72:75] offset:1024
ds_write_b128 v5, v[20:23]
s_waitcnt lgkmcnt(0)
s_barrier
ds_read_b128 v[128:131], v3
ds_read_b128 v[132:135], v3 offset:1024
ds_read_b128 v[136:139], v6
s_waitcnt lgkmcnt(1)
v_pk_add_f32 v[128:129], v[128:129], v[68:69]
v_pk_add_f32 v[130:131], v[130:131], v[70:71]
v_pk_add_f32 v[132:133], v[132:133], v[76:77]
v_pk_add_f32 v[134:135], v[134:135], v[78:79]
s_waitcnt lgkmcnt(0)
v_pk_add_f32 v[136:137], v[136:137], v[24:25]
v_pk_add_f32 v[138:139], v[138:139], v[26:27]
s_branch L_ex_d
L_kvp_s:
buffer_store_dwordx4 v[140:143], v16, s[12:15], s72 offen sc1
s_mov_b64 exec, s[92:93]
buffer_store_dwordx4 v[136:139], v4, s[12:15], s73 offen sc1
s_mov_b64 exec, -1
s_branch L_kvp_d
L_o0_rt:
s_add_u32 s78, s78, 1
s_cmp_gt_u32 s78, 65536
s_cbranch_scc1 L_o0_ok
s_add_u32 s70, s89, 0
s_and_b32 s70, s70, 15
s_lshl_b32 s70, s70, 11
buffer_load_dwordx4 v[56:59], v6, s[12:15], s70 offen offset:0 sc1
buffer_load_dwordx4 v[60:63], v19, s[12:15], s70 offen offset:0 sc1
buffer_load_dwordx4 v[64:67], v6, s[12:15], s70 offen offset:1024 sc1
buffer_load_dwordx4 v[68:71], v19, s[12:15], s70 offen offset:1024 sc1
s_add_u32 s70, s89, 1
s_and_b32 s70, s70, 15
s_lshl_b32 s70, s70, 11
buffer_load_dwordx4 v[72:75], v6, s[12:15], s70 offen offset:0 sc1
buffer_load_dwordx4 v[76:79], v19, s[12:15], s70 offen offset:0 sc1
buffer_load_dwordx4 v[80:83], v6, s[12:15], s70 offen offset:1024 sc1
buffer_load_dwordx4 v[84:87], v19, s[12:15], s70 offen offset:1024 sc1
s_add_u32 s70, s89, 2
s_and_b32 s70, s70, 15
s_lshl_b32 s70, s70, 11
buffer_load_dwordx4 v[88:91], v6, s[12:15], s70 offen offset:0 sc1
buffer_load_dwordx4 v[92:95], v19, s[12:15], s70 offen offset:0 sc1
buffer_load_dwordx4 v[96:99], v6, s[12:15], s70 offen offset:1024 sc1
buffer_load_dwordx4 v[100:103], v19, s[12:15], s70 offen offset:1024 sc1
s_waitcnt vmcnt(0)
s_branch L_o0_chk
L_o1_rt:
s_add_u32 s78, s78, 1
s_cmp_gt_u32 s78, 65536
s_cbranch_scc1 L_o1_ok
s_add_u32 s70, s89, 1
s_and_b32 s70, s70, 15
s_lshl_b32 s70, s70, 11
buffer_load_dwordx4 v[72:75], v6, s[12:15], s70 offen offset:0 sc1
buffer_load_dwordx4 v[76:79], v19, s[12:15], s70 offen offset:0 sc1
buffer_load_dwordx4 v[80:83], v6, s[12:15], s70 offen offset:1024 sc1
buffer_load_dwordx4 v[84:87], v19, s[12:15], s70 offen offset:1024 sc1
s_add_u32 s70, s89, 2
s_and_b32 s70, s70, 15
s_lshl_b32 s70, s70, 11
buffer_load_dwordx4 v[88:91], v6, s[12:15], s70 offen offset:0 sc1
buffer_load_dwordx4 v[92:95], v19, s[12:15], s70 offen offset:0 sc1
buffer_load_dwordx4 v[96:99], v6, s[12:15], s70 offen offset:1024 sc1
buffer_load_dwordx4 v[100:103], v19, s[12:15], s70 offen offset:1024 sc1
s_waitcnt vmcnt(0)
v_max3_u32 v2, v72, v76, v80
v_max_u32 v2, v2, v84
v_cmp_eq_u32 vcc, -1, v2
s_cbranch_vccnz L_o1_rt
s_branch L_o1_ok
L_o2_rt:
s_add_u32 s78, s78, 1
s_cmp_gt_u32 s78, 65536
s_cbranch_scc1 L_o2_ok
s_add_u32 s70, s89, 2
s_and_b32 s70, s70, 15
s_lshl_b32 s70, s70, 11
buffer_load_dwordx4 v[88:91], v6, s[12:15], s70 offen offset:0 sc1
buffer_load_dwordx4 v[92:95], v19, s[12:15], s70 offen offset:0 sc1
buffer_load_dwordx4 v[96:99], v6, s[12:15], s70 offen offset:1024 sc1
buffer_load_dwordx4 v[100:103], v19, s[12:15], s70 offen offset:1024 sc1
s_add_u32 s70, s89, 3
s_and_b32 s70, s70, 15
s_lshl_b32 s70, s70, 11
buffer_load_dwordx4 v[104:107], v6, s[12:15], s70 offen offset:0 sc1
buffer_load_dwordx4 v[108:111], v19, s[12:15], s70 offen offset:0 sc1
buffer_load_dwordx4 v[112:115], v6, s[12:15], s70 offen offset:1024 sc1
buffer_load_dwordx4 v[116:119], v19, s[12:15], s70 offen offset:1024 sc1
s_waitcnt vmcnt(0)
v_max3_u32 v2, v88, v92, v96
v_max_u32 v2, v2, v100
v_cmp_eq_u32 vcc, -1, v2
s_cbranch_vccnz L_o2_rt
s_branch L_o2_ok
L_o3_rt:
s_add_u32 s78, s78, 1
s_cmp_gt_u32 s78, 65536
s_cbranch_scc1 L_o3_ok
s_add_u32 s70, s89, 3
s_and_b32 s70, s70, 15
s_lshl_b32 s70, s70, 11
buffer_load_dwordx4 v[104:107], v6, s[12:15], s70 offen offset:0 sc1
buffer_load_dwordx4 v[108:111], v19, s[12:15], s70 offen offset:0 sc1
buffer_load_dwordx4 v[112:115], v6, s[12:15], s70 offen offset:1024 sc1
buffer_load_dwordx4 v[116:119], v19, s[12:15], s70 offen offset:1024 sc1
s_add_u32 s70, s89, 4
s_and_b32 s70, s70, 15
s_lshl_b32 s70, s70, 11
buffer_load_dwordx4 v[56:59], v6, s[12:15], s70 offen offset:0 sc1
buffer_load_dwordx4 v[60:63], v19, s[12:15], s70 offen offset:0 sc1
buffer_load_dwordx4 v[64:67], v6, s[12:15], s70 offen offset:1024 sc1
buffer_load_dwordx4 v[68:71], v19, s[12:15], s70 offen offset:1024 sc1
s_waitcnt vmcnt(0)
v_max3_u32 v2, v104, v108, v112
v_max_u32 v2, v2, v116
v_cmp_eq_u32 vcc, -1, v2
s_cbranch_vccnz L_o3_rt
s_branch L_o3_ok
L_o4_rt:
s_add_u32 s78, s78, 1
s_cmp_gt_u32 s78, 65536
s_cbranch_scc1 L_o4_ok
s_add_u32 s70, s89, 4
s_and_b32 s70, s70, 15
s_lshl_b32 s70, s70, 11
buffer_load_dwordx4 v[56:59], v6, s[12:15], s70 offen offset:0 sc1
buffer_load_dwordx4 v[60:63], v19, s[12:15], s70 offen offset:0 sc1
buffer_load_dwordx4 v[64:67], v6, s[12:15], s70 offen offset:1024 sc1
buffer_load_dwordx4 v[68:71], v19, s[12:15], s70 offen offset:1024 sc1
s_add_u32 s70, s89, 5
s_and_b32 s70, s70, 15
s_lshl_b32 s70, s70, 11
buffer_load_dwordx4 v[72:75], v6, s[12:15], s70 offen offset:0 sc1
buffer_load_dwordx4 v[76:79], v19, s[12:15], s70 offen offset:0 sc1
buffer_load_dwordx4 v[80:83], v6, s[12:15], s70 offen offset:1024 sc1
buffer_load_dwordx4 v[84:87], v19, s[12:15], s70 offen offset:1024 sc1
s_waitcnt vmcnt(0)
v_max3_u32 v2, v56, v60, v64
v_max_u32 v2, v2, v68
v_cmp_eq_u32 vcc, -1, v2
s_cbranch_vccnz L_o4_rt
s_branch L_o4_ok
L_o5_rt:
s_add_u32 s78, s78, 1
s_cmp_gt_u32 s78, 65536
s_cbranch_scc1 L_o5_ok
s_add_u32 s70, s89, 5
s_and_b32 s70, s70, 15
s_lshl_b32 s70, s70, 11
buffer_load_dwordx4 v[72:75], v6, s[12:15], s70 offen offset:0 sc1
buffer_load_dwordx4 v[76:79], v19, s[12:15], s70 offen offset:0 sc1
buffer_load_dwordx4 v[80:83], v6, s[12:15], s70 offen offset:1024 sc1
buffer_load_dwordx4 v[84:87], v19, s[12:15], s70 offen offset:1024 sc1
s_add_u32 s70, s89, 6
s_and_b32 s70, s70, 15
s_lshl_b32 s70, s70, 11
buffer_load_dwordx4 v[88:91], v6, s[12:15], s70 offen offset:0 sc1
buffer_load_dwordx4 v[92:95], v19, s[12:15], s70 offen offset:0 sc1
buffer_load_dwordx4 v[96:99], v6, s[12:15], s70 offen offset:1024 sc1
buffer_load_dwordx4 v[100:103], v19, s[12:15], s70 offen offset:1024 sc1
s_waitcnt vmcnt(0)
v_max3_u32 v2, v72, v76, v80
v_max_u32 v2, v2, v84
v_cmp_eq_u32 vcc, -1, v2
s_cbranch_vccnz L_o5_rt
s_branch L_o5_ok
L_o6_rt:
s_add_u32 s78, s78, 1
s_cmp_gt_u32 s78, 65536
s_cbranch_scc1 L_o6_ok
s_add_u32 s70, s89, 6
s_and_b32 s70, s70, 15
s_lshl_b32 s70, s70, 11
buffer_load_dwordx4 v[88:91], v6, s[12:15], s70 offen offset:0 sc1
buffer_load_dwordx4 v[92:95], v19, s[12:15], s70 offen offset:0 sc1
buffer_load_dwordx4 v[96:99], v6, s[12:15], s70 offen offset:1024 sc1
buffer_load_dwordx4 v[100:103], v19, s[12:15], s70 offen offset:1024 sc1
s_add_u32 s70, s89, 7
s_and_b32 s70, s70, 15
s_lshl_b32 s70, s70, 11
buffer_load_dwordx4 v[104:107], v6, s[12:15], s70 offen offset:0 sc1
buffer_load_dwordx4 v[108:111], v19, s[12:15], s70 offen offset:0 sc1
buffer_load_dwordx4 v[112:115], v6, s[12:15], s70 offen offset:1024 sc1
buffer_load_dwordx4 v[116:119], v19, s[12:15], s70 offen offset:1024 sc1
s_waitcnt vmcnt(0)
v_max3_u32 v2, v88, v92, v96
v_max_u32 v2, v2, v100
v_cmp_eq_u32 vcc, -1, v2
s_cbranch_vccnz L_o6_rt
s_branch L_o6_ok
L_o7_rt:
s_add_u32 s78, s78, 1
s_cmp_gt_u32 s78, 65536
s_cbranch_scc1 L_o7_ok
s_add_u32 s70, s89, 7
s_and_b32 s70, s70, 15
s_lshl_b32 s70, s70, 11
buffer_load_dwordx4 v[104:107], v6, s[12:15], s70 offen offset:0 sc1
buffer_load_dwordx4 v[108:111], v19, s[12:15], s70 offen offset:0 sc1
buffer_load_dwordx4 v[112:115], v6, s[12:15], s70 offen offset:1024 sc1
buffer_load_dwordx4 v[116:119], v19, s[12:15], s70 offen offset:1024 sc1
s_add_u32 s70, s89, 8
s_and_b32 s70, s70, 15
s_lshl_b32 s70, s70, 11
buffer_load_dwordx4 v[56:59], v6, s[12:15], s70 offen offset:0 sc1
buffer_load_dwordx4 v[60:63], v19, s[12:15], s70 offen offset:0 sc1
buffer_load_dwordx4 v[64:67], v6, s[12:15], s70 offen offset:1024 sc1
buffer_load_dwordx4 v[68:71], v19, s[12:15], s70 offen offset:1024 sc1
s_waitcnt vmcnt(0)
v_max3_u32 v2, v104, v108, v112
v_max_u32 v2, v2, v116
v_cmp_eq_u32 vcc, -1, v2
s_cbranch_vccnz L_o7_rt
s_branch L_o7_ok
L_o8_rt:
s_add_u32 s78, s78, 1
s_cmp_gt_u32 s78, 65536
s_cbranch_scc1 L_o8_ok
s_add_u32 s70, s89, 8
s_and_b32 s70, s70, 15
s_lshl_b32 s70, s70, 11
buffer_load_dwordx4 v[56:59], v6, s[12:15], s70 offen offset:0 sc1
buffer_load_dwordx4 v[60:63], v19, s[12:15], s70 offen offset:0 sc1
buffer_load_dwordx4 v[64:67], v6, s[12:15], s70 offen offset:1024 sc1
buffer_load_dwordx4 v[68:71], v19, s[12:15], s70 offen offset:1024 sc1
s_add_u32 s70, s89, 9
s_and_b32 s70, s70, 15
s_lshl_b32 s70, s70, 11
buffer_load_dwordx4 v[72:75], v6, s[12:15], s70 offen offset:0 sc1
buffer_load_dwordx4 v[76:79], v19, s[12:15], s70 offen offset:0 sc1
buffer_load_dwordx4 v[80:83], v6, s[12:15], s70 offen offset:1024 sc1
buffer_load_dwordx4 v[84:87], v19, s[12:15], s70 offen offset:1024 sc1
s_waitcnt vmcnt(0)
v_max3_u32 v2, v56, v60, v64
v_max_u32 v2, v2, v68
v_cmp_eq_u32 vcc, -1, v2
s_cbranch_vccnz L_o8_rt
s_branch L_o8_ok
L_o9_rt:
s_add_u32 s78, s78, 1
s_cmp_gt_u32 s78, 65536
s_cbranch_scc1 L_o9_ok
s_add_u32 s70, s89, 9
s_and_b32 s70, s70, 15
s_lshl_b32 s70, s70, 11
buffer_load_dwordx4 v[72:75], v6, s[12:15], s70 offen offset:0 sc1
buffer_load_dwordx4 v[76:79], v19, s[12:15], s70 offen offset:0 sc1
buffer_load_dwordx4 v[80:83], v6, s[12:15], s70 offen offset:1024 sc1
buffer_load_dwordx4 v[84:87], v19, s[12:15], s70 offen offset:1024 sc1
s_add_u32 s70, s89, 10
s_and_b32 s70, s70, 15
s_lshl_b32 s70, s70, 11
buffer_load_dwordx4 v[88:91], v6, s[12:15], s70 offen offset:0 sc1
buffer_load_dwordx4 v[92:95], v19, s[12:15], s70 offen offset:0 sc1
buffer_load_dwordx4 v[96:99], v6, s[12:15], s70 offen offset:1024 sc1
buffer_load_dwordx4 v[100:103], v19, s[12:15], s70 offen offset:1024 sc1
s_waitcnt vmcnt(0)
v_max3_u32 v2, v72, v76, v80
v_max_u32 v2, v2, v84
v_cmp_eq_u32 vcc, -1, v2
s_cbranch_vccnz L_o9_rt
s_branch L_o9_ok
L_o10_rt:
s_add_u32 s78, s78, 1
s_cmp_gt_u32 s78, 65536
s_cbranch_scc1 L_o10_ok
s_add_u32 s70, s89, 10
s_and_b32 s70, s70, 15
s_lshl_b32 s70, s70, 11
buffer_load_dwordx4 v[88:91], v6, s[12:15], s70 offen offset:0 sc1
buffer_load_dwordx4 v[92:95], v19, s[12:15], s70 offen offset:0 sc1
buffer_load_dwordx4 v[96:99], v6, s[12:15], s70 offen offset:1024 sc1
buffer_load_dwordx4 v[100:103], v19, s[12:15], s70 offen offset:1024 sc1
s_add_u32 s70, s89, 11
s_and_b32 s70, s70, 15
s_lshl_b32 s70, s70, 11
buffer_load_dwordx4 v[104:107], v6, s[12:15], s70 offen offset:0 sc1
buffer_load_dwordx4 v[108:111], v19, s[12:15], s70 offen offset:0 sc1
buffer_load_dwordx4 v[112:115], v6, s[12:15], s70 offen offset:1024 sc1
buffer_load_dwordx4 v[116:119], v19, s[12:15], s70 offen offset:1024 sc1
s_waitcnt vmcnt(0)
v_max3_u32 v2, v88, v92, v96
v_max_u32 v2, v2, v100
v_cmp_eq_u32 vcc, -1, v2
s_cbranch_vccnz L_o10_rt
s_branch L_o10_ok
L_o11_rt:
s_add_u32 s78, s78, 1
s_cmp_gt_u32 s78, 65536
s_cbranch_scc1 L_o11_ok
s_add_u32 s70, s89, 11
s_and_b32 s70, s70, 15
s_lshl_b32 s70, s70, 11
buffer_load_dwordx4 v[104:107], v6, s[12:15], s70 offen offset:0 sc1
buffer_load_dwordx4 v[108:111], v19, s[12:15], s70 offen offset:0 sc1
buffer_load_dwordx4 v[112:115], v6, s[12:15], s70 offen offset:1024 sc1
buffer_load_dwordx4 v[116:119], v19, s[12:15], s70 offen offset:1024 sc1
s_add_u32 s70, s89, 12
s_and_b32 s70, s70, 15
s_lshl_b32 s70, s70, 11
buffer_load_dwordx4 v[56:59], v6, s[12:15], s70 offen offset:0 sc1
buffer_load_dwordx4 v[60:63], v19, s[12:15], s70 offen offset:0 sc1
buffer_load_dwordx4 v[64:67], v6, s[12:15], s70 offen offset:1024 sc1
buffer_load_dwordx4 v[68:71], v19, s[12:15], s70 offen offset:1024 sc1
s_waitcnt vmcnt(0)
v_max3_u32 v2, v104, v108, v112
v_max_u32 v2, v2, v116
v_cmp_eq_u32 vcc, -1, v2
s_cbranch_vccnz L_o11_rt
s_branch L_o11_ok
L_o12_rt:
s_add_u32 s78, s78, 1
s_cmp_gt_u32 s78, 65536
s_cbranch_scc1 L_o12_ok
s_add_u32 s70, s89, 12
s_and_b32 s70, s70, 15
s_lshl_b32 s70, s70, 11
buffer_load_dwordx4 v[56:59], v6, s[12:15], s70 offen offset:0 sc1
buffer_load_dwordx4 v[60:63], v19, s[12:15], s70 offen offset:0 sc1
buffer_load_dwordx4 v[64:67], v6, s[12:15], s70 offen offset:1024 sc1
buffer_load_dwordx4 v[68:71], v19, s[12:15], s70 offen offset:1024 sc1
s_add_u32 s70, s89, 13
s_and_b32 s70, s70, 15
s_lshl_b32 s70, s70, 11
buffer_load_dwordx4 v[72:75], v6, s[12:15], s70 offen offset:0 sc1
buffer_load_dwordx4 v[76:79], v19, s[12:15], s70 offen offset:0 sc1
buffer_load_dwordx4 v[80:83], v6, s[12:15], s70 offen offset:1024 sc1
buffer_load_dwordx4 v[84:87], v19, s[12:15], s70 offen offset:1024 sc1
s_waitcnt vmcnt(0)
v_max3_u32 v2, v56, v60, v64
v_max_u32 v2, v2, v68
v_cmp_eq_u32 vcc, -1, v2
s_cbranch_vccnz L_o12_rt
s_branch L_o12_ok
L_o13_rt:
s_add_u32 s78, s78, 1
s_cmp_gt_u32 s78, 65536
s_cbranch_scc1 L_o13_ok
s_add_u32 s70, s89, 13
s_and_b32 s70, s70, 15
s_lshl_b32 s70, s70, 11
buffer_load_dwordx4 v[72:75], v6, s[12:15], s70 offen offset:0 sc1
buffer_load_dwordx4 v[76:79], v19, s[12:15], s70 offen offset:0 sc1
buffer_load_dwordx4 v[80:83], v6, s[12:15], s70 offen offset:1024 sc1
buffer_load_dwordx4 v[84:87], v19, s[12:15], s70 offen offset:1024 sc1
s_add_u32 s70, s89, 14
s_and_b32 s70, s70, 15
s_lshl_b32 s70, s70, 11
buffer_load_dwordx4 v[88:91], v6, s[12:15], s70 offen offset:0 sc1
buffer_load_dwordx4 v[92:95], v19, s[12:15], s70 offen offset:0 sc1
buffer_load_dwordx4 v[96:99], v6, s[12:15], s70 offen offset:1024 sc1
buffer_load_dwordx4 v[100:103], v19, s[12:15], s70 offen offset:1024 sc1
s_waitcnt vmcnt(0)
v_max3_u32 v2, v72, v76, v80
v_max_u32 v2, v2, v84
v_cmp_eq_u32 vcc, -1, v2
s_cbranch_vccnz L_o13_rt
s_branch L_o13_ok
L_o14_rt:
s_add_u32 s78, s78, 1
s_cmp_gt_u32 s78, 65536
s_cbranch_scc1 L_o14_ok
s_add_u32 s70, s89, 14
s_and_b32 s70, s70, 15
s_lshl_b32 s70, s70, 11
buffer_load_dwordx4 v[88:91], v6, s[12:15], s70 offen offset:0 sc1
buffer_load_dwordx4 v[92:95], v19, s[12:15], s70 offen offset:0 sc1
buffer_load_dwordx4 v[96:99], v6, s[12:15], s70 offen offset:1024 sc1
buffer_load_dwordx4 v[100:103], v19, s[12:15], s70 offen offset:1024 sc1
s_add_u32 s70, s89, 15
s_and_b32 s70, s70, 15
s_lshl_b32 s70, s70, 11
buffer_load_dwordx4 v[104:107], v6, s[12:15], s70 offen offset:0 sc1
buffer_load_dwordx4 v[108:111], v19, s[12:15], s70 offen offset:0 sc1
buffer_load_dwordx4 v[112:115], v6, s[12:15], s70 offen offset:1024 sc1
buffer_load_dwordx4 v[116:119], v19, s[12:15], s70 offen offset:1024 sc1
s_waitcnt vmcnt(0)
v_max3_u32 v2, v88, v92, v96
v_max_u32 v2, v2, v100
v_cmp_eq_u32 vcc, -1, v2
s_cbranch_vccnz L_o14_rt
s_branch L_o14_ok
L_o15_rt:
s_add_u32 s78, s78, 1
s_cmp_gt_u32 s78, 65536
s_cbranch_scc1 L_o15_ok
s_add_u32 s70, s89, 15
s_and_b32 s70, s70, 15
s_lshl_b32 s70, s70, 11
buffer_load_dwordx4 v[104:107], v6, s[12:15], s70 offen offset:0 sc1
buffer_load_dwordx4 v[108:111], v19, s[12:15], s70 offen offset:0 sc1
buffer_load_dwordx4 v[112:115], v6, s[12:15], s70 offen offset:1024 sc1
buffer_load_dwordx4 v[116:119], v19, s[12:15], s70 offen offset:1024 sc1
s_waitcnt vmcnt(0)
v_max3_u32 v2, v104, v108, v112
v_max_u32 v2, v2, v116
v_cmp_eq_u32 vcc, -1, v2
s_cbranch_vccnz L_o15_rt
s_branch L_o15_ok
L_stp_s:
buffer_store_dwordx4 v[72:75], v4, s[12:15], s72 offen sc1
s_branch L_stp_d
L_st_rt:
s_add_u32 s78, s78, 1
s_cmp_gt_u32 s78, 65536
s_cbranch_scc1 L_st_ok
s_add_u32 s70, s75, 0
buffer_load_dwordx4 v[96:99], v5, s[12:15], s70 offen sc1
s_add_u32 s70, s75, 4096
buffer_load_dwordx4 v[100:103], v5, s[12:15], s70 offen sc1
s_add_u32 s70, s75, 8192
buffer_load_dwordx4 v[104:107], v5, s[12:15], s70 offen sc1
s_add_u32 s70, s75, 12288
buffer_load_dwordx4 v[108:111], v5, s[12:15], s70 offen sc1
s_add_u32 s70, s75, 16384
buffer_load_dwordx4 v[112:115], v5, s[12:15], s70 offen sc1
s_add_u32 s70, s75, 20480
buffer_load_dwordx4 v[116:119], v5, s[12:15], s70 offen sc1
s_add_u32 s70, s75, 24576
buffer_load_dwordx4 v[120:123], v5, s[12:15], s70 offen sc1
s_add_u32 s70, s75, 28672
buffer_load_dwordx4 v[124:127], v5, s[12:15], s70 offen sc1
s_waitcnt vmcnt(0)
s_branch L_st_chk
L_rec_rt:
s_add_u32 s78, s78, 1
s_cmp_gt_u32 s78, 65536
s_cbranch_scc1 L_rec_ok
buffer_load_dwordx4 v[84:87], v8, s[12:15], s75 offen sc1
s_waitcnt vmcnt(0)
s_branch L_rec_chk
.section .rodata,"a"
.p2align 6
.amdhsa_kernel sequential_preLN__linear_attn_block__moe_arch_mod__prompt_kernel
  .amdhsa_next_free_vgpr 256
  .amdhsa_next_free_sgpr 102
  .amdhsa_accum_offset 152
  .amdhsa_group_segment_fixed_size 0
  .amdhsa_kernarg_size 88
  .amdhsa_user_sgpr_count 2
  .amdhsa_user_sgpr_kernarg_segment_ptr 1
  .amdhsa_system_sgpr_workgroup_id_x 1
  .amdhsa_float_denorm_mode_32 3
.end_amdhsa_kernel
```

```asm
; @launch grid=(256,1,1) block=(512,1,1) lds=163840
.amdgcn_target "amdgcn-amd-amdhsa--gfx950"
.text
.globl sequential_preLN__linear_attn_block__moe_arch_mod__prompt_kernel
.p2align 8
.type sequential_preLN__linear_attn_block__moe_arch_mod__prompt_kernel,@function
sequential_preLN__linear_attn_block__moe_arch_mod__prompt_kernel:
s_cmp_ge_u32 s2, 256
s_cbranch_scc1 L_end
s_load_dwordx16 s[40:55], s[0:1], 0
s_load_dwordx2 s[56:57], s[0:1], 64
s_load_dwordx2 s[58:59], s[0:1], 80
v_lshrrev_b32 v2, 6, v0
v_and_b32 v1, 63, v0
v_readfirstlane_b32 s60, v2
s_and_b32 s62, s2, 7
s_lshr_b32 s63, s2, 3
s_lshl_b32 s64, s62, 1
s_and_b32 s70, s63, 1
s_add_u32 s64, s64, s70
s_lshr_b32 s65, s63, 1
s_lshl_b32 s79, s64, 4
s_add_u32 s79, s79, s65
s_mov_b32 s78, 0
s_mov_b32 s89, s65
s_lshr_b32 s61, s60, 2
s_and_b32 s60, s60, 3
s_lshr_b32 s66, s60, 1
s_and_b32 s67, s60, 1
v_lshlrev_b32 v16, 4, v1
s_cmp_eq_u32 s61, 0
s_cbranch_scc1 L_compute
s_setprio 1
v_mov_b32 v18, v16
s_lshl_b32 s70, s65, 2
s_add_u32 s70, s70, s60
s_lshl_b32 s70, s70, 16
v_lshrrev_b32 v2, 3, v1
v_lshlrev_b32 v5, 11, v2
v_add_u32 v5, s70, v5
v_lshrrev_b32 v3, 4, v1
v_and_b32 v4, 7, v1
v_xor_b32 v3, v3, v4
v_xor_b32 v6, 0, v3
v_lshl_add_u32 v6, v6, 4, v5
v_add_u32 v8, 0, v6
v_xor_b32 v6, 4, v3
v_lshl_add_u32 v6, v6, 4, v5
v_add_u32 v9, 15360, v6
v_xor_b32 v6, 0, v3
v_lshl_add_u32 v6, v6, 4, v5
v_add_u32 v10, 30720, v6
v_xor_b32 v6, 4, v3
v_lshl_add_u32 v6, v6, 4, v5
v_add_u32 v11, 46080, v6
s_lshl_b32 s70, s60, 4
v_add_u32 v5, s70, v2
v_mul_u32_u24 v5, 6144, v5
s_lshl_b32 s70, s64, 7
v_add_u32 v5, s70, v5
v_bfe_u32 v3, v1, 4, 1
v_lshlrev_b32 v3, 1, v3
v_xor_b32 v3, v3, v4
v_xor_b32 v6, 0, v3
v_lshl_add_u32 v6, v6, 4, v5
v_add_u32 v12, 0, v6
v_xor_b32 v6, 4, v3
v_lshl_add_u32 v6, v6, 4, v5
v_add_u32 v13, 48128, v6
v_xor_b32 v6, 0, v3
v_lshl_add_u32 v6, v6, 4, v5
v_add_u32 v14, 0, v6
v_xor_b32 v6, 4, v3
v_lshl_add_u32 v6, v6, 4, v5
v_add_u32 v15, 48128, v6
v_xor_b32 v6, 0, v3
v_lshl_add_u32 v6, v6, 4, v5
v_add_u32 v16, 4096, v6
v_xor_b32 v6, 4, v3
v_lshl_add_u32 v6, v6, 4, v5
v_add_u32 v17, 52224, v6
s_lshl_b32 s76, s60, 12
s_mul_i32 s77, s60, 6144
s_and_b32 s70, s64, 1
s_lshl_b32 s70, s70, 3
s_mov_b32 s70, 0
s_add_u32 s70, s70, s65
s_and_b32 s70, s70, 15
s_mul_i32 s75, s70, 393216
s_lshl_b32 s74, s70, 7
s_waitcnt lgkmcnt(0)
s_mov_b32 s4, s40
s_and_b32 s5, s41, 0xffff
s_mov_b32 s6, 4194304
s_mov_b32 s7, 0x20000
s_mov_b32 s8, s42
s_and_b32 s9, s43, 0xffff
s_mov_b32 s10, 6291456
s_mov_b32 s11, 0x20000
s_add_u32 m0, s76, 122880
s_nop 0
buffer_load_dwordx4 v8, s[4:7], s74 offen offset:0 lds
buffer_load_dwordx4 v9, s[4:7], s74 offen offset:1024 lds
buffer_load_dwordx4 v10, s[4:7], s74 offen offset:2048 lds
buffer_load_dwordx4 v11, s[4:7], s74 offen offset:3072 lds
s_add_u32 s74, s74, 128
s_and_b32 s74, s74, 2047
s_add_u32 m0, s77, 0
s_nop 0
buffer_load_dwordx4 v12, s[8:11], s75 offen offset:0 lds
buffer_load_dwordx4 v13, s[8:11], s75 offen offset:1024 lds
buffer_load_dwordx4 v14, s[8:11], s75 offen offset:2048 lds
buffer_load_dwordx4 v15, s[8:11], s75 offen offset:3072 lds
s_add_u32 m0, s77, 4096
s_nop 0
buffer_load_dwordx4 v16, s[8:11], s75 offen offset:0 lds
buffer_load_dwordx4 v17, s[8:11], s75 offen offset:1024 lds
s_add_u32 s75, s75, 393216
s_cmp_eq_u32 s75, 6291456
s_cselect_b32 s75, 0, s75
s_add_u32 m0, s76, 106496
s_nop 0
buffer_load_dwordx4 v8, s[4:7], s74 offen offset:0 lds
buffer_load_dwordx4 v9, s[4:7], s74 offen offset:1024 lds
buffer_load_dwordx4 v10, s[4:7], s74 offen offset:2048 lds
buffer_load_dwordx4 v11, s[4:7], s74 offen offset:3072 lds
s_add_u32 s74, s74, 128
s_and_b32 s74, s74, 2047
s_add_u32 m0, s77, 81920
s_nop 0
buffer_load_dwordx4 v12, s[8:11], s75 offen offset:0 lds
buffer_load_dwordx4 v13, s[8:11], s75 offen offset:1024 lds
buffer_load_dwordx4 v14, s[8:11], s75 offen offset:2048 lds
buffer_load_dwordx4 v15, s[8:11], s75 offen offset:3072 lds
s_add_u32 m0, s77, 86016
s_nop 0
buffer_load_dwordx4 v16, s[8:11], s75 offen offset:0 lds
buffer_load_dwordx4 v17, s[8:11], s75 offen offset:1024 lds
s_add_u32 s75, s75, 393216
s_cmp_eq_u32 s75, 6291456
s_cselect_b32 s75, 0, s75
s_mov_b32 s12, s58
s_and_b32 s13, s59, 0xffff
s_mov_b32 s14, 268435456
s_mov_b32 s15, 0x20000
s_mov_b32 s16, s44
s_and_b32 s17, s45, 0xffff
s_mov_b32 s18, 2097152
s_mov_b32 s19, 0x20000
s_mov_b32 s20, s56
s_and_b32 s21, s57, 0xffff
s_mov_b32 s22, 4194304
s_mov_b32 s23, 0x20000
s_mov_b32 s24, s50
s_and_b32 s25, s51, 0xffff
s_mov_b32 s26, 7340032
s_mov_b32 s27, 0x20000
s_mov_b32 s28, s52
s_and_b32 s29, s53, 0xffff
s_mov_b32 s30, 7340032
s_mov_b32 s31, 0x20000
s_mov_b32 s32, s54
s_and_b32 s33, s55, 0xffff
s_mov_b32 s34, 7340032
s_mov_b32 s35, 0x20000
s_lshl_b32 s70, s65, 7
s_lshl_b32 s71, s64, 3
s_add_u32 s70, s70, s71
s_lshl_b32 s71, s60, 1
s_add_u32 s87, s70, s71
v_lshrrev_b32 v2, 3, v1
v_lshlrev_b32 v3, 11, v2
v_bfe_u32 v5, v1, 4, 2
v_lshlrev_b32 v5, 1, v5
v_and_b32 v4, 7, v1
v_xor_b32 v5, v5, v4
v_lshl_add_u32 v3, v5, 4, v3
s_lshl_b32 s70, s65, 7
v_add_u32 v80, s70, v3
v_mov_b32 v72, -1
v_mov_b32 v73, -1
v_mov_b32 v74, -1
v_mov_b32 v75, -1
s_mul_i32 s80, s79, 4352
s_add_u32 s80, s80, 524288
s_lshl_b32 s81, s65, 18
s_lshl_b32 s70, s66, 17
s_add_u32 s81, s81, s70
s_lshl_b32 s70, s64, 11
s_add_u32 s81, s81, s70
s_lshl_b32 s70, s67, 10
s_add_u32 s81, s81, s70
s_add_u32 s81, s81, 2097152
v_mul_u32_u24 v76, 7168, v2
v_lshl_add_u32 v76, v4, 4, v76
v_lshrrev_b32 v2, 4, v1
v_and_b32 v3, 15, v1
v_lshlrev_b32 v77, 13, v2
v_lshl_add_u32 v77, v3, 4, v77
v_add_u32 v78, 4096, v77
s_and_b32 s70, s65, 3
s_lshl_b32 s70, s70, 2
s_add_u32 s70, s70, s60
s_mul_i32 s85, s70, 458752
s_lshr_b32 s70, s79, 2
s_lshl_b32 s70, s70, 7
s_add_u32 s85, s85, s70
s_lshl_b32 s86, s79, 15
s_lshl_b32 s70, s60, 9
s_add_u32 s86, s86, s70
s_cmp_lt_u32 s64, 14
s_cselect_b32 s26, s26, 0
s_cselect_b32 s30, s30, 0
s_cselect_b32 s34, s34, 0
s_mov_b32 s90, 0x10001
s_movk_i32 s91, 0xff
v_mov_b32 v79, 0
s_lshl_b32 s70, s87, 4
s_add_u32 s70, s70, 8192
v_writelane_b32 v79, s70, 0
s_lshl_b32 s70, s79, 4
s_add_u32 s70, s70, 4096
v_writelane_b32 v79, s70, 1
s_lshl_b32 s70, s64, 7
s_add_u32 s70, s70, 6815744
v_writelane_b32 v79, s70, 2
s_lshl_b32 s70, s79, 10
s_add_u32 s70, s70, 65536
v_writelane_b32 v79, s70, 3
s_lshl_b32 s70, s60, 10
s_add_u32 s70, s70, s80
v_writelane_b32 v79, s70, 4
s_lshl_b32 s70, s67, 7
s_add_u32 s70, s70, s80
s_add_u32 s70, s70, 4096
v_writelane_b32 v79, s70, 5
s_lshl_b32 s71, s79, 2
s_add_u32 s71, s71, s60
s_lshl_b32 s70, s71, 11
s_add_u32 s70, s70, 7340032
v_writelane_b32 v79, s70, 6
s_lshl_b32 s71, s79, 2
s_add_u32 s71, s71, s60
s_lshl_b32 s70, s71, 9
s_add_u32 s70, s70, 6291456
v_writelane_b32 v79, s70, 7
s_and_b32 s71, s65, 3
s_sub_u32 s70, s79, s71
s_add_u32 s70, s70, s60
s_lshl_b32 s70, s70, 2
s_add_u32 s70, s70, s71
s_lshl_b32 s70, s70, 8
s_add_u32 s70, s70, 6946816
v_writelane_b32 v79, s70, 8
s_add_u32 s70, s81, 0
v_writelane_b32 v79, s70, 9
s_add_u32 s70, s81, 32768
v_writelane_b32 v79, s70, 10
s_add_u32 s70, s81, 65536
v_writelane_b32 v79, s70, 11
s_add_u32 s70, s81, 98304
v_writelane_b32 v79, s70, 12
v_and_b32 v2, 7, v1
v_lshlrev_b32 v2, 7, v2
v_lshrrev_b32 v3, 3, v1
v_lshl_add_u32 v83, v3, 15, v2
v_add_u32 v83, s81, v83
s_mov_b32 exec_lo, 0
s_lshl_b32 s71, s79, 2
s_add_u32 s71, s71, s60
s_lshl_b32 s70, s71, 11
s_add_u32 s70, s70, 7340032
s_mov_b32 exec_hi, 0xffff
v_and_b32 v2, 15, v1
v_lshl_add_u32 v83, v2, 7, s70
s_lshl_b32 s70, s60, 10
s_add_u32 s70, s70, s80
s_mov_b32 exec_hi, 0xff0000
v_and_b32 v2, 7, v1
v_lshl_add_u32 v83, v2, 7, s70
s_lshl_b32 s71, s79, 2
s_add_u32 s71, s71, s60
s_lshl_b32 s70, s71, 9
s_add_u32 s70, s70, 6291456
s_mov_b32 exec_hi, 0xf000000
v_and_b32 v2, 3, v1
v_lshl_add_u32 v83, v2, 7, s70
s_and_b32 s71, s65, 3
s_sub_u32 s70, s79, s71
s_add_u32 s70, s70, s60
s_lshl_b32 s70, s70, 2
s_add_u32 s70, s70, s71
s_lshl_b32 s70, s70, 8
s_add_u32 s70, s70, 6946816
s_mov_b32 exec_hi, 0x30000000
v_and_b32 v2, 1, v1
v_lshl_add_u32 v83, v2, 7, s70
s_lshl_b32 s70, s67, 7
s_add_u32 s70, s70, s80
s_add_u32 s70, s70, 4096
s_mov_b32 exec_hi, 0xc0000000
v_and_b32 v2, 0, v1
v_lshl_add_u32 v83, v2, 7, s70
s_mov_b64 exec, -1
s_waitcnt vmcnt(10)
s_barrier
s_add_u32 m0, s76, 65536
s_nop 0
buffer_load_dwordx4 v8, s[4:7], s74 offen offset:0 lds
buffer_load_dwordx4 v9, s[4:7], s74 offen offset:1024 lds
buffer_load_dwordx4 v10, s[4:7], s74 offen offset:2048 lds
buffer_load_dwordx4 v11, s[4:7], s74 offen offset:3072 lds
s_add_u32 s74, s74, 128
s_and_b32 s74, s74, 2047
s_add_u32 m0, s77, 40960
s_nop 0
buffer_load_dwordx4 v12, s[8:11], s75 offen offset:0 lds
buffer_load_dwordx4 v13, s[8:11], s75 offen offset:1024 lds
buffer_load_dwordx4 v14, s[8:11], s75 offen offset:2048 lds
buffer_load_dwordx4 v15, s[8:11], s75 offen offset:3072 lds
s_add_u32 m0, s77, 45056
s_nop 0
buffer_load_dwordx4 v16, s[8:11], s75 offen offset:0 lds
buffer_load_dwordx4 v17, s[8:11], s75 offen offset:1024 lds
s_add_u32 s75, s75, 393216
s_cmp_eq_u32 s75, 6291456
s_cselect_b32 s75, 0, s75
s_add_u32 m0, s76, 24576
s_nop 0
buffer_load_dwordx4 v8, s[4:7], s74 offen offset:0 lds
buffer_load_dwordx4 v9, s[4:7], s74 offen offset:1024 lds
buffer_load_dwordx4 v10, s[4:7], s74 offen offset:2048 lds
buffer_load_dwordx4 v11, s[4:7], s74 offen offset:3072 lds
s_add_u32 s74, s74, 128
s_and_b32 s74, s74, 2047
s_waitcnt vmcnt(14)
s_barrier
s_add_u32 m0, s77, 0
s_nop 0
buffer_load_dwordx4 v12, s[8:11], s75 offen offset:0 lds
buffer_load_dwordx4 v13, s[8:11], s75 offen offset:1024 lds
buffer_load_dwordx4 v14, s[8:11], s75 offen offset:2048 lds
buffer_load_dwordx4 v15, s[8:11], s75 offen offset:3072 lds
s_add_u32 m0, s77, 4096
s_nop 0
buffer_load_dwordx4 v16, s[8:11], s75 offen offset:0 lds
buffer_load_dwordx4 v17, s[8:11], s75 offen offset:1024 lds
s_add_u32 s75, s75, 393216
s_cmp_eq_u32 s75, 6291456
s_cselect_b32 s75, 0, s75
s_add_u32 m0, s76, 122880
s_nop 0
buffer_load_dwordx4 v8, s[4:7], s74 offen offset:0 lds
buffer_load_dwordx4 v9, s[4:7], s74 offen offset:1024 lds
buffer_load_dwordx4 v10, s[4:7], s74 offen offset:2048 lds
buffer_load_dwordx4 v11, s[4:7], s74 offen offset:3072 lds
s_add_u32 s74, s74, 128
s_and_b32 s74, s74, 2047
v_mov_b32 v2, 0
buffer_load_dword v19, v2, s[12:15], 0 offen sc1
s_lshl_b32 s70, s87, 11
buffer_load_dwordx4 v[20:23], v18, s[4:7], s70 offen offset:0
s_lshl_b32 s70, s87, 11
buffer_load_dwordx4 v[24:27], v18, s[4:7], s70 offen offset:1024
s_lshl_b32 s70, s87, 11
buffer_load_dwordx4 v[28:31], v18, s[4:7], s70 offen offset:2048
s_lshl_b32 s70, s87, 11
buffer_load_dwordx4 v[32:35], v18, s[4:7], s70 offen offset:3072
s_mov_b64 exec, 0x1fff
buffer_load_dword v81, v79, s[12:15], 0 offen
s_mov_b64 exec, -1
s_lshl_b32 s70, s64, 12
s_lshl_b32 s71, s66, 11
s_add_u32 s70, s70, s71
s_lshl_b32 s71, s65, 7
s_add_u32 s70, s70, s71
s_lshl_b32 s71, s67, 6
s_add_u32 s70, s70, s71
s_add_u32 s70, s70, 6881280
s_mov_b64 exec, 0xf
buffer_store_dwordx4 v[72:75], v18, s[12:15], s70 offen sc1
s_mov_b64 exec, -1
s_waitcnt vmcnt(21)
s_barrier
s_add_u32 m0, s77, 81920
s_nop 0
buffer_load_dwordx4 v12, s[8:11], s75 offen offset:0 lds
buffer_load_dwordx4 v13, s[8:11], s75 offen offset:1024 lds
buffer_load_dwordx4 v14, s[8:11], s75 offen offset:2048 lds
buffer_load_dwordx4 v15, s[8:11], s75 offen offset:3072 lds
s_add_u32 m0, s77, 86016
s_nop 0
buffer_load_dwordx4 v16, s[8:11], s75 offen offset:0 lds
buffer_load_dwordx4 v17, s[8:11], s75 offen offset:1024 lds
s_add_u32 s75, s75, 393216
s_cmp_eq_u32 s75, 6291456
s_cselect_b32 s75, 0, s75
s_add_u32 m0, s76, 106496
s_nop 0
buffer_load_dwordx4 v8, s[4:7], s74 offen offset:0 lds
buffer_load_dwordx4 v9, s[4:7], s74 offen offset:1024 lds
buffer_load_dwordx4 v10, s[4:7], s74 offen offset:2048 lds
buffer_load_dwordx4 v11, s[4:7], s74 offen offset:3072 lds
s_add_u32 s74, s74, 128
s_and_b32 s74, s74, 2047
s_waitcnt vmcnt(21)
s_barrier
s_add_u32 m0, s77, 40960
s_nop 0
buffer_load_dwordx4 v12, s[8:11], s75 offen offset:0 lds
s_waitcnt vmcnt(13)
v_readfirstlane_b32 s68, v19
s_nop 0
s_add_u32 s68, s68, 1
s_and_b32 s84, s68, 0xff
s_not_b32 s70, s68
v_and_b32 v82, 3, v1
v_lshrrev_b32_e64 v82, v82, s70
v_and_b32 v82, 1, v82
v_mul_u32_u24 v82, 0x10001, v82
buffer_load_dwordx4 v13, s[8:11], s75 offen offset:1024 lds
v_lshlrev_b32 v36, 16, v20
v_and_b32 v37, 0xffff0000, v20
v_lshlrev_b32 v38, 16, v21
v_and_b32 v39, 0xffff0000, v21
v_lshlrev_b32 v40, 16, v22
buffer_load_dwordx4 v14, s[8:11], s75 offen offset:2048 lds
v_and_b32 v41, 0xffff0000, v22
v_lshlrev_b32 v42, 16, v23
v_and_b32 v43, 0xffff0000, v23
v_lshlrev_b32 v44, 16, v24
v_and_b32 v45, 0xffff0000, v24
buffer_load_dwordx4 v15, s[8:11], s75 offen offset:3072 lds
v_lshlrev_b32 v46, 16, v25
v_and_b32 v47, 0xffff0000, v25
v_lshlrev_b32 v48, 16, v26
v_and_b32 v49, 0xffff0000, v26
v_lshlrev_b32 v50, 16, v27
s_add_u32 m0, s77, 45056
s_nop 0
buffer_load_dwordx4 v16, s[8:11], s75 offen offset:0 lds
v_and_b32 v51, 0xffff0000, v27
v_lshlrev_b32 v52, 16, v28
v_and_b32 v53, 0xffff0000, v28
v_lshlrev_b32 v54, 16, v29
v_and_b32 v55, 0xffff0000, v29
buffer_load_dwordx4 v17, s[8:11], s75 offen offset:1024 lds
s_add_u32 s75, s75, 393216
s_cmp_eq_u32 s75, 6291456
s_cselect_b32 s75, 0, s75
v_lshlrev_b32 v56, 16, v30
v_and_b32 v57, 0xffff0000, v30
v_lshlrev_b32 v58, 16, v31
v_and_b32 v59, 0xffff0000, v31
v_lshlrev_b32 v60, 16, v32
s_add_u32 m0, s76, 65536
s_nop 0
buffer_load_dwordx4 v8, s[4:7], s74 offen offset:0 lds
v_and_b32 v61, 0xffff0000, v32
v_lshlrev_b32 v62, 16, v33
v_and_b32 v63, 0xffff0000, v33
v_lshlrev_b32 v64, 16, v34
v_and_b32 v65, 0xffff0000, v34
buffer_load_dwordx4 v9, s[4:7], s74 offen offset:1024 lds
v_lshlrev_b32 v66, 16, v35
v_and_b32 v67, 0xffff0000, v35
v_add_f32 v20, v36, v40
v_add_f32 v28, v52, v56
v_add_f32 v21, v37, v41
buffer_load_dwordx4 v10, s[4:7], s74 offen offset:2048 lds
v_add_f32 v29, v53, v57
v_add_f32 v22, v38, v42
v_add_f32 v30, v54, v58
v_add_f32 v23, v39, v43
v_add_f32 v31, v55, v59
buffer_load_dwordx4 v11, s[4:7], s74 offen offset:3072 lds
s_add_u32 s74, s74, 128
s_and_b32 s74, s74, 2047
v_add_f32 v20, v20, v44
v_add_f32 v28, v28, v60
s_waitcnt vmcnt(14)
s_barrier
s_add_u32 m0, s77, 0
s_nop 0
buffer_load_dwordx4 v12, s[8:11], s75 offen offset:0 lds
v_add_f32 v21, v21, v45
v_add_f32 v29, v29, v61
v_add_f32 v22, v22, v46
v_add_f32 v30, v30, v62
v_add_f32 v23, v23, v47
buffer_load_dwordx4 v13, s[8:11], s75 offen offset:1024 lds
v_add_f32 v31, v31, v63
v_add_f32 v20, v20, v48
v_add_f32 v28, v28, v64
v_add_f32 v21, v21, v49
v_add_f32 v29, v29, v65
buffer_load_dwordx4 v14, s[8:11], s75 offen offset:2048 lds
v_add_f32 v22, v22, v50
v_add_f32 v30, v30, v66
v_add_f32 v23, v23, v51
v_add_f32 v31, v31, v67
v_add_f32 v20, v20, v21
buffer_load_dwordx4 v15, s[8:11], s75 offen offset:3072 lds
v_add_f32 v22, v22, v23
v_add_f32 v28, v28, v29
v_add_f32 v30, v30, v31
v_add_f32 v2, v20, v22
v_add_f32 v4, v28, v30
s_add_u32 m0, s77, 4096
s_nop 0
buffer_load_dwordx4 v16, s[8:11], s75 offen offset:0 lds
v_add_f32_dpp v2, v2, v2 row_ror:1 row_mask:0xf bank_mask:0xf
v_add_f32_dpp v4, v4, v4 row_ror:1 row_mask:0xf bank_mask:0xf
s_nop 0
v_add_f32_dpp v2, v2, v2 row_ror:2 row_mask:0xf bank_mask:0xf
v_add_f32_dpp v4, v4, v4 row_ror:2 row_mask:0xf bank_mask:0xf
s_nop 0
v_add_f32_dpp v2, v2, v2 row_ror:4 row_mask:0xf bank_mask:0xf
buffer_load_dwordx4 v17, s[8:11], s75 offen offset:1024 lds
s_add_u32 s75, s75, 393216
s_cmp_eq_u32 s75, 6291456
s_cselect_b32 s75, 0, s75
v_add_f32_dpp v4, v4, v4 row_ror:4 row_mask:0xf bank_mask:0xf
v_add_f32_dpp v2, v2, v2 row_ror:8 row_mask:0xf bank_mask:0xf
s_nop 0
v_add_f32_dpp v4, v4, v4 row_ror:8 row_mask:0xf bank_mask:0xf
v_mov_b32 v6, v2
v_mov_b32 v7, v4
s_add_u32 m0, s76, 24576
s_nop 0
buffer_load_dwordx4 v8, s[4:7], s74 offen offset:0 lds
v_permlane16_swap_b32 v2, v6
v_permlane16_swap_b32 v4, v7
v_add_f32 v2, v2, v6
v_add_f32 v4, v4, v7
v_mov_b32 v6, v2
buffer_load_dwordx4 v9, s[4:7], s74 offen offset:1024 lds
v_mov_b32 v7, v4
v_permlane32_swap_b32 v2, v6
s_nop 0
v_permlane32_swap_b32 v4, v7
v_add_f32 v2, v2, v6
v_add_f32 v4, v4, v7
buffer_load_dwordx4 v10, s[4:7], s74 offen offset:2048 lds
v_mul_f32 v2, 0xba800000, v2
v_mul_f32 v4, 0xba800000, v4
v_add_f32 v36, v36, v2
v_add_f32 v52, v52, v4
v_add_f32 v37, v37, v2
buffer_load_dwordx4 v11, s[4:7], s74 offen offset:3072 lds
s_add_u32 s74, s74, 128
s_and_b32 s74, s74, 2047
v_add_f32 v53, v53, v4
v_add_f32 v38, v38, v2
s_waitcnt vmcnt(14)
s_barrier
s_add_u32 m0, s77, 81920
s_nop 0
buffer_load_dwordx4 v12, s[8:11], s75 offen offset:0 lds
v_add_f32 v54, v54, v4
v_add_f32 v39, v39, v2
v_add_f32 v55, v55, v4
v_add_f32 v40, v40, v2
v_add_f32 v56, v56, v4
buffer_load_dwordx4 v13, s[8:11], s75 offen offset:1024 lds
v_add_f32 v41, v41, v2
v_add_f32 v57, v57, v4
v_add_f32 v42, v42, v2
v_add_f32 v58, v58, v4
v_add_f32 v43, v43, v2
buffer_load_dwordx4 v14, s[8:11], s75 offen offset:2048 lds
v_add_f32 v59, v59, v4
v_add_f32 v44, v44, v2
v_add_f32 v60, v60, v4
v_add_f32 v45, v45, v2
v_add_f32 v61, v61, v4
buffer_load_dwordx4 v15, s[8:11], s75 offen offset:3072 lds
v_add_f32 v46, v46, v2
v_add_f32 v62, v62, v4
v_add_f32 v47, v47, v2
v_add_f32 v63, v63, v4
v_add_f32 v48, v48, v2
s_add_u32 m0, s77, 86016
s_nop 0
buffer_load_dwordx4 v16, s[8:11], s75 offen offset:0 lds
v_add_f32 v64, v64, v4
v_add_f32 v49, v49, v2
v_add_f32 v65, v65, v4
v_add_f32 v50, v50, v2
v_add_f32 v66, v66, v4
buffer_load_dwordx4 v17, s[8:11], s75 offen offset:1024 lds
s_add_u32 s75, s75, 393216
s_cmp_eq_u32 s75, 6291456
s_cselect_b32 s75, 0, s75
v_add_f32 v51, v51, v2
v_add_f32 v67, v67, v4
v_mul_f32 v20, v36, v36
v_mul_f32 v28, v52, v52
v_mul_f32 v21, v37, v37
s_add_u32 m0, s76, 122880
s_nop 0
buffer_load_dwordx4 v8, s[4:7], s74 offen offset:0 lds
v_mul_f32 v29, v53, v53
v_fmac_f32 v20, v38, v38
v_fmac_f32 v28, v54, v54
v_fmac_f32 v21, v39, v39
v_fmac_f32 v29, v55, v55
buffer_load_dwordx4 v9, s[4:7], s74 offen offset:1024 lds
v_fmac_f32 v20, v40, v40
v_fmac_f32 v28, v56, v56
v_fmac_f32 v21, v41, v41
v_fmac_f32 v29, v57, v57
v_fmac_f32 v20, v42, v42
buffer_load_dwordx4 v10, s[4:7], s74 offen offset:2048 lds
v_fmac_f32 v28, v58, v58
v_fmac_f32 v21, v43, v43
v_fmac_f32 v29, v59, v59
v_fmac_f32 v20, v44, v44
v_fmac_f32 v28, v60, v60
buffer_load_dwordx4 v11, s[4:7], s74 offen offset:3072 lds
s_add_u32 s74, s74, 128
s_and_b32 s74, s74, 2047
v_fmac_f32 v21, v45, v45
v_fmac_f32 v29, v61, v61
s_waitcnt vmcnt(14)
s_barrier
s_add_u32 m0, s77, 40960
s_nop 0
buffer_load_dwordx4 v12, s[8:11], s75 offen offset:0 lds
v_fmac_f32 v20, v46, v46
v_fmac_f32 v28, v62, v62
v_fmac_f32 v21, v47, v47
v_fmac_f32 v29, v63, v63
v_fmac_f32 v20, v48, v48
buffer_load_dwordx4 v13, s[8:11], s75 offen offset:1024 lds
v_fmac_f32 v28, v64, v64
v_fmac_f32 v21, v49, v49
v_fmac_f32 v29, v65, v65
v_fmac_f32 v20, v50, v50
v_fmac_f32 v28, v66, v66
buffer_load_dwordx4 v14, s[8:11], s75 offen offset:2048 lds
v_fmac_f32 v21, v51, v51
v_fmac_f32 v29, v67, v67
v_add_f32 v3, v20, v21
v_add_f32 v5, v28, v29
s_nop 0
v_add_f32_dpp v3, v3, v3 row_ror:1 row_mask:0xf bank_mask:0xf
buffer_load_dwordx4 v15, s[8:11], s75 offen offset:3072 lds
v_add_f32_dpp v5, v5, v5 row_ror:1 row_mask:0xf bank_mask:0xf
v_add_f32_dpp v3, v3, v3 row_ror:2 row_mask:0xf bank_mask:0xf
s_nop 0
v_add_f32_dpp v5, v5, v5 row_ror:2 row_mask:0xf bank_mask:0xf
v_add_f32_dpp v3, v3, v3 row_ror:4 row_mask:0xf bank_mask:0xf
s_nop 0
v_add_f32_dpp v5, v5, v5 row_ror:4 row_mask:0xf bank_mask:0xf
s_add_u32 m0, s77, 45056
s_nop 0
buffer_load_dwordx4 v16, s[8:11], s75 offen offset:0 lds
v_add_f32_dpp v3, v3, v3 row_ror:8 row_mask:0xf bank_mask:0xf
v_add_f32_dpp v5, v5, v5 row_ror:8 row_mask:0xf bank_mask:0xf
v_mov_b32 v6, v3
v_mov_b32 v7, v5
s_nop 0
v_permlane16_swap_b32 v3, v6
buffer_load_dwordx4 v17, s[8:11], s75 offen offset:1024 lds
s_add_u32 s75, s75, 393216
s_cmp_eq_u32 s75, 6291456
s_cselect_b32 s75, 0, s75
v_permlane16_swap_b32 v5, v7
v_add_f32 v3, v3, v6
v_add_f32 v5, v5, v7
v_mov_b32 v6, v3
v_mov_b32 v7, v5
s_add_u32 m0, s76, 106496
s_nop 0
buffer_load_dwordx4 v8, s[4:7], s74 offen offset:0 lds
v_permlane32_swap_b32 v3, v6
v_permlane32_swap_b32 v5, v7
v_add_f32 v3, v3, v6
v_add_f32 v5, v5, v7
v_mov_b32 v6, 0x3727c5ac
buffer_load_dwordx4 v9, s[4:7], s74 offen offset:1024 lds
v_fmac_f32 v6, 0x3a800000, v3
v_rsq_f32 v3, v6
v_mov_b32 v6, 0x3727c5ac
v_fmac_f32 v6, 0x3a800000, v5
v_rsq_f32 v5, v6
buffer_load_dwordx4 v10, s[4:7], s74 offen offset:2048 lds
v_cmp_eq_u32 vcc, 1, v1
s_nop 1
v_cndmask_b32 v20, v2, v4, vcc
v_cndmask_b32 v21, v3, v5, vcc
v_mov_b32 v22, 0
v_mov_b32 v23, s68
buffer_load_dwordx4 v11, s[4:7], s74 offen offset:3072 lds
s_add_u32 s74, s74, 128
s_and_b32 s74, s74, 2047
buffer_load_dwordx4 a[0:3], v76, s[24:27], s85 offen nt
buffer_load_dwordx4 a[32:35], v76, s[28:31], s85 offen nt
s_add_u32 s85, s85, 57344
buffer_load_dwordx4 a[4:7], v76, s[24:27], s85 offen nt
s_lshl_b32 s70, s87, 4
s_add_u32 s70, s70, 8192
s_mov_b64 exec, 3
buffer_store_dwordx4 v[20:23], v18, s[12:15], s70 offen sc1
s_mov_b64 exec, -1
s_waitcnt vmcnt(18)
s_barrier
s_add_u32 m0, s77, 0
s_nop 0
buffer_load_dwordx4 v12, s[8:11], s75 offen offset:0 lds
buffer_load_dwordx4 v13, s[8:11], s75 offen offset:1024 lds
buffer_load_dwordx4 v14, s[8:11], s75 offen offset:2048 lds
buffer_load_dwordx4 v15, s[8:11], s75 offen offset:3072 lds
s_add_u32 m0, s77, 4096
s_nop 0
buffer_load_dwordx4 v16, s[8:11], s75 offen offset:0 lds
buffer_load_dwordx4 v17, s[8:11], s75 offen offset:1024 lds
s_add_u32 s75, s75, 393216
s_cmp_eq_u32 s75, 6291456
s_cselect_b32 s75, 0, s75
s_add_u32 m0, s76, 65536
s_nop 0
buffer_load_dwordx4 v8, s[4:7], s74 offen offset:0 lds
buffer_load_dwordx4 v9, s[4:7], s74 offen offset:1024 lds
buffer_load_dwordx4 v10, s[4:7], s74 offen offset:2048 lds
buffer_load_dwordx4 v11, s[4:7], s74 offen offset:3072 lds
s_add_u32 s74, s74, 128
s_and_b32 s74, s74, 2047
buffer_load_dwordx4 a[36:39], v76, s[28:31], s85 offen nt
s_add_u32 s85, s85, 57344
buffer_load_dwordx4 a[8:11], v76, s[24:27], s85 offen nt
buffer_load_dwordx4 a[40:43], v76, s[28:31], s85 offen nt
s_add_u32 s85, s85, 57344
s_waitcnt vmcnt(21)
s_barrier
s_add_u32 m0, s77, 81920
s_nop 0
buffer_load_dwordx4 v12, s[8:11], s75 offen offset:0 lds
s_getreg_b32 s71, hwreg(HW_REG_XCC_ID, 0, 4)
v_mov_b32 v84, s71
buffer_load_dwordx4 v13, s[8:11], s75 offen offset:1024 lds
v_mov_b32 v85, 0
buffer_load_dwordx4 v14, s[8:11], s75 offen offset:2048 lds
v_mov_b32 v86, 0
buffer_load_dwordx4 v15, s[8:11], s75 offen offset:3072 lds
v_mov_b32 v87, s68
s_add_u32 m0, s77, 86016
s_nop 0
buffer_load_dwordx4 v16, s[8:11], s75 offen offset:0 lds
buffer_load_dwordx4 v17, s[8:11], s75 offen offset:1024 lds
s_add_u32 s75, s75, 393216
s_cmp_eq_u32 s75, 6291456
s_cselect_b32 s75, 0, s75
s_add_u32 m0, s76, 24576
s_nop 0
buffer_load_dwordx4 v8, s[4:7], s74 offen offset:0 lds
buffer_load_dwordx4 v9, s[4:7], s74 offen offset:1024 lds
buffer_load_dwordx4 v10, s[4:7], s74 offen offset:2048 lds
buffer_load_dwordx4 v11, s[4:7], s74 offen offset:3072 lds
s_add_u32 s74, s74, 128
s_and_b32 s74, s74, 2047
buffer_load_dwordx4 a[12:15], v76, s[24:27], s85 offen nt
buffer_load_dwordx4 a[44:47], v76, s[28:31], s85 offen nt
s_add_u32 s85, s85, 57344
buffer_load_dwordx4 a[16:19], v76, s[24:27], s85 offen nt
s_lshl_b32 s70, s79, 4
s_add_u32 s70, s70, 4096
s_mov_b64 exec, 1
buffer_store_dwordx4 v[84:87], v18, s[12:15], s70 offen sc1
s_mov_b64 exec, -1
s_waitcnt vmcnt(21)
s_barrier
s_add_u32 m0, s77, 40960
s_nop 0
buffer_load_dwordx4 v12, s[8:11], s75 offen offset:0 lds
buffer_load_dwordx4 v13, s[8:11], s75 offen offset:1024 lds
buffer_load_dwordx4 v14, s[8:11], s75 offen offset:2048 lds
buffer_load_dwordx4 v15, s[8:11], s75 offen offset:3072 lds
s_add_u32 m0, s77, 45056
s_nop 0
buffer_load_dwordx4 v16, s[8:11], s75 offen offset:0 lds
buffer_load_dwordx4 v17, s[8:11], s75 offen offset:1024 lds
s_add_u32 s75, s75, 393216
s_cmp_eq_u32 s75, 6291456
s_cselect_b32 s75, 0, s75
s_add_u32 m0, s76, 122880
s_nop 0
buffer_load_dwordx4 v8, s[4:7], s74 offen offset:0 lds
buffer_load_dwordx4 v9, s[4:7], s74 offen offset:1024 lds
buffer_load_dwordx4 v10, s[4:7], s74 offen offset:2048 lds
buffer_load_dwordx4 v11, s[4:7], s74 offen offset:3072 lds
s_add_u32 s74, s74, 128
s_and_b32 s74, s74, 2047
buffer_load_dwordx4 a[48:51], v76, s[28:31], s85 offen nt
s_add_u32 s85, s85, 57344
buffer_load_dwordx4 a[20:23], v76, s[24:27], s85 offen nt
buffer_load_dwordx4 a[52:55], v76, s[28:31], s85 offen nt
s_add_u32 s85, s85, 57344
s_waitcnt vmcnt(21)
s_barrier
s_add_u32 m0, s77, 0
s_nop 0
buffer_load_dwordx4 v12, s[8:11], s75 offen offset:0 lds
buffer_load_dwordx4 v13, s[8:11], s75 offen offset:1024 lds
buffer_load_dwordx4 v14, s[8:11], s75 offen offset:2048 lds
buffer_load_dwordx4 v15, s[8:11], s75 offen offset:3072 lds
s_add_u32 m0, s77, 4096
s_nop 0
buffer_load_dwordx4 v16, s[8:11], s75 offen offset:0 lds
buffer_load_dwordx4 v17, s[8:11], s75 offen offset:1024 lds
s_add_u32 s75, s75, 393216
s_cmp_eq_u32 s75, 6291456
s_cselect_b32 s75, 0, s75
s_add_u32 m0, s76, 106496
s_nop 0
buffer_load_dwordx4 v8, s[4:7], s74 offen offset:0 lds
buffer_load_dwordx4 v9, s[4:7], s74 offen offset:1024 lds
buffer_load_dwordx4 v10, s[4:7], s74 offen offset:2048 lds
buffer_load_dwordx4 v11, s[4:7], s74 offen offset:3072 lds
s_add_u32 s74, s74, 128
s_and_b32 s74, s74, 2047
buffer_load_dwordx4 a[24:27], v76, s[24:27], s85 offen nt
buffer_load_dwordx4 a[56:59], v76, s[28:31], s85 offen nt
s_add_u32 s85, s85, 57344
buffer_load_dwordx4 a[28:31], v76, s[24:27], s85 offen nt
buffer_load_dwordx4 a[60:63], v76, s[28:31], s85 offen nt
s_add_u32 s85, s85, 57344
s_waitcnt vmcnt(21)
s_barrier
s_add_u32 m0, s77, 81920
s_nop 0
buffer_load_dwordx4 v12, s[8:11], s75 offen offset:0 lds
v_lshrrev_b32 v2, 4, v1
v_and_b32 v3, 15, v1
buffer_load_dwordx4 v13, s[8:11], s75 offen offset:1024 lds
v_lshlrev_b32 v44, 10, v2
v_lshl_add_u32 v44, v3, 4, v44
buffer_load_dwordx4 v14, s[8:11], s75 offen offset:2048 lds
s_lshl_b32 s70, s60, 8
v_add_u32 v44, s70, v44
s_lshl_b32 s87, s64, 14
s_add_u32 s87, s87, 65536
buffer_load_dwordx4 v15, s[8:11], s75 offen offset:3072 lds
v_and_b32 v45, 31, v1
v_lshlrev_b32 v45, 4, v45
s_add_u32 m0, s77, 86016
s_nop 0
buffer_load_dwordx4 v16, s[8:11], s75 offen offset:0 lds
s_lshl_b32 s88, s65, 11
s_lshl_b32 s70, s60, 9
s_add_u32 s88, s88, s70
s_add_u32 s88, s88, 8192
s_lshl_b32 s70, s64, 8
s_add_u32 s70, s70, 4096
v_lshlrev_b32 v4, 4, v3
v_add_u32 v4, s70, v4
buffer_load_dwordx4 v17, s[8:11], s75 offen offset:1024 lds
s_add_u32 s75, s75, 393216
s_cmp_eq_u32 s75, 6291456
s_cselect_b32 s75, 0, s75
s_lshl_b32 s70, s64, 4
s_add_u32 s70, s70, 4096
v_lshlrev_b32 v5, 8, v3
v_add_u32 v5, s70, v5
v_and_b32 v6, 1, v2
s_add_u32 m0, s76, 65536
s_nop 0
buffer_load_dwordx4 v8, s[4:7], s74 offen offset:0 lds
v_cmp_eq_u32 vcc, 1, v6
s_nop 1
v_cndmask_b32 v46, v4, v5, vcc
buffer_load_dwordx4 v9, s[4:7], s74 offen offset:1024 lds
buffer_load_dwordx4 v10, s[4:7], s74 offen offset:2048 lds
buffer_load_dwordx4 v11, s[4:7], s74 offen offset:3072 lds
s_add_u32 s74, s74, 128
s_and_b32 s74, s74, 2047
s_add_u32 s70, s87, 0
buffer_load_dwordx4 v[20:23], v44, s[12:15], s70 offen sc1
s_add_u32 s70, s87, 4096
buffer_load_dwordx4 v[24:27], v44, s[12:15], s70 offen sc1
s_add_u32 s70, s87, 8192
buffer_load_dwordx4 v[28:31], v44, s[12:15], s70 offen sc1
s_add_u32 s70, s87, 12288
buffer_load_dwordx4 v[32:35], v44, s[12:15], s70 offen sc1
buffer_load_dwordx4 v[36:39], v45, s[12:15], s88 offen sc1
buffer_load_dwordx4 v[40:43], v46, s[12:15], 0 offen offset:0 sc1
buffer_load_dwordx4 a[64:67], v77, s[32:35], s86 offen offset:0 nt
buffer_load_dwordx4 a[68:71], v77, s[32:35], s86 offen offset:2048 nt
buffer_load_dwordx4 a[72:75], v78, s[32:35], s86 offen offset:0 nt
s_waitcnt vmcnt(27)
s_barrier
s_add_u32 m0, s77, 40960
s_nop 0
buffer_load_dwordx4 v12, s[8:11], s75 offen offset:0 lds
buffer_load_dwordx4 v13, s[8:11], s75 offen offset:1024 lds
buffer_load_dwordx4 v14, s[8:11], s75 offen offset:2048 lds
buffer_load_dwordx4 v15, s[8:11], s75 offen offset:3072 lds
s_add_u32 m0, s77, 45056
s_nop 0
buffer_load_dwordx4 v16, s[8:11], s75 offen offset:0 lds
buffer_load_dwordx4 v17, s[8:11], s75 offen offset:1024 lds
s_add_u32 s75, s75, 393216
s_cmp_eq_u32 s75, 6291456
s_cselect_b32 s75, 0, s75
s_add_u32 m0, s76, 24576
s_nop 0
buffer_load_dwordx4 v8, s[4:7], s74 offen offset:0 lds
buffer_load_dwordx4 v9, s[4:7], s74 offen offset:1024 lds
buffer_load_dwordx4 v10, s[4:7], s74 offen offset:2048 lds
buffer_load_dwordx4 v11, s[4:7], s74 offen offset:3072 lds
s_add_u32 s74, s74, 128
s_and_b32 s74, s74, 2047
buffer_load_dwordx4 a[76:79], v78, s[32:35], s86 offen offset:2048 nt
buffer_load_dwordx4 a[80:83], v77, s[32:35], s86 offen offset:256 nt
buffer_load_dwordx4 a[84:87], v77, s[32:35], s86 offen offset:2304 nt
buffer_load_dwordx4 a[88:91], v78, s[32:35], s86 offen offset:256 nt
buffer_load_dwordx4 a[92:95], v78, s[32:35], s86 offen offset:2304 nt
s_waitcnt vmcnt(28)
s_barrier
s_add_u32 m0, s77, 0
s_nop 0
buffer_load_dwordx4 v12, s[8:11], s75 offen offset:0 lds
s_waitcnt vmcnt(19)
L_eg_chk:
v_xor_b32 v2, s68, v23
v_xor_b32 v3, s68, v27
v_xor_b32 v4, s68, v31
v_or3_b32 v2, v2, v3, v4
v_xor_b32 v3, s68, v35
v_xor_b32 v4, s68, v39
v_or3_b32 v2, v2, v3, v4
v_xor_b32 v3, s68, v43
v_or_b32 v2, v2, v3
v_cmp_ne_u32 vcc, 0, v2
s_cbranch_vccnz L_eg_rt
L_eg_ok:
v_add_f32 v20, v20, v24
buffer_load_dwordx4 v13, s[8:11], s75 offen offset:1024 lds
v_add_f32 v28, v28, v32
v_add_f32 v21, v21, v25
buffer_load_dwordx4 v14, s[8:11], s75 offen offset:2048 lds
v_add_f32 v29, v29, v33
v_add_f32 v22, v22, v26
buffer_load_dwordx4 v15, s[8:11], s75 offen offset:3072 lds
v_add_f32 v30, v30, v34
v_add_f32 v20, v20, v28
s_add_u32 m0, s77, 4096
s_nop 0
buffer_load_dwordx4 v16, s[8:11], s75 offen offset:0 lds
v_add_f32 v21, v21, v29
v_add_f32 v22, v22, v30
buffer_load_dwordx4 v17, s[8:11], s75 offen offset:1024 lds
s_add_u32 s75, s75, 393216
s_cmp_eq_u32 s75, 6291456
s_cselect_b32 s75, 0, s75
v_mov_b32 v24, v20
v_mov_b32 v25, v21
s_mul_i32 s70, s60, 9
s_add_u32 s70, s70, 92
s_lshl_b32 s82, s89, 3
s_add_u32 s82, s82, s70
s_lshl_b32 s70, s70, 10
s_add_u32 m0, s70, 28672
s_and_b32 s82, s82, 127
s_lshl_b32 s82, s82, 14
buffer_load_dwordx4 v80, s[16:19], s82 offen lds
v_mov_b32 v26, v22
v_permlane16_swap_b32 v20, v24
s_add_u32 m0, m0, 1024
s_add_u32 s82, s82, 16384
s_and_b32 s82, s82, 0x1fffff
buffer_load_dwordx4 v80, s[16:19], s82 offen lds
v_permlane16_swap_b32 v21, v25
v_permlane16_swap_b32 v22, v26
s_add_u32 m0, m0, 1024
s_add_u32 s82, s82, 16384
s_and_b32 s82, s82, 0x1fffff
buffer_load_dwordx4 v80, s[16:19], s82 offen lds
v_add_f32 v20, v20, v24
v_add_f32 v21, v21, v25
s_add_u32 m0, m0, 1024
s_add_u32 s82, s82, 16384
s_and_b32 s82, s82, 0x1fffff
buffer_load_dwordx4 v80, s[16:19], s82 offen lds
v_add_f32 v22, v22, v26
v_mov_b32 v24, v20
s_add_u32 m0, m0, 1024
s_add_u32 s82, s82, 16384
s_and_b32 s82, s82, 0x1fffff
buffer_load_dwordx4 v80, s[16:19], s82 offen lds
v_mov_b32 v25, v21
s_add_u32 m0, m0, 1024
s_add_u32 s82, s82, 16384
s_and_b32 s82, s82, 0x1fffff
buffer_load_dwordx4 v80, s[16:19], s82 offen lds
s_add_u32 m0, m0, 1024
s_add_u32 s82, s82, 16384
s_and_b32 s82, s82, 0x1fffff
buffer_load_dwordx4 v80, s[16:19], s82 offen lds
s_add_u32 m0, m0, 1024
s_add_u32 s82, s82, 16384
s_and_b32 s82, s82, 0x1fffff
buffer_load_dwordx4 v80, s[16:19], s82 offen lds
s_add_u32 m0, m0, 1024
s_add_u32 s82, s82, 16384
s_and_b32 s82, s82, 0x1fffff
buffer_load_dwordx4 v80, s[16:19], s82 offen lds
s_waitcnt vmcnt(24)
s_barrier
s_mul_i32 s70, s60, 10
s_add_u32 s70, s70, 52
s_lshl_b32 s82, s89, 3
s_add_u32 s82, s82, s70
s_lshl_b32 s70, s70, 10
s_add_u32 m0, s70, 28672
s_and_b32 s82, s82, 127
s_lshl_b32 s82, s82, 14
buffer_load_dwordx4 v80, s[16:19], s82 offen lds
v_mov_b32 v26, v22
v_permlane32_swap_b32 v20, v24
v_permlane32_swap_b32 v21, v25
s_add_u32 m0, m0, 1024
s_add_u32 s82, s82, 16384
s_and_b32 s82, s82, 0x1fffff
buffer_load_dwordx4 v80, s[16:19], s82 offen lds
v_permlane32_swap_b32 v22, v26
v_add_f32 v20, v20, v24
v_add_f32 v21, v21, v25
s_add_u32 m0, m0, 1024
s_add_u32 s82, s82, 16384
s_and_b32 s82, s82, 0x1fffff
buffer_load_dwordx4 v80, s[16:19], s82 offen lds
v_add_f32 v22, v22, v26
v_and_b32 v3, 15, v1
v_lshlrev_b32 v3, 2, v3
s_add_u32 m0, m0, 1024
s_add_u32 s82, s82, 16384
s_and_b32 s82, s82, 0x1fffff
buffer_load_dwordx4 v80, s[16:19], s82 offen lds
s_lshl_b32 s70, s60, 6
s_add_u32 s70, s70, 160768
v_add_u32 v3, s70, v3
ds_write_b32 v3, v20 offset:0
ds_write_b32 v3, v21 offset:256
s_add_u32 m0, m0, 1024
s_add_u32 s82, s82, 16384
s_and_b32 s82, s82, 0x1fffff
buffer_load_dwordx4 v80, s[16:19], s82 offen lds
ds_write_b32 v3, v22 offset:512
v_lshrrev_b32 v4, 2, v45
s_lshl_b32 s70, s60, 7
s_add_u32 s70, s70, 159744
v_add_u32 v4, s70, v4
s_add_u32 m0, m0, 1024
s_add_u32 s82, s82, 16384
s_and_b32 s82, s82, 0x1fffff
buffer_load_dwordx4 v80, s[16:19], s82 offen lds
ds_write_b32 v4, v36
ds_write_b32 v4, v37 offset:512
s_getreg_b32 s71, hwreg(HW_REG_XCC_ID, 0, 4)
v_cmp_ne_u32 vcc, s71, v40
s_nop 0
s_and_b32 s70, vcc_lo, 0xffff
s_cselect_b32 s69, 0, 1
s_add_u32 m0, m0, 1024
s_add_u32 s82, s82, 16384
s_and_b32 s82, s82, 0x1fffff
buffer_load_dwordx4 v80, s[16:19], s82 offen lds
v_mov_b32 v5, s69
v_mov_b32 v6, 161536
ds_write_b32 v6, v5
s_add_u32 m0, m0, 1024
s_add_u32 s82, s82, 16384
s_and_b32 s82, s82, 0x1fffff
buffer_load_dwordx4 v80, s[16:19], s82 offen lds
s_add_u32 m0, m0, 1024
s_add_u32 s82, s82, 16384
s_and_b32 s82, s82, 0x1fffff
buffer_load_dwordx4 v80, s[16:19], s82 offen lds
s_add_u32 m0, m0, 1024
s_add_u32 s82, s82, 16384
s_and_b32 s82, s82, 0x1fffff
buffer_load_dwordx4 v80, s[16:19], s82 offen lds
s_waitcnt vmcnt(19)
s_barrier
s_mul_i32 s70, s60, 10
s_add_u32 s70, s70, 12
s_lshl_b32 s82, s89, 3
s_add_u32 s82, s82, s70
s_lshl_b32 s70, s70, 10
s_add_u32 m0, s70, 28672
s_and_b32 s82, s82, 127
s_lshl_b32 s82, s82, 14
buffer_load_dwordx4 v80, s[16:19], s82 offen lds
s_add_u32 m0, m0, 1024
s_add_u32 s82, s82, 16384
s_and_b32 s82, s82, 0x1fffff
buffer_load_dwordx4 v80, s[16:19], s82 offen lds
s_add_u32 m0, m0, 1024
s_add_u32 s82, s82, 16384
s_and_b32 s82, s82, 0x1fffff
buffer_load_dwordx4 v80, s[16:19], s82 offen lds
s_add_u32 m0, m0, 1024
s_add_u32 s82, s82, 16384
s_and_b32 s82, s82, 0x1fffff
buffer_load_dwordx4 v80, s[16:19], s82 offen lds
s_add_u32 m0, m0, 1024
s_add_u32 s82, s82, 16384
s_and_b32 s82, s82, 0x1fffff
buffer_load_dwordx4 v80, s[16:19], s82 offen lds
s_add_u32 m0, m0, 1024
s_add_u32 s82, s82, 16384
s_and_b32 s82, s82, 0x1fffff
buffer_load_dwordx4 v80, s[16:19], s82 offen lds
s_add_u32 m0, m0, 1024
s_add_u32 s82, s82, 16384
s_and_b32 s82, s82, 0x1fffff
buffer_load_dwordx4 v80, s[16:19], s82 offen lds
s_add_u32 m0, m0, 1024
s_add_u32 s82, s82, 16384
s_and_b32 s82, s82, 0x1fffff
buffer_load_dwordx4 v80, s[16:19], s82 offen lds
s_add_u32 m0, m0, 1024
s_add_u32 s82, s82, 16384
s_and_b32 s82, s82, 0x1fffff
buffer_load_dwordx4 v80, s[16:19], s82 offen lds
s_add_u32 m0, m0, 1024
s_add_u32 s82, s82, 16384
s_and_b32 s82, s82, 0x1fffff
buffer_load_dwordx4 v80, s[16:19], s82 offen lds
s_setprio 0
s_waitcnt lgkmcnt(0)
s_barrier
s_mul_i32 s70, s60, 3
s_add_u32 s70, s70, 0
s_lshl_b32 s82, s89, 3
s_add_u32 s82, s82, s70
s_lshl_b32 s70, s70, 10
s_add_u32 m0, s70, 28672
s_and_b32 s82, s82, 127
s_lshl_b32 s82, s82, 14
buffer_load_dwordx4 v80, s[16:19], s82 offen lds
s_add_u32 m0, m0, 1024
s_add_u32 s82, s82, 16384
s_and_b32 s82, s82, 0x1fffff
buffer_load_dwordx4 v80, s[16:19], s82 offen lds
s_add_u32 m0, m0, 1024
s_add_u32 s82, s82, 16384
s_and_b32 s82, s82, 0x1fffff
buffer_load_dwordx4 v80, s[16:19], s82 offen lds
s_sub_i32 s70, s64, s65
s_lshl_b32 s70, s70, 18
v_add_u32 v8, s70, v8
v_add_u32 v9, s70, v9
v_add_u32 v10, s70, v10
v_add_u32 v11, s70, v11
s_lshl_b32 s70, s65, 7
s_mov_b32 m0, s76
s_nop 0
buffer_load_dwordx4 v8, s[4:7], s70 offen offset:0 lds
buffer_load_dwordx4 v9, s[4:7], s70 offen offset:1024 lds
buffer_load_dwordx4 v10, s[4:7], s70 offen offset:2048 lds
buffer_load_dwordx4 v11, s[4:7], s70 offen offset:3072 lds
v_lshrrev_b32 v2, 4, v1
v_bfe_u32 v3, v1, 2, 2
v_and_b32 v4, 1, v1
v_lshlrev_b32 v4, 4, v4
v_mov_b32 v5, 0x3f80
v_lshlrev_b32 v4, v4, v5
v_cmp_eq_u32 vcc, v2, v3
s_nop 1
v_cndmask_b32 v4, 0, v4, vcc
v_and_b32 v5, 2, v1
v_cmp_eq_u32 vcc, 0, v5
s_nop 1
v_cndmask_b32 v58, 0, v4, vcc
v_cndmask_b32_e64 v59, v4, 0, vcc
v_mov_b32 v56, 0
v_mov_b32 v57, 0
v_mov_b32 v60, 0
v_mov_b32 v61, 0
v_and_b32 v3, 15, v1
v_mul_u32_u24 v55, 4352, v3
v_lshrrev_b32 v2, 4, v1
v_lshl_add_u32 v55, v2, 5, v55
s_mul_i32 s87, s64, 69632
s_add_u32 s87, s87, 524288
s_lshl_b32 s70, s66, 7
s_lshl_b32 s71, s67, 4
s_add_u32 s88, s70, s71
s_add_u32 s88, s88, s87
s_add_u32 s88, s88, 4096
s_lshl_b32 s70, s60, 10
s_add_u32 s87, s87, s70
s_barrier
s_add_u32 s70, s65, 1
s_and_b32 s70, s70, 15
s_mul_i32 s70, s70, 4352
s_add_u32 s70, s70, s87
buffer_load_dwordx4 v[84:87], v18, s[12:15], s70 offen sc1
s_add_u32 s70, s65, 2
s_and_b32 s70, s70, 15
s_mul_i32 s70, s70, 4352
s_add_u32 s70, s70, s87
buffer_load_dwordx4 v[88:91], v18, s[12:15], s70 offen sc1
s_add_u32 s70, s65, 3
s_and_b32 s70, s70, 15
s_mul_i32 s70, s70, 4352
s_add_u32 s70, s70, s87
buffer_load_dwordx4 v[92:95], v18, s[12:15], s70 offen sc1
s_add_u32 s70, s65, 4
s_and_b32 s70, s70, 15
s_mul_i32 s70, s70, 4352
s_add_u32 s70, s70, s87
buffer_load_dwordx4 v[96:99], v18, s[12:15], s70 offen sc1
s_add_u32 s70, s65, 5
s_and_b32 s70, s70, 15
s_mul_i32 s70, s70, 4352
s_add_u32 s70, s70, s87
buffer_load_dwordx4 v[100:103], v18, s[12:15], s70 offen sc1
s_add_u32 s70, s65, 6
s_and_b32 s70, s70, 15
s_mul_i32 s70, s70, 4352
s_add_u32 s70, s70, s87
buffer_load_dwordx4 v[104:107], v18, s[12:15], s70 offen sc1
s_add_u32 s70, s65, 7
s_and_b32 s70, s70, 15
s_mul_i32 s70, s70, 4352
s_add_u32 s70, s70, s87
buffer_load_dwordx4 v[108:111], v18, s[12:15], s70 offen sc1
s_add_u32 s70, s65, 8
s_and_b32 s70, s70, 15
s_mul_i32 s70, s70, 4352
s_add_u32 s70, s70, s87
buffer_load_dwordx4 v[112:115], v18, s[12:15], s70 offen sc1
s_add_u32 s70, s65, 9
s_and_b32 s70, s70, 15
s_mul_i32 s70, s70, 4352
s_add_u32 s70, s70, s87
buffer_load_dwordx4 v[116:119], v18, s[12:15], s70 offen sc1
s_add_u32 s70, s65, 10
s_and_b32 s70, s70, 15
s_mul_i32 s70, s70, 4352
s_add_u32 s70, s70, s87
buffer_load_dwordx4 v[120:123], v18, s[12:15], s70 offen sc1
s_add_u32 s70, s65, 11
s_and_b32 s70, s70, 15
s_mul_i32 s70, s70, 4352
s_add_u32 s70, s70, s87
buffer_load_dwordx4 v[124:127], v18, s[12:15], s70 offen sc1
s_add_u32 s70, s65, 12
s_and_b32 s70, s70, 15
s_mul_i32 s70, s70, 4352
s_add_u32 s70, s70, s87
buffer_load_dwordx4 v[128:131], v18, s[12:15], s70 offen sc1
s_add_u32 s70, s65, 13
s_and_b32 s70, s70, 15
s_mul_i32 s70, s70, 4352
s_add_u32 s70, s70, s87
buffer_load_dwordx4 v[132:135], v18, s[12:15], s70 offen sc1
s_add_u32 s70, s65, 14
s_and_b32 s70, s70, 15
s_mul_i32 s70, s70, 4352
s_add_u32 s70, s70, s87
buffer_load_dwordx4 v[136:139], v18, s[12:15], s70 offen sc1
s_add_u32 s70, s65, 15
s_and_b32 s70, s70, 15
s_mul_i32 s70, s70, 4352
s_add_u32 s70, s70, s87
buffer_load_dwordx4 v[140:143], v18, s[12:15], s70 offen sc1
s_add_u32 s70, s65, 16
s_and_b32 s70, s70, 15
s_mul_i32 s70, s70, 4352
s_add_u32 s70, s70, s87
buffer_load_dwordx4 v[144:147], v18, s[12:15], s70 offen sc1
buffer_load_dwordx4 v[148:151], v55, s[12:15], s88 offen sc1
s_lshl_b32 s70, s66, 6
s_lshl_b32 s71, s67, 3
s_add_u32 s70, s70, s71
s_add_u32 s70, s70, 161600
v_lshrrev_b32 v4, 4, v1
v_lshlrev_b32 v4, 4, v4
v_add_u32 v4, s70, v4
s_lshl_b32 s70, s60, 10
s_add_u32 s70, s70, 24576
v_add_u32 v3, s70, v18
s_mov_b32 s73, 31
L_kvr:
s_bitcmp1_b32 s73, 0
s_cbranch_scc0 L_kvs0
s_waitcnt vmcnt(13)
v_max3_u32 v2, v84, v88, v92
v_max_u32 v2, v2, v96
v_cmp_eq_u32 vcc, -1, v2
s_cbranch_vccnz L_kvs0
s_bitset0_b32 s73, 0
v_mfma_f32_16x16x32_bf16 v[20:23], v[58:61], v[84:87], 0
v_mfma_f32_16x16x32_bf16 v[24:27], v[56:59], v[84:87], 0
v_mfma_f32_16x16x32_bf16 v[20:23], v[58:61], v[88:91], v[20:23]
v_mfma_f32_16x16x32_bf16 v[24:27], v[56:59], v[88:91], v[24:27]
v_mfma_f32_16x16x32_bf16 v[20:23], v[58:61], v[92:95], v[20:23]
v_mfma_f32_16x16x32_bf16 v[24:27], v[56:59], v[92:95], v[24:27]
v_mfma_f32_16x16x32_bf16 v[20:23], v[58:61], v[96:99], v[20:23]
v_mfma_f32_16x16x32_bf16 v[24:27], v[56:59], v[96:99], v[24:27]
L_kvs0:
s_bitcmp1_b32 s73, 1
s_cbranch_scc0 L_kvs1
s_waitcnt vmcnt(9)
v_max3_u32 v2, v100, v104, v108
v_max_u32 v2, v2, v112
v_cmp_eq_u32 vcc, -1, v2
s_cbranch_vccnz L_kvs1
s_bitset0_b32 s73, 1
v_mfma_f32_16x16x32_bf16 v[28:31], v[58:61], v[100:103], 0
v_mfma_f32_16x16x32_bf16 v[32:35], v[56:59], v[100:103], 0
v_mfma_f32_16x16x32_bf16 v[28:31], v[58:61], v[104:107], v[28:31]
v_mfma_f32_16x16x32_bf16 v[32:35], v[56:59], v[104:107], v[32:35]
v_mfma_f32_16x16x32_bf16 v[28:31], v[58:61], v[108:111], v[28:31]
v_mfma_f32_16x16x32_bf16 v[32:35], v[56:59], v[108:111], v[32:35]
v_mfma_f32_16x16x32_bf16 v[28:31], v[58:61], v[112:115], v[28:31]
v_mfma_f32_16x16x32_bf16 v[32:35], v[56:59], v[112:115], v[32:35]
L_kvs1:
s_bitcmp1_b32 s73, 2
s_cbranch_scc0 L_kvs2
s_waitcnt vmcnt(5)
v_max3_u32 v2, v116, v120, v124
v_max_u32 v2, v2, v128
v_cmp_eq_u32 vcc, -1, v2
s_cbranch_vccnz L_kvs2
s_bitset0_b32 s73, 2
v_mfma_f32_16x16x32_bf16 v[36:39], v[58:61], v[116:119], 0
v_mfma_f32_16x16x32_bf16 v[40:43], v[56:59], v[116:119], 0
v_mfma_f32_16x16x32_bf16 v[36:39], v[58:61], v[120:123], v[36:39]
v_mfma_f32_16x16x32_bf16 v[40:43], v[56:59], v[120:123], v[40:43]
v_mfma_f32_16x16x32_bf16 v[36:39], v[58:61], v[124:127], v[36:39]
v_mfma_f32_16x16x32_bf16 v[40:43], v[56:59], v[124:127], v[40:43]
v_mfma_f32_16x16x32_bf16 v[36:39], v[58:61], v[128:131], v[36:39]
v_mfma_f32_16x16x32_bf16 v[40:43], v[56:59], v[128:131], v[40:43]
L_kvs2:
s_bitcmp1_b32 s73, 3
s_cbranch_scc0 L_kvs3
s_waitcnt vmcnt(1)
v_max3_u32 v2, v132, v136, v140
v_max_u32 v2, v2, v144
v_cmp_eq_u32 vcc, -1, v2
s_cbranch_vccnz L_kvs3
s_bitset0_b32 s73, 3
v_mfma_f32_16x16x32_bf16 v[44:47], v[58:61], v[132:135], 0
v_mfma_f32_16x16x32_bf16 v[48:51], v[56:59], v[132:135], 0
v_mfma_f32_16x16x32_bf16 v[44:47], v[58:61], v[136:139], v[44:47]
v_mfma_f32_16x16x32_bf16 v[48:51], v[56:59], v[136:139], v[48:51]
v_mfma_f32_16x16x32_bf16 v[44:47], v[58:61], v[140:143], v[44:47]
v_mfma_f32_16x16x32_bf16 v[48:51], v[56:59], v[140:143], v[48:51]
v_mfma_f32_16x16x32_bf16 v[44:47], v[58:61], v[144:147], v[44:47]
v_mfma_f32_16x16x32_bf16 v[48:51], v[56:59], v[144:147], v[48:51]
L_kvs3:
s_bitcmp1_b32 s73, 4
s_cbranch_scc0 L_kvs4
s_waitcnt vmcnt(0)
v_xor_b32 v148, s84, v148
v_xor_b32 v149, s84, v149
v_xor_b32 v150, s84, v150
v_xor_b32 v151, s84, v151
v_or3_b32 v2, v148, v149, v150
v_bitop3_b32 v2, v2, v151, s91 bitop3:0xa8
v_cmp_ne_u32 vcc, 0, v2
s_cbranch_vccnz L_kvs4
s_bitset0_b32 s73, 4
v_add_f32_dpp v148, v148, v148 row_ror:1 row_mask:0xf bank_mask:0xf
v_add_f32_dpp v149, v149, v149 row_ror:1 row_mask:0xf bank_mask:0xf
v_add_f32_dpp v150, v150, v150 row_ror:1 row_mask:0xf bank_mask:0xf
v_add_f32_dpp v151, v151, v151 row_ror:1 row_mask:0xf bank_mask:0xf
v_add_f32_dpp v148, v148, v148 row_ror:2 row_mask:0xf bank_mask:0xf
v_add_f32_dpp v149, v149, v149 row_ror:2 row_mask:0xf bank_mask:0xf
v_add_f32_dpp v150, v150, v150 row_ror:2 row_mask:0xf bank_mask:0xf
v_add_f32_dpp v151, v151, v151 row_ror:2 row_mask:0xf bank_mask:0xf
v_add_f32_dpp v148, v148, v148 row_ror:4 row_mask:0xf bank_mask:0xf
v_add_f32_dpp v149, v149, v149 row_ror:4 row_mask:0xf bank_mask:0xf
v_add_f32_dpp v150, v150, v150 row_ror:4 row_mask:0xf bank_mask:0xf
v_add_f32_dpp v151, v151, v151 row_ror:4 row_mask:0xf bank_mask:0xf
v_add_f32_dpp v148, v148, v148 row_ror:8 row_mask:0xf bank_mask:0xf
v_add_f32_dpp v149, v149, v149 row_ror:8 row_mask:0xf bank_mask:0xf
v_add_f32_dpp v150, v150, v150 row_ror:8 row_mask:0xf bank_mask:0xf
v_add_f32_dpp v151, v151, v151 row_ror:8 row_mask:0xf bank_mask:0xf
v_cvt_pk_bf16_f32 v148, v148, v149
v_cvt_pk_bf16_f32 v149, v150, v151
ds_write_b64 v4, v[148:149]
L_kvs4:
s_cmp_lg_u32 s73, 0
s_cbranch_scc1 L_kvrt
L_kvok:
s_nop 3
v_pk_add_f32 v[20:21], v[20:21], v[28:29]
v_pk_add_f32 v[22:23], v[22:23], v[30:31]
v_pk_add_f32 v[24:25], v[24:25], v[32:33]
v_pk_add_f32 v[26:27], v[26:27], v[34:35]
v_pk_add_f32 v[36:37], v[36:37], v[44:45]
v_pk_add_f32 v[38:39], v[38:39], v[46:47]
v_pk_add_f32 v[40:41], v[40:41], v[48:49]
v_pk_add_f32 v[42:43], v[42:43], v[50:51]
v_pk_add_f32 v[20:21], v[20:21], v[36:37]
v_pk_add_f32 v[22:23], v[22:23], v[38:39]
v_pk_add_f32 v[24:25], v[24:25], v[40:41]
v_pk_add_f32 v[26:27], v[26:27], v[42:43]
v_cvt_pk_bf16_f32 v20, v20, v21
v_cvt_pk_bf16_f32 v21, v22, v23
v_cvt_pk_bf16_f32 v22, v24, v25
v_cvt_pk_bf16_f32 v23, v26, v27
ds_write_b128 v3, v[20:23]
s_waitcnt lgkmcnt(0)
s_barrier
s_mov_b32 exec_lo, 0x0
s_mov_b32 exec_hi, 0x3f000000
buffer_load_dword v81, v83, s[12:15], 0 offen
s_mov_b64 exec, -1
s_barrier
s_cmp_ge_u32 s64, 14
s_cbranch_scc1 L_noprep0
v_lshrrev_b32 v2, 5, v1
v_lshlrev_b32 v2, 11, v2
v_bfe_u32 v3, v1, 3, 2
v_lshl_add_u32 v2, v3, 7, v2
v_bfe_u32 v3, v1, 4, 1
v_bfe_u32 v4, v1, 1, 2
v_xor_b32 v3, v3, v4
v_lshl_add_u32 v2, v3, 5, v2
v_and_b32 v3, 1, v1
v_lshl_add_u32 v2, v3, 4, v2
s_lshl_b32 s70, s60, 13
s_add_u32 s70, s70, 65536
v_add_u32 v2, s70, v2
v_xor_b32 v3, 64, v2
s_mov_b32 s94, 0x05040100
s_mov_b32 s95, 0x07060302
s_waitcnt vmcnt(0)
ds_write_b128 v2, a[0:3] offset:0
ds_write_b128 v3, a[4:7] offset:512
ds_write_b128 v2, a[8:11] offset:1024
ds_write_b128 v3, a[12:15] offset:1536
ds_write_b128 v2, a[16:19] offset:4096
ds_write_b128 v3, a[20:23] offset:4608
ds_write_b128 v2, a[24:27] offset:5120
ds_write_b128 v3, a[28:31] offset:5632
ds_write_b128 v2, a[32:35] offset:32768
ds_write_b128 v3, a[36:39] offset:33280
ds_write_b128 v2, a[40:43] offset:33792
ds_write_b128 v3, a[44:47] offset:34304
ds_write_b128 v2, a[48:51] offset:36864
ds_write_b128 v3, a[52:55] offset:37376
ds_write_b128 v2, a[56:59] offset:37888
ds_write_b128 v3, a[60:63] offset:38400
v_accvgpr_read_b32 v84, a64
v_accvgpr_read_b32 v85, a65
v_accvgpr_read_b32 v86, a66
v_accvgpr_read_b32 v87, a67
v_accvgpr_read_b32 v88, a68
v_accvgpr_read_b32 v89, a69
v_accvgpr_read_b32 v90, a70
v_accvgpr_read_b32 v91, a71
v_accvgpr_read_b32 v92, a72
v_accvgpr_read_b32 v93, a73
v_accvgpr_read_b32 v94, a74
v_accvgpr_read_b32 v95, a75
v_accvgpr_read_b32 v96, a76
v_accvgpr_read_b32 v97, a77
v_accvgpr_read_b32 v98, a78
v_accvgpr_read_b32 v99, a79
v_accvgpr_read_b32 v100, a80
v_accvgpr_read_b32 v101, a81
v_accvgpr_read_b32 v102, a82
v_accvgpr_read_b32 v103, a83
v_accvgpr_read_b32 v104, a84
v_accvgpr_read_b32 v105, a85
v_accvgpr_read_b32 v106, a86
v_accvgpr_read_b32 v107, a87
v_accvgpr_read_b32 v108, a88
v_accvgpr_read_b32 v109, a89
v_accvgpr_read_b32 v110, a90
v_accvgpr_read_b32 v111, a91
v_accvgpr_read_b32 v112, a92
v_accvgpr_read_b32 v113, a93
v_accvgpr_read_b32 v114, a94
v_accvgpr_read_b32 v115, a95
v_perm_b32 v116, v88, v84, s94
v_perm_b32 v117, v96, v92, s94
v_perm_b32 v118, v88, v84, s95
v_perm_b32 v119, v96, v92, s95
v_perm_b32 v120, v89, v85, s94
v_perm_b32 v121, v97, v93, s94
v_perm_b32 v122, v89, v85, s95
v_perm_b32 v123, v97, v93, s95
v_perm_b32 v124, v90, v86, s94
v_perm_b32 v125, v98, v94, s94
v_perm_b32 v126, v90, v86, s95
v_perm_b32 v127, v98, v94, s95
v_perm_b32 v128, v91, v87, s94
v_perm_b32 v129, v99, v95, s94
v_perm_b32 v130, v91, v87, s95
v_perm_b32 v131, v99, v95, s95
v_perm_b32 v132, v104, v100, s94
v_perm_b32 v133, v112, v108, s94
v_perm_b32 v134, v104, v100, s95
v_perm_b32 v135, v112, v108, s95
v_perm_b32 v136, v105, v101, s94
v_perm_b32 v137, v113, v109, s94
v_perm_b32 v138, v105, v101, s95
v_perm_b32 v139, v113, v109, s95
v_perm_b32 v140, v106, v102, s94
v_perm_b32 v141, v114, v110, s94
v_perm_b32 v142, v106, v102, s95
v_perm_b32 v143, v114, v110, s95
v_perm_b32 v144, v107, v103, s94
v_perm_b32 v145, v115, v111, s94
v_perm_b32 v146, v107, v103, s95
v_perm_b32 v147, v115, v111, s95
s_waitcnt lgkmcnt(0)
L_noprep0:
s_barrier
s_cmp_ge_u32 s64, 14
s_cbranch_scc1 L_noprep
v_lshrrev_b32 v2, 2, v1
v_bfe_u32 v3, v1, 3, 2
v_xor_b32 v3, s60, v3
v_lshlrev_b32 v3, 5, v3
v_lshl_add_u32 v3, v2, 7, v3
v_and_b32 v2, 3, v1
v_lshl_add_u32 v3, v2, 3, v3
v_add_u32 v3, 65536, v3
ds_read_b64_tr_b16 a[0:1], v3 offset:0
ds_read_b64_tr_b16 a[2:3], v3 offset:2048
ds_read_b64_tr_b16 a[32:33], v3 offset:32768
ds_read_b64_tr_b16 a[34:35], v3 offset:34816
ds_read_b64_tr_b16 a[4:5], v3 offset:4096
ds_read_b64_tr_b16 a[6:7], v3 offset:6144
ds_read_b64_tr_b16 a[36:37], v3 offset:36864
ds_read_b64_tr_b16 a[38:39], v3 offset:38912
ds_read_b64_tr_b16 a[8:9], v3 offset:8192
ds_read_b64_tr_b16 a[10:11], v3 offset:10240
ds_read_b64_tr_b16 a[40:41], v3 offset:40960
ds_read_b64_tr_b16 a[42:43], v3 offset:43008
ds_read_b64_tr_b16 a[12:13], v3 offset:12288
ds_read_b64_tr_b16 a[14:15], v3 offset:14336
ds_read_b64_tr_b16 a[44:45], v3 offset:45056
ds_read_b64_tr_b16 a[46:47], v3 offset:47104
ds_read_b64_tr_b16 a[16:17], v3 offset:16384
ds_read_b64_tr_b16 a[18:19], v3 offset:18432
ds_read_b64_tr_b16 a[48:49], v3 offset:49152
ds_read_b64_tr_b16 a[50:51], v3 offset:51200
ds_read_b64_tr_b16 a[20:21], v3 offset:20480
ds_read_b64_tr_b16 a[22:23], v3 offset:22528
ds_read_b64_tr_b16 a[52:53], v3 offset:53248
ds_read_b64_tr_b16 a[54:55], v3 offset:55296
ds_read_b64_tr_b16 a[24:25], v3 offset:24576
ds_read_b64_tr_b16 a[26:27], v3 offset:26624
ds_read_b64_tr_b16 a[56:57], v3 offset:57344
ds_read_b64_tr_b16 a[58:59], v3 offset:59392
ds_read_b64_tr_b16 a[28:29], v3 offset:28672
ds_read_b64_tr_b16 a[30:31], v3 offset:30720
ds_read_b64_tr_b16 a[60:61], v3 offset:61440
ds_read_b64_tr_b16 a[62:63], v3 offset:63488
v_mov_b32 v64, 0x3f803f80
v_mov_b32 v65, 0x3f803f80
v_mov_b32 v66, 0x3f803f80
v_mov_b32 v67, 0x3f803f80
s_waitcnt lgkmcnt(0)
s_nop 0
v_mfma_f32_16x16x32_bf16 v[68:71], a[0:3], v[64:67], 0
v_mfma_f32_16x16x32_bf16 v[72:75], a[32:35], v[64:67], 0
v_mfma_f32_16x16x32_bf16 v[68:71], a[4:7], v[64:67], v[68:71]
v_mfma_f32_16x16x32_bf16 v[72:75], a[36:39], v[64:67], v[72:75]
v_mfma_f32_16x16x32_bf16 v[68:71], a[8:11], v[64:67], v[68:71]
v_mfma_f32_16x16x32_bf16 v[72:75], a[40:43], v[64:67], v[72:75]
v_mfma_f32_16x16x32_bf16 v[68:71], a[12:15], v[64:67], v[68:71]
v_mfma_f32_16x16x32_bf16 v[72:75], a[44:47], v[64:67], v[72:75]
v_mfma_f32_16x16x32_bf16 v[68:71], a[16:19], v[64:67], v[68:71]
v_mfma_f32_16x16x32_bf16 v[72:75], a[48:51], v[64:67], v[72:75]
v_mfma_f32_16x16x32_bf16 v[68:71], a[20:23], v[64:67], v[68:71]
v_mfma_f32_16x16x32_bf16 v[72:75], a[52:55], v[64:67], v[72:75]
v_mfma_f32_16x16x32_bf16 v[68:71], a[24:27], v[64:67], v[68:71]
v_mfma_f32_16x16x32_bf16 v[72:75], a[56:59], v[64:67], v[72:75]
v_mfma_f32_16x16x32_bf16 v[68:71], a[28:31], v[64:67], v[68:71]
v_mfma_f32_16x16x32_bf16 v[72:75], a[60:63], v[64:67], v[72:75]
s_mov_b32 exec_lo, 0x0
s_mov_b32 exec_hi, 0xffff
buffer_load_dword v81, v83, s[12:15], 0 offen
s_mov_b64 exec, -1
L_noprep:
v_and_b32 v2, 1, v1
v_lshlrev_b32 v56, 4, v2
v_add_u32 v56, 161856, v56
v_lshrrev_b32 v3, 4, v1
v_lshlrev_b32 v57, 4, v3
s_and_b32 s71, s65, 3
s_lshl_b32 s70, s71, 9
s_add_u32 s70, s70, 6881280
v_add_u32 v57, s70, v57
v_and_b32 v58, 3, v1
v_lshlrev_b32 v58, 6, v58
v_lshl_add_u32 v58, v3, 4, v58
s_sub_u32 s85, s79, s71
s_add_u32 s85, s85, s60
s_lshl_b32 s85, s85, 10
s_lshl_b32 s71, s71, 8
s_add_u32 s85, s85, s71
s_add_u32 s85, s85, 6946816
s_lshl_b32 s86, s79, 10
s_add_u32 s86, s86, 6946816
v_bfe_u32 v60, v1, 1, 3
v_mov_b32 v59, s68
s_barrier
ds_read_b128 v[20:23], v56
s_mov_b32 s92, 0x00030003
s_mov_b32 s93, 0x00030003
s_sub_u32 s88, s63, 24
s_lshl_b32 s70, s62, 3
s_add_u32 s88, s88, s70
s_waitcnt lgkmcnt(0)
s_cmp_ge_u32 s64, 14
s_cbranch_scc1 L_nomoe
v_lshl_add_u32 v57, v23, 11, v57
s_mov_b64 exec, s[92:93]
buffer_load_dwordx4 v[24:27], v57, s[12:15], 0 offen offset:0 sc1
buffer_load_dwordx4 v[28:31], v57, s[12:15], 0 offen offset:64 sc1
buffer_load_dwordx4 v[32:35], v57, s[12:15], 0 offen offset:128 sc1
buffer_load_dwordx4 v[36:39], v57, s[12:15], 0 offen offset:192 sc1
buffer_load_dwordx4 v[40:43], v57, s[12:15], 0 offen offset:256 sc1
buffer_load_dwordx4 v[44:47], v57, s[12:15], 0 offen offset:320 sc1
buffer_load_dwordx4 v[48:51], v57, s[12:15], 0 offen offset:384 sc1
buffer_load_dwordx4 v[52:55], v57, s[12:15], 0 offen offset:448 sc1
v_mul_f32_e64 v68, v68, -v21
v_mul_f32_e64 v69, v69, -v21
v_mul_f32_e64 v70, v70, -v21
v_mul_f32_e64 v71, v71, -v21
v_mul_f32_e64 v72, v72, -v21
v_mul_f32_e64 v73, v73, -v21
v_mul_f32_e64 v74, v74, -v21
v_mul_f32_e64 v75, v75, -v21
s_waitcnt vmcnt(0)
L_x_chk:
v_max3_u32 v2, v24, v28, v32
v_max3_u32 v3, v36, v40, v44
v_max3_u32 v2, v2, v48, v52
v_max_u32 v2, v2, v3
v_cmp_eq_u32 vcc, -1, v2
s_cbranch_vccnz L_x_rt
L_x_ok:
s_mov_b64 exec, -1
v_mfma_f32_16x16x32_bf16 v[68:71], a[0:3], v[24:27], v[68:71]
v_mfma_f32_16x16x32_bf16 v[72:75], a[32:35], v[24:27], v[72:75]
v_mfma_f32_16x16x32_bf16 v[68:71], a[4:7], v[28:31], v[68:71]
v_mfma_f32_16x16x32_bf16 v[72:75], a[36:39], v[28:31], v[72:75]
v_mfma_f32_16x16x32_bf16 v[68:71], a[8:11], v[32:35], v[68:71]
v_mfma_f32_16x16x32_bf16 v[72:75], a[40:43], v[32:35], v[72:75]
v_mfma_f32_16x16x32_bf16 v[68:71], a[12:15], v[36:39], v[68:71]
v_mfma_f32_16x16x32_bf16 v[72:75], a[44:47], v[36:39], v[72:75]
v_mfma_f32_16x16x32_bf16 v[68:71], a[16:19], v[40:43], v[68:71]
v_mfma_f32_16x16x32_bf16 v[72:75], a[48:51], v[40:43], v[72:75]
v_mfma_f32_16x16x32_bf16 v[68:71], a[20:23], v[44:47], v[68:71]
v_mfma_f32_16x16x32_bf16 v[72:75], a[52:55], v[44:47], v[72:75]
v_mfma_f32_16x16x32_bf16 v[68:71], a[24:27], v[48:51], v[68:71]
v_mfma_f32_16x16x32_bf16 v[72:75], a[56:59], v[48:51], v[72:75]
v_mfma_f32_16x16x32_bf16 v[68:71], a[28:31], v[52:55], v[68:71]
v_mfma_f32_16x16x32_bf16 v[72:75], a[60:63], v[52:55], v[72:75]
s_nop 6
v_bfi_b32 v68, s91, v59, v68
v_bfi_b32 v69, s91, v59, v69
v_bfi_b32 v70, s91, v59, v70
v_bfi_b32 v71, s91, v59, v71
v_bfi_b32 v72, s91, v59, v72
v_bfi_b32 v73, s91, v59, v73
v_bfi_b32 v74, s91, v59, v74
v_bfi_b32 v75, s91, v59, v75
s_mov_b64 exec, s[92:93]
s_cmp_eq_u32 s69, 0
s_cbranch_scc1 L_pxp_s
buffer_store_dwordx4 v[68:71], v58, s[12:15], s85 offen offset:0
buffer_store_dwordx4 v[72:75], v58, s[12:15], s85 offen offset:128
L_pxp_d:
s_mov_b64 exec, -1
buffer_load_dwordx4 v[24:27], v58, s[12:15], s86 offen offset:0 sc1
buffer_load_dwordx4 v[28:31], v58, s[12:15], s86 offen offset:256 sc1
buffer_load_dwordx4 v[32:35], v58, s[12:15], s86 offen offset:512 sc1
buffer_load_dwordx4 v[36:39], v58, s[12:15], s86 offen offset:768 sc1
s_waitcnt vmcnt(0)
L_px_chk:
v_xor_b32 v24, s84, v24
v_xor_b32 v25, s84, v25
v_xor_b32 v26, s84, v26
v_xor_b32 v27, s84, v27
v_or3_b32 v2, v24, v25, v26
v_xor_b32 v28, s84, v28
v_xor_b32 v29, s84, v29
v_or3_b32 v2, v2, v27, v28
v_xor_b32 v30, s84, v30
v_xor_b32 v31, s84, v31
v_or3_b32 v2, v2, v29, v30
v_xor_b32 v32, s84, v32
v_xor_b32 v33, s84, v33
v_or3_b32 v2, v2, v31, v32
v_xor_b32 v34, s84, v34
v_xor_b32 v35, s84, v35
v_or3_b32 v2, v2, v33, v34
v_xor_b32 v36, s84, v36
v_xor_b32 v37, s84, v37
v_or3_b32 v2, v2, v35, v36
v_xor_b32 v38, s84, v38
v_xor_b32 v39, s84, v39
v_or3_b32 v2, v2, v37, v38
v_bitop3_b32 v2, v2, v39, s91 bitop3:0xa8
v_cmp_ne_u32 vcc, 0, v2
s_cbranch_vccnz L_px_rt
L_px_ok:
v_pk_add_f32 v[24:25], v[24:25], v[28:29]
v_pk_add_f32 v[32:33], v[32:33], v[36:37]
v_pk_add_f32 v[26:27], v[26:27], v[30:31]
v_pk_add_f32 v[34:35], v[34:35], v[38:39]
v_pk_add_f32 v[24:25], v[24:25], v[32:33]
v_pk_add_f32 v[26:27], v[26:27], v[34:35]
v_pk_mul_f32 v[24:25], v[24:25], v[22:23] op_sel_hi:[1,0]
v_pk_mul_f32 v[26:27], v[26:27], v[22:23] op_sel_hi:[1,0]
v_mul_f32 v28, 0xbfb8aa3b, v24
v_mul_f32 v29, 0xbfb8aa3b, v25
v_mul_f32 v30, 0xbfb8aa3b, v26
v_mul_f32 v31, 0xbfb8aa3b, v27
v_exp_f32 v28, v28
v_exp_f32 v29, v29
v_exp_f32 v30, v30
v_exp_f32 v31, v31
v_mul_f32_dpp v32, v24, v24 quad_perm:[2,3,0,1] row_mask:0xf bank_mask:0xf
v_mul_f32_dpp v33, v25, v25 quad_perm:[2,3,0,1] row_mask:0xf bank_mask:0xf
v_mul_f32_dpp v34, v26, v26 quad_perm:[2,3,0,1] row_mask:0xf bank_mask:0xf
v_mul_f32_dpp v35, v27, v27 quad_perm:[2,3,0,1] row_mask:0xf bank_mask:0xf
v_add_f32 v28, 1.0, v28
v_add_f32 v29, 1.0, v29
v_add_f32 v30, 1.0, v30
v_add_f32 v31, 1.0, v31
v_rcp_f32 v28, v28
v_rcp_f32 v29, v29
v_rcp_f32 v30, v30
v_rcp_f32 v31, v31
v_mul_f32 v24, v32, v28
v_mul_f32 v25, v33, v29
v_mul_f32 v26, v34, v30
v_mul_f32 v27, v35, v31
v_cvt_pk_bf16_f32 v28, v24, v25
v_cvt_pk_bf16_f32 v29, v26, v27
s_nop 0
v_mov_b32_dpp v24, v28 quad_perm:[0,1,0,1] row_mask:0xf bank_mask:0xf
v_mov_b32_dpp v25, v29 quad_perm:[0,1,0,1] row_mask:0xf bank_mask:0xf
v_cmp_eq_u32 vcc, 0, v60
s_nop 1
v_cndmask_b32 v32, 0, v24, vcc
v_cndmask_b32 v33, 0, v25, vcc
v_cmp_eq_u32 vcc, 1, v60
s_nop 1
v_cndmask_b32 v34, 0, v24, vcc
v_cndmask_b32 v35, 0, v25, vcc
v_cmp_eq_u32 vcc, 2, v60
s_nop 1
v_cndmask_b32 v36, 0, v24, vcc
v_cndmask_b32 v37, 0, v25, vcc
v_cmp_eq_u32 vcc, 3, v60
s_nop 1
v_cndmask_b32 v38, 0, v24, vcc
v_cndmask_b32 v39, 0, v25, vcc
v_cmp_eq_u32 vcc, 4, v60
s_nop 1
v_cndmask_b32 v40, 0, v24, vcc
v_cndmask_b32 v41, 0, v25, vcc
v_cmp_eq_u32 vcc, 5, v60
s_nop 1
v_cndmask_b32 v42, 0, v24, vcc
v_cndmask_b32 v43, 0, v25, vcc
v_cmp_eq_u32 vcc, 6, v60
s_nop 1
v_cndmask_b32 v44, 0, v24, vcc
v_cndmask_b32 v45, 0, v25, vcc
v_cmp_eq_u32 vcc, 7, v60
s_nop 1
v_cndmask_b32 v46, 0, v24, vcc
v_cndmask_b32 v47, 0, v25, vcc
v_mfma_f32_16x16x32_bf16 v[68:71], v[116:119], v[32:35], 0
v_mfma_f32_16x16x32_bf16 v[72:75], v[132:135], v[32:35], 0
v_mfma_f32_16x16x32_bf16 v[68:71], v[120:123], v[36:39], v[68:71]
v_mfma_f32_16x16x32_bf16 v[72:75], v[136:139], v[36:39], v[72:75]
v_mfma_f32_16x16x32_bf16 v[68:71], v[124:127], v[40:43], v[68:71]
v_mfma_f32_16x16x32_bf16 v[72:75], v[140:143], v[40:43], v[72:75]
v_mfma_f32_16x16x32_bf16 v[68:71], v[128:131], v[44:47], v[68:71]
v_mfma_f32_16x16x32_bf16 v[72:75], v[144:147], v[44:47], v[72:75]
s_lshl_b32 s70, s79, 13
s_lshl_b32 s71, s60, 11
s_add_u32 s70, s70, s71
s_add_u32 s70, s70, 7340032
s_nop 2
v_bfi_b32 v68, s91, v59, v68
v_bfi_b32 v72, s91, v59, v72
buffer_store_dwordx4 v[68:71], v18, s[12:15], s70 offen offset:0 sc1
buffer_store_dwordx4 v[72:75], v18, s[12:15], s70 offen offset:1024 sc1
L_nomoe:
s_cmp_lt_u32 s63, 24
s_cbranch_scc1 L_ldone
v_lshrrev_b32 v2, 3, v1
v_and_b32 v3, 7, v1
v_lshlrev_b32 v62, 13, v2
v_lshl_add_u32 v62, v3, 4, v62
s_mul_i32 s87, s60, 458752
s_lshl_b32 s70, s88, 7
s_add_u32 s87, s87, s70
s_add_u32 s87, s87, 7340032
s_lshr_b32 s70, s88, 1
s_lshl_b32 s70, s70, 5
s_and_b32 s71, s88, 1
s_lshl_b32 s71, s71, 2
s_add_u32 s70, s70, s71
v_bfe_u32 v4, v1, 3, 2
v_lshlrev_b32 v4, 3, v4
v_bfe_u32 v5, v1, 1, 2
v_add3_u32 v63, v4, v5, s70
v_lshlrev_b32 v63, 1, v63
v_lshl_add_u32 v64, v23, 11, v63
s_mov_b32 s72, 6881280
buffer_load_ushort v61, v64, s[12:15], s72 offen sc1
s_add_u32 s70, s87, 0
buffer_load_dwordx4 v[24:27], v62, s[12:15], s70 offen sc1
s_add_u32 s70, s87, 65536
buffer_load_dwordx4 v[28:31], v62, s[12:15], s70 offen sc1
s_add_u32 s70, s87, 131072
buffer_load_dwordx4 v[32:35], v62, s[12:15], s70 offen sc1
s_add_u32 s70, s87, 196608
buffer_load_dwordx4 v[36:39], v62, s[12:15], s70 offen sc1
s_add_u32 s70, s87, 262144
buffer_load_dwordx4 v[40:43], v62, s[12:15], s70 offen sc1
s_add_u32 s70, s87, 327680
buffer_load_dwordx4 v[44:47], v62, s[12:15], s70 offen sc1
s_add_u32 s70, s87, 393216
buffer_load_dwordx4 v[48:51], v62, s[12:15], s70 offen sc1
v_and_b32 v65, 0xfffff800, v20
v_not_b32 v4, v65
v_ashrrev_i32 v4, 31, v4
v_or_b32 v4, 0x80000000, v4
v_xor_b32 v65, v65, v4
v_mul_f32 v65, 0xbfb8aa3b, v65
v_exp_f32 v65, v65
s_nop 0
v_add_f32 v65, 1.0, v65
v_rcp_f32 v65, v65
v_and_b32 v66, 0x7ff, v20
v_sub_u32 v66, 2047, v66
v_lshl_add_u32 v66, v66, 11, v63
v_add_f32 v67, 1.0, v22
v_mul_f32_e64 v21, -v21, v22
s_lshl_b32 s71, s60, 7
s_add_u32 s71, s71, 163072
v_lshlrev_b32 v6, 4, v3
v_add_u32 v6, s71, v6
v_bfe_u32 v4, v1, 3, 2
v_lshlrev_b32 v7, 4, v3
v_lshl_add_u32 v7, v4, 2, v7
v_add_u32 v7, 163072, v7
s_waitcnt vmcnt(0)
L_y_chk:
v_add_u32 v8, 1, v61
v_lshrrev_b32 v8, 16, v8
v_xor_b32 v8, s84, v8
v_xor_b32 v24, s84, v24
v_xor_b32 v28, s84, v28
v_xor_b32 v32, s84, v32
v_xor_b32 v36, s84, v36
v_or3_b32 v2, v24, v28, v32
v_xor_b32 v40, s84, v40
v_xor_b32 v44, s84, v44
v_or3_b32 v2, v2, v36, v40
v_xor_b32 v48, s84, v48
v_xor_b32 v8, s84, v8
v_or3_b32 v2, v2, v44, v48
v_bitop3_b32 v2, v2, v8, s91 bitop3:0xa8
v_cmp_ne_u32 vcc, 0, v2
s_cbranch_vccnz L_y_rt
L_y_ok:
v_pk_add_f32 v[24:25], v[24:25], v[28:29]
v_pk_add_f32 v[26:27], v[26:27], v[30:31]
v_pk_add_f32 v[32:33], v[32:33], v[36:37]
v_pk_add_f32 v[34:35], v[34:35], v[38:39]
v_pk_add_f32 v[40:41], v[40:41], v[44:45]
v_pk_add_f32 v[42:43], v[42:43], v[46:47]
v_pk_add_f32 v[24:25], v[24:25], v[32:33]
v_pk_add_f32 v[26:27], v[26:27], v[34:35]
v_pk_add_f32 v[40:41], v[40:41], v[48:49]
v_pk_add_f32 v[42:43], v[42:43], v[50:51]
v_pk_add_f32 v[24:25], v[24:25], v[40:41]
v_pk_add_f32 v[26:27], v[26:27], v[42:43]
s_nop 0
v_add_f32_dpp v24, v24, v24 row_ror:8 row_mask:0xf bank_mask:0xf
v_add_f32_dpp v25, v25, v25 row_ror:8 row_mask:0xf bank_mask:0xf
v_add_f32_dpp v26, v26, v26 row_ror:8 row_mask:0xf bank_mask:0xf
v_add_f32_dpp v27, v27, v27 row_ror:8 row_mask:0xf bank_mask:0xf
v_mov_b32 v28, v24
v_mov_b32 v29, v25
v_mov_b32 v30, v26
v_mov_b32 v31, v27
v_permlane16_swap_b32 v24, v28
v_permlane16_swap_b32 v25, v29
v_permlane16_swap_b32 v26, v30
v_permlane16_swap_b32 v27, v31
v_add_f32 v24, v24, v28
v_add_f32 v25, v25, v29
v_add_f32 v26, v26, v30
v_add_f32 v27, v27, v31
v_mov_b32 v28, v24
v_mov_b32 v29, v25
v_mov_b32 v30, v26
v_mov_b32 v31, v27
v_permlane32_swap_b32 v24, v28
v_permlane32_swap_b32 v25, v29
v_permlane32_swap_b32 v26, v30
v_permlane32_swap_b32 v27, v31
v_add_f32 v24, v24, v28
v_add_f32 v25, v25, v29
v_add_f32 v26, v26, v30
v_add_f32 v27, v27, v31
ds_write_b128 v6, v[24:27]
s_waitcnt lgkmcnt(0)
s_barrier
s_cmp_lg_u32 s60, 0
s_cbranch_scc1 L_ldone
ds_read_b32 v24, v7 offset:0
ds_read_b32 v25, v7 offset:128
ds_read_b32 v26, v7 offset:256
ds_read_b32 v27, v7 offset:384
v_lshlrev_b32 v61, 16, v61
v_fma_f32 v61, v61, v67, v21
s_waitcnt lgkmcnt(0)
v_add_f32 v24, v24, v25
v_add_f32 v26, v26, v27
v_add_f32 v24, v24, v26
v_fmac_f32 v61, v24, v65
v_cvt_pk_bf16_f32 v61, v61, v61
s_mov_b64 exec, 0xffffffff
buffer_store_short v61, v66, s[20:23], 0 offen sc1
L_ldone:
s_endpgm
L_compute:
v_and_b32 v2, 15, v1
v_lshrrev_b32 v4, 4, v1
v_lshrrev_b32 v3, 1, v2
v_xor_b32 v3, v3, v4
v_lshlrev_b32 v2, 7, v2
s_lshl_b32 s70, s66, 13
v_add_u32 v2, s70, v2
v_xor_b32 v5, 0, v3
v_lshl_add_u32 v8, v5, 4, v2
v_add_u32 v10, 65536, v8
v_xor_b32 v5, 4, v3
v_lshl_add_u32 v9, v5, 4, v2
v_add_u32 v11, 65536, v9
v_lshrrev_b32 v2, 5, v1
v_mul_u32_u24 v2, 6144, v2
v_bfe_u32 v3, v1, 4, 1
v_lshl_add_u32 v2, v3, 10, v2
v_bfe_u32 v4, v1, 2, 2
v_lshl_add_u32 v2, v4, 7, v2
v_lshlrev_b32 v3, 1, v3
v_bfe_u32 v4, v1, 3, 1
v_or_b32 v3, v3, v4
s_lshl_b32 s70, s67, 1
v_xor_b32 v3, s70, v3
v_and_b32 v4, 3, v1
v_lshl_add_u32 v2, v4, 3, v2
v_xor_b32 v4, 0, v3
v_lshl_add_u32 v12, v4, 5, v2
v_add_u32 v14, 65536, v12
v_xor_b32 v4, 1, v3
v_lshl_add_u32 v13, v4, 5, v2
v_add_u32 v15, 65536, v13
s_waitcnt lgkmcnt(0)
s_mov_b32 s12, s58
s_and_b32 s13, s59, 0xffff
s_mov_b32 s14, 268435456
s_mov_b32 s15, 0x20000
s_mov_b32 s36, s48
s_and_b32 s37, s49, 0xffff
s_mov_b32 s38, 2048
s_mov_b32 s39, 0x20000
s_mov_b32 s20, s56
s_and_b32 s21, s57, 0xffff
s_mov_b32 s22, 4194304
s_mov_b32 s23, 0x20000
s_lshl_b32 s87, s64, 4
s_add_u32 s87, s87, s65
s_mul_i32 s87, s87, 4352
s_add_u32 s87, s87, 524288
s_lshl_b32 s88, s65, 18
s_lshl_b32 s70, s66, 17
s_add_u32 s88, s88, s70
s_lshl_b32 s70, s64, 11
s_add_u32 s88, s88, s70
s_lshl_b32 s70, s67, 10
s_add_u32 s88, s88, s70
s_add_u32 s88, s88, 2097152
v_mov_b32 v2, 0
buffer_load_dword v19, v2, s[12:15], 0 offen sc1
buffer_load_dwordx4 v[24:27], v16, s[36:39], 0 offen
buffer_load_dwordx4 v[28:31], v16, s[36:39], 0 offen offset:1024
v_lshrrev_b32 v3, 4, v1
v_lshlrev_b32 v3, 3, v3
s_lshl_b32 s70, s65, 7
buffer_load_dwordx2 a[96:97], v3, s[36:39], s70 offen offset:0
buffer_load_dwordx2 a[98:99], v3, s[36:39], s70 offen offset:32
buffer_load_dwordx2 a[100:101], v3, s[36:39], s70 offen offset:64
buffer_load_dwordx2 a[102:103], v3, s[36:39], s70 offen offset:96
v_mov_b32 v32, 0
v_mov_b32 v33, 0
v_mov_b32 v34, 0
v_mov_b32 v35, 0
v_mov_b32 v36, 0
v_mov_b32 v37, 0
v_mov_b32 v38, 0
v_mov_b32 v39, 0
v_mov_b32 v40, 0
v_mov_b32 v41, 0
v_mov_b32 v42, 0
v_mov_b32 v43, 0
v_mov_b32 v44, 0
v_mov_b32 v45, 0
v_mov_b32 v46, 0
v_mov_b32 v47, 0
v_mov_b32 v48, 0
v_mov_b32 v49, 0
v_mov_b32 v50, 0
v_mov_b32 v51, 0
v_mov_b32 v52, 0
v_mov_b32 v53, 0
v_mov_b32 v54, 0
v_mov_b32 v55, 0
v_mov_b32 v56, 0
v_mov_b32 v57, 0
v_mov_b32 v58, 0
v_mov_b32 v59, 0
v_mov_b32 v60, 0
v_mov_b32 v61, 0
v_mov_b32 v62, 0
v_mov_b32 v63, 0
v_mov_b32 v64, 0
v_mov_b32 v65, 0
v_mov_b32 v66, 0
v_mov_b32 v67, 0
v_mov_b32 v68, 0
v_mov_b32 v69, 0
v_mov_b32 v70, 0
v_mov_b32 v71, 0
v_mov_b32 v72, 0
v_mov_b32 v73, 0
v_mov_b32 v74, 0
v_mov_b32 v75, 0
v_mov_b32 v76, 0
v_mov_b32 v77, 0
v_mov_b32 v78, 0
v_mov_b32 v79, 0
v_mov_b32 v80, 0
v_mov_b32 v81, 0
v_mov_b32 v82, 0
v_mov_b32 v83, 0
v_mov_b32 v84, 0
v_mov_b32 v85, 0
v_mov_b32 v86, 0
v_mov_b32 v87, 0
v_mov_b32 v88, 0
v_mov_b32 v89, 0
v_mov_b32 v90, 0
v_mov_b32 v91, 0
v_mov_b32 v92, 0
v_mov_b32 v93, 0
v_mov_b32 v94, 0
v_mov_b32 v95, 0
v_mov_b32 v96, 0
v_mov_b32 v97, 0
v_mov_b32 v98, 0
v_mov_b32 v99, 0
v_mov_b32 v100, 0
v_mov_b32 v101, 0
v_mov_b32 v102, 0
v_mov_b32 v103, 0
v_mov_b32 v104, 0
v_mov_b32 v105, 0
v_mov_b32 v106, 0
v_mov_b32 v107, 0
v_mov_b32 v108, 0
v_mov_b32 v109, 0
v_mov_b32 v110, 0
v_mov_b32 v111, 0
v_mov_b32 v112, 0
v_mov_b32 v113, 0
v_mov_b32 v114, 0
v_mov_b32 v115, 0
v_mov_b32 v116, 0
v_mov_b32 v117, 0
v_mov_b32 v118, 0
v_mov_b32 v119, 0
v_mov_b32 v120, 0
v_mov_b32 v121, 0
v_mov_b32 v122, 0
v_mov_b32 v123, 0
v_mov_b32 v124, 0
v_mov_b32 v125, 0
v_mov_b32 v126, 0
v_mov_b32 v127, 0
s_mov_b32 s70, 0x3f803f80
v_accvgpr_write_b32 a80, s70
v_accvgpr_write_b32 a81, s70
v_accvgpr_write_b32 a82, s70
v_accvgpr_write_b32 a83, s70
s_mov_b32 s80, 0x358637bd
s_mov_b32 s81, 0x358637bd
s_mov_b32 s82, 0x3f800008
s_mov_b32 s83, 0x3f800008
s_mov_b32 s90, 0x3fb8aa3b
s_mov_b32 s91, 0x3fb8aa3b
s_waitcnt vmcnt(4)
v_readfirstlane_b32 s68, v19
v_lshlrev_b32 v128, 16, v24
v_and_b32 v129, 0xffff0000, v24
v_lshlrev_b32 v130, 16, v25
v_and_b32 v131, 0xffff0000, v25
v_lshlrev_b32 v132, 16, v26
v_and_b32 v133, 0xffff0000, v26
v_lshlrev_b32 v134, 16, v27
v_and_b32 v135, 0xffff0000, v27
v_lshlrev_b32 v136, 16, v28
v_and_b32 v137, 0xffff0000, v28
v_lshlrev_b32 v138, 16, v29
v_and_b32 v139, 0xffff0000, v29
v_lshlrev_b32 v140, 16, v30
v_and_b32 v141, 0xffff0000, v30
v_lshlrev_b32 v142, 16, v31
v_and_b32 v143, 0xffff0000, v31
s_add_u32 s68, s68, 1
v_pk_add_f32 v[128:129], v[128:129], v[130:131]
v_pk_add_f32 v[132:133], v[132:133], v[134:135]
v_pk_add_f32 v[136:137], v[136:137], v[138:139]
v_pk_add_f32 v[140:141], v[140:141], v[142:143]
v_pk_add_f32 v[128:129], v[128:129], v[132:133]
v_pk_add_f32 v[136:137], v[136:137], v[140:141]
v_pk_add_f32 v[128:129], v[128:129], v[136:137]
v_add_f32 v2, v128, v129
s_nop 1
v_add_f32_dpp v2, v2, v2 row_ror:1 row_mask:0xf bank_mask:0xf
s_nop 1
v_add_f32_dpp v2, v2, v2 row_ror:2 row_mask:0xf bank_mask:0xf
s_nop 1
v_add_f32_dpp v2, v2, v2 row_ror:4 row_mask:0xf bank_mask:0xf
s_nop 1
v_add_f32_dpp v2, v2, v2 row_ror:8 row_mask:0xf bank_mask:0xf
v_mov_b32 v3, v2
s_nop 1
v_permlane16_swap_b32 v2, v3
v_add_f32 v2, v2, v3
v_mov_b32 v3, v2
s_nop 1
v_permlane32_swap_b32 v2, v3
v_add_f32 v2, v2, v3
s_nop 0
v_readfirstlane_b32 s84, v2
v_and_b32 v7, 3, v1
v_lshrrev_b32_e64 v7, v7, s68
v_and_b32 v7, 1, v7
v_mul_u32_u24 v7, 0x10001, v7
s_mov_b32 s76, 0x10001
s_mov_b32 s77, 0x07060302
s_movk_i32 s85, 0xff
v_mov_b32 v28, -1
v_mov_b32 v29, -1
v_mov_b32 v30, -1
v_mov_b32 v31, -1
s_barrier
ds_read_b128 a[0:3], v10 offset:57344
ds_read_b64_tr_b16 a[32:33], v12 offset:0
ds_read_b64_tr_b16 a[34:35], v12 offset:512
ds_read_b128 a[4:7], v10 offset:59392
ds_read_b128 a[8:11], v10 offset:61440
ds_read_b128 a[12:15], v10 offset:63488
ds_read_b64_tr_b16 a[36:37], v13 offset:0
ds_read_b64_tr_b16 a[38:39], v13 offset:512
ds_read_b64_tr_b16 a[40:41], v12 offset:2048
ds_read_b64_tr_b16 a[42:43], v12 offset:2560
ds_read_b64_tr_b16 a[44:45], v13 offset:2048
ds_read_b64_tr_b16 a[46:47], v13 offset:2560
ds_read_b64_tr_b16 a[48:49], v12 offset:4096
ds_read_b64_tr_b16 a[50:51], v12 offset:4608
ds_read_b64_tr_b16 a[52:53], v13 offset:4096
ds_read_b64_tr_b16 a[54:55], v13 offset:4608
s_waitcnt lgkmcnt(0)
s_cmp_lg_u32 s66, 0
s_cbranch_scc1 L_nocs0
v_mfma_f32_16x16x32_bf16 v[128:131], a[80:83], a[32:35], 0
v_mfma_f32_16x16x32_bf16 v[132:135], a[80:83], a[36:39], 0
v_mfma_f32_16x16x32_bf16 v[136:139], a[80:83], a[40:43], 0
v_mfma_f32_16x16x32_bf16 v[140:143], a[80:83], a[44:47], 0
v_mfma_f32_16x16x32_bf16 v[144:147], a[80:83], a[48:51], 0
v_mfma_f32_16x16x32_bf16 v[148:151], a[80:83], a[52:55], 0
L_nocs0:
v_mfma_f32_16x16x32_bf16 v[32:35], a[32:35], a[0:3], v[32:35]
ds_read_b128 a[16:19], v11 offset:57344
v_mfma_f32_16x16x32_bf16 v[56:59], a[32:35], a[4:7], v[56:59]
ds_read_b64_tr_b16 a[56:57], v12 offset:12288
v_mfma_f32_16x16x32_bf16 v[80:83], a[32:35], a[8:11], v[80:83]
ds_read_b64_tr_b16 a[58:59], v12 offset:12800
v_mfma_f32_16x16x32_bf16 v[104:107], a[32:35], a[12:15], v[104:107]
ds_read_b128 a[20:23], v11 offset:59392
v_mfma_f32_16x16x32_bf16 v[36:39], a[36:39], a[0:3], v[36:39]
ds_read_b128 a[24:27], v11 offset:61440
v_mfma_f32_16x16x32_bf16 v[60:63], a[36:39], a[4:7], v[60:63]
ds_read_b128 a[28:31], v11 offset:63488
v_mfma_f32_16x16x32_bf16 v[84:87], a[36:39], a[8:11], v[84:87]
ds_read_b64_tr_b16 a[60:61], v13 offset:12288
v_mfma_f32_16x16x32_bf16 v[108:111], a[36:39], a[12:15], v[108:111]
ds_read_b64_tr_b16 a[62:63], v13 offset:12800
v_mfma_f32_16x16x32_bf16 v[40:43], a[0:3], a[40:43], v[40:43]
ds_read_b64_tr_b16 a[64:65], v12 offset:14336
v_mfma_f32_16x16x32_bf16 v[64:67], a[4:7], a[40:43], v[64:67]
ds_read_b64_tr_b16 a[66:67], v12 offset:14848
v_mfma_f32_16x16x32_bf16 v[88:91], a[8:11], a[40:43], v[88:91]
ds_read_b64_tr_b16 a[68:69], v13 offset:14336
v_mfma_f32_16x16x32_bf16 v[112:115], a[12:15], a[40:43], v[112:115]
ds_read_b64_tr_b16 a[70:71], v13 offset:14848
v_mfma_f32_16x16x32_bf16 v[44:47], a[0:3], a[44:47], v[44:47]
ds_read_b64_tr_b16 a[72:73], v12 offset:16384
v_mfma_f32_16x16x32_bf16 v[68:71], a[4:7], a[44:47], v[68:71]
ds_read_b64_tr_b16 a[74:75], v12 offset:16896
v_mfma_f32_16x16x32_bf16 v[92:95], a[8:11], a[44:47], v[92:95]
ds_read_b64_tr_b16 a[76:77], v13 offset:16384
v_mfma_f32_16x16x32_bf16 v[116:119], a[12:15], a[44:47], v[116:119]
ds_read_b64_tr_b16 a[78:79], v13 offset:16896
v_mfma_f32_16x16x32_bf16 v[48:51], a[0:3], a[48:51], v[48:51]
v_mfma_f32_16x16x32_bf16 v[72:75], a[4:7], a[48:51], v[72:75]
v_mfma_f32_16x16x32_bf16 v[96:99], a[8:11], a[48:51], v[96:99]
v_mfma_f32_16x16x32_bf16 v[120:123], a[12:15], a[48:51], v[120:123]
v_mfma_f32_16x16x32_bf16 v[52:55], a[0:3], a[52:55], v[52:55]
v_mfma_f32_16x16x32_bf16 v[76:79], a[4:7], a[52:55], v[76:79]
v_mfma_f32_16x16x32_bf16 v[100:103], a[8:11], a[52:55], v[100:103]
v_mfma_f32_16x16x32_bf16 v[124:127], a[12:15], a[52:55], v[124:127]
s_waitcnt lgkmcnt(0)
s_cmp_lg_u32 s66, 0
s_cbranch_scc1 L_nocs1
v_mfma_f32_16x16x32_bf16 v[128:131], a[80:83], a[56:59], v[128:131]
v_mfma_f32_16x16x32_bf16 v[132:135], a[80:83], a[60:63], v[132:135]
v_mfma_f32_16x16x32_bf16 v[136:139], a[80:83], a[64:67], v[136:139]
v_mfma_f32_16x16x32_bf16 v[140:143], a[80:83], a[68:71], v[140:143]
v_mfma_f32_16x16x32_bf16 v[144:147], a[80:83], a[72:75], v[144:147]
v_mfma_f32_16x16x32_bf16 v[148:151], a[80:83], a[76:79], v[148:151]
L_nocs1:
v_mfma_f32_16x16x32_bf16 v[32:35], a[56:59], a[16:19], v[32:35]
s_barrier
ds_read_b128 a[0:3], v10 offset:40960
v_mfma_f32_16x16x32_bf16 v[56:59], a[56:59], a[20:23], v[56:59]
ds_read_b64_tr_b16 a[32:33], v14 offset:16384
v_mfma_f32_16x16x32_bf16 v[80:83], a[56:59], a[24:27], v[80:83]
ds_read_b64_tr_b16 a[34:35], v14 offset:16896
v_mfma_f32_16x16x32_bf16 v[104:107], a[56:59], a[28:31], v[104:107]
ds_read_b128 a[4:7], v10 offset:43008
v_mfma_f32_16x16x32_bf16 v[36:39], a[60:63], a[16:19], v[36:39]
ds_read_b128 a[8:11], v10 offset:45056
v_mfma_f32_16x16x32_bf16 v[60:63], a[60:63], a[20:23], v[60:63]
ds_read_b128 a[12:15], v10 offset:47104
v_mfma_f32_16x16x32_bf16 v[84:87], a[60:63], a[24:27], v[84:87]
ds_read_b64_tr_b16 a[36:37], v15 offset:16384
v_mfma_f32_16x16x32_bf16 v[108:111], a[60:63], a[28:31], v[108:111]
ds_read_b64_tr_b16 a[38:39], v15 offset:16896
v_mfma_f32_16x16x32_bf16 v[40:43], a[16:19], a[64:67], v[40:43]
ds_read_b64_tr_b16 a[40:41], v14 offset:18432
v_mfma_f32_16x16x32_bf16 v[64:67], a[20:23], a[64:67], v[64:67]
ds_read_b64_tr_b16 a[42:43], v14 offset:18944
v_mfma_f32_16x16x32_bf16 v[88:91], a[24:27], a[64:67], v[88:91]
ds_read_b64_tr_b16 a[44:45], v15 offset:18432
v_mfma_f32_16x16x32_bf16 v[112:115], a[28:31], a[64:67], v[112:115]
ds_read_b64_tr_b16 a[46:47], v15 offset:18944
v_mfma_f32_16x16x32_bf16 v[44:47], a[16:19], a[68:71], v[44:47]
ds_read_b64_tr_b16 a[48:49], v14 offset:20480
v_mfma_f32_16x16x32_bf16 v[68:71], a[20:23], a[68:71], v[68:71]
ds_read_b64_tr_b16 a[50:51], v14 offset:20992
v_mfma_f32_16x16x32_bf16 v[92:95], a[24:27], a[68:71], v[92:95]
ds_read_b64_tr_b16 a[52:53], v15 offset:20480
v_mfma_f32_16x16x32_bf16 v[116:119], a[28:31], a[68:71], v[116:119]
ds_read_b64_tr_b16 a[54:55], v15 offset:20992
v_mfma_f32_16x16x32_bf16 v[48:51], a[16:19], a[72:75], v[48:51]
v_mfma_f32_16x16x32_bf16 v[72:75], a[20:23], a[72:75], v[72:75]
v_mfma_f32_16x16x32_bf16 v[96:99], a[24:27], a[72:75], v[96:99]
v_mfma_f32_16x16x32_bf16 v[120:123], a[28:31], a[72:75], v[120:123]
v_mfma_f32_16x16x32_bf16 v[52:55], a[16:19], a[76:79], v[52:55]
v_mfma_f32_16x16x32_bf16 v[76:79], a[20:23], a[76:79], v[76:79]
v_mfma_f32_16x16x32_bf16 v[100:103], a[24:27], a[76:79], v[100:103]
v_mfma_f32_16x16x32_bf16 v[124:127], a[28:31], a[76:79], v[124:127]
s_waitcnt lgkmcnt(0)
v_mfma_f32_16x16x32_bf16 v[32:35], a[32:35], a[0:3], v[32:35]
ds_read_b128 a[16:19], v11 offset:40960
v_mfma_f32_16x16x32_bf16 v[56:59], a[32:35], a[4:7], v[56:59]
ds_read_b64_tr_b16 a[56:57], v14 offset:28672
v_mfma_f32_16x16x32_bf16 v[80:83], a[32:35], a[8:11], v[80:83]
ds_read_b64_tr_b16 a[58:59], v14 offset:29184
v_mfma_f32_16x16x32_bf16 v[104:107], a[32:35], a[12:15], v[104:107]
ds_read_b128 a[20:23], v11 offset:43008
v_mfma_f32_16x16x32_bf16 v[36:39], a[36:39], a[0:3], v[36:39]
ds_read_b128 a[24:27], v11 offset:45056
v_mfma_f32_16x16x32_bf16 v[60:63], a[36:39], a[4:7], v[60:63]
ds_read_b128 a[28:31], v11 offset:47104
v_mfma_f32_16x16x32_bf16 v[84:87], a[36:39], a[8:11], v[84:87]
ds_read_b64_tr_b16 a[60:61], v15 offset:28672
v_mfma_f32_16x16x32_bf16 v[108:111], a[36:39], a[12:15], v[108:111]
ds_read_b64_tr_b16 a[62:63], v15 offset:29184
v_mfma_f32_16x16x32_bf16 v[40:43], a[0:3], a[40:43], v[40:43]
ds_read_b64_tr_b16 a[64:65], v14 offset:30720
v_mfma_f32_16x16x32_bf16 v[64:67], a[4:7], a[40:43], v[64:67]
ds_read_b64_tr_b16 a[66:67], v14 offset:31232
v_mfma_f32_16x16x32_bf16 v[88:91], a[8:11], a[40:43], v[88:91]
ds_read_b64_tr_b16 a[68:69], v15 offset:30720
v_mfma_f32_16x16x32_bf16 v[112:115], a[12:15], a[40:43], v[112:115]
ds_read_b64_tr_b16 a[70:71], v15 offset:31232
v_mfma_f32_16x16x32_bf16 v[44:47], a[0:3], a[44:47], v[44:47]
ds_read_b64_tr_b16 a[72:73], v14 offset:32768
v_mfma_f32_16x16x32_bf16 v[68:71], a[4:7], a[44:47], v[68:71]
ds_read_b64_tr_b16 a[74:75], v14 offset:33280
v_mfma_f32_16x16x32_bf16 v[92:95], a[8:11], a[44:47], v[92:95]
ds_read_b64_tr_b16 a[76:77], v15 offset:32768
v_mfma_f32_16x16x32_bf16 v[116:119], a[12:15], a[44:47], v[116:119]
ds_read_b64_tr_b16 a[78:79], v15 offset:33280
v_mfma_f32_16x16x32_bf16 v[48:51], a[0:3], a[48:51], v[48:51]
v_mfma_f32_16x16x32_bf16 v[72:75], a[4:7], a[48:51], v[72:75]
v_mfma_f32_16x16x32_bf16 v[96:99], a[8:11], a[48:51], v[96:99]
v_mfma_f32_16x16x32_bf16 v[120:123], a[12:15], a[48:51], v[120:123]
v_mfma_f32_16x16x32_bf16 v[52:55], a[0:3], a[52:55], v[52:55]
v_mfma_f32_16x16x32_bf16 v[76:79], a[4:7], a[52:55], v[76:79]
v_mfma_f32_16x16x32_bf16 v[100:103], a[8:11], a[52:55], v[100:103]
v_mfma_f32_16x16x32_bf16 v[124:127], a[12:15], a[52:55], v[124:127]
s_waitcnt lgkmcnt(0)
v_mfma_f32_16x16x32_bf16 v[32:35], a[56:59], a[16:19], v[32:35]
s_barrier
ds_read_b128 a[0:3], v10 offset:0
v_mfma_f32_16x16x32_bf16 v[56:59], a[56:59], a[20:23], v[56:59]
ds_read_b64_tr_b16 a[32:33], v12 offset:40960
v_mfma_f32_16x16x32_bf16 v[80:83], a[56:59], a[24:27], v[80:83]
ds_read_b64_tr_b16 a[34:35], v12 offset:41472
v_mfma_f32_16x16x32_bf16 v[104:107], a[56:59], a[28:31], v[104:107]
ds_read_b128 a[4:7], v10 offset:2048
v_mfma_f32_16x16x32_bf16 v[36:39], a[60:63], a[16:19], v[36:39]
ds_read_b128 a[8:11], v10 offset:4096
v_mfma_f32_16x16x32_bf16 v[60:63], a[60:63], a[20:23], v[60:63]
ds_read_b128 a[12:15], v10 offset:6144
v_mfma_f32_16x16x32_bf16 v[84:87], a[60:63], a[24:27], v[84:87]
ds_read_b64_tr_b16 a[36:37], v13 offset:40960
v_mfma_f32_16x16x32_bf16 v[108:111], a[60:63], a[28:31], v[108:111]
ds_read_b64_tr_b16 a[38:39], v13 offset:41472
v_mfma_f32_16x16x32_bf16 v[40:43], a[16:19], a[64:67], v[40:43]
ds_read_b64_tr_b16 a[40:41], v12 offset:43008
v_mfma_f32_16x16x32_bf16 v[64:67], a[20:23], a[64:67], v[64:67]
ds_read_b64_tr_b16 a[42:43], v12 offset:43520
v_mfma_f32_16x16x32_bf16 v[88:91], a[24:27], a[64:67], v[88:91]
ds_read_b64_tr_b16 a[44:45], v13 offset:43008
v_mfma_f32_16x16x32_bf16 v[112:115], a[28:31], a[64:67], v[112:115]
ds_read_b64_tr_b16 a[46:47], v13 offset:43520
v_mfma_f32_16x16x32_bf16 v[44:47], a[16:19], a[68:71], v[44:47]
ds_read_b64_tr_b16 a[48:49], v12 offset:45056
v_mfma_f32_16x16x32_bf16 v[68:71], a[20:23], a[68:71], v[68:71]
ds_read_b64_tr_b16 a[50:51], v12 offset:45568
v_mfma_f32_16x16x32_bf16 v[92:95], a[24:27], a[68:71], v[92:95]
ds_read_b64_tr_b16 a[52:53], v13 offset:45056
v_mfma_f32_16x16x32_bf16 v[116:119], a[28:31], a[68:71], v[116:119]
ds_read_b64_tr_b16 a[54:55], v13 offset:45568
v_mfma_f32_16x16x32_bf16 v[48:51], a[16:19], a[72:75], v[48:51]
v_mfma_f32_16x16x32_bf16 v[72:75], a[20:23], a[72:75], v[72:75]
v_mfma_f32_16x16x32_bf16 v[96:99], a[24:27], a[72:75], v[96:99]
v_mfma_f32_16x16x32_bf16 v[120:123], a[28:31], a[72:75], v[120:123]
v_mfma_f32_16x16x32_bf16 v[52:55], a[16:19], a[76:79], v[52:55]
v_mfma_f32_16x16x32_bf16 v[76:79], a[20:23], a[76:79], v[76:79]
v_mfma_f32_16x16x32_bf16 v[100:103], a[24:27], a[76:79], v[100:103]
v_mfma_f32_16x16x32_bf16 v[124:127], a[28:31], a[76:79], v[124:127]
s_waitcnt lgkmcnt(0)
v_mfma_f32_16x16x32_bf16 v[32:35], a[32:35], a[0:3], v[32:35]
ds_read_b128 a[16:19], v11 offset:0
v_mfma_f32_16x16x32_bf16 v[56:59], a[32:35], a[4:7], v[56:59]
ds_read_b64_tr_b16 a[56:57], v12 offset:53248
v_mfma_f32_16x16x32_bf16 v[80:83], a[32:35], a[8:11], v[80:83]
ds_read_b64_tr_b16 a[58:59], v12 offset:53760
v_mfma_f32_16x16x32_bf16 v[104:107], a[32:35], a[12:15], v[104:107]
ds_read_b128 a[20:23], v11 offset:2048
v_mfma_f32_16x16x32_bf16 v[36:39], a[36:39], a[0:3], v[36:39]
ds_read_b128 a[24:27], v11 offset:4096
v_mfma_f32_16x16x32_bf16 v[60:63], a[36:39], a[4:7], v[60:63]
ds_read_b128 a[28:31], v11 offset:6144
v_mfma_f32_16x16x32_bf16 v[84:87], a[36:39], a[8:11], v[84:87]
ds_read_b64_tr_b16 a[60:61], v13 offset:53248
v_mfma_f32_16x16x32_bf16 v[108:111], a[36:39], a[12:15], v[108:111]
ds_read_b64_tr_b16 a[62:63], v13 offset:53760
v_mfma_f32_16x16x32_bf16 v[40:43], a[0:3], a[40:43], v[40:43]
ds_read_b64_tr_b16 a[64:65], v12 offset:55296
v_mfma_f32_16x16x32_bf16 v[64:67], a[4:7], a[40:43], v[64:67]
ds_read_b64_tr_b16 a[66:67], v12 offset:55808
v_mfma_f32_16x16x32_bf16 v[88:91], a[8:11], a[40:43], v[88:91]
ds_read_b64_tr_b16 a[68:69], v13 offset:55296
v_mfma_f32_16x16x32_bf16 v[112:115], a[12:15], a[40:43], v[112:115]
ds_read_b64_tr_b16 a[70:71], v13 offset:55808
v_mfma_f32_16x16x32_bf16 v[44:47], a[0:3], a[44:47], v[44:47]
ds_read_b64_tr_b16 a[72:73], v12 offset:57344
v_mfma_f32_16x16x32_bf16 v[68:71], a[4:7], a[44:47], v[68:71]
ds_read_b64_tr_b16 a[74:75], v12 offset:57856
v_mfma_f32_16x16x32_bf16 v[92:95], a[8:11], a[44:47], v[92:95]
ds_read_b64_tr_b16 a[76:77], v13 offset:57344
v_mfma_f32_16x16x32_bf16 v[116:119], a[12:15], a[44:47], v[116:119]
ds_read_b64_tr_b16 a[78:79], v13 offset:57856
v_mfma_f32_16x16x32_bf16 v[48:51], a[0:3], a[48:51], v[48:51]
s_lshl_b32 s70, s60, 10
s_add_u32 s70, s70, s87
buffer_store_dwordx4 v[28:31], v16, s[12:15], s70 offen sc1
v_mfma_f32_16x16x32_bf16 v[72:75], a[4:7], a[48:51], v[72:75]
v_mfma_f32_16x16x32_bf16 v[96:99], a[8:11], a[48:51], v[96:99]
v_mfma_f32_16x16x32_bf16 v[120:123], a[12:15], a[48:51], v[120:123]
v_mfma_f32_16x16x32_bf16 v[52:55], a[0:3], a[52:55], v[52:55]
v_mfma_f32_16x16x32_bf16 v[76:79], a[4:7], a[52:55], v[76:79]
v_mfma_f32_16x16x32_bf16 v[100:103], a[8:11], a[52:55], v[100:103]
v_mfma_f32_16x16x32_bf16 v[124:127], a[12:15], a[52:55], v[124:127]
s_waitcnt lgkmcnt(0)
v_mfma_f32_16x16x32_bf16 v[32:35], a[56:59], a[16:19], v[32:35]
s_barrier
ds_read_b128 a[0:3], v8 offset:24576
v_mfma_f32_16x16x32_bf16 v[56:59], a[56:59], a[20:23], v[56:59]
ds_read_b64_tr_b16 a[32:33], v12 offset:0
v_mfma_f32_16x16x32_bf16 v[80:83], a[56:59], a[24:27], v[80:83]
ds_read_b64_tr_b16 a[34:35], v12 offset:512
v_mfma_f32_16x16x32_bf16 v[104:107], a[56:59], a[28:31], v[104:107]
ds_read_b128 a[4:7], v8 offset:26624
v_mfma_f32_16x16x32_bf16 v[36:39], a[60:63], a[16:19], v[36:39]
ds_read_b128 a[8:11], v8 offset:28672
v_mfma_f32_16x16x32_bf16 v[60:63], a[60:63], a[20:23], v[60:63]
ds_read_b128 a[12:15], v8 offset:30720
v_mfma_f32_16x16x32_bf16 v[84:87], a[60:63], a[24:27], v[84:87]
ds_read_b64_tr_b16 a[36:37], v13 offset:0
v_mfma_f32_16x16x32_bf16 v[108:111], a[60:63], a[28:31], v[108:111]
ds_read_b64_tr_b16 a[38:39], v13 offset:512
v_mfma_f32_16x16x32_bf16 v[40:43], a[16:19], a[64:67], v[40:43]
ds_read_b64_tr_b16 a[40:41], v12 offset:2048
v_mfma_f32_16x16x32_bf16 v[64:67], a[20:23], a[64:67], v[64:67]
ds_read_b64_tr_b16 a[42:43], v12 offset:2560
v_mfma_f32_16x16x32_bf16 v[88:91], a[24:27], a[64:67], v[88:91]
ds_read_b64_tr_b16 a[44:45], v13 offset:2048
v_mfma_f32_16x16x32_bf16 v[112:115], a[28:31], a[64:67], v[112:115]
ds_read_b64_tr_b16 a[46:47], v13 offset:2560
v_mfma_f32_16x16x32_bf16 v[44:47], a[16:19], a[68:71], v[44:47]
ds_read_b64_tr_b16 a[48:49], v12 offset:4096
v_mfma_f32_16x16x32_bf16 v[68:71], a[20:23], a[68:71], v[68:71]
ds_read_b64_tr_b16 a[50:51], v12 offset:4608
v_mfma_f32_16x16x32_bf16 v[92:95], a[24:27], a[68:71], v[92:95]
ds_read_b64_tr_b16 a[52:53], v13 offset:4096
v_mfma_f32_16x16x32_bf16 v[116:119], a[28:31], a[68:71], v[116:119]
ds_read_b64_tr_b16 a[54:55], v13 offset:4608
v_mfma_f32_16x16x32_bf16 v[48:51], a[16:19], a[72:75], v[48:51]
v_mfma_f32_16x16x32_bf16 v[72:75], a[20:23], a[72:75], v[72:75]
v_mfma_f32_16x16x32_bf16 v[96:99], a[24:27], a[72:75], v[96:99]
v_mfma_f32_16x16x32_bf16 v[120:123], a[28:31], a[72:75], v[120:123]
v_mfma_f32_16x16x32_bf16 v[52:55], a[16:19], a[76:79], v[52:55]
v_mfma_f32_16x16x32_bf16 v[76:79], a[20:23], a[76:79], v[76:79]
v_mfma_f32_16x16x32_bf16 v[100:103], a[24:27], a[76:79], v[100:103]
v_mfma_f32_16x16x32_bf16 v[124:127], a[28:31], a[76:79], v[124:127]
s_waitcnt lgkmcnt(0)
v_mfma_f32_16x16x32_bf16 v[32:35], a[32:35], a[0:3], v[32:35]
ds_read_b128 a[16:19], v9 offset:24576
v_mfma_f32_16x16x32_bf16 v[56:59], a[32:35], a[4:7], v[56:59]
ds_read_b64_tr_b16 a[56:57], v12 offset:12288
v_mfma_f32_16x16x32_bf16 v[80:83], a[32:35], a[8:11], v[80:83]
ds_read_b64_tr_b16 a[58:59], v12 offset:12800
v_mfma_f32_16x16x32_bf16 v[104:107], a[32:35], a[12:15], v[104:107]
ds_read_b128 a[20:23], v9 offset:26624
v_mfma_f32_16x16x32_bf16 v[36:39], a[36:39], a[0:3], v[36:39]
ds_read_b128 a[24:27], v9 offset:28672
v_mfma_f32_16x16x32_bf16 v[60:63], a[36:39], a[4:7], v[60:63]
ds_read_b128 a[28:31], v9 offset:30720
v_mfma_f32_16x16x32_bf16 v[84:87], a[36:39], a[8:11], v[84:87]
ds_read_b64_tr_b16 a[60:61], v13 offset:12288
v_mfma_f32_16x16x32_bf16 v[108:111], a[36:39], a[12:15], v[108:111]
ds_read_b64_tr_b16 a[62:63], v13 offset:12800
v_mfma_f32_16x16x32_bf16 v[40:43], a[0:3], a[40:43], v[40:43]
ds_read_b64_tr_b16 a[64:65], v12 offset:14336
v_mfma_f32_16x16x32_bf16 v[64:67], a[4:7], a[40:43], v[64:67]
ds_read_b64_tr_b16 a[66:67], v12 offset:14848
v_mfma_f32_16x16x32_bf16 v[88:91], a[8:11], a[40:43], v[88:91]
ds_read_b64_tr_b16 a[68:69], v13 offset:14336
v_mfma_f32_16x16x32_bf16 v[112:115], a[12:15], a[40:43], v[112:115]
ds_read_b64_tr_b16 a[70:71], v13 offset:14848
v_mfma_f32_16x16x32_bf16 v[44:47], a[0:3], a[44:47], v[44:47]
ds_read_b64_tr_b16 a[72:73], v12 offset:16384
v_mfma_f32_16x16x32_bf16 v[68:71], a[4:7], a[44:47], v[68:71]
ds_read_b64_tr_b16 a[74:75], v12 offset:16896
v_mfma_f32_16x16x32_bf16 v[92:95], a[8:11], a[44:47], v[92:95]
ds_read_b64_tr_b16 a[76:77], v13 offset:16384
v_mfma_f32_16x16x32_bf16 v[116:119], a[12:15], a[44:47], v[116:119]
ds_read_b64_tr_b16 a[78:79], v13 offset:16896
v_mfma_f32_16x16x32_bf16 v[48:51], a[0:3], a[48:51], v[48:51]
s_cmp_lg_u32 s66, 0
s_cbranch_scc1 L_nocsp
v_and_b32 v2, 16, v1
v_cmp_ne_u32 vcc, 0, v2
s_nop 1
v_cndmask_b32 v24, v128, v132, vcc
v_cndmask_b32 v25, v136, v140, vcc
v_cndmask_b32 v26, v144, v148, vcc
v_mov_b32 v27, s68
s_lshl_b32 s70, s64, 4
s_add_u32 s70, s70, s65
s_lshl_b32 s70, s70, 10
s_lshl_b32 s71, s67, 9
s_add_u32 s70, s70, s71
s_add_u32 s70, s70, 65536
s_mov_b64 exec, 0xffffffff
buffer_store_dwordx4 v[24:27], v16, s[12:15], s70 offen sc1
s_mov_b64 exec, -1
L_nocsp:
v_mfma_f32_16x16x32_bf16 v[72:75], a[4:7], a[48:51], v[72:75]
v_mfma_f32_16x16x32_bf16 v[96:99], a[8:11], a[48:51], v[96:99]
v_mfma_f32_16x16x32_bf16 v[120:123], a[12:15], a[48:51], v[120:123]
v_mfma_f32_16x16x32_bf16 v[52:55], a[0:3], a[52:55], v[52:55]
v_mfma_f32_16x16x32_bf16 v[76:79], a[4:7], a[52:55], v[76:79]
v_mfma_f32_16x16x32_bf16 v[100:103], a[8:11], a[52:55], v[100:103]
v_mfma_f32_16x16x32_bf16 v[124:127], a[12:15], a[52:55], v[124:127]
s_waitcnt lgkmcnt(0)
v_mfma_f32_16x16x32_bf16 v[32:35], a[56:59], a[16:19], v[32:35]
s_barrier
ds_read_b128 a[0:3], v10 offset:57344
v_mfma_f32_16x16x32_bf16 v[56:59], a[56:59], a[20:23], v[56:59]
ds_read_b64_tr_b16 a[32:33], v14 offset:16384
v_mfma_f32_16x16x32_bf16 v[80:83], a[56:59], a[24:27], v[80:83]
ds_read_b64_tr_b16 a[34:35], v14 offset:16896
v_mfma_f32_16x16x32_bf16 v[104:107], a[56:59], a[28:31], v[104:107]
ds_read_b128 a[4:7], v10 offset:59392
v_mfma_f32_16x16x32_bf16 v[36:39], a[60:63], a[16:19], v[36:39]
ds_read_b128 a[8:11], v10 offset:61440
v_mfma_f32_16x16x32_bf16 v[60:63], a[60:63], a[20:23], v[60:63]
ds_read_b128 a[12:15], v10 offset:63488
v_mfma_f32_16x16x32_bf16 v[84:87], a[60:63], a[24:27], v[84:87]
ds_read_b64_tr_b16 a[36:37], v15 offset:16384
v_mfma_f32_16x16x32_bf16 v[108:111], a[60:63], a[28:31], v[108:111]
ds_read_b64_tr_b16 a[38:39], v15 offset:16896
v_mfma_f32_16x16x32_bf16 v[40:43], a[16:19], a[64:67], v[40:43]
ds_read_b64_tr_b16 a[40:41], v14 offset:18432
v_mfma_f32_16x16x32_bf16 v[64:67], a[20:23], a[64:67], v[64:67]
ds_read_b64_tr_b16 a[42:43], v14 offset:18944
v_mfma_f32_16x16x32_bf16 v[88:91], a[24:27], a[64:67], v[88:91]
ds_read_b64_tr_b16 a[44:45], v15 offset:18432
v_mfma_f32_16x16x32_bf16 v[112:115], a[28:31], a[64:67], v[112:115]
ds_read_b64_tr_b16 a[46:47], v15 offset:18944
v_mfma_f32_16x16x32_bf16 v[44:47], a[16:19], a[68:71], v[44:47]
ds_read_b64_tr_b16 a[48:49], v14 offset:20480
v_mfma_f32_16x16x32_bf16 v[68:71], a[20:23], a[68:71], v[68:71]
ds_read_b64_tr_b16 a[50:51], v14 offset:20992
v_mfma_f32_16x16x32_bf16 v[92:95], a[24:27], a[68:71], v[92:95]
ds_read_b64_tr_b16 a[52:53], v15 offset:20480
v_mfma_f32_16x16x32_bf16 v[116:119], a[28:31], a[68:71], v[116:119]
ds_read_b64_tr_b16 a[54:55], v15 offset:20992
v_mfma_f32_16x16x32_bf16 v[48:51], a[16:19], a[72:75], v[48:51]
v_mfma_f32_16x16x32_bf16 v[72:75], a[20:23], a[72:75], v[72:75]
v_mfma_f32_16x16x32_bf16 v[96:99], a[24:27], a[72:75], v[96:99]
v_mfma_f32_16x16x32_bf16 v[120:123], a[28:31], a[72:75], v[120:123]
v_mfma_f32_16x16x32_bf16 v[52:55], a[16:19], a[76:79], v[52:55]
v_mfma_f32_16x16x32_bf16 v[76:79], a[20:23], a[76:79], v[76:79]
v_mfma_f32_16x16x32_bf16 v[100:103], a[24:27], a[76:79], v[100:103]
v_mfma_f32_16x16x32_bf16 v[124:127], a[28:31], a[76:79], v[124:127]
s_waitcnt lgkmcnt(0)
v_mfma_f32_16x16x32_bf16 v[32:35], a[32:35], a[0:3], v[32:35]
ds_read_b128 a[16:19], v11 offset:57344
v_mfma_f32_16x16x32_bf16 v[56:59], a[32:35], a[4:7], v[56:59]
ds_read_b64_tr_b16 a[56:57], v14 offset:28672
v_mfma_f32_16x16x32_bf16 v[80:83], a[32:35], a[8:11], v[80:83]
ds_read_b64_tr_b16 a[58:59], v14 offset:29184
v_mfma_f32_16x16x32_bf16 v[104:107], a[32:35], a[12:15], v[104:107]
ds_read_b128 a[20:23], v11 offset:59392
v_mfma_f32_16x16x32_bf16 v[36:39], a[36:39], a[0:3], v[36:39]
ds_read_b128 a[24:27], v11 offset:61440
v_mfma_f32_16x16x32_bf16 v[60:63], a[36:39], a[4:7], v[60:63]
ds_read_b128 a[28:31], v11 offset:63488
v_mfma_f32_16x16x32_bf16 v[84:87], a[36:39], a[8:11], v[84:87]
ds_read_b64_tr_b16 a[60:61], v15 offset:28672
v_mfma_f32_16x16x32_bf16 v[108:111], a[36:39], a[12:15], v[108:111]
ds_read_b64_tr_b16 a[62:63], v15 offset:29184
v_mfma_f32_16x16x32_bf16 v[40:43], a[0:3], a[40:43], v[40:43]
ds_read_b64_tr_b16 a[64:65], v14 offset:30720
v_mfma_f32_16x16x32_bf16 v[64:67], a[4:7], a[40:43], v[64:67]
ds_read_b64_tr_b16 a[66:67], v14 offset:31232
v_mfma_f32_16x16x32_bf16 v[88:91], a[8:11], a[40:43], v[88:91]
ds_read_b64_tr_b16 a[68:69], v15 offset:30720
v_mfma_f32_16x16x32_bf16 v[112:115], a[12:15], a[40:43], v[112:115]
ds_read_b64_tr_b16 a[70:71], v15 offset:31232
v_mfma_f32_16x16x32_bf16 v[44:47], a[0:3], a[44:47], v[44:47]
ds_read_b64_tr_b16 a[72:73], v14 offset:32768
v_mfma_f32_16x16x32_bf16 v[68:71], a[4:7], a[44:47], v[68:71]
ds_read_b64_tr_b16 a[74:75], v14 offset:33280
v_mfma_f32_16x16x32_bf16 v[92:95], a[8:11], a[44:47], v[92:95]
ds_read_b64_tr_b16 a[76:77], v15 offset:32768
v_mfma_f32_16x16x32_bf16 v[116:119], a[12:15], a[44:47], v[116:119]
ds_read_b64_tr_b16 a[78:79], v15 offset:33280
v_mfma_f32_16x16x32_bf16 v[48:51], a[0:3], a[48:51], v[48:51]
s_add_u32 s70, s88, 0
buffer_store_dwordx4 v[28:31], v16, s[12:15], s70 offen sc1
v_mfma_f32_16x16x32_bf16 v[72:75], a[4:7], a[48:51], v[72:75]
v_mfma_f32_16x16x32_bf16 v[96:99], a[8:11], a[48:51], v[96:99]
s_add_u32 s70, s88, 32768
buffer_store_dwordx4 v[28:31], v16, s[12:15], s70 offen sc1
v_mfma_f32_16x16x32_bf16 v[120:123], a[12:15], a[48:51], v[120:123]
v_mfma_f32_16x16x32_bf16 v[52:55], a[0:3], a[52:55], v[52:55]
v_mfma_f32_16x16x32_bf16 v[76:79], a[4:7], a[52:55], v[76:79]
v_mfma_f32_16x16x32_bf16 v[100:103], a[8:11], a[52:55], v[100:103]
v_mfma_f32_16x16x32_bf16 v[124:127], a[12:15], a[52:55], v[124:127]
s_waitcnt lgkmcnt(0)
v_mfma_f32_16x16x32_bf16 v[32:35], a[56:59], a[16:19], v[32:35]
s_barrier
ds_read_b128 a[0:3], v10 offset:40960
v_mfma_f32_16x16x32_bf16 v[56:59], a[56:59], a[20:23], v[56:59]
ds_read_b64_tr_b16 a[32:33], v12 offset:40960
v_mfma_f32_16x16x32_bf16 v[80:83], a[56:59], a[24:27], v[80:83]
ds_read_b64_tr_b16 a[34:35], v12 offset:41472
v_mfma_f32_16x16x32_bf16 v[104:107], a[56:59], a[28:31], v[104:107]
ds_read_b128 a[4:7], v10 offset:43008
v_mfma_f32_16x16x32_bf16 v[36:39], a[60:63], a[16:19], v[36:39]
ds_read_b128 a[8:11], v10 offset:45056
v_mfma_f32_16x16x32_bf16 v[60:63], a[60:63], a[20:23], v[60:63]
ds_read_b128 a[12:15], v10 offset:47104
v_mfma_f32_16x16x32_bf16 v[84:87], a[60:63], a[24:27], v[84:87]
ds_read_b64_tr_b16 a[36:37], v13 offset:40960
v_mfma_f32_16x16x32_bf16 v[108:111], a[60:63], a[28:31], v[108:111]
ds_read_b64_tr_b16 a[38:39], v13 offset:41472
v_mfma_f32_16x16x32_bf16 v[40:43], a[16:19], a[64:67], v[40:43]
ds_read_b64_tr_b16 a[40:41], v12 offset:43008
v_mfma_f32_16x16x32_bf16 v[64:67], a[20:23], a[64:67], v[64:67]
ds_read_b64_tr_b16 a[42:43], v12 offset:43520
v_mfma_f32_16x16x32_bf16 v[88:91], a[24:27], a[64:67], v[88:91]
ds_read_b64_tr_b16 a[44:45], v13 offset:43008
v_mfma_f32_16x16x32_bf16 v[112:115], a[28:31], a[64:67], v[112:115]
ds_read_b64_tr_b16 a[46:47], v13 offset:43520
v_mfma_f32_16x16x32_bf16 v[44:47], a[16:19], a[68:71], v[44:47]
ds_read_b64_tr_b16 a[48:49], v12 offset:45056
v_mfma_f32_16x16x32_bf16 v[68:71], a[20:23], a[68:71], v[68:71]
ds_read_b64_tr_b16 a[50:51], v12 offset:45568
v_mfma_f32_16x16x32_bf16 v[92:95], a[24:27], a[68:71], v[92:95]
ds_read_b64_tr_b16 a[52:53], v13 offset:45056
v_mfma_f32_16x16x32_bf16 v[116:119], a[28:31], a[68:71], v[116:119]
ds_read_b64_tr_b16 a[54:55], v13 offset:45568
v_mfma_f32_16x16x32_bf16 v[48:51], a[16:19], a[72:75], v[48:51]
v_mfma_f32_16x16x32_bf16 v[72:75], a[20:23], a[72:75], v[72:75]
v_mfma_f32_16x16x32_bf16 v[96:99], a[24:27], a[72:75], v[96:99]
v_mfma_f32_16x16x32_bf16 v[120:123], a[28:31], a[72:75], v[120:123]
v_mfma_f32_16x16x32_bf16 v[52:55], a[16:19], a[76:79], v[52:55]
v_mfma_f32_16x16x32_bf16 v[76:79], a[20:23], a[76:79], v[76:79]
v_mfma_f32_16x16x32_bf16 v[100:103], a[24:27], a[76:79], v[100:103]
v_mfma_f32_16x16x32_bf16 v[124:127], a[28:31], a[76:79], v[124:127]
s_waitcnt lgkmcnt(0)
v_mfma_f32_16x16x32_bf16 v[32:35], a[32:35], a[0:3], v[32:35]
ds_read_b128 a[16:19], v11 offset:40960
v_mfma_f32_16x16x32_bf16 v[56:59], a[32:35], a[4:7], v[56:59]
ds_read_b64_tr_b16 a[56:57], v12 offset:53248
v_mfma_f32_16x16x32_bf16 v[80:83], a[32:35], a[8:11], v[80:83]
ds_read_b64_tr_b16 a[58:59], v12 offset:53760
v_mfma_f32_16x16x32_bf16 v[104:107], a[32:35], a[12:15], v[104:107]
ds_read_b128 a[20:23], v11 offset:43008
v_mfma_f32_16x16x32_bf16 v[36:39], a[36:39], a[0:3], v[36:39]
ds_read_b128 a[24:27], v11 offset:45056
v_mfma_f32_16x16x32_bf16 v[60:63], a[36:39], a[4:7], v[60:63]
ds_read_b128 a[28:31], v11 offset:47104
v_mfma_f32_16x16x32_bf16 v[84:87], a[36:39], a[8:11], v[84:87]
ds_read_b64_tr_b16 a[60:61], v13 offset:53248
v_mfma_f32_16x16x32_bf16 v[108:111], a[36:39], a[12:15], v[108:111]
ds_read_b64_tr_b16 a[62:63], v13 offset:53760
v_mfma_f32_16x16x32_bf16 v[40:43], a[0:3], a[40:43], v[40:43]
ds_read_b64_tr_b16 a[64:65], v12 offset:55296
v_mfma_f32_16x16x32_bf16 v[64:67], a[4:7], a[40:43], v[64:67]
ds_read_b64_tr_b16 a[66:67], v12 offset:55808
v_mfma_f32_16x16x32_bf16 v[88:91], a[8:11], a[40:43], v[88:91]
ds_read_b64_tr_b16 a[68:69], v13 offset:55296
v_mfma_f32_16x16x32_bf16 v[112:115], a[12:15], a[40:43], v[112:115]
ds_read_b64_tr_b16 a[70:71], v13 offset:55808
v_mfma_f32_16x16x32_bf16 v[44:47], a[0:3], a[44:47], v[44:47]
ds_read_b64_tr_b16 a[72:73], v12 offset:57344
v_mfma_f32_16x16x32_bf16 v[68:71], a[4:7], a[44:47], v[68:71]
ds_read_b64_tr_b16 a[74:75], v12 offset:57856
v_mfma_f32_16x16x32_bf16 v[92:95], a[8:11], a[44:47], v[92:95]
ds_read_b64_tr_b16 a[76:77], v13 offset:57344
v_mfma_f32_16x16x32_bf16 v[116:119], a[12:15], a[44:47], v[116:119]
ds_read_b64_tr_b16 a[78:79], v13 offset:57856
v_mfma_f32_16x16x32_bf16 v[48:51], a[0:3], a[48:51], v[48:51]
s_add_u32 s70, s88, 65536
buffer_store_dwordx4 v[28:31], v16, s[12:15], s70 offen sc1
v_mfma_f32_16x16x32_bf16 v[72:75], a[4:7], a[48:51], v[72:75]
v_mfma_f32_16x16x32_bf16 v[96:99], a[8:11], a[48:51], v[96:99]
s_add_u32 s70, s88, 98304
buffer_store_dwordx4 v[28:31], v16, s[12:15], s70 offen sc1
v_mfma_f32_16x16x32_bf16 v[120:123], a[12:15], a[48:51], v[120:123]
v_mfma_f32_16x16x32_bf16 v[52:55], a[0:3], a[52:55], v[52:55]
v_mfma_f32_16x16x32_bf16 v[76:79], a[4:7], a[52:55], v[76:79]
v_mfma_f32_16x16x32_bf16 v[100:103], a[8:11], a[52:55], v[100:103]
v_mfma_f32_16x16x32_bf16 v[124:127], a[12:15], a[52:55], v[124:127]
s_waitcnt lgkmcnt(0)
v_mfma_f32_16x16x32_bf16 v[32:35], a[56:59], a[16:19], v[32:35]
s_barrier
ds_read_b128 a[0:3], v10 offset:0
v_mfma_f32_16x16x32_bf16 v[56:59], a[56:59], a[20:23], v[56:59]
ds_read_b64_tr_b16 a[32:33], v12 offset:0
v_mfma_f32_16x16x32_bf16 v[80:83], a[56:59], a[24:27], v[80:83]
ds_read_b64_tr_b16 a[34:35], v12 offset:512
v_mfma_f32_16x16x32_bf16 v[104:107], a[56:59], a[28:31], v[104:107]
ds_read_b128 a[4:7], v10 offset:2048
v_mfma_f32_16x16x32_bf16 v[36:39], a[60:63], a[16:19], v[36:39]
ds_read_b128 a[8:11], v10 offset:4096
v_mfma_f32_16x16x32_bf16 v[60:63], a[60:63], a[20:23], v[60:63]
ds_read_b128 a[12:15], v10 offset:6144
v_mfma_f32_16x16x32_bf16 v[84:87], a[60:63], a[24:27], v[84:87]
ds_read_b64_tr_b16 a[36:37], v13 offset:0
v_mfma_f32_16x16x32_bf16 v[108:111], a[60:63], a[28:31], v[108:111]
ds_read_b64_tr_b16 a[38:39], v13 offset:512
v_mfma_f32_16x16x32_bf16 v[40:43], a[16:19], a[64:67], v[40:43]
ds_read_b64_tr_b16 a[40:41], v12 offset:2048
v_mfma_f32_16x16x32_bf16 v[64:67], a[20:23], a[64:67], v[64:67]
ds_read_b64_tr_b16 a[42:43], v12 offset:2560
v_mfma_f32_16x16x32_bf16 v[88:91], a[24:27], a[64:67], v[88:91]
ds_read_b64_tr_b16 a[44:45], v13 offset:2048
v_mfma_f32_16x16x32_bf16 v[112:115], a[28:31], a[64:67], v[112:115]
ds_read_b64_tr_b16 a[46:47], v13 offset:2560
v_mfma_f32_16x16x32_bf16 v[44:47], a[16:19], a[68:71], v[44:47]
ds_read_b64_tr_b16 a[48:49], v12 offset:4096
v_mfma_f32_16x16x32_bf16 v[68:71], a[20:23], a[68:71], v[68:71]
ds_read_b64_tr_b16 a[50:51], v12 offset:4608
v_mfma_f32_16x16x32_bf16 v[92:95], a[24:27], a[68:71], v[92:95]
ds_read_b64_tr_b16 a[52:53], v13 offset:4096
v_mfma_f32_16x16x32_bf16 v[116:119], a[28:31], a[68:71], v[116:119]
ds_read_b64_tr_b16 a[54:55], v13 offset:4608
v_mfma_f32_16x16x32_bf16 v[48:51], a[16:19], a[72:75], v[48:51]
v_mfma_f32_16x16x32_bf16 v[72:75], a[20:23], a[72:75], v[72:75]
v_mfma_f32_16x16x32_bf16 v[96:99], a[24:27], a[72:75], v[96:99]
v_mfma_f32_16x16x32_bf16 v[120:123], a[28:31], a[72:75], v[120:123]
v_mfma_f32_16x16x32_bf16 v[52:55], a[16:19], a[76:79], v[52:55]
v_mfma_f32_16x16x32_bf16 v[76:79], a[20:23], a[76:79], v[76:79]
v_mfma_f32_16x16x32_bf16 v[100:103], a[24:27], a[76:79], v[100:103]
v_mfma_f32_16x16x32_bf16 v[124:127], a[28:31], a[76:79], v[124:127]
s_waitcnt lgkmcnt(0)
v_mfma_f32_16x16x32_bf16 v[32:35], a[32:35], a[0:3], v[32:35]
ds_read_b128 a[16:19], v11 offset:0
v_mfma_f32_16x16x32_bf16 v[56:59], a[32:35], a[4:7], v[56:59]
ds_read_b64_tr_b16 a[56:57], v12 offset:12288
v_mfma_f32_16x16x32_bf16 v[80:83], a[32:35], a[8:11], v[80:83]
ds_read_b64_tr_b16 a[58:59], v12 offset:12800
v_mfma_f32_16x16x32_bf16 v[104:107], a[32:35], a[12:15], v[104:107]
ds_read_b128 a[20:23], v11 offset:2048
v_mfma_f32_16x16x32_bf16 v[36:39], a[36:39], a[0:3], v[36:39]
ds_read_b128 a[24:27], v11 offset:4096
v_mfma_f32_16x16x32_bf16 v[60:63], a[36:39], a[4:7], v[60:63]
ds_read_b128 a[28:31], v11 offset:6144
v_mfma_f32_16x16x32_bf16 v[84:87], a[36:39], a[8:11], v[84:87]
ds_read_b64_tr_b16 a[60:61], v13 offset:12288
v_mfma_f32_16x16x32_bf16 v[108:111], a[36:39], a[12:15], v[108:111]
ds_read_b64_tr_b16 a[62:63], v13 offset:12800
v_mfma_f32_16x16x32_bf16 v[40:43], a[0:3], a[40:43], v[40:43]
ds_read_b64_tr_b16 a[64:65], v12 offset:14336
v_mfma_f32_16x16x32_bf16 v[64:67], a[4:7], a[40:43], v[64:67]
ds_read_b64_tr_b16 a[66:67], v12 offset:14848
v_mfma_f32_16x16x32_bf16 v[88:91], a[8:11], a[40:43], v[88:91]
ds_read_b64_tr_b16 a[68:69], v13 offset:14336
v_mfma_f32_16x16x32_bf16 v[112:115], a[12:15], a[40:43], v[112:115]
ds_read_b64_tr_b16 a[70:71], v13 offset:14848
v_mfma_f32_16x16x32_bf16 v[44:47], a[0:3], a[44:47], v[44:47]
ds_read_b64_tr_b16 a[72:73], v12 offset:16384
v_mfma_f32_16x16x32_bf16 v[68:71], a[4:7], a[44:47], v[68:71]
ds_read_b64_tr_b16 a[74:75], v12 offset:16896
v_mfma_f32_16x16x32_bf16 v[92:95], a[8:11], a[44:47], v[92:95]
ds_read_b64_tr_b16 a[76:77], v13 offset:16384
v_mfma_f32_16x16x32_bf16 v[116:119], a[12:15], a[44:47], v[116:119]
ds_read_b64_tr_b16 a[78:79], v13 offset:16896
v_mfma_f32_16x16x32_bf16 v[48:51], a[0:3], a[48:51], v[48:51]
v_mfma_f32_16x16x32_bf16 v[72:75], a[4:7], a[48:51], v[72:75]
v_mfma_f32_16x16x32_bf16 v[96:99], a[8:11], a[48:51], v[96:99]
v_mfma_f32_16x16x32_bf16 v[120:123], a[12:15], a[48:51], v[120:123]
v_mfma_f32_16x16x32_bf16 v[52:55], a[0:3], a[52:55], v[52:55]
v_mfma_f32_16x16x32_bf16 v[76:79], a[4:7], a[52:55], v[76:79]
v_mfma_f32_16x16x32_bf16 v[100:103], a[8:11], a[52:55], v[100:103]
v_mfma_f32_16x16x32_bf16 v[124:127], a[12:15], a[52:55], v[124:127]
s_waitcnt lgkmcnt(0)
v_mfma_f32_16x16x32_bf16 v[32:35], a[56:59], a[16:19], v[32:35]
s_barrier
ds_read_b128 a[0:3], v8 offset:24576
v_mfma_f32_16x16x32_bf16 v[56:59], a[56:59], a[20:23], v[56:59]
ds_read_b64_tr_b16 a[32:33], v14 offset:16384
v_mfma_f32_16x16x32_bf16 v[80:83], a[56:59], a[24:27], v[80:83]
ds_read_b64_tr_b16 a[34:35], v14 offset:16896
v_mfma_f32_16x16x32_bf16 v[104:107], a[56:59], a[28:31], v[104:107]
ds_read_b128 a[4:7], v8 offset:26624
v_mfma_f32_16x16x32_bf16 v[36:39], a[60:63], a[16:19], v[36:39]
ds_read_b128 a[8:11], v8 offset:28672
v_mfma_f32_16x16x32_bf16 v[60:63], a[60:63], a[20:23], v[60:63]
ds_read_b128 a[12:15], v8 offset:30720
v_mfma_f32_16x16x32_bf16 v[84:87], a[60:63], a[24:27], v[84:87]
ds_read_b64_tr_b16 a[36:37], v15 offset:16384
v_mfma_f32_16x16x32_bf16 v[108:111], a[60:63], a[28:31], v[108:111]
ds_read_b64_tr_b16 a[38:39], v15 offset:16896
v_mfma_f32_16x16x32_bf16 v[40:43], a[16:19], a[64:67], v[40:43]
ds_read_b64_tr_b16 a[40:41], v14 offset:18432
v_mfma_f32_16x16x32_bf16 v[64:67], a[20:23], a[64:67], v[64:67]
ds_read_b64_tr_b16 a[42:43], v14 offset:18944
v_mfma_f32_16x16x32_bf16 v[88:91], a[24:27], a[64:67], v[88:91]
ds_read_b64_tr_b16 a[44:45], v15 offset:18432
v_mfma_f32_16x16x32_bf16 v[112:115], a[28:31], a[64:67], v[112:115]
ds_read_b64_tr_b16 a[46:47], v15 offset:18944
v_mfma_f32_16x16x32_bf16 v[44:47], a[16:19], a[68:71], v[44:47]
ds_read_b64_tr_b16 a[48:49], v14 offset:20480
v_mfma_f32_16x16x32_bf16 v[68:71], a[20:23], a[68:71], v[68:71]
ds_read_b64_tr_b16 a[50:51], v14 offset:20992
v_mfma_f32_16x16x32_bf16 v[92:95], a[24:27], a[68:71], v[92:95]
ds_read_b64_tr_b16 a[52:53], v15 offset:20480
v_mfma_f32_16x16x32_bf16 v[116:119], a[28:31], a[68:71], v[116:119]
ds_read_b64_tr_b16 a[54:55], v15 offset:20992
v_mfma_f32_16x16x32_bf16 v[48:51], a[16:19], a[72:75], v[48:51]
v_mfma_f32_16x16x32_bf16 v[72:75], a[20:23], a[72:75], v[72:75]
v_mfma_f32_16x16x32_bf16 v[96:99], a[24:27], a[72:75], v[96:99]
v_mfma_f32_16x16x32_bf16 v[120:123], a[28:31], a[72:75], v[120:123]
v_mfma_f32_16x16x32_bf16 v[52:55], a[16:19], a[76:79], v[52:55]
v_mfma_f32_16x16x32_bf16 v[76:79], a[20:23], a[76:79], v[76:79]
v_mfma_f32_16x16x32_bf16 v[100:103], a[24:27], a[76:79], v[100:103]
v_mfma_f32_16x16x32_bf16 v[124:127], a[28:31], a[76:79], v[124:127]
s_waitcnt lgkmcnt(0)
v_mfma_f32_16x16x32_bf16 v[32:35], a[32:35], a[0:3], v[32:35]
ds_read_b128 a[16:19], v9 offset:24576
v_mfma_f32_16x16x32_bf16 v[56:59], a[32:35], a[4:7], v[56:59]
ds_read_b64_tr_b16 a[56:57], v14 offset:28672
v_mfma_f32_16x16x32_bf16 v[80:83], a[32:35], a[8:11], v[80:83]
ds_read_b64_tr_b16 a[58:59], v14 offset:29184
v_mfma_f32_16x16x32_bf16 v[104:107], a[32:35], a[12:15], v[104:107]
ds_read_b128 a[20:23], v9 offset:26624
v_mfma_f32_16x16x32_bf16 v[36:39], a[36:39], a[0:3], v[36:39]
ds_read_b128 a[24:27], v9 offset:28672
v_mfma_f32_16x16x32_bf16 v[60:63], a[36:39], a[4:7], v[60:63]
ds_read_b128 a[28:31], v9 offset:30720
v_mfma_f32_16x16x32_bf16 v[84:87], a[36:39], a[8:11], v[84:87]
ds_read_b64_tr_b16 a[60:61], v15 offset:28672
v_mfma_f32_16x16x32_bf16 v[108:111], a[36:39], a[12:15], v[108:111]
ds_read_b64_tr_b16 a[62:63], v15 offset:29184
v_mfma_f32_16x16x32_bf16 v[40:43], a[0:3], a[40:43], v[40:43]
ds_read_b64_tr_b16 a[64:65], v14 offset:30720
v_mfma_f32_16x16x32_bf16 v[64:67], a[4:7], a[40:43], v[64:67]
ds_read_b64_tr_b16 a[66:67], v14 offset:31232
v_mfma_f32_16x16x32_bf16 v[88:91], a[8:11], a[40:43], v[88:91]
ds_read_b64_tr_b16 a[68:69], v15 offset:30720
v_mfma_f32_16x16x32_bf16 v[112:115], a[12:15], a[40:43], v[112:115]
ds_read_b64_tr_b16 a[70:71], v15 offset:31232
v_mfma_f32_16x16x32_bf16 v[44:47], a[0:3], a[44:47], v[44:47]
ds_read_b64_tr_b16 a[72:73], v14 offset:32768
v_mfma_f32_16x16x32_bf16 v[68:71], a[4:7], a[44:47], v[68:71]
ds_read_b64_tr_b16 a[74:75], v14 offset:33280
v_mfma_f32_16x16x32_bf16 v[92:95], a[8:11], a[44:47], v[92:95]
ds_read_b64_tr_b16 a[76:77], v15 offset:32768
v_mfma_f32_16x16x32_bf16 v[116:119], a[12:15], a[44:47], v[116:119]
ds_read_b64_tr_b16 a[78:79], v15 offset:33280
v_mfma_f32_16x16x32_bf16 v[48:51], a[0:3], a[48:51], v[48:51]
s_waitcnt vmcnt(0)
v_mfma_f32_16x16x32_bf16 v[72:75], a[4:7], a[48:51], v[72:75]
v_mfma_f32_16x16x32_bf16 v[96:99], a[8:11], a[48:51], v[96:99]
v_mfma_f32_16x16x32_bf16 v[120:123], a[12:15], a[48:51], v[120:123]
v_mfma_f32_16x16x32_bf16 v[52:55], a[0:3], a[52:55], v[52:55]
v_mfma_f32_16x16x32_bf16 v[76:79], a[4:7], a[52:55], v[76:79]
v_mfma_f32_16x16x32_bf16 v[100:103], a[8:11], a[52:55], v[100:103]
v_mfma_f32_16x16x32_bf16 v[124:127], a[12:15], a[52:55], v[124:127]
s_waitcnt lgkmcnt(0)
v_mfma_f32_16x16x32_bf16 v[32:35], a[56:59], a[16:19], v[32:35]
s_barrier
ds_read_b128 a[0:3], v10 offset:57344
v_mfma_f32_16x16x32_bf16 v[56:59], a[56:59], a[20:23], v[56:59]
ds_read_b64_tr_b16 a[32:33], v12 offset:40960
v_mfma_f32_16x16x32_bf16 v[80:83], a[56:59], a[24:27], v[80:83]
ds_read_b64_tr_b16 a[34:35], v12 offset:41472
v_mfma_f32_16x16x32_bf16 v[104:107], a[56:59], a[28:31], v[104:107]
ds_read_b128 a[4:7], v10 offset:59392
v_mfma_f32_16x16x32_bf16 v[36:39], a[60:63], a[16:19], v[36:39]
ds_read_b128 a[8:11], v10 offset:61440
v_mfma_f32_16x16x32_bf16 v[60:63], a[60:63], a[20:23], v[60:63]
ds_read_b128 a[12:15], v10 offset:63488
v_mfma_f32_16x16x32_bf16 v[84:87], a[60:63], a[24:27], v[84:87]
ds_read_b64_tr_b16 a[36:37], v13 offset:40960
v_mfma_f32_16x16x32_bf16 v[108:111], a[60:63], a[28:31], v[108:111]
ds_read_b64_tr_b16 a[38:39], v13 offset:41472
v_mfma_f32_16x16x32_bf16 v[40:43], a[16:19], a[64:67], v[40:43]
ds_read_b64_tr_b16 a[40:41], v12 offset:43008
v_mfma_f32_16x16x32_bf16 v[64:67], a[20:23], a[64:67], v[64:67]
ds_read_b64_tr_b16 a[42:43], v12 offset:43520
v_mfma_f32_16x16x32_bf16 v[88:91], a[24:27], a[64:67], v[88:91]
ds_read_b64_tr_b16 a[44:45], v13 offset:43008
v_mfma_f32_16x16x32_bf16 v[112:115], a[28:31], a[64:67], v[112:115]
ds_read_b64_tr_b16 a[46:47], v13 offset:43520
v_mfma_f32_16x16x32_bf16 v[44:47], a[16:19], a[68:71], v[44:47]
ds_read_b64_tr_b16 a[48:49], v12 offset:45056
v_mfma_f32_16x16x32_bf16 v[68:71], a[20:23], a[68:71], v[68:71]
ds_read_b64_tr_b16 a[50:51], v12 offset:45568
v_mfma_f32_16x16x32_bf16 v[92:95], a[24:27], a[68:71], v[92:95]
ds_read_b64_tr_b16 a[52:53], v13 offset:45056
v_mfma_f32_16x16x32_bf16 v[116:119], a[28:31], a[68:71], v[116:119]
ds_read_b64_tr_b16 a[54:55], v13 offset:45568
v_mfma_f32_16x16x32_bf16 v[48:51], a[16:19], a[72:75], v[48:51]
v_mfma_f32_16x16x32_bf16 v[72:75], a[20:23], a[72:75], v[72:75]
v_mfma_f32_16x16x32_bf16 v[96:99], a[24:27], a[72:75], v[96:99]
v_mfma_f32_16x16x32_bf16 v[120:123], a[28:31], a[72:75], v[120:123]
v_mfma_f32_16x16x32_bf16 v[52:55], a[16:19], a[76:79], v[52:55]
v_mfma_f32_16x16x32_bf16 v[76:79], a[20:23], a[76:79], v[76:79]
v_mfma_f32_16x16x32_bf16 v[100:103], a[24:27], a[76:79], v[100:103]
v_mfma_f32_16x16x32_bf16 v[124:127], a[28:31], a[76:79], v[124:127]
s_waitcnt lgkmcnt(0)
v_mfma_f32_16x16x32_bf16 v[32:35], a[32:35], a[0:3], v[32:35]
ds_read_b128 a[16:19], v11 offset:57344
v_mfma_f32_16x16x32_bf16 v[56:59], a[32:35], a[4:7], v[56:59]
ds_read_b64_tr_b16 a[56:57], v12 offset:53248
v_mfma_f32_16x16x32_bf16 v[80:83], a[32:35], a[8:11], v[80:83]
ds_read_b64_tr_b16 a[58:59], v12 offset:53760
v_mfma_f32_16x16x32_bf16 v[104:107], a[32:35], a[12:15], v[104:107]
ds_read_b128 a[20:23], v11 offset:59392
v_mfma_f32_16x16x32_bf16 v[36:39], a[36:39], a[0:3], v[36:39]
ds_read_b128 a[24:27], v11 offset:61440
v_mfma_f32_16x16x32_bf16 v[60:63], a[36:39], a[4:7], v[60:63]
ds_read_b128 a[28:31], v11 offset:63488
v_mfma_f32_16x16x32_bf16 v[84:87], a[36:39], a[8:11], v[84:87]
ds_read_b64_tr_b16 a[60:61], v13 offset:53248
v_mfma_f32_16x16x32_bf16 v[108:111], a[36:39], a[12:15], v[108:111]
ds_read_b64_tr_b16 a[62:63], v13 offset:53760
v_mfma_f32_16x16x32_bf16 v[40:43], a[0:3], a[40:43], v[40:43]
ds_read_b64_tr_b16 a[64:65], v12 offset:55296
v_mfma_f32_16x16x32_bf16 v[64:67], a[4:7], a[40:43], v[64:67]
ds_read_b64_tr_b16 a[66:67], v12 offset:55808
v_mfma_f32_16x16x32_bf16 v[88:91], a[8:11], a[40:43], v[88:91]
ds_read_b64_tr_b16 a[68:69], v13 offset:55296
v_mfma_f32_16x16x32_bf16 v[112:115], a[12:15], a[40:43], v[112:115]
ds_read_b64_tr_b16 a[70:71], v13 offset:55808
v_mfma_f32_16x16x32_bf16 v[44:47], a[0:3], a[44:47], v[44:47]
ds_read_b64_tr_b16 a[72:73], v12 offset:57344
v_mfma_f32_16x16x32_bf16 v[68:71], a[4:7], a[44:47], v[68:71]
ds_read_b64_tr_b16 a[74:75], v12 offset:57856
v_mfma_f32_16x16x32_bf16 v[92:95], a[8:11], a[44:47], v[92:95]
ds_read_b64_tr_b16 a[76:77], v13 offset:57344
v_mfma_f32_16x16x32_bf16 v[116:119], a[12:15], a[44:47], v[116:119]
ds_read_b64_tr_b16 a[78:79], v13 offset:57856
v_mfma_f32_16x16x32_bf16 v[48:51], a[0:3], a[48:51], v[48:51]
v_mfma_f32_16x16x32_bf16 v[72:75], a[4:7], a[48:51], v[72:75]
v_mfma_f32_16x16x32_bf16 v[96:99], a[8:11], a[48:51], v[96:99]
v_mfma_f32_16x16x32_bf16 v[120:123], a[12:15], a[48:51], v[120:123]
v_mfma_f32_16x16x32_bf16 v[52:55], a[0:3], a[52:55], v[52:55]
v_mfma_f32_16x16x32_bf16 v[76:79], a[4:7], a[52:55], v[76:79]
v_mfma_f32_16x16x32_bf16 v[100:103], a[8:11], a[52:55], v[100:103]
v_mfma_f32_16x16x32_bf16 v[124:127], a[12:15], a[52:55], v[124:127]
s_waitcnt lgkmcnt(0)
v_mfma_f32_16x16x32_bf16 v[32:35], a[56:59], a[16:19], v[32:35]
s_barrier
ds_read_b128 a[0:3], v10 offset:40960
v_mfma_f32_16x16x32_bf16 v[56:59], a[56:59], a[20:23], v[56:59]
ds_read_b64_tr_b16 a[32:33], v12 offset:0
v_mfma_f32_16x16x32_bf16 v[80:83], a[56:59], a[24:27], v[80:83]
ds_read_b64_tr_b16 a[34:35], v12 offset:512
v_mfma_f32_16x16x32_bf16 v[104:107], a[56:59], a[28:31], v[104:107]
ds_read_b128 a[4:7], v10 offset:43008
v_mfma_f32_16x16x32_bf16 v[36:39], a[60:63], a[16:19], v[36:39]
ds_read_b128 a[8:11], v10 offset:45056
v_mfma_f32_16x16x32_bf16 v[60:63], a[60:63], a[20:23], v[60:63]
ds_read_b128 a[12:15], v10 offset:47104
v_mfma_f32_16x16x32_bf16 v[84:87], a[60:63], a[24:27], v[84:87]
ds_read_b64_tr_b16 a[36:37], v13 offset:0
v_mfma_f32_16x16x32_bf16 v[108:111], a[60:63], a[28:31], v[108:111]
ds_read_b64_tr_b16 a[38:39], v13 offset:512
v_mfma_f32_16x16x32_bf16 v[40:43], a[16:19], a[64:67], v[40:43]
ds_read_b64_tr_b16 a[40:41], v12 offset:2048
v_mfma_f32_16x16x32_bf16 v[64:67], a[20:23], a[64:67], v[64:67]
ds_read_b64_tr_b16 a[42:43], v12 offset:2560
v_mfma_f32_16x16x32_bf16 v[88:91], a[24:27], a[64:67], v[88:91]
ds_read_b64_tr_b16 a[44:45], v13 offset:2048
v_mfma_f32_16x16x32_bf16 v[112:115], a[28:31], a[64:67], v[112:115]
ds_read_b64_tr_b16 a[46:47], v13 offset:2560
v_mfma_f32_16x16x32_bf16 v[44:47], a[16:19], a[68:71], v[44:47]
ds_read_b64_tr_b16 a[48:49], v12 offset:4096
v_mfma_f32_16x16x32_bf16 v[68:71], a[20:23], a[68:71], v[68:71]
ds_read_b64_tr_b16 a[50:51], v12 offset:4608
v_mfma_f32_16x16x32_bf16 v[92:95], a[24:27], a[68:71], v[92:95]
ds_read_b64_tr_b16 a[52:53], v13 offset:4096
v_mfma_f32_16x16x32_bf16 v[116:119], a[28:31], a[68:71], v[116:119]
ds_read_b64_tr_b16 a[54:55], v13 offset:4608
v_mfma_f32_16x16x32_bf16 v[48:51], a[16:19], a[72:75], v[48:51]
v_mfma_f32_16x16x32_bf16 v[72:75], a[20:23], a[72:75], v[72:75]
v_mfma_f32_16x16x32_bf16 v[96:99], a[24:27], a[72:75], v[96:99]
v_mfma_f32_16x16x32_bf16 v[120:123], a[28:31], a[72:75], v[120:123]
v_mfma_f32_16x16x32_bf16 v[52:55], a[16:19], a[76:79], v[52:55]
v_mfma_f32_16x16x32_bf16 v[76:79], a[20:23], a[76:79], v[76:79]
v_mfma_f32_16x16x32_bf16 v[100:103], a[24:27], a[76:79], v[100:103]
v_mfma_f32_16x16x32_bf16 v[124:127], a[28:31], a[76:79], v[124:127]
s_waitcnt lgkmcnt(0)
v_mfma_f32_16x16x32_bf16 v[32:35], a[32:35], a[0:3], v[32:35]
ds_read_b128 a[16:19], v11 offset:40960
v_mfma_f32_16x16x32_bf16 v[56:59], a[32:35], a[4:7], v[56:59]
ds_read_b64_tr_b16 a[56:57], v12 offset:12288
v_mfma_f32_16x16x32_bf16 v[80:83], a[32:35], a[8:11], v[80:83]
ds_read_b64_tr_b16 a[58:59], v12 offset:12800
v_mfma_f32_16x16x32_bf16 v[104:107], a[32:35], a[12:15], v[104:107]
ds_read_b128 a[20:23], v11 offset:43008
v_mfma_f32_16x16x32_bf16 v[36:39], a[36:39], a[0:3], v[36:39]
ds_read_b128 a[24:27], v11 offset:45056
v_mfma_f32_16x16x32_bf16 v[60:63], a[36:39], a[4:7], v[60:63]
ds_read_b128 a[28:31], v11 offset:47104
v_mfma_f32_16x16x32_bf16 v[84:87], a[36:39], a[8:11], v[84:87]
ds_read_b64_tr_b16 a[60:61], v13 offset:12288
v_mfma_f32_16x16x32_bf16 v[108:111], a[36:39], a[12:15], v[108:111]
ds_read_b64_tr_b16 a[62:63], v13 offset:12800
v_mfma_f32_16x16x32_bf16 v[40:43], a[0:3], a[40:43], v[40:43]
ds_read_b64_tr_b16 a[64:65], v12 offset:14336
v_mfma_f32_16x16x32_bf16 v[64:67], a[4:7], a[40:43], v[64:67]
ds_read_b64_tr_b16 a[66:67], v12 offset:14848
v_mfma_f32_16x16x32_bf16 v[88:91], a[8:11], a[40:43], v[88:91]
ds_read_b64_tr_b16 a[68:69], v13 offset:14336
v_mfma_f32_16x16x32_bf16 v[112:115], a[12:15], a[40:43], v[112:115]
ds_read_b64_tr_b16 a[70:71], v13 offset:14848
v_mfma_f32_16x16x32_bf16 v[44:47], a[0:3], a[44:47], v[44:47]
ds_read_b64_tr_b16 a[72:73], v12 offset:16384
v_mfma_f32_16x16x32_bf16 v[68:71], a[4:7], a[44:47], v[68:71]
ds_read_b64_tr_b16 a[74:75], v12 offset:16896
v_mfma_f32_16x16x32_bf16 v[92:95], a[8:11], a[44:47], v[92:95]
ds_read_b64_tr_b16 a[76:77], v13 offset:16384
v_mfma_f32_16x16x32_bf16 v[116:119], a[12:15], a[44:47], v[116:119]
ds_read_b64_tr_b16 a[78:79], v13 offset:16896
v_mfma_f32_16x16x32_bf16 v[48:51], a[0:3], a[48:51], v[48:51]
v_mfma_f32_16x16x32_bf16 v[72:75], a[4:7], a[48:51], v[72:75]
v_mfma_f32_16x16x32_bf16 v[96:99], a[8:11], a[48:51], v[96:99]
v_mfma_f32_16x16x32_bf16 v[120:123], a[12:15], a[48:51], v[120:123]
v_mfma_f32_16x16x32_bf16 v[52:55], a[0:3], a[52:55], v[52:55]
v_mfma_f32_16x16x32_bf16 v[76:79], a[4:7], a[52:55], v[76:79]
v_mfma_f32_16x16x32_bf16 v[100:103], a[8:11], a[52:55], v[100:103]
v_mfma_f32_16x16x32_bf16 v[124:127], a[12:15], a[52:55], v[124:127]
s_waitcnt lgkmcnt(0)
v_mfma_f32_16x16x32_bf16 v[32:35], a[56:59], a[16:19], v[32:35]
s_barrier
ds_read_b128 a[0:3], v10 offset:0
v_mfma_f32_16x16x32_bf16 v[56:59], a[56:59], a[20:23], v[56:59]
ds_read_b64_tr_b16 a[32:33], v14 offset:16384
v_mfma_f32_16x16x32_bf16 v[80:83], a[56:59], a[24:27], v[80:83]
ds_read_b64_tr_b16 a[34:35], v14 offset:16896
v_mfma_f32_16x16x32_bf16 v[104:107], a[56:59], a[28:31], v[104:107]
ds_read_b128 a[4:7], v10 offset:2048
v_mfma_f32_16x16x32_bf16 v[36:39], a[60:63], a[16:19], v[36:39]
ds_read_b128 a[8:11], v10 offset:4096
v_mfma_f32_16x16x32_bf16 v[60:63], a[60:63], a[20:23], v[60:63]
ds_read_b128 a[12:15], v10 offset:6144
v_mfma_f32_16x16x32_bf16 v[84:87], a[60:63], a[24:27], v[84:87]
ds_read_b64_tr_b16 a[36:37], v15 offset:16384
v_mfma_f32_16x16x32_bf16 v[108:111], a[60:63], a[28:31], v[108:111]
ds_read_b64_tr_b16 a[38:39], v15 offset:16896
v_mfma_f32_16x16x32_bf16 v[40:43], a[16:19], a[64:67], v[40:43]
ds_read_b64_tr_b16 a[40:41], v14 offset:18432
v_mfma_f32_16x16x32_bf16 v[64:67], a[20:23], a[64:67], v[64:67]
ds_read_b64_tr_b16 a[42:43], v14 offset:18944
v_mfma_f32_16x16x32_bf16 v[88:91], a[24:27], a[64:67], v[88:91]
ds_read_b64_tr_b16 a[44:45], v15 offset:18432
v_mfma_f32_16x16x32_bf16 v[112:115], a[28:31], a[64:67], v[112:115]
ds_read_b64_tr_b16 a[46:47], v15 offset:18944
v_mfma_f32_16x16x32_bf16 v[44:47], a[16:19], a[68:71], v[44:47]
ds_read_b64_tr_b16 a[48:49], v14 offset:20480
v_mfma_f32_16x16x32_bf16 v[68:71], a[20:23], a[68:71], v[68:71]
ds_read_b64_tr_b16 a[50:51], v14 offset:20992
v_mfma_f32_16x16x32_bf16 v[92:95], a[24:27], a[68:71], v[92:95]
ds_read_b64_tr_b16 a[52:53], v15 offset:20480
v_mfma_f32_16x16x32_bf16 v[116:119], a[28:31], a[68:71], v[116:119]
ds_read_b64_tr_b16 a[54:55], v15 offset:20992
v_mfma_f32_16x16x32_bf16 v[48:51], a[16:19], a[72:75], v[48:51]
v_mfma_f32_16x16x32_bf16 v[72:75], a[20:23], a[72:75], v[72:75]
v_mfma_f32_16x16x32_bf16 v[96:99], a[24:27], a[72:75], v[96:99]
v_mfma_f32_16x16x32_bf16 v[120:123], a[28:31], a[72:75], v[120:123]
v_mfma_f32_16x16x32_bf16 v[52:55], a[16:19], a[76:79], v[52:55]
v_mfma_f32_16x16x32_bf16 v[76:79], a[20:23], a[76:79], v[76:79]
v_mfma_f32_16x16x32_bf16 v[100:103], a[24:27], a[76:79], v[100:103]
v_mfma_f32_16x16x32_bf16 v[124:127], a[28:31], a[76:79], v[124:127]
s_waitcnt lgkmcnt(0)
v_mfma_f32_16x16x32_bf16 v[32:35], a[32:35], a[0:3], v[32:35]
ds_read_b128 a[16:19], v11 offset:0
v_mfma_f32_16x16x32_bf16 v[56:59], a[32:35], a[4:7], v[56:59]
ds_read_b64_tr_b16 a[56:57], v14 offset:28672
v_mfma_f32_16x16x32_bf16 v[80:83], a[32:35], a[8:11], v[80:83]
ds_read_b64_tr_b16 a[58:59], v14 offset:29184
v_mfma_f32_16x16x32_bf16 v[104:107], a[32:35], a[12:15], v[104:107]
ds_read_b128 a[20:23], v11 offset:2048
v_mfma_f32_16x16x32_bf16 v[36:39], a[36:39], a[0:3], v[36:39]
ds_read_b128 a[24:27], v11 offset:4096
v_mfma_f32_16x16x32_bf16 v[60:63], a[36:39], a[4:7], v[60:63]
ds_read_b128 a[28:31], v11 offset:6144
v_mfma_f32_16x16x32_bf16 v[84:87], a[36:39], a[8:11], v[84:87]
ds_read_b64_tr_b16 a[60:61], v15 offset:28672
v_mfma_f32_16x16x32_bf16 v[108:111], a[36:39], a[12:15], v[108:111]
ds_read_b64_tr_b16 a[62:63], v15 offset:29184
v_mfma_f32_16x16x32_bf16 v[40:43], a[0:3], a[40:43], v[40:43]
ds_read_b64_tr_b16 a[64:65], v14 offset:30720
v_mfma_f32_16x16x32_bf16 v[64:67], a[4:7], a[40:43], v[64:67]
ds_read_b64_tr_b16 a[66:67], v14 offset:31232
v_mfma_f32_16x16x32_bf16 v[88:91], a[8:11], a[40:43], v[88:91]
ds_read_b64_tr_b16 a[68:69], v15 offset:30720
v_mfma_f32_16x16x32_bf16 v[112:115], a[12:15], a[40:43], v[112:115]
ds_read_b64_tr_b16 a[70:71], v15 offset:31232
v_mfma_f32_16x16x32_bf16 v[44:47], a[0:3], a[44:47], v[44:47]
ds_read_b64_tr_b16 a[72:73], v14 offset:32768
v_mfma_f32_16x16x32_bf16 v[68:71], a[4:7], a[44:47], v[68:71]
ds_read_b64_tr_b16 a[74:75], v14 offset:33280
v_mfma_f32_16x16x32_bf16 v[92:95], a[8:11], a[44:47], v[92:95]
ds_read_b64_tr_b16 a[76:77], v15 offset:32768
v_mfma_f32_16x16x32_bf16 v[116:119], a[12:15], a[44:47], v[116:119]
ds_read_b64_tr_b16 a[78:79], v15 offset:33280
v_mfma_f32_16x16x32_bf16 v[48:51], a[0:3], a[48:51], v[48:51]
v_mfma_f32_16x16x32_bf16 v[72:75], a[4:7], a[48:51], v[72:75]
v_mfma_f32_16x16x32_bf16 v[96:99], a[8:11], a[48:51], v[96:99]
v_mfma_f32_16x16x32_bf16 v[120:123], a[12:15], a[48:51], v[120:123]
v_mfma_f32_16x16x32_bf16 v[52:55], a[0:3], a[52:55], v[52:55]
v_mfma_f32_16x16x32_bf16 v[76:79], a[4:7], a[52:55], v[76:79]
v_mfma_f32_16x16x32_bf16 v[100:103], a[8:11], a[52:55], v[100:103]
v_mfma_f32_16x16x32_bf16 v[124:127], a[12:15], a[52:55], v[124:127]
s_waitcnt lgkmcnt(0)
v_mfma_f32_16x16x32_bf16 v[32:35], a[56:59], a[16:19], v[32:35]
s_barrier
ds_read_b128 a[0:3], v8 offset:24576
v_mfma_f32_16x16x32_bf16 v[56:59], a[56:59], a[20:23], v[56:59]
ds_read_b64_tr_b16 a[32:33], v12 offset:40960
v_mfma_f32_16x16x32_bf16 v[80:83], a[56:59], a[24:27], v[80:83]
ds_read_b64_tr_b16 a[34:35], v12 offset:41472
v_mfma_f32_16x16x32_bf16 v[104:107], a[56:59], a[28:31], v[104:107]
ds_read_b128 a[4:7], v8 offset:26624
v_mfma_f32_16x16x32_bf16 v[36:39], a[60:63], a[16:19], v[36:39]
ds_read_b128 a[8:11], v8 offset:28672
v_mfma_f32_16x16x32_bf16 v[60:63], a[60:63], a[20:23], v[60:63]
ds_read_b128 a[12:15], v8 offset:30720
v_mfma_f32_16x16x32_bf16 v[84:87], a[60:63], a[24:27], v[84:87]
ds_read_b64_tr_b16 a[36:37], v13 offset:40960
v_mfma_f32_16x16x32_bf16 v[108:111], a[60:63], a[28:31], v[108:111]
ds_read_b64_tr_b16 a[38:39], v13 offset:41472
v_mfma_f32_16x16x32_bf16 v[40:43], a[16:19], a[64:67], v[40:43]
ds_read_b64_tr_b16 a[40:41], v12 offset:43008
v_mfma_f32_16x16x32_bf16 v[64:67], a[20:23], a[64:67], v[64:67]
ds_read_b64_tr_b16 a[42:43], v12 offset:43520
v_mfma_f32_16x16x32_bf16 v[88:91], a[24:27], a[64:67], v[88:91]
ds_read_b64_tr_b16 a[44:45], v13 offset:43008
v_mfma_f32_16x16x32_bf16 v[112:115], a[28:31], a[64:67], v[112:115]
ds_read_b64_tr_b16 a[46:47], v13 offset:43520
v_mfma_f32_16x16x32_bf16 v[44:47], a[16:19], a[68:71], v[44:47]
ds_read_b64_tr_b16 a[48:49], v12 offset:45056
v_mfma_f32_16x16x32_bf16 v[68:71], a[20:23], a[68:71], v[68:71]
ds_read_b64_tr_b16 a[50:51], v12 offset:45568
v_mfma_f32_16x16x32_bf16 v[92:95], a[24:27], a[68:71], v[92:95]
ds_read_b64_tr_b16 a[52:53], v13 offset:45056
v_mfma_f32_16x16x32_bf16 v[116:119], a[28:31], a[68:71], v[116:119]
ds_read_b64_tr_b16 a[54:55], v13 offset:45568
v_mfma_f32_16x16x32_bf16 v[48:51], a[16:19], a[72:75], v[48:51]
v_mfma_f32_16x16x32_bf16 v[72:75], a[20:23], a[72:75], v[72:75]
v_mfma_f32_16x16x32_bf16 v[96:99], a[24:27], a[72:75], v[96:99]
v_mfma_f32_16x16x32_bf16 v[120:123], a[28:31], a[72:75], v[120:123]
v_mfma_f32_16x16x32_bf16 v[52:55], a[16:19], a[76:79], v[52:55]
v_mfma_f32_16x16x32_bf16 v[76:79], a[20:23], a[76:79], v[76:79]
v_mfma_f32_16x16x32_bf16 v[100:103], a[24:27], a[76:79], v[100:103]
v_mfma_f32_16x16x32_bf16 v[124:127], a[28:31], a[76:79], v[124:127]
s_waitcnt lgkmcnt(0)
v_mfma_f32_16x16x32_bf16 v[32:35], a[32:35], a[0:3], v[32:35]
ds_read_b128 a[16:19], v9 offset:24576
v_mfma_f32_16x16x32_bf16 v[56:59], a[32:35], a[4:7], v[56:59]
ds_read_b64_tr_b16 a[56:57], v12 offset:53248
v_mfma_f32_16x16x32_bf16 v[80:83], a[32:35], a[8:11], v[80:83]
ds_read_b64_tr_b16 a[58:59], v12 offset:53760
v_mfma_f32_16x16x32_bf16 v[104:107], a[32:35], a[12:15], v[104:107]
ds_read_b128 a[20:23], v9 offset:26624
v_mfma_f32_16x16x32_bf16 v[36:39], a[36:39], a[0:3], v[36:39]
ds_read_b128 a[24:27], v9 offset:28672
v_mfma_f32_16x16x32_bf16 v[60:63], a[36:39], a[4:7], v[60:63]
ds_read_b128 a[28:31], v9 offset:30720
v_mfma_f32_16x16x32_bf16 v[84:87], a[36:39], a[8:11], v[84:87]
ds_read_b64_tr_b16 a[60:61], v13 offset:53248
v_mfma_f32_16x16x32_bf16 v[108:111], a[36:39], a[12:15], v[108:111]
ds_read_b64_tr_b16 a[62:63], v13 offset:53760
v_mfma_f32_16x16x32_bf16 v[40:43], a[0:3], a[40:43], v[40:43]
ds_read_b64_tr_b16 a[64:65], v12 offset:55296
v_mfma_f32_16x16x32_bf16 v[64:67], a[4:7], a[40:43], v[64:67]
ds_read_b64_tr_b16 a[66:67], v12 offset:55808
v_mfma_f32_16x16x32_bf16 v[88:91], a[8:11], a[40:43], v[88:91]
ds_read_b64_tr_b16 a[68:69], v13 offset:55296
v_mfma_f32_16x16x32_bf16 v[112:115], a[12:15], a[40:43], v[112:115]
ds_read_b64_tr_b16 a[70:71], v13 offset:55808
v_mfma_f32_16x16x32_bf16 v[44:47], a[0:3], a[44:47], v[44:47]
ds_read_b64_tr_b16 a[72:73], v12 offset:57344
v_mfma_f32_16x16x32_bf16 v[68:71], a[4:7], a[44:47], v[68:71]
ds_read_b64_tr_b16 a[74:75], v12 offset:57856
v_mfma_f32_16x16x32_bf16 v[92:95], a[8:11], a[44:47], v[92:95]
ds_read_b64_tr_b16 a[76:77], v13 offset:57344
v_mfma_f32_16x16x32_bf16 v[116:119], a[12:15], a[44:47], v[116:119]
ds_read_b64_tr_b16 a[78:79], v13 offset:57856
v_mfma_f32_16x16x32_bf16 v[48:51], a[0:3], a[48:51], v[48:51]
v_mfma_f32_16x16x32_bf16 v[72:75], a[4:7], a[48:51], v[72:75]
v_mfma_f32_16x16x32_bf16 v[96:99], a[8:11], a[48:51], v[96:99]
v_mfma_f32_16x16x32_bf16 v[120:123], a[12:15], a[48:51], v[120:123]
v_mfma_f32_16x16x32_bf16 v[52:55], a[0:3], a[52:55], v[52:55]
v_mfma_f32_16x16x32_bf16 v[76:79], a[4:7], a[52:55], v[76:79]
v_mfma_f32_16x16x32_bf16 v[100:103], a[8:11], a[52:55], v[100:103]
v_mfma_f32_16x16x32_bf16 v[124:127], a[12:15], a[52:55], v[124:127]
s_waitcnt lgkmcnt(0)
v_mfma_f32_16x16x32_bf16 v[32:35], a[56:59], a[16:19], v[32:35]
s_barrier
ds_read_b128 a[0:3], v10 offset:57344
v_mfma_f32_16x16x32_bf16 v[56:59], a[56:59], a[20:23], v[56:59]
ds_read_b64_tr_b16 a[32:33], v12 offset:0
v_mfma_f32_16x16x32_bf16 v[80:83], a[56:59], a[24:27], v[80:83]
ds_read_b64_tr_b16 a[34:35], v12 offset:512
v_mfma_f32_16x16x32_bf16 v[104:107], a[56:59], a[28:31], v[104:107]
ds_read_b128 a[4:7], v10 offset:59392
v_mfma_f32_16x16x32_bf16 v[36:39], a[60:63], a[16:19], v[36:39]
ds_read_b128 a[8:11], v10 offset:61440
v_mfma_f32_16x16x32_bf16 v[60:63], a[60:63], a[20:23], v[60:63]
ds_read_b128 a[12:15], v10 offset:63488
v_mfma_f32_16x16x32_bf16 v[84:87], a[60:63], a[24:27], v[84:87]
ds_read_b64_tr_b16 a[36:37], v13 offset:0
v_mfma_f32_16x16x32_bf16 v[108:111], a[60:63], a[28:31], v[108:111]
ds_read_b64_tr_b16 a[38:39], v13 offset:512
v_mfma_f32_16x16x32_bf16 v[40:43], a[16:19], a[64:67], v[40:43]
ds_read_b64_tr_b16 a[40:41], v12 offset:2048
v_mfma_f32_16x16x32_bf16 v[64:67], a[20:23], a[64:67], v[64:67]
ds_read_b64_tr_b16 a[42:43], v12 offset:2560
v_mfma_f32_16x16x32_bf16 v[88:91], a[24:27], a[64:67], v[88:91]
ds_read_b64_tr_b16 a[44:45], v13 offset:2048
v_mfma_f32_16x16x32_bf16 v[112:115], a[28:31], a[64:67], v[112:115]
ds_read_b64_tr_b16 a[46:47], v13 offset:2560
v_mfma_f32_16x16x32_bf16 v[44:47], a[16:19], a[68:71], v[44:47]
ds_read_b64_tr_b16 a[48:49], v12 offset:4096
v_mfma_f32_16x16x32_bf16 v[68:71], a[20:23], a[68:71], v[68:71]
ds_read_b64_tr_b16 a[50:51], v12 offset:4608
v_mfma_f32_16x16x32_bf16 v[92:95], a[24:27], a[68:71], v[92:95]
ds_read_b64_tr_b16 a[52:53], v13 offset:4096
v_mfma_f32_16x16x32_bf16 v[116:119], a[28:31], a[68:71], v[116:119]
ds_read_b64_tr_b16 a[54:55], v13 offset:4608
v_mfma_f32_16x16x32_bf16 v[48:51], a[16:19], a[72:75], v[48:51]
v_mfma_f32_16x16x32_bf16 v[72:75], a[20:23], a[72:75], v[72:75]
v_mfma_f32_16x16x32_bf16 v[96:99], a[24:27], a[72:75], v[96:99]
v_mfma_f32_16x16x32_bf16 v[120:123], a[28:31], a[72:75], v[120:123]
v_mfma_f32_16x16x32_bf16 v[52:55], a[16:19], a[76:79], v[52:55]
v_mfma_f32_16x16x32_bf16 v[76:79], a[20:23], a[76:79], v[76:79]
v_mfma_f32_16x16x32_bf16 v[100:103], a[24:27], a[76:79], v[100:103]
v_mfma_f32_16x16x32_bf16 v[124:127], a[28:31], a[76:79], v[124:127]
s_waitcnt lgkmcnt(0)
v_mfma_f32_16x16x32_bf16 v[32:35], a[32:35], a[0:3], v[32:35]
ds_read_b128 a[16:19], v11 offset:57344
v_mfma_f32_16x16x32_bf16 v[56:59], a[32:35], a[4:7], v[56:59]
ds_read_b64_tr_b16 a[56:57], v12 offset:12288
v_mfma_f32_16x16x32_bf16 v[80:83], a[32:35], a[8:11], v[80:83]
ds_read_b64_tr_b16 a[58:59], v12 offset:12800
v_mfma_f32_16x16x32_bf16 v[104:107], a[32:35], a[12:15], v[104:107]
ds_read_b128 a[20:23], v11 offset:59392
v_mfma_f32_16x16x32_bf16 v[36:39], a[36:39], a[0:3], v[36:39]
ds_read_b128 a[24:27], v11 offset:61440
v_mfma_f32_16x16x32_bf16 v[60:63], a[36:39], a[4:7], v[60:63]
ds_read_b128 a[28:31], v11 offset:63488
v_mfma_f32_16x16x32_bf16 v[84:87], a[36:39], a[8:11], v[84:87]
ds_read_b64_tr_b16 a[60:61], v13 offset:12288
v_mfma_f32_16x16x32_bf16 v[108:111], a[36:39], a[12:15], v[108:111]
ds_read_b64_tr_b16 a[62:63], v13 offset:12800
v_mfma_f32_16x16x32_bf16 v[40:43], a[0:3], a[40:43], v[40:43]
ds_read_b64_tr_b16 a[64:65], v12 offset:14336
v_mfma_f32_16x16x32_bf16 v[64:67], a[4:7], a[40:43], v[64:67]
ds_read_b64_tr_b16 a[66:67], v12 offset:14848
v_mfma_f32_16x16x32_bf16 v[88:91], a[8:11], a[40:43], v[88:91]
ds_read_b64_tr_b16 a[68:69], v13 offset:14336
v_mfma_f32_16x16x32_bf16 v[112:115], a[12:15], a[40:43], v[112:115]
ds_read_b64_tr_b16 a[70:71], v13 offset:14848
v_mfma_f32_16x16x32_bf16 v[44:47], a[0:3], a[44:47], v[44:47]
ds_read_b64_tr_b16 a[72:73], v12 offset:16384
v_mfma_f32_16x16x32_bf16 v[68:71], a[4:7], a[44:47], v[68:71]
ds_read_b64_tr_b16 a[74:75], v12 offset:16896
v_mfma_f32_16x16x32_bf16 v[92:95], a[8:11], a[44:47], v[92:95]
ds_read_b64_tr_b16 a[76:77], v13 offset:16384
v_mfma_f32_16x16x32_bf16 v[116:119], a[12:15], a[44:47], v[116:119]
ds_read_b64_tr_b16 a[78:79], v13 offset:16896
v_mfma_f32_16x16x32_bf16 v[48:51], a[0:3], a[48:51], v[48:51]
v_mfma_f32_16x16x32_bf16 v[72:75], a[4:7], a[48:51], v[72:75]
v_mfma_f32_16x16x32_bf16 v[96:99], a[8:11], a[48:51], v[96:99]
v_mfma_f32_16x16x32_bf16 v[120:123], a[12:15], a[48:51], v[120:123]
v_mfma_f32_16x16x32_bf16 v[52:55], a[0:3], a[52:55], v[52:55]
v_mfma_f32_16x16x32_bf16 v[76:79], a[4:7], a[52:55], v[76:79]
v_mfma_f32_16x16x32_bf16 v[100:103], a[8:11], a[52:55], v[100:103]
v_mfma_f32_16x16x32_bf16 v[124:127], a[12:15], a[52:55], v[124:127]
s_waitcnt lgkmcnt(0)
v_mfma_f32_16x16x32_bf16 v[32:35], a[56:59], a[16:19], v[32:35]
s_barrier
ds_read_b128 a[0:3], v10 offset:40960
v_mfma_f32_16x16x32_bf16 v[56:59], a[56:59], a[20:23], v[56:59]
ds_read_b64_tr_b16 a[32:33], v14 offset:16384
v_mfma_f32_16x16x32_bf16 v[80:83], a[56:59], a[24:27], v[80:83]
ds_read_b64_tr_b16 a[34:35], v14 offset:16896
v_mfma_f32_16x16x32_bf16 v[104:107], a[56:59], a[28:31], v[104:107]
ds_read_b128 a[4:7], v10 offset:43008
v_mfma_f32_16x16x32_bf16 v[36:39], a[60:63], a[16:19], v[36:39]
ds_read_b128 a[8:11], v10 offset:45056
v_mfma_f32_16x16x32_bf16 v[60:63], a[60:63], a[20:23], v[60:63]
ds_read_b128 a[12:15], v10 offset:47104
v_mfma_f32_16x16x32_bf16 v[84:87], a[60:63], a[24:27], v[84:87]
ds_read_b64_tr_b16 a[36:37], v15 offset:16384
v_mfma_f32_16x16x32_bf16 v[108:111], a[60:63], a[28:31], v[108:111]
ds_read_b64_tr_b16 a[38:39], v15 offset:16896
v_mfma_f32_16x16x32_bf16 v[40:43], a[16:19], a[64:67], v[40:43]
ds_read_b64_tr_b16 a[40:41], v14 offset:18432
v_mfma_f32_16x16x32_bf16 v[64:67], a[20:23], a[64:67], v[64:67]
ds_read_b64_tr_b16 a[42:43], v14 offset:18944
v_mfma_f32_16x16x32_bf16 v[88:91], a[24:27], a[64:67], v[88:91]
ds_read_b64_tr_b16 a[44:45], v15 offset:18432
v_mfma_f32_16x16x32_bf16 v[112:115], a[28:31], a[64:67], v[112:115]
ds_read_b64_tr_b16 a[46:47], v15 offset:18944
v_mfma_f32_16x16x32_bf16 v[44:47], a[16:19], a[68:71], v[44:47]
ds_read_b64_tr_b16 a[48:49], v14 offset:20480
v_mfma_f32_16x16x32_bf16 v[68:71], a[20:23], a[68:71], v[68:71]
ds_read_b64_tr_b16 a[50:51], v14 offset:20992
v_mfma_f32_16x16x32_bf16 v[92:95], a[24:27], a[68:71], v[92:95]
ds_read_b64_tr_b16 a[52:53], v15 offset:20480
v_mfma_f32_16x16x32_bf16 v[116:119], a[28:31], a[68:71], v[116:119]
ds_read_b64_tr_b16 a[54:55], v15 offset:20992
v_mfma_f32_16x16x32_bf16 v[48:51], a[16:19], a[72:75], v[48:51]
v_mfma_f32_16x16x32_bf16 v[72:75], a[20:23], a[72:75], v[72:75]
v_mfma_f32_16x16x32_bf16 v[96:99], a[24:27], a[72:75], v[96:99]
v_mfma_f32_16x16x32_bf16 v[120:123], a[28:31], a[72:75], v[120:123]
v_mfma_f32_16x16x32_bf16 v[52:55], a[16:19], a[76:79], v[52:55]
v_mfma_f32_16x16x32_bf16 v[76:79], a[20:23], a[76:79], v[76:79]
v_mfma_f32_16x16x32_bf16 v[100:103], a[24:27], a[76:79], v[100:103]
v_mfma_f32_16x16x32_bf16 v[124:127], a[28:31], a[76:79], v[124:127]
s_waitcnt lgkmcnt(0)
v_mfma_f32_16x16x32_bf16 v[32:35], a[32:35], a[0:3], v[32:35]
ds_read_b128 a[16:19], v11 offset:40960
v_mfma_f32_16x16x32_bf16 v[56:59], a[32:35], a[4:7], v[56:59]
ds_read_b64_tr_b16 a[56:57], v14 offset:28672
v_mfma_f32_16x16x32_bf16 v[80:83], a[32:35], a[8:11], v[80:83]
ds_read_b64_tr_b16 a[58:59], v14 offset:29184
v_mfma_f32_16x16x32_bf16 v[104:107], a[32:35], a[12:15], v[104:107]
ds_read_b128 a[20:23], v11 offset:43008
v_mfma_f32_16x16x32_bf16 v[36:39], a[36:39], a[0:3], v[36:39]
ds_read_b128 a[24:27], v11 offset:45056
v_mfma_f32_16x16x32_bf16 v[60:63], a[36:39], a[4:7], v[60:63]
ds_read_b128 a[28:31], v11 offset:47104
v_mfma_f32_16x16x32_bf16 v[84:87], a[36:39], a[8:11], v[84:87]
ds_read_b64_tr_b16 a[60:61], v15 offset:28672
v_mfma_f32_16x16x32_bf16 v[108:111], a[36:39], a[12:15], v[108:111]
ds_read_b64_tr_b16 a[62:63], v15 offset:29184
v_mfma_f32_16x16x32_bf16 v[40:43], a[0:3], a[40:43], v[40:43]
ds_read_b64_tr_b16 a[64:65], v14 offset:30720
v_mfma_f32_16x16x32_bf16 v[64:67], a[4:7], a[40:43], v[64:67]
ds_read_b64_tr_b16 a[66:67], v14 offset:31232
v_mfma_f32_16x16x32_bf16 v[88:91], a[8:11], a[40:43], v[88:91]
ds_read_b64_tr_b16 a[68:69], v15 offset:30720
v_mfma_f32_16x16x32_bf16 v[112:115], a[12:15], a[40:43], v[112:115]
ds_read_b64_tr_b16 a[70:71], v15 offset:31232
v_mfma_f32_16x16x32_bf16 v[44:47], a[0:3], a[44:47], v[44:47]
ds_read_b64_tr_b16 a[72:73], v14 offset:32768
v_mfma_f32_16x16x32_bf16 v[68:71], a[4:7], a[44:47], v[68:71]
ds_read_b64_tr_b16 a[74:75], v14 offset:33280
v_mfma_f32_16x16x32_bf16 v[92:95], a[8:11], a[44:47], v[92:95]
ds_read_b64_tr_b16 a[76:77], v15 offset:32768
v_mfma_f32_16x16x32_bf16 v[116:119], a[12:15], a[44:47], v[116:119]
ds_read_b64_tr_b16 a[78:79], v15 offset:33280
v_mfma_f32_16x16x32_bf16 v[48:51], a[0:3], a[48:51], v[48:51]
v_mfma_f32_16x16x32_bf16 v[72:75], a[4:7], a[48:51], v[72:75]
v_mfma_f32_16x16x32_bf16 v[96:99], a[8:11], a[48:51], v[96:99]
v_mfma_f32_16x16x32_bf16 v[120:123], a[12:15], a[48:51], v[120:123]
v_mfma_f32_16x16x32_bf16 v[52:55], a[0:3], a[52:55], v[52:55]
v_mfma_f32_16x16x32_bf16 v[76:79], a[4:7], a[52:55], v[76:79]
v_mfma_f32_16x16x32_bf16 v[100:103], a[8:11], a[52:55], v[100:103]
v_mfma_f32_16x16x32_bf16 v[124:127], a[12:15], a[52:55], v[124:127]
s_waitcnt lgkmcnt(0)
v_mfma_f32_16x16x32_bf16 v[32:35], a[56:59], a[16:19], v[32:35]
s_barrier
ds_read_b128 a[0:3], v10 offset:0
v_mfma_f32_16x16x32_bf16 v[56:59], a[56:59], a[20:23], v[56:59]
ds_read_b64_tr_b16 a[32:33], v12 offset:40960
v_mfma_f32_16x16x32_bf16 v[80:83], a[56:59], a[24:27], v[80:83]
ds_read_b64_tr_b16 a[34:35], v12 offset:41472
v_mfma_f32_16x16x32_bf16 v[104:107], a[56:59], a[28:31], v[104:107]
ds_read_b128 a[4:7], v10 offset:2048
v_mfma_f32_16x16x32_bf16 v[36:39], a[60:63], a[16:19], v[36:39]
ds_read_b128 a[8:11], v10 offset:4096
v_mfma_f32_16x16x32_bf16 v[60:63], a[60:63], a[20:23], v[60:63]
ds_read_b128 a[12:15], v10 offset:6144
v_mfma_f32_16x16x32_bf16 v[84:87], a[60:63], a[24:27], v[84:87]
ds_read_b64_tr_b16 a[36:37], v13 offset:40960
v_mfma_f32_16x16x32_bf16 v[108:111], a[60:63], a[28:31], v[108:111]
ds_read_b64_tr_b16 a[38:39], v13 offset:41472
v_mfma_f32_16x16x32_bf16 v[40:43], a[16:19], a[64:67], v[40:43]
ds_read_b64_tr_b16 a[40:41], v12 offset:43008
v_mfma_f32_16x16x32_bf16 v[64:67], a[20:23], a[64:67], v[64:67]
ds_read_b64_tr_b16 a[42:43], v12 offset:43520
v_mfma_f32_16x16x32_bf16 v[88:91], a[24:27], a[64:67], v[88:91]
ds_read_b64_tr_b16 a[44:45], v13 offset:43008
v_mfma_f32_16x16x32_bf16 v[112:115], a[28:31], a[64:67], v[112:115]
ds_read_b64_tr_b16 a[46:47], v13 offset:43520
v_mfma_f32_16x16x32_bf16 v[44:47], a[16:19], a[68:71], v[44:47]
ds_read_b64_tr_b16 a[48:49], v12 offset:45056
v_mfma_f32_16x16x32_bf16 v[68:71], a[20:23], a[68:71], v[68:71]
ds_read_b64_tr_b16 a[50:51], v12 offset:45568
v_mfma_f32_16x16x32_bf16 v[92:95], a[24:27], a[68:71], v[92:95]
ds_read_b64_tr_b16 a[52:53], v13 offset:45056
v_mfma_f32_16x16x32_bf16 v[116:119], a[28:31], a[68:71], v[116:119]
ds_read_b64_tr_b16 a[54:55], v13 offset:45568
v_mfma_f32_16x16x32_bf16 v[48:51], a[16:19], a[72:75], v[48:51]
v_mfma_f32_16x16x32_bf16 v[72:75], a[20:23], a[72:75], v[72:75]
v_mfma_f32_16x16x32_bf16 v[96:99], a[24:27], a[72:75], v[96:99]
v_mfma_f32_16x16x32_bf16 v[120:123], a[28:31], a[72:75], v[120:123]
v_mfma_f32_16x16x32_bf16 v[52:55], a[16:19], a[76:79], v[52:55]
v_mfma_f32_16x16x32_bf16 v[76:79], a[20:23], a[76:79], v[76:79]
v_mfma_f32_16x16x32_bf16 v[100:103], a[24:27], a[76:79], v[100:103]
v_mfma_f32_16x16x32_bf16 v[124:127], a[28:31], a[76:79], v[124:127]
s_waitcnt lgkmcnt(0)
v_mfma_f32_16x16x32_bf16 v[32:35], a[32:35], a[0:3], v[32:35]
ds_read_b128 a[16:19], v11 offset:0
v_mfma_f32_16x16x32_bf16 v[56:59], a[32:35], a[4:7], v[56:59]
ds_read_b64_tr_b16 a[56:57], v12 offset:53248
v_mfma_f32_16x16x32_bf16 v[80:83], a[32:35], a[8:11], v[80:83]
ds_read_b64_tr_b16 a[58:59], v12 offset:53760
v_mfma_f32_16x16x32_bf16 v[104:107], a[32:35], a[12:15], v[104:107]
ds_read_b128 a[20:23], v11 offset:2048
v_mfma_f32_16x16x32_bf16 v[36:39], a[36:39], a[0:3], v[36:39]
ds_read_b128 a[24:27], v11 offset:4096
v_mfma_f32_16x16x32_bf16 v[60:63], a[36:39], a[4:7], v[60:63]
ds_read_b128 a[28:31], v11 offset:6144
v_mfma_f32_16x16x32_bf16 v[84:87], a[36:39], a[8:11], v[84:87]
ds_read_b64_tr_b16 a[60:61], v13 offset:53248
v_mfma_f32_16x16x32_bf16 v[108:111], a[36:39], a[12:15], v[108:111]
ds_read_b64_tr_b16 a[62:63], v13 offset:53760
v_mfma_f32_16x16x32_bf16 v[40:43], a[0:3], a[40:43], v[40:43]
ds_read_b64_tr_b16 a[64:65], v12 offset:55296
v_mfma_f32_16x16x32_bf16 v[64:67], a[4:7], a[40:43], v[64:67]
ds_read_b64_tr_b16 a[66:67], v12 offset:55808
v_mfma_f32_16x16x32_bf16 v[88:91], a[8:11], a[40:43], v[88:91]
ds_read_b64_tr_b16 a[68:69], v13 offset:55296
v_mfma_f32_16x16x32_bf16 v[112:115], a[12:15], a[40:43], v[112:115]
ds_read_b64_tr_b16 a[70:71], v13 offset:55808
v_mfma_f32_16x16x32_bf16 v[44:47], a[0:3], a[44:47], v[44:47]
ds_read_b64_tr_b16 a[72:73], v12 offset:57344
v_mfma_f32_16x16x32_bf16 v[68:71], a[4:7], a[44:47], v[68:71]
ds_read_b64_tr_b16 a[74:75], v12 offset:57856
v_mfma_f32_16x16x32_bf16 v[92:95], a[8:11], a[44:47], v[92:95]
ds_read_b64_tr_b16 a[76:77], v13 offset:57344
v_mfma_f32_16x16x32_bf16 v[116:119], a[12:15], a[44:47], v[116:119]
ds_read_b64_tr_b16 a[78:79], v13 offset:57856
v_mfma_f32_16x16x32_bf16 v[48:51], a[0:3], a[48:51], v[48:51]
v_lshrrev_b32 v2, 4, v1
v_lshlrev_b32 v2, 4, v2
s_lshl_b32 s70, s66, 8
s_add_u32 s70, s70, 159744
v_add_u32 v17, s70, v2
v_mfma_f32_16x16x32_bf16 v[72:75], a[4:7], a[48:51], v[72:75]
v_mfma_f32_16x16x32_bf16 v[96:99], a[8:11], a[48:51], v[96:99]
v_and_b32 v2, 15, v1
v_lshlrev_b32 v2, 2, v2
s_lshl_b32 s70, s67, 7
s_add_u32 s70, s70, 160768
v_add_u32 v18, s70, v2
v_mfma_f32_16x16x32_bf16 v[120:123], a[12:15], a[48:51], v[120:123]
v_mfma_f32_16x16x32_bf16 v[52:55], a[0:3], a[52:55], v[52:55]
v_mfma_f32_16x16x32_bf16 v[76:79], a[4:7], a[52:55], v[76:79]
v_mfma_f32_16x16x32_bf16 v[100:103], a[8:11], a[52:55], v[100:103]
v_mfma_f32_16x16x32_bf16 v[124:127], a[12:15], a[52:55], v[124:127]
s_waitcnt lgkmcnt(0)
v_mfma_f32_16x16x32_bf16 v[32:35], a[56:59], a[16:19], v[32:35]
s_barrier
ds_read_b128 a[0:3], v8 offset:24576
v_mfma_f32_16x16x32_bf16 v[56:59], a[56:59], a[20:23], v[56:59]
ds_read_b64_tr_b16 a[32:33], v12 offset:0
v_mfma_f32_16x16x32_bf16 v[80:83], a[56:59], a[24:27], v[80:83]
ds_read_b64_tr_b16 a[34:35], v12 offset:512
v_mfma_f32_16x16x32_bf16 v[104:107], a[56:59], a[28:31], v[104:107]
ds_read_b128 a[4:7], v8 offset:26624
v_mfma_f32_16x16x32_bf16 v[36:39], a[60:63], a[16:19], v[36:39]
ds_read_b128 a[8:11], v8 offset:28672
v_mfma_f32_16x16x32_bf16 v[60:63], a[60:63], a[20:23], v[60:63]
ds_read_b128 a[12:15], v8 offset:30720
v_mfma_f32_16x16x32_bf16 v[84:87], a[60:63], a[24:27], v[84:87]
ds_read_b64_tr_b16 a[36:37], v13 offset:0
v_mfma_f32_16x16x32_bf16 v[108:111], a[60:63], a[28:31], v[108:111]
ds_read_b64_tr_b16 a[38:39], v13 offset:512
v_mfma_f32_16x16x32_bf16 v[40:43], a[16:19], a[64:67], v[40:43]
ds_read_b64_tr_b16 a[40:41], v12 offset:2048
v_mfma_f32_16x16x32_bf16 v[64:67], a[20:23], a[64:67], v[64:67]
ds_read_b64_tr_b16 a[42:43], v12 offset:2560
v_mfma_f32_16x16x32_bf16 v[88:91], a[24:27], a[64:67], v[88:91]
ds_read_b64_tr_b16 a[44:45], v13 offset:2048
v_mfma_f32_16x16x32_bf16 v[112:115], a[28:31], a[64:67], v[112:115]
ds_read_b64_tr_b16 a[46:47], v13 offset:2560
v_mfma_f32_16x16x32_bf16 v[44:47], a[16:19], a[68:71], v[44:47]
ds_read_b64_tr_b16 a[48:49], v12 offset:4096
v_mfma_f32_16x16x32_bf16 v[68:71], a[20:23], a[68:71], v[68:71]
ds_read_b64_tr_b16 a[50:51], v12 offset:4608
v_mfma_f32_16x16x32_bf16 v[92:95], a[24:27], a[68:71], v[92:95]
ds_read_b64_tr_b16 a[52:53], v13 offset:4096
v_mfma_f32_16x16x32_bf16 v[116:119], a[28:31], a[68:71], v[116:119]
ds_read_b64_tr_b16 a[54:55], v13 offset:4608
v_mfma_f32_16x16x32_bf16 v[48:51], a[16:19], a[72:75], v[48:51]
v_mfma_f32_16x16x32_bf16 v[72:75], a[20:23], a[72:75], v[72:75]
v_mfma_f32_16x16x32_bf16 v[96:99], a[24:27], a[72:75], v[96:99]
v_mfma_f32_16x16x32_bf16 v[120:123], a[28:31], a[72:75], v[120:123]
v_mfma_f32_16x16x32_bf16 v[52:55], a[16:19], a[76:79], v[52:55]
v_mfma_f32_16x16x32_bf16 v[76:79], a[20:23], a[76:79], v[76:79]
v_mfma_f32_16x16x32_bf16 v[100:103], a[24:27], a[76:79], v[100:103]
v_mfma_f32_16x16x32_bf16 v[124:127], a[28:31], a[76:79], v[124:127]
s_waitcnt lgkmcnt(0)
v_mfma_f32_16x16x32_bf16 v[32:35], a[32:35], a[0:3], v[32:35]
ds_read_b128 a[16:19], v9 offset:24576
v_mfma_f32_16x16x32_bf16 v[56:59], a[32:35], a[4:7], v[56:59]
ds_read_b64_tr_b16 a[56:57], v12 offset:12288
v_mfma_f32_16x16x32_bf16 v[80:83], a[32:35], a[8:11], v[80:83]
ds_read_b64_tr_b16 a[58:59], v12 offset:12800
v_mfma_f32_16x16x32_bf16 v[104:107], a[32:35], a[12:15], v[104:107]
ds_read_b128 a[20:23], v9 offset:26624
v_mfma_f32_16x16x32_bf16 v[36:39], a[36:39], a[0:3], v[36:39]
ds_read_b128 a[24:27], v9 offset:28672
v_mfma_f32_16x16x32_bf16 v[60:63], a[36:39], a[4:7], v[60:63]
ds_read_b128 a[28:31], v9 offset:30720
v_mfma_f32_16x16x32_bf16 v[84:87], a[36:39], a[8:11], v[84:87]
ds_read_b64_tr_b16 a[60:61], v13 offset:12288
v_mfma_f32_16x16x32_bf16 v[108:111], a[36:39], a[12:15], v[108:111]
ds_read_b64_tr_b16 a[62:63], v13 offset:12800
v_mfma_f32_16x16x32_bf16 v[40:43], a[0:3], a[40:43], v[40:43]
ds_read_b64_tr_b16 a[64:65], v12 offset:14336
v_mfma_f32_16x16x32_bf16 v[64:67], a[4:7], a[40:43], v[64:67]
ds_read_b64_tr_b16 a[66:67], v12 offset:14848
v_mfma_f32_16x16x32_bf16 v[88:91], a[8:11], a[40:43], v[88:91]
ds_read_b64_tr_b16 a[68:69], v13 offset:14336
v_mfma_f32_16x16x32_bf16 v[112:115], a[12:15], a[40:43], v[112:115]
ds_read_b64_tr_b16 a[70:71], v13 offset:14848
v_mfma_f32_16x16x32_bf16 v[44:47], a[0:3], a[44:47], v[44:47]
ds_read_b64_tr_b16 a[72:73], v12 offset:16384
v_mfma_f32_16x16x32_bf16 v[68:71], a[4:7], a[44:47], v[68:71]
ds_read_b64_tr_b16 a[74:75], v12 offset:16896
v_mfma_f32_16x16x32_bf16 v[92:95], a[8:11], a[44:47], v[92:95]
ds_read_b64_tr_b16 a[76:77], v13 offset:16384
v_mfma_f32_16x16x32_bf16 v[116:119], a[12:15], a[44:47], v[116:119]
ds_read_b64_tr_b16 a[78:79], v13 offset:16896
v_mfma_f32_16x16x32_bf16 v[48:51], a[0:3], a[48:51], v[48:51]
v_mfma_f32_16x16x32_bf16 v[72:75], a[4:7], a[48:51], v[72:75]
v_mfma_f32_16x16x32_bf16 v[96:99], a[8:11], a[48:51], v[96:99]
v_mfma_f32_16x16x32_bf16 v[120:123], a[12:15], a[48:51], v[120:123]
v_mfma_f32_16x16x32_bf16 v[52:55], a[0:3], a[52:55], v[52:55]
v_mfma_f32_16x16x32_bf16 v[76:79], a[4:7], a[52:55], v[76:79]
v_mfma_f32_16x16x32_bf16 v[100:103], a[8:11], a[52:55], v[100:103]
v_mfma_f32_16x16x32_bf16 v[124:127], a[12:15], a[52:55], v[124:127]
s_waitcnt lgkmcnt(0)
v_mfma_f32_16x16x32_bf16 v[40:43], a[16:19], a[64:67], v[40:43]
s_barrier
ds_read_b128 v[20:23], v17 offset:0
v_mfma_f32_16x16x32_bf16 v[64:67], a[20:23], a[64:67], v[64:67]
ds_read_b128 v[24:27], v17 offset:512
v_mfma_f32_16x16x32_bf16 v[88:91], a[24:27], a[64:67], v[88:91]
ds_read_b32 v6, v18 offset:256
v_mfma_f32_16x16x32_bf16 v[112:115], a[28:31], a[64:67], v[112:115]
ds_read_b32 v8, v18 offset:320
v_mfma_f32_16x16x32_bf16 v[44:47], a[16:19], a[68:71], v[44:47]
ds_read_b32 v10, v18 offset:512
v_mfma_f32_16x16x32_bf16 v[68:71], a[20:23], a[68:71], v[68:71]
ds_read_b32 v18, v18 offset:576
v_mfma_f32_16x16x32_bf16 v[92:95], a[24:27], a[68:71], v[92:95]
v_mov_b32 v19, 161536
ds_read_b32 v19, v19
v_mfma_f32_16x16x32_bf16 v[116:119], a[28:31], a[68:71], v[116:119]
ds_read_b128 v[128:131], v17 offset:64
v_mfma_f32_16x16x32_bf16 v[48:51], a[16:19], a[72:75], v[48:51]
ds_read_b128 v[132:135], v17 offset:576
v_mfma_f32_16x16x32_bf16 v[72:75], a[20:23], a[72:75], v[72:75]
ds_read_b128 v[136:139], v17 offset:128
v_mfma_f32_16x16x32_bf16 v[96:99], a[24:27], a[72:75], v[96:99]
ds_read_b128 v[140:143], v17 offset:640
v_mfma_f32_16x16x32_bf16 v[120:123], a[28:31], a[72:75], v[120:123]
ds_read_b128 v[144:147], v17 offset:192
v_mfma_f32_16x16x32_bf16 v[52:55], a[16:19], a[76:79], v[52:55]
ds_read_b128 v[148:151], v17 offset:704
v_mfma_f32_16x16x32_bf16 v[76:79], a[20:23], a[76:79], v[76:79]
v_mfma_f32_16x16x32_bf16 v[100:103], a[24:27], a[76:79], v[100:103]
v_mfma_f32_16x16x32_bf16 v[124:127], a[28:31], a[76:79], v[124:127]
v_mfma_f32_16x16x32_bf16 v[32:35], a[56:59], a[16:19], v[32:35]
v_mfma_f32_16x16x32_bf16 v[56:59], a[56:59], a[20:23], v[56:59]
v_mfma_f32_16x16x32_bf16 v[80:83], a[56:59], a[24:27], v[80:83]
v_mfma_f32_16x16x32_bf16 v[104:107], a[56:59], a[28:31], v[104:107]
v_mfma_f32_16x16x32_bf16 v[36:39], a[60:63], a[16:19], v[36:39]
v_mfma_f32_16x16x32_bf16 v[60:63], a[60:63], a[20:23], v[60:63]
v_mfma_f32_16x16x32_bf16 v[84:87], a[60:63], a[24:27], v[84:87]
v_mfma_f32_16x16x32_bf16 v[108:111], a[60:63], a[28:31], v[108:111]
s_waitcnt lgkmcnt(0)
v_readfirstlane_b32 s69, v19
v_pk_mul_f32 v[28:29], v[24:25], s[90:91]
v_pk_mul_f32 v[30:31], v[26:27], s[90:91]
v_pk_fma_f32 v[40:41], v[20:21], v[6:7], v[40:41] op_sel:[0,0,0] op_sel_hi:[1,0,1]
v_pk_fma_f32 v[44:45], v[20:21], v[8:9], v[44:45] op_sel:[0,0,0] op_sel_hi:[1,0,1]
v_pk_fma_f32 v[42:43], v[22:23], v[6:7], v[42:43] op_sel:[0,0,0] op_sel_hi:[1,0,1]
v_pk_fma_f32 v[46:47], v[22:23], v[8:9], v[46:47] op_sel:[0,0,0] op_sel_hi:[1,0,1]
v_pk_mul_f32 v[2:3], v[40:41], v[28:29]
v_pk_mul_f32 v[12:13], v[44:45], v[28:29]
v_pk_mul_f32 v[4:5], v[42:43], v[30:31]
v_pk_mul_f32 v[14:15], v[46:47], v[30:31]
v_pk_fma_f32 v[40:41], v[40:41], v[24:25], s[82:83]
v_pk_fma_f32 v[44:45], v[44:45], v[24:25], s[82:83]
v_pk_fma_f32 v[42:43], v[42:43], v[26:27], s[82:83]
v_pk_fma_f32 v[46:47], v[46:47], v[26:27], s[82:83]
v_exp_f32_e64 v2, v2 clamp
v_exp_f32_e64 v12, v12 clamp
v_exp_f32_e64 v3, v3 clamp
v_exp_f32_e64 v13, v13 clamp
v_exp_f32_e64 v4, v4 clamp
v_exp_f32_e64 v14, v14 clamp
v_exp_f32_e64 v5, v5 clamp
v_exp_f32_e64 v15, v15 clamp
v_pk_add_f32 v[2:3], v[2:3], s[80:81]
v_pk_add_f32 v[12:13], v[12:13], s[80:81]
v_pk_add_f32 v[4:5], v[4:5], s[80:81]
v_pk_add_f32 v[14:15], v[14:15], s[80:81]
v_max_f32 v40, v40, v2
v_max_f32 v44, v44, v12
v_max_f32 v41, v41, v3
v_max_f32 v45, v45, v13
v_max_f32 v42, v42, v4
v_max_f32 v46, v46, v14
v_max_f32 v43, v43, v5
v_max_f32 v47, v47, v15
v_cvt_pk_bf16_f32 v40, v40, v41
v_cvt_pk_bf16_f32 v44, v44, v45
v_cvt_pk_bf16_f32 v41, v42, v43
v_cvt_pk_bf16_f32 v45, v46, v47
v_pk_fma_f32 v[48:49], v[20:21], v[10:11], v[48:49] op_sel:[0,0,0] op_sel_hi:[1,0,1]
v_pk_fma_f32 v[52:53], v[20:21], v[18:19], v[52:53] op_sel:[0,0,0] op_sel_hi:[1,0,1]
v_pk_fma_f32 v[50:51], v[22:23], v[10:11], v[50:51] op_sel:[0,0,0] op_sel_hi:[1,0,1]
v_pk_fma_f32 v[54:55], v[22:23], v[18:19], v[54:55] op_sel:[0,0,0] op_sel_hi:[1,0,1]
v_pk_mul_f32 v[48:49], v[48:49], v[24:25]
v_pk_mul_f32 v[52:53], v[52:53], v[24:25]
v_pk_mul_f32 v[50:51], v[50:51], v[26:27]
v_pk_mul_f32 v[54:55], v[54:55], v[26:27]
v_cvt_pk_bf16_f32 v48, v48, v49
v_cvt_pk_bf16_f32 v52, v52, v53
v_cvt_pk_bf16_f32 v49, v50, v51
v_cvt_pk_bf16_f32 v53, v54, v55
v_pk_mul_f32 v[28:29], v[132:133], s[90:91]
v_pk_mul_f32 v[30:31], v[134:135], s[90:91]
v_pk_fma_f32 v[64:65], v[128:129], v[6:7], v[64:65] op_sel:[0,0,0] op_sel_hi:[1,0,1]
v_pk_fma_f32 v[68:69], v[128:129], v[8:9], v[68:69] op_sel:[0,0,0] op_sel_hi:[1,0,1]
v_pk_fma_f32 v[66:67], v[130:131], v[6:7], v[66:67] op_sel:[0,0,0] op_sel_hi:[1,0,1]
v_pk_fma_f32 v[70:71], v[130:131], v[8:9], v[70:71] op_sel:[0,0,0] op_sel_hi:[1,0,1]
v_pk_mul_f32 v[2:3], v[64:65], v[28:29]
v_pk_mul_f32 v[12:13], v[68:69], v[28:29]
v_pk_mul_f32 v[4:5], v[66:67], v[30:31]
v_pk_mul_f32 v[14:15], v[70:71], v[30:31]
v_pk_fma_f32 v[64:65], v[64:65], v[132:133], s[82:83]
v_pk_fma_f32 v[68:69], v[68:69], v[132:133], s[82:83]
v_pk_fma_f32 v[66:67], v[66:67], v[134:135], s[82:83]
v_pk_fma_f32 v[70:71], v[70:71], v[134:135], s[82:83]
v_exp_f32_e64 v2, v2 clamp
v_exp_f32_e64 v12, v12 clamp
v_exp_f32_e64 v3, v3 clamp
v_exp_f32_e64 v13, v13 clamp
v_exp_f32_e64 v4, v4 clamp
v_exp_f32_e64 v14, v14 clamp
v_exp_f32_e64 v5, v5 clamp
v_exp_f32_e64 v15, v15 clamp
v_pk_add_f32 v[2:3], v[2:3], s[80:81]
v_pk_add_f32 v[12:13], v[12:13], s[80:81]
v_pk_add_f32 v[4:5], v[4:5], s[80:81]
v_pk_add_f32 v[14:15], v[14:15], s[80:81]
v_max_f32 v64, v64, v2
v_max_f32 v68, v68, v12
v_max_f32 v65, v65, v3
v_max_f32 v69, v69, v13
v_max_f32 v66, v66, v4
v_max_f32 v70, v70, v14
v_max_f32 v67, v67, v5
v_max_f32 v71, v71, v15
v_cvt_pk_bf16_f32 v42, v64, v65
v_cvt_pk_bf16_f32 v46, v68, v69
v_cvt_pk_bf16_f32 v43, v66, v67
v_cvt_pk_bf16_f32 v47, v70, v71
v_pk_fma_f32 v[72:73], v[128:129], v[10:11], v[72:73] op_sel:[0,0,0] op_sel_hi:[1,0,1]
v_pk_fma_f32 v[76:77], v[128:129], v[18:19], v[76:77] op_sel:[0,0,0] op_sel_hi:[1,0,1]
v_pk_fma_f32 v[74:75], v[130:131], v[10:11], v[74:75] op_sel:[0,0,0] op_sel_hi:[1,0,1]
v_pk_fma_f32 v[78:79], v[130:131], v[18:19], v[78:79] op_sel:[0,0,0] op_sel_hi:[1,0,1]
v_pk_mul_f32 v[72:73], v[72:73], v[132:133]
v_pk_mul_f32 v[76:77], v[76:77], v[132:133]
v_pk_mul_f32 v[74:75], v[74:75], v[134:135]
v_pk_mul_f32 v[78:79], v[78:79], v[134:135]
v_cvt_pk_bf16_f32 v50, v72, v73
v_cvt_pk_bf16_f32 v54, v76, v77
v_cvt_pk_bf16_f32 v51, v74, v75
v_cvt_pk_bf16_f32 v55, v78, v79
s_nop 0
v_mfma_f32_16x16x32_bf16 v[64:67], v[40:43], v[48:51], 0
v_mfma_f32_16x16x32_bf16 v[68:71], v[40:43], v[52:55], 0
v_mfma_f32_16x16x32_bf16 v[20:23], v[40:43], a[80:83], 0
v_mfma_f32_16x16x32_bf16 v[72:75], v[44:47], v[48:51], 0
v_mfma_f32_16x16x32_bf16 v[76:79], v[44:47], v[52:55], 0
v_mfma_f32_16x16x32_bf16 v[24:27], v[44:47], a[80:83], 0
v_pk_mul_f32 v[28:29], v[140:141], s[90:91]
v_pk_mul_f32 v[30:31], v[142:143], s[90:91]
v_pk_fma_f32 v[88:89], v[136:137], v[6:7], v[88:89] op_sel:[0,0,0] op_sel_hi:[1,0,1]
v_pk_fma_f32 v[92:93], v[136:137], v[8:9], v[92:93] op_sel:[0,0,0] op_sel_hi:[1,0,1]
v_pk_fma_f32 v[90:91], v[138:139], v[6:7], v[90:91] op_sel:[0,0,0] op_sel_hi:[1,0,1]
v_pk_fma_f32 v[94:95], v[138:139], v[8:9], v[94:95] op_sel:[0,0,0] op_sel_hi:[1,0,1]
v_pk_mul_f32 v[2:3], v[88:89], v[28:29]
v_pk_mul_f32 v[12:13], v[92:93], v[28:29]
v_pk_mul_f32 v[4:5], v[90:91], v[30:31]
v_pk_mul_f32 v[14:15], v[94:95], v[30:31]
v_pk_fma_f32 v[88:89], v[88:89], v[140:141], s[82:83]
v_pk_fma_f32 v[92:93], v[92:93], v[140:141], s[82:83]
v_pk_fma_f32 v[90:91], v[90:91], v[142:143], s[82:83]
v_pk_fma_f32 v[94:95], v[94:95], v[142:143], s[82:83]
v_exp_f32_e64 v2, v2 clamp
v_exp_f32_e64 v12, v12 clamp
v_exp_f32_e64 v3, v3 clamp
v_exp_f32_e64 v13, v13 clamp
v_exp_f32_e64 v4, v4 clamp
v_exp_f32_e64 v14, v14 clamp
v_exp_f32_e64 v5, v5 clamp
v_exp_f32_e64 v15, v15 clamp
v_pk_add_f32 v[2:3], v[2:3], s[80:81]
v_pk_add_f32 v[12:13], v[12:13], s[80:81]
v_pk_add_f32 v[4:5], v[4:5], s[80:81]
v_pk_add_f32 v[14:15], v[14:15], s[80:81]
v_max_f32 v88, v88, v2
v_max_f32 v92, v92, v12
v_max_f32 v89, v89, v3
v_max_f32 v93, v93, v13
v_max_f32 v90, v90, v4
v_max_f32 v94, v94, v14
v_max_f32 v91, v91, v5
v_max_f32 v95, v95, v15
v_cvt_pk_bf16_f32 v88, v88, v89
v_cvt_pk_bf16_f32 v92, v92, v93
v_cvt_pk_bf16_f32 v89, v90, v91
v_cvt_pk_bf16_f32 v93, v94, v95
v_pk_fma_f32 v[96:97], v[136:137], v[10:11], v[96:97] op_sel:[0,0,0] op_sel_hi:[1,0,1]
v_pk_fma_f32 v[100:101], v[136:137], v[18:19], v[100:101] op_sel:[0,0,0] op_sel_hi:[1,0,1]
v_pk_fma_f32 v[98:99], v[138:139], v[10:11], v[98:99] op_sel:[0,0,0] op_sel_hi:[1,0,1]
v_pk_fma_f32 v[102:103], v[138:139], v[18:19], v[102:103] op_sel:[0,0,0] op_sel_hi:[1,0,1]
v_pk_mul_f32 v[96:97], v[96:97], v[140:141]
v_pk_mul_f32 v[100:101], v[100:101], v[140:141]
v_pk_mul_f32 v[98:99], v[98:99], v[142:143]
v_pk_mul_f32 v[102:103], v[102:103], v[142:143]
v_cvt_pk_bf16_f32 v96, v96, v97
v_cvt_pk_bf16_f32 v100, v100, v101
v_cvt_pk_bf16_f32 v97, v98, v99
v_cvt_pk_bf16_f32 v101, v102, v103
v_pk_mul_f32 v[28:29], v[148:149], s[90:91]
v_pk_mul_f32 v[30:31], v[150:151], s[90:91]
v_pk_fma_f32 v[112:113], v[144:145], v[6:7], v[112:113] op_sel:[0,0,0] op_sel_hi:[1,0,1]
v_pk_fma_f32 v[116:117], v[144:145], v[8:9], v[116:117] op_sel:[0,0,0] op_sel_hi:[1,0,1]
v_pk_fma_f32 v[114:115], v[146:147], v[6:7], v[114:115] op_sel:[0,0,0] op_sel_hi:[1,0,1]
v_pk_fma_f32 v[118:119], v[146:147], v[8:9], v[118:119] op_sel:[0,0,0] op_sel_hi:[1,0,1]
v_pk_mul_f32 v[2:3], v[112:113], v[28:29]
v_pk_mul_f32 v[12:13], v[116:117], v[28:29]
v_pk_mul_f32 v[4:5], v[114:115], v[30:31]
v_pk_mul_f32 v[14:15], v[118:119], v[30:31]
v_pk_fma_f32 v[112:113], v[112:113], v[148:149], s[82:83]
v_pk_fma_f32 v[116:117], v[116:117], v[148:149], s[82:83]
v_pk_fma_f32 v[114:115], v[114:115], v[150:151], s[82:83]
v_pk_fma_f32 v[118:119], v[118:119], v[150:151], s[82:83]
v_exp_f32_e64 v2, v2 clamp
v_exp_f32_e64 v12, v12 clamp
v_exp_f32_e64 v3, v3 clamp
v_exp_f32_e64 v13, v13 clamp
v_exp_f32_e64 v4, v4 clamp
v_exp_f32_e64 v14, v14 clamp
v_exp_f32_e64 v5, v5 clamp
v_exp_f32_e64 v15, v15 clamp
v_pk_add_f32 v[2:3], v[2:3], s[80:81]
v_pk_add_f32 v[12:13], v[12:13], s[80:81]
v_pk_add_f32 v[4:5], v[4:5], s[80:81]
v_pk_add_f32 v[14:15], v[14:15], s[80:81]
v_max_f32 v112, v112, v2
v_max_f32 v116, v116, v12
v_max_f32 v113, v113, v3
v_max_f32 v117, v117, v13
v_max_f32 v114, v114, v4
v_max_f32 v118, v118, v14
v_max_f32 v115, v115, v5
v_max_f32 v119, v119, v15
v_cvt_pk_bf16_f32 v90, v112, v113
v_cvt_pk_bf16_f32 v94, v116, v117
v_cvt_pk_bf16_f32 v91, v114, v115
v_cvt_pk_bf16_f32 v95, v118, v119
v_pk_fma_f32 v[120:121], v[144:145], v[10:11], v[120:121] op_sel:[0,0,0] op_sel_hi:[1,0,1]
v_pk_fma_f32 v[124:125], v[144:145], v[18:19], v[124:125] op_sel:[0,0,0] op_sel_hi:[1,0,1]
v_pk_fma_f32 v[122:123], v[146:147], v[10:11], v[122:123] op_sel:[0,0,0] op_sel_hi:[1,0,1]
v_pk_fma_f32 v[126:127], v[146:147], v[18:19], v[126:127] op_sel:[0,0,0] op_sel_hi:[1,0,1]
v_pk_mul_f32 v[120:121], v[120:121], v[148:149]
v_pk_mul_f32 v[124:125], v[124:125], v[148:149]
v_pk_mul_f32 v[122:123], v[122:123], v[150:151]
v_pk_mul_f32 v[126:127], v[126:127], v[150:151]
v_cvt_pk_bf16_f32 v98, v120, v121
v_cvt_pk_bf16_f32 v102, v124, v125
v_cvt_pk_bf16_f32 v99, v122, v123
v_cvt_pk_bf16_f32 v103, v126, v127
s_nop 0
v_mfma_f32_16x16x32_bf16 v[64:67], v[88:91], v[96:99], v[64:67]
v_mfma_f32_16x16x32_bf16 v[68:71], v[88:91], v[100:103], v[68:71]
v_mfma_f32_16x16x32_bf16 v[20:23], v[88:91], a[80:83], v[20:23]
v_mfma_f32_16x16x32_bf16 v[72:75], v[92:95], v[96:99], v[72:75]
v_mfma_f32_16x16x32_bf16 v[76:79], v[92:95], v[100:103], v[76:79]
v_mfma_f32_16x16x32_bf16 v[24:27], v[92:95], a[80:83], v[24:27]
s_lshl_b32 s70, s60, 11
s_add_u32 s70, s70, 16384
v_add_u32 v2, s70, v16
v_xor_b32 v3, 4096, v2
v_lshrrev_b32 v4, 4, v1
v_lshlrev_b32 v5, 4, v4
v_lshlrev_b32 v4, 5, v4
s_lshl_b32 s70, s60, 6
s_add_u32 s70, s70, 163584
v_add_u32 v5, s70, v5
v_xor_b32 v6, 128, v5
s_lshl_b32 s72, s67, 1
s_add_u32 s72, s72, s66
s_lshl_b32 s72, s72, 10
s_add_u32 s72, s72, s87
s_lshl_b32 s73, s67, 7
s_lshl_b32 s70, s66, 4
s_add_u32 s73, s73, s70
s_add_u32 s73, s73, s87
s_add_u32 s73, s73, 4096
s_mov_b32 s92, 0x00010001
s_mov_b32 s93, 0x00010001
v_mov_b32 v15, s68
s_cmp_eq_u32 s66, 0
s_cbranch_scc0 L_ex1
ds_write_b128 v2, v[68:71]
ds_write_b128 v2, v[76:79] offset:1024
ds_write_b128 v5, v[24:27]
s_waitcnt lgkmcnt(0)
s_barrier
ds_read_b128 v[128:131], v3
ds_read_b128 v[132:135], v3 offset:1024
ds_read_b128 v[136:139], v6
s_waitcnt lgkmcnt(1)
v_pk_add_f32 v[128:129], v[128:129], v[64:65]
v_pk_add_f32 v[130:131], v[130:131], v[66:67]
v_pk_add_f32 v[132:133], v[132:133], v[72:73]
v_pk_add_f32 v[134:135], v[134:135], v[74:75]
s_waitcnt lgkmcnt(0)
v_pk_add_f32 v[136:137], v[136:137], v[20:21]
v_pk_add_f32 v[138:139], v[138:139], v[22:23]
s_branch L_ex_d
L_ex1:
ds_write_b128 v2, v[64:67]
ds_write_b128 v2, v[72:75] offset:1024
ds_write_b128 v5, v[20:23]
s_waitcnt lgkmcnt(0)
s_barrier
ds_read_b128 v[128:131], v3
ds_read_b128 v[132:135], v3 offset:1024
ds_read_b128 v[136:139], v6
s_waitcnt lgkmcnt(1)
v_pk_add_f32 v[128:129], v[128:129], v[68:69]
v_pk_add_f32 v[130:131], v[130:131], v[70:71]
v_pk_add_f32 v[132:133], v[132:133], v[76:77]
v_pk_add_f32 v[134:135], v[134:135], v[78:79]
s_waitcnt lgkmcnt(0)
v_pk_add_f32 v[136:137], v[136:137], v[24:25]
v_pk_add_f32 v[138:139], v[138:139], v[26:27]
L_ex_d:
v_cvt_pk_bf16_f32 v140, v128, v129
v_cvt_pk_bf16_f32 v141, v130, v131
v_cvt_pk_bf16_f32 v142, v132, v133
v_cvt_pk_bf16_f32 v143, v134, v135
v_bfi_b32 v136, s85, v15, v136
v_bfi_b32 v137, s85, v15, v137
v_bfi_b32 v138, s85, v15, v138
v_bfi_b32 v139, s85, v15, v139
s_cmp_eq_u32 s69, 0
s_cbranch_scc1 L_kvp_s
buffer_store_dwordx4 v[140:143], v16, s[12:15], s72 offen
s_mov_b64 exec, s[92:93]
buffer_store_dwordx4 v[136:139], v4, s[12:15], s73 offen
s_mov_b64 exec, -1
L_kvp_d:
v_and_b32 v2, 15, v1
v_lshlrev_b32 v2, 2, v2
s_lshl_b32 s70, s66, 8
s_add_u32 s70, s70, 159744
v_add_u32 v2, s70, v2
v_lshrrev_b32 v3, 4, v1
v_lshlrev_b32 v3, 4, v3
s_lshl_b32 s70, s67, 7
s_add_u32 s70, s70, 160768
v_add_u32 v5, s70, v3
ds_read_b32 v8, v2 offset:0
ds_read_b32 v128, v2 offset:512
ds_read_b32 v10, v2 offset:64
ds_read_b32 v130, v2 offset:576
ds_read_b32 v12, v2 offset:128
ds_read_b32 v132, v2 offset:640
ds_read_b32 v14, v2 offset:192
ds_read_b32 v134, v2 offset:704
ds_read_b128 v[144:147], v5 offset:0
ds_read_b128 v[148:151], v5 offset:64
s_lshl_b32 s70, s67, 11
s_add_u32 s70, s70, 24576
v_add_u32 v17, s70, v16
s_lshl_b32 s70, s67, 6
s_add_u32 s70, s70, 161600
v_add_u32 v18, s70, v3
s_waitcnt lgkmcnt(0)
v_mul_f32 v20, s90, v128
v_mul_f32 v22, s90, v130
v_mul_f32 v4, s90, v132
v_mul_f32 v6, s90, v134
v_pk_fma_f32 v[32:33], v[144:145], v[8:9], v[32:33] op_sel:[0,0,0] op_sel_hi:[1,0,1]
v_pk_fma_f32 v[36:37], v[148:149], v[8:9], v[36:37] op_sel:[0,0,0] op_sel_hi:[1,0,1]
v_pk_fma_f32 v[34:35], v[146:147], v[8:9], v[34:35] op_sel:[0,0,0] op_sel_hi:[1,0,1]
v_pk_fma_f32 v[38:39], v[150:151], v[8:9], v[38:39] op_sel:[0,0,0] op_sel_hi:[1,0,1]
v_pk_mul_f32 v[24:25], v[32:33], v[20:21] op_sel:[0,0] op_sel_hi:[1,0]
v_pk_mul_f32 v[28:29], v[36:37], v[20:21] op_sel:[0,0] op_sel_hi:[1,0]
v_pk_mul_f32 v[26:27], v[34:35], v[20:21] op_sel:[0,0] op_sel_hi:[1,0]
v_pk_mul_f32 v[30:31], v[38:39], v[20:21] op_sel:[0,0] op_sel_hi:[1,0]
v_pk_fma_f32 v[32:33], v[32:33], v[128:129], s[82:83] op_sel:[0,0,0] op_sel_hi:[1,0,1]
v_pk_fma_f32 v[36:37], v[36:37], v[128:129], s[82:83] op_sel:[0,0,0] op_sel_hi:[1,0,1]
v_pk_fma_f32 v[34:35], v[34:35], v[128:129], s[82:83] op_sel:[0,0,0] op_sel_hi:[1,0,1]
v_pk_fma_f32 v[38:39], v[38:39], v[128:129], s[82:83] op_sel:[0,0,0] op_sel_hi:[1,0,1]
v_exp_f32_e64 v24, v24 clamp
v_exp_f32_e64 v28, v28 clamp
v_exp_f32_e64 v25, v25 clamp
v_exp_f32_e64 v29, v29 clamp
v_exp_f32_e64 v26, v26 clamp
v_exp_f32_e64 v30, v30 clamp
v_exp_f32_e64 v27, v27 clamp
v_exp_f32_e64 v31, v31 clamp
v_pk_add_f32 v[24:25], v[24:25], s[80:81]
v_pk_add_f32 v[28:29], v[28:29], s[80:81]
v_pk_add_f32 v[26:27], v[26:27], s[80:81]
v_pk_add_f32 v[30:31], v[30:31], s[80:81]
v_max_f32 v32, v32, v24
v_max_f32 v36, v36, v28
v_max_f32 v33, v33, v25
v_max_f32 v37, v37, v29
v_max_f32 v34, v34, v26
v_max_f32 v38, v38, v30
v_max_f32 v35, v35, v27
v_max_f32 v39, v39, v31
v_cvt_pk_bf16_f32 v32, v32, v33
v_cvt_pk_bf16_f32 v33, v34, v35
v_cvt_pk_bf16_f32 v34, v36, v37
v_cvt_pk_bf16_f32 v35, v38, v39
v_pk_fma_f32 v[56:57], v[144:145], v[10:11], v[56:57] op_sel:[0,0,0] op_sel_hi:[1,0,1]
v_pk_fma_f32 v[60:61], v[148:149], v[10:11], v[60:61] op_sel:[0,0,0] op_sel_hi:[1,0,1]
v_pk_fma_f32 v[58:59], v[146:147], v[10:11], v[58:59] op_sel:[0,0,0] op_sel_hi:[1,0,1]
v_pk_fma_f32 v[62:63], v[150:151], v[10:11], v[62:63] op_sel:[0,0,0] op_sel_hi:[1,0,1]
v_pk_mul_f32 v[24:25], v[56:57], v[22:23] op_sel:[0,0] op_sel_hi:[1,0]
v_pk_mul_f32 v[28:29], v[60:61], v[22:23] op_sel:[0,0] op_sel_hi:[1,0]
v_pk_mul_f32 v[26:27], v[58:59], v[22:23] op_sel:[0,0] op_sel_hi:[1,0]
v_pk_mul_f32 v[30:31], v[62:63], v[22:23] op_sel:[0,0] op_sel_hi:[1,0]
v_pk_fma_f32 v[56:57], v[56:57], v[130:131], s[82:83] op_sel:[0,0,0] op_sel_hi:[1,0,1]
v_pk_fma_f32 v[60:61], v[60:61], v[130:131], s[82:83] op_sel:[0,0,0] op_sel_hi:[1,0,1]
v_pk_fma_f32 v[58:59], v[58:59], v[130:131], s[82:83] op_sel:[0,0,0] op_sel_hi:[1,0,1]
v_pk_fma_f32 v[62:63], v[62:63], v[130:131], s[82:83] op_sel:[0,0,0] op_sel_hi:[1,0,1]
v_exp_f32_e64 v24, v24 clamp
v_exp_f32_e64 v28, v28 clamp
v_exp_f32_e64 v25, v25 clamp
v_exp_f32_e64 v29, v29 clamp
v_exp_f32_e64 v26, v26 clamp
v_exp_f32_e64 v30, v30 clamp
v_exp_f32_e64 v27, v27 clamp
v_exp_f32_e64 v31, v31 clamp
v_pk_add_f32 v[24:25], v[24:25], s[80:81]
v_pk_add_f32 v[28:29], v[28:29], s[80:81]
v_pk_add_f32 v[26:27], v[26:27], s[80:81]
v_pk_add_f32 v[30:31], v[30:31], s[80:81]
v_max_f32 v56, v56, v24
v_max_f32 v60, v60, v28
v_max_f32 v57, v57, v25
v_max_f32 v61, v61, v29
v_max_f32 v58, v58, v26
v_max_f32 v62, v62, v30
v_max_f32 v59, v59, v27
v_max_f32 v63, v63, v31
v_cvt_pk_bf16_f32 v56, v56, v57
v_cvt_pk_bf16_f32 v57, v58, v59
v_cvt_pk_bf16_f32 v58, v60, v61
v_cvt_pk_bf16_f32 v59, v62, v63
v_pk_fma_f32 v[80:81], v[144:145], v[12:13], v[80:81] op_sel:[0,0,0] op_sel_hi:[1,0,1]
v_pk_fma_f32 v[84:85], v[148:149], v[12:13], v[84:85] op_sel:[0,0,0] op_sel_hi:[1,0,1]
v_pk_fma_f32 v[82:83], v[146:147], v[12:13], v[82:83] op_sel:[0,0,0] op_sel_hi:[1,0,1]
v_pk_fma_f32 v[86:87], v[150:151], v[12:13], v[86:87] op_sel:[0,0,0] op_sel_hi:[1,0,1]
v_pk_mul_f32 v[24:25], v[80:81], v[4:5] op_sel:[0,0] op_sel_hi:[1,0]
v_pk_mul_f32 v[28:29], v[84:85], v[4:5] op_sel:[0,0] op_sel_hi:[1,0]
v_pk_mul_f32 v[26:27], v[82:83], v[4:5] op_sel:[0,0] op_sel_hi:[1,0]
v_pk_mul_f32 v[30:31], v[86:87], v[4:5] op_sel:[0,0] op_sel_hi:[1,0]
v_pk_fma_f32 v[80:81], v[80:81], v[132:133], s[82:83] op_sel:[0,0,0] op_sel_hi:[1,0,1]
v_pk_fma_f32 v[84:85], v[84:85], v[132:133], s[82:83] op_sel:[0,0,0] op_sel_hi:[1,0,1]
v_pk_fma_f32 v[82:83], v[82:83], v[132:133], s[82:83] op_sel:[0,0,0] op_sel_hi:[1,0,1]
v_pk_fma_f32 v[86:87], v[86:87], v[132:133], s[82:83] op_sel:[0,0,0] op_sel_hi:[1,0,1]
v_exp_f32_e64 v24, v24 clamp
v_exp_f32_e64 v28, v28 clamp
v_exp_f32_e64 v25, v25 clamp
v_exp_f32_e64 v29, v29 clamp
v_exp_f32_e64 v26, v26 clamp
v_exp_f32_e64 v30, v30 clamp
v_exp_f32_e64 v27, v27 clamp
v_exp_f32_e64 v31, v31 clamp
v_pk_add_f32 v[24:25], v[24:25], s[80:81]
v_pk_add_f32 v[28:29], v[28:29], s[80:81]
v_pk_add_f32 v[26:27], v[26:27], s[80:81]
v_pk_add_f32 v[30:31], v[30:31], s[80:81]
v_max_f32 v80, v80, v24
v_max_f32 v84, v84, v28
v_max_f32 v81, v81, v25
v_max_f32 v85, v85, v29
v_max_f32 v82, v82, v26
v_max_f32 v86, v86, v30
v_max_f32 v83, v83, v27
v_max_f32 v87, v87, v31
v_cvt_pk_bf16_f32 v80, v80, v81
v_cvt_pk_bf16_f32 v81, v82, v83
v_cvt_pk_bf16_f32 v82, v84, v85
v_cvt_pk_bf16_f32 v83, v86, v87
v_pk_fma_f32 v[104:105], v[144:145], v[14:15], v[104:105] op_sel:[0,0,0] op_sel_hi:[1,0,1]
v_pk_fma_f32 v[108:109], v[148:149], v[14:15], v[108:109] op_sel:[0,0,0] op_sel_hi:[1,0,1]
v_pk_fma_f32 v[106:107], v[146:147], v[14:15], v[106:107] op_sel:[0,0,0] op_sel_hi:[1,0,1]
v_pk_fma_f32 v[110:111], v[150:151], v[14:15], v[110:111] op_sel:[0,0,0] op_sel_hi:[1,0,1]
v_pk_mul_f32 v[24:25], v[104:105], v[6:7] op_sel:[0,0] op_sel_hi:[1,0]
v_pk_mul_f32 v[28:29], v[108:109], v[6:7] op_sel:[0,0] op_sel_hi:[1,0]
v_pk_mul_f32 v[26:27], v[106:107], v[6:7] op_sel:[0,0] op_sel_hi:[1,0]
v_pk_mul_f32 v[30:31], v[110:111], v[6:7] op_sel:[0,0] op_sel_hi:[1,0]
v_pk_fma_f32 v[104:105], v[104:105], v[134:135], s[82:83] op_sel:[0,0,0] op_sel_hi:[1,0,1]
v_pk_fma_f32 v[108:109], v[108:109], v[134:135], s[82:83] op_sel:[0,0,0] op_sel_hi:[1,0,1]
v_pk_fma_f32 v[106:107], v[106:107], v[134:135], s[82:83] op_sel:[0,0,0] op_sel_hi:[1,0,1]
v_pk_fma_f32 v[110:111], v[110:111], v[134:135], s[82:83] op_sel:[0,0,0] op_sel_hi:[1,0,1]
v_exp_f32_e64 v24, v24 clamp
v_exp_f32_e64 v28, v28 clamp
v_exp_f32_e64 v25, v25 clamp
v_exp_f32_e64 v29, v29 clamp
v_exp_f32_e64 v26, v26 clamp
v_exp_f32_e64 v30, v30 clamp
v_exp_f32_e64 v27, v27 clamp
v_exp_f32_e64 v31, v31 clamp
v_pk_add_f32 v[24:25], v[24:25], s[80:81]
v_pk_add_f32 v[28:29], v[28:29], s[80:81]
v_pk_add_f32 v[26:27], v[26:27], s[80:81]
v_pk_add_f32 v[30:31], v[30:31], s[80:81]
v_max_f32 v104, v104, v24
v_max_f32 v108, v108, v28
v_max_f32 v105, v105, v25
v_max_f32 v109, v109, v29
v_max_f32 v106, v106, v26
v_max_f32 v110, v110, v30
v_max_f32 v107, v107, v27
v_max_f32 v111, v111, v31
v_cvt_pk_bf16_f32 v104, v104, v105
v_cvt_pk_bf16_f32 v105, v106, v107
v_cvt_pk_bf16_f32 v106, v108, v109
v_cvt_pk_bf16_f32 v107, v110, v111
v_lshrrev_b32 v2, 4, v1
v_bfe_u32 v3, v1, 2, 2
v_lshl_add_u32 v4, v2, 2, v3
v_lshlrev_b32 v5, 7, v4
v_bfe_u32 v4, v4, 1, 2
v_lshl_add_u32 v5, v4, 5, v5
v_and_b32 v4, 3, v1
v_lshl_add_u32 v5, v4, 3, v5
v_add_u32 v8, 28672, v5
v_xor_b32 v9, 32, v8
v_xor_b32 v10, 64, v8
v_xor_b32 v11, 96, v8
v_add_u32 v12, 65536, v8
v_add_u32 v13, 65536, v9
v_add_u32 v14, 65536, v10
v_add_u32 v15, 65536, v11
v_and_b32 v3, 15, v1
v_lshrrev_b32 v4, 1, v3
v_lshrrev_b32 v5, 1, v2
v_xor_b32 v4, v4, v5
v_lshlrev_b32 v4, 4, v4
v_lshl_add_u32 v4, v3, 7, v4
v_and_b32 v5, 1, v2
v_lshl_add_u32 v4, v5, 3, v4
s_lshl_b32 s70, s60, 12
v_add_u32 v20, s70, v4
v_xor_b32 v21, 32, v20
v_xor_b32 v22, 64, v20
v_xor_b32 v23, 96, v20
s_lshl_b32 s74, s64, 18
s_lshl_b32 s70, s60, 16
s_add_u32 s74, s74, s70
s_add_u32 s74, s74, 2097152
v_add_u32 v6, s74, v16
v_add_u32 v19, 32768, v6
s_lshl_b32 s74, s89, 11
s_barrier
ds_read_b128 a[0:3], v17
ds_read_b128 a[4:7], v17 offset:1024
ds_read_b128 a[8:11], v18
s_waitcnt lgkmcnt(0)
v_mfma_f32_16x16x32_bf16 v[48:51], a[8:11], v[32:35], 0
v_mfma_f32_16x16x32_bf16 v[40:43], a[0:3], v[32:35], 0
v_mfma_f32_16x16x32_bf16 v[44:47], a[4:7], v[32:35], 0
v_mfma_f32_16x16x32_bf16 v[72:75], a[8:11], v[56:59], 0
v_mfma_f32_16x16x32_bf16 v[64:67], a[0:3], v[56:59], 0
v_mfma_f32_16x16x32_bf16 v[68:71], a[4:7], v[56:59], 0
v_mfma_f32_16x16x32_bf16 v[96:99], a[8:11], v[80:83], 0
v_mfma_f32_16x16x32_bf16 v[88:91], a[0:3], v[80:83], 0
v_mfma_f32_16x16x32_bf16 v[92:95], a[4:7], v[80:83], 0
v_mfma_f32_16x16x32_bf16 v[120:123], a[8:11], v[104:107], 0
v_mfma_f32_16x16x32_bf16 v[112:115], a[0:3], v[104:107], 0
v_mfma_f32_16x16x32_bf16 v[116:119], a[4:7], v[104:107], 0
v_add_f32 v48, s80, v48
v_rcp_f32 v48, v48
s_nop 0
v_pk_mul_f32 v[40:41], v[40:41], v[48:49] op_sel_hi:[1,0]
v_pk_mul_f32 v[42:43], v[42:43], v[48:49] op_sel_hi:[1,0]
v_pk_mul_f32 v[44:45], v[44:45], v[48:49] op_sel_hi:[1,0]
v_pk_mul_f32 v[46:47], v[46:47], v[48:49] op_sel_hi:[1,0]
v_cvt_pk_bf16_f32 v52, v40, v41
v_cvt_pk_bf16_f32 v53, v42, v43
v_cvt_pk_bf16_f32 v54, v44, v45
v_cvt_pk_bf16_f32 v55, v46, v47
s_add_u32 s70, s88, 0
buffer_store_dwordx4 v[52:55], v16, s[12:15], s70 offen sc1
v_add_f32 v72, s80, v72
v_rcp_f32 v72, v72
s_nop 0
v_pk_mul_f32 v[64:65], v[64:65], v[72:73] op_sel_hi:[1,0]
v_pk_mul_f32 v[66:67], v[66:67], v[72:73] op_sel_hi:[1,0]
v_pk_mul_f32 v[68:69], v[68:69], v[72:73] op_sel_hi:[1,0]
v_pk_mul_f32 v[70:71], v[70:71], v[72:73] op_sel_hi:[1,0]
v_cvt_pk_bf16_f32 v76, v64, v65
v_cvt_pk_bf16_f32 v77, v66, v67
v_cvt_pk_bf16_f32 v78, v68, v69
v_cvt_pk_bf16_f32 v79, v70, v71
s_add_u32 s70, s88, 32768
buffer_store_dwordx4 v[76:79], v16, s[12:15], s70 offen sc1
v_add_f32 v96, s80, v96
v_rcp_f32 v96, v96
s_nop 0
v_pk_mul_f32 v[88:89], v[88:89], v[96:97] op_sel_hi:[1,0]
v_pk_mul_f32 v[90:91], v[90:91], v[96:97] op_sel_hi:[1,0]
v_pk_mul_f32 v[92:93], v[92:93], v[96:97] op_sel_hi:[1,0]
v_pk_mul_f32 v[94:95], v[94:95], v[96:97] op_sel_hi:[1,0]
v_cvt_pk_bf16_f32 v100, v88, v89
v_cvt_pk_bf16_f32 v101, v90, v91
v_cvt_pk_bf16_f32 v102, v92, v93
v_cvt_pk_bf16_f32 v103, v94, v95
s_add_u32 s70, s88, 65536
buffer_store_dwordx4 v[100:103], v16, s[12:15], s70 offen sc1
v_add_f32 v120, s80, v120
v_rcp_f32 v120, v120
s_nop 0
v_pk_mul_f32 v[112:113], v[112:113], v[120:121] op_sel_hi:[1,0]
v_pk_mul_f32 v[114:115], v[114:115], v[120:121] op_sel_hi:[1,0]
v_pk_mul_f32 v[116:117], v[116:117], v[120:121] op_sel_hi:[1,0]
v_pk_mul_f32 v[118:119], v[118:119], v[120:121] op_sel_hi:[1,0]
v_cvt_pk_bf16_f32 v124, v112, v113
v_cvt_pk_bf16_f32 v125, v114, v115
v_cvt_pk_bf16_f32 v126, v116, v117
v_cvt_pk_bf16_f32 v127, v118, v119
s_add_u32 s70, s88, 98304
buffer_store_dwordx4 v[124:127], v16, s[12:15], s70 offen sc1
v_xor_b32 v7, s76, v7
ds_read_b64 v[26:27], v20 offset:0
ds_read_b64 v[30:31], v21 offset:0
ds_read_b64 v[34:35], v22 offset:0
ds_read_b64 v[38:39], v23 offset:0
ds_read_b64 v[42:43], v20 offset:2048
ds_read_b64 v[46:47], v21 offset:2048
ds_read_b64 v[50:51], v22 offset:2048
ds_read_b64 v[54:55], v23 offset:2048
s_waitcnt lgkmcnt(0)
ds_read_b64_tr_b16 a[0:1], v8 offset:0
ds_read_b64_tr_b16 a[2:3], v8 offset:2048
ds_read_b64_tr_b16 a[4:5], v9 offset:0
ds_read_b64_tr_b16 a[6:7], v9 offset:2048
ds_read_b64_tr_b16 a[8:9], v10 offset:0
ds_read_b64_tr_b16 a[10:11], v10 offset:2048
ds_read_b64_tr_b16 a[12:13], v11 offset:0
ds_read_b64_tr_b16 a[14:15], v11 offset:2048
ds_read_b64_tr_b16 a[16:17], v8 offset:4096
ds_read_b64_tr_b16 a[18:19], v8 offset:6144
ds_read_b64_tr_b16 a[20:21], v9 offset:4096
ds_read_b64_tr_b16 a[22:23], v9 offset:6144
ds_read_b64_tr_b16 a[24:25], v10 offset:4096
ds_read_b64_tr_b16 a[26:27], v10 offset:6144
ds_read_b64_tr_b16 a[28:29], v11 offset:4096
ds_read_b64_tr_b16 a[30:31], v11 offset:6144
v_lshlrev_b32 v24, 16, v26
v_and_b32 v25, 0xffff0000, v26
v_lshlrev_b32 v26, 16, v27
v_and_b32 v27, 0xffff0000, v27
v_lshlrev_b32 v28, 16, v30
v_and_b32 v29, 0xffff0000, v30
v_lshlrev_b32 v30, 16, v31
v_and_b32 v31, 0xffff0000, v31
v_lshlrev_b32 v32, 16, v34
v_and_b32 v33, 0xffff0000, v34
v_lshlrev_b32 v34, 16, v35
v_and_b32 v35, 0xffff0000, v35
v_lshlrev_b32 v36, 16, v38
v_and_b32 v37, 0xffff0000, v38
v_lshlrev_b32 v38, 16, v39
v_and_b32 v39, 0xffff0000, v39
v_lshlrev_b32 v40, 16, v42
v_and_b32 v41, 0xffff0000, v42
v_lshlrev_b32 v42, 16, v43
v_and_b32 v43, 0xffff0000, v43
v_lshlrev_b32 v44, 16, v46
v_and_b32 v45, 0xffff0000, v46
v_lshlrev_b32 v46, 16, v47
v_and_b32 v47, 0xffff0000, v47
v_lshlrev_b32 v48, 16, v50
v_and_b32 v49, 0xffff0000, v50
v_lshlrev_b32 v50, 16, v51
v_and_b32 v51, 0xffff0000, v51
v_lshlrev_b32 v52, 16, v54
v_and_b32 v53, 0xffff0000, v54
v_lshlrev_b32 v54, 16, v55
v_and_b32 v55, 0xffff0000, v55
v_accvgpr_read_b32 v136, a96
v_accvgpr_read_b32 v137, a97
v_accvgpr_read_b32 v138, a98
v_accvgpr_read_b32 v139, a99
v_accvgpr_read_b32 v140, a100
v_accvgpr_read_b32 v141, a101
v_accvgpr_read_b32 v142, a102
v_accvgpr_read_b32 v143, a103
v_lshlrev_b32 v120, 16, v136
v_and_b32 v121, 0xffff0000, v136
v_lshlrev_b32 v122, 16, v137
v_and_b32 v123, 0xffff0000, v137
v_lshlrev_b32 v124, 16, v138
v_and_b32 v125, 0xffff0000, v138
v_lshlrev_b32 v126, 16, v139
v_and_b32 v127, 0xffff0000, v139
v_lshlrev_b32 v128, 16, v140
v_and_b32 v129, 0xffff0000, v140
v_lshlrev_b32 v130, 16, v141
v_and_b32 v131, 0xffff0000, v141
v_lshlrev_b32 v132, 16, v142
v_and_b32 v133, 0xffff0000, v142
v_lshlrev_b32 v134, 16, v143
v_and_b32 v135, 0xffff0000, v143
v_and_b32 v2, 15, v1
v_lshrrev_b32 v3, 5, v1
v_lshlrev_b32 v4, 4, v2
v_lshl_add_u32 v144, v3, 8, v4
s_lshl_b32 s75, s64, 15
s_lshl_b32 s70, s60, 9
s_add_u32 s75, s75, s70
s_add_u32 s75, s75, 6291456
s_lshl_b32 s70, s65, 11
s_add_u32 s72, s75, s70
s_mov_b32 s92, 0xffff
s_mov_b32 s93, 0xffff
v_and_b32 v2, 31, v1
v_lshlrev_b32 v5, 4, v2
v_lshl_add_u32 v145, v3, 11, v5
s_lshl_b32 s70, s64, 7
s_lshl_b32 s71, s60, 5
s_add_u32 s70, s70, s71
s_sub_u32 s70, 2047, s70
v_sub_u32 v146, s70, v2
s_lshl_b32 s70, s60, 9
s_add_u32 s70, s70, 49152
v_add_u32 v147, s70, v5
s_waitcnt vmcnt(0)
buffer_load_dwordx4 v[56:59], v6, s[12:15], s74 offen offset:0 sc1
buffer_load_dwordx4 v[60:63], v19, s[12:15], s74 offen offset:0 sc1
buffer_load_dwordx4 v[64:67], v6, s[12:15], s74 offen offset:1024 sc1
buffer_load_dwordx4 v[68:71], v19, s[12:15], s74 offen offset:1024 sc1
s_add_u32 s74, s74, 2048
s_and_b32 s74, s74, 0x7fff
buffer_load_dwordx4 v[72:75], v6, s[12:15], s74 offen offset:0 sc1
buffer_load_dwordx4 v[76:79], v19, s[12:15], s74 offen offset:0 sc1
buffer_load_dwordx4 v[80:83], v6, s[12:15], s74 offen offset:1024 sc1
buffer_load_dwordx4 v[84:87], v19, s[12:15], s74 offen offset:1024 sc1
s_add_u32 s74, s74, 2048
s_and_b32 s74, s74, 0x7fff
buffer_load_dwordx4 v[88:91], v6, s[12:15], s74 offen offset:0 sc1
buffer_load_dwordx4 v[92:95], v19, s[12:15], s74 offen offset:0 sc1
buffer_load_dwordx4 v[96:99], v6, s[12:15], s74 offen offset:1024 sc1
buffer_load_dwordx4 v[100:103], v19, s[12:15], s74 offen offset:1024 sc1
s_add_u32 s74, s74, 2048
s_and_b32 s74, s74, 0x7fff
s_waitcnt vmcnt(8)
L_o0_chk:
v_max3_u32 v2, v56, v60, v64
v_max_u32 v2, v2, v68
v_cmp_eq_u32 vcc, -1, v2
s_cbranch_vccnz L_o0_rt
L_o0_ok:
s_waitcnt lgkmcnt(8)
v_mfma_f32_16x16x32_bf16 v[24:27], a[0:3], v[56:59], v[24:27]
ds_read_b64_tr_b16 a[32:33], v8 offset:8192
buffer_load_dwordx4 v[104:107], v6, s[12:15], s74 offen offset:0 sc1
v_mfma_f32_16x16x32_bf16 v[40:43], a[0:3], v[60:63], v[40:43]
ds_read_b64_tr_b16 a[34:35], v8 offset:10240
buffer_load_dwordx4 v[108:111], v19, s[12:15], s74 offen offset:0 sc1
v_mfma_f32_16x16x32_bf16 v[28:31], a[4:7], v[56:59], v[28:31]
ds_read_b64_tr_b16 a[36:37], v9 offset:8192
v_mfma_f32_16x16x32_bf16 v[44:47], a[4:7], v[60:63], v[44:47]
ds_read_b64_tr_b16 a[38:39], v9 offset:10240
buffer_load_dwordx4 v[112:115], v6, s[12:15], s74 offen offset:1024 sc1
v_mfma_f32_16x16x32_bf16 v[32:35], a[8:11], v[56:59], v[32:35]
ds_read_b64_tr_b16 a[40:41], v10 offset:8192
buffer_load_dwordx4 v[116:119], v19, s[12:15], s74 offen offset:1024 sc1
v_mfma_f32_16x16x32_bf16 v[48:51], a[8:11], v[60:63], v[48:51]
ds_read_b64_tr_b16 a[42:43], v10 offset:10240
v_mfma_f32_16x16x32_bf16 v[36:39], a[12:15], v[56:59], v[36:39]
ds_read_b64_tr_b16 a[44:45], v11 offset:8192
s_add_u32 s74, s74, 2048
v_mfma_f32_16x16x32_bf16 v[52:55], a[12:15], v[60:63], v[52:55]
ds_read_b64_tr_b16 a[46:47], v11 offset:10240
s_waitcnt lgkmcnt(8)
v_mfma_f32_16x16x32_bf16 v[24:27], a[16:19], v[64:67], v[24:27]
ds_read_b64_tr_b16 a[0:1], v8 offset:12288
s_and_b32 s74, s74, 0x7fff
v_mfma_f32_16x16x32_bf16 v[40:43], a[16:19], v[68:71], v[40:43]
ds_read_b64_tr_b16 a[2:3], v8 offset:14336
s_waitcnt vmcnt(8)
v_mfma_f32_16x16x32_bf16 v[28:31], a[20:23], v[64:67], v[28:31]
ds_read_b64_tr_b16 a[4:5], v9 offset:12288
v_mfma_f32_16x16x32_bf16 v[44:47], a[20:23], v[68:71], v[44:47]
ds_read_b64_tr_b16 a[6:7], v9 offset:14336
v_max3_u32 v2, v72, v76, v80
v_mfma_f32_16x16x32_bf16 v[32:35], a[24:27], v[64:67], v[32:35]
ds_read_b64_tr_b16 a[8:9], v10 offset:12288
v_max_u32 v2, v2, v84
v_mfma_f32_16x16x32_bf16 v[48:51], a[24:27], v[68:71], v[48:51]
ds_read_b64_tr_b16 a[10:11], v10 offset:14336
v_mfma_f32_16x16x32_bf16 v[36:39], a[28:31], v[64:67], v[36:39]
ds_read_b64_tr_b16 a[12:13], v11 offset:12288
v_cmp_eq_u32 vcc, -1, v2
v_mfma_f32_16x16x32_bf16 v[52:55], a[28:31], v[68:71], v[52:55]
ds_read_b64_tr_b16 a[14:15], v11 offset:14336
s_cbranch_vccnz L_o1_rt
L_o1_ok:
s_waitcnt lgkmcnt(8)
v_mfma_f32_16x16x32_bf16 v[24:27], a[32:35], v[72:75], v[24:27]
ds_read_b64_tr_b16 a[16:17], v8 offset:16384
buffer_load_dwordx4 v[56:59], v6, s[12:15], s74 offen offset:0 sc1
v_mfma_f32_16x16x32_bf16 v[40:43], a[32:35], v[76:79], v[40:43]
ds_read_b64_tr_b16 a[18:19], v8 offset:18432
buffer_load_dwordx4 v[60:63], v19, s[12:15], s74 offen offset:0 sc1
v_mfma_f32_16x16x32_bf16 v[28:31], a[36:39], v[72:75], v[28:31]
ds_read_b64_tr_b16 a[20:21], v9 offset:16384
v_mfma_f32_16x16x32_bf16 v[44:47], a[36:39], v[76:79], v[44:47]
ds_read_b64_tr_b16 a[22:23], v9 offset:18432
buffer_load_dwordx4 v[64:67], v6, s[12:15], s74 offen offset:1024 sc1
v_mfma_f32_16x16x32_bf16 v[32:35], a[40:43], v[72:75], v[32:35]
ds_read_b64_tr_b16 a[24:25], v10 offset:16384
buffer_load_dwordx4 v[68:71], v19, s[12:15], s74 offen offset:1024 sc1
v_mfma_f32_16x16x32_bf16 v[48:51], a[40:43], v[76:79], v[48:51]
ds_read_b64_tr_b16 a[26:27], v10 offset:18432
v_mfma_f32_16x16x32_bf16 v[36:39], a[44:47], v[72:75], v[36:39]
ds_read_b64_tr_b16 a[28:29], v11 offset:16384
s_add_u32 s74, s74, 2048
v_mfma_f32_16x16x32_bf16 v[52:55], a[44:47], v[76:79], v[52:55]
ds_read_b64_tr_b16 a[30:31], v11 offset:18432
s_waitcnt lgkmcnt(8)
v_mfma_f32_16x16x32_bf16 v[24:27], a[0:3], v[80:83], v[24:27]
ds_read_b64_tr_b16 a[32:33], v8 offset:20480
s_and_b32 s74, s74, 0x7fff
v_mfma_f32_16x16x32_bf16 v[40:43], a[0:3], v[84:87], v[40:43]
ds_read_b64_tr_b16 a[34:35], v8 offset:22528
s_waitcnt vmcnt(8)
v_mfma_f32_16x16x32_bf16 v[28:31], a[4:7], v[80:83], v[28:31]
ds_read_b64_tr_b16 a[36:37], v9 offset:20480
v_mfma_f32_16x16x32_bf16 v[44:47], a[4:7], v[84:87], v[44:47]
ds_read_b64_tr_b16 a[38:39], v9 offset:22528
v_max3_u32 v2, v88, v92, v96
v_mfma_f32_16x16x32_bf16 v[32:35], a[8:11], v[80:83], v[32:35]
ds_read_b64_tr_b16 a[40:41], v10 offset:20480
v_max_u32 v2, v2, v100
v_mfma_f32_16x16x32_bf16 v[48:51], a[8:11], v[84:87], v[48:51]
ds_read_b64_tr_b16 a[42:43], v10 offset:22528
v_mfma_f32_16x16x32_bf16 v[36:39], a[12:15], v[80:83], v[36:39]
ds_read_b64_tr_b16 a[44:45], v11 offset:20480
v_cmp_eq_u32 vcc, -1, v2
v_mfma_f32_16x16x32_bf16 v[52:55], a[12:15], v[84:87], v[52:55]
ds_read_b64_tr_b16 a[46:47], v11 offset:22528
s_cbranch_vccnz L_o2_rt
L_o2_ok:
s_waitcnt lgkmcnt(8)
v_mfma_f32_16x16x32_bf16 v[24:27], a[16:19], v[88:91], v[24:27]
ds_read_b64_tr_b16 a[0:1], v8 offset:24576
buffer_load_dwordx4 v[72:75], v6, s[12:15], s74 offen offset:0 sc1
v_mfma_f32_16x16x32_bf16 v[40:43], a[16:19], v[92:95], v[40:43]
ds_read_b64_tr_b16 a[2:3], v8 offset:26624
buffer_load_dwordx4 v[76:79], v19, s[12:15], s74 offen offset:0 sc1
v_mfma_f32_16x16x32_bf16 v[28:31], a[20:23], v[88:91], v[28:31]
ds_read_b64_tr_b16 a[4:5], v9 offset:24576
v_mfma_f32_16x16x32_bf16 v[44:47], a[20:23], v[92:95], v[44:47]
ds_read_b64_tr_b16 a[6:7], v9 offset:26624
buffer_load_dwordx4 v[80:83], v6, s[12:15], s74 offen offset:1024 sc1
v_mfma_f32_16x16x32_bf16 v[32:35], a[24:27], v[88:91], v[32:35]
ds_read_b64_tr_b16 a[8:9], v10 offset:24576
buffer_load_dwordx4 v[84:87], v19, s[12:15], s74 offen offset:1024 sc1
v_mfma_f32_16x16x32_bf16 v[48:51], a[24:27], v[92:95], v[48:51]
ds_read_b64_tr_b16 a[10:11], v10 offset:26624
v_mfma_f32_16x16x32_bf16 v[36:39], a[28:31], v[88:91], v[36:39]
ds_read_b64_tr_b16 a[12:13], v11 offset:24576
s_add_u32 s74, s74, 2048
v_mfma_f32_16x16x32_bf16 v[52:55], a[28:31], v[92:95], v[52:55]
ds_read_b64_tr_b16 a[14:15], v11 offset:26624
s_waitcnt lgkmcnt(8)
v_mfma_f32_16x16x32_bf16 v[24:27], a[32:35], v[96:99], v[24:27]
ds_read_b64_tr_b16 a[16:17], v8 offset:28672
s_and_b32 s74, s74, 0x7fff
v_mfma_f32_16x16x32_bf16 v[40:43], a[32:35], v[100:103], v[40:43]
ds_read_b64_tr_b16 a[18:19], v8 offset:30720
s_waitcnt vmcnt(8)
v_mfma_f32_16x16x32_bf16 v[28:31], a[36:39], v[96:99], v[28:31]
ds_read_b64_tr_b16 a[20:21], v9 offset:28672
v_mfma_f32_16x16x32_bf16 v[44:47], a[36:39], v[100:103], v[44:47]
ds_read_b64_tr_b16 a[22:23], v9 offset:30720
v_max3_u32 v2, v104, v108, v112
v_mfma_f32_16x16x32_bf16 v[32:35], a[40:43], v[96:99], v[32:35]
ds_read_b64_tr_b16 a[24:25], v10 offset:28672
v_max_u32 v2, v2, v116
v_mfma_f32_16x16x32_bf16 v[48:51], a[40:43], v[100:103], v[48:51]
ds_read_b64_tr_b16 a[26:27], v10 offset:30720
v_mfma_f32_16x16x32_bf16 v[36:39], a[44:47], v[96:99], v[36:39]
ds_read_b64_tr_b16 a[28:29], v11 offset:28672
v_cmp_eq_u32 vcc, -1, v2
v_mfma_f32_16x16x32_bf16 v[52:55], a[44:47], v[100:103], v[52:55]
ds_read_b64_tr_b16 a[30:31], v11 offset:30720
s_cbranch_vccnz L_o3_rt
L_o3_ok:
s_waitcnt lgkmcnt(8)
v_mfma_f32_16x16x32_bf16 v[24:27], a[0:3], v[104:107], v[24:27]
ds_read_b64_tr_b16 a[32:33], v8 offset:32768
buffer_load_dwordx4 v[88:91], v6, s[12:15], s74 offen offset:0 sc1
v_mfma_f32_16x16x32_bf16 v[40:43], a[0:3], v[108:111], v[40:43]
ds_read_b64_tr_b16 a[34:35], v8 offset:34816
buffer_load_dwordx4 v[92:95], v19, s[12:15], s74 offen offset:0 sc1
v_mfma_f32_16x16x32_bf16 v[28:31], a[4:7], v[104:107], v[28:31]
ds_read_b64_tr_b16 a[36:37], v9 offset:32768
v_mfma_f32_16x16x32_bf16 v[44:47], a[4:7], v[108:111], v[44:47]
ds_read_b64_tr_b16 a[38:39], v9 offset:34816
buffer_load_dwordx4 v[96:99], v6, s[12:15], s74 offen offset:1024 sc1
v_mfma_f32_16x16x32_bf16 v[32:35], a[8:11], v[104:107], v[32:35]
ds_read_b64_tr_b16 a[40:41], v10 offset:32768
buffer_load_dwordx4 v[100:103], v19, s[12:15], s74 offen offset:1024 sc1
v_mfma_f32_16x16x32_bf16 v[48:51], a[8:11], v[108:111], v[48:51]
ds_read_b64_tr_b16 a[42:43], v10 offset:34816
v_mfma_f32_16x16x32_bf16 v[36:39], a[12:15], v[104:107], v[36:39]
ds_read_b64_tr_b16 a[44:45], v11 offset:32768
s_add_u32 s74, s74, 2048
v_mfma_f32_16x16x32_bf16 v[52:55], a[12:15], v[108:111], v[52:55]
ds_read_b64_tr_b16 a[46:47], v11 offset:34816
s_waitcnt lgkmcnt(8)
v_mfma_f32_16x16x32_bf16 v[24:27], a[16:19], v[112:115], v[24:27]
ds_read_b64_tr_b16 a[0:1], v8 offset:36864
s_and_b32 s74, s74, 0x7fff
v_mfma_f32_16x16x32_bf16 v[40:43], a[16:19], v[116:119], v[40:43]
ds_read_b64_tr_b16 a[2:3], v8 offset:38912
s_waitcnt vmcnt(8)
v_mfma_f32_16x16x32_bf16 v[28:31], a[20:23], v[112:115], v[28:31]
ds_read_b64_tr_b16 a[4:5], v9 offset:36864
v_mfma_f32_16x16x32_bf16 v[44:47], a[20:23], v[116:119], v[44:47]
ds_read_b64_tr_b16 a[6:7], v9 offset:38912
v_max3_u32 v2, v56, v60, v64
v_mfma_f32_16x16x32_bf16 v[32:35], a[24:27], v[112:115], v[32:35]
ds_read_b64_tr_b16 a[8:9], v10 offset:36864
v_max_u32 v2, v2, v68
v_mfma_f32_16x16x32_bf16 v[48:51], a[24:27], v[116:119], v[48:51]
ds_read_b64_tr_b16 a[10:11], v10 offset:38912
v_mfma_f32_16x16x32_bf16 v[36:39], a[28:31], v[112:115], v[36:39]
ds_read_b64_tr_b16 a[12:13], v11 offset:36864
v_cmp_eq_u32 vcc, -1, v2
v_mfma_f32_16x16x32_bf16 v[52:55], a[28:31], v[116:119], v[52:55]
ds_read_b64_tr_b16 a[14:15], v11 offset:38912
s_cbranch_vccnz L_o4_rt
L_o4_ok:
s_waitcnt lgkmcnt(8)
v_mfma_f32_16x16x32_bf16 v[24:27], a[32:35], v[56:59], v[24:27]
ds_read_b64_tr_b16 a[16:17], v8 offset:40960
buffer_load_dwordx4 v[104:107], v6, s[12:15], s74 offen offset:0 sc1
v_mfma_f32_16x16x32_bf16 v[40:43], a[32:35], v[60:63], v[40:43]
ds_read_b64_tr_b16 a[18:19], v8 offset:43008
buffer_load_dwordx4 v[108:111], v19, s[12:15], s74 offen offset:0 sc1
v_mfma_f32_16x16x32_bf16 v[28:31], a[36:39], v[56:59], v[28:31]
ds_read_b64_tr_b16 a[20:21], v9 offset:40960
v_mfma_f32_16x16x32_bf16 v[44:47], a[36:39], v[60:63], v[44:47]
ds_read_b64_tr_b16 a[22:23], v9 offset:43008
buffer_load_dwordx4 v[112:115], v6, s[12:15], s74 offen offset:1024 sc1
v_mfma_f32_16x16x32_bf16 v[32:35], a[40:43], v[56:59], v[32:35]
ds_read_b64_tr_b16 a[24:25], v10 offset:40960
buffer_load_dwordx4 v[116:119], v19, s[12:15], s74 offen offset:1024 sc1
v_mfma_f32_16x16x32_bf16 v[48:51], a[40:43], v[60:63], v[48:51]
ds_read_b64_tr_b16 a[26:27], v10 offset:43008
v_mfma_f32_16x16x32_bf16 v[36:39], a[44:47], v[56:59], v[36:39]
ds_read_b64_tr_b16 a[28:29], v11 offset:40960
s_add_u32 s74, s74, 2048
v_mfma_f32_16x16x32_bf16 v[52:55], a[44:47], v[60:63], v[52:55]
ds_read_b64_tr_b16 a[30:31], v11 offset:43008
s_waitcnt lgkmcnt(8)
v_mfma_f32_16x16x32_bf16 v[24:27], a[0:3], v[64:67], v[24:27]
ds_read_b64_tr_b16 a[32:33], v8 offset:45056
s_and_b32 s74, s74, 0x7fff
v_mfma_f32_16x16x32_bf16 v[40:43], a[0:3], v[68:71], v[40:43]
ds_read_b64_tr_b16 a[34:35], v8 offset:47104
s_waitcnt vmcnt(8)
v_mfma_f32_16x16x32_bf16 v[28:31], a[4:7], v[64:67], v[28:31]
ds_read_b64_tr_b16 a[36:37], v9 offset:45056
v_mfma_f32_16x16x32_bf16 v[44:47], a[4:7], v[68:71], v[44:47]
ds_read_b64_tr_b16 a[38:39], v9 offset:47104
v_max3_u32 v2, v72, v76, v80
v_mfma_f32_16x16x32_bf16 v[32:35], a[8:11], v[64:67], v[32:35]
ds_read_b64_tr_b16 a[40:41], v10 offset:45056
v_max_u32 v2, v2, v84
v_mfma_f32_16x16x32_bf16 v[48:51], a[8:11], v[68:71], v[48:51]
ds_read_b64_tr_b16 a[42:43], v10 offset:47104
v_mfma_f32_16x16x32_bf16 v[36:39], a[12:15], v[64:67], v[36:39]
ds_read_b64_tr_b16 a[44:45], v11 offset:45056
v_cmp_eq_u32 vcc, -1, v2
v_mfma_f32_16x16x32_bf16 v[52:55], a[12:15], v[68:71], v[52:55]
ds_read_b64_tr_b16 a[46:47], v11 offset:47104
s_cbranch_vccnz L_o5_rt
L_o5_ok:
s_waitcnt lgkmcnt(8)
v_mfma_f32_16x16x32_bf16 v[24:27], a[16:19], v[72:75], v[24:27]
ds_read_b64_tr_b16 a[0:1], v8 offset:49152
buffer_load_dwordx4 v[56:59], v6, s[12:15], s74 offen offset:0 sc1
v_mfma_f32_16x16x32_bf16 v[40:43], a[16:19], v[76:79], v[40:43]
ds_read_b64_tr_b16 a[2:3], v8 offset:51200
buffer_load_dwordx4 v[60:63], v19, s[12:15], s74 offen offset:0 sc1
v_mfma_f32_16x16x32_bf16 v[28:31], a[20:23], v[72:75], v[28:31]
ds_read_b64_tr_b16 a[4:5], v9 offset:49152
v_mfma_f32_16x16x32_bf16 v[44:47], a[20:23], v[76:79], v[44:47]
ds_read_b64_tr_b16 a[6:7], v9 offset:51200
buffer_load_dwordx4 v[64:67], v6, s[12:15], s74 offen offset:1024 sc1
v_mfma_f32_16x16x32_bf16 v[32:35], a[24:27], v[72:75], v[32:35]
ds_read_b64_tr_b16 a[8:9], v10 offset:49152
buffer_load_dwordx4 v[68:71], v19, s[12:15], s74 offen offset:1024 sc1
v_mfma_f32_16x16x32_bf16 v[48:51], a[24:27], v[76:79], v[48:51]
ds_read_b64_tr_b16 a[10:11], v10 offset:51200
v_mfma_f32_16x16x32_bf16 v[36:39], a[28:31], v[72:75], v[36:39]
ds_read_b64_tr_b16 a[12:13], v11 offset:49152
s_add_u32 s74, s74, 2048
v_mfma_f32_16x16x32_bf16 v[52:55], a[28:31], v[76:79], v[52:55]
ds_read_b64_tr_b16 a[14:15], v11 offset:51200
s_waitcnt lgkmcnt(8)
v_mfma_f32_16x16x32_bf16 v[24:27], a[32:35], v[80:83], v[24:27]
ds_read_b64_tr_b16 a[16:17], v8 offset:53248
s_and_b32 s74, s74, 0x7fff
v_mfma_f32_16x16x32_bf16 v[40:43], a[32:35], v[84:87], v[40:43]
ds_read_b64_tr_b16 a[18:19], v8 offset:55296
s_waitcnt vmcnt(8)
v_mfma_f32_16x16x32_bf16 v[28:31], a[36:39], v[80:83], v[28:31]
ds_read_b64_tr_b16 a[20:21], v9 offset:53248
v_mfma_f32_16x16x32_bf16 v[44:47], a[36:39], v[84:87], v[44:47]
ds_read_b64_tr_b16 a[22:23], v9 offset:55296
v_max3_u32 v2, v88, v92, v96
v_mfma_f32_16x16x32_bf16 v[32:35], a[40:43], v[80:83], v[32:35]
ds_read_b64_tr_b16 a[24:25], v10 offset:53248
v_max_u32 v2, v2, v100
v_mfma_f32_16x16x32_bf16 v[48:51], a[40:43], v[84:87], v[48:51]
ds_read_b64_tr_b16 a[26:27], v10 offset:55296
v_mfma_f32_16x16x32_bf16 v[36:39], a[44:47], v[80:83], v[36:39]
ds_read_b64_tr_b16 a[28:29], v11 offset:53248
v_cmp_eq_u32 vcc, -1, v2
v_mfma_f32_16x16x32_bf16 v[52:55], a[44:47], v[84:87], v[52:55]
ds_read_b64_tr_b16 a[30:31], v11 offset:55296
s_cbranch_vccnz L_o6_rt
L_o6_ok:
s_waitcnt lgkmcnt(8)
v_mfma_f32_16x16x32_bf16 v[24:27], a[0:3], v[88:91], v[24:27]
ds_read_b64_tr_b16 a[32:33], v8 offset:57344
buffer_load_dwordx4 v[72:75], v6, s[12:15], s74 offen offset:0 sc1
v_mfma_f32_16x16x32_bf16 v[40:43], a[0:3], v[92:95], v[40:43]
ds_read_b64_tr_b16 a[34:35], v8 offset:59392
buffer_load_dwordx4 v[76:79], v19, s[12:15], s74 offen offset:0 sc1
v_mfma_f32_16x16x32_bf16 v[28:31], a[4:7], v[88:91], v[28:31]
ds_read_b64_tr_b16 a[36:37], v9 offset:57344
v_mfma_f32_16x16x32_bf16 v[44:47], a[4:7], v[92:95], v[44:47]
ds_read_b64_tr_b16 a[38:39], v9 offset:59392
buffer_load_dwordx4 v[80:83], v6, s[12:15], s74 offen offset:1024 sc1
v_mfma_f32_16x16x32_bf16 v[32:35], a[8:11], v[88:91], v[32:35]
ds_read_b64_tr_b16 a[40:41], v10 offset:57344
buffer_load_dwordx4 v[84:87], v19, s[12:15], s74 offen offset:1024 sc1
v_mfma_f32_16x16x32_bf16 v[48:51], a[8:11], v[92:95], v[48:51]
ds_read_b64_tr_b16 a[42:43], v10 offset:59392
v_mfma_f32_16x16x32_bf16 v[36:39], a[12:15], v[88:91], v[36:39]
ds_read_b64_tr_b16 a[44:45], v11 offset:57344
s_add_u32 s74, s74, 2048
v_mfma_f32_16x16x32_bf16 v[52:55], a[12:15], v[92:95], v[52:55]
ds_read_b64_tr_b16 a[46:47], v11 offset:59392
s_waitcnt lgkmcnt(8)
v_mfma_f32_16x16x32_bf16 v[24:27], a[16:19], v[96:99], v[24:27]
ds_read_b64_tr_b16 a[0:1], v8 offset:61440
s_and_b32 s74, s74, 0x7fff
v_mfma_f32_16x16x32_bf16 v[40:43], a[16:19], v[100:103], v[40:43]
ds_read_b64_tr_b16 a[2:3], v8 offset:63488
s_waitcnt vmcnt(8)
v_mfma_f32_16x16x32_bf16 v[28:31], a[20:23], v[96:99], v[28:31]
ds_read_b64_tr_b16 a[4:5], v9 offset:61440
v_mfma_f32_16x16x32_bf16 v[44:47], a[20:23], v[100:103], v[44:47]
ds_read_b64_tr_b16 a[6:7], v9 offset:63488
v_max3_u32 v2, v104, v108, v112
v_mfma_f32_16x16x32_bf16 v[32:35], a[24:27], v[96:99], v[32:35]
ds_read_b64_tr_b16 a[8:9], v10 offset:61440
v_max_u32 v2, v2, v116
v_mfma_f32_16x16x32_bf16 v[48:51], a[24:27], v[100:103], v[48:51]
ds_read_b64_tr_b16 a[10:11], v10 offset:63488
v_mfma_f32_16x16x32_bf16 v[36:39], a[28:31], v[96:99], v[36:39]
ds_read_b64_tr_b16 a[12:13], v11 offset:61440
v_cmp_eq_u32 vcc, -1, v2
v_mfma_f32_16x16x32_bf16 v[52:55], a[28:31], v[100:103], v[52:55]
ds_read_b64_tr_b16 a[14:15], v11 offset:63488
s_cbranch_vccnz L_o7_rt
L_o7_ok:
s_waitcnt lgkmcnt(8)
v_mfma_f32_16x16x32_bf16 v[24:27], a[32:35], v[104:107], v[24:27]
ds_read_b64_tr_b16 a[16:17], v12 offset:0
buffer_load_dwordx4 v[88:91], v6, s[12:15], s74 offen offset:0 sc1
v_mfma_f32_16x16x32_bf16 v[40:43], a[32:35], v[108:111], v[40:43]
ds_read_b64_tr_b16 a[18:19], v12 offset:2048
buffer_load_dwordx4 v[92:95], v19, s[12:15], s74 offen offset:0 sc1
v_mfma_f32_16x16x32_bf16 v[28:31], a[36:39], v[104:107], v[28:31]
ds_read_b64_tr_b16 a[20:21], v13 offset:0
v_mfma_f32_16x16x32_bf16 v[44:47], a[36:39], v[108:111], v[44:47]
ds_read_b64_tr_b16 a[22:23], v13 offset:2048
buffer_load_dwordx4 v[96:99], v6, s[12:15], s74 offen offset:1024 sc1
v_mfma_f32_16x16x32_bf16 v[32:35], a[40:43], v[104:107], v[32:35]
ds_read_b64_tr_b16 a[24:25], v14 offset:0
buffer_load_dwordx4 v[100:103], v19, s[12:15], s74 offen offset:1024 sc1
v_mfma_f32_16x16x32_bf16 v[48:51], a[40:43], v[108:111], v[48:51]
ds_read_b64_tr_b16 a[26:27], v14 offset:2048
v_mfma_f32_16x16x32_bf16 v[36:39], a[44:47], v[104:107], v[36:39]
ds_read_b64_tr_b16 a[28:29], v15 offset:0
s_add_u32 s74, s74, 2048
v_mfma_f32_16x16x32_bf16 v[52:55], a[44:47], v[108:111], v[52:55]
ds_read_b64_tr_b16 a[30:31], v15 offset:2048
s_waitcnt lgkmcnt(8)
v_mfma_f32_16x16x32_bf16 v[24:27], a[0:3], v[112:115], v[24:27]
ds_read_b64_tr_b16 a[32:33], v12 offset:4096
s_and_b32 s74, s74, 0x7fff
v_mfma_f32_16x16x32_bf16 v[40:43], a[0:3], v[116:119], v[40:43]
ds_read_b64_tr_b16 a[34:35], v12 offset:6144
s_waitcnt vmcnt(8)
v_mfma_f32_16x16x32_bf16 v[28:31], a[4:7], v[112:115], v[28:31]
ds_read_b64_tr_b16 a[36:37], v13 offset:4096
v_mfma_f32_16x16x32_bf16 v[44:47], a[4:7], v[116:119], v[44:47]
ds_read_b64_tr_b16 a[38:39], v13 offset:6144
v_max3_u32 v2, v56, v60, v64
v_mfma_f32_16x16x32_bf16 v[32:35], a[8:11], v[112:115], v[32:35]
ds_read_b64_tr_b16 a[40:41], v14 offset:4096
v_max_u32 v2, v2, v68
v_mfma_f32_16x16x32_bf16 v[48:51], a[8:11], v[116:119], v[48:51]
ds_read_b64_tr_b16 a[42:43], v14 offset:6144
v_mfma_f32_16x16x32_bf16 v[36:39], a[12:15], v[112:115], v[36:39]
ds_read_b64_tr_b16 a[44:45], v15 offset:4096
v_cmp_eq_u32 vcc, -1, v2
v_mfma_f32_16x16x32_bf16 v[52:55], a[12:15], v[116:119], v[52:55]
ds_read_b64_tr_b16 a[46:47], v15 offset:6144
s_cbranch_vccnz L_o8_rt
L_o8_ok:
s_waitcnt lgkmcnt(8)
v_mfma_f32_16x16x32_bf16 v[24:27], a[16:19], v[56:59], v[24:27]
ds_read_b64_tr_b16 a[0:1], v12 offset:8192
buffer_load_dwordx4 v[104:107], v6, s[12:15], s74 offen offset:0 sc1
v_mfma_f32_16x16x32_bf16 v[40:43], a[16:19], v[60:63], v[40:43]
ds_read_b64_tr_b16 a[2:3], v12 offset:10240
buffer_load_dwordx4 v[108:111], v19, s[12:15], s74 offen offset:0 sc1
v_mfma_f32_16x16x32_bf16 v[28:31], a[20:23], v[56:59], v[28:31]
ds_read_b64_tr_b16 a[4:5], v13 offset:8192
v_mfma_f32_16x16x32_bf16 v[44:47], a[20:23], v[60:63], v[44:47]
ds_read_b64_tr_b16 a[6:7], v13 offset:10240
buffer_load_dwordx4 v[112:115], v6, s[12:15], s74 offen offset:1024 sc1
v_mfma_f32_16x16x32_bf16 v[32:35], a[24:27], v[56:59], v[32:35]
ds_read_b64_tr_b16 a[8:9], v14 offset:8192
buffer_load_dwordx4 v[116:119], v19, s[12:15], s74 offen offset:1024 sc1
v_mfma_f32_16x16x32_bf16 v[48:51], a[24:27], v[60:63], v[48:51]
ds_read_b64_tr_b16 a[10:11], v14 offset:10240
v_mfma_f32_16x16x32_bf16 v[36:39], a[28:31], v[56:59], v[36:39]
ds_read_b64_tr_b16 a[12:13], v15 offset:8192
s_add_u32 s74, s74, 2048
v_mfma_f32_16x16x32_bf16 v[52:55], a[28:31], v[60:63], v[52:55]
ds_read_b64_tr_b16 a[14:15], v15 offset:10240
s_waitcnt lgkmcnt(8)
v_mfma_f32_16x16x32_bf16 v[24:27], a[32:35], v[64:67], v[24:27]
ds_read_b64_tr_b16 a[16:17], v12 offset:12288
s_and_b32 s74, s74, 0x7fff
v_mfma_f32_16x16x32_bf16 v[40:43], a[32:35], v[68:71], v[40:43]
ds_read_b64_tr_b16 a[18:19], v12 offset:14336
s_waitcnt vmcnt(8)
v_mfma_f32_16x16x32_bf16 v[28:31], a[36:39], v[64:67], v[28:31]
ds_read_b64_tr_b16 a[20:21], v13 offset:12288
v_mfma_f32_16x16x32_bf16 v[44:47], a[36:39], v[68:71], v[44:47]
ds_read_b64_tr_b16 a[22:23], v13 offset:14336
v_max3_u32 v2, v72, v76, v80
v_mfma_f32_16x16x32_bf16 v[32:35], a[40:43], v[64:67], v[32:35]
ds_read_b64_tr_b16 a[24:25], v14 offset:12288
v_max_u32 v2, v2, v84
v_mfma_f32_16x16x32_bf16 v[48:51], a[40:43], v[68:71], v[48:51]
ds_read_b64_tr_b16 a[26:27], v14 offset:14336
v_mfma_f32_16x16x32_bf16 v[36:39], a[44:47], v[64:67], v[36:39]
ds_read_b64_tr_b16 a[28:29], v15 offset:12288
v_cmp_eq_u32 vcc, -1, v2
v_mfma_f32_16x16x32_bf16 v[52:55], a[44:47], v[68:71], v[52:55]
ds_read_b64_tr_b16 a[30:31], v15 offset:14336
s_cbranch_vccnz L_o9_rt
L_o9_ok:
s_waitcnt lgkmcnt(8)
v_mfma_f32_16x16x32_bf16 v[24:27], a[0:3], v[72:75], v[24:27]
ds_read_b64_tr_b16 a[32:33], v12 offset:16384
buffer_load_dwordx4 v[56:59], v6, s[12:15], s74 offen offset:0 sc1
v_mfma_f32_16x16x32_bf16 v[40:43], a[0:3], v[76:79], v[40:43]
ds_read_b64_tr_b16 a[34:35], v12 offset:18432
buffer_load_dwordx4 v[60:63], v19, s[12:15], s74 offen offset:0 sc1
v_mfma_f32_16x16x32_bf16 v[28:31], a[4:7], v[72:75], v[28:31]
ds_read_b64_tr_b16 a[36:37], v13 offset:16384
v_mfma_f32_16x16x32_bf16 v[44:47], a[4:7], v[76:79], v[44:47]
ds_read_b64_tr_b16 a[38:39], v13 offset:18432
buffer_load_dwordx4 v[64:67], v6, s[12:15], s74 offen offset:1024 sc1
v_mfma_f32_16x16x32_bf16 v[32:35], a[8:11], v[72:75], v[32:35]
ds_read_b64_tr_b16 a[40:41], v14 offset:16384
buffer_load_dwordx4 v[68:71], v19, s[12:15], s74 offen offset:1024 sc1
v_mfma_f32_16x16x32_bf16 v[48:51], a[8:11], v[76:79], v[48:51]
ds_read_b64_tr_b16 a[42:43], v14 offset:18432
v_mfma_f32_16x16x32_bf16 v[36:39], a[12:15], v[72:75], v[36:39]
ds_read_b64_tr_b16 a[44:45], v15 offset:16384
s_add_u32 s74, s74, 2048
v_mfma_f32_16x16x32_bf16 v[52:55], a[12:15], v[76:79], v[52:55]
ds_read_b64_tr_b16 a[46:47], v15 offset:18432
s_waitcnt lgkmcnt(8)
v_mfma_f32_16x16x32_bf16 v[24:27], a[16:19], v[80:83], v[24:27]
ds_read_b64_tr_b16 a[0:1], v12 offset:20480
s_and_b32 s74, s74, 0x7fff
v_mfma_f32_16x16x32_bf16 v[40:43], a[16:19], v[84:87], v[40:43]
ds_read_b64_tr_b16 a[2:3], v12 offset:22528
s_waitcnt vmcnt(8)
v_mfma_f32_16x16x32_bf16 v[28:31], a[20:23], v[80:83], v[28:31]
ds_read_b64_tr_b16 a[4:5], v13 offset:20480
v_mfma_f32_16x16x32_bf16 v[44:47], a[20:23], v[84:87], v[44:47]
ds_read_b64_tr_b16 a[6:7], v13 offset:22528
v_max3_u32 v2, v88, v92, v96
v_mfma_f32_16x16x32_bf16 v[32:35], a[24:27], v[80:83], v[32:35]
ds_read_b64_tr_b16 a[8:9], v14 offset:20480
v_max_u32 v2, v2, v100
v_mfma_f32_16x16x32_bf16 v[48:51], a[24:27], v[84:87], v[48:51]
ds_read_b64_tr_b16 a[10:11], v14 offset:22528
v_mfma_f32_16x16x32_bf16 v[36:39], a[28:31], v[80:83], v[36:39]
ds_read_b64_tr_b16 a[12:13], v15 offset:20480
v_cmp_eq_u32 vcc, -1, v2
v_mfma_f32_16x16x32_bf16 v[52:55], a[28:31], v[84:87], v[52:55]
ds_read_b64_tr_b16 a[14:15], v15 offset:22528
s_cbranch_vccnz L_o10_rt
L_o10_ok:
s_waitcnt lgkmcnt(8)
v_mfma_f32_16x16x32_bf16 v[24:27], a[32:35], v[88:91], v[24:27]
ds_read_b64_tr_b16 a[16:17], v12 offset:24576
buffer_load_dwordx4 v[72:75], v6, s[12:15], s74 offen offset:0 sc1
v_mfma_f32_16x16x32_bf16 v[40:43], a[32:35], v[92:95], v[40:43]
ds_read_b64_tr_b16 a[18:19], v12 offset:26624
buffer_load_dwordx4 v[76:79], v19, s[12:15], s74 offen offset:0 sc1
v_mfma_f32_16x16x32_bf16 v[28:31], a[36:39], v[88:91], v[28:31]
ds_read_b64_tr_b16 a[20:21], v13 offset:24576
v_mfma_f32_16x16x32_bf16 v[44:47], a[36:39], v[92:95], v[44:47]
ds_read_b64_tr_b16 a[22:23], v13 offset:26624
buffer_load_dwordx4 v[80:83], v6, s[12:15], s74 offen offset:1024 sc1
v_mfma_f32_16x16x32_bf16 v[32:35], a[40:43], v[88:91], v[32:35]
ds_read_b64_tr_b16 a[24:25], v14 offset:24576
buffer_load_dwordx4 v[84:87], v19, s[12:15], s74 offen offset:1024 sc1
v_mfma_f32_16x16x32_bf16 v[48:51], a[40:43], v[92:95], v[48:51]
ds_read_b64_tr_b16 a[26:27], v14 offset:26624
v_mfma_f32_16x16x32_bf16 v[36:39], a[44:47], v[88:91], v[36:39]
ds_read_b64_tr_b16 a[28:29], v15 offset:24576
s_add_u32 s74, s74, 2048
v_mfma_f32_16x16x32_bf16 v[52:55], a[44:47], v[92:95], v[52:55]
ds_read_b64_tr_b16 a[30:31], v15 offset:26624
s_waitcnt lgkmcnt(8)
v_mfma_f32_16x16x32_bf16 v[24:27], a[0:3], v[96:99], v[24:27]
ds_read_b64_tr_b16 a[32:33], v12 offset:28672
s_and_b32 s74, s74, 0x7fff
v_mfma_f32_16x16x32_bf16 v[40:43], a[0:3], v[100:103], v[40:43]
ds_read_b64_tr_b16 a[34:35], v12 offset:30720
s_waitcnt vmcnt(8)
v_mfma_f32_16x16x32_bf16 v[28:31], a[4:7], v[96:99], v[28:31]
ds_read_b64_tr_b16 a[36:37], v13 offset:28672
v_mfma_f32_16x16x32_bf16 v[44:47], a[4:7], v[100:103], v[44:47]
ds_read_b64_tr_b16 a[38:39], v13 offset:30720
v_max3_u32 v2, v104, v108, v112
v_mfma_f32_16x16x32_bf16 v[32:35], a[8:11], v[96:99], v[32:35]
ds_read_b64_tr_b16 a[40:41], v14 offset:28672
v_max_u32 v2, v2, v116
v_mfma_f32_16x16x32_bf16 v[48:51], a[8:11], v[100:103], v[48:51]
ds_read_b64_tr_b16 a[42:43], v14 offset:30720
v_mfma_f32_16x16x32_bf16 v[36:39], a[12:15], v[96:99], v[36:39]
ds_read_b64_tr_b16 a[44:45], v15 offset:28672
v_cmp_eq_u32 vcc, -1, v2
v_mfma_f32_16x16x32_bf16 v[52:55], a[12:15], v[100:103], v[52:55]
ds_read_b64_tr_b16 a[46:47], v15 offset:30720
s_cbranch_vccnz L_o11_rt
L_o11_ok:
s_waitcnt lgkmcnt(8)
v_mfma_f32_16x16x32_bf16 v[24:27], a[16:19], v[104:107], v[24:27]
ds_read_b64_tr_b16 a[0:1], v12 offset:32768
buffer_load_dwordx4 v[88:91], v6, s[12:15], s74 offen offset:0 sc1
v_mfma_f32_16x16x32_bf16 v[40:43], a[16:19], v[108:111], v[40:43]
ds_read_b64_tr_b16 a[2:3], v12 offset:34816
buffer_load_dwordx4 v[92:95], v19, s[12:15], s74 offen offset:0 sc1
v_mfma_f32_16x16x32_bf16 v[28:31], a[20:23], v[104:107], v[28:31]
ds_read_b64_tr_b16 a[4:5], v13 offset:32768
v_mfma_f32_16x16x32_bf16 v[44:47], a[20:23], v[108:111], v[44:47]
ds_read_b64_tr_b16 a[6:7], v13 offset:34816
buffer_load_dwordx4 v[96:99], v6, s[12:15], s74 offen offset:1024 sc1
v_mfma_f32_16x16x32_bf16 v[32:35], a[24:27], v[104:107], v[32:35]
ds_read_b64_tr_b16 a[8:9], v14 offset:32768
buffer_load_dwordx4 v[100:103], v19, s[12:15], s74 offen offset:1024 sc1
v_mfma_f32_16x16x32_bf16 v[48:51], a[24:27], v[108:111], v[48:51]
ds_read_b64_tr_b16 a[10:11], v14 offset:34816
v_mfma_f32_16x16x32_bf16 v[36:39], a[28:31], v[104:107], v[36:39]
ds_read_b64_tr_b16 a[12:13], v15 offset:32768
s_add_u32 s74, s74, 2048
v_mfma_f32_16x16x32_bf16 v[52:55], a[28:31], v[108:111], v[52:55]
ds_read_b64_tr_b16 a[14:15], v15 offset:34816
s_waitcnt lgkmcnt(8)
v_mfma_f32_16x16x32_bf16 v[24:27], a[32:35], v[112:115], v[24:27]
ds_read_b64_tr_b16 a[16:17], v12 offset:36864
s_and_b32 s74, s74, 0x7fff
v_mfma_f32_16x16x32_bf16 v[40:43], a[32:35], v[116:119], v[40:43]
ds_read_b64_tr_b16 a[18:19], v12 offset:38912
s_waitcnt vmcnt(8)
v_mfma_f32_16x16x32_bf16 v[28:31], a[36:39], v[112:115], v[28:31]
ds_read_b64_tr_b16 a[20:21], v13 offset:36864
v_mfma_f32_16x16x32_bf16 v[44:47], a[36:39], v[116:119], v[44:47]
ds_read_b64_tr_b16 a[22:23], v13 offset:38912
v_max3_u32 v2, v56, v60, v64
v_mfma_f32_16x16x32_bf16 v[32:35], a[40:43], v[112:115], v[32:35]
ds_read_b64_tr_b16 a[24:25], v14 offset:36864
v_max_u32 v2, v2, v68
v_mfma_f32_16x16x32_bf16 v[48:51], a[40:43], v[116:119], v[48:51]
ds_read_b64_tr_b16 a[26:27], v14 offset:38912
v_mfma_f32_16x16x32_bf16 v[36:39], a[44:47], v[112:115], v[36:39]
ds_read_b64_tr_b16 a[28:29], v15 offset:36864
v_cmp_eq_u32 vcc, -1, v2
v_mfma_f32_16x16x32_bf16 v[52:55], a[44:47], v[116:119], v[52:55]
ds_read_b64_tr_b16 a[30:31], v15 offset:38912
s_cbranch_vccnz L_o12_rt
L_o12_ok:
s_waitcnt lgkmcnt(8)
v_mfma_f32_16x16x32_bf16 v[24:27], a[0:3], v[56:59], v[24:27]
ds_read_b64_tr_b16 a[32:33], v12 offset:40960
buffer_load_dwordx4 v[104:107], v6, s[12:15], s74 offen offset:0 sc1
v_mfma_f32_16x16x32_bf16 v[40:43], a[0:3], v[60:63], v[40:43]
ds_read_b64_tr_b16 a[34:35], v12 offset:43008
v_mfma_f32_16x16x32_bf16 v[28:31], a[4:7], v[56:59], v[28:31]
ds_read_b64_tr_b16 a[36:37], v13 offset:40960
buffer_load_dwordx4 v[108:111], v19, s[12:15], s74 offen offset:0 sc1
v_mfma_f32_16x16x32_bf16 v[44:47], a[4:7], v[60:63], v[44:47]
ds_read_b64_tr_b16 a[38:39], v13 offset:43008
v_mfma_f32_16x16x32_bf16 v[32:35], a[8:11], v[56:59], v[32:35]
ds_read_b64_tr_b16 a[40:41], v14 offset:40960
buffer_load_dwordx4 v[112:115], v6, s[12:15], s74 offen offset:1024 sc1
v_mfma_f32_16x16x32_bf16 v[48:51], a[8:11], v[60:63], v[48:51]
ds_read_b64_tr_b16 a[42:43], v14 offset:43008
v_mfma_f32_16x16x32_bf16 v[36:39], a[12:15], v[56:59], v[36:39]
ds_read_b64_tr_b16 a[44:45], v15 offset:40960
buffer_load_dwordx4 v[116:119], v19, s[12:15], s74 offen offset:1024 sc1
v_mfma_f32_16x16x32_bf16 v[52:55], a[12:15], v[60:63], v[52:55]
ds_read_b64_tr_b16 a[46:47], v15 offset:43008
s_waitcnt lgkmcnt(8)
v_mfma_f32_16x16x32_bf16 v[24:27], a[16:19], v[64:67], v[24:27]
ds_read_b64_tr_b16 a[0:1], v12 offset:45056
s_waitcnt vmcnt(8)
v_mfma_f32_16x16x32_bf16 v[40:43], a[16:19], v[68:71], v[40:43]
ds_read_b64_tr_b16 a[2:3], v12 offset:47104
v_mfma_f32_16x16x32_bf16 v[28:31], a[20:23], v[64:67], v[28:31]
ds_read_b64_tr_b16 a[4:5], v13 offset:45056
v_max3_u32 v2, v72, v76, v80
v_mfma_f32_16x16x32_bf16 v[44:47], a[20:23], v[68:71], v[44:47]
ds_read_b64_tr_b16 a[6:7], v13 offset:47104
v_mfma_f32_16x16x32_bf16 v[32:35], a[24:27], v[64:67], v[32:35]
ds_read_b64_tr_b16 a[8:9], v14 offset:45056
v_max_u32 v2, v2, v84
v_mfma_f32_16x16x32_bf16 v[48:51], a[24:27], v[68:71], v[48:51]
ds_read_b64_tr_b16 a[10:11], v14 offset:47104
v_mfma_f32_16x16x32_bf16 v[36:39], a[28:31], v[64:67], v[36:39]
ds_read_b64_tr_b16 a[12:13], v15 offset:45056
v_cmp_eq_u32 vcc, -1, v2
v_mfma_f32_16x16x32_bf16 v[52:55], a[28:31], v[68:71], v[52:55]
ds_read_b64_tr_b16 a[14:15], v15 offset:47104
s_cbranch_vccnz L_o13_rt
L_o13_ok:
s_waitcnt lgkmcnt(8)
v_mfma_f32_16x16x32_bf16 v[24:27], a[32:35], v[72:75], v[24:27]
ds_read_b64_tr_b16 a[16:17], v12 offset:49152
s_waitcnt vmcnt(4)
v_mfma_f32_16x16x32_bf16 v[40:43], a[32:35], v[76:79], v[40:43]
ds_read_b64_tr_b16 a[18:19], v12 offset:51200
v_mfma_f32_16x16x32_bf16 v[28:31], a[36:39], v[72:75], v[28:31]
ds_read_b64_tr_b16 a[20:21], v13 offset:49152
v_mfma_f32_16x16x32_bf16 v[44:47], a[36:39], v[76:79], v[44:47]
ds_read_b64_tr_b16 a[22:23], v13 offset:51200
v_mfma_f32_16x16x32_bf16 v[32:35], a[40:43], v[72:75], v[32:35]
ds_read_b64_tr_b16 a[24:25], v14 offset:49152
v_max3_u32 v2, v88, v92, v96
v_mfma_f32_16x16x32_bf16 v[48:51], a[40:43], v[76:79], v[48:51]
ds_read_b64_tr_b16 a[26:27], v14 offset:51200
v_mfma_f32_16x16x32_bf16 v[36:39], a[44:47], v[72:75], v[36:39]
ds_read_b64_tr_b16 a[28:29], v15 offset:49152
v_mfma_f32_16x16x32_bf16 v[52:55], a[44:47], v[76:79], v[52:55]
ds_read_b64_tr_b16 a[30:31], v15 offset:51200
s_waitcnt lgkmcnt(8)
v_mfma_f32_16x16x32_bf16 v[24:27], a[0:3], v[80:83], v[24:27]
ds_read_b64_tr_b16 a[32:33], v12 offset:53248
v_max_u32 v2, v2, v100
v_mfma_f32_16x16x32_bf16 v[40:43], a[0:3], v[84:87], v[40:43]
ds_read_b64_tr_b16 a[34:35], v12 offset:55296
v_mfma_f32_16x16x32_bf16 v[28:31], a[4:7], v[80:83], v[28:31]
ds_read_b64_tr_b16 a[36:37], v13 offset:53248
v_mfma_f32_16x16x32_bf16 v[44:47], a[4:7], v[84:87], v[44:47]
ds_read_b64_tr_b16 a[38:39], v13 offset:55296
v_mfma_f32_16x16x32_bf16 v[32:35], a[8:11], v[80:83], v[32:35]
ds_read_b64_tr_b16 a[40:41], v14 offset:53248
v_cmp_eq_u32 vcc, -1, v2
v_mfma_f32_16x16x32_bf16 v[48:51], a[8:11], v[84:87], v[48:51]
ds_read_b64_tr_b16 a[42:43], v14 offset:55296
v_mfma_f32_16x16x32_bf16 v[36:39], a[12:15], v[80:83], v[36:39]
ds_read_b64_tr_b16 a[44:45], v15 offset:53248
v_mfma_f32_16x16x32_bf16 v[52:55], a[12:15], v[84:87], v[52:55]
ds_read_b64_tr_b16 a[46:47], v15 offset:55296
s_cbranch_vccnz L_o14_rt
L_o14_ok:
s_waitcnt lgkmcnt(8)
v_mfma_f32_16x16x32_bf16 v[24:27], a[16:19], v[88:91], v[24:27]
ds_read_b64_tr_b16 a[0:1], v12 offset:57344
s_waitcnt vmcnt(0)
v_mfma_f32_16x16x32_bf16 v[40:43], a[16:19], v[92:95], v[40:43]
ds_read_b64_tr_b16 a[2:3], v12 offset:59392
v_mfma_f32_16x16x32_bf16 v[28:31], a[20:23], v[88:91], v[28:31]
ds_read_b64_tr_b16 a[4:5], v13 offset:57344
v_mfma_f32_16x16x32_bf16 v[44:47], a[20:23], v[92:95], v[44:47]
ds_read_b64_tr_b16 a[6:7], v13 offset:59392
v_mfma_f32_16x16x32_bf16 v[32:35], a[24:27], v[88:91], v[32:35]
ds_read_b64_tr_b16 a[8:9], v14 offset:57344
v_max3_u32 v2, v104, v108, v112
v_mfma_f32_16x16x32_bf16 v[48:51], a[24:27], v[92:95], v[48:51]
ds_read_b64_tr_b16 a[10:11], v14 offset:59392
v_mfma_f32_16x16x32_bf16 v[36:39], a[28:31], v[88:91], v[36:39]
ds_read_b64_tr_b16 a[12:13], v15 offset:57344
v_mfma_f32_16x16x32_bf16 v[52:55], a[28:31], v[92:95], v[52:55]
ds_read_b64_tr_b16 a[14:15], v15 offset:59392
s_waitcnt lgkmcnt(8)
v_mfma_f32_16x16x32_bf16 v[24:27], a[32:35], v[96:99], v[24:27]
ds_read_b64_tr_b16 a[16:17], v12 offset:61440
v_max_u32 v2, v2, v116
v_mfma_f32_16x16x32_bf16 v[40:43], a[32:35], v[100:103], v[40:43]
ds_read_b64_tr_b16 a[18:19], v12 offset:63488
v_mfma_f32_16x16x32_bf16 v[28:31], a[36:39], v[96:99], v[28:31]
ds_read_b64_tr_b16 a[20:21], v13 offset:61440
v_mfma_f32_16x16x32_bf16 v[44:47], a[36:39], v[100:103], v[44:47]
ds_read_b64_tr_b16 a[22:23], v13 offset:63488
v_mfma_f32_16x16x32_bf16 v[32:35], a[40:43], v[96:99], v[32:35]
ds_read_b64_tr_b16 a[24:25], v14 offset:61440
v_cmp_eq_u32 vcc, -1, v2
v_mfma_f32_16x16x32_bf16 v[48:51], a[40:43], v[100:103], v[48:51]
ds_read_b64_tr_b16 a[26:27], v14 offset:63488
v_mfma_f32_16x16x32_bf16 v[36:39], a[44:47], v[96:99], v[36:39]
ds_read_b64_tr_b16 a[28:29], v15 offset:61440
v_mfma_f32_16x16x32_bf16 v[52:55], a[44:47], v[100:103], v[52:55]
ds_read_b64_tr_b16 a[30:31], v15 offset:63488
s_cbranch_vccnz L_o15_rt
L_o15_ok:
s_waitcnt lgkmcnt(8)
v_mfma_f32_16x16x32_bf16 v[24:27], a[0:3], v[104:107], v[24:27]
v_mfma_f32_16x16x32_bf16 v[40:43], a[0:3], v[108:111], v[40:43]
v_mfma_f32_16x16x32_bf16 v[28:31], a[4:7], v[104:107], v[28:31]
v_mfma_f32_16x16x32_bf16 v[44:47], a[4:7], v[108:111], v[44:47]
v_mfma_f32_16x16x32_bf16 v[32:35], a[8:11], v[104:107], v[32:35]
v_mfma_f32_16x16x32_bf16 v[48:51], a[8:11], v[108:111], v[48:51]
v_mfma_f32_16x16x32_bf16 v[36:39], a[12:15], v[104:107], v[36:39]
v_mfma_f32_16x16x32_bf16 v[52:55], a[12:15], v[108:111], v[52:55]
s_waitcnt lgkmcnt(0)
v_mfma_f32_16x16x32_bf16 v[24:27], a[16:19], v[112:115], v[24:27]
v_mfma_f32_16x16x32_bf16 v[40:43], a[16:19], v[116:119], v[40:43]
v_mfma_f32_16x16x32_bf16 v[28:31], a[20:23], v[112:115], v[28:31]
v_mfma_f32_16x16x32_bf16 v[44:47], a[20:23], v[116:119], v[44:47]
v_mfma_f32_16x16x32_bf16 v[32:35], a[24:27], v[112:115], v[32:35]
v_mfma_f32_16x16x32_bf16 v[48:51], a[24:27], v[116:119], v[48:51]
v_mfma_f32_16x16x32_bf16 v[36:39], a[28:31], v[112:115], v[36:39]
v_mfma_f32_16x16x32_bf16 v[52:55], a[28:31], v[116:119], v[52:55]
s_nop 0
v_pk_add_f32 v[72:73], v[24:25], v[26:27]
v_pk_mul_f32 v[74:75], v[24:25], v[24:25]
v_pk_mul_f32 v[76:77], v[24:25], v[120:121]
v_pk_fma_f32 v[74:75], v[26:27], v[26:27], v[74:75]
v_pk_fma_f32 v[76:77], v[26:27], v[122:123], v[76:77]
v_pk_add_f32 v[72:73], v[72:73], v[28:29]
v_pk_fma_f32 v[74:75], v[28:29], v[28:29], v[74:75]
v_pk_fma_f32 v[76:77], v[28:29], v[124:125], v[76:77]
v_pk_add_f32 v[72:73], v[72:73], v[30:31]
v_pk_fma_f32 v[74:75], v[30:31], v[30:31], v[74:75]
v_pk_fma_f32 v[76:77], v[30:31], v[126:127], v[76:77]
v_pk_add_f32 v[72:73], v[72:73], v[32:33]
v_pk_fma_f32 v[74:75], v[32:33], v[32:33], v[74:75]
v_pk_fma_f32 v[76:77], v[32:33], v[128:129], v[76:77]
v_pk_add_f32 v[72:73], v[72:73], v[34:35]
v_pk_fma_f32 v[74:75], v[34:35], v[34:35], v[74:75]
v_pk_fma_f32 v[76:77], v[34:35], v[130:131], v[76:77]
v_pk_add_f32 v[72:73], v[72:73], v[36:37]
v_pk_fma_f32 v[74:75], v[36:37], v[36:37], v[74:75]
v_pk_fma_f32 v[76:77], v[36:37], v[132:133], v[76:77]
v_pk_add_f32 v[72:73], v[72:73], v[38:39]
v_pk_fma_f32 v[74:75], v[38:39], v[38:39], v[74:75]
v_pk_fma_f32 v[76:77], v[38:39], v[134:135], v[76:77]
v_add_f32 v72, v72, v73
v_add_f32 v73, v74, v75
v_add_f32 v74, v76, v77
v_pk_add_f32 v[80:81], v[40:41], v[42:43]
v_pk_mul_f32 v[82:83], v[40:41], v[40:41]
v_pk_mul_f32 v[84:85], v[40:41], v[120:121]
v_pk_fma_f32 v[82:83], v[42:43], v[42:43], v[82:83]
v_pk_fma_f32 v[84:85], v[42:43], v[122:123], v[84:85]
v_pk_add_f32 v[80:81], v[80:81], v[44:45]
v_pk_fma_f32 v[82:83], v[44:45], v[44:45], v[82:83]
v_pk_fma_f32 v[84:85], v[44:45], v[124:125], v[84:85]
v_pk_add_f32 v[80:81], v[80:81], v[46:47]
v_pk_fma_f32 v[82:83], v[46:47], v[46:47], v[82:83]
v_pk_fma_f32 v[84:85], v[46:47], v[126:127], v[84:85]
v_pk_add_f32 v[80:81], v[80:81], v[48:49]
v_pk_fma_f32 v[82:83], v[48:49], v[48:49], v[82:83]
v_pk_fma_f32 v[84:85], v[48:49], v[128:129], v[84:85]
v_pk_add_f32 v[80:81], v[80:81], v[50:51]
v_pk_fma_f32 v[82:83], v[50:51], v[50:51], v[82:83]
v_pk_fma_f32 v[84:85], v[50:51], v[130:131], v[84:85]
v_pk_add_f32 v[80:81], v[80:81], v[52:53]
v_pk_fma_f32 v[82:83], v[52:53], v[52:53], v[82:83]
v_pk_fma_f32 v[84:85], v[52:53], v[132:133], v[84:85]
v_pk_add_f32 v[80:81], v[80:81], v[54:55]
v_pk_fma_f32 v[82:83], v[54:55], v[54:55], v[82:83]
v_pk_fma_f32 v[84:85], v[54:55], v[134:135], v[84:85]
v_add_f32 v80, v80, v81
v_add_f32 v81, v82, v83
v_add_f32 v82, v84, v85
v_permlane32_swap_b32 v72, v80
v_permlane32_swap_b32 v73, v81
v_permlane32_swap_b32 v74, v82
v_add_f32 v72, v72, v80
v_add_f32 v73, v73, v81
v_add_f32 v74, v74, v82
v_mov_b32 v80, v72
v_mov_b32 v81, v73
v_mov_b32 v82, v74
v_permlane16_swap_b32 v72, v80
v_permlane16_swap_b32 v73, v81
v_permlane16_swap_b32 v74, v82
v_add_f32 v72, v72, v80
v_add_f32 v73, v73, v81
v_add_f32 v74, v74, v82
v_mov_b32 v75, s68
s_mov_b64 exec, s[92:93]
s_cmp_eq_u32 s69, 0
s_cbranch_scc1 L_stp_s
buffer_store_dwordx4 v[72:75], v144, s[12:15], s72 offen
L_stp_d:
s_mov_b64 exec, -1
s_add_u32 s70, s75, 0
buffer_load_dwordx4 v[96:99], v145, s[12:15], s70 offen sc1
s_add_u32 s70, s75, 4096
buffer_load_dwordx4 v[100:103], v145, s[12:15], s70 offen sc1
s_add_u32 s70, s75, 8192
buffer_load_dwordx4 v[104:107], v145, s[12:15], s70 offen sc1
s_add_u32 s70, s75, 12288
buffer_load_dwordx4 v[108:111], v145, s[12:15], s70 offen sc1
s_add_u32 s70, s75, 16384
buffer_load_dwordx4 v[112:115], v145, s[12:15], s70 offen sc1
s_add_u32 s70, s75, 20480
buffer_load_dwordx4 v[116:119], v145, s[12:15], s70 offen sc1
s_add_u32 s70, s75, 24576
buffer_load_dwordx4 v[120:123], v145, s[12:15], s70 offen sc1
s_add_u32 s70, s75, 28672
buffer_load_dwordx4 v[124:127], v145, s[12:15], s70 offen sc1
s_barrier
v_cvt_pk_bf16_f32 v128, v24, v25
v_cvt_pk_bf16_f32 v129, v26, v27
ds_write_b64 v20, v[128:129] offset:0
v_cvt_pk_bf16_f32 v130, v28, v29
v_cvt_pk_bf16_f32 v131, v30, v31
ds_write_b64 v21, v[130:131] offset:0
v_cvt_pk_bf16_f32 v132, v32, v33
v_cvt_pk_bf16_f32 v133, v34, v35
ds_write_b64 v22, v[132:133] offset:0
v_cvt_pk_bf16_f32 v134, v36, v37
v_cvt_pk_bf16_f32 v135, v38, v39
ds_write_b64 v23, v[134:135] offset:0
v_cvt_pk_bf16_f32 v136, v40, v41
v_cvt_pk_bf16_f32 v137, v42, v43
ds_write_b64 v20, v[136:137] offset:2048
v_cvt_pk_bf16_f32 v138, v44, v45
v_cvt_pk_bf16_f32 v139, v46, v47
ds_write_b64 v21, v[138:139] offset:2048
v_cvt_pk_bf16_f32 v140, v48, v49
v_cvt_pk_bf16_f32 v141, v50, v51
ds_write_b64 v22, v[140:141] offset:2048
v_cvt_pk_bf16_f32 v142, v52, v53
v_cvt_pk_bf16_f32 v143, v54, v55
ds_write_b64 v23, v[142:143] offset:2048
s_waitcnt vmcnt(0)
L_st_chk:
v_xor_b32 v88, s68, v99
v_xor_b32 v89, s68, v103
v_xor_b32 v90, s68, v107
v_xor_b32 v91, s68, v111
v_xor_b32 v92, s68, v115
v_xor_b32 v93, s68, v119
v_xor_b32 v94, s68, v123
v_xor_b32 v95, s68, v127
v_or3_b32 v88, v88, v89, v90
v_or3_b32 v91, v91, v92, v93
v_or3_b32 v88, v88, v94, v95
v_or_b32 v88, v88, v91
v_cmp_ne_u32 vcc, 0, v88
s_cbranch_vccnz L_st_rt
L_st_ok:
v_pk_add_f32 v[96:97], v[96:97], v[100:101]
v_add_f32 v98, v98, v102
v_pk_add_f32 v[104:105], v[104:105], v[108:109]
v_add_f32 v106, v106, v110
v_pk_add_f32 v[112:113], v[112:113], v[116:117]
v_add_f32 v114, v114, v118
v_pk_add_f32 v[120:121], v[120:121], v[124:125]
v_add_f32 v122, v122, v126
v_pk_add_f32 v[96:97], v[96:97], v[104:105]
v_add_f32 v98, v98, v106
v_pk_add_f32 v[112:113], v[112:113], v[120:121]
v_add_f32 v114, v114, v122
v_pk_add_f32 v[96:97], v[96:97], v[112:113]
v_add_f32 v98, v98, v114
v_mov_b32 v100, v96
v_mov_b32 v101, v97
v_mov_b32 v102, v98
v_permlane32_swap_b32 v96, v100
v_permlane32_swap_b32 v97, v101
v_permlane32_swap_b32 v98, v102
v_add_f32 v96, v96, v100
v_add_f32 v97, v97, v101
v_add_f32 v98, v98, v102
v_mul_f32 v73, 0x3a800000, v96
v_mul_f32 v97, 0x3a800000, v97
v_fma_f32 v97, -v73, v73, v97
v_fma_f32 v98, -v73, s84, v98
v_max_f32 v97, 0, v97
v_add_f32 v97, 0x3727c5ac, v97
v_rsq_f32 v74, v97
v_mov_b32 v75, s68
v_mul_f32 v98, v98, v74
v_ashrrev_i32 v99, 31, v98
v_or_b32 v99, 0x80000000, v99
v_xor_b32 v98, v98, v99
s_mov_b32 s70, 0xfffff800
v_and_or_b32 v72, v98, s70, v146
ds_write_b128 v147, v[72:75]
s_nop 0
v_mov_b32_dpp v78, v72 row_ror:1 row_mask:0xf bank_mask:0xf
v_max_u32 v76, v72, v78
v_min_u32 v77, v72, v78
s_nop 0
v_mov_b32_dpp v78, v76 row_ror:2 row_mask:0xf bank_mask:0xf
v_max_u32_dpp v79, v77, v77 row_ror:2 row_mask:0xf bank_mask:0xf
v_med3_u32 v77, v76, v78, v79
v_max_u32 v76, v76, v78
s_nop 1
v_mov_b32_dpp v78, v76 row_ror:4 row_mask:0xf bank_mask:0xf
v_max_u32_dpp v79, v77, v77 row_ror:4 row_mask:0xf bank_mask:0xf
v_med3_u32 v77, v76, v78, v79
v_max_u32 v76, v76, v78
s_nop 1
v_mov_b32_dpp v78, v76 row_ror:8 row_mask:0xf bank_mask:0xf
v_max_u32_dpp v79, v77, v77 row_ror:8 row_mask:0xf bank_mask:0xf
v_med3_u32 v77, v76, v78, v79
v_max_u32 v76, v76, v78
v_mov_b32 v78, v76
v_mov_b32 v79, v77
s_nop 0
v_permlane16_swap_b32 v76, v78
v_permlane16_swap_b32 v77, v79
v_max_u32 v79, v77, v79
v_med3_u32 v77, v76, v78, v79
v_max_u32 v76, v76, v78
s_lshl_b32 s70, s60, 3
s_add_u32 s70, s70, 161792
v_mov_b32 v2, s70
ds_write_b64 v2, v[76:77]
v_mov_b32 v2, 161792
v_add_f32 v80, 1.0, v74
v_mul_f32_e64 v56, -v73, v74
v_mov_b32 v82, v80
v_mov_b32 v58, v56
s_nop 0
v_permlane16_swap_b32 v80, v82
v_permlane16_swap_b32 v56, v58
s_waitcnt lgkmcnt(0)
s_barrier
ds_read_b128 v[88:91], v2
ds_read_b128 v[92:95], v2 offset:16
s_waitcnt lgkmcnt(0)
v_max_u32 v89, v89, v91
v_max_u32 v93, v93, v95
v_med3_u32 v89, v88, v90, v89
v_med3_u32 v93, v92, v94, v93
v_max_u32 v88, v88, v90
v_max_u32 v92, v92, v94
v_max_u32 v89, v89, v93
v_med3_u32 v89, v88, v92, v89
v_max_u32 v88, v88, v92
v_readfirstlane_b32 s86, v89
v_readfirstlane_b32 s85, v88
s_not_b32 s95, s86
s_and_b32 s95, s95, 127
s_not_b32 s94, s85
s_and_b32 s94, s94, 127
s_cmp_lg_u32 s60, 0
s_cbranch_scc1 L_nocand
v_mov_b32 v2, s94
v_mov_b32 v3, s95
v_and_b32 v4, 8, v1
v_cmp_ne_u32 vcc, 0, v4
s_nop 1
v_cndmask_b32 v5, v2, v3, vcc
v_bfe_u32 v6, v5, 1, 3
v_and_b32 v7, 7, v1
v_xor_b32 v6, v6, v7
v_lshlrev_b32 v6, 4, v6
v_lshl_add_u32 v6, v5, 7, v6
ds_read_b128 v[88:91], v6
v_cmp_eq_u32 vcc, 1, v1
s_nop 1
v_cndmask_b32 v5, v2, v3, vcc
v_lshlrev_b32 v5, 4, v5
v_add_u32 v5, 49152, v5
ds_read_b128 v[92:95], v5
v_lshlrev_b32 v4, 8, v4
v_lshl_add_u32 v4, v7, 4, v4
s_lshl_b32 s70, s64, 12
s_lshl_b32 s71, s65, 7
s_add_u32 s70, s70, s71
s_add_u32 s70, s70, 6881280
s_lshl_b32 s71, s64, 7
s_add_u32 s71, s71, 6815744
s_mov_b64 exec, 0xffff
s_waitcnt lgkmcnt(1)
buffer_store_dwordx4 v[88:91], v4, s[12:15], s70 offen sc1
s_cmp_lg_u32 s64, s65
s_cbranch_scc1 L_norec
s_mov_b64 exec, 3
s_waitcnt lgkmcnt(0)
buffer_store_dwordx4 v[92:95], v16, s[12:15], s71 offen sc1
L_norec:
s_mov_b64 exec, -1
L_nocand:
v_bfe_u32 v8, v1, 1, 4
v_lshlrev_b32 v8, 7, v8
v_and_b32 v2, 1, v1
v_lshl_add_u32 v8, v2, 4, v8
s_mov_b32 s75, 6815744
v_pk_fma_f32 v[24:25], v[24:25], v[80:81], v[56:57] op_sel_hi:[1,0,0]
v_pk_fma_f32 v[26:27], v[26:27], v[80:81], v[56:57] op_sel_hi:[1,0,0]
v_cvt_pk_bf16_f32 v128, v24, v25
v_cvt_pk_bf16_f32 v129, v26, v27
ds_write_b64 v20, v[128:129] offset:32768
v_pk_fma_f32 v[28:29], v[28:29], v[80:81], v[56:57] op_sel_hi:[1,0,0]
v_pk_fma_f32 v[30:31], v[30:31], v[80:81], v[56:57] op_sel_hi:[1,0,0]
v_cvt_pk_bf16_f32 v130, v28, v29
v_cvt_pk_bf16_f32 v131, v30, v31
ds_write_b64 v21, v[130:131] offset:32768
v_pk_fma_f32 v[32:33], v[32:33], v[80:81], v[56:57] op_sel_hi:[1,0,0]
v_pk_fma_f32 v[34:35], v[34:35], v[80:81], v[56:57] op_sel_hi:[1,0,0]
v_cvt_pk_bf16_f32 v132, v32, v33
v_cvt_pk_bf16_f32 v133, v34, v35
ds_write_b64 v22, v[132:133] offset:32768
v_pk_fma_f32 v[36:37], v[36:37], v[80:81], v[56:57] op_sel_hi:[1,0,0]
v_pk_fma_f32 v[38:39], v[38:39], v[80:81], v[56:57] op_sel_hi:[1,0,0]
v_cvt_pk_bf16_f32 v134, v36, v37
v_cvt_pk_bf16_f32 v135, v38, v39
ds_write_b64 v23, v[134:135] offset:32768
v_pk_fma_f32 v[40:41], v[40:41], v[82:83], v[58:59] op_sel_hi:[1,0,0]
v_pk_fma_f32 v[42:43], v[42:43], v[82:83], v[58:59] op_sel_hi:[1,0,0]
v_cvt_pk_bf16_f32 v136, v40, v41
v_cvt_pk_bf16_f32 v137, v42, v43
ds_write_b64 v20, v[136:137] offset:34816
v_pk_fma_f32 v[44:45], v[44:45], v[82:83], v[58:59] op_sel_hi:[1,0,0]
v_pk_fma_f32 v[46:47], v[46:47], v[82:83], v[58:59] op_sel_hi:[1,0,0]
v_cvt_pk_bf16_f32 v138, v44, v45
v_cvt_pk_bf16_f32 v139, v46, v47
ds_write_b64 v21, v[138:139] offset:34816
v_pk_fma_f32 v[48:49], v[48:49], v[82:83], v[58:59] op_sel_hi:[1,0,0]
v_pk_fma_f32 v[50:51], v[50:51], v[82:83], v[58:59] op_sel_hi:[1,0,0]
v_cvt_pk_bf16_f32 v140, v48, v49
v_cvt_pk_bf16_f32 v141, v50, v51
ds_write_b64 v22, v[140:141] offset:34816
v_pk_fma_f32 v[52:53], v[52:53], v[82:83], v[58:59] op_sel_hi:[1,0,0]
v_pk_fma_f32 v[54:55], v[54:55], v[82:83], v[58:59] op_sel_hi:[1,0,0]
v_cvt_pk_bf16_f32 v142, v52, v53
v_cvt_pk_bf16_f32 v143, v54, v55
ds_write_b64 v23, v[142:143] offset:34816
v_lshrrev_b32 v2, 3, v1
v_lshrrev_b32 v3, 4, v1
v_and_b32 v4, 7, v1
v_xor_b32 v3, v3, v4
v_lshlrev_b32 v3, 4, v3
v_lshl_add_u32 v3, v2, 7, v3
s_lshl_b32 s70, s60, 12
v_add_u32 v9, s70, v3
v_xor_b32 v10, 64, v9
v_lshlrev_b32 v11, 11, v2
v_lshl_add_u32 v11, v4, 4, v11
s_lshl_b32 s70, s60, 5
v_add_u32 v12, s70, v2
s_lshl_b32 s87, s64, 18
s_lshl_b32 s70, s60, 16
s_add_u32 s87, s87, s70
s_lshl_b32 s70, s65, 7
s_add_u32 s87, s87, s70
s_waitcnt lgkmcnt(0)
ds_read_b128 v[96:99], v9 offset:32768
ds_read_b128 v[100:103], v10 offset:33792
ds_read_b128 v[104:107], v9 offset:34816
ds_read_b128 v[108:111], v10 offset:35840
v_add_u32 v2, 0, v12
v_cmp_ne_u32 vcc, s94, v2
v_cmp_ne_u32_e64 s[92:93], s95, v2
s_add_u32 s70, s87, 0
s_waitcnt lgkmcnt(3)
s_and_b64 exec, vcc, s[92:93]
buffer_store_dwordx4 v[96:99], v11, s[20:23], s70 offen
s_mov_b64 exec, -1
v_add_u32 v2, 8, v12
v_cmp_ne_u32 vcc, s94, v2
v_cmp_ne_u32_e64 s[92:93], s95, v2
s_add_u32 s70, s87, 16384
s_waitcnt lgkmcnt(2)
s_and_b64 exec, vcc, s[92:93]
buffer_store_dwordx4 v[100:103], v11, s[20:23], s70 offen
s_mov_b64 exec, -1
v_add_u32 v2, 16, v12
v_cmp_ne_u32 vcc, s94, v2
v_cmp_ne_u32_e64 s[92:93], s95, v2
s_add_u32 s70, s87, 32768
s_waitcnt lgkmcnt(1)
s_and_b64 exec, vcc, s[92:93]
buffer_store_dwordx4 v[104:107], v11, s[20:23], s70 offen
s_mov_b64 exec, -1
v_add_u32 v2, 24, v12
v_cmp_ne_u32 vcc, s94, v2
v_cmp_ne_u32_e64 s[92:93], s95, v2
s_add_u32 s70, s87, 49152
s_waitcnt lgkmcnt(0)
s_and_b64 exec, vcc, s[92:93]
buffer_store_dwordx4 v[108:111], v11, s[20:23], s70 offen
s_mov_b64 exec, -1
s_cmp_lg_u32 s60, 1
s_cbranch_scc1 L_nopick
buffer_load_dwordx4 v[84:87], v8, s[12:15], s75 offen sc1
s_waitcnt vmcnt(0)
L_rec_chk:
v_cmp_ne_u32 vcc, s68, v87
s_cbranch_vccnz L_rec_rt
L_rec_ok:
v_mov_b32_dpp v78, v84 row_ror:1 row_mask:0xf bank_mask:0xf
v_max_u32 v76, v84, v78
v_min_u32 v77, v84, v78
s_nop 0
v_mov_b32_dpp v78, v76 row_ror:2 row_mask:0xf bank_mask:0xf
v_max_u32_dpp v79, v77, v77 row_ror:2 row_mask:0xf bank_mask:0xf
v_med3_u32 v77, v76, v78, v79
v_max_u32 v76, v76, v78
s_nop 1
v_mov_b32_dpp v78, v76 row_ror:4 row_mask:0xf bank_mask:0xf
v_max_u32_dpp v79, v77, v77 row_ror:4 row_mask:0xf bank_mask:0xf
v_med3_u32 v77, v76, v78, v79
v_max_u32 v76, v76, v78
s_nop 1
v_mov_b32_dpp v78, v76 row_ror:8 row_mask:0xf bank_mask:0xf
v_max_u32_dpp v79, v77, v77 row_ror:8 row_mask:0xf bank_mask:0xf
v_med3_u32 v77, v76, v78, v79
v_max_u32 v76, v76, v78
v_mov_b32 v78, v76
v_mov_b32 v79, v77
s_nop 0
v_permlane16_swap_b32 v76, v78
v_permlane16_swap_b32 v77, v79
v_max_u32 v79, v77, v79
v_med3_u32 v77, v76, v78, v79
v_max_u32 v76, v76, v78
v_cmp_eq_u32 vcc, v84, v77
v_cmp_eq_u32_e64 s[92:93], v84, v76
v_and_b32 v87, 31, v1
v_mov_b32 v2, 161856
v_mov_b32 v3, 161872
v_cndmask_b32 v2, v2, v3, vcc
s_or_b64 exec, vcc, s[92:93]
ds_write_b128 v2, v[84:87]
s_mov_b64 exec, -1
s_cmp_lg_u32 s2, 0
s_cbranch_scc1 L_nopick
v_mov_b32 v2, s68
v_mov_b32 v3, 0
s_mov_b64 exec, 1
buffer_store_dword v2, v3, s[12:15], 0 offen sc1
s_mov_b64 exec, -1
L_nopick:
v_mov_b32 v2, 161856
s_waitcnt lgkmcnt(0)
s_barrier
ds_read_b32 v3, v2
ds_read_b32 v4, v2 offset:16
s_waitcnt lgkmcnt(0)
v_readfirstlane_b32 s72, v3
v_readfirstlane_b32 s73, v4
s_cmp_eq_u32 s85, s72
s_cselect_b32 s94, 255, s94
s_cmp_eq_u32 s85, s73
s_cselect_b32 s94, 255, s94
s_cmp_eq_u32 s86, s72
s_cselect_b32 s95, 255, s95
s_cmp_eq_u32 s86, s73
s_cselect_b32 s95, 255, s95
v_add_u32 v2, 0, v12
v_cmp_eq_u32 vcc, s94, v2
v_cmp_eq_u32_e64 s[92:93], s95, v2
s_add_u32 s70, s87, 0
s_or_b64 exec, vcc, s[92:93]
s_cbranch_execz L_nodef0
buffer_store_dwordx4 v[96:99], v11, s[20:23], s70 offen
L_nodef0:
s_mov_b64 exec, -1
v_add_u32 v2, 8, v12
v_cmp_eq_u32 vcc, s94, v2
v_cmp_eq_u32_e64 s[92:93], s95, v2
s_add_u32 s70, s87, 16384
s_or_b64 exec, vcc, s[92:93]
s_cbranch_execz L_nodef1
buffer_store_dwordx4 v[100:103], v11, s[20:23], s70 offen
L_nodef1:
s_mov_b64 exec, -1
v_add_u32 v2, 16, v12
v_cmp_eq_u32 vcc, s94, v2
v_cmp_eq_u32_e64 s[92:93], s95, v2
s_add_u32 s70, s87, 32768
s_or_b64 exec, vcc, s[92:93]
s_cbranch_execz L_nodef2
buffer_store_dwordx4 v[104:107], v11, s[20:23], s70 offen
L_nodef2:
s_mov_b64 exec, -1
v_add_u32 v2, 24, v12
v_cmp_eq_u32 vcc, s94, v2
v_cmp_eq_u32_e64 s[92:93], s95, v2
s_add_u32 s70, s87, 49152
s_or_b64 exec, vcc, s[92:93]
s_cbranch_execz L_nodef3
buffer_store_dwordx4 v[108:111], v11, s[20:23], s70 offen
L_nodef3:
s_mov_b64 exec, -1
L_end:
s_endpgm
L_eg_rt:
s_add_u32 s78, s78, 1
s_cmp_gt_u32 s78, 65536
s_cbranch_scc1 L_eg_ok
s_add_u32 s70, s87, 0
buffer_load_dwordx4 v[20:23], v44, s[12:15], s70 offen sc1
s_add_u32 s70, s87, 4096
buffer_load_dwordx4 v[24:27], v44, s[12:15], s70 offen sc1
s_add_u32 s70, s87, 8192
buffer_load_dwordx4 v[28:31], v44, s[12:15], s70 offen sc1
s_add_u32 s70, s87, 12288
buffer_load_dwordx4 v[32:35], v44, s[12:15], s70 offen sc1
buffer_load_dwordx4 v[36:39], v45, s[12:15], s88 offen sc1
buffer_load_dwordx4 v[40:43], v46, s[12:15], 0 offen offset:0 sc1
s_waitcnt vmcnt(0)
s_branch L_eg_chk
L_kvrt:
s_add_u32 s78, s78, 1
s_cmp_gt_u32 s78, 65536
s_cbranch_scc1 L_kvok
s_bitcmp1_b32 s73, 0
s_cbranch_scc0 L_kvn0
v_cmp_eq_u32 vcc, -1, v84
s_cbranch_vccz L_kv0_p0
s_add_u32 s70, s65, 1
s_and_b32 s70, s70, 15
s_mul_i32 s70, s70, 4352
s_add_u32 s70, s70, s87
buffer_load_dwordx4 v[84:87], v18, s[12:15], s70 offen sc1
L_kv0_p0:
v_cmp_eq_u32 vcc, -1, v88
s_cbranch_vccz L_kv0_p1
s_add_u32 s70, s65, 2
s_and_b32 s70, s70, 15
s_mul_i32 s70, s70, 4352
s_add_u32 s70, s70, s87
buffer_load_dwordx4 v[88:91], v18, s[12:15], s70 offen sc1
L_kv0_p1:
v_cmp_eq_u32 vcc, -1, v92
s_cbranch_vccz L_kv0_p2
s_add_u32 s70, s65, 3
s_and_b32 s70, s70, 15
s_mul_i32 s70, s70, 4352
s_add_u32 s70, s70, s87
buffer_load_dwordx4 v[92:95], v18, s[12:15], s70 offen sc1
L_kv0_p2:
v_cmp_eq_u32 vcc, -1, v96
s_cbranch_vccz L_kv0_p3
s_add_u32 s70, s65, 4
s_and_b32 s70, s70, 15
s_mul_i32 s70, s70, 4352
s_add_u32 s70, s70, s87
buffer_load_dwordx4 v[96:99], v18, s[12:15], s70 offen sc1
L_kv0_p3:
L_kvn0:
s_bitcmp1_b32 s73, 1
s_cbranch_scc0 L_kvn1
v_cmp_eq_u32 vcc, -1, v100
s_cbranch_vccz L_kv1_p0
s_add_u32 s70, s65, 5
s_and_b32 s70, s70, 15
s_mul_i32 s70, s70, 4352
s_add_u32 s70, s70, s87
buffer_load_dwordx4 v[100:103], v18, s[12:15], s70 offen sc1
L_kv1_p0:
v_cmp_eq_u32 vcc, -1, v104
s_cbranch_vccz L_kv1_p1
s_add_u32 s70, s65, 6
s_and_b32 s70, s70, 15
s_mul_i32 s70, s70, 4352
s_add_u32 s70, s70, s87
buffer_load_dwordx4 v[104:107], v18, s[12:15], s70 offen sc1
L_kv1_p1:
v_cmp_eq_u32 vcc, -1, v108
s_cbranch_vccz L_kv1_p2
s_add_u32 s70, s65, 7
s_and_b32 s70, s70, 15
s_mul_i32 s70, s70, 4352
s_add_u32 s70, s70, s87
buffer_load_dwordx4 v[108:111], v18, s[12:15], s70 offen sc1
L_kv1_p2:
v_cmp_eq_u32 vcc, -1, v112
s_cbranch_vccz L_kv1_p3
s_add_u32 s70, s65, 8
s_and_b32 s70, s70, 15
s_mul_i32 s70, s70, 4352
s_add_u32 s70, s70, s87
buffer_load_dwordx4 v[112:115], v18, s[12:15], s70 offen sc1
L_kv1_p3:
L_kvn1:
s_bitcmp1_b32 s73, 2
s_cbranch_scc0 L_kvn2
v_cmp_eq_u32 vcc, -1, v116
s_cbranch_vccz L_kv2_p0
s_add_u32 s70, s65, 9
s_and_b32 s70, s70, 15
s_mul_i32 s70, s70, 4352
s_add_u32 s70, s70, s87
buffer_load_dwordx4 v[116:119], v18, s[12:15], s70 offen sc1
L_kv2_p0:
v_cmp_eq_u32 vcc, -1, v120
s_cbranch_vccz L_kv2_p1
s_add_u32 s70, s65, 10
s_and_b32 s70, s70, 15
s_mul_i32 s70, s70, 4352
s_add_u32 s70, s70, s87
buffer_load_dwordx4 v[120:123], v18, s[12:15], s70 offen sc1
L_kv2_p1:
v_cmp_eq_u32 vcc, -1, v124
s_cbranch_vccz L_kv2_p2
s_add_u32 s70, s65, 11
s_and_b32 s70, s70, 15
s_mul_i32 s70, s70, 4352
s_add_u32 s70, s70, s87
buffer_load_dwordx4 v[124:127], v18, s[12:15], s70 offen sc1
L_kv2_p2:
v_cmp_eq_u32 vcc, -1, v128
s_cbranch_vccz L_kv2_p3
s_add_u32 s70, s65, 12
s_and_b32 s70, s70, 15
s_mul_i32 s70, s70, 4352
s_add_u32 s70, s70, s87
buffer_load_dwordx4 v[128:131], v18, s[12:15], s70 offen sc1
L_kv2_p3:
L_kvn2:
s_bitcmp1_b32 s73, 3
s_cbranch_scc0 L_kvn3
v_cmp_eq_u32 vcc, -1, v132
s_cbranch_vccz L_kv3_p0
s_add_u32 s70, s65, 13
s_and_b32 s70, s70, 15
s_mul_i32 s70, s70, 4352
s_add_u32 s70, s70, s87
buffer_load_dwordx4 v[132:135], v18, s[12:15], s70 offen sc1
L_kv3_p0:
v_cmp_eq_u32 vcc, -1, v136
s_cbranch_vccz L_kv3_p1
s_add_u32 s70, s65, 14
s_and_b32 s70, s70, 15
s_mul_i32 s70, s70, 4352
s_add_u32 s70, s70, s87
buffer_load_dwordx4 v[136:139], v18, s[12:15], s70 offen sc1
L_kv3_p1:
v_cmp_eq_u32 vcc, -1, v140
s_cbranch_vccz L_kv3_p2
s_add_u32 s70, s65, 15
s_and_b32 s70, s70, 15
s_mul_i32 s70, s70, 4352
s_add_u32 s70, s70, s87
buffer_load_dwordx4 v[140:143], v18, s[12:15], s70 offen sc1
L_kv3_p2:
v_cmp_eq_u32 vcc, -1, v144
s_cbranch_vccz L_kv3_p3
s_add_u32 s70, s65, 16
s_and_b32 s70, s70, 15
s_mul_i32 s70, s70, 4352
s_add_u32 s70, s70, s87
buffer_load_dwordx4 v[144:147], v18, s[12:15], s70 offen sc1
L_kv3_p3:
L_kvn3:
s_bitcmp1_b32 s73, 4
s_cbranch_scc0 L_kvn4
buffer_load_dwordx4 v[148:151], v55, s[12:15], s88 offen sc1
L_kvn4:
s_waitcnt vmcnt(0)
s_branch L_kvr
L_x_rt:
s_add_u32 s78, s78, 1
s_cmp_gt_u32 s78, 65536
s_cbranch_scc1 L_x_ok
buffer_load_dwordx4 v[24:27], v57, s[12:15], 0 offen offset:0 sc1
buffer_load_dwordx4 v[28:31], v57, s[12:15], 0 offen offset:64 sc1
buffer_load_dwordx4 v[32:35], v57, s[12:15], 0 offen offset:128 sc1
buffer_load_dwordx4 v[36:39], v57, s[12:15], 0 offen offset:192 sc1
buffer_load_dwordx4 v[40:43], v57, s[12:15], 0 offen offset:256 sc1
buffer_load_dwordx4 v[44:47], v57, s[12:15], 0 offen offset:320 sc1
buffer_load_dwordx4 v[48:51], v57, s[12:15], 0 offen offset:384 sc1
buffer_load_dwordx4 v[52:55], v57, s[12:15], 0 offen offset:448 sc1
s_waitcnt vmcnt(0)
s_branch L_x_chk
L_pxp_s:
buffer_store_dwordx4 v[68:71], v58, s[12:15], s85 offen offset:0 sc1
buffer_store_dwordx4 v[72:75], v58, s[12:15], s85 offen offset:128 sc1
s_branch L_pxp_d
L_px_rt:
s_add_u32 s78, s78, 1
s_cmp_gt_u32 s78, 65536
s_cbranch_scc1 L_px_ok
buffer_load_dwordx4 v[24:27], v58, s[12:15], s86 offen offset:0 sc1
buffer_load_dwordx4 v[28:31], v58, s[12:15], s86 offen offset:256 sc1
buffer_load_dwordx4 v[32:35], v58, s[12:15], s86 offen offset:512 sc1
buffer_load_dwordx4 v[36:39], v58, s[12:15], s86 offen offset:768 sc1
s_waitcnt vmcnt(0)
s_branch L_px_chk
L_y_rt:
s_add_u32 s78, s78, 1
s_cmp_gt_u32 s78, 65536
s_cbranch_scc1 L_y_ok
v_cmp_ne_u32 vcc, 0, v8
s_nop 0
s_cbranch_vccz L_y_p0
buffer_load_ushort v61, v64, s[12:15], s72 offen sc1
L_y_p0:
v_and_b32 v2, s91, v24
v_cmp_ne_u32 vcc, 0, v2
v_xor_b32 v24, s84, v24
s_cbranch_vccz L_y_p1
s_add_u32 s70, s87, 0
buffer_load_dwordx4 v[24:27], v62, s[12:15], s70 offen sc1
L_y_p1:
v_and_b32 v2, s91, v28
v_cmp_ne_u32 vcc, 0, v2
v_xor_b32 v28, s84, v28
s_cbranch_vccz L_y_p2
s_add_u32 s70, s87, 65536
buffer_load_dwordx4 v[28:31], v62, s[12:15], s70 offen sc1
L_y_p2:
v_and_b32 v2, s91, v32
v_cmp_ne_u32 vcc, 0, v2
v_xor_b32 v32, s84, v32
s_cbranch_vccz L_y_p3
s_add_u32 s70, s87, 131072
buffer_load_dwordx4 v[32:35], v62, s[12:15], s70 offen sc1
L_y_p3:
v_and_b32 v2, s91, v36
v_cmp_ne_u32 vcc, 0, v2
v_xor_b32 v36, s84, v36
s_cbranch_vccz L_y_p4
s_add_u32 s70, s87, 196608
buffer_load_dwordx4 v[36:39], v62, s[12:15], s70 offen sc1
L_y_p4:
v_and_b32 v2, s91, v40
v_cmp_ne_u32 vcc, 0, v2
v_xor_b32 v40, s84, v40
s_cbranch_vccz L_y_p5
s_add_u32 s70, s87, 262144
buffer_load_dwordx4 v[40:43], v62, s[12:15], s70 offen sc1
L_y_p5:
v_and_b32 v2, s91, v44
v_cmp_ne_u32 vcc, 0, v2
v_xor_b32 v44, s84, v44
s_cbranch_vccz L_y_p6
s_add_u32 s70, s87, 327680
buffer_load_dwordx4 v[44:47], v62, s[12:15], s70 offen sc1
L_y_p6:
v_and_b32 v2, s91, v48
v_cmp_ne_u32 vcc, 0, v2
v_xor_b32 v48, s84, v48
s_cbranch_vccz L_y_p7
s_add_u32 s70, s87, 393216
buffer_load_dwordx4 v[48:51], v62, s[12:15], s70 offen sc1
L_y_p7:
s_waitcnt vmcnt(0)
s_branch L_y_chk
L_kvp_s:
buffer_store_dwordx4 v[140:143], v16, s[12:15], s72 offen sc1
s_mov_b64 exec, s[92:93]
buffer_store_dwordx4 v[136:139], v4, s[12:15], s73 offen sc1
s_mov_b64 exec, -1
s_branch L_kvp_d
L_o0_rt:
s_add_u32 s78, s78, 1
s_cmp_gt_u32 s78, 65536
s_cbranch_scc1 L_o0_ok
s_add_u32 s70, s89, 0
s_and_b32 s70, s70, 15
s_lshl_b32 s70, s70, 11
buffer_load_dwordx4 v[56:59], v6, s[12:15], s70 offen offset:0 sc1
buffer_load_dwordx4 v[60:63], v19, s[12:15], s70 offen offset:0 sc1
buffer_load_dwordx4 v[64:67], v6, s[12:15], s70 offen offset:1024 sc1
buffer_load_dwordx4 v[68:71], v19, s[12:15], s70 offen offset:1024 sc1
s_add_u32 s70, s89, 1
s_and_b32 s70, s70, 15
s_lshl_b32 s70, s70, 11
buffer_load_dwordx4 v[72:75], v6, s[12:15], s70 offen offset:0 sc1
buffer_load_dwordx4 v[76:79], v19, s[12:15], s70 offen offset:0 sc1
buffer_load_dwordx4 v[80:83], v6, s[12:15], s70 offen offset:1024 sc1
buffer_load_dwordx4 v[84:87], v19, s[12:15], s70 offen offset:1024 sc1
s_add_u32 s70, s89, 2
s_and_b32 s70, s70, 15
s_lshl_b32 s70, s70, 11
buffer_load_dwordx4 v[88:91], v6, s[12:15], s70 offen offset:0 sc1
buffer_load_dwordx4 v[92:95], v19, s[12:15], s70 offen offset:0 sc1
buffer_load_dwordx4 v[96:99], v6, s[12:15], s70 offen offset:1024 sc1
buffer_load_dwordx4 v[100:103], v19, s[12:15], s70 offen offset:1024 sc1
s_waitcnt vmcnt(0)
s_branch L_o0_chk
L_o1_rt:
s_add_u32 s78, s78, 1
s_cmp_gt_u32 s78, 65536
s_cbranch_scc1 L_o1_ok
s_add_u32 s70, s89, 1
s_and_b32 s70, s70, 15
s_lshl_b32 s70, s70, 11
buffer_load_dwordx4 v[72:75], v6, s[12:15], s70 offen offset:0 sc1
buffer_load_dwordx4 v[76:79], v19, s[12:15], s70 offen offset:0 sc1
buffer_load_dwordx4 v[80:83], v6, s[12:15], s70 offen offset:1024 sc1
buffer_load_dwordx4 v[84:87], v19, s[12:15], s70 offen offset:1024 sc1
s_add_u32 s70, s89, 2
s_and_b32 s70, s70, 15
s_lshl_b32 s70, s70, 11
buffer_load_dwordx4 v[88:91], v6, s[12:15], s70 offen offset:0 sc1
buffer_load_dwordx4 v[92:95], v19, s[12:15], s70 offen offset:0 sc1
buffer_load_dwordx4 v[96:99], v6, s[12:15], s70 offen offset:1024 sc1
buffer_load_dwordx4 v[100:103], v19, s[12:15], s70 offen offset:1024 sc1
s_waitcnt vmcnt(0)
v_max3_u32 v2, v72, v76, v80
v_max_u32 v2, v2, v84
v_cmp_eq_u32 vcc, -1, v2
s_cbranch_vccnz L_o1_rt
s_branch L_o1_ok
L_o2_rt:
s_add_u32 s78, s78, 1
s_cmp_gt_u32 s78, 65536
s_cbranch_scc1 L_o2_ok
s_add_u32 s70, s89, 2
s_and_b32 s70, s70, 15
s_lshl_b32 s70, s70, 11
buffer_load_dwordx4 v[88:91], v6, s[12:15], s70 offen offset:0 sc1
buffer_load_dwordx4 v[92:95], v19, s[12:15], s70 offen offset:0 sc1
buffer_load_dwordx4 v[96:99], v6, s[12:15], s70 offen offset:1024 sc1
buffer_load_dwordx4 v[100:103], v19, s[12:15], s70 offen offset:1024 sc1
s_add_u32 s70, s89, 3
s_and_b32 s70, s70, 15
s_lshl_b32 s70, s70, 11
buffer_load_dwordx4 v[104:107], v6, s[12:15], s70 offen offset:0 sc1
buffer_load_dwordx4 v[108:111], v19, s[12:15], s70 offen offset:0 sc1
buffer_load_dwordx4 v[112:115], v6, s[12:15], s70 offen offset:1024 sc1
buffer_load_dwordx4 v[116:119], v19, s[12:15], s70 offen offset:1024 sc1
s_waitcnt vmcnt(0)
v_max3_u32 v2, v88, v92, v96
v_max_u32 v2, v2, v100
v_cmp_eq_u32 vcc, -1, v2
s_cbranch_vccnz L_o2_rt
s_branch L_o2_ok
L_o3_rt:
s_add_u32 s78, s78, 1
s_cmp_gt_u32 s78, 65536
s_cbranch_scc1 L_o3_ok
s_add_u32 s70, s89, 3
s_and_b32 s70, s70, 15
s_lshl_b32 s70, s70, 11
buffer_load_dwordx4 v[104:107], v6, s[12:15], s70 offen offset:0 sc1
buffer_load_dwordx4 v[108:111], v19, s[12:15], s70 offen offset:0 sc1
buffer_load_dwordx4 v[112:115], v6, s[12:15], s70 offen offset:1024 sc1
buffer_load_dwordx4 v[116:119], v19, s[12:15], s70 offen offset:1024 sc1
s_add_u32 s70, s89, 4
s_and_b32 s70, s70, 15
s_lshl_b32 s70, s70, 11
buffer_load_dwordx4 v[56:59], v6, s[12:15], s70 offen offset:0 sc1
buffer_load_dwordx4 v[60:63], v19, s[12:15], s70 offen offset:0 sc1
buffer_load_dwordx4 v[64:67], v6, s[12:15], s70 offen offset:1024 sc1
buffer_load_dwordx4 v[68:71], v19, s[12:15], s70 offen offset:1024 sc1
s_waitcnt vmcnt(0)
v_max3_u32 v2, v104, v108, v112
v_max_u32 v2, v2, v116
v_cmp_eq_u32 vcc, -1, v2
s_cbranch_vccnz L_o3_rt
s_branch L_o3_ok
L_o4_rt:
s_add_u32 s78, s78, 1
s_cmp_gt_u32 s78, 65536
s_cbranch_scc1 L_o4_ok
s_add_u32 s70, s89, 4
s_and_b32 s70, s70, 15
s_lshl_b32 s70, s70, 11
buffer_load_dwordx4 v[56:59], v6, s[12:15], s70 offen offset:0 sc1
buffer_load_dwordx4 v[60:63], v19, s[12:15], s70 offen offset:0 sc1
buffer_load_dwordx4 v[64:67], v6, s[12:15], s70 offen offset:1024 sc1
buffer_load_dwordx4 v[68:71], v19, s[12:15], s70 offen offset:1024 sc1
s_add_u32 s70, s89, 5
s_and_b32 s70, s70, 15
s_lshl_b32 s70, s70, 11
buffer_load_dwordx4 v[72:75], v6, s[12:15], s70 offen offset:0 sc1
buffer_load_dwordx4 v[76:79], v19, s[12:15], s70 offen offset:0 sc1
buffer_load_dwordx4 v[80:83], v6, s[12:15], s70 offen offset:1024 sc1
buffer_load_dwordx4 v[84:87], v19, s[12:15], s70 offen offset:1024 sc1
s_waitcnt vmcnt(0)
v_max3_u32 v2, v56, v60, v64
v_max_u32 v2, v2, v68
v_cmp_eq_u32 vcc, -1, v2
s_cbranch_vccnz L_o4_rt
s_branch L_o4_ok
L_o5_rt:
s_add_u32 s78, s78, 1
s_cmp_gt_u32 s78, 65536
s_cbranch_scc1 L_o5_ok
s_add_u32 s70, s89, 5
s_and_b32 s70, s70, 15
s_lshl_b32 s70, s70, 11
buffer_load_dwordx4 v[72:75], v6, s[12:15], s70 offen offset:0 sc1
buffer_load_dwordx4 v[76:79], v19, s[12:15], s70 offen offset:0 sc1
buffer_load_dwordx4 v[80:83], v6, s[12:15], s70 offen offset:1024 sc1
buffer_load_dwordx4 v[84:87], v19, s[12:15], s70 offen offset:1024 sc1
s_add_u32 s70, s89, 6
s_and_b32 s70, s70, 15
s_lshl_b32 s70, s70, 11
buffer_load_dwordx4 v[88:91], v6, s[12:15], s70 offen offset:0 sc1
buffer_load_dwordx4 v[92:95], v19, s[12:15], s70 offen offset:0 sc1
buffer_load_dwordx4 v[96:99], v6, s[12:15], s70 offen offset:1024 sc1
buffer_load_dwordx4 v[100:103], v19, s[12:15], s70 offen offset:1024 sc1
s_waitcnt vmcnt(0)
v_max3_u32 v2, v72, v76, v80
v_max_u32 v2, v2, v84
v_cmp_eq_u32 vcc, -1, v2
s_cbranch_vccnz L_o5_rt
s_branch L_o5_ok
L_o6_rt:
s_add_u32 s78, s78, 1
s_cmp_gt_u32 s78, 65536
s_cbranch_scc1 L_o6_ok
s_add_u32 s70, s89, 6
s_and_b32 s70, s70, 15
s_lshl_b32 s70, s70, 11
buffer_load_dwordx4 v[88:91], v6, s[12:15], s70 offen offset:0 sc1
buffer_load_dwordx4 v[92:95], v19, s[12:15], s70 offen offset:0 sc1
buffer_load_dwordx4 v[96:99], v6, s[12:15], s70 offen offset:1024 sc1
buffer_load_dwordx4 v[100:103], v19, s[12:15], s70 offen offset:1024 sc1
s_add_u32 s70, s89, 7
s_and_b32 s70, s70, 15
s_lshl_b32 s70, s70, 11
buffer_load_dwordx4 v[104:107], v6, s[12:15], s70 offen offset:0 sc1
buffer_load_dwordx4 v[108:111], v19, s[12:15], s70 offen offset:0 sc1
buffer_load_dwordx4 v[112:115], v6, s[12:15], s70 offen offset:1024 sc1
buffer_load_dwordx4 v[116:119], v19, s[12:15], s70 offen offset:1024 sc1
s_waitcnt vmcnt(0)
v_max3_u32 v2, v88, v92, v96
v_max_u32 v2, v2, v100
v_cmp_eq_u32 vcc, -1, v2
s_cbranch_vccnz L_o6_rt
s_branch L_o6_ok
L_o7_rt:
s_add_u32 s78, s78, 1
s_cmp_gt_u32 s78, 65536
s_cbranch_scc1 L_o7_ok
s_add_u32 s70, s89, 7
s_and_b32 s70, s70, 15
s_lshl_b32 s70, s70, 11
buffer_load_dwordx4 v[104:107], v6, s[12:15], s70 offen offset:0 sc1
buffer_load_dwordx4 v[108:111], v19, s[12:15], s70 offen offset:0 sc1
buffer_load_dwordx4 v[112:115], v6, s[12:15], s70 offen offset:1024 sc1
buffer_load_dwordx4 v[116:119], v19, s[12:15], s70 offen offset:1024 sc1
s_add_u32 s70, s89, 8
s_and_b32 s70, s70, 15
s_lshl_b32 s70, s70, 11
buffer_load_dwordx4 v[56:59], v6, s[12:15], s70 offen offset:0 sc1
buffer_load_dwordx4 v[60:63], v19, s[12:15], s70 offen offset:0 sc1
buffer_load_dwordx4 v[64:67], v6, s[12:15], s70 offen offset:1024 sc1
buffer_load_dwordx4 v[68:71], v19, s[12:15], s70 offen offset:1024 sc1
s_waitcnt vmcnt(0)
v_max3_u32 v2, v104, v108, v112
v_max_u32 v2, v2, v116
v_cmp_eq_u32 vcc, -1, v2
s_cbranch_vccnz L_o7_rt
s_branch L_o7_ok
L_o8_rt:
s_add_u32 s78, s78, 1
s_cmp_gt_u32 s78, 65536
s_cbranch_scc1 L_o8_ok
s_add_u32 s70, s89, 8
s_and_b32 s70, s70, 15
s_lshl_b32 s70, s70, 11
buffer_load_dwordx4 v[56:59], v6, s[12:15], s70 offen offset:0 sc1
buffer_load_dwordx4 v[60:63], v19, s[12:15], s70 offen offset:0 sc1
buffer_load_dwordx4 v[64:67], v6, s[12:15], s70 offen offset:1024 sc1
buffer_load_dwordx4 v[68:71], v19, s[12:15], s70 offen offset:1024 sc1
s_add_u32 s70, s89, 9
s_and_b32 s70, s70, 15
s_lshl_b32 s70, s70, 11
buffer_load_dwordx4 v[72:75], v6, s[12:15], s70 offen offset:0 sc1
buffer_load_dwordx4 v[76:79], v19, s[12:15], s70 offen offset:0 sc1
buffer_load_dwordx4 v[80:83], v6, s[12:15], s70 offen offset:1024 sc1
buffer_load_dwordx4 v[84:87], v19, s[12:15], s70 offen offset:1024 sc1
s_waitcnt vmcnt(0)
v_max3_u32 v2, v56, v60, v64
v_max_u32 v2, v2, v68
v_cmp_eq_u32 vcc, -1, v2
s_cbranch_vccnz L_o8_rt
s_branch L_o8_ok
L_o9_rt:
s_add_u32 s78, s78, 1
s_cmp_gt_u32 s78, 65536
s_cbranch_scc1 L_o9_ok
s_add_u32 s70, s89, 9
s_and_b32 s70, s70, 15
s_lshl_b32 s70, s70, 11
buffer_load_dwordx4 v[72:75], v6, s[12:15], s70 offen offset:0 sc1
buffer_load_dwordx4 v[76:79], v19, s[12:15], s70 offen offset:0 sc1
buffer_load_dwordx4 v[80:83], v6, s[12:15], s70 offen offset:1024 sc1
buffer_load_dwordx4 v[84:87], v19, s[12:15], s70 offen offset:1024 sc1
s_add_u32 s70, s89, 10
s_and_b32 s70, s70, 15
s_lshl_b32 s70, s70, 11
buffer_load_dwordx4 v[88:91], v6, s[12:15], s70 offen offset:0 sc1
buffer_load_dwordx4 v[92:95], v19, s[12:15], s70 offen offset:0 sc1
buffer_load_dwordx4 v[96:99], v6, s[12:15], s70 offen offset:1024 sc1
buffer_load_dwordx4 v[100:103], v19, s[12:15], s70 offen offset:1024 sc1
s_waitcnt vmcnt(0)
v_max3_u32 v2, v72, v76, v80
v_max_u32 v2, v2, v84
v_cmp_eq_u32 vcc, -1, v2
s_cbranch_vccnz L_o9_rt
s_branch L_o9_ok
L_o10_rt:
s_add_u32 s78, s78, 1
s_cmp_gt_u32 s78, 65536
s_cbranch_scc1 L_o10_ok
s_add_u32 s70, s89, 10
s_and_b32 s70, s70, 15
s_lshl_b32 s70, s70, 11
buffer_load_dwordx4 v[88:91], v6, s[12:15], s70 offen offset:0 sc1
buffer_load_dwordx4 v[92:95], v19, s[12:15], s70 offen offset:0 sc1
buffer_load_dwordx4 v[96:99], v6, s[12:15], s70 offen offset:1024 sc1
buffer_load_dwordx4 v[100:103], v19, s[12:15], s70 offen offset:1024 sc1
s_add_u32 s70, s89, 11
s_and_b32 s70, s70, 15
s_lshl_b32 s70, s70, 11
buffer_load_dwordx4 v[104:107], v6, s[12:15], s70 offen offset:0 sc1
buffer_load_dwordx4 v[108:111], v19, s[12:15], s70 offen offset:0 sc1
buffer_load_dwordx4 v[112:115], v6, s[12:15], s70 offen offset:1024 sc1
buffer_load_dwordx4 v[116:119], v19, s[12:15], s70 offen offset:1024 sc1
s_waitcnt vmcnt(0)
v_max3_u32 v2, v88, v92, v96
v_max_u32 v2, v2, v100
v_cmp_eq_u32 vcc, -1, v2
s_cbranch_vccnz L_o10_rt
s_branch L_o10_ok
L_o11_rt:
s_add_u32 s78, s78, 1
s_cmp_gt_u32 s78, 65536
s_cbranch_scc1 L_o11_ok
s_add_u32 s70, s89, 11
s_and_b32 s70, s70, 15
s_lshl_b32 s70, s70, 11
buffer_load_dwordx4 v[104:107], v6, s[12:15], s70 offen offset:0 sc1
buffer_load_dwordx4 v[108:111], v19, s[12:15], s70 offen offset:0 sc1
buffer_load_dwordx4 v[112:115], v6, s[12:15], s70 offen offset:1024 sc1
buffer_load_dwordx4 v[116:119], v19, s[12:15], s70 offen offset:1024 sc1
s_add_u32 s70, s89, 12
s_and_b32 s70, s70, 15
s_lshl_b32 s70, s70, 11
buffer_load_dwordx4 v[56:59], v6, s[12:15], s70 offen offset:0 sc1
buffer_load_dwordx4 v[60:63], v19, s[12:15], s70 offen offset:0 sc1
buffer_load_dwordx4 v[64:67], v6, s[12:15], s70 offen offset:1024 sc1
buffer_load_dwordx4 v[68:71], v19, s[12:15], s70 offen offset:1024 sc1
s_waitcnt vmcnt(0)
v_max3_u32 v2, v104, v108, v112
v_max_u32 v2, v2, v116
v_cmp_eq_u32 vcc, -1, v2
s_cbranch_vccnz L_o11_rt
s_branch L_o11_ok
L_o12_rt:
s_add_u32 s78, s78, 1
s_cmp_gt_u32 s78, 65536
s_cbranch_scc1 L_o12_ok
s_add_u32 s70, s89, 12
s_and_b32 s70, s70, 15
s_lshl_b32 s70, s70, 11
buffer_load_dwordx4 v[56:59], v6, s[12:15], s70 offen offset:0 sc1
buffer_load_dwordx4 v[60:63], v19, s[12:15], s70 offen offset:0 sc1
buffer_load_dwordx4 v[64:67], v6, s[12:15], s70 offen offset:1024 sc1
buffer_load_dwordx4 v[68:71], v19, s[12:15], s70 offen offset:1024 sc1
s_add_u32 s70, s89, 13
s_and_b32 s70, s70, 15
s_lshl_b32 s70, s70, 11
buffer_load_dwordx4 v[72:75], v6, s[12:15], s70 offen offset:0 sc1
buffer_load_dwordx4 v[76:79], v19, s[12:15], s70 offen offset:0 sc1
buffer_load_dwordx4 v[80:83], v6, s[12:15], s70 offen offset:1024 sc1
buffer_load_dwordx4 v[84:87], v19, s[12:15], s70 offen offset:1024 sc1
s_waitcnt vmcnt(0)
v_max3_u32 v2, v56, v60, v64
v_max_u32 v2, v2, v68
v_cmp_eq_u32 vcc, -1, v2
s_cbranch_vccnz L_o12_rt
s_branch L_o12_ok
L_o13_rt:
s_add_u32 s78, s78, 1
s_cmp_gt_u32 s78, 65536
s_cbranch_scc1 L_o13_ok
s_add_u32 s70, s89, 13
s_and_b32 s70, s70, 15
s_lshl_b32 s70, s70, 11
buffer_load_dwordx4 v[72:75], v6, s[12:15], s70 offen offset:0 sc1
buffer_load_dwordx4 v[76:79], v19, s[12:15], s70 offen offset:0 sc1
buffer_load_dwordx4 v[80:83], v6, s[12:15], s70 offen offset:1024 sc1
buffer_load_dwordx4 v[84:87], v19, s[12:15], s70 offen offset:1024 sc1
s_add_u32 s70, s89, 14
s_and_b32 s70, s70, 15
s_lshl_b32 s70, s70, 11
buffer_load_dwordx4 v[88:91], v6, s[12:15], s70 offen offset:0 sc1
buffer_load_dwordx4 v[92:95], v19, s[12:15], s70 offen offset:0 sc1
buffer_load_dwordx4 v[96:99], v6, s[12:15], s70 offen offset:1024 sc1
buffer_load_dwordx4 v[100:103], v19, s[12:15], s70 offen offset:1024 sc1
s_waitcnt vmcnt(0)
v_max3_u32 v2, v72, v76, v80
v_max_u32 v2, v2, v84
v_cmp_eq_u32 vcc, -1, v2
s_cbranch_vccnz L_o13_rt
s_branch L_o13_ok
L_o14_rt:
s_add_u32 s78, s78, 1
s_cmp_gt_u32 s78, 65536
s_cbranch_scc1 L_o14_ok
s_add_u32 s70, s89, 14
s_and_b32 s70, s70, 15
s_lshl_b32 s70, s70, 11
buffer_load_dwordx4 v[88:91], v6, s[12:15], s70 offen offset:0 sc1
buffer_load_dwordx4 v[92:95], v19, s[12:15], s70 offen offset:0 sc1
buffer_load_dwordx4 v[96:99], v6, s[12:15], s70 offen offset:1024 sc1
buffer_load_dwordx4 v[100:103], v19, s[12:15], s70 offen offset:1024 sc1
s_add_u32 s70, s89, 15
s_and_b32 s70, s70, 15
s_lshl_b32 s70, s70, 11
buffer_load_dwordx4 v[104:107], v6, s[12:15], s70 offen offset:0 sc1
buffer_load_dwordx4 v[108:111], v19, s[12:15], s70 offen offset:0 sc1
buffer_load_dwordx4 v[112:115], v6, s[12:15], s70 offen offset:1024 sc1
buffer_load_dwordx4 v[116:119], v19, s[12:15], s70 offen offset:1024 sc1
s_waitcnt vmcnt(0)
v_max3_u32 v2, v88, v92, v96
v_max_u32 v2, v2, v100
v_cmp_eq_u32 vcc, -1, v2
s_cbranch_vccnz L_o14_rt
s_branch L_o14_ok
L_o15_rt:
s_add_u32 s78, s78, 1
s_cmp_gt_u32 s78, 65536
s_cbranch_scc1 L_o15_ok
s_add_u32 s70, s89, 15
s_and_b32 s70, s70, 15
s_lshl_b32 s70, s70, 11
buffer_load_dwordx4 v[104:107], v6, s[12:15], s70 offen offset:0 sc1
buffer_load_dwordx4 v[108:111], v19, s[12:15], s70 offen offset:0 sc1
buffer_load_dwordx4 v[112:115], v6, s[12:15], s70 offen offset:1024 sc1
buffer_load_dwordx4 v[116:119], v19, s[12:15], s70 offen offset:1024 sc1
s_waitcnt vmcnt(0)
v_max3_u32 v2, v104, v108, v112
v_max_u32 v2, v2, v116
v_cmp_eq_u32 vcc, -1, v2
s_cbranch_vccnz L_o15_rt
s_branch L_o15_ok
L_stp_s:
buffer_store_dwordx4 v[72:75], v144, s[12:15], s72 offen sc1
s_branch L_stp_d
L_st_rt:
s_add_u32 s78, s78, 1
s_cmp_gt_u32 s78, 65536
s_cbranch_scc1 L_st_ok
v_cmp_ne_u32 vcc, s68, v99
s_cbranch_vccz L_st_p0
s_add_u32 s70, s75, 0
buffer_load_dwordx4 v[96:99], v145, s[12:15], s70 offen sc1
L_st_p0:
v_cmp_ne_u32 vcc, s68, v103
s_cbranch_vccz L_st_p1
s_add_u32 s70, s75, 4096
buffer_load_dwordx4 v[100:103], v145, s[12:15], s70 offen sc1
L_st_p1:
v_cmp_ne_u32 vcc, s68, v107
s_cbranch_vccz L_st_p2
s_add_u32 s70, s75, 8192
buffer_load_dwordx4 v[104:107], v145, s[12:15], s70 offen sc1
L_st_p2:
v_cmp_ne_u32 vcc, s68, v111
s_cbranch_vccz L_st_p3
s_add_u32 s70, s75, 12288
buffer_load_dwordx4 v[108:111], v145, s[12:15], s70 offen sc1
L_st_p3:
v_cmp_ne_u32 vcc, s68, v115
s_cbranch_vccz L_st_p4
s_add_u32 s70, s75, 16384
buffer_load_dwordx4 v[112:115], v145, s[12:15], s70 offen sc1
L_st_p4:
v_cmp_ne_u32 vcc, s68, v119
s_cbranch_vccz L_st_p5
s_add_u32 s70, s75, 20480
buffer_load_dwordx4 v[116:119], v145, s[12:15], s70 offen sc1
L_st_p5:
v_cmp_ne_u32 vcc, s68, v123
s_cbranch_vccz L_st_p6
s_add_u32 s70, s75, 24576
buffer_load_dwordx4 v[120:123], v145, s[12:15], s70 offen sc1
L_st_p6:
v_cmp_ne_u32 vcc, s68, v127
s_cbranch_vccz L_st_p7
s_add_u32 s70, s75, 28672
buffer_load_dwordx4 v[124:127], v145, s[12:15], s70 offen sc1
L_st_p7:
s_waitcnt vmcnt(0)
s_branch L_st_chk
L_rec_rt:
s_add_u32 s78, s78, 1
s_cmp_gt_u32 s78, 65536
s_cbranch_scc1 L_rec_ok
buffer_load_dwordx4 v[84:87], v8, s[12:15], s75 offen sc1
s_waitcnt vmcnt(0)
s_branch L_rec_chk
.section .rodata,"a"
.p2align 6
.amdhsa_kernel sequential_preLN__linear_attn_block__moe_arch_mod__prompt_kernel
  .amdhsa_next_free_vgpr 256
  .amdhsa_next_free_sgpr 102
  .amdhsa_accum_offset 152
  .amdhsa_group_segment_fixed_size 0
  .amdhsa_kernarg_size 88
  .amdhsa_user_sgpr_count 2
  .amdhsa_user_sgpr_kernarg_segment_ptr 1
  .amdhsa_system_sgpr_workgroup_id_x 1
  .amdhsa_float_denorm_mode_32 3
.end_amdhsa_kernel
```

```asm
; @launch grid=(256,1,1) block=(512,1,1) lds=163840
.amdgcn_target "amdgcn-amd-amdhsa--gfx950"
.text
.globl sequential_preLN__linear_attn_block__moe_arch_mod__prompt_kernel
.p2align 8
.type sequential_preLN__linear_attn_block__moe_arch_mod__prompt_kernel,@function
sequential_preLN__linear_attn_block__moe_arch_mod__prompt_kernel:
s_cmp_ge_u32 s2, 256
s_cbranch_scc1 L_end
s_load_dwordx16 s[40:55], s[0:1], 0
s_load_dwordx2 s[56:57], s[0:1], 64
s_load_dwordx2 s[58:59], s[0:1], 80
v_lshrrev_b32 v2, 6, v0
v_and_b32 v1, 63, v0
v_readfirstlane_b32 s60, v2
s_and_b32 s62, s2, 7
s_lshr_b32 s63, s2, 3
s_lshl_b32 s64, s62, 1
s_and_b32 s70, s63, 1
s_add_u32 s64, s64, s70
s_lshr_b32 s65, s63, 1
s_lshl_b32 s79, s64, 4
s_add_u32 s79, s79, s65
s_mov_b32 s78, 0
s_mov_b32 s89, s65
s_lshr_b32 s61, s60, 2
s_and_b32 s60, s60, 3
s_lshr_b32 s66, s60, 1
s_and_b32 s67, s60, 1
v_lshlrev_b32 v16, 4, v1
s_cmp_eq_u32 s61, 0
s_cbranch_scc1 L_compute
s_setprio 1
v_mov_b32 v18, v16
s_lshl_b32 s70, s65, 2
s_add_u32 s70, s70, s60
s_lshl_b32 s70, s70, 16
v_lshrrev_b32 v2, 3, v1
v_lshlrev_b32 v5, 11, v2
v_add_u32 v5, s70, v5
v_lshrrev_b32 v3, 4, v1
v_and_b32 v4, 7, v1
v_xor_b32 v3, v3, v4
v_xor_b32 v6, 0, v3
v_lshl_add_u32 v6, v6, 4, v5
v_add_u32 v8, 0, v6
v_xor_b32 v6, 4, v3
v_lshl_add_u32 v6, v6, 4, v5
v_add_u32 v9, 15360, v6
v_xor_b32 v6, 0, v3
v_lshl_add_u32 v6, v6, 4, v5
v_add_u32 v10, 30720, v6
v_xor_b32 v6, 4, v3
v_lshl_add_u32 v6, v6, 4, v5
v_add_u32 v11, 46080, v6
s_lshl_b32 s70, s60, 4
v_add_u32 v5, s70, v2
v_mul_u32_u24 v5, 6144, v5
s_lshl_b32 s70, s64, 7
v_add_u32 v5, s70, v5
v_bfe_u32 v3, v1, 4, 1
v_lshlrev_b32 v3, 1, v3
v_xor_b32 v3, v3, v4
v_xor_b32 v6, 0, v3
v_lshl_add_u32 v6, v6, 4, v5
v_add_u32 v12, 0, v6
v_xor_b32 v6, 4, v3
v_lshl_add_u32 v6, v6, 4, v5
v_add_u32 v13, 48128, v6
v_xor_b32 v6, 0, v3
v_lshl_add_u32 v6, v6, 4, v5
v_add_u32 v14, 0, v6
v_xor_b32 v6, 4, v3
v_lshl_add_u32 v6, v6, 4, v5
v_add_u32 v15, 48128, v6
v_xor_b32 v6, 0, v3
v_lshl_add_u32 v6, v6, 4, v5
v_add_u32 v16, 4096, v6
v_xor_b32 v6, 4, v3
v_lshl_add_u32 v6, v6, 4, v5
v_add_u32 v17, 52224, v6
s_lshl_b32 s76, s60, 12
s_mul_i32 s77, s60, 6144
s_and_b32 s70, s64, 1
s_lshl_b32 s70, s70, 3
s_mov_b32 s70, 0
s_add_u32 s70, s70, s65
s_and_b32 s70, s70, 15
s_mul_i32 s75, s70, 393216
s_lshl_b32 s74, s70, 7
s_waitcnt lgkmcnt(0)
s_load_dword s68, s[58:59], 0
s_mov_b32 s4, s40
s_and_b32 s5, s41, 0xffff
s_mov_b32 s6, 4194304
s_mov_b32 s7, 0x20000
s_mov_b32 s8, s42
s_and_b32 s9, s43, 0xffff
s_mov_b32 s10, 6291456
s_mov_b32 s11, 0x20000
s_add_u32 m0, s76, 122880
s_nop 0
buffer_load_dwordx4 v8, s[4:7], s74 offen offset:0 lds
buffer_load_dwordx4 v9, s[4:7], s74 offen offset:1024 lds
buffer_load_dwordx4 v10, s[4:7], s74 offen offset:2048 lds
buffer_load_dwordx4 v11, s[4:7], s74 offen offset:3072 lds
s_add_u32 s74, s74, 128
s_and_b32 s74, s74, 2047
s_add_u32 m0, s77, 0
s_nop 0
buffer_load_dwordx4 v12, s[8:11], s75 offen offset:0 lds
buffer_load_dwordx4 v13, s[8:11], s75 offen offset:1024 lds
buffer_load_dwordx4 v14, s[8:11], s75 offen offset:2048 lds
buffer_load_dwordx4 v15, s[8:11], s75 offen offset:3072 lds
s_add_u32 m0, s77, 4096
s_nop 0
buffer_load_dwordx4 v16, s[8:11], s75 offen offset:0 lds
buffer_load_dwordx4 v17, s[8:11], s75 offen offset:1024 lds
s_add_u32 s75, s75, 393216
s_cmp_eq_u32 s75, 6291456
s_cselect_b32 s75, 0, s75
s_mov_b32 s12, s58
s_and_b32 s13, s59, 0xffff
s_mov_b32 s14, 268435456
s_mov_b32 s15, 0x20000
s_mov_b32 s16, s44
s_and_b32 s17, s45, 0xffff
s_mov_b32 s18, 2097152
s_mov_b32 s19, 0x20000
s_mov_b32 s20, s56
s_and_b32 s21, s57, 0xffff
s_mov_b32 s22, 4194304
s_mov_b32 s23, 0x20000
s_mov_b32 s24, s50
s_and_b32 s25, s51, 0xffff
s_mov_b32 s26, 7340032
s_mov_b32 s27, 0x20000
s_mov_b32 s28, s52
s_and_b32 s29, s53, 0xffff
s_mov_b32 s30, 7340032
s_mov_b32 s31, 0x20000
s_mov_b32 s32, s54
s_and_b32 s33, s55, 0xffff
s_mov_b32 s34, 7340032
s_mov_b32 s35, 0x20000
s_mov_b32 s36, s48
s_and_b32 s37, s49, 0xffff
s_mov_b32 s38, 2048
s_mov_b32 s39, 0x20000
s_lshl_b32 s70, s65, 7
s_lshl_b32 s71, s64, 3
s_add_u32 s70, s70, s71
s_lshl_b32 s71, s60, 1
s_add_u32 s87, s70, s71
v_lshrrev_b32 v2, 3, v1
v_lshlrev_b32 v3, 11, v2
v_bfe_u32 v5, v1, 4, 2
v_lshlrev_b32 v5, 1, v5
v_and_b32 v4, 7, v1
v_xor_b32 v5, v5, v4
v_lshl_add_u32 v3, v5, 4, v3
s_lshl_b32 s70, s65, 7
v_add_u32 v80, s70, v3
v_mov_b32 v72, -1
v_mov_b32 v73, -1
v_mov_b32 v74, -1
v_mov_b32 v75, -1
s_mul_i32 s80, s79, 4352
s_add_u32 s80, s80, 524288
s_lshl_b32 s81, s65, 18
s_lshl_b32 s70, s66, 17
s_add_u32 s81, s81, s70
s_lshl_b32 s70, s64, 11
s_add_u32 s81, s81, s70
s_lshl_b32 s70, s67, 10
s_add_u32 s81, s81, s70
s_add_u32 s81, s81, 2097152
v_mul_u32_u24 v76, 7168, v2
v_lshl_add_u32 v76, v4, 4, v76
v_lshlrev_b32 v77, 11, v2
v_lshl_add_u32 v77, v4, 4, v77
s_and_b32 s70, s65, 3
s_lshl_b32 s70, s70, 2
s_add_u32 s70, s70, s60
s_mul_i32 s85, s70, 458752
s_lshr_b32 s70, s79, 2
s_lshl_b32 s70, s70, 7
s_add_u32 s85, s85, s70
s_lshl_b32 s70, s64, 2
s_add_u32 s70, s70, s60
s_lshl_b32 s86, s70, 17
s_lshl_b32 s70, s65, 7
s_add_u32 s86, s86, s70
s_cmp_lt_u32 s64, 14
s_cselect_b32 s26, s26, 0
s_cselect_b32 s30, s30, 0
s_cselect_b32 s34, s34, 0
s_mov_b32 s90, 0x10001
s_movk_i32 s91, 0xff
v_mov_b32 v79, 0
s_lshl_b32 s70, s87, 4
s_add_u32 s70, s70, 8192
v_writelane_b32 v79, s70, 0
s_lshl_b32 s70, s79, 4
s_add_u32 s70, s70, 4096
v_writelane_b32 v79, s70, 1
s_lshl_b32 s70, s64, 7
s_add_u32 s70, s70, 6815744
v_writelane_b32 v79, s70, 2
s_lshl_b32 s70, s79, 10
s_add_u32 s70, s70, 65536
v_writelane_b32 v79, s70, 3
s_lshl_b32 s70, s60, 10
s_add_u32 s70, s70, s80
v_writelane_b32 v79, s70, 4
s_lshl_b32 s70, s67, 7
s_add_u32 s70, s70, s80
s_add_u32 s70, s70, 4096
v_writelane_b32 v79, s70, 5
s_lshl_b32 s71, s64, 2
s_add_u32 s71, s71, s60
s_lshl_b32 s71, s71, 7
s_lshl_b32 s70, s65, 15
s_add_u32 s70, s70, s71
s_add_u32 s70, s70, 7340032
v_writelane_b32 v79, s70, 6
s_lshl_b32 s71, s79, 2
s_add_u32 s71, s71, s60
s_lshl_b32 s70, s71, 9
s_add_u32 s70, s70, 6291456
v_writelane_b32 v79, s70, 7
s_lshl_b32 s71, s79, 2
s_add_u32 s71, s71, s60
s_lshl_b32 s70, s71, 8
s_add_u32 s70, s70, 6946816
v_writelane_b32 v79, s70, 8
s_add_u32 s70, s81, 0
v_writelane_b32 v79, s70, 9
s_add_u32 s70, s81, 32768
v_writelane_b32 v79, s70, 10
s_add_u32 s70, s81, 65536
v_writelane_b32 v79, s70, 11
s_add_u32 s70, s81, 98304
v_writelane_b32 v79, s70, 12
s_and_b32 s70, s65, 7
s_min_u32 s71, s60, 0
s_lshl_b32 s71, s71, 3
s_add_u32 s70, s70, s71
s_lshl_b32 s70, s70, 4
s_add_u32 s70, s70, s64
s_lshl_b32 s70, s70, 7
s_add_u32 s70, s70, 6815744
v_writelane_b32 v79, s70, 2
v_and_b32 v2, 7, v1
v_lshlrev_b32 v2, 7, v2
v_lshrrev_b32 v3, 3, v1
v_lshl_add_u32 v83, v3, 15, v2
v_add_u32 v83, s81, v83
s_mov_b32 exec_lo, 0
s_lshl_b32 s71, s64, 2
s_add_u32 s71, s71, s60
s_lshl_b32 s71, s71, 7
s_lshl_b32 s70, s65, 15
s_add_u32 s70, s70, s71
s_add_u32 s70, s70, 7340032
s_mov_b32 exec_hi, 0xff
v_and_b32 v2, 3, v1
v_lshl_add_u32 v83, v2, 13, s70
s_lshl_b32 s70, s60, 10
s_add_u32 s70, s70, s80
s_mov_b32 exec_hi, 0xff0000
v_and_b32 v2, 7, v1
v_lshl_add_u32 v83, v2, 7, s70
s_lshl_b32 s71, s79, 2
s_add_u32 s71, s71, s60
s_lshl_b32 s70, s71, 9
s_add_u32 s70, s70, 6291456
s_mov_b32 exec_hi, 0xf000000
v_and_b32 v2, 3, v1
v_lshl_add_u32 v83, v2, 7, s70
s_lshl_b32 s71, s79, 2
s_add_u32 s71, s71, s60
s_lshl_b32 s70, s71, 8
s_add_u32 s70, s70, 6946816
s_mov_b32 exec_hi, 0x30000000
v_and_b32 v2, 1, v1
v_lshl_add_u32 v83, v2, 7, s70
s_lshl_b32 s70, s67, 7
s_add_u32 s70, s70, s80
s_add_u32 s70, s70, 4096
s_mov_b32 exec_hi, 0xc0000000
v_and_b32 v2, 0, v1
v_lshl_add_u32 v83, v2, 7, s70
s_mov_b64 exec, -1
s_add_u32 m0, s76, 106496
s_nop 0
buffer_load_dwordx4 v8, s[4:7], s74 offen offset:0 lds
buffer_load_dwordx4 v9, s[4:7], s74 offen offset:1024 lds
buffer_load_dwordx4 v10, s[4:7], s74 offen offset:2048 lds
buffer_load_dwordx4 v11, s[4:7], s74 offen offset:3072 lds
s_add_u32 s74, s74, 128
s_and_b32 s74, s74, 2047
s_add_u32 m0, s77, 81920
s_nop 0
buffer_load_dwordx4 v12, s[8:11], s75 offen offset:0 lds
buffer_load_dwordx4 v13, s[8:11], s75 offen offset:1024 lds
buffer_load_dwordx4 v14, s[8:11], s75 offen offset:2048 lds
buffer_load_dwordx4 v15, s[8:11], s75 offen offset:3072 lds
s_add_u32 m0, s77, 86016
s_nop 0
buffer_load_dwordx4 v16, s[8:11], s75 offen offset:0 lds
buffer_load_dwordx4 v17, s[8:11], s75 offen offset:1024 lds
s_add_u32 s75, s75, 393216
s_cmp_eq_u32 s75, 6291456
s_cselect_b32 s75, 0, s75
s_getpc_b64 s[70:71]
L_pc:
s_sub_u32 s96, s70, L_pc-sequential_preLN__linear_attn_block__moe_arch_mod__prompt_kernel
s_subb_u32 s97, s71, 0
s_and_b32 s97, s97, 0xffff
s_mov_b32 s98, L_fin-sequential_preLN__linear_attn_block__moe_arch_mod__prompt_kernel
s_mov_b32 s99, 0x20000
s_mul_i32 s70, s63, 12
s_mul_i32 s71, s60, 3
s_add_u32 s70, s70, s71
v_add_u32 v81, s70, v1
v_lshlrev_b32 v81, 7, v81
s_mov_b64 exec, 7
buffer_load_dword v81, v81, s[96:99], 0 offen
s_mov_b64 exec, -1
s_waitcnt vmcnt(11)
s_barrier
s_add_u32 m0, s76, 65536
s_nop 0
buffer_load_dwordx4 v8, s[4:7], s74 offen offset:0 lds
buffer_load_dwordx4 v9, s[4:7], s74 offen offset:1024 lds
buffer_load_dwordx4 v10, s[4:7], s74 offen offset:2048 lds
buffer_load_dwordx4 v11, s[4:7], s74 offen offset:3072 lds
s_add_u32 s74, s74, 128
s_and_b32 s74, s74, 2047
s_add_u32 m0, s77, 40960
s_nop 0
buffer_load_dwordx4 v12, s[8:11], s75 offen offset:0 lds
buffer_load_dwordx4 v13, s[8:11], s75 offen offset:1024 lds
buffer_load_dwordx4 v14, s[8:11], s75 offen offset:2048 lds
buffer_load_dwordx4 v15, s[8:11], s75 offen offset:3072 lds
s_add_u32 m0, s77, 45056
s_nop 0
buffer_load_dwordx4 v16, s[8:11], s75 offen offset:0 lds
buffer_load_dwordx4 v17, s[8:11], s75 offen offset:1024 lds
s_add_u32 s75, s75, 393216
s_cmp_eq_u32 s75, 6291456
s_cselect_b32 s75, 0, s75
s_waitcnt vmcnt(11)
s_barrier
s_add_u32 m0, s76, 24576
s_nop 0
buffer_load_dwordx4 v8, s[4:7], s74 offen offset:0 lds
buffer_load_dwordx4 v9, s[4:7], s74 offen offset:1024 lds
buffer_load_dwordx4 v10, s[4:7], s74 offen offset:2048 lds
buffer_load_dwordx4 v11, s[4:7], s74 offen offset:3072 lds
s_add_u32 s74, s74, 128
s_and_b32 s74, s74, 2047
s_add_u32 m0, s77, 0
s_nop 0
buffer_load_dwordx4 v12, s[8:11], s75 offen offset:0 lds
buffer_load_dwordx4 v13, s[8:11], s75 offen offset:1024 lds
buffer_load_dwordx4 v14, s[8:11], s75 offen offset:2048 lds
buffer_load_dwordx4 v15, s[8:11], s75 offen offset:3072 lds
s_add_u32 m0, s77, 4096
s_nop 0
buffer_load_dwordx4 v16, s[8:11], s75 offen offset:0 lds
buffer_load_dwordx4 v17, s[8:11], s75 offen offset:1024 lds
s_add_u32 s75, s75, 393216
s_cmp_eq_u32 s75, 6291456
s_cselect_b32 s75, 0, s75
s_add_u32 m0, s76, 122880
s_nop 0
buffer_load_dwordx4 v8, s[4:7], s74 offen offset:0 lds
buffer_load_dwordx4 v9, s[4:7], s74 offen offset:1024 lds
buffer_load_dwordx4 v10, s[4:7], s74 offen offset:2048 lds
buffer_load_dwordx4 v11, s[4:7], s74 offen offset:3072 lds
s_add_u32 s74, s74, 128
s_and_b32 s74, s74, 2047
v_lshlrev_b32 v2, 3, v1
s_lshl_b32 s70, s60, 9
buffer_load_dwordx2 v[88:89], v2, s[36:39], s70 offen
s_lshl_b32 s70, s87, 11
buffer_load_dwordx4 v[20:23], v18, s[4:7], s70 offen offset:0
s_lshl_b32 s70, s87, 11
buffer_load_dwordx4 v[24:27], v18, s[4:7], s70 offen offset:1024
s_lshl_b32 s70, s87, 11
buffer_load_dwordx4 v[28:31], v18, s[4:7], s70 offen offset:2048
s_lshl_b32 s70, s87, 11
buffer_load_dwordx4 v[32:35], v18, s[4:7], s70 offen offset:3072
s_mov_b64 exec, 0x1fff
buffer_load_dword v81, v79, s[12:15], 0 offen
s_mov_b64 exec, -1
s_lshl_b32 s70, s64, 2
s_add_u32 s70, s70, s60
s_lshl_b32 s70, s70, 12
s_lshl_b32 s71, s65, 7
s_add_u32 s70, s70, s71
s_add_u32 s70, s70, 7864320
s_mov_b64 exec, 0xffff
buffer_store_dwordx4 v[72:75], v77, s[12:15], s70 offen sc1
s_mov_b64 exec, -1
s_waitcnt vmcnt(21)
s_barrier
s_add_u32 m0, s77, 81920
s_nop 0
buffer_load_dwordx4 v12, s[8:11], s75 offen offset:0 lds
buffer_load_dwordx4 v13, s[8:11], s75 offen offset:1024 lds
buffer_load_dwordx4 v14, s[8:11], s75 offen offset:2048 lds
buffer_load_dwordx4 v15, s[8:11], s75 offen offset:3072 lds
s_add_u32 m0, s77, 86016
s_nop 0
buffer_load_dwordx4 v16, s[8:11], s75 offen offset:0 lds
buffer_load_dwordx4 v17, s[8:11], s75 offen offset:1024 lds
s_add_u32 s75, s75, 393216
s_cmp_eq_u32 s75, 6291456
s_cselect_b32 s75, 0, s75
s_add_u32 m0, s76, 106496
s_nop 0
buffer_load_dwordx4 v8, s[4:7], s74 offen offset:0 lds
buffer_load_dwordx4 v9, s[4:7], s74 offen offset:1024 lds
buffer_load_dwordx4 v10, s[4:7], s74 offen offset:2048 lds
buffer_load_dwordx4 v11, s[4:7], s74 offen offset:3072 lds
s_add_u32 s74, s74, 128
s_and_b32 s74, s74, 2047
s_waitcnt vmcnt(21)
s_barrier
s_add_u32 m0, s77, 40960
s_nop 0
buffer_load_dwordx4 v12, s[8:11], s75 offen offset:0 lds
s_waitcnt vmcnt(13)
s_waitcnt lgkmcnt(0)
s_add_u32 s68, s68, 1
s_and_b32 s84, s68, 0xff
s_not_b32 s70, s68
v_and_b32 v82, 3, v1
v_lshrrev_b32_e64 v82, v82, s70
v_and_b32 v82, 1, v82
v_mul_u32_u24 v82, 0x10001, v82
buffer_load_dwordx4 v13, s[8:11], s75 offen offset:1024 lds
v_lshlrev_b32 v36, 16, v20
v_and_b32 v37, 0xffff0000, v20
v_lshlrev_b32 v38, 16, v21
v_and_b32 v39, 0xffff0000, v21
v_lshlrev_b32 v40, 16, v22
buffer_load_dwordx4 v14, s[8:11], s75 offen offset:2048 lds
v_and_b32 v41, 0xffff0000, v22
v_lshlrev_b32 v42, 16, v23
v_and_b32 v43, 0xffff0000, v23
v_lshlrev_b32 v44, 16, v24
v_and_b32 v45, 0xffff0000, v24
buffer_load_dwordx4 v15, s[8:11], s75 offen offset:3072 lds
v_lshlrev_b32 v46, 16, v25
v_and_b32 v47, 0xffff0000, v25
v_lshlrev_b32 v48, 16, v26
v_and_b32 v49, 0xffff0000, v26
v_lshlrev_b32 v50, 16, v27
s_add_u32 m0, s77, 45056
s_nop 0
buffer_load_dwordx4 v16, s[8:11], s75 offen offset:0 lds
v_and_b32 v51, 0xffff0000, v27
v_lshlrev_b32 v52, 16, v28
v_and_b32 v53, 0xffff0000, v28
v_lshlrev_b32 v54, 16, v29
v_and_b32 v55, 0xffff0000, v29
buffer_load_dwordx4 v17, s[8:11], s75 offen offset:1024 lds
s_add_u32 s75, s75, 393216
s_cmp_eq_u32 s75, 6291456
s_cselect_b32 s75, 0, s75
v_lshlrev_b32 v56, 16, v30
v_and_b32 v57, 0xffff0000, v30
v_lshlrev_b32 v58, 16, v31
v_and_b32 v59, 0xffff0000, v31
v_lshlrev_b32 v60, 16, v32
s_add_u32 m0, s76, 65536
s_nop 0
buffer_load_dwordx4 v8, s[4:7], s74 offen offset:0 lds
v_and_b32 v61, 0xffff0000, v32
v_lshlrev_b32 v62, 16, v33
v_and_b32 v63, 0xffff0000, v33
v_lshlrev_b32 v64, 16, v34
v_and_b32 v65, 0xffff0000, v34
buffer_load_dwordx4 v9, s[4:7], s74 offen offset:1024 lds
v_lshlrev_b32 v66, 16, v35
v_and_b32 v67, 0xffff0000, v35
v_add_f32 v20, v36, v40
v_add_f32 v28, v52, v56
v_add_f32 v21, v37, v41
buffer_load_dwordx4 v10, s[4:7], s74 offen offset:2048 lds
v_add_f32 v29, v53, v57
v_add_f32 v22, v38, v42
v_add_f32 v30, v54, v58
v_add_f32 v23, v39, v43
v_add_f32 v31, v55, v59
buffer_load_dwordx4 v11, s[4:7], s74 offen offset:3072 lds
s_add_u32 s74, s74, 128
s_and_b32 s74, s74, 2047
v_add_f32 v20, v20, v44
v_add_f32 v28, v28, v60
s_waitcnt vmcnt(14)
s_barrier
s_add_u32 m0, s77, 0
s_nop 0
buffer_load_dwordx4 v12, s[8:11], s75 offen offset:0 lds
v_add_f32 v21, v21, v45
v_add_f32 v29, v29, v61
v_add_f32 v22, v22, v46
v_add_f32 v30, v30, v62
v_add_f32 v23, v23, v47
buffer_load_dwordx4 v13, s[8:11], s75 offen offset:1024 lds
v_add_f32 v31, v31, v63
v_add_f32 v20, v20, v48
v_add_f32 v28, v28, v64
v_add_f32 v21, v21, v49
v_add_f32 v29, v29, v65
buffer_load_dwordx4 v14, s[8:11], s75 offen offset:2048 lds
v_add_f32 v22, v22, v50
v_add_f32 v30, v30, v66
v_add_f32 v23, v23, v51
v_add_f32 v31, v31, v67
v_add_f32 v20, v20, v21
buffer_load_dwordx4 v15, s[8:11], s75 offen offset:3072 lds
v_add_f32 v22, v22, v23
v_add_f32 v28, v28, v29
v_add_f32 v30, v30, v31
v_add_f32 v2, v20, v22
v_add_f32 v4, v28, v30
s_add_u32 m0, s77, 4096
s_nop 0
buffer_load_dwordx4 v16, s[8:11], s75 offen offset:0 lds
v_add_f32_dpp v2, v2, v2 row_ror:1 row_mask:0xf bank_mask:0xf
v_add_f32_dpp v4, v4, v4 row_ror:1 row_mask:0xf bank_mask:0xf
s_nop 0
v_add_f32_dpp v2, v2, v2 row_ror:2 row_mask:0xf bank_mask:0xf
v_add_f32_dpp v4, v4, v4 row_ror:2 row_mask:0xf bank_mask:0xf
s_nop 0
v_add_f32_dpp v2, v2, v2 row_ror:4 row_mask:0xf bank_mask:0xf
buffer_load_dwordx4 v17, s[8:11], s75 offen offset:1024 lds
s_add_u32 s75, s75, 393216
s_cmp_eq_u32 s75, 6291456
s_cselect_b32 s75, 0, s75
v_add_f32_dpp v4, v4, v4 row_ror:4 row_mask:0xf bank_mask:0xf
v_add_f32_dpp v2, v2, v2 row_ror:8 row_mask:0xf bank_mask:0xf
s_nop 0
v_add_f32_dpp v4, v4, v4 row_ror:8 row_mask:0xf bank_mask:0xf
v_mov_b32 v6, v2
v_mov_b32 v7, v4
s_add_u32 m0, s76, 24576
s_nop 0
buffer_load_dwordx4 v8, s[4:7], s74 offen offset:0 lds
v_permlane16_swap_b32 v2, v6
v_permlane16_swap_b32 v4, v7
v_add_f32 v2, v2, v6
v_add_f32 v4, v4, v7
v_mov_b32 v6, v2
buffer_load_dwordx4 v9, s[4:7], s74 offen offset:1024 lds
v_mov_b32 v7, v4
v_permlane32_swap_b32 v2, v6
s_nop 0
v_permlane32_swap_b32 v4, v7
v_add_f32 v2, v2, v6
v_add_f32 v4, v4, v7
buffer_load_dwordx4 v10, s[4:7], s74 offen offset:2048 lds
v_mul_f32 v2, 0xba800000, v2
v_mul_f32 v4, 0xba800000, v4
v_add_f32 v36, v36, v2
v_add_f32 v52, v52, v4
v_add_f32 v37, v37, v2
buffer_load_dwordx4 v11, s[4:7], s74 offen offset:3072 lds
s_add_u32 s74, s74, 128
s_and_b32 s74, s74, 2047
v_add_f32 v53, v53, v4
v_add_f32 v38, v38, v2
s_waitcnt vmcnt(14)
s_barrier
s_add_u32 m0, s77, 81920
s_nop 0
buffer_load_dwordx4 v12, s[8:11], s75 offen offset:0 lds
v_add_f32 v54, v54, v4
v_add_f32 v39, v39, v2
v_add_f32 v55, v55, v4
v_add_f32 v40, v40, v2
v_add_f32 v56, v56, v4
buffer_load_dwordx4 v13, s[8:11], s75 offen offset:1024 lds
v_add_f32 v41, v41, v2
v_add_f32 v57, v57, v4
v_add_f32 v42, v42, v2
v_add_f32 v58, v58, v4
v_add_f32 v43, v43, v2
buffer_load_dwordx4 v14, s[8:11], s75 offen offset:2048 lds
v_add_f32 v59, v59, v4
v_add_f32 v44, v44, v2
v_add_f32 v60, v60, v4
v_add_f32 v45, v45, v2
v_add_f32 v61, v61, v4
buffer_load_dwordx4 v15, s[8:11], s75 offen offset:3072 lds
v_add_f32 v46, v46, v2
v_add_f32 v62, v62, v4
v_add_f32 v47, v47, v2
v_add_f32 v63, v63, v4
v_add_f32 v48, v48, v2
s_add_u32 m0, s77, 86016
s_nop 0
buffer_load_dwordx4 v16, s[8:11], s75 offen offset:0 lds
v_add_f32 v64, v64, v4
v_add_f32 v49, v49, v2
v_add_f32 v65, v65, v4
v_add_f32 v50, v50, v2
v_add_f32 v66, v66, v4
buffer_load_dwordx4 v17, s[8:11], s75 offen offset:1024 lds
s_add_u32 s75, s75, 393216
s_cmp_eq_u32 s75, 6291456
s_cselect_b32 s75, 0, s75
v_add_f32 v51, v51, v2
v_add_f32 v67, v67, v4
v_mul_f32 v20, v36, v36
v_mul_f32 v28, v52, v52
v_mul_f32 v21, v37, v37
s_add_u32 m0, s76, 122880
s_nop 0
buffer_load_dwordx4 v8, s[4:7], s74 offen offset:0 lds
v_mul_f32 v29, v53, v53
v_fmac_f32 v20, v38, v38
v_fmac_f32 v28, v54, v54
v_fmac_f32 v21, v39, v39
v_fmac_f32 v29, v55, v55
buffer_load_dwordx4 v9, s[4:7], s74 offen offset:1024 lds
v_fmac_f32 v20, v40, v40
v_fmac_f32 v28, v56, v56
v_fmac_f32 v21, v41, v41
v_fmac_f32 v29, v57, v57
v_fmac_f32 v20, v42, v42
buffer_load_dwordx4 v10, s[4:7], s74 offen offset:2048 lds
v_fmac_f32 v28, v58, v58
v_fmac_f32 v21, v43, v43
v_fmac_f32 v29, v59, v59
v_fmac_f32 v20, v44, v44
v_fmac_f32 v28, v60, v60
buffer_load_dwordx4 v11, s[4:7], s74 offen offset:3072 lds
s_add_u32 s74, s74, 128
s_and_b32 s74, s74, 2047
v_fmac_f32 v21, v45, v45
v_fmac_f32 v29, v61, v61
s_waitcnt vmcnt(14)
s_barrier
s_add_u32 m0, s77, 40960
s_nop 0
buffer_load_dwordx4 v12, s[8:11], s75 offen offset:0 lds
v_fmac_f32 v20, v46, v46
v_fmac_f32 v28, v62, v62
v_fmac_f32 v21, v47, v47
v_fmac_f32 v29, v63, v63
v_fmac_f32 v20, v48, v48
buffer_load_dwordx4 v13, s[8:11], s75 offen offset:1024 lds
v_fmac_f32 v28, v64, v64
v_fmac_f32 v21, v49, v49
v_fmac_f32 v29, v65, v65
v_fmac_f32 v20, v50, v50
v_fmac_f32 v28, v66, v66
buffer_load_dwordx4 v14, s[8:11], s75 offen offset:2048 lds
v_fmac_f32 v21, v51, v51
v_fmac_f32 v29, v67, v67
v_add_f32 v3, v20, v21
v_add_f32 v5, v28, v29
s_nop 0
v_add_f32_dpp v3, v3, v3 row_ror:1 row_mask:0xf bank_mask:0xf
buffer_load_dwordx4 v15, s[8:11], s75 offen offset:3072 lds
v_add_f32_dpp v5, v5, v5 row_ror:1 row_mask:0xf bank_mask:0xf
v_add_f32_dpp v3, v3, v3 row_ror:2 row_mask:0xf bank_mask:0xf
s_nop 0
v_add_f32_dpp v5, v5, v5 row_ror:2 row_mask:0xf bank_mask:0xf
v_add_f32_dpp v3, v3, v3 row_ror:4 row_mask:0xf bank_mask:0xf
s_nop 0
v_add_f32_dpp v5, v5, v5 row_ror:4 row_mask:0xf bank_mask:0xf
s_add_u32 m0, s77, 45056
s_nop 0
buffer_load_dwordx4 v16, s[8:11], s75 offen offset:0 lds
v_add_f32_dpp v3, v3, v3 row_ror:8 row_mask:0xf bank_mask:0xf
v_add_f32_dpp v5, v5, v5 row_ror:8 row_mask:0xf bank_mask:0xf
v_mov_b32 v6, v3
v_mov_b32 v7, v5
s_nop 0
v_permlane16_swap_b32 v3, v6
buffer_load_dwordx4 v17, s[8:11], s75 offen offset:1024 lds
s_add_u32 s75, s75, 393216
s_cmp_eq_u32 s75, 6291456
s_cselect_b32 s75, 0, s75
v_permlane16_swap_b32 v5, v7
v_add_f32 v3, v3, v6
v_add_f32 v5, v5, v7
v_mov_b32 v6, v3
v_mov_b32 v7, v5
s_add_u32 m0, s76, 106496
s_nop 0
buffer_load_dwordx4 v8, s[4:7], s74 offen offset:0 lds
v_permlane32_swap_b32 v3, v6
v_permlane32_swap_b32 v5, v7
v_add_f32 v3, v3, v6
v_add_f32 v5, v5, v7
v_mov_b32 v6, 0x3727c5ac
buffer_load_dwordx4 v9, s[4:7], s74 offen offset:1024 lds
v_fmac_f32 v6, 0x3a800000, v3
v_rsq_f32 v3, v6
v_mov_b32 v6, 0x3727c5ac
v_fmac_f32 v6, 0x3a800000, v5
v_rsq_f32 v5, v6
buffer_load_dwordx4 v10, s[4:7], s74 offen offset:2048 lds
v_cmp_eq_u32 vcc, 1, v1
s_nop 1
v_cndmask_b32 v20, v2, v4, vcc
v_cndmask_b32 v21, v3, v5, vcc
v_mov_b32 v22, 0
v_mov_b32 v23, s68
buffer_load_dwordx4 v11, s[4:7], s74 offen offset:3072 lds
s_add_u32 s74, s74, 128
s_and_b32 s74, s74, 2047
buffer_load_dwordx4 a[0:3], v76, s[24:27], s85 offen nt
buffer_load_dwordx4 a[32:35], v76, s[28:31], s85 offen nt
s_add_u32 s85, s85, 57344
buffer_load_dwordx4 a[4:7], v76, s[24:27], s85 offen nt
buffer_load_dwordx4 a[36:39], v76, s[28:31], s85 offen nt
s_add_u32 s85, s85, 57344
buffer_load_dwordx4 a[8:11], v76, s[24:27], s85 offen nt
buffer_load_dwordx4 a[40:43], v76, s[28:31], s85 offen nt
s_add_u32 s85, s85, 57344
s_lshl_b32 s70, s87, 4
s_add_u32 s70, s70, 8192
s_mov_b64 exec, 3
buffer_store_dwordx4 v[20:23], v18, s[12:15], s70 offen sc1
s_mov_b64 exec, -1
s_waitcnt vmcnt(21)
s_barrier
s_add_u32 m0, s77, 0
s_nop 0
buffer_load_dwordx4 v12, s[8:11], s75 offen offset:0 lds
v_lshlrev_b32 v2, 16, v88
v_and_b32 v3, 0xffff0000, v88
v_lshlrev_b32 v4, 16, v89
buffer_load_dwordx4 v13, s[8:11], s75 offen offset:1024 lds
v_and_b32 v5, 0xffff0000, v89
v_add_f32 v2, v2, v3
v_add_f32 v4, v4, v5
buffer_load_dwordx4 v14, s[8:11], s75 offen offset:2048 lds
v_add_f32 v2, v2, v4
s_nop 1
v_add_f32_dpp v2, v2, v2 row_ror:1 row_mask:0xf bank_mask:0xf
s_nop 1
v_add_f32_dpp v2, v2, v2 row_ror:2 row_mask:0xf bank_mask:0xf
buffer_load_dwordx4 v15, s[8:11], s75 offen offset:3072 lds
s_nop 0
v_add_f32_dpp v2, v2, v2 row_ror:4 row_mask:0xf bank_mask:0xf
s_nop 1
v_add_f32_dpp v2, v2, v2 row_ror:8 row_mask:0xf bank_mask:0xf
v_mov_b32 v3, v2
s_add_u32 m0, s77, 4096
s_nop 0
buffer_load_dwordx4 v16, s[8:11], s75 offen offset:0 lds
v_permlane16_swap_b32 v2, v3
v_add_f32 v2, v2, v3
v_mov_b32 v3, v2
buffer_load_dwordx4 v17, s[8:11], s75 offen offset:1024 lds
s_add_u32 s75, s75, 393216
s_cmp_eq_u32 s75, 6291456
s_cselect_b32 s75, 0, s75
v_permlane32_swap_b32 v2, v3
v_add_f32 v2, v2, v3
s_lshl_b32 s70, s60, 2
s_add_u32 s70, s70, 162176
v_mov_b32 v3, s70
s_add_u32 m0, s76, 65536
s_nop 0
buffer_load_dwordx4 v8, s[4:7], s74 offen offset:0 lds
ds_write_b32 v3, v2
s_lshl_b32 s70, s60, 2
s_sub_u32 s70, s70, s65
s_lshl_b32 s70, s70, 4
v_add_u32 v4, s70, v1
v_min_u32 v4, 18, v4
buffer_load_dwordx4 v9, s[4:7], s74 offen offset:1024 lds
v_cmp_gt_u32 vcc, 16, v4
s_nop 1
v_cndmask_b32 v4, 18, v4, vcc
v_lshlrev_b32 v4, 3, v4
buffer_load_dwordx4 v10, s[4:7], s74 offen offset:2048 lds
v_add_u32 v4, 162048, v4
ds_write_b64 v4, v[88:89]
buffer_load_dwordx4 v11, s[4:7], s74 offen offset:3072 lds
s_add_u32 s74, s74, 128
s_and_b32 s74, s74, 2047
s_waitcnt vmcnt(21)
s_barrier
s_add_u32 m0, s77, 81920
s_nop 0
buffer_load_dwordx4 v12, s[8:11], s75 offen offset:0 lds
s_getreg_b32 s71, hwreg(HW_REG_XCC_ID, 0, 4)
v_mov_b32 v84, s71
buffer_load_dwordx4 v13, s[8:11], s75 offen offset:1024 lds
v_mov_b32 v85, 0
buffer_load_dwordx4 v14, s[8:11], s75 offen offset:2048 lds
v_mov_b32 v86, 0
buffer_load_dwordx4 v15, s[8:11], s75 offen offset:3072 lds
v_mov_b32 v87, s68
s_add_u32 m0, s77, 86016
s_nop 0
buffer_load_dwordx4 v16, s[8:11], s75 offen offset:0 lds
buffer_load_dwordx4 v17, s[8:11], s75 offen offset:1024 lds
s_add_u32 s75, s75, 393216
s_cmp_eq_u32 s75, 6291456
s_cselect_b32 s75, 0, s75
s_add_u32 m0, s76, 24576
s_nop 0
buffer_load_dwordx4 v8, s[4:7], s74 offen offset:0 lds
buffer_load_dwordx4 v9, s[4:7], s74 offen offset:1024 lds
buffer_load_dwordx4 v10, s[4:7], s74 offen offset:2048 lds
buffer_load_dwordx4 v11, s[4:7], s74 offen offset:3072 lds
s_add_u32 s74, s74, 128
s_and_b32 s74, s74, 2047
buffer_load_dwordx4 a[12:15], v76, s[24:27], s85 offen nt
buffer_load_dwordx4 a[44:47], v76, s[28:31], s85 offen nt
s_add_u32 s85, s85, 57344
buffer_load_dwordx4 a[16:19], v76, s[24:27], s85 offen nt
buffer_load_dwordx4 a[48:51], v76, s[28:31], s85 offen nt
s_add_u32 s85, s85, 57344
buffer_load_dwordx4 a[20:23], v76, s[24:27], s85 offen nt
buffer_load_dwordx4 a[52:55], v76, s[28:31], s85 offen nt
s_add_u32 s85, s85, 57344
s_lshl_b32 s70, s79, 4
s_add_u32 s70, s70, 4096
s_mov_b64 exec, 1
buffer_store_dwordx4 v[84:87], v18, s[12:15], s70 offen sc1
s_mov_b64 exec, -1
s_waitcnt vmcnt(21)
s_barrier
s_add_u32 m0, s77, 40960
s_nop 0
buffer_load_dwordx4 v12, s[8:11], s75 offen offset:0 lds
buffer_load_dwordx4 v13, s[8:11], s75 offen offset:1024 lds
buffer_load_dwordx4 v14, s[8:11], s75 offen offset:2048 lds
buffer_load_dwordx4 v15, s[8:11], s75 offen offset:3072 lds
s_add_u32 m0, s77, 45056
s_nop 0
buffer_load_dwordx4 v16, s[8:11], s75 offen offset:0 lds
buffer_load_dwordx4 v17, s[8:11], s75 offen offset:1024 lds
s_add_u32 s75, s75, 393216
s_cmp_eq_u32 s75, 6291456
s_cselect_b32 s75, 0, s75
s_add_u32 m0, s76, 122880
s_nop 0
buffer_load_dwordx4 v8, s[4:7], s74 offen offset:0 lds
buffer_load_dwordx4 v9, s[4:7], s74 offen offset:1024 lds
buffer_load_dwordx4 v10, s[4:7], s74 offen offset:2048 lds
buffer_load_dwordx4 v11, s[4:7], s74 offen offset:3072 lds
s_add_u32 s74, s74, 128
s_and_b32 s74, s74, 2047
s_waitcnt vmcnt(21)
s_barrier
s_add_u32 m0, s77, 0
s_nop 0
buffer_load_dwordx4 v12, s[8:11], s75 offen offset:0 lds
buffer_load_dwordx4 v13, s[8:11], s75 offen offset:1024 lds
buffer_load_dwordx4 v14, s[8:11], s75 offen offset:2048 lds
buffer_load_dwordx4 v15, s[8:11], s75 offen offset:3072 lds
s_add_u32 m0, s77, 4096
s_nop 0
buffer_load_dwordx4 v16, s[8:11], s75 offen offset:0 lds
buffer_load_dwordx4 v17, s[8:11], s75 offen offset:1024 lds
s_add_u32 s75, s75, 393216
s_cmp_eq_u32 s75, 6291456
s_cselect_b32 s75, 0, s75
s_add_u32 m0, s76, 106496
s_nop 0
buffer_load_dwordx4 v8, s[4:7], s74 offen offset:0 lds
buffer_load_dwordx4 v9, s[4:7], s74 offen offset:1024 lds
buffer_load_dwordx4 v10, s[4:7], s74 offen offset:2048 lds
buffer_load_dwordx4 v11, s[4:7], s74 offen offset:3072 lds
s_add_u32 s74, s74, 128
s_and_b32 s74, s74, 2047
buffer_load_dwordx4 a[24:27], v76, s[24:27], s85 offen nt
buffer_load_dwordx4 a[56:59], v76, s[28:31], s85 offen nt
s_add_u32 s85, s85, 57344
buffer_load_dwordx4 a[28:31], v76, s[24:27], s85 offen nt
buffer_load_dwordx4 a[60:63], v76, s[28:31], s85 offen nt
s_add_u32 s85, s85, 57344
buffer_load_dwordx4 a[64:67], v77, s[32:35], s86 offen nt
s_add_u32 s86, s86, 16384
buffer_load_dwordx4 a[68:71], v77, s[32:35], s86 offen nt
s_add_u32 s86, s86, 16384
s_waitcnt vmcnt(20)
s_barrier
s_add_u32 m0, s77, 81920
s_nop 0
buffer_load_dwordx4 v12, s[8:11], s75 offen offset:0 lds
v_lshrrev_b32 v2, 4, v1
v_and_b32 v3, 15, v1
buffer_load_dwordx4 v13, s[8:11], s75 offen offset:1024 lds
v_lshlrev_b32 v44, 10, v2
v_lshl_add_u32 v44, v3, 4, v44
buffer_load_dwordx4 v14, s[8:11], s75 offen offset:2048 lds
s_lshl_b32 s70, s60, 8
v_add_u32 v44, s70, v44
s_lshl_b32 s87, s64, 14
s_add_u32 s87, s87, 65536
buffer_load_dwordx4 v15, s[8:11], s75 offen offset:3072 lds
v_and_b32 v45, 31, v1
v_lshlrev_b32 v45, 4, v45
s_add_u32 m0, s77, 86016
s_nop 0
buffer_load_dwordx4 v16, s[8:11], s75 offen offset:0 lds
s_lshl_b32 s88, s65, 11
s_lshl_b32 s70, s60, 9
s_add_u32 s88, s88, s70
s_add_u32 s88, s88, 8192
s_lshl_b32 s70, s64, 8
s_add_u32 s70, s70, 4096
v_lshlrev_b32 v4, 4, v3
v_add_u32 v4, s70, v4
buffer_load_dwordx4 v17, s[8:11], s75 offen offset:1024 lds
s_add_u32 s75, s75, 393216
s_cmp_eq_u32 s75, 6291456
s_cselect_b32 s75, 0, s75
s_lshl_b32 s70, s64, 4
s_add_u32 s70, s70, 4096
v_lshlrev_b32 v5, 8, v3
v_add_u32 v5, s70, v5
v_and_b32 v6, 1, v2
s_add_u32 m0, s76, 65536
s_nop 0
buffer_load_dwordx4 v8, s[4:7], s74 offen offset:0 lds
v_cmp_eq_u32 vcc, 1, v6
s_nop 1
v_cndmask_b32 v46, v4, v5, vcc
buffer_load_dwordx4 v9, s[4:7], s74 offen offset:1024 lds
buffer_load_dwordx4 v10, s[4:7], s74 offen offset:2048 lds
buffer_load_dwordx4 v11, s[4:7], s74 offen offset:3072 lds
s_add_u32 s74, s74, 128
s_and_b32 s74, s74, 2047
s_add_u32 s70, s87, 0
buffer_load_dwordx4 v[20:23], v44, s[12:15], s70 offen sc1
s_add_u32 s70, s87, 4096
buffer_load_dwordx4 v[24:27], v44, s[12:15], s70 offen sc1
s_add_u32 s70, s87, 8192
buffer_load_dwordx4 v[28:31], v44, s[12:15], s70 offen sc1
s_add_u32 s70, s87, 12288
buffer_load_dwordx4 v[32:35], v44, s[12:15], s70 offen sc1
buffer_load_dwordx4 v[36:39], v45, s[12:15], s88 offen sc1
buffer_load_dwordx4 v[40:43], v46, s[12:15], 0 offen offset:0 sc1
s_waitcnt vmcnt(26)
s_barrier
s_add_u32 m0, s77, 40960
s_nop 0
buffer_load_dwordx4 v12, s[8:11], s75 offen offset:0 lds
buffer_load_dwordx4 v13, s[8:11], s75 offen offset:1024 lds
buffer_load_dwordx4 v14, s[8:11], s75 offen offset:2048 lds
buffer_load_dwordx4 v15, s[8:11], s75 offen offset:3072 lds
s_add_u32 m0, s77, 45056
s_nop 0
buffer_load_dwordx4 v16, s[8:11], s75 offen offset:0 lds
buffer_load_dwordx4 v17, s[8:11], s75 offen offset:1024 lds
s_add_u32 s75, s75, 393216
s_cmp_eq_u32 s75, 6291456
s_cselect_b32 s75, 0, s75
s_add_u32 m0, s76, 24576
s_nop 0
buffer_load_dwordx4 v8, s[4:7], s74 offen offset:0 lds
buffer_load_dwordx4 v9, s[4:7], s74 offen offset:1024 lds
buffer_load_dwordx4 v10, s[4:7], s74 offen offset:2048 lds
buffer_load_dwordx4 v11, s[4:7], s74 offen offset:3072 lds
s_add_u32 s74, s74, 128
s_and_b32 s74, s74, 2047
buffer_load_dwordx4 a[72:75], v77, s[32:35], s86 offen nt
s_add_u32 s86, s86, 16384
buffer_load_dwordx4 a[76:79], v77, s[32:35], s86 offen nt
s_add_u32 s86, s86, 16384
buffer_load_dwordx4 a[80:83], v77, s[32:35], s86 offen nt
s_add_u32 s86, s86, 16384
buffer_load_dwordx4 a[84:87], v77, s[32:35], s86 offen nt
s_add_u32 s86, s86, 16384
buffer_load_dwordx4 a[88:91], v77, s[32:35], s86 offen nt
s_add_u32 s86, s86, 16384
buffer_load_dwordx4 a[92:95], v77, s[32:35], s86 offen nt
s_add_u32 s86, s86, 16384
s_waitcnt vmcnt(26)
s_barrier
s_add_u32 m0, s77, 0
s_nop 0
buffer_load_dwordx4 v12, s[8:11], s75 offen offset:0 lds
s_waitcnt vmcnt(17)
L_eg_chk:
v_xor_b32 v2, s68, v23
v_xor_b32 v3, s68, v27
v_xor_b32 v4, s68, v31
v_or3_b32 v2, v2, v3, v4
v_xor_b32 v3, s68, v35
v_xor_b32 v4, s68, v39
v_or3_b32 v2, v2, v3, v4
v_xor_b32 v3, s68, v43
v_or_b32 v2, v2, v3
v_cmp_ne_u32 vcc, 0, v2
s_cbranch_vccnz L_eg_rt
L_eg_ok:
v_add_f32 v20, v20, v24
buffer_load_dwordx4 v13, s[8:11], s75 offen offset:1024 lds
v_add_f32 v28, v28, v32
v_add_f32 v21, v21, v25
buffer_load_dwordx4 v14, s[8:11], s75 offen offset:2048 lds
v_add_f32 v29, v29, v33
v_add_f32 v22, v22, v26
buffer_load_dwordx4 v15, s[8:11], s75 offen offset:3072 lds
v_add_f32 v30, v30, v34
v_add_f32 v20, v20, v28
s_add_u32 m0, s77, 4096
s_nop 0
buffer_load_dwordx4 v16, s[8:11], s75 offen offset:0 lds
v_add_f32 v21, v21, v29
v_add_f32 v22, v22, v30
buffer_load_dwordx4 v17, s[8:11], s75 offen offset:1024 lds
s_add_u32 s75, s75, 393216
s_cmp_eq_u32 s75, 6291456
s_cselect_b32 s75, 0, s75
v_mov_b32 v24, v20
v_mov_b32 v25, v21
s_mul_i32 s70, s60, 9
s_add_u32 s70, s70, 92
s_lshl_b32 s82, s89, 3
s_add_u32 s82, s82, s70
s_lshl_b32 s70, s70, 10
s_add_u32 m0, s70, 28672
s_and_b32 s82, s82, 127
s_lshl_b32 s82, s82, 14
buffer_load_dwordx4 v80, s[16:19], s82 offen lds
v_mov_b32 v26, v22
v_permlane16_swap_b32 v20, v24
s_add_u32 m0, m0, 1024
s_add_u32 s82, s82, 16384
s_and_b32 s82, s82, 0x1fffff
buffer_load_dwordx4 v80, s[16:19], s82 offen lds
v_permlane16_swap_b32 v21, v25
v_permlane16_swap_b32 v22, v26
s_add_u32 m0, m0, 1024
s_add_u32 s82, s82, 16384
s_and_b32 s82, s82, 0x1fffff
buffer_load_dwordx4 v80, s[16:19], s82 offen lds
v_add_f32 v20, v20, v24
v_add_f32 v21, v21, v25
s_add_u32 m0, m0, 1024
s_add_u32 s82, s82, 16384
s_and_b32 s82, s82, 0x1fffff
buffer_load_dwordx4 v80, s[16:19], s82 offen lds
v_add_f32 v22, v22, v26
v_mov_b32 v24, v20
s_add_u32 m0, m0, 1024
s_add_u32 s82, s82, 16384
s_and_b32 s82, s82, 0x1fffff
buffer_load_dwordx4 v80, s[16:19], s82 offen lds
v_mov_b32 v25, v21
s_add_u32 m0, m0, 1024
s_add_u32 s82, s82, 16384
s_and_b32 s82, s82, 0x1fffff
buffer_load_dwordx4 v80, s[16:19], s82 offen lds
s_add_u32 m0, m0, 1024
s_add_u32 s82, s82, 16384
s_and_b32 s82, s82, 0x1fffff
buffer_load_dwordx4 v80, s[16:19], s82 offen lds
s_add_u32 m0, m0, 1024
s_add_u32 s82, s82, 16384
s_and_b32 s82, s82, 0x1fffff
buffer_load_dwordx4 v80, s[16:19], s82 offen lds
s_add_u32 m0, m0, 1024
s_add_u32 s82, s82, 16384
s_and_b32 s82, s82, 0x1fffff
buffer_load_dwordx4 v80, s[16:19], s82 offen lds
s_waitcnt vmcnt(25)
s_barrier
s_mul_i32 s70, s60, 10
s_add_u32 s70, s70, 52
s_lshl_b32 s82, s89, 3
s_add_u32 s82, s82, s70
s_lshl_b32 s70, s70, 10
s_add_u32 m0, s70, 28672
s_and_b32 s82, s82, 127
s_lshl_b32 s82, s82, 14
buffer_load_dwordx4 v80, s[16:19], s82 offen lds
v_mov_b32 v26, v22
v_permlane32_swap_b32 v20, v24
v_permlane32_swap_b32 v21, v25
s_add_u32 m0, m0, 1024
s_add_u32 s82, s82, 16384
s_and_b32 s82, s82, 0x1fffff
buffer_load_dwordx4 v80, s[16:19], s82 offen lds
v_permlane32_swap_b32 v22, v26
v_add_f32 v20, v20, v24
v_add_f32 v21, v21, v25
s_add_u32 m0, m0, 1024
s_add_u32 s82, s82, 16384
s_and_b32 s82, s82, 0x1fffff
buffer_load_dwordx4 v80, s[16:19], s82 offen lds
v_add_f32 v22, v22, v26
v_and_b32 v3, 15, v1
v_lshlrev_b32 v3, 2, v3
s_add_u32 m0, m0, 1024
s_add_u32 s82, s82, 16384
s_and_b32 s82, s82, 0x1fffff
buffer_load_dwordx4 v80, s[16:19], s82 offen lds
s_lshl_b32 s70, s60, 6
s_add_u32 s70, s70, 160768
v_add_u32 v3, s70, v3
ds_write_b32 v3, v20 offset:0
ds_write_b32 v3, v21 offset:256
s_add_u32 m0, m0, 1024
s_add_u32 s82, s82, 16384
s_and_b32 s82, s82, 0x1fffff
buffer_load_dwordx4 v80, s[16:19], s82 offen lds
ds_write_b32 v3, v22 offset:512
v_lshrrev_b32 v4, 2, v45
s_lshl_b32 s70, s60, 7
s_add_u32 s70, s70, 159744
v_add_u32 v4, s70, v4
s_add_u32 m0, m0, 1024
s_add_u32 s82, s82, 16384
s_and_b32 s82, s82, 0x1fffff
buffer_load_dwordx4 v80, s[16:19], s82 offen lds
ds_write_b32 v4, v36
ds_write_b32 v4, v37 offset:512
s_getreg_b32 s71, hwreg(HW_REG_XCC_ID, 0, 4)
v_cmp_ne_u32 vcc, s71, v40
s_nop 0
s_and_b32 s70, vcc_lo, 0xffff
s_cselect_b32 s69, 0, 1
s_add_u32 m0, m0, 1024
s_add_u32 s82, s82, 16384
s_and_b32 s82, s82, 0x1fffff
buffer_load_dwordx4 v80, s[16:19], s82 offen lds
v_mov_b32 v5, s69
v_mov_b32 v6, 161536
ds_write_b32 v6, v5
s_add_u32 m0, m0, 1024
s_add_u32 s82, s82, 16384
s_and_b32 s82, s82, 0x1fffff
buffer_load_dwordx4 v80, s[16:19], s82 offen lds
s_add_u32 m0, m0, 1024
s_add_u32 s82, s82, 16384
s_and_b32 s82, s82, 0x1fffff
buffer_load_dwordx4 v80, s[16:19], s82 offen lds
s_add_u32 m0, m0, 1024
s_add_u32 s82, s82, 16384
s_and_b32 s82, s82, 0x1fffff
buffer_load_dwordx4 v80, s[16:19], s82 offen lds
s_waitcnt vmcnt(19)
s_barrier
s_mul_i32 s70, s60, 10
s_add_u32 s70, s70, 12
s_lshl_b32 s82, s89, 3
s_add_u32 s82, s82, s70
s_lshl_b32 s70, s70, 10
s_add_u32 m0, s70, 28672
s_and_b32 s82, s82, 127
s_lshl_b32 s82, s82, 14
buffer_load_dwordx4 v80, s[16:19], s82 offen lds
s_add_u32 m0, m0, 1024
s_add_u32 s82, s82, 16384
s_and_b32 s82, s82, 0x1fffff
buffer_load_dwordx4 v80, s[16:19], s82 offen lds
s_add_u32 m0, m0, 1024
s_add_u32 s82, s82, 16384
s_and_b32 s82, s82, 0x1fffff
buffer_load_dwordx4 v80, s[16:19], s82 offen lds
s_add_u32 m0, m0, 1024
s_add_u32 s82, s82, 16384
s_and_b32 s82, s82, 0x1fffff
buffer_load_dwordx4 v80, s[16:19], s82 offen lds
s_add_u32 m0, m0, 1024
s_add_u32 s82, s82, 16384
s_and_b32 s82, s82, 0x1fffff
buffer_load_dwordx4 v80, s[16:19], s82 offen lds
s_add_u32 m0, m0, 1024
s_add_u32 s82, s82, 16384
s_and_b32 s82, s82, 0x1fffff
buffer_load_dwordx4 v80, s[16:19], s82 offen lds
s_add_u32 m0, m0, 1024
s_add_u32 s82, s82, 16384
s_and_b32 s82, s82, 0x1fffff
buffer_load_dwordx4 v80, s[16:19], s82 offen lds
s_add_u32 m0, m0, 1024
s_add_u32 s82, s82, 16384
s_and_b32 s82, s82, 0x1fffff
buffer_load_dwordx4 v80, s[16:19], s82 offen lds
s_add_u32 m0, m0, 1024
s_add_u32 s82, s82, 16384
s_and_b32 s82, s82, 0x1fffff
buffer_load_dwordx4 v80, s[16:19], s82 offen lds
s_add_u32 m0, m0, 1024
s_add_u32 s82, s82, 16384
s_and_b32 s82, s82, 0x1fffff
buffer_load_dwordx4 v80, s[16:19], s82 offen lds
s_setprio 0
s_waitcnt lgkmcnt(0)
s_barrier
s_mov_b32 exec_lo, 0x0
s_mov_b32 exec_hi, 0xf
buffer_load_dword v81, v83, s[12:15], 0 offen
s_mov_b64 exec, -1
s_mul_i32 s70, s60, 3
s_add_u32 s70, s70, 0
s_lshl_b32 s82, s89, 3
s_add_u32 s82, s82, s70
s_lshl_b32 s70, s70, 10
s_add_u32 m0, s70, 28672
s_and_b32 s82, s82, 127
s_lshl_b32 s82, s82, 14
buffer_load_dwordx4 v80, s[16:19], s82 offen lds
s_add_u32 m0, m0, 1024
s_add_u32 s82, s82, 16384
s_and_b32 s82, s82, 0x1fffff
buffer_load_dwordx4 v80, s[16:19], s82 offen lds
s_add_u32 m0, m0, 1024
s_add_u32 s82, s82, 16384
s_and_b32 s82, s82, 0x1fffff
buffer_load_dwordx4 v80, s[16:19], s82 offen lds
s_sub_i32 s70, s64, s65
s_lshl_b32 s70, s70, 18
v_add_u32 v8, s70, v8
v_add_u32 v9, s70, v9
v_add_u32 v10, s70, v10
v_add_u32 v11, s70, v11
s_lshl_b32 s70, s65, 7
s_mov_b32 m0, s76
s_nop 0
buffer_load_dwordx4 v8, s[4:7], s70 offen offset:0 lds
buffer_load_dwordx4 v9, s[4:7], s70 offen offset:1024 lds
buffer_load_dwordx4 v10, s[4:7], s70 offen offset:2048 lds
buffer_load_dwordx4 v11, s[4:7], s70 offen offset:3072 lds
v_lshrrev_b32 v2, 4, v1
v_bfe_u32 v3, v1, 2, 2
v_and_b32 v4, 1, v1
v_lshlrev_b32 v4, 4, v4
v_mov_b32 v5, 0x3f80
v_lshlrev_b32 v4, v4, v5
v_cmp_eq_u32 vcc, v2, v3
s_nop 1
v_cndmask_b32 v4, 0, v4, vcc
v_and_b32 v5, 2, v1
v_cmp_eq_u32 vcc, 0, v5
s_nop 1
v_cndmask_b32 v58, 0, v4, vcc
v_cndmask_b32_e64 v59, v4, 0, vcc
v_mov_b32 v56, 0
v_mov_b32 v57, 0
v_mov_b32 v60, 0
v_mov_b32 v61, 0
v_and_b32 v3, 15, v1
v_mul_u32_u24 v55, 4352, v3
v_lshrrev_b32 v2, 4, v1
v_lshl_add_u32 v55, v2, 5, v55
s_mul_i32 s87, s64, 69632
s_add_u32 s87, s87, 524288
s_lshl_b32 s70, s66, 7
s_lshl_b32 s71, s67, 4
s_add_u32 s88, s70, s71
s_add_u32 s88, s88, s87
s_add_u32 s88, s88, 4096
s_lshl_b32 s70, s60, 10
s_add_u32 s87, s87, s70
s_barrier
s_add_u32 s70, s65, 1
s_and_b32 s70, s70, 15
s_mul_i32 s70, s70, 4352
s_add_u32 s70, s70, s87
buffer_load_dwordx4 v[84:87], v18, s[12:15], s70 offen sc1
s_add_u32 s70, s65, 2
s_and_b32 s70, s70, 15
s_mul_i32 s70, s70, 4352
s_add_u32 s70, s70, s87
buffer_load_dwordx4 v[88:91], v18, s[12:15], s70 offen sc1
s_add_u32 s70, s65, 3
s_and_b32 s70, s70, 15
s_mul_i32 s70, s70, 4352
s_add_u32 s70, s70, s87
buffer_load_dwordx4 v[92:95], v18, s[12:15], s70 offen sc1
s_add_u32 s70, s65, 4
s_and_b32 s70, s70, 15
s_mul_i32 s70, s70, 4352
s_add_u32 s70, s70, s87
buffer_load_dwordx4 v[96:99], v18, s[12:15], s70 offen sc1
s_add_u32 s70, s65, 5
s_and_b32 s70, s70, 15
s_mul_i32 s70, s70, 4352
s_add_u32 s70, s70, s87
buffer_load_dwordx4 v[100:103], v18, s[12:15], s70 offen sc1
s_add_u32 s70, s65, 6
s_and_b32 s70, s70, 15
s_mul_i32 s70, s70, 4352
s_add_u32 s70, s70, s87
buffer_load_dwordx4 v[104:107], v18, s[12:15], s70 offen sc1
s_add_u32 s70, s65, 7
s_and_b32 s70, s70, 15
s_mul_i32 s70, s70, 4352
s_add_u32 s70, s70, s87
buffer_load_dwordx4 v[108:111], v18, s[12:15], s70 offen sc1
s_add_u32 s70, s65, 8
s_and_b32 s70, s70, 15
s_mul_i32 s70, s70, 4352
s_add_u32 s70, s70, s87
buffer_load_dwordx4 v[112:115], v18, s[12:15], s70 offen sc1
s_add_u32 s70, s65, 9
s_and_b32 s70, s70, 15
s_mul_i32 s70, s70, 4352
s_add_u32 s70, s70, s87
buffer_load_dwordx4 v[116:119], v18, s[12:15], s70 offen sc1
s_add_u32 s70, s65, 10
s_and_b32 s70, s70, 15
s_mul_i32 s70, s70, 4352
s_add_u32 s70, s70, s87
buffer_load_dwordx4 v[120:123], v18, s[12:15], s70 offen sc1
s_add_u32 s70, s65, 11
s_and_b32 s70, s70, 15
s_mul_i32 s70, s70, 4352
s_add_u32 s70, s70, s87
buffer_load_dwordx4 v[124:127], v18, s[12:15], s70 offen sc1
s_add_u32 s70, s65, 12
s_and_b32 s70, s70, 15
s_mul_i32 s70, s70, 4352
s_add_u32 s70, s70, s87
buffer_load_dwordx4 v[128:131], v18, s[12:15], s70 offen sc1
s_add_u32 s70, s65, 13
s_and_b32 s70, s70, 15
s_mul_i32 s70, s70, 4352
s_add_u32 s70, s70, s87
buffer_load_dwordx4 v[132:135], v18, s[12:15], s70 offen sc1
s_add_u32 s70, s65, 14
s_and_b32 s70, s70, 15
s_mul_i32 s70, s70, 4352
s_add_u32 s70, s70, s87
buffer_load_dwordx4 v[136:139], v18, s[12:15], s70 offen sc1
s_add_u32 s70, s65, 15
s_and_b32 s70, s70, 15
s_mul_i32 s70, s70, 4352
s_add_u32 s70, s70, s87
buffer_load_dwordx4 v[140:143], v18, s[12:15], s70 offen sc1
s_add_u32 s70, s65, 16
s_and_b32 s70, s70, 15
s_mul_i32 s70, s70, 4352
s_add_u32 s70, s70, s87
buffer_load_dwordx4 v[144:147], v18, s[12:15], s70 offen sc1
buffer_load_dwordx4 v[148:151], v55, s[12:15], s88 offen sc1
s_lshl_b32 s70, s66, 6
s_lshl_b32 s71, s67, 3
s_add_u32 s70, s70, s71
s_add_u32 s70, s70, 161600
v_lshrrev_b32 v4, 4, v1
v_lshlrev_b32 v4, 4, v4
v_add_u32 v4, s70, v4
s_lshl_b32 s70, s60, 10
s_add_u32 s70, s70, 24576
v_add_u32 v3, s70, v18
s_mov_b32 s73, 31
L_kvr:
s_bitcmp1_b32 s73, 0
s_cbranch_scc0 L_kvs0
s_waitcnt vmcnt(13)
v_max3_u32 v2, v84, v88, v92
v_max_u32 v2, v2, v96
v_cmp_eq_u32 vcc, -1, v2
s_cbranch_vccnz L_kvs0
s_bitset0_b32 s73, 0
v_mfma_f32_16x16x32_bf16 v[20:23], v[58:61], v[84:87], 0
v_mfma_f32_16x16x32_bf16 v[24:27], v[56:59], v[84:87], 0
v_mfma_f32_16x16x32_bf16 v[20:23], v[58:61], v[88:91], v[20:23]
v_mfma_f32_16x16x32_bf16 v[24:27], v[56:59], v[88:91], v[24:27]
v_mfma_f32_16x16x32_bf16 v[20:23], v[58:61], v[92:95], v[20:23]
v_mfma_f32_16x16x32_bf16 v[24:27], v[56:59], v[92:95], v[24:27]
v_mfma_f32_16x16x32_bf16 v[20:23], v[58:61], v[96:99], v[20:23]
v_mfma_f32_16x16x32_bf16 v[24:27], v[56:59], v[96:99], v[24:27]
L_kvs0:
s_bitcmp1_b32 s73, 1
s_cbranch_scc0 L_kvs1
s_waitcnt vmcnt(9)
v_max3_u32 v2, v100, v104, v108
v_max_u32 v2, v2, v112
v_cmp_eq_u32 vcc, -1, v2
s_cbranch_vccnz L_kvs1
s_bitset0_b32 s73, 1
v_mfma_f32_16x16x32_bf16 v[28:31], v[58:61], v[100:103], 0
v_mfma_f32_16x16x32_bf16 v[32:35], v[56:59], v[100:103], 0
v_mfma_f32_16x16x32_bf16 v[28:31], v[58:61], v[104:107], v[28:31]
v_mfma_f32_16x16x32_bf16 v[32:35], v[56:59], v[104:107], v[32:35]
v_mfma_f32_16x16x32_bf16 v[28:31], v[58:61], v[108:111], v[28:31]
v_mfma_f32_16x16x32_bf16 v[32:35], v[56:59], v[108:111], v[32:35]
v_mfma_f32_16x16x32_bf16 v[28:31], v[58:61], v[112:115], v[28:31]
v_mfma_f32_16x16x32_bf16 v[32:35], v[56:59], v[112:115], v[32:35]
L_kvs1:
s_bitcmp1_b32 s73, 2
s_cbranch_scc0 L_kvs2
s_waitcnt vmcnt(5)
v_max3_u32 v2, v116, v120, v124
v_max_u32 v2, v2, v128
v_cmp_eq_u32 vcc, -1, v2
s_cbranch_vccnz L_kvs2
s_bitset0_b32 s73, 2
v_mfma_f32_16x16x32_bf16 v[36:39], v[58:61], v[116:119], 0
v_mfma_f32_16x16x32_bf16 v[40:43], v[56:59], v[116:119], 0
v_mfma_f32_16x16x32_bf16 v[36:39], v[58:61], v[120:123], v[36:39]
v_mfma_f32_16x16x32_bf16 v[40:43], v[56:59], v[120:123], v[40:43]
v_mfma_f32_16x16x32_bf16 v[36:39], v[58:61], v[124:127], v[36:39]
v_mfma_f32_16x16x32_bf16 v[40:43], v[56:59], v[124:127], v[40:43]
v_mfma_f32_16x16x32_bf16 v[36:39], v[58:61], v[128:131], v[36:39]
v_mfma_f32_16x16x32_bf16 v[40:43], v[56:59], v[128:131], v[40:43]
L_kvs2:
s_bitcmp1_b32 s73, 3
s_cbranch_scc0 L_kvs3
s_waitcnt vmcnt(1)
v_max3_u32 v2, v132, v136, v140
v_max_u32 v2, v2, v144
v_cmp_eq_u32 vcc, -1, v2
s_cbranch_vccnz L_kvs3
s_bitset0_b32 s73, 3
v_mfma_f32_16x16x32_bf16 v[44:47], v[58:61], v[132:135], 0
v_mfma_f32_16x16x32_bf16 v[48:51], v[56:59], v[132:135], 0
v_mfma_f32_16x16x32_bf16 v[44:47], v[58:61], v[136:139], v[44:47]
v_mfma_f32_16x16x32_bf16 v[48:51], v[56:59], v[136:139], v[48:51]
v_mfma_f32_16x16x32_bf16 v[44:47], v[58:61], v[140:143], v[44:47]
v_mfma_f32_16x16x32_bf16 v[48:51], v[56:59], v[140:143], v[48:51]
v_mfma_f32_16x16x32_bf16 v[44:47], v[58:61], v[144:147], v[44:47]
v_mfma_f32_16x16x32_bf16 v[48:51], v[56:59], v[144:147], v[48:51]
L_kvs3:
s_bitcmp1_b32 s73, 4
s_cbranch_scc0 L_kvs4
s_waitcnt vmcnt(0)
v_xor_b32 v148, s84, v148
v_xor_b32 v149, s84, v149
v_xor_b32 v150, s84, v150
v_xor_b32 v151, s84, v151
v_or3_b32 v2, v148, v149, v150
v_bitop3_b32 v2, v2, v151, s91 bitop3:0xa8
v_cmp_ne_u32 vcc, 0, v2
s_cbranch_vccnz L_kvs4
s_bitset0_b32 s73, 4
v_add_f32_dpp v148, v148, v148 row_ror:1 row_mask:0xf bank_mask:0xf
v_add_f32_dpp v149, v149, v149 row_ror:1 row_mask:0xf bank_mask:0xf
v_add_f32_dpp v150, v150, v150 row_ror:1 row_mask:0xf bank_mask:0xf
v_add_f32_dpp v151, v151, v151 row_ror:1 row_mask:0xf bank_mask:0xf
v_add_f32_dpp v148, v148, v148 row_ror:2 row_mask:0xf bank_mask:0xf
v_add_f32_dpp v149, v149, v149 row_ror:2 row_mask:0xf bank_mask:0xf
v_add_f32_dpp v150, v150, v150 row_ror:2 row_mask:0xf bank_mask:0xf
v_add_f32_dpp v151, v151, v151 row_ror:2 row_mask:0xf bank_mask:0xf
v_add_f32_dpp v148, v148, v148 row_ror:4 row_mask:0xf bank_mask:0xf
v_add_f32_dpp v149, v149, v149 row_ror:4 row_mask:0xf bank_mask:0xf
v_add_f32_dpp v150, v150, v150 row_ror:4 row_mask:0xf bank_mask:0xf
v_add_f32_dpp v151, v151, v151 row_ror:4 row_mask:0xf bank_mask:0xf
v_add_f32_dpp v148, v148, v148 row_ror:8 row_mask:0xf bank_mask:0xf
v_add_f32_dpp v149, v149, v149 row_ror:8 row_mask:0xf bank_mask:0xf
v_add_f32_dpp v150, v150, v150 row_ror:8 row_mask:0xf bank_mask:0xf
v_add_f32_dpp v151, v151, v151 row_ror:8 row_mask:0xf bank_mask:0xf
v_cvt_pk_bf16_f32 v148, v148, v149
v_cvt_pk_bf16_f32 v149, v150, v151
ds_write_b64 v4, v[148:149]
L_kvs4:
s_cmp_lg_u32 s73, 0
s_cbranch_scc1 L_kvrt
L_kvok:
s_nop 3
v_pk_add_f32 v[20:21], v[20:21], v[28:29]
v_pk_add_f32 v[22:23], v[22:23], v[30:31]
v_pk_add_f32 v[24:25], v[24:25], v[32:33]
v_pk_add_f32 v[26:27], v[26:27], v[34:35]
v_pk_add_f32 v[36:37], v[36:37], v[44:45]
v_pk_add_f32 v[38:39], v[38:39], v[46:47]
v_pk_add_f32 v[40:41], v[40:41], v[48:49]
v_pk_add_f32 v[42:43], v[42:43], v[50:51]
v_pk_add_f32 v[20:21], v[20:21], v[36:37]
v_pk_add_f32 v[22:23], v[22:23], v[38:39]
v_pk_add_f32 v[24:25], v[24:25], v[40:41]
v_pk_add_f32 v[26:27], v[26:27], v[42:43]
v_cvt_pk_bf16_f32 v20, v20, v21
v_cvt_pk_bf16_f32 v21, v22, v23
v_cvt_pk_bf16_f32 v22, v24, v25
v_cvt_pk_bf16_f32 v23, v26, v27
ds_write_b128 v3, v[20:23]
s_waitcnt lgkmcnt(0)
s_barrier
s_mov_b32 exec_lo, 0x0
s_mov_b32 exec_hi, 0x3f000000
buffer_load_dword v81, v83, s[12:15], 0 offen
s_mov_b64 exec, -1
v_lshrrev_b32 v2, 5, v1
v_lshlrev_b32 v2, 11, v2
v_bfe_u32 v3, v1, 3, 2
v_lshl_add_u32 v2, v3, 7, v2
v_bfe_u32 v3, v1, 4, 1
v_bfe_u32 v4, v1, 1, 2
v_xor_b32 v3, v3, v4
v_lshl_add_u32 v2, v3, 5, v2
v_and_b32 v3, 1, v1
v_lshl_add_u32 v2, v3, 4, v2
s_lshl_b32 s70, s60, 13
s_add_u32 s71, s70, 65536
v_add_u32 v100, s71, v2
v_xor_b32 v101, 64, v100
v_lshrrev_b32 v2, 2, v1
v_bfe_u32 v5, v1, 3, 2
v_xor_b32 v6, s60, v5
v_lshlrev_b32 v6, 5, v6
v_lshl_add_u32 v6, v2, 7, v6
v_and_b32 v7, 3, v1
v_lshl_add_u32 v6, v7, 3, v6
v_add_u32 v102, 65536, v6
s_lshl_b32 s71, s66, 16
s_add_u32 s70, s70, s71
s_add_u32 s70, s70, 49152
v_lshlrev_b32 v6, 5, v5
v_lshl_add_u32 v6, v2, 7, v6
v_lshl_add_u32 v6, v7, 3, v6
v_add_u32 v104, s70, v6
v_xor_b32 v105, 32, v104
v_xor_b32 v106, 64, v104
v_xor_b32 v107, 96, v104
v_lshrrev_b32 v5, 4, v1
v_xor_b32 v4, v4, v5
v_lshlrev_b32 v4, 5, v4
v_lshrrev_b32 v6, 3, v1
v_lshl_add_u32 v4, v6, 7, v4
v_lshl_add_u32 v4, v3, 4, v4
v_add_u32 v103, s70, v4
s_lshl_b32 s70, s60, 5
s_add_u32 s70, s70, 161792
v_mov_b32 v63, s70
v_add_u32 v114, 16, v63
v_lshl_add_u32 v56, v3, 4, v63
s_and_b32 s70, s65, 3
s_lshl_b32 s70, s70, 9
s_add_u32 s70, s70, 7864320
v_lshl_add_u32 v57, v5, 4, s70
v_lshlrev_b32 v60, 6, v5
v_lshl_add_u32 v60, v7, 4, v60
v_and_b32 v2, 3, v2
v_lshl_add_u32 v61, v2, 8, v60
v_lshlrev_b32 v62, 4, v3
v_lshl_add_u32 v62, v5, 5, v62
v_mov_b32 v59, s68
s_lshl_b32 s71, s79, 2
s_add_u32 s71, s71, s60
s_lshl_b32 s70, s71, 8
s_add_u32 s70, s70, 6946816
s_mov_b32 s85, s70
s_lshl_b32 s71, s64, 2
s_add_u32 s71, s71, s60
s_lshl_b32 s71, s71, 7
s_lshl_b32 s70, s65, 15
s_add_u32 s70, s70, s71
s_add_u32 s70, s70, 7340032
s_mov_b32 s88, s70
s_lshl_b32 s70, s64, 2
s_add_u32 s70, s70, s60
s_lshl_b32 s70, s70, 12
s_add_u32 s86, s70, 6946816
s_lshl_b32 s87, s62, 11
s_add_u32 s87, s87, 6815744
s_mov_b32 s94, 0
s_mov_b32 s95, 0
s_mov_b32 s92, 0x000f000f
s_mov_b32 s93, 0x000f000f
s_mov_b32 s38, 0
v_mov_b32 v64, 0x3f803f80
v_mov_b32 v65, 0x3f803f80
v_mov_b32 v66, 0x3f803f80
v_mov_b32 v67, 0x3f803f80
v_add_u32 v115, 64, v1
v_mov_b32 v2, 0
v_mov_b32 v95, 0
v_mov_b32 v99, 0
s_waitcnt vmcnt(0) lgkmcnt(0)
s_barrier
ds_write_b128 v100, a[0:3] offset:0
ds_write_b128 v101, a[4:7] offset:512
ds_write_b128 v100, a[8:11] offset:1024
ds_write_b128 v101, a[12:15] offset:1536
ds_write_b128 v100, a[16:19] offset:4096
ds_write_b128 v101, a[20:23] offset:4608
ds_write_b128 v100, a[24:27] offset:5120
ds_write_b128 v101, a[28:31] offset:5632
ds_write_b128 v100, a[32:35] offset:32768
ds_write_b128 v101, a[36:39] offset:33280
ds_write_b128 v100, a[40:43] offset:33792
ds_write_b128 v101, a[44:47] offset:34304
ds_write_b128 v100, a[48:51] offset:36864
ds_write_b128 v101, a[52:55] offset:37376
ds_write_b128 v100, a[56:59] offset:37888
ds_write_b128 v101, a[60:63] offset:38400
ds_write_b128 v103, a[64:67] offset:0
ds_write_b128 v103, a[68:71] offset:1024
ds_write_b128 v103, a[72:75] offset:2048
ds_write_b128 v103, a[76:79] offset:3072
ds_write_b128 v103, a[80:83] offset:4096
ds_write_b128 v103, a[84:87] offset:5120
ds_write_b128 v103, a[88:91] offset:6144
ds_write_b128 v103, a[92:95] offset:7168
s_waitcnt lgkmcnt(0)
ds_read_b64_tr_b16 a[64:65], v104 offset:0
ds_read_b64_tr_b16 a[66:67], v104 offset:2048
ds_read_b64_tr_b16 a[68:69], v104 offset:4096
ds_read_b64_tr_b16 a[70:71], v104 offset:6144
ds_read_b64_tr_b16 a[72:73], v105 offset:0
ds_read_b64_tr_b16 a[74:75], v105 offset:2048
ds_read_b64_tr_b16 a[76:77], v105 offset:4096
ds_read_b64_tr_b16 a[78:79], v105 offset:6144
ds_read_b64_tr_b16 a[80:81], v106 offset:0
ds_read_b64_tr_b16 a[82:83], v106 offset:2048
ds_read_b64_tr_b16 a[84:85], v106 offset:4096
ds_read_b64_tr_b16 a[86:87], v106 offset:6144
ds_read_b64_tr_b16 a[88:89], v107 offset:0
ds_read_b64_tr_b16 a[90:91], v107 offset:2048
ds_read_b64_tr_b16 a[92:93], v107 offset:4096
ds_read_b64_tr_b16 a[94:95], v107 offset:6144
s_barrier
ds_read_b64_tr_b16 a[0:1], v102 offset:0
ds_read_b64_tr_b16 a[2:3], v102 offset:2048
ds_read_b64_tr_b16 a[32:33], v102 offset:32768
ds_read_b64_tr_b16 a[34:35], v102 offset:34816
ds_read_b64_tr_b16 a[4:5], v102 offset:4096
ds_read_b64_tr_b16 a[6:7], v102 offset:6144
ds_read_b64_tr_b16 a[36:37], v102 offset:36864
ds_read_b64_tr_b16 a[38:39], v102 offset:38912
ds_read_b64_tr_b16 a[8:9], v102 offset:8192
ds_read_b64_tr_b16 a[10:11], v102 offset:10240
ds_read_b64_tr_b16 a[40:41], v102 offset:40960
ds_read_b64_tr_b16 a[42:43], v102 offset:43008
ds_read_b64_tr_b16 a[12:13], v102 offset:12288
ds_read_b64_tr_b16 a[14:15], v102 offset:14336
ds_read_b64_tr_b16 a[44:45], v102 offset:45056
ds_read_b64_tr_b16 a[46:47], v102 offset:47104
ds_read_b64_tr_b16 a[16:17], v102 offset:16384
ds_read_b64_tr_b16 a[18:19], v102 offset:18432
ds_read_b64_tr_b16 a[48:49], v102 offset:49152
ds_read_b64_tr_b16 a[50:51], v102 offset:51200
ds_read_b64_tr_b16 a[20:21], v102 offset:20480
ds_read_b64_tr_b16 a[22:23], v102 offset:22528
ds_read_b64_tr_b16 a[52:53], v102 offset:53248
ds_read_b64_tr_b16 a[54:55], v102 offset:55296
ds_read_b64_tr_b16 a[24:25], v102 offset:24576
ds_read_b64_tr_b16 a[26:27], v102 offset:26624
ds_read_b64_tr_b16 a[56:57], v102 offset:57344
ds_read_b64_tr_b16 a[58:59], v102 offset:59392
ds_read_b64_tr_b16 a[28:29], v102 offset:28672
ds_read_b64_tr_b16 a[30:31], v102 offset:30720
ds_read_b64_tr_b16 a[60:61], v102 offset:61440
ds_read_b64_tr_b16 a[62:63], v102 offset:63488
s_waitcnt lgkmcnt(0)
buffer_load_dwordx4 v[92:95], v18, s[12:15], s87 offen offset:0 sc1
buffer_load_dwordx4 v[96:99], v18, s[12:15], s87 offen offset:1024 sc1
v_mfma_f32_16x16x32_bf16 v[68:71], a[0:3], v[64:67], 0
v_mfma_f32_16x16x32_bf16 v[72:75], a[32:35], v[64:67], 0
v_mfma_f32_16x16x32_bf16 v[68:71], a[4:7], v[64:67], v[68:71]
v_mfma_f32_16x16x32_bf16 v[72:75], a[36:39], v[64:67], v[72:75]
v_mfma_f32_16x16x32_bf16 v[68:71], a[8:11], v[64:67], v[68:71]
v_mfma_f32_16x16x32_bf16 v[72:75], a[40:43], v[64:67], v[72:75]
v_mfma_f32_16x16x32_bf16 v[68:71], a[12:15], v[64:67], v[68:71]
v_mfma_f32_16x16x32_bf16 v[72:75], a[44:47], v[64:67], v[72:75]
v_mfma_f32_16x16x32_bf16 v[68:71], a[16:19], v[64:67], v[68:71]
v_mfma_f32_16x16x32_bf16 v[72:75], a[48:51], v[64:67], v[72:75]
v_mfma_f32_16x16x32_bf16 v[68:71], a[20:23], v[64:67], v[68:71]
v_mfma_f32_16x16x32_bf16 v[72:75], a[52:55], v[64:67], v[72:75]
v_mfma_f32_16x16x32_bf16 v[68:71], a[24:27], v[64:67], v[68:71]
v_mfma_f32_16x16x32_bf16 v[72:75], a[56:59], v[64:67], v[72:75]
v_mfma_f32_16x16x32_bf16 v[68:71], a[28:31], v[64:67], v[68:71]
v_mfma_f32_16x16x32_bf16 v[72:75], a[60:63], v[64:67], v[72:75]
L_pk:
s_waitcnt vmcnt(0)
L_pk2:
v_cmp_eq_u32_e64 s[80:81], s68, v95
v_cmp_eq_u32_e64 s[82:83], s68, v99
s_nop 0
v_cndmask_b32_e64 v108, 0, v92, s[80:81]
v_cndmask_b32_e64 v109, 0, v96, s[82:83]
s_and_b64 s[76:77], s[80:81], s[82:83]
v_max_u32 v110, v108, v109
v_min_u32 v111, v108, v109
s_cmp_eq_u64 s[76:77], -1
s_cselect_b32 s73, 0, 1
s_cbranch_scc1 L_pkc
s_not_b64 exec, s[80:81]
s_cselect_b64 exec, exec, 1
buffer_load_dwordx4 v[92:95], v18, s[12:15], s87 offen offset:0 sc1
s_not_b64 exec, s[82:83]
s_cselect_b64 exec, exec, 1
buffer_load_dwordx4 v[96:99], v18, s[12:15], s87 offen offset:1024 sc1
s_mov_b64 exec, -1
L_pkc:
v_cmp_le_u32 vcc, s95, v110
v_cmp_le_u32_e64 s[76:77], s95, v111
s_bcnt1_i32_b64 s70, vcc
s_bcnt1_i32_b64 s71, s[76:77]
s_add_u32 s70, s70, s71
s_cmp_eq_u32 s70, 2
s_cbranch_scc1 L_pksame
v_mov_b32_dpp v112, v110 row_ror:1 row_mask:0xf bank_mask:0xf
v_max_u32_dpp v113, v111, v111 row_ror:1 row_mask:0xf bank_mask:0xf
v_med3_u32 v111, v110, v112, v113
v_max_u32 v110, v110, v112
s_nop 1
v_mov_b32_dpp v112, v110 row_ror:2 row_mask:0xf bank_mask:0xf
v_max_u32_dpp v113, v111, v111 row_ror:2 row_mask:0xf bank_mask:0xf
v_med3_u32 v111, v110, v112, v113
v_max_u32 v110, v110, v112
s_nop 1
v_mov_b32_dpp v112, v110 row_ror:4 row_mask:0xf bank_mask:0xf
v_max_u32_dpp v113, v111, v111 row_ror:4 row_mask:0xf bank_mask:0xf
v_med3_u32 v111, v110, v112, v113
v_max_u32 v110, v110, v112
s_nop 1
v_mov_b32_dpp v112, v110 row_ror:8 row_mask:0xf bank_mask:0xf
v_max_u32_dpp v113, v111, v111 row_ror:8 row_mask:0xf bank_mask:0xf
v_med3_u32 v111, v110, v112, v113
v_max_u32 v110, v110, v112
v_mov_b32 v112, v110
v_mov_b32 v113, v111
s_nop 0
v_permlane16_swap_b32 v110, v112
v_permlane16_swap_b32 v111, v113
v_max_u32 v113, v111, v113
v_med3_u32 v111, v110, v112, v113
v_max_u32 v110, v110, v112
v_mov_b32 v112, v110
v_mov_b32 v113, v111
s_nop 0
v_permlane32_swap_b32 v110, v112
v_permlane32_swap_b32 v111, v113
v_max_u32 v113, v111, v113
v_med3_u32 v111, v110, v112, v113
v_max_u32 v110, v110, v112
v_readfirstlane_b32 s95, v111
s_nop 0
s_cmp_eq_u32 s95, 0
s_cbranch_scc1 L_pksame
v_cmp_eq_u32 vcc, v108, v111
v_cmp_eq_u32_e64 s[76:77], v108, v110
s_nop 0
v_cndmask_b32 v112, v63, v114, vcc
s_or_b64 exec, vcc, s[76:77]
ds_write_b96 v112, v[92:94]
ds_write_b32 v112, v1 offset:12
s_mov_b64 exec, -1
v_cmp_eq_u32 vcc, v109, v111
v_cmp_eq_u32_e64 s[76:77], v109, v110
s_nop 0
v_cndmask_b32 v113, v63, v114, vcc
s_or_b64 exec, vcc, s[76:77]
ds_write_b96 v113, v[96:98]
ds_write_b32 v113, v115 offset:12
s_mov_b64 exec, -1
ds_read_b128 v[20:23], v56
s_waitcnt lgkmcnt(0)
v_lshl_add_u32 v58, v23, 11, v57
s_mov_b64 exec, s[92:93]
buffer_load_dwordx4 v[24:27], v58, s[12:15], 0 offen offset:0 sc1
buffer_load_dwordx4 v[28:31], v58, s[12:15], 0 offen offset:64 sc1
buffer_load_dwordx4 v[32:35], v58, s[12:15], 0 offen offset:128 sc1
buffer_load_dwordx4 v[36:39], v58, s[12:15], 0 offen offset:192 sc1
buffer_load_dwordx4 v[40:43], v58, s[12:15], 0 offen offset:256 sc1
buffer_load_dwordx4 v[44:47], v58, s[12:15], 0 offen offset:320 sc1
buffer_load_dwordx4 v[48:51], v58, s[12:15], 0 offen offset:384 sc1
buffer_load_dwordx4 v[52:55], v58, s[12:15], 0 offen offset:448 sc1
s_mov_b64 exec, -1
v_mul_f32_e64 v84, v68, -v21
v_mul_f32_e64 v85, v69, -v21
v_mul_f32_e64 v86, v70, -v21
v_mul_f32_e64 v87, v71, -v21
v_mul_f32_e64 v88, v72, -v21
v_mul_f32_e64 v89, v73, -v21
v_mul_f32_e64 v90, v74, -v21
v_mul_f32_e64 v91, v75, -v21
s_cmp_eq_u32 s73, 0
s_cbranch_scc1 L_pkf
s_waitcnt vmcnt(8)
s_add_u32 s78, s78, 1
s_cmp_le_u32 s78, 65536
s_cbranch_scc1 L_pk2
L_pkf:
s_waitcnt vmcnt(0)
L_pkx_chk:
v_max3_u32 v2, v24, v28, v32
v_max3_u32 v3, v36, v40, v44
v_max3_u32 v2, v2, v48, v52
v_max_u32 v2, v2, v3
v_cmp_eq_u32 vcc, -1, v2
s_nop 0
s_and_b64 vcc, vcc, s[92:93]
s_cbranch_vccnz L_pkx_rt
L_pkx_ok:
v_mfma_f32_16x16x32_bf16 v[84:87], a[0:3], v[24:27], v[84:87]
v_mfma_f32_16x16x32_bf16 v[88:91], a[32:35], v[24:27], v[88:91]
v_mfma_f32_16x16x32_bf16 v[84:87], a[4:7], v[28:31], v[84:87]
v_mfma_f32_16x16x32_bf16 v[88:91], a[36:39], v[28:31], v[88:91]
v_mfma_f32_16x16x32_bf16 v[84:87], a[8:11], v[32:35], v[84:87]
v_mfma_f32_16x16x32_bf16 v[88:91], a[40:43], v[32:35], v[88:91]
v_mfma_f32_16x16x32_bf16 v[84:87], a[12:15], v[36:39], v[84:87]
v_mfma_f32_16x16x32_bf16 v[88:91], a[44:47], v[36:39], v[88:91]
v_mfma_f32_16x16x32_bf16 v[84:87], a[16:19], v[40:43], v[84:87]
v_mfma_f32_16x16x32_bf16 v[88:91], a[48:51], v[40:43], v[88:91]
v_mfma_f32_16x16x32_bf16 v[84:87], a[20:23], v[44:47], v[84:87]
v_mfma_f32_16x16x32_bf16 v[88:91], a[52:55], v[44:47], v[88:91]
v_mfma_f32_16x16x32_bf16 v[84:87], a[24:27], v[48:51], v[84:87]
v_mfma_f32_16x16x32_bf16 v[88:91], a[56:59], v[48:51], v[88:91]
v_mfma_f32_16x16x32_bf16 v[84:87], a[28:31], v[52:55], v[84:87]
v_mfma_f32_16x16x32_bf16 v[88:91], a[60:63], v[52:55], v[88:91]
s_mov_b32 s76, 0xcccccccc
s_mov_b32 s77, 0xcccccccc
s_nop 5
v_cndmask_b32_e64 v84, v84, v88, s[76:77]
v_cndmask_b32_e64 v85, v85, v89, s[76:77]
v_cndmask_b32_e64 v86, v86, v90, s[76:77]
v_cndmask_b32_e64 v87, v87, v91, s[76:77]
v_bfi_b32 v84, s91, v59, v84
s_mov_b64 exec, s[92:93]
s_cmp_eq_u32 s69, 0
s_cbranch_scc1 L_pxp_s
buffer_store_dwordx4 v[84:87], v60, s[12:15], s85 offen
L_pxp_d:
s_mov_b64 exec, -1
buffer_load_dwordx4 v[24:27], v61, s[12:15], s86 offen offset:0 sc1
buffer_load_dwordx4 v[28:31], v61, s[12:15], s86 offen offset:1024 sc1
buffer_load_dwordx4 v[32:35], v61, s[12:15], s86 offen offset:2048 sc1
buffer_load_dwordx4 v[36:39], v61, s[12:15], s86 offen offset:3072 sc1
s_barrier
s_mov_b32 s92, 0x00030003
s_mov_b32 s93, 0x00030003
s_waitcnt vmcnt(0)
L_px_chk:
v_xor_b32 v24, s84, v24
v_xor_b32 v28, s84, v28
v_xor_b32 v32, s84, v32
v_xor_b32 v36, s84, v36
v_or3_b32 v2, v24, v28, v32
v_bitop3_b32 v2, v2, v36, s91 bitop3:0xa8
v_cmp_ne_u32 vcc, 0, v2
s_cbranch_vccnz L_px_rt
L_px_ok:
v_pk_add_f32 v[24:25], v[24:25], v[28:29]
v_pk_add_f32 v[32:33], v[32:33], v[36:37]
v_pk_add_f32 v[26:27], v[26:27], v[30:31]
v_pk_add_f32 v[34:35], v[34:35], v[38:39]
v_pk_add_f32 v[24:25], v[24:25], v[32:33]
v_pk_add_f32 v[26:27], v[26:27], v[34:35]
v_pk_mul_f32 v[24:25], v[24:25], v[22:23] op_sel_hi:[1,0]
v_pk_mul_f32 v[26:27], v[26:27], v[22:23] op_sel_hi:[1,0]
v_mul_f32 v28, 0xbfb8aa3b, v24
v_mul_f32 v29, 0xbfb8aa3b, v25
v_mul_f32 v30, 0xbfb8aa3b, v26
v_mul_f32 v31, 0xbfb8aa3b, v27
v_exp_f32 v28, v28
v_exp_f32 v29, v29
v_exp_f32 v30, v30
v_exp_f32 v31, v31
v_mul_f32_dpp v32, v24, v24 quad_perm:[2,3,0,1] row_mask:0xf bank_mask:0xf
v_mul_f32_dpp v33, v25, v25 quad_perm:[2,3,0,1] row_mask:0xf bank_mask:0xf
v_mul_f32_dpp v34, v26, v26 quad_perm:[2,3,0,1] row_mask:0xf bank_mask:0xf
v_mul_f32_dpp v35, v27, v27 quad_perm:[2,3,0,1] row_mask:0xf bank_mask:0xf
v_add_f32 v28, 1.0, v28
v_add_f32 v29, 1.0, v29
v_add_f32 v30, 1.0, v30
v_add_f32 v31, 1.0, v31
v_rcp_f32 v28, v28
v_rcp_f32 v29, v29
v_rcp_f32 v30, v30
v_rcp_f32 v31, v31
v_mul_f32 v24, v32, v28
v_mul_f32 v25, v33, v29
v_mul_f32 v26, v34, v30
v_mul_f32 v27, v35, v31
v_cvt_pk_bf16_f32 v28, v24, v25
v_cvt_pk_bf16_f32 v29, v26, v27
s_nop 0
v_mov_b32_dpp v30, v28 row_shl:4 row_mask:0xf bank_mask:0xf
v_mov_b32_dpp v31, v29 row_shl:4 row_mask:0xf bank_mask:0xf
v_mov_b32_dpp v32, v28 row_shl:8 row_mask:0xf bank_mask:0xf
v_mov_b32_dpp v33, v29 row_shl:8 row_mask:0xf bank_mask:0xf
v_mov_b32_dpp v34, v28 row_shl:12 row_mask:0xf bank_mask:0xf
v_mov_b32_dpp v35, v29 row_shl:12 row_mask:0xf bank_mask:0xf
v_mfma_f32_16x16x32_bf16 v[40:43], a[64:67], v[28:31], 0
v_mfma_f32_16x16x32_bf16 v[44:47], a[72:75], v[28:31], 0
v_mfma_f32_16x16x32_bf16 v[48:51], a[80:83], v[28:31], 0
v_mfma_f32_16x16x32_bf16 v[52:55], a[88:91], v[28:31], 0
v_mfma_f32_16x16x32_bf16 v[40:43], a[68:71], v[32:35], v[40:43]
v_mfma_f32_16x16x32_bf16 v[44:47], a[76:79], v[32:35], v[44:47]
v_mfma_f32_16x16x32_bf16 v[48:51], a[84:87], v[32:35], v[48:51]
v_mfma_f32_16x16x32_bf16 v[52:55], a[92:95], v[32:35], v[52:55]
s_cmp_ge_u32 s64, 14
s_cbranch_scc1 L_noy
s_mov_b64 exec, s[92:93]
s_nop 1
v_bfi_b32 v40, s91, v59, v40
buffer_store_dwordx4 v[40:43], v62, s[12:15], s88 offen sc1
s_add_u32 s88, s88, 8192
v_bfi_b32 v44, s91, v59, v44
buffer_store_dwordx4 v[44:47], v62, s[12:15], s88 offen sc1
s_add_u32 s88, s88, 8192
v_bfi_b32 v48, s91, v59, v48
buffer_store_dwordx4 v[48:51], v62, s[12:15], s88 offen sc1
s_add_u32 s88, s88, 8192
v_bfi_b32 v52, s91, v59, v52
buffer_store_dwordx4 v[52:55], v62, s[12:15], s88 offen sc1
s_mov_b64 exec, -1
L_noy:
s_or_b32 s70, s2, s60
s_cbranch_scc1 L_noep
v_mov_b32 v3, 0
s_mov_b64 exec, 1
buffer_store_dword v59, v3, s[12:15], 0 offen sc1
s_mov_b64 exec, -1
L_noep:
s_cmp_lt_u32 s63, 24
s_cbranch_scc1 L_ldone
s_cmp_lg_u32 s60, 1
s_cbranch_scc1 L_ldone
s_lshl_b32 s87, s62, 3
s_add_u32 s87, s87, s63
s_sub_u32 s87, s87, 24
s_lshl_b32 s88, s87, 13
s_add_u32 s88, s88, 7340032
s_add_u32 s71, s88, 4096
s_lshl_b32 s70, s87, 5
v_bfe_u32 v3, v1, 1, 2
v_lshl_add_u32 v7, v3, 3, s70
s_mov_b32 s72, 7864320
v_lshl_add_u32 v64, v23, 11, v7
buffer_load_dwordx2 v[84:85], v64, s[12:15], s72 offen sc1
buffer_load_dwordx4 v[120:123], v18, s[12:15], s88 offen offset:0 sc1
buffer_load_dwordx4 v[124:127], v18, s[12:15], s88 offen offset:1024 sc1
buffer_load_dwordx4 v[128:131], v18, s[12:15], s88 offen offset:2048 sc1
buffer_load_dwordx4 v[132:135], v18, s[12:15], s88 offen offset:3072 sc1
buffer_load_dwordx4 v[136:139], v18, s[12:15], s71 offen offset:0 sc1
buffer_load_dwordx4 v[140:143], v18, s[12:15], s71 offen offset:1024 sc1
buffer_load_dwordx4 v[144:147], v18, s[12:15], s71 offen offset:2048 sc1
v_mov_b32 v88, s84
v_and_b32 v65, 0xfffff800, v20
v_not_b32 v4, v65
v_ashrrev_i32 v4, 31, v4
v_or_b32 v4, 0x80000000, v4
v_xor_b32 v65, v65, v4
v_mul_f32 v65, 0xbfb8aa3b, v65
v_exp_f32 v65, v65
s_nop 0
v_add_f32 v65, 1.0, v65
v_rcp_f32 v65, v65
v_and_b32 v66, 0x7ff, v20
v_sub_u32 v66, 2047, v66
v_lshl_add_u32 v66, v66, 11, v7
v_add_f32 v67, 1.0, v22
v_mul_f32_e64 v21, -v21, v22
s_waitcnt vmcnt(7)
L_h_chk:
v_cmp_eq_u32 vcc, -1, v84
s_cbranch_vccnz L_h_rt
L_h_ok:
v_lshlrev_b32 v86, 16, v85
v_and_b32 v87, 0xffff0000, v85
v_and_b32 v85, 0xffff0000, v84
v_lshlrev_b32 v84, 16, v84
v_fma_f32 v84, v84, v67, v21
v_fma_f32 v85, v85, v67, v21
v_fma_f32 v86, v86, v67, v21
v_fma_f32 v87, v87, v67, v21
s_waitcnt vmcnt(0)
L_y_chk:
v_xor_b32 v120, s84, v120
v_xor_b32 v124, s84, v124
v_xor_b32 v128, s84, v128
v_xor_b32 v132, s84, v132
v_or3_b32 v2, v120, v124, v128
v_xor_b32 v136, s84, v136
v_xor_b32 v140, s84, v140
v_or3_b32 v2, v2, v132, v136
v_xor_b32 v144, s84, v144
v_xor_b32 v88, s84, v88
v_or3_b32 v2, v2, v140, v144
v_bitop3_b32 v2, v2, v88, s91 bitop3:0xa8
v_cmp_ne_u32 vcc, 0, v2
s_cbranch_vccnz L_y_rt
L_y_ok:
v_pk_add_f32 v[120:121], v[120:121], v[124:125]
v_pk_add_f32 v[122:123], v[122:123], v[126:127]
v_pk_add_f32 v[128:129], v[128:129], v[132:133]
v_pk_add_f32 v[130:131], v[130:131], v[134:135]
v_pk_add_f32 v[136:137], v[136:137], v[140:141]
v_pk_add_f32 v[138:139], v[138:139], v[142:143]
v_pk_add_f32 v[120:121], v[120:121], v[128:129]
v_pk_add_f32 v[122:123], v[122:123], v[130:131]
v_pk_add_f32 v[136:137], v[136:137], v[144:145]
v_pk_add_f32 v[138:139], v[138:139], v[146:147]
v_pk_add_f32 v[120:121], v[120:121], v[136:137]
v_pk_add_f32 v[122:123], v[122:123], v[138:139]
s_nop 0
v_add_f32_dpp v120, v120, v120 row_ror:8 row_mask:0xf bank_mask:0xf
v_add_f32_dpp v121, v121, v121 row_ror:8 row_mask:0xf bank_mask:0xf
v_add_f32_dpp v122, v122, v122 row_ror:8 row_mask:0xf bank_mask:0xf
v_add_f32_dpp v123, v123, v123 row_ror:8 row_mask:0xf bank_mask:0xf
v_mov_b32 v124, v120
v_mov_b32 v125, v121
v_mov_b32 v126, v122
v_mov_b32 v127, v123
v_permlane16_swap_b32 v120, v124
v_permlane16_swap_b32 v121, v125
v_permlane16_swap_b32 v122, v126
v_permlane16_swap_b32 v123, v127
v_add_f32 v120, v120, v124
v_add_f32 v121, v121, v125
v_add_f32 v122, v122, v126
v_add_f32 v123, v123, v127
v_mov_b32 v124, v120
v_mov_b32 v125, v121
v_mov_b32 v126, v122
v_mov_b32 v127, v123
v_permlane32_swap_b32 v120, v124
v_permlane32_swap_b32 v121, v125
v_permlane32_swap_b32 v122, v126
v_permlane32_swap_b32 v123, v127
v_add_f32 v120, v120, v124
v_add_f32 v121, v121, v125
v_add_f32 v122, v122, v126
v_add_f32 v123, v123, v127
v_fmac_f32 v84, v120, v65
v_fmac_f32 v85, v121, v65
v_fmac_f32 v86, v122, v65
v_fmac_f32 v87, v123, v65
v_cvt_pk_bf16_f32 v84, v84, v85
v_cvt_pk_bf16_f32 v85, v86, v87
s_mov_b64 exec, 0xff
buffer_store_dwordx2 v[84:85], v66, s[20:23], 0 offen sc1
L_ldone:
s_endpgm
L_compute:
v_and_b32 v2, 15, v1
v_lshrrev_b32 v4, 4, v1
v_lshrrev_b32 v3, 1, v2
v_xor_b32 v3, v3, v4
v_lshlrev_b32 v2, 7, v2
s_lshl_b32 s70, s66, 13
v_add_u32 v2, s70, v2
v_xor_b32 v5, 0, v3
v_lshl_add_u32 v8, v5, 4, v2
v_add_u32 v10, 65536, v8
v_xor_b32 v5, 4, v3
v_lshl_add_u32 v9, v5, 4, v2
v_add_u32 v11, 65536, v9
v_lshrrev_b32 v2, 5, v1
v_mul_u32_u24 v2, 6144, v2
v_bfe_u32 v3, v1, 4, 1
v_lshl_add_u32 v2, v3, 10, v2
v_bfe_u32 v4, v1, 2, 2
v_lshl_add_u32 v2, v4, 7, v2
v_lshlrev_b32 v3, 1, v3
v_bfe_u32 v4, v1, 3, 1
v_or_b32 v3, v3, v4
s_lshl_b32 s70, s67, 1
v_xor_b32 v3, s70, v3
v_and_b32 v4, 3, v1
v_lshl_add_u32 v2, v4, 3, v2
v_xor_b32 v4, 0, v3
v_lshl_add_u32 v12, v4, 5, v2
v_add_u32 v14, 65536, v12
v_xor_b32 v4, 1, v3
v_lshl_add_u32 v13, v4, 5, v2
v_add_u32 v15, 65536, v13
s_waitcnt lgkmcnt(0)
s_mov_b32 s12, s58
s_and_b32 s13, s59, 0xffff
s_mov_b32 s14, 268435456
s_mov_b32 s15, 0x20000
s_load_dword s68, s[58:59], 0
s_mov_b32 s20, s56
s_and_b32 s21, s57, 0xffff
s_mov_b32 s22, 4194304
s_mov_b32 s23, 0x20000
s_lshl_b32 s87, s64, 4
s_add_u32 s87, s87, s65
s_mul_i32 s87, s87, 4352
s_add_u32 s87, s87, 524288
s_lshl_b32 s88, s65, 18
s_lshl_b32 s70, s66, 17
s_add_u32 s88, s88, s70
s_lshl_b32 s70, s64, 11
s_add_u32 s88, s88, s70
s_lshl_b32 s70, s67, 10
s_add_u32 s88, s88, s70
s_add_u32 s88, s88, 2097152
v_mov_b32 v32, 0
v_mov_b32 v33, 0
v_mov_b32 v34, 0
v_mov_b32 v35, 0
v_mov_b32 v36, 0
v_mov_b32 v37, 0
v_mov_b32 v38, 0
v_mov_b32 v39, 0
v_mov_b32 v40, 0
v_mov_b32 v41, 0
v_mov_b32 v42, 0
v_mov_b32 v43, 0
v_mov_b32 v44, 0
v_mov_b32 v45, 0
v_mov_b32 v46, 0
v_mov_b32 v47, 0
v_mov_b32 v48, 0
v_mov_b32 v49, 0
v_mov_b32 v50, 0
v_mov_b32 v51, 0
v_mov_b32 v52, 0
v_mov_b32 v53, 0
v_mov_b32 v54, 0
v_mov_b32 v55, 0
v_mov_b32 v56, 0
v_mov_b32 v57, 0
v_mov_b32 v58, 0
v_mov_b32 v59, 0
v_mov_b32 v60, 0
v_mov_b32 v61, 0
v_mov_b32 v62, 0
v_mov_b32 v63, 0
v_mov_b32 v64, 0
v_mov_b32 v65, 0
v_mov_b32 v66, 0
v_mov_b32 v67, 0
v_mov_b32 v68, 0
v_mov_b32 v69, 0
v_mov_b32 v70, 0
v_mov_b32 v71, 0
v_mov_b32 v72, 0
v_mov_b32 v73, 0
v_mov_b32 v74, 0
v_mov_b32 v75, 0
v_mov_b32 v76, 0
v_mov_b32 v77, 0
v_mov_b32 v78, 0
v_mov_b32 v79, 0
v_mov_b32 v80, 0
v_mov_b32 v81, 0
v_mov_b32 v82, 0
v_mov_b32 v83, 0
v_mov_b32 v84, 0
v_mov_b32 v85, 0
v_mov_b32 v86, 0
v_mov_b32 v87, 0
v_mov_b32 v88, 0
v_mov_b32 v89, 0
v_mov_b32 v90, 0
v_mov_b32 v91, 0
v_mov_b32 v92, 0
v_mov_b32 v93, 0
v_mov_b32 v94, 0
v_mov_b32 v95, 0
v_mov_b32 v96, 0
v_mov_b32 v97, 0
v_mov_b32 v98, 0
v_mov_b32 v99, 0
v_mov_b32 v100, 0
v_mov_b32 v101, 0
v_mov_b32 v102, 0
v_mov_b32 v103, 0
v_mov_b32 v104, 0
v_mov_b32 v105, 0
v_mov_b32 v106, 0
v_mov_b32 v107, 0
v_mov_b32 v108, 0
v_mov_b32 v109, 0
v_mov_b32 v110, 0
v_mov_b32 v111, 0
v_mov_b32 v112, 0
v_mov_b32 v113, 0
v_mov_b32 v114, 0
v_mov_b32 v115, 0
v_mov_b32 v116, 0
v_mov_b32 v117, 0
v_mov_b32 v118, 0
v_mov_b32 v119, 0
v_mov_b32 v120, 0
v_mov_b32 v121, 0
v_mov_b32 v122, 0
v_mov_b32 v123, 0
v_mov_b32 v124, 0
v_mov_b32 v125, 0
v_mov_b32 v126, 0
v_mov_b32 v127, 0
s_mov_b32 s70, 0x3f803f80
v_accvgpr_write_b32 a80, s70
v_accvgpr_write_b32 a81, s70
v_accvgpr_write_b32 a82, s70
v_accvgpr_write_b32 a83, s70
s_mov_b32 s80, 0x358637bd
s_mov_b32 s81, 0x358637bd
s_mov_b32 s82, 0x3f800008
s_mov_b32 s83, 0x3f800008
s_mov_b32 s90, 0x3fb8aa3b
s_mov_b32 s91, 0x3fb8aa3b
s_waitcnt lgkmcnt(0)
s_add_u32 s68, s68, 1
v_and_b32 v7, 3, v1
v_lshrrev_b32_e64 v7, v7, s68
v_and_b32 v7, 1, v7
v_mul_u32_u24 v7, 0x10001, v7
s_mov_b32 s76, 0x10001
s_mov_b32 s77, 0x07060302
s_movk_i32 s85, 0xff
v_mov_b32 v28, -1
v_mov_b32 v29, -1
v_mov_b32 v30, -1
v_mov_b32 v31, -1
s_barrier
ds_read_b128 a[0:3], v10 offset:57344
ds_read_b64_tr_b16 a[32:33], v12 offset:0
ds_read_b64_tr_b16 a[34:35], v12 offset:512
ds_read_b128 a[4:7], v10 offset:59392
ds_read_b128 a[8:11], v10 offset:61440
ds_read_b128 a[12:15], v10 offset:63488
ds_read_b64_tr_b16 a[36:37], v13 offset:0
ds_read_b64_tr_b16 a[38:39], v13 offset:512
ds_read_b64_tr_b16 a[40:41], v12 offset:2048
ds_read_b64_tr_b16 a[42:43], v12 offset:2560
ds_read_b64_tr_b16 a[44:45], v13 offset:2048
ds_read_b64_tr_b16 a[46:47], v13 offset:2560
ds_read_b64_tr_b16 a[48:49], v12 offset:4096
ds_read_b64_tr_b16 a[50:51], v12 offset:4608
ds_read_b64_tr_b16 a[52:53], v13 offset:4096
ds_read_b64_tr_b16 a[54:55], v13 offset:4608
s_waitcnt lgkmcnt(0)
s_cmp_lg_u32 s66, 0
s_cbranch_scc1 L_nocs0
v_mfma_f32_16x16x32_bf16 v[128:131], a[80:83], a[32:35], 0
v_mfma_f32_16x16x32_bf16 v[132:135], a[80:83], a[36:39], 0
v_mfma_f32_16x16x32_bf16 v[136:139], a[80:83], a[40:43], 0
v_mfma_f32_16x16x32_bf16 v[140:143], a[80:83], a[44:47], 0
v_mfma_f32_16x16x32_bf16 v[144:147], a[80:83], a[48:51], 0
v_mfma_f32_16x16x32_bf16 v[148:151], a[80:83], a[52:55], 0
L_nocs0:
v_mfma_f32_16x16x32_bf16 v[32:35], a[32:35], a[0:3], v[32:35]
ds_read_b128 a[16:19], v11 offset:57344
v_mfma_f32_16x16x32_bf16 v[56:59], a[32:35], a[4:7], v[56:59]
ds_read_b64_tr_b16 a[56:57], v12 offset:12288
v_mfma_f32_16x16x32_bf16 v[80:83], a[32:35], a[8:11], v[80:83]
ds_read_b64_tr_b16 a[58:59], v12 offset:12800
v_mfma_f32_16x16x32_bf16 v[104:107], a[32:35], a[12:15], v[104:107]
ds_read_b128 a[20:23], v11 offset:59392
v_mfma_f32_16x16x32_bf16 v[36:39], a[36:39], a[0:3], v[36:39]
ds_read_b128 a[24:27], v11 offset:61440
v_mfma_f32_16x16x32_bf16 v[60:63], a[36:39], a[4:7], v[60:63]
ds_read_b128 a[28:31], v11 offset:63488
v_mfma_f32_16x16x32_bf16 v[84:87], a[36:39], a[8:11], v[84:87]
ds_read_b64_tr_b16 a[60:61], v13 offset:12288
v_mfma_f32_16x16x32_bf16 v[108:111], a[36:39], a[12:15], v[108:111]
ds_read_b64_tr_b16 a[62:63], v13 offset:12800
v_mfma_f32_16x16x32_bf16 v[40:43], a[0:3], a[40:43], v[40:43]
ds_read_b64_tr_b16 a[64:65], v12 offset:14336
v_mfma_f32_16x16x32_bf16 v[64:67], a[4:7], a[40:43], v[64:67]
ds_read_b64_tr_b16 a[66:67], v12 offset:14848
v_mfma_f32_16x16x32_bf16 v[88:91], a[8:11], a[40:43], v[88:91]
ds_read_b64_tr_b16 a[68:69], v13 offset:14336
v_mfma_f32_16x16x32_bf16 v[112:115], a[12:15], a[40:43], v[112:115]
ds_read_b64_tr_b16 a[70:71], v13 offset:14848
v_mfma_f32_16x16x32_bf16 v[44:47], a[0:3], a[44:47], v[44:47]
ds_read_b64_tr_b16 a[72:73], v12 offset:16384
v_mfma_f32_16x16x32_bf16 v[68:71], a[4:7], a[44:47], v[68:71]
ds_read_b64_tr_b16 a[74:75], v12 offset:16896
v_mfma_f32_16x16x32_bf16 v[92:95], a[8:11], a[44:47], v[92:95]
ds_read_b64_tr_b16 a[76:77], v13 offset:16384
v_mfma_f32_16x16x32_bf16 v[116:119], a[12:15], a[44:47], v[116:119]
ds_read_b64_tr_b16 a[78:79], v13 offset:16896
v_mfma_f32_16x16x32_bf16 v[48:51], a[0:3], a[48:51], v[48:51]
v_mfma_f32_16x16x32_bf16 v[72:75], a[4:7], a[48:51], v[72:75]
v_mfma_f32_16x16x32_bf16 v[96:99], a[8:11], a[48:51], v[96:99]
v_mfma_f32_16x16x32_bf16 v[120:123], a[12:15], a[48:51], v[120:123]
v_mfma_f32_16x16x32_bf16 v[52:55], a[0:3], a[52:55], v[52:55]
v_mfma_f32_16x16x32_bf16 v[76:79], a[4:7], a[52:55], v[76:79]
v_mfma_f32_16x16x32_bf16 v[100:103], a[8:11], a[52:55], v[100:103]
v_mfma_f32_16x16x32_bf16 v[124:127], a[12:15], a[52:55], v[124:127]
s_waitcnt lgkmcnt(0)
s_cmp_lg_u32 s66, 0
s_cbranch_scc1 L_nocs1
v_mfma_f32_16x16x32_bf16 v[128:131], a[80:83], a[56:59], v[128:131]
v_mfma_f32_16x16x32_bf16 v[132:135], a[80:83], a[60:63], v[132:135]
v_mfma_f32_16x16x32_bf16 v[136:139], a[80:83], a[64:67], v[136:139]
v_mfma_f32_16x16x32_bf16 v[140:143], a[80:83], a[68:71], v[140:143]
v_mfma_f32_16x16x32_bf16 v[144:147], a[80:83], a[72:75], v[144:147]
v_mfma_f32_16x16x32_bf16 v[148:151], a[80:83], a[76:79], v[148:151]
L_nocs1:
v_mfma_f32_16x16x32_bf16 v[32:35], a[56:59], a[16:19], v[32:35]
s_barrier
ds_read_b128 a[0:3], v10 offset:40960
v_mfma_f32_16x16x32_bf16 v[56:59], a[56:59], a[20:23], v[56:59]
ds_read_b64_tr_b16 a[32:33], v14 offset:16384
v_mfma_f32_16x16x32_bf16 v[80:83], a[56:59], a[24:27], v[80:83]
ds_read_b64_tr_b16 a[34:35], v14 offset:16896
v_mfma_f32_16x16x32_bf16 v[104:107], a[56:59], a[28:31], v[104:107]
ds_read_b128 a[4:7], v10 offset:43008
v_mfma_f32_16x16x32_bf16 v[36:39], a[60:63], a[16:19], v[36:39]
ds_read_b128 a[8:11], v10 offset:45056
v_mfma_f32_16x16x32_bf16 v[60:63], a[60:63], a[20:23], v[60:63]
ds_read_b128 a[12:15], v10 offset:47104
v_mfma_f32_16x16x32_bf16 v[84:87], a[60:63], a[24:27], v[84:87]
ds_read_b64_tr_b16 a[36:37], v15 offset:16384
v_mfma_f32_16x16x32_bf16 v[108:111], a[60:63], a[28:31], v[108:111]
ds_read_b64_tr_b16 a[38:39], v15 offset:16896
v_mfma_f32_16x16x32_bf16 v[40:43], a[16:19], a[64:67], v[40:43]
ds_read_b64_tr_b16 a[40:41], v14 offset:18432
v_mfma_f32_16x16x32_bf16 v[64:67], a[20:23], a[64:67], v[64:67]
ds_read_b64_tr_b16 a[42:43], v14 offset:18944
v_mfma_f32_16x16x32_bf16 v[88:91], a[24:27], a[64:67], v[88:91]
ds_read_b64_tr_b16 a[44:45], v15 offset:18432
v_mfma_f32_16x16x32_bf16 v[112:115], a[28:31], a[64:67], v[112:115]
ds_read_b64_tr_b16 a[46:47], v15 offset:18944
v_mfma_f32_16x16x32_bf16 v[44:47], a[16:19], a[68:71], v[44:47]
ds_read_b64_tr_b16 a[48:49], v14 offset:20480
v_mfma_f32_16x16x32_bf16 v[68:71], a[20:23], a[68:71], v[68:71]
ds_read_b64_tr_b16 a[50:51], v14 offset:20992
v_mfma_f32_16x16x32_bf16 v[92:95], a[24:27], a[68:71], v[92:95]
ds_read_b64_tr_b16 a[52:53], v15 offset:20480
v_mfma_f32_16x16x32_bf16 v[116:119], a[28:31], a[68:71], v[116:119]
ds_read_b64_tr_b16 a[54:55], v15 offset:20992
v_mfma_f32_16x16x32_bf16 v[48:51], a[16:19], a[72:75], v[48:51]
v_mfma_f32_16x16x32_bf16 v[72:75], a[20:23], a[72:75], v[72:75]
v_mfma_f32_16x16x32_bf16 v[96:99], a[24:27], a[72:75], v[96:99]
v_mfma_f32_16x16x32_bf16 v[120:123], a[28:31], a[72:75], v[120:123]
v_mfma_f32_16x16x32_bf16 v[52:55], a[16:19], a[76:79], v[52:55]
v_mfma_f32_16x16x32_bf16 v[76:79], a[20:23], a[76:79], v[76:79]
v_mfma_f32_16x16x32_bf16 v[100:103], a[24:27], a[76:79], v[100:103]
v_mfma_f32_16x16x32_bf16 v[124:127], a[28:31], a[76:79], v[124:127]
s_waitcnt lgkmcnt(0)
v_mfma_f32_16x16x32_bf16 v[32:35], a[32:35], a[0:3], v[32:35]
ds_read_b128 a[16:19], v11 offset:40960
v_mfma_f32_16x16x32_bf16 v[56:59], a[32:35], a[4:7], v[56:59]
ds_read_b64_tr_b16 a[56:57], v14 offset:28672
v_mfma_f32_16x16x32_bf16 v[80:83], a[32:35], a[8:11], v[80:83]
ds_read_b64_tr_b16 a[58:59], v14 offset:29184
v_mfma_f32_16x16x32_bf16 v[104:107], a[32:35], a[12:15], v[104:107]
ds_read_b128 a[20:23], v11 offset:43008
v_mfma_f32_16x16x32_bf16 v[36:39], a[36:39], a[0:3], v[36:39]
ds_read_b128 a[24:27], v11 offset:45056
v_mfma_f32_16x16x32_bf16 v[60:63], a[36:39], a[4:7], v[60:63]
ds_read_b128 a[28:31], v11 offset:47104
v_mfma_f32_16x16x32_bf16 v[84:87], a[36:39], a[8:11], v[84:87]
ds_read_b64_tr_b16 a[60:61], v15 offset:28672
v_mfma_f32_16x16x32_bf16 v[108:111], a[36:39], a[12:15], v[108:111]
ds_read_b64_tr_b16 a[62:63], v15 offset:29184
v_mfma_f32_16x16x32_bf16 v[40:43], a[0:3], a[40:43], v[40:43]
ds_read_b64_tr_b16 a[64:65], v14 offset:30720
v_mfma_f32_16x16x32_bf16 v[64:67], a[4:7], a[40:43], v[64:67]
ds_read_b64_tr_b16 a[66:67], v14 offset:31232
v_mfma_f32_16x16x32_bf16 v[88:91], a[8:11], a[40:43], v[88:91]
ds_read_b64_tr_b16 a[68:69], v15 offset:30720
v_mfma_f32_16x16x32_bf16 v[112:115], a[12:15], a[40:43], v[112:115]
ds_read_b64_tr_b16 a[70:71], v15 offset:31232
v_mfma_f32_16x16x32_bf16 v[44:47], a[0:3], a[44:47], v[44:47]
ds_read_b64_tr_b16 a[72:73], v14 offset:32768
v_mfma_f32_16x16x32_bf16 v[68:71], a[4:7], a[44:47], v[68:71]
ds_read_b64_tr_b16 a[74:75], v14 offset:33280
v_mfma_f32_16x16x32_bf16 v[92:95], a[8:11], a[44:47], v[92:95]
ds_read_b64_tr_b16 a[76:77], v15 offset:32768
v_mfma_f32_16x16x32_bf16 v[116:119], a[12:15], a[44:47], v[116:119]
ds_read_b64_tr_b16 a[78:79], v15 offset:33280
v_mfma_f32_16x16x32_bf16 v[48:51], a[0:3], a[48:51], v[48:51]
v_mfma_f32_16x16x32_bf16 v[72:75], a[4:7], a[48:51], v[72:75]
v_mfma_f32_16x16x32_bf16 v[96:99], a[8:11], a[48:51], v[96:99]
v_mfma_f32_16x16x32_bf16 v[120:123], a[12:15], a[48:51], v[120:123]
v_mfma_f32_16x16x32_bf16 v[52:55], a[0:3], a[52:55], v[52:55]
v_mfma_f32_16x16x32_bf16 v[76:79], a[4:7], a[52:55], v[76:79]
v_mfma_f32_16x16x32_bf16 v[100:103], a[8:11], a[52:55], v[100:103]
v_mfma_f32_16x16x32_bf16 v[124:127], a[12:15], a[52:55], v[124:127]
s_waitcnt lgkmcnt(0)
v_mfma_f32_16x16x32_bf16 v[32:35], a[56:59], a[16:19], v[32:35]
s_barrier
ds_read_b128 a[0:3], v10 offset:0
v_mfma_f32_16x16x32_bf16 v[56:59], a[56:59], a[20:23], v[56:59]
ds_read_b64_tr_b16 a[32:33], v12 offset:40960
v_mfma_f32_16x16x32_bf16 v[80:83], a[56:59], a[24:27], v[80:83]
ds_read_b64_tr_b16 a[34:35], v12 offset:41472
v_mfma_f32_16x16x32_bf16 v[104:107], a[56:59], a[28:31], v[104:107]
ds_read_b128 a[4:7], v10 offset:2048
v_mfma_f32_16x16x32_bf16 v[36:39], a[60:63], a[16:19], v[36:39]
ds_read_b128 a[8:11], v10 offset:4096
v_mfma_f32_16x16x32_bf16 v[60:63], a[60:63], a[20:23], v[60:63]
ds_read_b128 a[12:15], v10 offset:6144
v_mfma_f32_16x16x32_bf16 v[84:87], a[60:63], a[24:27], v[84:87]
ds_read_b64_tr_b16 a[36:37], v13 offset:40960
v_mfma_f32_16x16x32_bf16 v[108:111], a[60:63], a[28:31], v[108:111]
ds_read_b64_tr_b16 a[38:39], v13 offset:41472
v_mfma_f32_16x16x32_bf16 v[40:43], a[16:19], a[64:67], v[40:43]
ds_read_b64_tr_b16 a[40:41], v12 offset:43008
v_mfma_f32_16x16x32_bf16 v[64:67], a[20:23], a[64:67], v[64:67]
ds_read_b64_tr_b16 a[42:43], v12 offset:43520
v_mfma_f32_16x16x32_bf16 v[88:91], a[24:27], a[64:67], v[88:91]
ds_read_b64_tr_b16 a[44:45], v13 offset:43008
v_mfma_f32_16x16x32_bf16 v[112:115], a[28:31], a[64:67], v[112:115]
ds_read_b64_tr_b16 a[46:47], v13 offset:43520
v_mfma_f32_16x16x32_bf16 v[44:47], a[16:19], a[68:71], v[44:47]
ds_read_b64_tr_b16 a[48:49], v12 offset:45056
v_mfma_f32_16x16x32_bf16 v[68:71], a[20:23], a[68:71], v[68:71]
ds_read_b64_tr_b16 a[50:51], v12 offset:45568
v_mfma_f32_16x16x32_bf16 v[92:95], a[24:27], a[68:71], v[92:95]
ds_read_b64_tr_b16 a[52:53], v13 offset:45056
v_mfma_f32_16x16x32_bf16 v[116:119], a[28:31], a[68:71], v[116:119]
ds_read_b64_tr_b16 a[54:55], v13 offset:45568
v_mfma_f32_16x16x32_bf16 v[48:51], a[16:19], a[72:75], v[48:51]
v_mfma_f32_16x16x32_bf16 v[72:75], a[20:23], a[72:75], v[72:75]
v_mfma_f32_16x16x32_bf16 v[96:99], a[24:27], a[72:75], v[96:99]
v_mfma_f32_16x16x32_bf16 v[120:123], a[28:31], a[72:75], v[120:123]
v_mfma_f32_16x16x32_bf16 v[52:55], a[16:19], a[76:79], v[52:55]
v_mfma_f32_16x16x32_bf16 v[76:79], a[20:23], a[76:79], v[76:79]
v_mfma_f32_16x16x32_bf16 v[100:103], a[24:27], a[76:79], v[100:103]
v_mfma_f32_16x16x32_bf16 v[124:127], a[28:31], a[76:79], v[124:127]
s_waitcnt lgkmcnt(0)
v_mfma_f32_16x16x32_bf16 v[32:35], a[32:35], a[0:3], v[32:35]
ds_read_b128 a[16:19], v11 offset:0
v_mfma_f32_16x16x32_bf16 v[56:59], a[32:35], a[4:7], v[56:59]
ds_read_b64_tr_b16 a[56:57], v12 offset:53248
v_mfma_f32_16x16x32_bf16 v[80:83], a[32:35], a[8:11], v[80:83]
ds_read_b64_tr_b16 a[58:59], v12 offset:53760
v_mfma_f32_16x16x32_bf16 v[104:107], a[32:35], a[12:15], v[104:107]
ds_read_b128 a[20:23], v11 offset:2048
v_mfma_f32_16x16x32_bf16 v[36:39], a[36:39], a[0:3], v[36:39]
ds_read_b128 a[24:27], v11 offset:4096
v_mfma_f32_16x16x32_bf16 v[60:63], a[36:39], a[4:7], v[60:63]
ds_read_b128 a[28:31], v11 offset:6144
v_mfma_f32_16x16x32_bf16 v[84:87], a[36:39], a[8:11], v[84:87]
ds_read_b64_tr_b16 a[60:61], v13 offset:53248
v_mfma_f32_16x16x32_bf16 v[108:111], a[36:39], a[12:15], v[108:111]
ds_read_b64_tr_b16 a[62:63], v13 offset:53760
v_mfma_f32_16x16x32_bf16 v[40:43], a[0:3], a[40:43], v[40:43]
ds_read_b64_tr_b16 a[64:65], v12 offset:55296
v_mfma_f32_16x16x32_bf16 v[64:67], a[4:7], a[40:43], v[64:67]
ds_read_b64_tr_b16 a[66:67], v12 offset:55808
v_mfma_f32_16x16x32_bf16 v[88:91], a[8:11], a[40:43], v[88:91]
ds_read_b64_tr_b16 a[68:69], v13 offset:55296
v_mfma_f32_16x16x32_bf16 v[112:115], a[12:15], a[40:43], v[112:115]
ds_read_b64_tr_b16 a[70:71], v13 offset:55808
v_mfma_f32_16x16x32_bf16 v[44:47], a[0:3], a[44:47], v[44:47]
ds_read_b64_tr_b16 a[72:73], v12 offset:57344
v_mfma_f32_16x16x32_bf16 v[68:71], a[4:7], a[44:47], v[68:71]
ds_read_b64_tr_b16 a[74:75], v12 offset:57856
v_mfma_f32_16x16x32_bf16 v[92:95], a[8:11], a[44:47], v[92:95]
ds_read_b64_tr_b16 a[76:77], v13 offset:57344
v_mfma_f32_16x16x32_bf16 v[116:119], a[12:15], a[44:47], v[116:119]
ds_read_b64_tr_b16 a[78:79], v13 offset:57856
v_mfma_f32_16x16x32_bf16 v[48:51], a[0:3], a[48:51], v[48:51]
s_lshl_b32 s70, s60, 10
s_add_u32 s70, s70, s87
buffer_store_dwordx4 v[28:31], v16, s[12:15], s70 offen sc1
v_mfma_f32_16x16x32_bf16 v[72:75], a[4:7], a[48:51], v[72:75]
v_mfma_f32_16x16x32_bf16 v[96:99], a[8:11], a[48:51], v[96:99]
v_mfma_f32_16x16x32_bf16 v[120:123], a[12:15], a[48:51], v[120:123]
v_mfma_f32_16x16x32_bf16 v[52:55], a[0:3], a[52:55], v[52:55]
v_mfma_f32_16x16x32_bf16 v[76:79], a[4:7], a[52:55], v[76:79]
v_mfma_f32_16x16x32_bf16 v[100:103], a[8:11], a[52:55], v[100:103]
v_mfma_f32_16x16x32_bf16 v[124:127], a[12:15], a[52:55], v[124:127]
s_waitcnt lgkmcnt(0)
v_mfma_f32_16x16x32_bf16 v[32:35], a[56:59], a[16:19], v[32:35]
s_barrier
ds_read_b128 a[0:3], v8 offset:24576
v_mfma_f32_16x16x32_bf16 v[56:59], a[56:59], a[20:23], v[56:59]
ds_read_b64_tr_b16 a[32:33], v12 offset:0
v_mfma_f32_16x16x32_bf16 v[80:83], a[56:59], a[24:27], v[80:83]
ds_read_b64_tr_b16 a[34:35], v12 offset:512
v_mfma_f32_16x16x32_bf16 v[104:107], a[56:59], a[28:31], v[104:107]
ds_read_b128 a[4:7], v8 offset:26624
v_mfma_f32_16x16x32_bf16 v[36:39], a[60:63], a[16:19], v[36:39]
ds_read_b128 a[8:11], v8 offset:28672
v_mfma_f32_16x16x32_bf16 v[60:63], a[60:63], a[20:23], v[60:63]
ds_read_b128 a[12:15], v8 offset:30720
v_mfma_f32_16x16x32_bf16 v[84:87], a[60:63], a[24:27], v[84:87]
ds_read_b64_tr_b16 a[36:37], v13 offset:0
v_mfma_f32_16x16x32_bf16 v[108:111], a[60:63], a[28:31], v[108:111]
ds_read_b64_tr_b16 a[38:39], v13 offset:512
v_mfma_f32_16x16x32_bf16 v[40:43], a[16:19], a[64:67], v[40:43]
ds_read_b64_tr_b16 a[40:41], v12 offset:2048
v_mfma_f32_16x16x32_bf16 v[64:67], a[20:23], a[64:67], v[64:67]
ds_read_b64_tr_b16 a[42:43], v12 offset:2560
v_mfma_f32_16x16x32_bf16 v[88:91], a[24:27], a[64:67], v[88:91]
ds_read_b64_tr_b16 a[44:45], v13 offset:2048
v_mfma_f32_16x16x32_bf16 v[112:115], a[28:31], a[64:67], v[112:115]
ds_read_b64_tr_b16 a[46:47], v13 offset:2560
v_mfma_f32_16x16x32_bf16 v[44:47], a[16:19], a[68:71], v[44:47]
ds_read_b64_tr_b16 a[48:49], v12 offset:4096
v_mfma_f32_16x16x32_bf16 v[68:71], a[20:23], a[68:71], v[68:71]
ds_read_b64_tr_b16 a[50:51], v12 offset:4608
v_mfma_f32_16x16x32_bf16 v[92:95], a[24:27], a[68:71], v[92:95]
ds_read_b64_tr_b16 a[52:53], v13 offset:4096
v_mfma_f32_16x16x32_bf16 v[116:119], a[28:31], a[68:71], v[116:119]
ds_read_b64_tr_b16 a[54:55], v13 offset:4608
v_mfma_f32_16x16x32_bf16 v[48:51], a[16:19], a[72:75], v[48:51]
v_mfma_f32_16x16x32_bf16 v[72:75], a[20:23], a[72:75], v[72:75]
v_mfma_f32_16x16x32_bf16 v[96:99], a[24:27], a[72:75], v[96:99]
v_mfma_f32_16x16x32_bf16 v[120:123], a[28:31], a[72:75], v[120:123]
v_mfma_f32_16x16x32_bf16 v[52:55], a[16:19], a[76:79], v[52:55]
v_mfma_f32_16x16x32_bf16 v[76:79], a[20:23], a[76:79], v[76:79]
v_mfma_f32_16x16x32_bf16 v[100:103], a[24:27], a[76:79], v[100:103]
v_mfma_f32_16x16x32_bf16 v[124:127], a[28:31], a[76:79], v[124:127]
s_waitcnt lgkmcnt(0)
v_mfma_f32_16x16x32_bf16 v[32:35], a[32:35], a[0:3], v[32:35]
ds_read_b128 a[16:19], v9 offset:24576
v_mfma_f32_16x16x32_bf16 v[56:59], a[32:35], a[4:7], v[56:59]
ds_read_b64_tr_b16 a[56:57], v12 offset:12288
v_mfma_f32_16x16x32_bf16 v[80:83], a[32:35], a[8:11], v[80:83]
ds_read_b64_tr_b16 a[58:59], v12 offset:12800
v_mfma_f32_16x16x32_bf16 v[104:107], a[32:35], a[12:15], v[104:107]
ds_read_b128 a[20:23], v9 offset:26624
v_mfma_f32_16x16x32_bf16 v[36:39], a[36:39], a[0:3], v[36:39]
ds_read_b128 a[24:27], v9 offset:28672
v_mfma_f32_16x16x32_bf16 v[60:63], a[36:39], a[4:7], v[60:63]
ds_read_b128 a[28:31], v9 offset:30720
v_mfma_f32_16x16x32_bf16 v[84:87], a[36:39], a[8:11], v[84:87]
ds_read_b64_tr_b16 a[60:61], v13 offset:12288
v_mfma_f32_16x16x32_bf16 v[108:111], a[36:39], a[12:15], v[108:111]
ds_read_b64_tr_b16 a[62:63], v13 offset:12800
v_mfma_f32_16x16x32_bf16 v[40:43], a[0:3], a[40:43], v[40:43]
ds_read_b64_tr_b16 a[64:65], v12 offset:14336
v_mfma_f32_16x16x32_bf16 v[64:67], a[4:7], a[40:43], v[64:67]
ds_read_b64_tr_b16 a[66:67], v12 offset:14848
v_mfma_f32_16x16x32_bf16 v[88:91], a[8:11], a[40:43], v[88:91]
ds_read_b64_tr_b16 a[68:69], v13 offset:14336
v_mfma_f32_16x16x32_bf16 v[112:115], a[12:15], a[40:43], v[112:115]
ds_read_b64_tr_b16 a[70:71], v13 offset:14848
v_mfma_f32_16x16x32_bf16 v[44:47], a[0:3], a[44:47], v[44:47]
ds_read_b64_tr_b16 a[72:73], v12 offset:16384
v_mfma_f32_16x16x32_bf16 v[68:71], a[4:7], a[44:47], v[68:71]
ds_read_b64_tr_b16 a[74:75], v12 offset:16896
v_mfma_f32_16x16x32_bf16 v[92:95], a[8:11], a[44:47], v[92:95]
ds_read_b64_tr_b16 a[76:77], v13 offset:16384
v_mfma_f32_16x16x32_bf16 v[116:119], a[12:15], a[44:47], v[116:119]
ds_read_b64_tr_b16 a[78:79], v13 offset:16896
v_mfma_f32_16x16x32_bf16 v[48:51], a[0:3], a[48:51], v[48:51]
s_cmp_lg_u32 s66, 0
s_cbranch_scc1 L_nocsp
v_and_b32 v2, 16, v1
v_cmp_ne_u32 vcc, 0, v2
s_nop 1
v_cndmask_b32 v24, v128, v132, vcc
v_cndmask_b32 v25, v136, v140, vcc
v_cndmask_b32 v26, v144, v148, vcc
v_mov_b32 v27, s68
s_lshl_b32 s70, s64, 4
s_add_u32 s70, s70, s65
s_lshl_b32 s70, s70, 10
s_lshl_b32 s71, s67, 9
s_add_u32 s70, s70, s71
s_add_u32 s70, s70, 65536
s_mov_b64 exec, 0xffffffff
buffer_store_dwordx4 v[24:27], v16, s[12:15], s70 offen sc1
s_mov_b64 exec, -1
L_nocsp:
v_mfma_f32_16x16x32_bf16 v[72:75], a[4:7], a[48:51], v[72:75]
v_mfma_f32_16x16x32_bf16 v[96:99], a[8:11], a[48:51], v[96:99]
v_mfma_f32_16x16x32_bf16 v[120:123], a[12:15], a[48:51], v[120:123]
v_mfma_f32_16x16x32_bf16 v[52:55], a[0:3], a[52:55], v[52:55]
v_mfma_f32_16x16x32_bf16 v[76:79], a[4:7], a[52:55], v[76:79]
v_mfma_f32_16x16x32_bf16 v[100:103], a[8:11], a[52:55], v[100:103]
v_mfma_f32_16x16x32_bf16 v[124:127], a[12:15], a[52:55], v[124:127]
s_waitcnt lgkmcnt(0)
v_mfma_f32_16x16x32_bf16 v[32:35], a[56:59], a[16:19], v[32:35]
s_barrier
ds_read_b128 a[0:3], v10 offset:57344
v_mfma_f32_16x16x32_bf16 v[56:59], a[56:59], a[20:23], v[56:59]
ds_read_b64_tr_b16 a[32:33], v14 offset:16384
v_mfma_f32_16x16x32_bf16 v[80:83], a[56:59], a[24:27], v[80:83]
ds_read_b64_tr_b16 a[34:35], v14 offset:16896
v_mfma_f32_16x16x32_bf16 v[104:107], a[56:59], a[28:31], v[104:107]
ds_read_b128 a[4:7], v10 offset:59392
v_mfma_f32_16x16x32_bf16 v[36:39], a[60:63], a[16:19], v[36:39]
ds_read_b128 a[8:11], v10 offset:61440
v_mfma_f32_16x16x32_bf16 v[60:63], a[60:63], a[20:23], v[60:63]
ds_read_b128 a[12:15], v10 offset:63488
v_mfma_f32_16x16x32_bf16 v[84:87], a[60:63], a[24:27], v[84:87]
ds_read_b64_tr_b16 a[36:37], v15 offset:16384
v_mfma_f32_16x16x32_bf16 v[108:111], a[60:63], a[28:31], v[108:111]
ds_read_b64_tr_b16 a[38:39], v15 offset:16896
v_mfma_f32_16x16x32_bf16 v[40:43], a[16:19], a[64:67], v[40:43]
ds_read_b64_tr_b16 a[40:41], v14 offset:18432
v_mfma_f32_16x16x32_bf16 v[64:67], a[20:23], a[64:67], v[64:67]
ds_read_b64_tr_b16 a[42:43], v14 offset:18944
v_mfma_f32_16x16x32_bf16 v[88:91], a[24:27], a[64:67], v[88:91]
ds_read_b64_tr_b16 a[44:45], v15 offset:18432
v_mfma_f32_16x16x32_bf16 v[112:115], a[28:31], a[64:67], v[112:115]
ds_read_b64_tr_b16 a[46:47], v15 offset:18944
v_mfma_f32_16x16x32_bf16 v[44:47], a[16:19], a[68:71], v[44:47]
ds_read_b64_tr_b16 a[48:49], v14 offset:20480
v_mfma_f32_16x16x32_bf16 v[68:71], a[20:23], a[68:71], v[68:71]
ds_read_b64_tr_b16 a[50:51], v14 offset:20992
v_mfma_f32_16x16x32_bf16 v[92:95], a[24:27], a[68:71], v[92:95]
ds_read_b64_tr_b16 a[52:53], v15 offset:20480
v_mfma_f32_16x16x32_bf16 v[116:119], a[28:31], a[68:71], v[116:119]
ds_read_b64_tr_b16 a[54:55], v15 offset:20992
v_mfma_f32_16x16x32_bf16 v[48:51], a[16:19], a[72:75], v[48:51]
v_mfma_f32_16x16x32_bf16 v[72:75], a[20:23], a[72:75], v[72:75]
v_mfma_f32_16x16x32_bf16 v[96:99], a[24:27], a[72:75], v[96:99]
v_mfma_f32_16x16x32_bf16 v[120:123], a[28:31], a[72:75], v[120:123]
v_mfma_f32_16x16x32_bf16 v[52:55], a[16:19], a[76:79], v[52:55]
v_mfma_f32_16x16x32_bf16 v[76:79], a[20:23], a[76:79], v[76:79]
v_mfma_f32_16x16x32_bf16 v[100:103], a[24:27], a[76:79], v[100:103]
v_mfma_f32_16x16x32_bf16 v[124:127], a[28:31], a[76:79], v[124:127]
s_waitcnt lgkmcnt(0)
v_mfma_f32_16x16x32_bf16 v[32:35], a[32:35], a[0:3], v[32:35]
ds_read_b128 a[16:19], v11 offset:57344
v_mfma_f32_16x16x32_bf16 v[56:59], a[32:35], a[4:7], v[56:59]
ds_read_b64_tr_b16 a[56:57], v14 offset:28672
v_mfma_f32_16x16x32_bf16 v[80:83], a[32:35], a[8:11], v[80:83]
ds_read_b64_tr_b16 a[58:59], v14 offset:29184
v_mfma_f32_16x16x32_bf16 v[104:107], a[32:35], a[12:15], v[104:107]
ds_read_b128 a[20:23], v11 offset:59392
v_mfma_f32_16x16x32_bf16 v[36:39], a[36:39], a[0:3], v[36:39]
ds_read_b128 a[24:27], v11 offset:61440
v_mfma_f32_16x16x32_bf16 v[60:63], a[36:39], a[4:7], v[60:63]
ds_read_b128 a[28:31], v11 offset:63488
v_mfma_f32_16x16x32_bf16 v[84:87], a[36:39], a[8:11], v[84:87]
ds_read_b64_tr_b16 a[60:61], v15 offset:28672
v_mfma_f32_16x16x32_bf16 v[108:111], a[36:39], a[12:15], v[108:111]
ds_read_b64_tr_b16 a[62:63], v15 offset:29184
v_mfma_f32_16x16x32_bf16 v[40:43], a[0:3], a[40:43], v[40:43]
ds_read_b64_tr_b16 a[64:65], v14 offset:30720
v_mfma_f32_16x16x32_bf16 v[64:67], a[4:7], a[40:43], v[64:67]
ds_read_b64_tr_b16 a[66:67], v14 offset:31232
v_mfma_f32_16x16x32_bf16 v[88:91], a[8:11], a[40:43], v[88:91]
ds_read_b64_tr_b16 a[68:69], v15 offset:30720
v_mfma_f32_16x16x32_bf16 v[112:115], a[12:15], a[40:43], v[112:115]
ds_read_b64_tr_b16 a[70:71], v15 offset:31232
v_mfma_f32_16x16x32_bf16 v[44:47], a[0:3], a[44:47], v[44:47]
ds_read_b64_tr_b16 a[72:73], v14 offset:32768
v_mfma_f32_16x16x32_bf16 v[68:71], a[4:7], a[44:47], v[68:71]
ds_read_b64_tr_b16 a[74:75], v14 offset:33280
v_mfma_f32_16x16x32_bf16 v[92:95], a[8:11], a[44:47], v[92:95]
ds_read_b64_tr_b16 a[76:77], v15 offset:32768
v_mfma_f32_16x16x32_bf16 v[116:119], a[12:15], a[44:47], v[116:119]
ds_read_b64_tr_b16 a[78:79], v15 offset:33280
v_mfma_f32_16x16x32_bf16 v[48:51], a[0:3], a[48:51], v[48:51]
s_add_u32 s70, s88, 0
buffer_store_dwordx4 v[28:31], v16, s[12:15], s70 offen sc1
v_mfma_f32_16x16x32_bf16 v[72:75], a[4:7], a[48:51], v[72:75]
v_mfma_f32_16x16x32_bf16 v[96:99], a[8:11], a[48:51], v[96:99]
s_add_u32 s70, s88, 32768
buffer_store_dwordx4 v[28:31], v16, s[12:15], s70 offen sc1
v_mfma_f32_16x16x32_bf16 v[120:123], a[12:15], a[48:51], v[120:123]
v_mfma_f32_16x16x32_bf16 v[52:55], a[0:3], a[52:55], v[52:55]
v_mfma_f32_16x16x32_bf16 v[76:79], a[4:7], a[52:55], v[76:79]
v_mfma_f32_16x16x32_bf16 v[100:103], a[8:11], a[52:55], v[100:103]
v_mfma_f32_16x16x32_bf16 v[124:127], a[12:15], a[52:55], v[124:127]
s_waitcnt lgkmcnt(0)
v_mfma_f32_16x16x32_bf16 v[32:35], a[56:59], a[16:19], v[32:35]
s_barrier
ds_read_b128 a[0:3], v10 offset:40960
v_mfma_f32_16x16x32_bf16 v[56:59], a[56:59], a[20:23], v[56:59]
ds_read_b64_tr_b16 a[32:33], v12 offset:40960
v_mfma_f32_16x16x32_bf16 v[80:83], a[56:59], a[24:27], v[80:83]
ds_read_b64_tr_b16 a[34:35], v12 offset:41472
v_mfma_f32_16x16x32_bf16 v[104:107], a[56:59], a[28:31], v[104:107]
ds_read_b128 a[4:7], v10 offset:43008
v_mfma_f32_16x16x32_bf16 v[36:39], a[60:63], a[16:19], v[36:39]
ds_read_b128 a[8:11], v10 offset:45056
v_mfma_f32_16x16x32_bf16 v[60:63], a[60:63], a[20:23], v[60:63]
ds_read_b128 a[12:15], v10 offset:47104
v_mfma_f32_16x16x32_bf16 v[84:87], a[60:63], a[24:27], v[84:87]
ds_read_b64_tr_b16 a[36:37], v13 offset:40960
v_mfma_f32_16x16x32_bf16 v[108:111], a[60:63], a[28:31], v[108:111]
ds_read_b64_tr_b16 a[38:39], v13 offset:41472
v_mfma_f32_16x16x32_bf16 v[40:43], a[16:19], a[64:67], v[40:43]
ds_read_b64_tr_b16 a[40:41], v12 offset:43008
v_mfma_f32_16x16x32_bf16 v[64:67], a[20:23], a[64:67], v[64:67]
ds_read_b64_tr_b16 a[42:43], v12 offset:43520
v_mfma_f32_16x16x32_bf16 v[88:91], a[24:27], a[64:67], v[88:91]
ds_read_b64_tr_b16 a[44:45], v13 offset:43008
v_mfma_f32_16x16x32_bf16 v[112:115], a[28:31], a[64:67], v[112:115]
ds_read_b64_tr_b16 a[46:47], v13 offset:43520
v_mfma_f32_16x16x32_bf16 v[44:47], a[16:19], a[68:71], v[44:47]
ds_read_b64_tr_b16 a[48:49], v12 offset:45056
v_mfma_f32_16x16x32_bf16 v[68:71], a[20:23], a[68:71], v[68:71]
ds_read_b64_tr_b16 a[50:51], v12 offset:45568
v_mfma_f32_16x16x32_bf16 v[92:95], a[24:27], a[68:71], v[92:95]
ds_read_b64_tr_b16 a[52:53], v13 offset:45056
v_mfma_f32_16x16x32_bf16 v[116:119], a[28:31], a[68:71], v[116:119]
ds_read_b64_tr_b16 a[54:55], v13 offset:45568
v_mfma_f32_16x16x32_bf16 v[48:51], a[16:19], a[72:75], v[48:51]
v_mfma_f32_16x16x32_bf16 v[72:75], a[20:23], a[72:75], v[72:75]
v_mfma_f32_16x16x32_bf16 v[96:99], a[24:27], a[72:75], v[96:99]
v_mfma_f32_16x16x32_bf16 v[120:123], a[28:31], a[72:75], v[120:123]
v_mfma_f32_16x16x32_bf16 v[52:55], a[16:19], a[76:79], v[52:55]
v_mfma_f32_16x16x32_bf16 v[76:79], a[20:23], a[76:79], v[76:79]
v_mfma_f32_16x16x32_bf16 v[100:103], a[24:27], a[76:79], v[100:103]
v_mfma_f32_16x16x32_bf16 v[124:127], a[28:31], a[76:79], v[124:127]
s_waitcnt lgkmcnt(0)
v_mfma_f32_16x16x32_bf16 v[32:35], a[32:35], a[0:3], v[32:35]
ds_read_b128 a[16:19], v11 offset:40960
v_mfma_f32_16x16x32_bf16 v[56:59], a[32:35], a[4:7], v[56:59]
ds_read_b64_tr_b16 a[56:57], v12 offset:53248
v_mfma_f32_16x16x32_bf16 v[80:83], a[32:35], a[8:11], v[80:83]
ds_read_b64_tr_b16 a[58:59], v12 offset:53760
v_mfma_f32_16x16x32_bf16 v[104:107], a[32:35], a[12:15], v[104:107]
ds_read_b128 a[20:23], v11 offset:43008
v_mfma_f32_16x16x32_bf16 v[36:39], a[36:39], a[0:3], v[36:39]
ds_read_b128 a[24:27], v11 offset:45056
v_mfma_f32_16x16x32_bf16 v[60:63], a[36:39], a[4:7], v[60:63]
ds_read_b128 a[28:31], v11 offset:47104
v_mfma_f32_16x16x32_bf16 v[84:87], a[36:39], a[8:11], v[84:87]
ds_read_b64_tr_b16 a[60:61], v13 offset:53248
v_mfma_f32_16x16x32_bf16 v[108:111], a[36:39], a[12:15], v[108:111]
ds_read_b64_tr_b16 a[62:63], v13 offset:53760
v_mfma_f32_16x16x32_bf16 v[40:43], a[0:3], a[40:43], v[40:43]
ds_read_b64_tr_b16 a[64:65], v12 offset:55296
v_mfma_f32_16x16x32_bf16 v[64:67], a[4:7], a[40:43], v[64:67]
ds_read_b64_tr_b16 a[66:67], v12 offset:55808
v_mfma_f32_16x16x32_bf16 v[88:91], a[8:11], a[40:43], v[88:91]
ds_read_b64_tr_b16 a[68:69], v13 offset:55296
v_mfma_f32_16x16x32_bf16 v[112:115], a[12:15], a[40:43], v[112:115]
ds_read_b64_tr_b16 a[70:71], v13 offset:55808
v_mfma_f32_16x16x32_bf16 v[44:47], a[0:3], a[44:47], v[44:47]
ds_read_b64_tr_b16 a[72:73], v12 offset:57344
v_mfma_f32_16x16x32_bf16 v[68:71], a[4:7], a[44:47], v[68:71]
ds_read_b64_tr_b16 a[74:75], v12 offset:57856
v_mfma_f32_16x16x32_bf16 v[92:95], a[8:11], a[44:47], v[92:95]
ds_read_b64_tr_b16 a[76:77], v13 offset:57344
v_mfma_f32_16x16x32_bf16 v[116:119], a[12:15], a[44:47], v[116:119]
ds_read_b64_tr_b16 a[78:79], v13 offset:57856
v_mfma_f32_16x16x32_bf16 v[48:51], a[0:3], a[48:51], v[48:51]
s_add_u32 s70, s88, 65536
buffer_store_dwordx4 v[28:31], v16, s[12:15], s70 offen sc1
v_mfma_f32_16x16x32_bf16 v[72:75], a[4:7], a[48:51], v[72:75]
v_mfma_f32_16x16x32_bf16 v[96:99], a[8:11], a[48:51], v[96:99]
s_add_u32 s70, s88, 98304
buffer_store_dwordx4 v[28:31], v16, s[12:15], s70 offen sc1
v_mfma_f32_16x16x32_bf16 v[120:123], a[12:15], a[48:51], v[120:123]
v_mfma_f32_16x16x32_bf16 v[52:55], a[0:3], a[52:55], v[52:55]
v_mfma_f32_16x16x32_bf16 v[76:79], a[4:7], a[52:55], v[76:79]
v_mfma_f32_16x16x32_bf16 v[100:103], a[8:11], a[52:55], v[100:103]
v_mfma_f32_16x16x32_bf16 v[124:127], a[12:15], a[52:55], v[124:127]
s_waitcnt lgkmcnt(0)
v_mfma_f32_16x16x32_bf16 v[32:35], a[56:59], a[16:19], v[32:35]
s_barrier
ds_read_b128 a[0:3], v10 offset:0
v_mfma_f32_16x16x32_bf16 v[56:59], a[56:59], a[20:23], v[56:59]
ds_read_b64_tr_b16 a[32:33], v12 offset:0
v_mfma_f32_16x16x32_bf16 v[80:83], a[56:59], a[24:27], v[80:83]
ds_read_b64_tr_b16 a[34:35], v12 offset:512
v_mfma_f32_16x16x32_bf16 v[104:107], a[56:59], a[28:31], v[104:107]
ds_read_b128 a[4:7], v10 offset:2048
v_mfma_f32_16x16x32_bf16 v[36:39], a[60:63], a[16:19], v[36:39]
ds_read_b128 a[8:11], v10 offset:4096
v_mfma_f32_16x16x32_bf16 v[60:63], a[60:63], a[20:23], v[60:63]
ds_read_b128 a[12:15], v10 offset:6144
v_mfma_f32_16x16x32_bf16 v[84:87], a[60:63], a[24:27], v[84:87]
ds_read_b64_tr_b16 a[36:37], v13 offset:0
v_mfma_f32_16x16x32_bf16 v[108:111], a[60:63], a[28:31], v[108:111]
ds_read_b64_tr_b16 a[38:39], v13 offset:512
v_mfma_f32_16x16x32_bf16 v[40:43], a[16:19], a[64:67], v[40:43]
ds_read_b64_tr_b16 a[40:41], v12 offset:2048
v_mfma_f32_16x16x32_bf16 v[64:67], a[20:23], a[64:67], v[64:67]
ds_read_b64_tr_b16 a[42:43], v12 offset:2560
v_mfma_f32_16x16x32_bf16 v[88:91], a[24:27], a[64:67], v[88:91]
ds_read_b64_tr_b16 a[44:45], v13 offset:2048
v_mfma_f32_16x16x32_bf16 v[112:115], a[28:31], a[64:67], v[112:115]
ds_read_b64_tr_b16 a[46:47], v13 offset:2560
v_mfma_f32_16x16x32_bf16 v[44:47], a[16:19], a[68:71], v[44:47]
ds_read_b64_tr_b16 a[48:49], v12 offset:4096
v_mfma_f32_16x16x32_bf16 v[68:71], a[20:23], a[68:71], v[68:71]
ds_read_b64_tr_b16 a[50:51], v12 offset:4608
v_mfma_f32_16x16x32_bf16 v[92:95], a[24:27], a[68:71], v[92:95]
ds_read_b64_tr_b16 a[52:53], v13 offset:4096
v_mfma_f32_16x16x32_bf16 v[116:119], a[28:31], a[68:71], v[116:119]
ds_read_b64_tr_b16 a[54:55], v13 offset:4608
v_mfma_f32_16x16x32_bf16 v[48:51], a[16:19], a[72:75], v[48:51]
v_mfma_f32_16x16x32_bf16 v[72:75], a[20:23], a[72:75], v[72:75]
v_mfma_f32_16x16x32_bf16 v[96:99], a[24:27], a[72:75], v[96:99]
v_mfma_f32_16x16x32_bf16 v[120:123], a[28:31], a[72:75], v[120:123]
v_mfma_f32_16x16x32_bf16 v[52:55], a[16:19], a[76:79], v[52:55]
v_mfma_f32_16x16x32_bf16 v[76:79], a[20:23], a[76:79], v[76:79]
v_mfma_f32_16x16x32_bf16 v[100:103], a[24:27], a[76:79], v[100:103]
v_mfma_f32_16x16x32_bf16 v[124:127], a[28:31], a[76:79], v[124:127]
s_waitcnt lgkmcnt(0)
v_mfma_f32_16x16x32_bf16 v[32:35], a[32:35], a[0:3], v[32:35]
ds_read_b128 a[16:19], v11 offset:0
v_mfma_f32_16x16x32_bf16 v[56:59], a[32:35], a[4:7], v[56:59]
ds_read_b64_tr_b16 a[56:57], v12 offset:12288
v_mfma_f32_16x16x32_bf16 v[80:83], a[32:35], a[8:11], v[80:83]
ds_read_b64_tr_b16 a[58:59], v12 offset:12800
v_mfma_f32_16x16x32_bf16 v[104:107], a[32:35], a[12:15], v[104:107]
ds_read_b128 a[20:23], v11 offset:2048
v_mfma_f32_16x16x32_bf16 v[36:39], a[36:39], a[0:3], v[36:39]
ds_read_b128 a[24:27], v11 offset:4096
v_mfma_f32_16x16x32_bf16 v[60:63], a[36:39], a[4:7], v[60:63]
ds_read_b128 a[28:31], v11 offset:6144
v_mfma_f32_16x16x32_bf16 v[84:87], a[36:39], a[8:11], v[84:87]
ds_read_b64_tr_b16 a[60:61], v13 offset:12288
v_mfma_f32_16x16x32_bf16 v[108:111], a[36:39], a[12:15], v[108:111]
ds_read_b64_tr_b16 a[62:63], v13 offset:12800
v_mfma_f32_16x16x32_bf16 v[40:43], a[0:3], a[40:43], v[40:43]
ds_read_b64_tr_b16 a[64:65], v12 offset:14336
v_mfma_f32_16x16x32_bf16 v[64:67], a[4:7], a[40:43], v[64:67]
ds_read_b64_tr_b16 a[66:67], v12 offset:14848
v_mfma_f32_16x16x32_bf16 v[88:91], a[8:11], a[40:43], v[88:91]
ds_read_b64_tr_b16 a[68:69], v13 offset:14336
v_mfma_f32_16x16x32_bf16 v[112:115], a[12:15], a[40:43], v[112:115]
ds_read_b64_tr_b16 a[70:71], v13 offset:14848
v_mfma_f32_16x16x32_bf16 v[44:47], a[0:3], a[44:47], v[44:47]
ds_read_b64_tr_b16 a[72:73], v12 offset:16384
v_mfma_f32_16x16x32_bf16 v[68:71], a[4:7], a[44:47], v[68:71]
ds_read_b64_tr_b16 a[74:75], v12 offset:16896
v_mfma_f32_16x16x32_bf16 v[92:95], a[8:11], a[44:47], v[92:95]
ds_read_b64_tr_b16 a[76:77], v13 offset:16384
v_mfma_f32_16x16x32_bf16 v[116:119], a[12:15], a[44:47], v[116:119]
ds_read_b64_tr_b16 a[78:79], v13 offset:16896
v_mfma_f32_16x16x32_bf16 v[48:51], a[0:3], a[48:51], v[48:51]
v_mfma_f32_16x16x32_bf16 v[72:75], a[4:7], a[48:51], v[72:75]
v_mfma_f32_16x16x32_bf16 v[96:99], a[8:11], a[48:51], v[96:99]
v_mfma_f32_16x16x32_bf16 v[120:123], a[12:15], a[48:51], v[120:123]
v_mfma_f32_16x16x32_bf16 v[52:55], a[0:3], a[52:55], v[52:55]
v_mfma_f32_16x16x32_bf16 v[76:79], a[4:7], a[52:55], v[76:79]
v_mfma_f32_16x16x32_bf16 v[100:103], a[8:11], a[52:55], v[100:103]
v_mfma_f32_16x16x32_bf16 v[124:127], a[12:15], a[52:55], v[124:127]
s_waitcnt lgkmcnt(0)
v_mfma_f32_16x16x32_bf16 v[32:35], a[56:59], a[16:19], v[32:35]
s_barrier
ds_read_b128 a[0:3], v8 offset:24576
v_mfma_f32_16x16x32_bf16 v[56:59], a[56:59], a[20:23], v[56:59]
ds_read_b64_tr_b16 a[32:33], v14 offset:16384
v_mfma_f32_16x16x32_bf16 v[80:83], a[56:59], a[24:27], v[80:83]
ds_read_b64_tr_b16 a[34:35], v14 offset:16896
v_mfma_f32_16x16x32_bf16 v[104:107], a[56:59], a[28:31], v[104:107]
ds_read_b128 a[4:7], v8 offset:26624
v_mfma_f32_16x16x32_bf16 v[36:39], a[60:63], a[16:19], v[36:39]
ds_read_b128 a[8:11], v8 offset:28672
v_mfma_f32_16x16x32_bf16 v[60:63], a[60:63], a[20:23], v[60:63]
ds_read_b128 a[12:15], v8 offset:30720
v_mfma_f32_16x16x32_bf16 v[84:87], a[60:63], a[24:27], v[84:87]
ds_read_b64_tr_b16 a[36:37], v15 offset:16384
v_mfma_f32_16x16x32_bf16 v[108:111], a[60:63], a[28:31], v[108:111]
ds_read_b64_tr_b16 a[38:39], v15 offset:16896
v_mfma_f32_16x16x32_bf16 v[40:43], a[16:19], a[64:67], v[40:43]
ds_read_b64_tr_b16 a[40:41], v14 offset:18432
v_mfma_f32_16x16x32_bf16 v[64:67], a[20:23], a[64:67], v[64:67]
ds_read_b64_tr_b16 a[42:43], v14 offset:18944
v_mfma_f32_16x16x32_bf16 v[88:91], a[24:27], a[64:67], v[88:91]
ds_read_b64_tr_b16 a[44:45], v15 offset:18432
v_mfma_f32_16x16x32_bf16 v[112:115], a[28:31], a[64:67], v[112:115]
ds_read_b64_tr_b16 a[46:47], v15 offset:18944
v_mfma_f32_16x16x32_bf16 v[44:47], a[16:19], a[68:71], v[44:47]
ds_read_b64_tr_b16 a[48:49], v14 offset:20480
v_mfma_f32_16x16x32_bf16 v[68:71], a[20:23], a[68:71], v[68:71]
ds_read_b64_tr_b16 a[50:51], v14 offset:20992
v_mfma_f32_16x16x32_bf16 v[92:95], a[24:27], a[68:71], v[92:95]
ds_read_b64_tr_b16 a[52:53], v15 offset:20480
v_mfma_f32_16x16x32_bf16 v[116:119], a[28:31], a[68:71], v[116:119]
ds_read_b64_tr_b16 a[54:55], v15 offset:20992
v_mfma_f32_16x16x32_bf16 v[48:51], a[16:19], a[72:75], v[48:51]
v_mfma_f32_16x16x32_bf16 v[72:75], a[20:23], a[72:75], v[72:75]
v_mfma_f32_16x16x32_bf16 v[96:99], a[24:27], a[72:75], v[96:99]
v_mfma_f32_16x16x32_bf16 v[120:123], a[28:31], a[72:75], v[120:123]
v_mfma_f32_16x16x32_bf16 v[52:55], a[16:19], a[76:79], v[52:55]
v_mfma_f32_16x16x32_bf16 v[76:79], a[20:23], a[76:79], v[76:79]
v_mfma_f32_16x16x32_bf16 v[100:103], a[24:27], a[76:79], v[100:103]
v_mfma_f32_16x16x32_bf16 v[124:127], a[28:31], a[76:79], v[124:127]
s_waitcnt lgkmcnt(0)
v_mfma_f32_16x16x32_bf16 v[32:35], a[32:35], a[0:3], v[32:35]
ds_read_b128 a[16:19], v9 offset:24576
v_mfma_f32_16x16x32_bf16 v[56:59], a[32:35], a[4:7], v[56:59]
ds_read_b64_tr_b16 a[56:57], v14 offset:28672
v_mfma_f32_16x16x32_bf16 v[80:83], a[32:35], a[8:11], v[80:83]
ds_read_b64_tr_b16 a[58:59], v14 offset:29184
v_mfma_f32_16x16x32_bf16 v[104:107], a[32:35], a[12:15], v[104:107]
ds_read_b128 a[20:23], v9 offset:26624
v_mfma_f32_16x16x32_bf16 v[36:39], a[36:39], a[0:3], v[36:39]
ds_read_b128 a[24:27], v9 offset:28672
v_mfma_f32_16x16x32_bf16 v[60:63], a[36:39], a[4:7], v[60:63]
ds_read_b128 a[28:31], v9 offset:30720
v_mfma_f32_16x16x32_bf16 v[84:87], a[36:39], a[8:11], v[84:87]
ds_read_b64_tr_b16 a[60:61], v15 offset:28672
v_mfma_f32_16x16x32_bf16 v[108:111], a[36:39], a[12:15], v[108:111]
ds_read_b64_tr_b16 a[62:63], v15 offset:29184
v_mfma_f32_16x16x32_bf16 v[40:43], a[0:3], a[40:43], v[40:43]
ds_read_b64_tr_b16 a[64:65], v14 offset:30720
v_mfma_f32_16x16x32_bf16 v[64:67], a[4:7], a[40:43], v[64:67]
ds_read_b64_tr_b16 a[66:67], v14 offset:31232
v_mfma_f32_16x16x32_bf16 v[88:91], a[8:11], a[40:43], v[88:91]
ds_read_b64_tr_b16 a[68:69], v15 offset:30720
v_mfma_f32_16x16x32_bf16 v[112:115], a[12:15], a[40:43], v[112:115]
ds_read_b64_tr_b16 a[70:71], v15 offset:31232
v_mfma_f32_16x16x32_bf16 v[44:47], a[0:3], a[44:47], v[44:47]
ds_read_b64_tr_b16 a[72:73], v14 offset:32768
v_mfma_f32_16x16x32_bf16 v[68:71], a[4:7], a[44:47], v[68:71]
ds_read_b64_tr_b16 a[74:75], v14 offset:33280
v_mfma_f32_16x16x32_bf16 v[92:95], a[8:11], a[44:47], v[92:95]
ds_read_b64_tr_b16 a[76:77], v15 offset:32768
v_mfma_f32_16x16x32_bf16 v[116:119], a[12:15], a[44:47], v[116:119]
ds_read_b64_tr_b16 a[78:79], v15 offset:33280
v_mfma_f32_16x16x32_bf16 v[48:51], a[0:3], a[48:51], v[48:51]
s_waitcnt vmcnt(0)
v_mfma_f32_16x16x32_bf16 v[72:75], a[4:7], a[48:51], v[72:75]
v_mfma_f32_16x16x32_bf16 v[96:99], a[8:11], a[48:51], v[96:99]
v_mfma_f32_16x16x32_bf16 v[120:123], a[12:15], a[48:51], v[120:123]
v_mfma_f32_16x16x32_bf16 v[52:55], a[0:3], a[52:55], v[52:55]
v_mfma_f32_16x16x32_bf16 v[76:79], a[4:7], a[52:55], v[76:79]
v_mfma_f32_16x16x32_bf16 v[100:103], a[8:11], a[52:55], v[100:103]
v_mfma_f32_16x16x32_bf16 v[124:127], a[12:15], a[52:55], v[124:127]
s_waitcnt lgkmcnt(0)
v_mfma_f32_16x16x32_bf16 v[32:35], a[56:59], a[16:19], v[32:35]
s_barrier
ds_read_b128 a[0:3], v10 offset:57344
v_mfma_f32_16x16x32_bf16 v[56:59], a[56:59], a[20:23], v[56:59]
ds_read_b64_tr_b16 a[32:33], v12 offset:40960
v_mfma_f32_16x16x32_bf16 v[80:83], a[56:59], a[24:27], v[80:83]
ds_read_b64_tr_b16 a[34:35], v12 offset:41472
v_mfma_f32_16x16x32_bf16 v[104:107], a[56:59], a[28:31], v[104:107]
ds_read_b128 a[4:7], v10 offset:59392
v_mfma_f32_16x16x32_bf16 v[36:39], a[60:63], a[16:19], v[36:39]
ds_read_b128 a[8:11], v10 offset:61440
v_mfma_f32_16x16x32_bf16 v[60:63], a[60:63], a[20:23], v[60:63]
ds_read_b128 a[12:15], v10 offset:63488
v_mfma_f32_16x16x32_bf16 v[84:87], a[60:63], a[24:27], v[84:87]
ds_read_b64_tr_b16 a[36:37], v13 offset:40960
v_mfma_f32_16x16x32_bf16 v[108:111], a[60:63], a[28:31], v[108:111]
ds_read_b64_tr_b16 a[38:39], v13 offset:41472
v_mfma_f32_16x16x32_bf16 v[40:43], a[16:19], a[64:67], v[40:43]
ds_read_b64_tr_b16 a[40:41], v12 offset:43008
v_mfma_f32_16x16x32_bf16 v[64:67], a[20:23], a[64:67], v[64:67]
ds_read_b64_tr_b16 a[42:43], v12 offset:43520
v_mfma_f32_16x16x32_bf16 v[88:91], a[24:27], a[64:67], v[88:91]
ds_read_b64_tr_b16 a[44:45], v13 offset:43008
v_mfma_f32_16x16x32_bf16 v[112:115], a[28:31], a[64:67], v[112:115]
ds_read_b64_tr_b16 a[46:47], v13 offset:43520
v_mfma_f32_16x16x32_bf16 v[44:47], a[16:19], a[68:71], v[44:47]
ds_read_b64_tr_b16 a[48:49], v12 offset:45056
v_mfma_f32_16x16x32_bf16 v[68:71], a[20:23], a[68:71], v[68:71]
ds_read_b64_tr_b16 a[50:51], v12 offset:45568
v_mfma_f32_16x16x32_bf16 v[92:95], a[24:27], a[68:71], v[92:95]
ds_read_b64_tr_b16 a[52:53], v13 offset:45056
v_mfma_f32_16x16x32_bf16 v[116:119], a[28:31], a[68:71], v[116:119]
ds_read_b64_tr_b16 a[54:55], v13 offset:45568
v_mfma_f32_16x16x32_bf16 v[48:51], a[16:19], a[72:75], v[48:51]
v_mfma_f32_16x16x32_bf16 v[72:75], a[20:23], a[72:75], v[72:75]
v_mfma_f32_16x16x32_bf16 v[96:99], a[24:27], a[72:75], v[96:99]
v_mfma_f32_16x16x32_bf16 v[120:123], a[28:31], a[72:75], v[120:123]
v_mfma_f32_16x16x32_bf16 v[52:55], a[16:19], a[76:79], v[52:55]
v_mfma_f32_16x16x32_bf16 v[76:79], a[20:23], a[76:79], v[76:79]
v_mfma_f32_16x16x32_bf16 v[100:103], a[24:27], a[76:79], v[100:103]
v_mfma_f32_16x16x32_bf16 v[124:127], a[28:31], a[76:79], v[124:127]
s_waitcnt lgkmcnt(0)
v_mfma_f32_16x16x32_bf16 v[32:35], a[32:35], a[0:3], v[32:35]
ds_read_b128 a[16:19], v11 offset:57344
v_mfma_f32_16x16x32_bf16 v[56:59], a[32:35], a[4:7], v[56:59]
ds_read_b64_tr_b16 a[56:57], v12 offset:53248
v_mfma_f32_16x16x32_bf16 v[80:83], a[32:35], a[8:11], v[80:83]
ds_read_b64_tr_b16 a[58:59], v12 offset:53760
v_mfma_f32_16x16x32_bf16 v[104:107], a[32:35], a[12:15], v[104:107]
ds_read_b128 a[20:23], v11 offset:59392
v_mfma_f32_16x16x32_bf16 v[36:39], a[36:39], a[0:3], v[36:39]
ds_read_b128 a[24:27], v11 offset:61440
v_mfma_f32_16x16x32_bf16 v[60:63], a[36:39], a[4:7], v[60:63]
ds_read_b128 a[28:31], v11 offset:63488
v_mfma_f32_16x16x32_bf16 v[84:87], a[36:39], a[8:11], v[84:87]
ds_read_b64_tr_b16 a[60:61], v13 offset:53248
v_mfma_f32_16x16x32_bf16 v[108:111], a[36:39], a[12:15], v[108:111]
ds_read_b64_tr_b16 a[62:63], v13 offset:53760
v_mfma_f32_16x16x32_bf16 v[40:43], a[0:3], a[40:43], v[40:43]
ds_read_b64_tr_b16 a[64:65], v12 offset:55296
v_mfma_f32_16x16x32_bf16 v[64:67], a[4:7], a[40:43], v[64:67]
ds_read_b64_tr_b16 a[66:67], v12 offset:55808
v_mfma_f32_16x16x32_bf16 v[88:91], a[8:11], a[40:43], v[88:91]
ds_read_b64_tr_b16 a[68:69], v13 offset:55296
v_mfma_f32_16x16x32_bf16 v[112:115], a[12:15], a[40:43], v[112:115]
ds_read_b64_tr_b16 a[70:71], v13 offset:55808
v_mfma_f32_16x16x32_bf16 v[44:47], a[0:3], a[44:47], v[44:47]
ds_read_b64_tr_b16 a[72:73], v12 offset:57344
v_mfma_f32_16x16x32_bf16 v[68:71], a[4:7], a[44:47], v[68:71]
ds_read_b64_tr_b16 a[74:75], v12 offset:57856
v_mfma_f32_16x16x32_bf16 v[92:95], a[8:11], a[44:47], v[92:95]
ds_read_b64_tr_b16 a[76:77], v13 offset:57344
v_mfma_f32_16x16x32_bf16 v[116:119], a[12:15], a[44:47], v[116:119]
ds_read_b64_tr_b16 a[78:79], v13 offset:57856
v_mfma_f32_16x16x32_bf16 v[48:51], a[0:3], a[48:51], v[48:51]
v_mfma_f32_16x16x32_bf16 v[72:75], a[4:7], a[48:51], v[72:75]
v_mfma_f32_16x16x32_bf16 v[96:99], a[8:11], a[48:51], v[96:99]
v_mfma_f32_16x16x32_bf16 v[120:123], a[12:15], a[48:51], v[120:123]
v_mfma_f32_16x16x32_bf16 v[52:55], a[0:3], a[52:55], v[52:55]
v_mfma_f32_16x16x32_bf16 v[76:79], a[4:7], a[52:55], v[76:79]
v_mfma_f32_16x16x32_bf16 v[100:103], a[8:11], a[52:55], v[100:103]
v_mfma_f32_16x16x32_bf16 v[124:127], a[12:15], a[52:55], v[124:127]
s_waitcnt lgkmcnt(0)
v_mfma_f32_16x16x32_bf16 v[32:35], a[56:59], a[16:19], v[32:35]
s_barrier
ds_read_b128 a[0:3], v10 offset:40960
v_mfma_f32_16x16x32_bf16 v[56:59], a[56:59], a[20:23], v[56:59]
ds_read_b64_tr_b16 a[32:33], v12 offset:0
v_mfma_f32_16x16x32_bf16 v[80:83], a[56:59], a[24:27], v[80:83]
ds_read_b64_tr_b16 a[34:35], v12 offset:512
v_mfma_f32_16x16x32_bf16 v[104:107], a[56:59], a[28:31], v[104:107]
ds_read_b128 a[4:7], v10 offset:43008
v_mfma_f32_16x16x32_bf16 v[36:39], a[60:63], a[16:19], v[36:39]
ds_read_b128 a[8:11], v10 offset:45056
v_mfma_f32_16x16x32_bf16 v[60:63], a[60:63], a[20:23], v[60:63]
ds_read_b128 a[12:15], v10 offset:47104
v_mfma_f32_16x16x32_bf16 v[84:87], a[60:63], a[24:27], v[84:87]
ds_read_b64_tr_b16 a[36:37], v13 offset:0
v_mfma_f32_16x16x32_bf16 v[108:111], a[60:63], a[28:31], v[108:111]
ds_read_b64_tr_b16 a[38:39], v13 offset:512
v_mfma_f32_16x16x32_bf16 v[40:43], a[16:19], a[64:67], v[40:43]
ds_read_b64_tr_b16 a[40:41], v12 offset:2048
v_mfma_f32_16x16x32_bf16 v[64:67], a[20:23], a[64:67], v[64:67]
ds_read_b64_tr_b16 a[42:43], v12 offset:2560
v_mfma_f32_16x16x32_bf16 v[88:91], a[24:27], a[64:67], v[88:91]
ds_read_b64_tr_b16 a[44:45], v13 offset:2048
v_mfma_f32_16x16x32_bf16 v[112:115], a[28:31], a[64:67], v[112:115]
ds_read_b64_tr_b16 a[46:47], v13 offset:2560
v_mfma_f32_16x16x32_bf16 v[44:47], a[16:19], a[68:71], v[44:47]
ds_read_b64_tr_b16 a[48:49], v12 offset:4096
v_mfma_f32_16x16x32_bf16 v[68:71], a[20:23], a[68:71], v[68:71]
ds_read_b64_tr_b16 a[50:51], v12 offset:4608
v_mfma_f32_16x16x32_bf16 v[92:95], a[24:27], a[68:71], v[92:95]
ds_read_b64_tr_b16 a[52:53], v13 offset:4096
v_mfma_f32_16x16x32_bf16 v[116:119], a[28:31], a[68:71], v[116:119]
ds_read_b64_tr_b16 a[54:55], v13 offset:4608
v_mfma_f32_16x16x32_bf16 v[48:51], a[16:19], a[72:75], v[48:51]
v_mfma_f32_16x16x32_bf16 v[72:75], a[20:23], a[72:75], v[72:75]
v_mfma_f32_16x16x32_bf16 v[96:99], a[24:27], a[72:75], v[96:99]
v_mfma_f32_16x16x32_bf16 v[120:123], a[28:31], a[72:75], v[120:123]
v_mfma_f32_16x16x32_bf16 v[52:55], a[16:19], a[76:79], v[52:55]
v_mfma_f32_16x16x32_bf16 v[76:79], a[20:23], a[76:79], v[76:79]
v_mfma_f32_16x16x32_bf16 v[100:103], a[24:27], a[76:79], v[100:103]
v_mfma_f32_16x16x32_bf16 v[124:127], a[28:31], a[76:79], v[124:127]
s_waitcnt lgkmcnt(0)
v_mfma_f32_16x16x32_bf16 v[32:35], a[32:35], a[0:3], v[32:35]
ds_read_b128 a[16:19], v11 offset:40960
v_mfma_f32_16x16x32_bf16 v[56:59], a[32:35], a[4:7], v[56:59]
ds_read_b64_tr_b16 a[56:57], v12 offset:12288
v_mfma_f32_16x16x32_bf16 v[80:83], a[32:35], a[8:11], v[80:83]
ds_read_b64_tr_b16 a[58:59], v12 offset:12800
v_mfma_f32_16x16x32_bf16 v[104:107], a[32:35], a[12:15], v[104:107]
ds_read_b128 a[20:23], v11 offset:43008
v_mfma_f32_16x16x32_bf16 v[36:39], a[36:39], a[0:3], v[36:39]
ds_read_b128 a[24:27], v11 offset:45056
v_mfma_f32_16x16x32_bf16 v[60:63], a[36:39], a[4:7], v[60:63]
ds_read_b128 a[28:31], v11 offset:47104
v_mfma_f32_16x16x32_bf16 v[84:87], a[36:39], a[8:11], v[84:87]
ds_read_b64_tr_b16 a[60:61], v13 offset:12288
v_mfma_f32_16x16x32_bf16 v[108:111], a[36:39], a[12:15], v[108:111]
ds_read_b64_tr_b16 a[62:63], v13 offset:12800
v_mfma_f32_16x16x32_bf16 v[40:43], a[0:3], a[40:43], v[40:43]
ds_read_b64_tr_b16 a[64:65], v12 offset:14336
v_mfma_f32_16x16x32_bf16 v[64:67], a[4:7], a[40:43], v[64:67]
ds_read_b64_tr_b16 a[66:67], v12 offset:14848
v_mfma_f32_16x16x32_bf16 v[88:91], a[8:11], a[40:43], v[88:91]
ds_read_b64_tr_b16 a[68:69], v13 offset:14336
v_mfma_f32_16x16x32_bf16 v[112:115], a[12:15], a[40:43], v[112:115]
ds_read_b64_tr_b16 a[70:71], v13 offset:14848
v_mfma_f32_16x16x32_bf16 v[44:47], a[0:3], a[44:47], v[44:47]
ds_read_b64_tr_b16 a[72:73], v12 offset:16384
v_mfma_f32_16x16x32_bf16 v[68:71], a[4:7], a[44:47], v[68:71]
ds_read_b64_tr_b16 a[74:75], v12 offset:16896
v_mfma_f32_16x16x32_bf16 v[92:95], a[8:11], a[44:47], v[92:95]
ds_read_b64_tr_b16 a[76:77], v13 offset:16384
v_mfma_f32_16x16x32_bf16 v[116:119], a[12:15], a[44:47], v[116:119]
ds_read_b64_tr_b16 a[78:79], v13 offset:16896
v_mfma_f32_16x16x32_bf16 v[48:51], a[0:3], a[48:51], v[48:51]
v_mfma_f32_16x16x32_bf16 v[72:75], a[4:7], a[48:51], v[72:75]
v_mfma_f32_16x16x32_bf16 v[96:99], a[8:11], a[48:51], v[96:99]
v_mfma_f32_16x16x32_bf16 v[120:123], a[12:15], a[48:51], v[120:123]
v_mfma_f32_16x16x32_bf16 v[52:55], a[0:3], a[52:55], v[52:55]
v_mfma_f32_16x16x32_bf16 v[76:79], a[4:7], a[52:55], v[76:79]
v_mfma_f32_16x16x32_bf16 v[100:103], a[8:11], a[52:55], v[100:103]
v_mfma_f32_16x16x32_bf16 v[124:127], a[12:15], a[52:55], v[124:127]
s_waitcnt lgkmcnt(0)
v_mfma_f32_16x16x32_bf16 v[32:35], a[56:59], a[16:19], v[32:35]
s_barrier
ds_read_b128 a[0:3], v10 offset:0
v_mfma_f32_16x16x32_bf16 v[56:59], a[56:59], a[20:23], v[56:59]
ds_read_b64_tr_b16 a[32:33], v14 offset:16384
v_mfma_f32_16x16x32_bf16 v[80:83], a[56:59], a[24:27], v[80:83]
ds_read_b64_tr_b16 a[34:35], v14 offset:16896
v_mfma_f32_16x16x32_bf16 v[104:107], a[56:59], a[28:31], v[104:107]
ds_read_b128 a[4:7], v10 offset:2048
v_mfma_f32_16x16x32_bf16 v[36:39], a[60:63], a[16:19], v[36:39]
ds_read_b128 a[8:11], v10 offset:4096
v_mfma_f32_16x16x32_bf16 v[60:63], a[60:63], a[20:23], v[60:63]
ds_read_b128 a[12:15], v10 offset:6144
v_mfma_f32_16x16x32_bf16 v[84:87], a[60:63], a[24:27], v[84:87]
ds_read_b64_tr_b16 a[36:37], v15 offset:16384
v_mfma_f32_16x16x32_bf16 v[108:111], a[60:63], a[28:31], v[108:111]
ds_read_b64_tr_b16 a[38:39], v15 offset:16896
v_mfma_f32_16x16x32_bf16 v[40:43], a[16:19], a[64:67], v[40:43]
ds_read_b64_tr_b16 a[40:41], v14 offset:18432
v_mfma_f32_16x16x32_bf16 v[64:67], a[20:23], a[64:67], v[64:67]
ds_read_b64_tr_b16 a[42:43], v14 offset:18944
v_mfma_f32_16x16x32_bf16 v[88:91], a[24:27], a[64:67], v[88:91]
ds_read_b64_tr_b16 a[44:45], v15 offset:18432
v_mfma_f32_16x16x32_bf16 v[112:115], a[28:31], a[64:67], v[112:115]
ds_read_b64_tr_b16 a[46:47], v15 offset:18944
v_mfma_f32_16x16x32_bf16 v[44:47], a[16:19], a[68:71], v[44:47]
ds_read_b64_tr_b16 a[48:49], v14 offset:20480
v_mfma_f32_16x16x32_bf16 v[68:71], a[20:23], a[68:71], v[68:71]
ds_read_b64_tr_b16 a[50:51], v14 offset:20992
v_mfma_f32_16x16x32_bf16 v[92:95], a[24:27], a[68:71], v[92:95]
ds_read_b64_tr_b16 a[52:53], v15 offset:20480
v_mfma_f32_16x16x32_bf16 v[116:119], a[28:31], a[68:71], v[116:119]
ds_read_b64_tr_b16 a[54:55], v15 offset:20992
v_mfma_f32_16x16x32_bf16 v[48:51], a[16:19], a[72:75], v[48:51]
v_mfma_f32_16x16x32_bf16 v[72:75], a[20:23], a[72:75], v[72:75]
v_mfma_f32_16x16x32_bf16 v[96:99], a[24:27], a[72:75], v[96:99]
v_mfma_f32_16x16x32_bf16 v[120:123], a[28:31], a[72:75], v[120:123]
v_mfma_f32_16x16x32_bf16 v[52:55], a[16:19], a[76:79], v[52:55]
v_mfma_f32_16x16x32_bf16 v[76:79], a[20:23], a[76:79], v[76:79]
v_mfma_f32_16x16x32_bf16 v[100:103], a[24:27], a[76:79], v[100:103]
v_mfma_f32_16x16x32_bf16 v[124:127], a[28:31], a[76:79], v[124:127]
s_waitcnt lgkmcnt(0)
v_mfma_f32_16x16x32_bf16 v[32:35], a[32:35], a[0:3], v[32:35]
ds_read_b128 a[16:19], v11 offset:0
v_mfma_f32_16x16x32_bf16 v[56:59], a[32:35], a[4:7], v[56:59]
ds_read_b64_tr_b16 a[56:57], v14 offset:28672
v_mfma_f32_16x16x32_bf16 v[80:83], a[32:35], a[8:11], v[80:83]
ds_read_b64_tr_b16 a[58:59], v14 offset:29184
v_mfma_f32_16x16x32_bf16 v[104:107], a[32:35], a[12:15], v[104:107]
ds_read_b128 a[20:23], v11 offset:2048
v_mfma_f32_16x16x32_bf16 v[36:39], a[36:39], a[0:3], v[36:39]
ds_read_b128 a[24:27], v11 offset:4096
v_mfma_f32_16x16x32_bf16 v[60:63], a[36:39], a[4:7], v[60:63]
ds_read_b128 a[28:31], v11 offset:6144
v_mfma_f32_16x16x32_bf16 v[84:87], a[36:39], a[8:11], v[84:87]
ds_read_b64_tr_b16 a[60:61], v15 offset:28672
v_mfma_f32_16x16x32_bf16 v[108:111], a[36:39], a[12:15], v[108:111]
ds_read_b64_tr_b16 a[62:63], v15 offset:29184
v_mfma_f32_16x16x32_bf16 v[40:43], a[0:3], a[40:43], v[40:43]
ds_read_b64_tr_b16 a[64:65], v14 offset:30720
v_mfma_f32_16x16x32_bf16 v[64:67], a[4:7], a[40:43], v[64:67]
ds_read_b64_tr_b16 a[66:67], v14 offset:31232
v_mfma_f32_16x16x32_bf16 v[88:91], a[8:11], a[40:43], v[88:91]
ds_read_b64_tr_b16 a[68:69], v15 offset:30720
v_mfma_f32_16x16x32_bf16 v[112:115], a[12:15], a[40:43], v[112:115]
ds_read_b64_tr_b16 a[70:71], v15 offset:31232
v_mfma_f32_16x16x32_bf16 v[44:47], a[0:3], a[44:47], v[44:47]
ds_read_b64_tr_b16 a[72:73], v14 offset:32768
v_mfma_f32_16x16x32_bf16 v[68:71], a[4:7], a[44:47], v[68:71]
ds_read_b64_tr_b16 a[74:75], v14 offset:33280
v_mfma_f32_16x16x32_bf16 v[92:95], a[8:11], a[44:47], v[92:95]
ds_read_b64_tr_b16 a[76:77], v15 offset:32768
v_mfma_f32_16x16x32_bf16 v[116:119], a[12:15], a[44:47], v[116:119]
ds_read_b64_tr_b16 a[78:79], v15 offset:33280
v_mfma_f32_16x16x32_bf16 v[48:51], a[0:3], a[48:51], v[48:51]
v_mfma_f32_16x16x32_bf16 v[72:75], a[4:7], a[48:51], v[72:75]
v_mfma_f32_16x16x32_bf16 v[96:99], a[8:11], a[48:51], v[96:99]
v_mfma_f32_16x16x32_bf16 v[120:123], a[12:15], a[48:51], v[120:123]
v_mfma_f32_16x16x32_bf16 v[52:55], a[0:3], a[52:55], v[52:55]
v_mfma_f32_16x16x32_bf16 v[76:79], a[4:7], a[52:55], v[76:79]
v_mfma_f32_16x16x32_bf16 v[100:103], a[8:11], a[52:55], v[100:103]
v_mfma_f32_16x16x32_bf16 v[124:127], a[12:15], a[52:55], v[124:127]
s_waitcnt lgkmcnt(0)
v_mfma_f32_16x16x32_bf16 v[32:35], a[56:59], a[16:19], v[32:35]
s_barrier
ds_read_b128 a[0:3], v8 offset:24576
v_mfma_f32_16x16x32_bf16 v[56:59], a[56:59], a[20:23], v[56:59]
ds_read_b64_tr_b16 a[32:33], v12 offset:40960
v_mfma_f32_16x16x32_bf16 v[80:83], a[56:59], a[24:27], v[80:83]
ds_read_b64_tr_b16 a[34:35], v12 offset:41472
v_mfma_f32_16x16x32_bf16 v[104:107], a[56:59], a[28:31], v[104:107]
ds_read_b128 a[4:7], v8 offset:26624
v_mfma_f32_16x16x32_bf16 v[36:39], a[60:63], a[16:19], v[36:39]
ds_read_b128 a[8:11], v8 offset:28672
v_mfma_f32_16x16x32_bf16 v[60:63], a[60:63], a[20:23], v[60:63]
ds_read_b128 a[12:15], v8 offset:30720
v_mfma_f32_16x16x32_bf16 v[84:87], a[60:63], a[24:27], v[84:87]
ds_read_b64_tr_b16 a[36:37], v13 offset:40960
v_mfma_f32_16x16x32_bf16 v[108:111], a[60:63], a[28:31], v[108:111]
ds_read_b64_tr_b16 a[38:39], v13 offset:41472
v_mfma_f32_16x16x32_bf16 v[40:43], a[16:19], a[64:67], v[40:43]
ds_read_b64_tr_b16 a[40:41], v12 offset:43008
v_mfma_f32_16x16x32_bf16 v[64:67], a[20:23], a[64:67], v[64:67]
ds_read_b64_tr_b16 a[42:43], v12 offset:43520
v_mfma_f32_16x16x32_bf16 v[88:91], a[24:27], a[64:67], v[88:91]
ds_read_b64_tr_b16 a[44:45], v13 offset:43008
v_mfma_f32_16x16x32_bf16 v[112:115], a[28:31], a[64:67], v[112:115]
ds_read_b64_tr_b16 a[46:47], v13 offset:43520
v_mfma_f32_16x16x32_bf16 v[44:47], a[16:19], a[68:71], v[44:47]
ds_read_b64_tr_b16 a[48:49], v12 offset:45056
v_mfma_f32_16x16x32_bf16 v[68:71], a[20:23], a[68:71], v[68:71]
ds_read_b64_tr_b16 a[50:51], v12 offset:45568
v_mfma_f32_16x16x32_bf16 v[92:95], a[24:27], a[68:71], v[92:95]
ds_read_b64_tr_b16 a[52:53], v13 offset:45056
v_mfma_f32_16x16x32_bf16 v[116:119], a[28:31], a[68:71], v[116:119]
ds_read_b64_tr_b16 a[54:55], v13 offset:45568
v_mfma_f32_16x16x32_bf16 v[48:51], a[16:19], a[72:75], v[48:51]
v_mfma_f32_16x16x32_bf16 v[72:75], a[20:23], a[72:75], v[72:75]
v_mfma_f32_16x16x32_bf16 v[96:99], a[24:27], a[72:75], v[96:99]
v_mfma_f32_16x16x32_bf16 v[120:123], a[28:31], a[72:75], v[120:123]
v_mfma_f32_16x16x32_bf16 v[52:55], a[16:19], a[76:79], v[52:55]
v_mfma_f32_16x16x32_bf16 v[76:79], a[20:23], a[76:79], v[76:79]
v_mfma_f32_16x16x32_bf16 v[100:103], a[24:27], a[76:79], v[100:103]
v_mfma_f32_16x16x32_bf16 v[124:127], a[28:31], a[76:79], v[124:127]
s_waitcnt lgkmcnt(0)
v_mfma_f32_16x16x32_bf16 v[32:35], a[32:35], a[0:3], v[32:35]
ds_read_b128 a[16:19], v9 offset:24576
v_mfma_f32_16x16x32_bf16 v[56:59], a[32:35], a[4:7], v[56:59]
ds_read_b64_tr_b16 a[56:57], v12 offset:53248
v_mfma_f32_16x16x32_bf16 v[80:83], a[32:35], a[8:11], v[80:83]
ds_read_b64_tr_b16 a[58:59], v12 offset:53760
v_mfma_f32_16x16x32_bf16 v[104:107], a[32:35], a[12:15], v[104:107]
ds_read_b128 a[20:23], v9 offset:26624
v_mfma_f32_16x16x32_bf16 v[36:39], a[36:39], a[0:3], v[36:39]
ds_read_b128 a[24:27], v9 offset:28672
v_mfma_f32_16x16x32_bf16 v[60:63], a[36:39], a[4:7], v[60:63]
ds_read_b128 a[28:31], v9 offset:30720
v_mfma_f32_16x16x32_bf16 v[84:87], a[36:39], a[8:11], v[84:87]
ds_read_b64_tr_b16 a[60:61], v13 offset:53248
v_mfma_f32_16x16x32_bf16 v[108:111], a[36:39], a[12:15], v[108:111]
ds_read_b64_tr_b16 a[62:63], v13 offset:53760
v_mfma_f32_16x16x32_bf16 v[40:43], a[0:3], a[40:43], v[40:43]
ds_read_b64_tr_b16 a[64:65], v12 offset:55296
v_mfma_f32_16x16x32_bf16 v[64:67], a[4:7], a[40:43], v[64:67]
ds_read_b64_tr_b16 a[66:67], v12 offset:55808
v_mfma_f32_16x16x32_bf16 v[88:91], a[8:11], a[40:43], v[88:91]
ds_read_b64_tr_b16 a[68:69], v13 offset:55296
v_mfma_f32_16x16x32_bf16 v[112:115], a[12:15], a[40:43], v[112:115]
ds_read_b64_tr_b16 a[70:71], v13 offset:55808
v_mfma_f32_16x16x32_bf16 v[44:47], a[0:3], a[44:47], v[44:47]
ds_read_b64_tr_b16 a[72:73], v12 offset:57344
v_mfma_f32_16x16x32_bf16 v[68:71], a[4:7], a[44:47], v[68:71]
ds_read_b64_tr_b16 a[74:75], v12 offset:57856
v_mfma_f32_16x16x32_bf16 v[92:95], a[8:11], a[44:47], v[92:95]
ds_read_b64_tr_b16 a[76:77], v13 offset:57344
v_mfma_f32_16x16x32_bf16 v[116:119], a[12:15], a[44:47], v[116:119]
ds_read_b64_tr_b16 a[78:79], v13 offset:57856
v_mfma_f32_16x16x32_bf16 v[48:51], a[0:3], a[48:51], v[48:51]
v_mfma_f32_16x16x32_bf16 v[72:75], a[4:7], a[48:51], v[72:75]
v_mfma_f32_16x16x32_bf16 v[96:99], a[8:11], a[48:51], v[96:99]
v_mfma_f32_16x16x32_bf16 v[120:123], a[12:15], a[48:51], v[120:123]
v_mfma_f32_16x16x32_bf16 v[52:55], a[0:3], a[52:55], v[52:55]
v_mfma_f32_16x16x32_bf16 v[76:79], a[4:7], a[52:55], v[76:79]
v_mfma_f32_16x16x32_bf16 v[100:103], a[8:11], a[52:55], v[100:103]
v_mfma_f32_16x16x32_bf16 v[124:127], a[12:15], a[52:55], v[124:127]
s_waitcnt lgkmcnt(0)
v_mfma_f32_16x16x32_bf16 v[32:35], a[56:59], a[16:19], v[32:35]
s_barrier
ds_read_b128 a[0:3], v10 offset:57344
v_mfma_f32_16x16x32_bf16 v[56:59], a[56:59], a[20:23], v[56:59]
ds_read_b64_tr_b16 a[32:33], v12 offset:0
v_mfma_f32_16x16x32_bf16 v[80:83], a[56:59], a[24:27], v[80:83]
ds_read_b64_tr_b16 a[34:35], v12 offset:512
v_mfma_f32_16x16x32_bf16 v[104:107], a[56:59], a[28:31], v[104:107]
ds_read_b128 a[4:7], v10 offset:59392
v_mfma_f32_16x16x32_bf16 v[36:39], a[60:63], a[16:19], v[36:39]
ds_read_b128 a[8:11], v10 offset:61440
v_mfma_f32_16x16x32_bf16 v[60:63], a[60:63], a[20:23], v[60:63]
ds_read_b128 a[12:15], v10 offset:63488
v_mfma_f32_16x16x32_bf16 v[84:87], a[60:63], a[24:27], v[84:87]
ds_read_b64_tr_b16 a[36:37], v13 offset:0
v_mfma_f32_16x16x32_bf16 v[108:111], a[60:63], a[28:31], v[108:111]
ds_read_b64_tr_b16 a[38:39], v13 offset:512
v_mfma_f32_16x16x32_bf16 v[40:43], a[16:19], a[64:67], v[40:43]
ds_read_b64_tr_b16 a[40:41], v12 offset:2048
v_mfma_f32_16x16x32_bf16 v[64:67], a[20:23], a[64:67], v[64:67]
ds_read_b64_tr_b16 a[42:43], v12 offset:2560
v_mfma_f32_16x16x32_bf16 v[88:91], a[24:27], a[64:67], v[88:91]
ds_read_b64_tr_b16 a[44:45], v13 offset:2048
v_mfma_f32_16x16x32_bf16 v[112:115], a[28:31], a[64:67], v[112:115]
ds_read_b64_tr_b16 a[46:47], v13 offset:2560
v_mfma_f32_16x16x32_bf16 v[44:47], a[16:19], a[68:71], v[44:47]
ds_read_b64_tr_b16 a[48:49], v12 offset:4096
v_mfma_f32_16x16x32_bf16 v[68:71], a[20:23], a[68:71], v[68:71]
ds_read_b64_tr_b16 a[50:51], v12 offset:4608
v_mfma_f32_16x16x32_bf16 v[92:95], a[24:27], a[68:71], v[92:95]
ds_read_b64_tr_b16 a[52:53], v13 offset:4096
v_mfma_f32_16x16x32_bf16 v[116:119], a[28:31], a[68:71], v[116:119]
ds_read_b64_tr_b16 a[54:55], v13 offset:4608
v_mfma_f32_16x16x32_bf16 v[48:51], a[16:19], a[72:75], v[48:51]
v_mfma_f32_16x16x32_bf16 v[72:75], a[20:23], a[72:75], v[72:75]
v_mfma_f32_16x16x32_bf16 v[96:99], a[24:27], a[72:75], v[96:99]
v_mfma_f32_16x16x32_bf16 v[120:123], a[28:31], a[72:75], v[120:123]
v_mfma_f32_16x16x32_bf16 v[52:55], a[16:19], a[76:79], v[52:55]
v_mfma_f32_16x16x32_bf16 v[76:79], a[20:23], a[76:79], v[76:79]
v_mfma_f32_16x16x32_bf16 v[100:103], a[24:27], a[76:79], v[100:103]
v_mfma_f32_16x16x32_bf16 v[124:127], a[28:31], a[76:79], v[124:127]
s_waitcnt lgkmcnt(0)
v_mfma_f32_16x16x32_bf16 v[32:35], a[32:35], a[0:3], v[32:35]
ds_read_b128 a[16:19], v11 offset:57344
v_mfma_f32_16x16x32_bf16 v[56:59], a[32:35], a[4:7], v[56:59]
ds_read_b64_tr_b16 a[56:57], v12 offset:12288
v_mfma_f32_16x16x32_bf16 v[80:83], a[32:35], a[8:11], v[80:83]
ds_read_b64_tr_b16 a[58:59], v12 offset:12800
v_mfma_f32_16x16x32_bf16 v[104:107], a[32:35], a[12:15], v[104:107]
ds_read_b128 a[20:23], v11 offset:59392
v_mfma_f32_16x16x32_bf16 v[36:39], a[36:39], a[0:3], v[36:39]
ds_read_b128 a[24:27], v11 offset:61440
v_mfma_f32_16x16x32_bf16 v[60:63], a[36:39], a[4:7], v[60:63]
ds_read_b128 a[28:31], v11 offset:63488
v_mfma_f32_16x16x32_bf16 v[84:87], a[36:39], a[8:11], v[84:87]
ds_read_b64_tr_b16 a[60:61], v13 offset:12288
v_mfma_f32_16x16x32_bf16 v[108:111], a[36:39], a[12:15], v[108:111]
ds_read_b64_tr_b16 a[62:63], v13 offset:12800
v_mfma_f32_16x16x32_bf16 v[40:43], a[0:3], a[40:43], v[40:43]
ds_read_b64_tr_b16 a[64:65], v12 offset:14336
v_mfma_f32_16x16x32_bf16 v[64:67], a[4:7], a[40:43], v[64:67]
ds_read_b64_tr_b16 a[66:67], v12 offset:14848
v_mfma_f32_16x16x32_bf16 v[88:91], a[8:11], a[40:43], v[88:91]
ds_read_b64_tr_b16 a[68:69], v13 offset:14336
v_mfma_f32_16x16x32_bf16 v[112:115], a[12:15], a[40:43], v[112:115]
ds_read_b64_tr_b16 a[70:71], v13 offset:14848
v_mfma_f32_16x16x32_bf16 v[44:47], a[0:3], a[44:47], v[44:47]
ds_read_b64_tr_b16 a[72:73], v12 offset:16384
v_mfma_f32_16x16x32_bf16 v[68:71], a[4:7], a[44:47], v[68:71]
ds_read_b64_tr_b16 a[74:75], v12 offset:16896
v_mfma_f32_16x16x32_bf16 v[92:95], a[8:11], a[44:47], v[92:95]
ds_read_b64_tr_b16 a[76:77], v13 offset:16384
v_mfma_f32_16x16x32_bf16 v[116:119], a[12:15], a[44:47], v[116:119]
ds_read_b64_tr_b16 a[78:79], v13 offset:16896
v_mfma_f32_16x16x32_bf16 v[48:51], a[0:3], a[48:51], v[48:51]
v_mfma_f32_16x16x32_bf16 v[72:75], a[4:7], a[48:51], v[72:75]
v_mfma_f32_16x16x32_bf16 v[96:99], a[8:11], a[48:51], v[96:99]
v_mfma_f32_16x16x32_bf16 v[120:123], a[12:15], a[48:51], v[120:123]
v_mfma_f32_16x16x32_bf16 v[52:55], a[0:3], a[52:55], v[52:55]
v_mfma_f32_16x16x32_bf16 v[76:79], a[4:7], a[52:55], v[76:79]
v_mfma_f32_16x16x32_bf16 v[100:103], a[8:11], a[52:55], v[100:103]
v_mfma_f32_16x16x32_bf16 v[124:127], a[12:15], a[52:55], v[124:127]
s_waitcnt lgkmcnt(0)
v_mfma_f32_16x16x32_bf16 v[32:35], a[56:59], a[16:19], v[32:35]
s_barrier
ds_read_b128 a[0:3], v10 offset:40960
v_mfma_f32_16x16x32_bf16 v[56:59], a[56:59], a[20:23], v[56:59]
ds_read_b64_tr_b16 a[32:33], v14 offset:16384
v_mfma_f32_16x16x32_bf16 v[80:83], a[56:59], a[24:27], v[80:83]
ds_read_b64_tr_b16 a[34:35], v14 offset:16896
v_mfma_f32_16x16x32_bf16 v[104:107], a[56:59], a[28:31], v[104:107]
ds_read_b128 a[4:7], v10 offset:43008
v_mfma_f32_16x16x32_bf16 v[36:39], a[60:63], a[16:19], v[36:39]
ds_read_b128 a[8:11], v10 offset:45056
v_mfma_f32_16x16x32_bf16 v[60:63], a[60:63], a[20:23], v[60:63]
ds_read_b128 a[12:15], v10 offset:47104
v_mfma_f32_16x16x32_bf16 v[84:87], a[60:63], a[24:27], v[84:87]
ds_read_b64_tr_b16 a[36:37], v15 offset:16384
v_mfma_f32_16x16x32_bf16 v[108:111], a[60:63], a[28:31], v[108:111]
ds_read_b64_tr_b16 a[38:39], v15 offset:16896
v_mfma_f32_16x16x32_bf16 v[40:43], a[16:19], a[64:67], v[40:43]
ds_read_b64_tr_b16 a[40:41], v14 offset:18432
v_mfma_f32_16x16x32_bf16 v[64:67], a[20:23], a[64:67], v[64:67]
ds_read_b64_tr_b16 a[42:43], v14 offset:18944
v_mfma_f32_16x16x32_bf16 v[88:91], a[24:27], a[64:67], v[88:91]
ds_read_b64_tr_b16 a[44:45], v15 offset:18432
v_mfma_f32_16x16x32_bf16 v[112:115], a[28:31], a[64:67], v[112:115]
ds_read_b64_tr_b16 a[46:47], v15 offset:18944
v_mfma_f32_16x16x32_bf16 v[44:47], a[16:19], a[68:71], v[44:47]
ds_read_b64_tr_b16 a[48:49], v14 offset:20480
v_mfma_f32_16x16x32_bf16 v[68:71], a[20:23], a[68:71], v[68:71]
ds_read_b64_tr_b16 a[50:51], v14 offset:20992
v_mfma_f32_16x16x32_bf16 v[92:95], a[24:27], a[68:71], v[92:95]
ds_read_b64_tr_b16 a[52:53], v15 offset:20480
v_mfma_f32_16x16x32_bf16 v[116:119], a[28:31], a[68:71], v[116:119]
ds_read_b64_tr_b16 a[54:55], v15 offset:20992
v_mfma_f32_16x16x32_bf16 v[48:51], a[16:19], a[72:75], v[48:51]
v_mfma_f32_16x16x32_bf16 v[72:75], a[20:23], a[72:75], v[72:75]
v_mfma_f32_16x16x32_bf16 v[96:99], a[24:27], a[72:75], v[96:99]
v_mfma_f32_16x16x32_bf16 v[120:123], a[28:31], a[72:75], v[120:123]
v_mfma_f32_16x16x32_bf16 v[52:55], a[16:19], a[76:79], v[52:55]
v_mfma_f32_16x16x32_bf16 v[76:79], a[20:23], a[76:79], v[76:79]
v_mfma_f32_16x16x32_bf16 v[100:103], a[24:27], a[76:79], v[100:103]
v_mfma_f32_16x16x32_bf16 v[124:127], a[28:31], a[76:79], v[124:127]
s_waitcnt lgkmcnt(0)
v_mfma_f32_16x16x32_bf16 v[32:35], a[32:35], a[0:3], v[32:35]
ds_read_b128 a[16:19], v11 offset:40960
v_mfma_f32_16x16x32_bf16 v[56:59], a[32:35], a[4:7], v[56:59]
ds_read_b64_tr_b16 a[56:57], v14 offset:28672
v_mfma_f32_16x16x32_bf16 v[80:83], a[32:35], a[8:11], v[80:83]
ds_read_b64_tr_b16 a[58:59], v14 offset:29184
v_mfma_f32_16x16x32_bf16 v[104:107], a[32:35], a[12:15], v[104:107]
ds_read_b128 a[20:23], v11 offset:43008
v_mfma_f32_16x16x32_bf16 v[36:39], a[36:39], a[0:3], v[36:39]
ds_read_b128 a[24:27], v11 offset:45056
v_mfma_f32_16x16x32_bf16 v[60:63], a[36:39], a[4:7], v[60:63]
ds_read_b128 a[28:31], v11 offset:47104
v_mfma_f32_16x16x32_bf16 v[84:87], a[36:39], a[8:11], v[84:87]
ds_read_b64_tr_b16 a[60:61], v15 offset:28672
v_mfma_f32_16x16x32_bf16 v[108:111], a[36:39], a[12:15], v[108:111]
ds_read_b64_tr_b16 a[62:63], v15 offset:29184
v_mfma_f32_16x16x32_bf16 v[40:43], a[0:3], a[40:43], v[40:43]
ds_read_b64_tr_b16 a[64:65], v14 offset:30720
v_mfma_f32_16x16x32_bf16 v[64:67], a[4:7], a[40:43], v[64:67]
ds_read_b64_tr_b16 a[66:67], v14 offset:31232
v_mfma_f32_16x16x32_bf16 v[88:91], a[8:11], a[40:43], v[88:91]
ds_read_b64_tr_b16 a[68:69], v15 offset:30720
v_mfma_f32_16x16x32_bf16 v[112:115], a[12:15], a[40:43], v[112:115]
ds_read_b64_tr_b16 a[70:71], v15 offset:31232
v_mfma_f32_16x16x32_bf16 v[44:47], a[0:3], a[44:47], v[44:47]
ds_read_b64_tr_b16 a[72:73], v14 offset:32768
v_mfma_f32_16x16x32_bf16 v[68:71], a[4:7], a[44:47], v[68:71]
ds_read_b64_tr_b16 a[74:75], v14 offset:33280
v_mfma_f32_16x16x32_bf16 v[92:95], a[8:11], a[44:47], v[92:95]
ds_read_b64_tr_b16 a[76:77], v15 offset:32768
v_mfma_f32_16x16x32_bf16 v[116:119], a[12:15], a[44:47], v[116:119]
ds_read_b64_tr_b16 a[78:79], v15 offset:33280
v_mfma_f32_16x16x32_bf16 v[48:51], a[0:3], a[48:51], v[48:51]
v_mfma_f32_16x16x32_bf16 v[72:75], a[4:7], a[48:51], v[72:75]
v_mfma_f32_16x16x32_bf16 v[96:99], a[8:11], a[48:51], v[96:99]
v_mfma_f32_16x16x32_bf16 v[120:123], a[12:15], a[48:51], v[120:123]
v_mfma_f32_16x16x32_bf16 v[52:55], a[0:3], a[52:55], v[52:55]
v_mfma_f32_16x16x32_bf16 v[76:79], a[4:7], a[52:55], v[76:79]
v_mfma_f32_16x16x32_bf16 v[100:103], a[8:11], a[52:55], v[100:103]
v_mfma_f32_16x16x32_bf16 v[124:127], a[12:15], a[52:55], v[124:127]
s_waitcnt lgkmcnt(0)
v_mfma_f32_16x16x32_bf16 v[32:35], a[56:59], a[16:19], v[32:35]
s_barrier
ds_read_b128 a[0:3], v10 offset:0
v_mfma_f32_16x16x32_bf16 v[56:59], a[56:59], a[20:23], v[56:59]
ds_read_b64_tr_b16 a[32:33], v12 offset:40960
v_mfma_f32_16x16x32_bf16 v[80:83], a[56:59], a[24:27], v[80:83]
ds_read_b64_tr_b16 a[34:35], v12 offset:41472
v_mfma_f32_16x16x32_bf16 v[104:107], a[56:59], a[28:31], v[104:107]
ds_read_b128 a[4:7], v10 offset:2048
v_mfma_f32_16x16x32_bf16 v[36:39], a[60:63], a[16:19], v[36:39]
ds_read_b128 a[8:11], v10 offset:4096
v_mfma_f32_16x16x32_bf16 v[60:63], a[60:63], a[20:23], v[60:63]
ds_read_b128 a[12:15], v10 offset:6144
v_mfma_f32_16x16x32_bf16 v[84:87], a[60:63], a[24:27], v[84:87]
ds_read_b64_tr_b16 a[36:37], v13 offset:40960
v_mfma_f32_16x16x32_bf16 v[108:111], a[60:63], a[28:31], v[108:111]
ds_read_b64_tr_b16 a[38:39], v13 offset:41472
v_mfma_f32_16x16x32_bf16 v[40:43], a[16:19], a[64:67], v[40:43]
ds_read_b64_tr_b16 a[40:41], v12 offset:43008
v_mfma_f32_16x16x32_bf16 v[64:67], a[20:23], a[64:67], v[64:67]
ds_read_b64_tr_b16 a[42:43], v12 offset:43520
v_mfma_f32_16x16x32_bf16 v[88:91], a[24:27], a[64:67], v[88:91]
ds_read_b64_tr_b16 a[44:45], v13 offset:43008
v_mfma_f32_16x16x32_bf16 v[112:115], a[28:31], a[64:67], v[112:115]
ds_read_b64_tr_b16 a[46:47], v13 offset:43520
v_mfma_f32_16x16x32_bf16 v[44:47], a[16:19], a[68:71], v[44:47]
ds_read_b64_tr_b16 a[48:49], v12 offset:45056
v_mfma_f32_16x16x32_bf16 v[68:71], a[20:23], a[68:71], v[68:71]
ds_read_b64_tr_b16 a[50:51], v12 offset:45568
v_mfma_f32_16x16x32_bf16 v[92:95], a[24:27], a[68:71], v[92:95]
ds_read_b64_tr_b16 a[52:53], v13 offset:45056
v_mfma_f32_16x16x32_bf16 v[116:119], a[28:31], a[68:71], v[116:119]
ds_read_b64_tr_b16 a[54:55], v13 offset:45568
v_mfma_f32_16x16x32_bf16 v[48:51], a[16:19], a[72:75], v[48:51]
v_mfma_f32_16x16x32_bf16 v[72:75], a[20:23], a[72:75], v[72:75]
v_mfma_f32_16x16x32_bf16 v[96:99], a[24:27], a[72:75], v[96:99]
v_mfma_f32_16x16x32_bf16 v[120:123], a[28:31], a[72:75], v[120:123]
v_mfma_f32_16x16x32_bf16 v[52:55], a[16:19], a[76:79], v[52:55]
v_mfma_f32_16x16x32_bf16 v[76:79], a[20:23], a[76:79], v[76:79]
v_mfma_f32_16x16x32_bf16 v[100:103], a[24:27], a[76:79], v[100:103]
v_mfma_f32_16x16x32_bf16 v[124:127], a[28:31], a[76:79], v[124:127]
s_waitcnt lgkmcnt(0)
v_mfma_f32_16x16x32_bf16 v[32:35], a[32:35], a[0:3], v[32:35]
ds_read_b128 a[16:19], v11 offset:0
v_mfma_f32_16x16x32_bf16 v[56:59], a[32:35], a[4:7], v[56:59]
ds_read_b64_tr_b16 a[56:57], v12 offset:53248
v_mfma_f32_16x16x32_bf16 v[80:83], a[32:35], a[8:11], v[80:83]
ds_read_b64_tr_b16 a[58:59], v12 offset:53760
v_mfma_f32_16x16x32_bf16 v[104:107], a[32:35], a[12:15], v[104:107]
ds_read_b128 a[20:23], v11 offset:2048
v_mfma_f32_16x16x32_bf16 v[36:39], a[36:39], a[0:3], v[36:39]
ds_read_b128 a[24:27], v11 offset:4096
v_mfma_f32_16x16x32_bf16 v[60:63], a[36:39], a[4:7], v[60:63]
ds_read_b128 a[28:31], v11 offset:6144
v_mfma_f32_16x16x32_bf16 v[84:87], a[36:39], a[8:11], v[84:87]
ds_read_b64_tr_b16 a[60:61], v13 offset:53248
v_mfma_f32_16x16x32_bf16 v[108:111], a[36:39], a[12:15], v[108:111]
ds_read_b64_tr_b16 a[62:63], v13 offset:53760
v_mfma_f32_16x16x32_bf16 v[40:43], a[0:3], a[40:43], v[40:43]
ds_read_b64_tr_b16 a[64:65], v12 offset:55296
v_mfma_f32_16x16x32_bf16 v[64:67], a[4:7], a[40:43], v[64:67]
ds_read_b64_tr_b16 a[66:67], v12 offset:55808
v_mfma_f32_16x16x32_bf16 v[88:91], a[8:11], a[40:43], v[88:91]
ds_read_b64_tr_b16 a[68:69], v13 offset:55296
v_mfma_f32_16x16x32_bf16 v[112:115], a[12:15], a[40:43], v[112:115]
ds_read_b64_tr_b16 a[70:71], v13 offset:55808
v_mfma_f32_16x16x32_bf16 v[44:47], a[0:3], a[44:47], v[44:47]
ds_read_b64_tr_b16 a[72:73], v12 offset:57344
v_mfma_f32_16x16x32_bf16 v[68:71], a[4:7], a[44:47], v[68:71]
ds_read_b64_tr_b16 a[74:75], v12 offset:57856
v_mfma_f32_16x16x32_bf16 v[92:95], a[8:11], a[44:47], v[92:95]
ds_read_b64_tr_b16 a[76:77], v13 offset:57344
v_mfma_f32_16x16x32_bf16 v[116:119], a[12:15], a[44:47], v[116:119]
ds_read_b64_tr_b16 a[78:79], v13 offset:57856
v_mfma_f32_16x16x32_bf16 v[48:51], a[0:3], a[48:51], v[48:51]
v_lshrrev_b32 v2, 4, v1
v_lshlrev_b32 v2, 4, v2
s_lshl_b32 s70, s66, 8
s_add_u32 s70, s70, 159744
v_add_u32 v17, s70, v2
v_mfma_f32_16x16x32_bf16 v[72:75], a[4:7], a[48:51], v[72:75]
v_mfma_f32_16x16x32_bf16 v[96:99], a[8:11], a[48:51], v[96:99]
v_and_b32 v2, 15, v1
v_lshlrev_b32 v2, 2, v2
s_lshl_b32 s70, s67, 7
s_add_u32 s70, s70, 160768
v_add_u32 v18, s70, v2
v_mfma_f32_16x16x32_bf16 v[120:123], a[12:15], a[48:51], v[120:123]
v_mfma_f32_16x16x32_bf16 v[52:55], a[0:3], a[52:55], v[52:55]
v_mfma_f32_16x16x32_bf16 v[76:79], a[4:7], a[52:55], v[76:79]
v_mfma_f32_16x16x32_bf16 v[100:103], a[8:11], a[52:55], v[100:103]
v_mfma_f32_16x16x32_bf16 v[124:127], a[12:15], a[52:55], v[124:127]
s_waitcnt lgkmcnt(0)
v_mfma_f32_16x16x32_bf16 v[32:35], a[56:59], a[16:19], v[32:35]
s_barrier
ds_read_b128 a[0:3], v8 offset:24576
v_mfma_f32_16x16x32_bf16 v[56:59], a[56:59], a[20:23], v[56:59]
ds_read_b64_tr_b16 a[32:33], v12 offset:0
v_mfma_f32_16x16x32_bf16 v[80:83], a[56:59], a[24:27], v[80:83]
ds_read_b64_tr_b16 a[34:35], v12 offset:512
v_mfma_f32_16x16x32_bf16 v[104:107], a[56:59], a[28:31], v[104:107]
ds_read_b128 a[4:7], v8 offset:26624
v_mfma_f32_16x16x32_bf16 v[36:39], a[60:63], a[16:19], v[36:39]
ds_read_b128 a[8:11], v8 offset:28672
v_mfma_f32_16x16x32_bf16 v[60:63], a[60:63], a[20:23], v[60:63]
ds_read_b128 a[12:15], v8 offset:30720
v_mfma_f32_16x16x32_bf16 v[84:87], a[60:63], a[24:27], v[84:87]
ds_read_b64_tr_b16 a[36:37], v13 offset:0
v_mfma_f32_16x16x32_bf16 v[108:111], a[60:63], a[28:31], v[108:111]
ds_read_b64_tr_b16 a[38:39], v13 offset:512
v_mfma_f32_16x16x32_bf16 v[40:43], a[16:19], a[64:67], v[40:43]
ds_read_b64_tr_b16 a[40:41], v12 offset:2048
v_mfma_f32_16x16x32_bf16 v[64:67], a[20:23], a[64:67], v[64:67]
ds_read_b64_tr_b16 a[42:43], v12 offset:2560
v_mfma_f32_16x16x32_bf16 v[88:91], a[24:27], a[64:67], v[88:91]
ds_read_b64_tr_b16 a[44:45], v13 offset:2048
v_mfma_f32_16x16x32_bf16 v[112:115], a[28:31], a[64:67], v[112:115]
ds_read_b64_tr_b16 a[46:47], v13 offset:2560
v_mfma_f32_16x16x32_bf16 v[44:47], a[16:19], a[68:71], v[44:47]
ds_read_b64_tr_b16 a[48:49], v12 offset:4096
v_mfma_f32_16x16x32_bf16 v[68:71], a[20:23], a[68:71], v[68:71]
ds_read_b64_tr_b16 a[50:51], v12 offset:4608
v_mfma_f32_16x16x32_bf16 v[92:95], a[24:27], a[68:71], v[92:95]
ds_read_b64_tr_b16 a[52:53], v13 offset:4096
v_mfma_f32_16x16x32_bf16 v[116:119], a[28:31], a[68:71], v[116:119]
ds_read_b64_tr_b16 a[54:55], v13 offset:4608
v_mfma_f32_16x16x32_bf16 v[48:51], a[16:19], a[72:75], v[48:51]
v_mfma_f32_16x16x32_bf16 v[72:75], a[20:23], a[72:75], v[72:75]
v_mfma_f32_16x16x32_bf16 v[96:99], a[24:27], a[72:75], v[96:99]
v_mfma_f32_16x16x32_bf16 v[120:123], a[28:31], a[72:75], v[120:123]
v_mfma_f32_16x16x32_bf16 v[52:55], a[16:19], a[76:79], v[52:55]
v_mfma_f32_16x16x32_bf16 v[76:79], a[20:23], a[76:79], v[76:79]
v_mfma_f32_16x16x32_bf16 v[100:103], a[24:27], a[76:79], v[100:103]
v_mfma_f32_16x16x32_bf16 v[124:127], a[28:31], a[76:79], v[124:127]
s_waitcnt lgkmcnt(0)
v_mfma_f32_16x16x32_bf16 v[32:35], a[32:35], a[0:3], v[32:35]
ds_read_b128 a[16:19], v9 offset:24576
v_mfma_f32_16x16x32_bf16 v[56:59], a[32:35], a[4:7], v[56:59]
ds_read_b64_tr_b16 a[56:57], v12 offset:12288
v_mfma_f32_16x16x32_bf16 v[80:83], a[32:35], a[8:11], v[80:83]
ds_read_b64_tr_b16 a[58:59], v12 offset:12800
v_mfma_f32_16x16x32_bf16 v[104:107], a[32:35], a[12:15], v[104:107]
ds_read_b128 a[20:23], v9 offset:26624
v_mfma_f32_16x16x32_bf16 v[36:39], a[36:39], a[0:3], v[36:39]
ds_read_b128 a[24:27], v9 offset:28672
v_mfma_f32_16x16x32_bf16 v[60:63], a[36:39], a[4:7], v[60:63]
ds_read_b128 a[28:31], v9 offset:30720
v_mfma_f32_16x16x32_bf16 v[84:87], a[36:39], a[8:11], v[84:87]
ds_read_b64_tr_b16 a[60:61], v13 offset:12288
v_mfma_f32_16x16x32_bf16 v[108:111], a[36:39], a[12:15], v[108:111]
ds_read_b64_tr_b16 a[62:63], v13 offset:12800
v_mfma_f32_16x16x32_bf16 v[40:43], a[0:3], a[40:43], v[40:43]
ds_read_b64_tr_b16 a[64:65], v12 offset:14336
v_mfma_f32_16x16x32_bf16 v[64:67], a[4:7], a[40:43], v[64:67]
ds_read_b64_tr_b16 a[66:67], v12 offset:14848
v_mfma_f32_16x16x32_bf16 v[88:91], a[8:11], a[40:43], v[88:91]
ds_read_b64_tr_b16 a[68:69], v13 offset:14336
v_mfma_f32_16x16x32_bf16 v[112:115], a[12:15], a[40:43], v[112:115]
ds_read_b64_tr_b16 a[70:71], v13 offset:14848
v_mfma_f32_16x16x32_bf16 v[44:47], a[0:3], a[44:47], v[44:47]
ds_read_b64_tr_b16 a[72:73], v12 offset:16384
v_mfma_f32_16x16x32_bf16 v[68:71], a[4:7], a[44:47], v[68:71]
ds_read_b64_tr_b16 a[74:75], v12 offset:16896
v_mfma_f32_16x16x32_bf16 v[92:95], a[8:11], a[44:47], v[92:95]
ds_read_b64_tr_b16 a[76:77], v13 offset:16384
v_mfma_f32_16x16x32_bf16 v[116:119], a[12:15], a[44:47], v[116:119]
ds_read_b64_tr_b16 a[78:79], v13 offset:16896
v_mfma_f32_16x16x32_bf16 v[48:51], a[0:3], a[48:51], v[48:51]
v_mfma_f32_16x16x32_bf16 v[72:75], a[4:7], a[48:51], v[72:75]
v_mfma_f32_16x16x32_bf16 v[96:99], a[8:11], a[48:51], v[96:99]
v_mfma_f32_16x16x32_bf16 v[120:123], a[12:15], a[48:51], v[120:123]
v_mfma_f32_16x16x32_bf16 v[52:55], a[0:3], a[52:55], v[52:55]
v_mfma_f32_16x16x32_bf16 v[76:79], a[4:7], a[52:55], v[76:79]
v_mfma_f32_16x16x32_bf16 v[100:103], a[8:11], a[52:55], v[100:103]
v_mfma_f32_16x16x32_bf16 v[124:127], a[12:15], a[52:55], v[124:127]
s_waitcnt lgkmcnt(0)
v_mfma_f32_16x16x32_bf16 v[40:43], a[16:19], a[64:67], v[40:43]
s_barrier
ds_read_b128 v[20:23], v17 offset:0
v_mfma_f32_16x16x32_bf16 v[64:67], a[20:23], a[64:67], v[64:67]
ds_read_b128 v[24:27], v17 offset:512
v_mfma_f32_16x16x32_bf16 v[88:91], a[24:27], a[64:67], v[88:91]
ds_read_b32 v6, v18 offset:256
v_mfma_f32_16x16x32_bf16 v[112:115], a[28:31], a[64:67], v[112:115]
ds_read_b32 v8, v18 offset:320
v_mfma_f32_16x16x32_bf16 v[44:47], a[16:19], a[68:71], v[44:47]
ds_read_b32 v10, v18 offset:512
v_mfma_f32_16x16x32_bf16 v[68:71], a[20:23], a[68:71], v[68:71]
ds_read_b32 v18, v18 offset:576
v_mfma_f32_16x16x32_bf16 v[92:95], a[24:27], a[68:71], v[92:95]
v_mov_b32 v19, 161536
ds_read_b32 v19, v19
v_mfma_f32_16x16x32_bf16 v[116:119], a[28:31], a[68:71], v[116:119]
ds_read_b128 v[128:131], v17 offset:64
v_mfma_f32_16x16x32_bf16 v[48:51], a[16:19], a[72:75], v[48:51]
ds_read_b128 v[132:135], v17 offset:576
v_mfma_f32_16x16x32_bf16 v[72:75], a[20:23], a[72:75], v[72:75]
ds_read_b128 v[136:139], v17 offset:128
v_mfma_f32_16x16x32_bf16 v[96:99], a[24:27], a[72:75], v[96:99]
ds_read_b128 v[140:143], v17 offset:640
v_mfma_f32_16x16x32_bf16 v[120:123], a[28:31], a[72:75], v[120:123]
ds_read_b128 v[144:147], v17 offset:192
v_mfma_f32_16x16x32_bf16 v[52:55], a[16:19], a[76:79], v[52:55]
ds_read_b128 v[148:151], v17 offset:704
v_mfma_f32_16x16x32_bf16 v[76:79], a[20:23], a[76:79], v[76:79]
v_mfma_f32_16x16x32_bf16 v[100:103], a[24:27], a[76:79], v[100:103]
v_mfma_f32_16x16x32_bf16 v[124:127], a[28:31], a[76:79], v[124:127]
v_mfma_f32_16x16x32_bf16 v[32:35], a[56:59], a[16:19], v[32:35]
v_mfma_f32_16x16x32_bf16 v[56:59], a[56:59], a[20:23], v[56:59]
v_mfma_f32_16x16x32_bf16 v[80:83], a[56:59], a[24:27], v[80:83]
v_mfma_f32_16x16x32_bf16 v[104:107], a[56:59], a[28:31], v[104:107]
v_mfma_f32_16x16x32_bf16 v[36:39], a[60:63], a[16:19], v[36:39]
v_mfma_f32_16x16x32_bf16 v[60:63], a[60:63], a[20:23], v[60:63]
v_mfma_f32_16x16x32_bf16 v[84:87], a[60:63], a[24:27], v[84:87]
v_mfma_f32_16x16x32_bf16 v[108:111], a[60:63], a[28:31], v[108:111]
s_waitcnt lgkmcnt(0)
v_readfirstlane_b32 s69, v19
v_pk_mul_f32 v[28:29], v[24:25], s[90:91]
v_pk_mul_f32 v[30:31], v[26:27], s[90:91]
v_pk_fma_f32 v[40:41], v[20:21], v[6:7], v[40:41] op_sel:[0,0,0] op_sel_hi:[1,0,1]
v_pk_fma_f32 v[44:45], v[20:21], v[8:9], v[44:45] op_sel:[0,0,0] op_sel_hi:[1,0,1]
v_pk_fma_f32 v[42:43], v[22:23], v[6:7], v[42:43] op_sel:[0,0,0] op_sel_hi:[1,0,1]
v_pk_fma_f32 v[46:47], v[22:23], v[8:9], v[46:47] op_sel:[0,0,0] op_sel_hi:[1,0,1]
v_pk_mul_f32 v[2:3], v[40:41], v[28:29]
v_pk_mul_f32 v[12:13], v[44:45], v[28:29]
v_pk_mul_f32 v[4:5], v[42:43], v[30:31]
v_pk_mul_f32 v[14:15], v[46:47], v[30:31]
v_pk_fma_f32 v[40:41], v[40:41], v[24:25], s[82:83]
v_pk_fma_f32 v[44:45], v[44:45], v[24:25], s[82:83]
v_pk_fma_f32 v[42:43], v[42:43], v[26:27], s[82:83]
v_pk_fma_f32 v[46:47], v[46:47], v[26:27], s[82:83]
v_exp_f32_e64 v2, v2 clamp
v_exp_f32_e64 v12, v12 clamp
v_exp_f32_e64 v3, v3 clamp
v_exp_f32_e64 v13, v13 clamp
v_exp_f32_e64 v4, v4 clamp
v_exp_f32_e64 v14, v14 clamp
v_exp_f32_e64 v5, v5 clamp
v_exp_f32_e64 v15, v15 clamp
v_pk_add_f32 v[2:3], v[2:3], s[80:81]
v_pk_add_f32 v[12:13], v[12:13], s[80:81]
v_pk_add_f32 v[4:5], v[4:5], s[80:81]
v_pk_add_f32 v[14:15], v[14:15], s[80:81]
v_max_f32 v40, v40, v2
v_max_f32 v44, v44, v12
v_max_f32 v41, v41, v3
v_max_f32 v45, v45, v13
v_max_f32 v42, v42, v4
v_max_f32 v46, v46, v14
v_max_f32 v43, v43, v5
v_max_f32 v47, v47, v15
v_cvt_pk_bf16_f32 v40, v40, v41
v_cvt_pk_bf16_f32 v44, v44, v45
v_cvt_pk_bf16_f32 v41, v42, v43
v_cvt_pk_bf16_f32 v45, v46, v47
v_pk_fma_f32 v[48:49], v[20:21], v[10:11], v[48:49] op_sel:[0,0,0] op_sel_hi:[1,0,1]
v_pk_fma_f32 v[52:53], v[20:21], v[18:19], v[52:53] op_sel:[0,0,0] op_sel_hi:[1,0,1]
v_pk_fma_f32 v[50:51], v[22:23], v[10:11], v[50:51] op_sel:[0,0,0] op_sel_hi:[1,0,1]
v_pk_fma_f32 v[54:55], v[22:23], v[18:19], v[54:55] op_sel:[0,0,0] op_sel_hi:[1,0,1]
v_pk_mul_f32 v[48:49], v[48:49], v[24:25]
v_pk_mul_f32 v[52:53], v[52:53], v[24:25]
v_pk_mul_f32 v[50:51], v[50:51], v[26:27]
v_pk_mul_f32 v[54:55], v[54:55], v[26:27]
v_cvt_pk_bf16_f32 v48, v48, v49
v_cvt_pk_bf16_f32 v52, v52, v53
v_cvt_pk_bf16_f32 v49, v50, v51
v_cvt_pk_bf16_f32 v53, v54, v55
v_pk_mul_f32 v[28:29], v[132:133], s[90:91]
v_pk_mul_f32 v[30:31], v[134:135], s[90:91]
v_pk_fma_f32 v[64:65], v[128:129], v[6:7], v[64:65] op_sel:[0,0,0] op_sel_hi:[1,0,1]
v_pk_fma_f32 v[68:69], v[128:129], v[8:9], v[68:69] op_sel:[0,0,0] op_sel_hi:[1,0,1]
v_pk_fma_f32 v[66:67], v[130:131], v[6:7], v[66:67] op_sel:[0,0,0] op_sel_hi:[1,0,1]
v_pk_fma_f32 v[70:71], v[130:131], v[8:9], v[70:71] op_sel:[0,0,0] op_sel_hi:[1,0,1]
v_pk_mul_f32 v[2:3], v[64:65], v[28:29]
v_pk_mul_f32 v[12:13], v[68:69], v[28:29]
v_pk_mul_f32 v[4:5], v[66:67], v[30:31]
v_pk_mul_f32 v[14:15], v[70:71], v[30:31]
v_pk_fma_f32 v[64:65], v[64:65], v[132:133], s[82:83]
v_pk_fma_f32 v[68:69], v[68:69], v[132:133], s[82:83]
v_pk_fma_f32 v[66:67], v[66:67], v[134:135], s[82:83]
v_pk_fma_f32 v[70:71], v[70:71], v[134:135], s[82:83]
v_exp_f32_e64 v2, v2 clamp
v_exp_f32_e64 v12, v12 clamp
v_exp_f32_e64 v3, v3 clamp
v_exp_f32_e64 v13, v13 clamp
v_exp_f32_e64 v4, v4 clamp
v_exp_f32_e64 v14, v14 clamp
v_exp_f32_e64 v5, v5 clamp
v_exp_f32_e64 v15, v15 clamp
v_pk_add_f32 v[2:3], v[2:3], s[80:81]
v_pk_add_f32 v[12:13], v[12:13], s[80:81]
v_pk_add_f32 v[4:5], v[4:5], s[80:81]
v_pk_add_f32 v[14:15], v[14:15], s[80:81]
v_max_f32 v64, v64, v2
v_max_f32 v68, v68, v12
v_max_f32 v65, v65, v3
v_max_f32 v69, v69, v13
v_max_f32 v66, v66, v4
v_max_f32 v70, v70, v14
v_max_f32 v67, v67, v5
v_max_f32 v71, v71, v15
v_cvt_pk_bf16_f32 v42, v64, v65
v_cvt_pk_bf16_f32 v46, v68, v69
v_cvt_pk_bf16_f32 v43, v66, v67
v_cvt_pk_bf16_f32 v47, v70, v71
v_pk_fma_f32 v[72:73], v[128:129], v[10:11], v[72:73] op_sel:[0,0,0] op_sel_hi:[1,0,1]
v_pk_fma_f32 v[76:77], v[128:129], v[18:19], v[76:77] op_sel:[0,0,0] op_sel_hi:[1,0,1]
v_pk_fma_f32 v[74:75], v[130:131], v[10:11], v[74:75] op_sel:[0,0,0] op_sel_hi:[1,0,1]
v_pk_fma_f32 v[78:79], v[130:131], v[18:19], v[78:79] op_sel:[0,0,0] op_sel_hi:[1,0,1]
v_pk_mul_f32 v[72:73], v[72:73], v[132:133]
v_pk_mul_f32 v[76:77], v[76:77], v[132:133]
v_pk_mul_f32 v[74:75], v[74:75], v[134:135]
v_pk_mul_f32 v[78:79], v[78:79], v[134:135]
v_cvt_pk_bf16_f32 v50, v72, v73
v_cvt_pk_bf16_f32 v54, v76, v77
v_cvt_pk_bf16_f32 v51, v74, v75
v_cvt_pk_bf16_f32 v55, v78, v79
s_nop 0
v_mfma_f32_16x16x32_bf16 v[64:67], v[40:43], v[48:51], 0
v_mfma_f32_16x16x32_bf16 v[68:71], v[40:43], v[52:55], 0
v_mfma_f32_16x16x32_bf16 v[20:23], v[40:43], a[80:83], 0
v_mfma_f32_16x16x32_bf16 v[72:75], v[44:47], v[48:51], 0
v_mfma_f32_16x16x32_bf16 v[76:79], v[44:47], v[52:55], 0
v_mfma_f32_16x16x32_bf16 v[24:27], v[44:47], a[80:83], 0
v_pk_mul_f32 v[28:29], v[140:141], s[90:91]
v_pk_mul_f32 v[30:31], v[142:143], s[90:91]
v_pk_fma_f32 v[88:89], v[136:137], v[6:7], v[88:89] op_sel:[0,0,0] op_sel_hi:[1,0,1]
v_pk_fma_f32 v[92:93], v[136:137], v[8:9], v[92:93] op_sel:[0,0,0] op_sel_hi:[1,0,1]
v_pk_fma_f32 v[90:91], v[138:139], v[6:7], v[90:91] op_sel:[0,0,0] op_sel_hi:[1,0,1]
v_pk_fma_f32 v[94:95], v[138:139], v[8:9], v[94:95] op_sel:[0,0,0] op_sel_hi:[1,0,1]
v_pk_mul_f32 v[2:3], v[88:89], v[28:29]
v_pk_mul_f32 v[12:13], v[92:93], v[28:29]
v_pk_mul_f32 v[4:5], v[90:91], v[30:31]
v_pk_mul_f32 v[14:15], v[94:95], v[30:31]
v_pk_fma_f32 v[88:89], v[88:89], v[140:141], s[82:83]
v_pk_fma_f32 v[92:93], v[92:93], v[140:141], s[82:83]
v_pk_fma_f32 v[90:91], v[90:91], v[142:143], s[82:83]
v_pk_fma_f32 v[94:95], v[94:95], v[142:143], s[82:83]
v_exp_f32_e64 v2, v2 clamp
v_exp_f32_e64 v12, v12 clamp
v_exp_f32_e64 v3, v3 clamp
v_exp_f32_e64 v13, v13 clamp
v_exp_f32_e64 v4, v4 clamp
v_exp_f32_e64 v14, v14 clamp
v_exp_f32_e64 v5, v5 clamp
v_exp_f32_e64 v15, v15 clamp
v_pk_add_f32 v[2:3], v[2:3], s[80:81]
v_pk_add_f32 v[12:13], v[12:13], s[80:81]
v_pk_add_f32 v[4:5], v[4:5], s[80:81]
v_pk_add_f32 v[14:15], v[14:15], s[80:81]
v_max_f32 v88, v88, v2
v_max_f32 v92, v92, v12
v_max_f32 v89, v89, v3
v_max_f32 v93, v93, v13
v_max_f32 v90, v90, v4
v_max_f32 v94, v94, v14
v_max_f32 v91, v91, v5
v_max_f32 v95, v95, v15
v_cvt_pk_bf16_f32 v88, v88, v89
v_cvt_pk_bf16_f32 v92, v92, v93
v_cvt_pk_bf16_f32 v89, v90, v91
v_cvt_pk_bf16_f32 v93, v94, v95
v_pk_fma_f32 v[96:97], v[136:137], v[10:11], v[96:97] op_sel:[0,0,0] op_sel_hi:[1,0,1]
v_pk_fma_f32 v[100:101], v[136:137], v[18:19], v[100:101] op_sel:[0,0,0] op_sel_hi:[1,0,1]
v_pk_fma_f32 v[98:99], v[138:139], v[10:11], v[98:99] op_sel:[0,0,0] op_sel_hi:[1,0,1]
v_pk_fma_f32 v[102:103], v[138:139], v[18:19], v[102:103] op_sel:[0,0,0] op_sel_hi:[1,0,1]
v_pk_mul_f32 v[96:97], v[96:97], v[140:141]
v_pk_mul_f32 v[100:101], v[100:101], v[140:141]
v_pk_mul_f32 v[98:99], v[98:99], v[142:143]
v_pk_mul_f32 v[102:103], v[102:103], v[142:143]
v_cvt_pk_bf16_f32 v96, v96, v97
v_cvt_pk_bf16_f32 v100, v100, v101
v_cvt_pk_bf16_f32 v97, v98, v99
v_cvt_pk_bf16_f32 v101, v102, v103
v_pk_mul_f32 v[28:29], v[148:149], s[90:91]
v_pk_mul_f32 v[30:31], v[150:151], s[90:91]
v_pk_fma_f32 v[112:113], v[144:145], v[6:7], v[112:113] op_sel:[0,0,0] op_sel_hi:[1,0,1]
v_pk_fma_f32 v[116:117], v[144:145], v[8:9], v[116:117] op_sel:[0,0,0] op_sel_hi:[1,0,1]
v_pk_fma_f32 v[114:115], v[146:147], v[6:7], v[114:115] op_sel:[0,0,0] op_sel_hi:[1,0,1]
v_pk_fma_f32 v[118:119], v[146:147], v[8:9], v[118:119] op_sel:[0,0,0] op_sel_hi:[1,0,1]
v_pk_mul_f32 v[2:3], v[112:113], v[28:29]
v_pk_mul_f32 v[12:13], v[116:117], v[28:29]
v_pk_mul_f32 v[4:5], v[114:115], v[30:31]
v_pk_mul_f32 v[14:15], v[118:119], v[30:31]
v_pk_fma_f32 v[112:113], v[112:113], v[148:149], s[82:83]
v_pk_fma_f32 v[116:117], v[116:117], v[148:149], s[82:83]
v_pk_fma_f32 v[114:115], v[114:115], v[150:151], s[82:83]
v_pk_fma_f32 v[118:119], v[118:119], v[150:151], s[82:83]
v_exp_f32_e64 v2, v2 clamp
v_exp_f32_e64 v12, v12 clamp
v_exp_f32_e64 v3, v3 clamp
v_exp_f32_e64 v13, v13 clamp
v_exp_f32_e64 v4, v4 clamp
v_exp_f32_e64 v14, v14 clamp
v_exp_f32_e64 v5, v5 clamp
v_exp_f32_e64 v15, v15 clamp
v_pk_add_f32 v[2:3], v[2:3], s[80:81]
v_pk_add_f32 v[12:13], v[12:13], s[80:81]
v_pk_add_f32 v[4:5], v[4:5], s[80:81]
v_pk_add_f32 v[14:15], v[14:15], s[80:81]
v_max_f32 v112, v112, v2
v_max_f32 v116, v116, v12
v_max_f32 v113, v113, v3
v_max_f32 v117, v117, v13
v_max_f32 v114, v114, v4
v_max_f32 v118, v118, v14
v_max_f32 v115, v115, v5
v_max_f32 v119, v119, v15
v_cvt_pk_bf16_f32 v90, v112, v113
v_cvt_pk_bf16_f32 v94, v116, v117
v_cvt_pk_bf16_f32 v91, v114, v115
v_cvt_pk_bf16_f32 v95, v118, v119
v_pk_fma_f32 v[120:121], v[144:145], v[10:11], v[120:121] op_sel:[0,0,0] op_sel_hi:[1,0,1]
v_pk_fma_f32 v[124:125], v[144:145], v[18:19], v[124:125] op_sel:[0,0,0] op_sel_hi:[1,0,1]
v_pk_fma_f32 v[122:123], v[146:147], v[10:11], v[122:123] op_sel:[0,0,0] op_sel_hi:[1,0,1]
v_pk_fma_f32 v[126:127], v[146:147], v[18:19], v[126:127] op_sel:[0,0,0] op_sel_hi:[1,0,1]
v_pk_mul_f32 v[120:121], v[120:121], v[148:149]
v_pk_mul_f32 v[124:125], v[124:125], v[148:149]
v_pk_mul_f32 v[122:123], v[122:123], v[150:151]
v_pk_mul_f32 v[126:127], v[126:127], v[150:151]
v_cvt_pk_bf16_f32 v98, v120, v121
v_cvt_pk_bf16_f32 v102, v124, v125
v_cvt_pk_bf16_f32 v99, v122, v123
v_cvt_pk_bf16_f32 v103, v126, v127
s_nop 0
v_mfma_f32_16x16x32_bf16 v[64:67], v[88:91], v[96:99], v[64:67]
v_mfma_f32_16x16x32_bf16 v[68:71], v[88:91], v[100:103], v[68:71]
v_mfma_f32_16x16x32_bf16 v[20:23], v[88:91], a[80:83], v[20:23]
v_mfma_f32_16x16x32_bf16 v[72:75], v[92:95], v[96:99], v[72:75]
v_mfma_f32_16x16x32_bf16 v[76:79], v[92:95], v[100:103], v[76:79]
v_mfma_f32_16x16x32_bf16 v[24:27], v[92:95], a[80:83], v[24:27]
s_lshl_b32 s70, s60, 11
s_add_u32 s70, s70, 16384
v_add_u32 v2, s70, v16
v_xor_b32 v3, 4096, v2
v_lshrrev_b32 v4, 4, v1
v_lshlrev_b32 v5, 4, v4
v_lshlrev_b32 v4, 5, v4
s_lshl_b32 s70, s60, 6
s_add_u32 s70, s70, 163584
v_add_u32 v5, s70, v5
v_xor_b32 v6, 128, v5
s_lshl_b32 s72, s67, 1
s_add_u32 s72, s72, s66
s_lshl_b32 s72, s72, 10
s_add_u32 s72, s72, s87
s_lshl_b32 s73, s67, 7
s_lshl_b32 s70, s66, 4
s_add_u32 s73, s73, s70
s_add_u32 s73, s73, s87
s_add_u32 s73, s73, 4096
s_mov_b32 s92, 0x00010001
s_mov_b32 s93, 0x00010001
v_mov_b32 v15, s68
s_cmp_eq_u32 s66, 0
s_cbranch_scc0 L_ex1
ds_write_b128 v2, v[68:71]
ds_write_b128 v2, v[76:79] offset:1024
ds_write_b128 v5, v[24:27]
s_waitcnt lgkmcnt(0)
s_barrier
ds_read_b128 v[128:131], v3
ds_read_b128 v[132:135], v3 offset:1024
ds_read_b128 v[136:139], v6
s_waitcnt lgkmcnt(1)
v_pk_add_f32 v[128:129], v[128:129], v[64:65]
v_pk_add_f32 v[130:131], v[130:131], v[66:67]
v_pk_add_f32 v[132:133], v[132:133], v[72:73]
v_pk_add_f32 v[134:135], v[134:135], v[74:75]
s_waitcnt lgkmcnt(0)
v_pk_add_f32 v[136:137], v[136:137], v[20:21]
v_pk_add_f32 v[138:139], v[138:139], v[22:23]
s_branch L_ex_d
L_ex1:
ds_write_b128 v2, v[64:67]
ds_write_b128 v2, v[72:75] offset:1024
ds_write_b128 v5, v[20:23]
s_waitcnt lgkmcnt(0)
s_barrier
ds_read_b128 v[128:131], v3
ds_read_b128 v[132:135], v3 offset:1024
ds_read_b128 v[136:139], v6
s_waitcnt lgkmcnt(1)
v_pk_add_f32 v[128:129], v[128:129], v[68:69]
v_pk_add_f32 v[130:131], v[130:131], v[70:71]
v_pk_add_f32 v[132:133], v[132:133], v[76:77]
v_pk_add_f32 v[134:135], v[134:135], v[78:79]
s_waitcnt lgkmcnt(0)
v_pk_add_f32 v[136:137], v[136:137], v[24:25]
v_pk_add_f32 v[138:139], v[138:139], v[26:27]
L_ex_d:
v_cvt_pk_bf16_f32 v140, v128, v129
v_cvt_pk_bf16_f32 v141, v130, v131
v_cvt_pk_bf16_f32 v142, v132, v133
v_cvt_pk_bf16_f32 v143, v134, v135
v_bfi_b32 v136, s85, v15, v136
v_bfi_b32 v137, s85, v15, v137
v_bfi_b32 v138, s85, v15, v138
v_bfi_b32 v139, s85, v15, v139
s_cmp_eq_u32 s69, 0
s_cbranch_scc1 L_kvp_s
buffer_store_dwordx4 v[140:143], v16, s[12:15], s72 offen
s_mov_b64 exec, s[92:93]
buffer_store_dwordx4 v[136:139], v4, s[12:15], s73 offen
s_mov_b64 exec, -1
L_kvp_d:
v_and_b32 v2, 15, v1
v_lshlrev_b32 v2, 2, v2
s_lshl_b32 s70, s66, 8
s_add_u32 s70, s70, 159744
v_add_u32 v2, s70, v2
v_lshrrev_b32 v3, 4, v1
v_lshlrev_b32 v3, 4, v3
s_lshl_b32 s70, s67, 7
s_add_u32 s70, s70, 160768
v_add_u32 v5, s70, v3
ds_read_b32 v8, v2 offset:0
ds_read_b32 v128, v2 offset:512
ds_read_b32 v10, v2 offset:64
ds_read_b32 v130, v2 offset:576
ds_read_b32 v12, v2 offset:128
ds_read_b32 v132, v2 offset:640
ds_read_b32 v14, v2 offset:192
ds_read_b32 v134, v2 offset:704
ds_read_b128 v[144:147], v5 offset:0
ds_read_b128 v[148:151], v5 offset:64
s_lshl_b32 s70, s67, 11
s_add_u32 s70, s70, 24576
v_add_u32 v17, s70, v16
s_lshl_b32 s70, s67, 6
s_add_u32 s70, s70, 161600
v_add_u32 v18, s70, v3
s_waitcnt lgkmcnt(0)
v_mul_f32 v20, s90, v128
v_mul_f32 v22, s90, v130
v_mul_f32 v4, s90, v132
v_mul_f32 v6, s90, v134
v_pk_fma_f32 v[32:33], v[144:145], v[8:9], v[32:33] op_sel:[0,0,0] op_sel_hi:[1,0,1]
v_pk_fma_f32 v[36:37], v[148:149], v[8:9], v[36:37] op_sel:[0,0,0] op_sel_hi:[1,0,1]
v_pk_fma_f32 v[34:35], v[146:147], v[8:9], v[34:35] op_sel:[0,0,0] op_sel_hi:[1,0,1]
v_pk_fma_f32 v[38:39], v[150:151], v[8:9], v[38:39] op_sel:[0,0,0] op_sel_hi:[1,0,1]
v_pk_mul_f32 v[24:25], v[32:33], v[20:21] op_sel:[0,0] op_sel_hi:[1,0]
v_pk_mul_f32 v[28:29], v[36:37], v[20:21] op_sel:[0,0] op_sel_hi:[1,0]
v_pk_mul_f32 v[26:27], v[34:35], v[20:21] op_sel:[0,0] op_sel_hi:[1,0]
v_pk_mul_f32 v[30:31], v[38:39], v[20:21] op_sel:[0,0] op_sel_hi:[1,0]
v_pk_fma_f32 v[32:33], v[32:33], v[128:129], s[82:83] op_sel:[0,0,0] op_sel_hi:[1,0,1]
v_pk_fma_f32 v[36:37], v[36:37], v[128:129], s[82:83] op_sel:[0,0,0] op_sel_hi:[1,0,1]
v_pk_fma_f32 v[34:35], v[34:35], v[128:129], s[82:83] op_sel:[0,0,0] op_sel_hi:[1,0,1]
v_pk_fma_f32 v[38:39], v[38:39], v[128:129], s[82:83] op_sel:[0,0,0] op_sel_hi:[1,0,1]
v_exp_f32_e64 v24, v24 clamp
v_exp_f32_e64 v28, v28 clamp
v_exp_f32_e64 v25, v25 clamp
v_exp_f32_e64 v29, v29 clamp
v_exp_f32_e64 v26, v26 clamp
v_exp_f32_e64 v30, v30 clamp
v_exp_f32_e64 v27, v27 clamp
v_exp_f32_e64 v31, v31 clamp
v_pk_add_f32 v[24:25], v[24:25], s[80:81]
v_pk_add_f32 v[28:29], v[28:29], s[80:81]
v_pk_add_f32 v[26:27], v[26:27], s[80:81]
v_pk_add_f32 v[30:31], v[30:31], s[80:81]
v_max_f32 v32, v32, v24
v_max_f32 v36, v36, v28
v_max_f32 v33, v33, v25
v_max_f32 v37, v37, v29
v_max_f32 v34, v34, v26
v_max_f32 v38, v38, v30
v_max_f32 v35, v35, v27
v_max_f32 v39, v39, v31
v_cvt_pk_bf16_f32 v32, v32, v33
v_cvt_pk_bf16_f32 v33, v34, v35
v_cvt_pk_bf16_f32 v34, v36, v37
v_cvt_pk_bf16_f32 v35, v38, v39
v_pk_fma_f32 v[56:57], v[144:145], v[10:11], v[56:57] op_sel:[0,0,0] op_sel_hi:[1,0,1]
v_pk_fma_f32 v[60:61], v[148:149], v[10:11], v[60:61] op_sel:[0,0,0] op_sel_hi:[1,0,1]
v_pk_fma_f32 v[58:59], v[146:147], v[10:11], v[58:59] op_sel:[0,0,0] op_sel_hi:[1,0,1]
v_pk_fma_f32 v[62:63], v[150:151], v[10:11], v[62:63] op_sel:[0,0,0] op_sel_hi:[1,0,1]
v_pk_mul_f32 v[24:25], v[56:57], v[22:23] op_sel:[0,0] op_sel_hi:[1,0]
v_pk_mul_f32 v[28:29], v[60:61], v[22:23] op_sel:[0,0] op_sel_hi:[1,0]
v_pk_mul_f32 v[26:27], v[58:59], v[22:23] op_sel:[0,0] op_sel_hi:[1,0]
v_pk_mul_f32 v[30:31], v[62:63], v[22:23] op_sel:[0,0] op_sel_hi:[1,0]
v_pk_fma_f32 v[56:57], v[56:57], v[130:131], s[82:83] op_sel:[0,0,0] op_sel_hi:[1,0,1]
v_pk_fma_f32 v[60:61], v[60:61], v[130:131], s[82:83] op_sel:[0,0,0] op_sel_hi:[1,0,1]
v_pk_fma_f32 v[58:59], v[58:59], v[130:131], s[82:83] op_sel:[0,0,0] op_sel_hi:[1,0,1]
v_pk_fma_f32 v[62:63], v[62:63], v[130:131], s[82:83] op_sel:[0,0,0] op_sel_hi:[1,0,1]
v_exp_f32_e64 v24, v24 clamp
v_exp_f32_e64 v28, v28 clamp
v_exp_f32_e64 v25, v25 clamp
v_exp_f32_e64 v29, v29 clamp
v_exp_f32_e64 v26, v26 clamp
v_exp_f32_e64 v30, v30 clamp
v_exp_f32_e64 v27, v27 clamp
v_exp_f32_e64 v31, v31 clamp
v_pk_add_f32 v[24:25], v[24:25], s[80:81]
v_pk_add_f32 v[28:29], v[28:29], s[80:81]
v_pk_add_f32 v[26:27], v[26:27], s[80:81]
v_pk_add_f32 v[30:31], v[30:31], s[80:81]
v_max_f32 v56, v56, v24
v_max_f32 v60, v60, v28
v_max_f32 v57, v57, v25
v_max_f32 v61, v61, v29
v_max_f32 v58, v58, v26
v_max_f32 v62, v62, v30
v_max_f32 v59, v59, v27
v_max_f32 v63, v63, v31
v_cvt_pk_bf16_f32 v56, v56, v57
v_cvt_pk_bf16_f32 v57, v58, v59
v_cvt_pk_bf16_f32 v58, v60, v61
v_cvt_pk_bf16_f32 v59, v62, v63
v_pk_fma_f32 v[80:81], v[144:145], v[12:13], v[80:81] op_sel:[0,0,0] op_sel_hi:[1,0,1]
v_pk_fma_f32 v[84:85], v[148:149], v[12:13], v[84:85] op_sel:[0,0,0] op_sel_hi:[1,0,1]
v_pk_fma_f32 v[82:83], v[146:147], v[12:13], v[82:83] op_sel:[0,0,0] op_sel_hi:[1,0,1]
v_pk_fma_f32 v[86:87], v[150:151], v[12:13], v[86:87] op_sel:[0,0,0] op_sel_hi:[1,0,1]
v_pk_mul_f32 v[24:25], v[80:81], v[4:5] op_sel:[0,0] op_sel_hi:[1,0]
v_pk_mul_f32 v[28:29], v[84:85], v[4:5] op_sel:[0,0] op_sel_hi:[1,0]
v_pk_mul_f32 v[26:27], v[82:83], v[4:5] op_sel:[0,0] op_sel_hi:[1,0]
v_pk_mul_f32 v[30:31], v[86:87], v[4:5] op_sel:[0,0] op_sel_hi:[1,0]
v_pk_fma_f32 v[80:81], v[80:81], v[132:133], s[82:83] op_sel:[0,0,0] op_sel_hi:[1,0,1]
v_pk_fma_f32 v[84:85], v[84:85], v[132:133], s[82:83] op_sel:[0,0,0] op_sel_hi:[1,0,1]
v_pk_fma_f32 v[82:83], v[82:83], v[132:133], s[82:83] op_sel:[0,0,0] op_sel_hi:[1,0,1]
v_pk_fma_f32 v[86:87], v[86:87], v[132:133], s[82:83] op_sel:[0,0,0] op_sel_hi:[1,0,1]
v_exp_f32_e64 v24, v24 clamp
v_exp_f32_e64 v28, v28 clamp
v_exp_f32_e64 v25, v25 clamp
v_exp_f32_e64 v29, v29 clamp
v_exp_f32_e64 v26, v26 clamp
v_exp_f32_e64 v30, v30 clamp
v_exp_f32_e64 v27, v27 clamp
v_exp_f32_e64 v31, v31 clamp
v_pk_add_f32 v[24:25], v[24:25], s[80:81]
v_pk_add_f32 v[28:29], v[28:29], s[80:81]
v_pk_add_f32 v[26:27], v[26:27], s[80:81]
v_pk_add_f32 v[30:31], v[30:31], s[80:81]
v_max_f32 v80, v80, v24
v_max_f32 v84, v84, v28
v_max_f32 v81, v81, v25
v_max_f32 v85, v85, v29
v_max_f32 v82, v82, v26
v_max_f32 v86, v86, v30
v_max_f32 v83, v83, v27
v_max_f32 v87, v87, v31
v_cvt_pk_bf16_f32 v80, v80, v81
v_cvt_pk_bf16_f32 v81, v82, v83
v_cvt_pk_bf16_f32 v82, v84, v85
v_cvt_pk_bf16_f32 v83, v86, v87
v_pk_fma_f32 v[104:105], v[144:145], v[14:15], v[104:105] op_sel:[0,0,0] op_sel_hi:[1,0,1]
v_pk_fma_f32 v[108:109], v[148:149], v[14:15], v[108:109] op_sel:[0,0,0] op_sel_hi:[1,0,1]
v_pk_fma_f32 v[106:107], v[146:147], v[14:15], v[106:107] op_sel:[0,0,0] op_sel_hi:[1,0,1]
v_pk_fma_f32 v[110:111], v[150:151], v[14:15], v[110:111] op_sel:[0,0,0] op_sel_hi:[1,0,1]
v_pk_mul_f32 v[24:25], v[104:105], v[6:7] op_sel:[0,0] op_sel_hi:[1,0]
v_pk_mul_f32 v[28:29], v[108:109], v[6:7] op_sel:[0,0] op_sel_hi:[1,0]
v_pk_mul_f32 v[26:27], v[106:107], v[6:7] op_sel:[0,0] op_sel_hi:[1,0]
v_pk_mul_f32 v[30:31], v[110:111], v[6:7] op_sel:[0,0] op_sel_hi:[1,0]
v_pk_fma_f32 v[104:105], v[104:105], v[134:135], s[82:83] op_sel:[0,0,0] op_sel_hi:[1,0,1]
v_pk_fma_f32 v[108:109], v[108:109], v[134:135], s[82:83] op_sel:[0,0,0] op_sel_hi:[1,0,1]
v_pk_fma_f32 v[106:107], v[106:107], v[134:135], s[82:83] op_sel:[0,0,0] op_sel_hi:[1,0,1]
v_pk_fma_f32 v[110:111], v[110:111], v[134:135], s[82:83] op_sel:[0,0,0] op_sel_hi:[1,0,1]
v_exp_f32_e64 v24, v24 clamp
v_exp_f32_e64 v28, v28 clamp
v_exp_f32_e64 v25, v25 clamp
v_exp_f32_e64 v29, v29 clamp
v_exp_f32_e64 v26, v26 clamp
v_exp_f32_e64 v30, v30 clamp
v_exp_f32_e64 v27, v27 clamp
v_exp_f32_e64 v31, v31 clamp
v_pk_add_f32 v[24:25], v[24:25], s[80:81]
v_pk_add_f32 v[28:29], v[28:29], s[80:81]
v_pk_add_f32 v[26:27], v[26:27], s[80:81]
v_pk_add_f32 v[30:31], v[30:31], s[80:81]
v_max_f32 v104, v104, v24
v_max_f32 v108, v108, v28
v_max_f32 v105, v105, v25
v_max_f32 v109, v109, v29
v_max_f32 v106, v106, v26
v_max_f32 v110, v110, v30
v_max_f32 v107, v107, v27
v_max_f32 v111, v111, v31
v_cvt_pk_bf16_f32 v104, v104, v105
v_cvt_pk_bf16_f32 v105, v106, v107
v_cvt_pk_bf16_f32 v106, v108, v109
v_cvt_pk_bf16_f32 v107, v110, v111
v_lshrrev_b32 v2, 4, v1
v_bfe_u32 v3, v1, 2, 2
v_lshl_add_u32 v4, v2, 2, v3
v_lshlrev_b32 v5, 7, v4
v_bfe_u32 v4, v4, 1, 2
v_lshl_add_u32 v5, v4, 5, v5
v_and_b32 v4, 3, v1
v_lshl_add_u32 v5, v4, 3, v5
v_add_u32 v8, 28672, v5
v_xor_b32 v9, 32, v8
v_xor_b32 v10, 64, v8
v_xor_b32 v11, 96, v8
v_add_u32 v12, 65536, v8
v_add_u32 v13, 65536, v9
v_add_u32 v14, 65536, v10
v_add_u32 v15, 65536, v11
v_and_b32 v3, 15, v1
v_lshrrev_b32 v4, 1, v3
v_lshrrev_b32 v5, 1, v2
v_xor_b32 v4, v4, v5
v_lshlrev_b32 v4, 4, v4
v_lshl_add_u32 v4, v3, 7, v4
v_and_b32 v5, 1, v2
v_lshl_add_u32 v4, v5, 3, v4
s_lshl_b32 s70, s60, 12
v_add_u32 v20, s70, v4
v_xor_b32 v21, 32, v20
v_xor_b32 v22, 64, v20
v_xor_b32 v23, 96, v20
s_lshl_b32 s74, s64, 18
s_lshl_b32 s70, s60, 16
s_add_u32 s74, s74, s70
s_add_u32 s74, s74, 2097152
v_add_u32 v6, s74, v16
v_add_u32 v19, 32768, v6
s_lshl_b32 s74, s89, 11
s_barrier
ds_read_b128 a[0:3], v17
ds_read_b128 a[4:7], v17 offset:1024
ds_read_b128 a[8:11], v18
s_waitcnt lgkmcnt(0)
v_mfma_f32_16x16x32_bf16 v[48:51], a[8:11], v[32:35], 0
v_mfma_f32_16x16x32_bf16 v[40:43], a[0:3], v[32:35], 0
v_mfma_f32_16x16x32_bf16 v[44:47], a[4:7], v[32:35], 0
v_mfma_f32_16x16x32_bf16 v[72:75], a[8:11], v[56:59], 0
v_mfma_f32_16x16x32_bf16 v[64:67], a[0:3], v[56:59], 0
v_mfma_f32_16x16x32_bf16 v[68:71], a[4:7], v[56:59], 0
v_mfma_f32_16x16x32_bf16 v[96:99], a[8:11], v[80:83], 0
v_mfma_f32_16x16x32_bf16 v[88:91], a[0:3], v[80:83], 0
v_mfma_f32_16x16x32_bf16 v[92:95], a[4:7], v[80:83], 0
v_mfma_f32_16x16x32_bf16 v[120:123], a[8:11], v[104:107], 0
v_mfma_f32_16x16x32_bf16 v[112:115], a[0:3], v[104:107], 0
v_mfma_f32_16x16x32_bf16 v[116:119], a[4:7], v[104:107], 0
v_add_f32 v48, s80, v48
v_rcp_f32 v48, v48
s_nop 0
v_pk_mul_f32 v[40:41], v[40:41], v[48:49] op_sel_hi:[1,0]
v_pk_mul_f32 v[42:43], v[42:43], v[48:49] op_sel_hi:[1,0]
v_pk_mul_f32 v[44:45], v[44:45], v[48:49] op_sel_hi:[1,0]
v_pk_mul_f32 v[46:47], v[46:47], v[48:49] op_sel_hi:[1,0]
v_cvt_pk_bf16_f32 v52, v40, v41
v_cvt_pk_bf16_f32 v53, v42, v43
v_cvt_pk_bf16_f32 v54, v44, v45
v_cvt_pk_bf16_f32 v55, v46, v47
s_add_u32 s70, s88, 0
buffer_store_dwordx4 v[52:55], v16, s[12:15], s70 offen sc1
v_add_f32 v72, s80, v72
v_rcp_f32 v72, v72
s_nop 0
v_pk_mul_f32 v[64:65], v[64:65], v[72:73] op_sel_hi:[1,0]
v_pk_mul_f32 v[66:67], v[66:67], v[72:73] op_sel_hi:[1,0]
v_pk_mul_f32 v[68:69], v[68:69], v[72:73] op_sel_hi:[1,0]
v_pk_mul_f32 v[70:71], v[70:71], v[72:73] op_sel_hi:[1,0]
v_cvt_pk_bf16_f32 v76, v64, v65
v_cvt_pk_bf16_f32 v77, v66, v67
v_cvt_pk_bf16_f32 v78, v68, v69
v_cvt_pk_bf16_f32 v79, v70, v71
s_add_u32 s70, s88, 32768
buffer_store_dwordx4 v[76:79], v16, s[12:15], s70 offen sc1
v_add_f32 v96, s80, v96
v_rcp_f32 v96, v96
s_nop 0
v_pk_mul_f32 v[88:89], v[88:89], v[96:97] op_sel_hi:[1,0]
v_pk_mul_f32 v[90:91], v[90:91], v[96:97] op_sel_hi:[1,0]
v_pk_mul_f32 v[92:93], v[92:93], v[96:97] op_sel_hi:[1,0]
v_pk_mul_f32 v[94:95], v[94:95], v[96:97] op_sel_hi:[1,0]
v_cvt_pk_bf16_f32 v100, v88, v89
v_cvt_pk_bf16_f32 v101, v90, v91
v_cvt_pk_bf16_f32 v102, v92, v93
v_cvt_pk_bf16_f32 v103, v94, v95
s_add_u32 s70, s88, 65536
buffer_store_dwordx4 v[100:103], v16, s[12:15], s70 offen sc1
v_add_f32 v120, s80, v120
v_rcp_f32 v120, v120
s_nop 0
v_pk_mul_f32 v[112:113], v[112:113], v[120:121] op_sel_hi:[1,0]
v_pk_mul_f32 v[114:115], v[114:115], v[120:121] op_sel_hi:[1,0]
v_pk_mul_f32 v[116:117], v[116:117], v[120:121] op_sel_hi:[1,0]
v_pk_mul_f32 v[118:119], v[118:119], v[120:121] op_sel_hi:[1,0]
v_cvt_pk_bf16_f32 v124, v112, v113
v_cvt_pk_bf16_f32 v125, v114, v115
v_cvt_pk_bf16_f32 v126, v116, v117
v_cvt_pk_bf16_f32 v127, v118, v119
s_add_u32 s70, s88, 98304
buffer_store_dwordx4 v[124:127], v16, s[12:15], s70 offen sc1
v_xor_b32 v7, s76, v7
ds_read_b64 v[26:27], v20 offset:0
ds_read_b64 v[30:31], v21 offset:0
ds_read_b64 v[34:35], v22 offset:0
ds_read_b64 v[38:39], v23 offset:0
ds_read_b64 v[42:43], v20 offset:2048
ds_read_b64 v[46:47], v21 offset:2048
ds_read_b64 v[50:51], v22 offset:2048
ds_read_b64 v[54:55], v23 offset:2048
s_waitcnt lgkmcnt(0)
ds_read_b64_tr_b16 a[0:1], v8 offset:0
ds_read_b64_tr_b16 a[2:3], v8 offset:2048
ds_read_b64_tr_b16 a[4:5], v9 offset:0
ds_read_b64_tr_b16 a[6:7], v9 offset:2048
ds_read_b64_tr_b16 a[8:9], v10 offset:0
ds_read_b64_tr_b16 a[10:11], v10 offset:2048
ds_read_b64_tr_b16 a[12:13], v11 offset:0
ds_read_b64_tr_b16 a[14:15], v11 offset:2048
ds_read_b64_tr_b16 a[16:17], v8 offset:4096
ds_read_b64_tr_b16 a[18:19], v8 offset:6144
ds_read_b64_tr_b16 a[20:21], v9 offset:4096
ds_read_b64_tr_b16 a[22:23], v9 offset:6144
ds_read_b64_tr_b16 a[24:25], v10 offset:4096
ds_read_b64_tr_b16 a[26:27], v10 offset:6144
ds_read_b64_tr_b16 a[28:29], v11 offset:4096
ds_read_b64_tr_b16 a[30:31], v11 offset:6144
v_lshlrev_b32 v24, 16, v26
v_and_b32 v25, 0xffff0000, v26
v_lshlrev_b32 v26, 16, v27
v_and_b32 v27, 0xffff0000, v27
v_lshlrev_b32 v28, 16, v30
v_and_b32 v29, 0xffff0000, v30
v_lshlrev_b32 v30, 16, v31
v_and_b32 v31, 0xffff0000, v31
v_lshlrev_b32 v32, 16, v34
v_and_b32 v33, 0xffff0000, v34
v_lshlrev_b32 v34, 16, v35
v_and_b32 v35, 0xffff0000, v35
v_lshlrev_b32 v36, 16, v38
v_and_b32 v37, 0xffff0000, v38
v_lshlrev_b32 v38, 16, v39
v_and_b32 v39, 0xffff0000, v39
v_lshlrev_b32 v40, 16, v42
v_and_b32 v41, 0xffff0000, v42
v_lshlrev_b32 v42, 16, v43
v_and_b32 v43, 0xffff0000, v43
v_lshlrev_b32 v44, 16, v46
v_and_b32 v45, 0xffff0000, v46
v_lshlrev_b32 v46, 16, v47
v_and_b32 v47, 0xffff0000, v47
v_lshlrev_b32 v48, 16, v50
v_and_b32 v49, 0xffff0000, v50
v_lshlrev_b32 v50, 16, v51
v_and_b32 v51, 0xffff0000, v51
v_lshlrev_b32 v52, 16, v54
v_and_b32 v53, 0xffff0000, v54
v_lshlrev_b32 v54, 16, v55
v_and_b32 v55, 0xffff0000, v55
v_lshrrev_b32 v2, 4, v1
v_lshlrev_b32 v2, 3, v2
v_add_u32 v2, 162048, v2
v_mov_b32 v3, 162176
ds_read_b64 v[136:137], v2 offset:0
ds_read_b64 v[138:139], v2 offset:32
ds_read_b64 v[140:141], v2 offset:64
ds_read_b64 v[142:143], v2 offset:96
ds_read_b128 v[148:151], v3
s_waitcnt lgkmcnt(0)
v_add_f32 v148, v148, v149
v_add_f32 v150, v150, v151
v_add_f32 v148, v148, v150
s_nop 0
v_readfirstlane_b32 s84, v148
v_and_b32 v2, 3, v1
v_cmp_eq_u32 vcc, 0, v2
v_mov_b32 v3, 0x3f803f80
s_nop 0
v_cndmask_b32 v3, 0, v3, vcc
v_cmp_eq_u32 vcc, 2, v2
s_nop 1
v_cndmask_b32 v120, v3, v136, vcc
v_cndmask_b32 v121, v3, v137, vcc
v_cndmask_b32 v122, v3, v138, vcc
v_cndmask_b32 v123, v3, v139, vcc
v_cndmask_b32 v124, v3, v140, vcc
v_cndmask_b32 v125, v3, v141, vcc
v_cndmask_b32 v126, v3, v142, vcc
v_cndmask_b32 v127, v3, v143, vcc
v_and_b32 v2, 15, v1
v_lshrrev_b32 v3, 5, v1
v_lshlrev_b32 v4, 4, v2
v_mov_b32 v144, v4
s_lshl_b32 s75, s64, 15
s_lshl_b32 s70, s60, 9
s_add_u32 s75, s75, s70
s_add_u32 s75, s75, 6291456
s_lshl_b32 s70, s65, 11
s_add_u32 s72, s75, s70
s_mov_b32 s92, 0x00f0000f
s_mov_b32 s93, 0xf0000f00
s_mov_b32 s80, 0x22222222
s_mov_b32 s81, 0x22222222
s_mov_b32 s82, 0x44444444
s_mov_b32 s83, 0x44444444
s_mov_b32 s90, 0x88888888
s_mov_b32 s91, 0x88888888
v_and_b32 v2, 31, v1
v_lshlrev_b32 v5, 4, v2
v_lshl_add_u32 v145, v3, 11, v5
s_lshl_b32 s70, s64, 7
s_lshl_b32 s71, s60, 5
s_add_u32 s70, s70, s71
s_add_u32 s87, s70, 6815744
s_sub_u32 s70, 2047, s70
v_sub_u32 v146, s70, v2
s_lshl_b32 s70, s64, 2
s_add_u32 s70, s70, s60
s_lshl_b32 s70, s70, 12
s_lshl_b32 s71, s65, 7
s_add_u32 s70, s70, s71
s_add_u32 s88, s70, 7864320
v_lshrrev_b32 v2, 3, v1
v_and_b32 v3, 7, v1
v_lshlrev_b32 v147, 11, v2
v_lshl_add_u32 v147, v3, 4, v147
s_waitcnt vmcnt(0)
buffer_load_dwordx4 v[56:59], v6, s[12:15], s74 offen offset:0 sc1
buffer_load_dwordx4 v[60:63], v19, s[12:15], s74 offen offset:0 sc1
buffer_load_dwordx4 v[64:67], v6, s[12:15], s74 offen offset:1024 sc1
buffer_load_dwordx4 v[68:71], v19, s[12:15], s74 offen offset:1024 sc1
s_add_u32 s74, s74, 2048
s_and_b32 s74, s74, 0x7fff
buffer_load_dwordx4 v[72:75], v6, s[12:15], s74 offen offset:0 sc1
buffer_load_dwordx4 v[76:79], v19, s[12:15], s74 offen offset:0 sc1
buffer_load_dwordx4 v[80:83], v6, s[12:15], s74 offen offset:1024 sc1
buffer_load_dwordx4 v[84:87], v19, s[12:15], s74 offen offset:1024 sc1
s_add_u32 s74, s74, 2048
s_and_b32 s74, s74, 0x7fff
buffer_load_dwordx4 v[88:91], v6, s[12:15], s74 offen offset:0 sc1
buffer_load_dwordx4 v[92:95], v19, s[12:15], s74 offen offset:0 sc1
buffer_load_dwordx4 v[96:99], v6, s[12:15], s74 offen offset:1024 sc1
buffer_load_dwordx4 v[100:103], v19, s[12:15], s74 offen offset:1024 sc1
s_add_u32 s74, s74, 2048
s_and_b32 s74, s74, 0x7fff
s_waitcnt vmcnt(8)
L_o0_chk:
v_max3_u32 v2, v56, v60, v64
v_max_u32 v2, v2, v68
v_cmp_eq_u32 vcc, -1, v2
s_cbranch_vccnz L_o0_rt
L_o0_ok:
s_waitcnt lgkmcnt(8)
v_mfma_f32_16x16x32_bf16 v[24:27], a[0:3], v[56:59], v[24:27]
ds_read_b64_tr_b16 a[32:33], v8 offset:8192
buffer_load_dwordx4 v[104:107], v6, s[12:15], s74 offen offset:0 sc1
v_mfma_f32_16x16x32_bf16 v[40:43], a[0:3], v[60:63], v[40:43]
ds_read_b64_tr_b16 a[34:35], v8 offset:10240
buffer_load_dwordx4 v[108:111], v19, s[12:15], s74 offen offset:0 sc1
v_mfma_f32_16x16x32_bf16 v[28:31], a[4:7], v[56:59], v[28:31]
ds_read_b64_tr_b16 a[36:37], v9 offset:8192
v_mfma_f32_16x16x32_bf16 v[44:47], a[4:7], v[60:63], v[44:47]
ds_read_b64_tr_b16 a[38:39], v9 offset:10240
buffer_load_dwordx4 v[112:115], v6, s[12:15], s74 offen offset:1024 sc1
v_mfma_f32_16x16x32_bf16 v[32:35], a[8:11], v[56:59], v[32:35]
ds_read_b64_tr_b16 a[40:41], v10 offset:8192
buffer_load_dwordx4 v[116:119], v19, s[12:15], s74 offen offset:1024 sc1
v_mfma_f32_16x16x32_bf16 v[48:51], a[8:11], v[60:63], v[48:51]
ds_read_b64_tr_b16 a[42:43], v10 offset:10240
v_mfma_f32_16x16x32_bf16 v[36:39], a[12:15], v[56:59], v[36:39]
ds_read_b64_tr_b16 a[44:45], v11 offset:8192
s_add_u32 s74, s74, 2048
v_mfma_f32_16x16x32_bf16 v[52:55], a[12:15], v[60:63], v[52:55]
ds_read_b64_tr_b16 a[46:47], v11 offset:10240
s_waitcnt lgkmcnt(8)
v_mfma_f32_16x16x32_bf16 v[24:27], a[16:19], v[64:67], v[24:27]
ds_read_b64_tr_b16 a[0:1], v8 offset:12288
s_and_b32 s74, s74, 0x7fff
v_mfma_f32_16x16x32_bf16 v[40:43], a[16:19], v[68:71], v[40:43]
ds_read_b64_tr_b16 a[2:3], v8 offset:14336
s_waitcnt vmcnt(8)
v_mfma_f32_16x16x32_bf16 v[28:31], a[20:23], v[64:67], v[28:31]
ds_read_b64_tr_b16 a[4:5], v9 offset:12288
v_mfma_f32_16x16x32_bf16 v[44:47], a[20:23], v[68:71], v[44:47]
ds_read_b64_tr_b16 a[6:7], v9 offset:14336
v_max3_u32 v2, v72, v76, v80
v_mfma_f32_16x16x32_bf16 v[32:35], a[24:27], v[64:67], v[32:35]
ds_read_b64_tr_b16 a[8:9], v10 offset:12288
v_max_u32 v2, v2, v84
v_mfma_f32_16x16x32_bf16 v[48:51], a[24:27], v[68:71], v[48:51]
ds_read_b64_tr_b16 a[10:11], v10 offset:14336
v_mfma_f32_16x16x32_bf16 v[36:39], a[28:31], v[64:67], v[36:39]
ds_read_b64_tr_b16 a[12:13], v11 offset:12288
v_cmp_eq_u32 vcc, -1, v2
v_mfma_f32_16x16x32_bf16 v[52:55], a[28:31], v[68:71], v[52:55]
ds_read_b64_tr_b16 a[14:15], v11 offset:14336
s_cbranch_vccnz L_o1_rt
L_o1_ok:
s_waitcnt lgkmcnt(8)
v_mfma_f32_16x16x32_bf16 v[24:27], a[32:35], v[72:75], v[24:27]
ds_read_b64_tr_b16 a[16:17], v8 offset:16384
buffer_load_dwordx4 v[56:59], v6, s[12:15], s74 offen offset:0 sc1
v_mfma_f32_16x16x32_bf16 v[40:43], a[32:35], v[76:79], v[40:43]
ds_read_b64_tr_b16 a[18:19], v8 offset:18432
buffer_load_dwordx4 v[60:63], v19, s[12:15], s74 offen offset:0 sc1
v_mfma_f32_16x16x32_bf16 v[28:31], a[36:39], v[72:75], v[28:31]
ds_read_b64_tr_b16 a[20:21], v9 offset:16384
v_mfma_f32_16x16x32_bf16 v[44:47], a[36:39], v[76:79], v[44:47]
ds_read_b64_tr_b16 a[22:23], v9 offset:18432
buffer_load_dwordx4 v[64:67], v6, s[12:15], s74 offen offset:1024 sc1
v_mfma_f32_16x16x32_bf16 v[32:35], a[40:43], v[72:75], v[32:35]
ds_read_b64_tr_b16 a[24:25], v10 offset:16384
buffer_load_dwordx4 v[68:71], v19, s[12:15], s74 offen offset:1024 sc1
v_mfma_f32_16x16x32_bf16 v[48:51], a[40:43], v[76:79], v[48:51]
ds_read_b64_tr_b16 a[26:27], v10 offset:18432
v_mfma_f32_16x16x32_bf16 v[36:39], a[44:47], v[72:75], v[36:39]
ds_read_b64_tr_b16 a[28:29], v11 offset:16384
s_add_u32 s74, s74, 2048
v_mfma_f32_16x16x32_bf16 v[52:55], a[44:47], v[76:79], v[52:55]
ds_read_b64_tr_b16 a[30:31], v11 offset:18432
s_waitcnt lgkmcnt(8)
v_mfma_f32_16x16x32_bf16 v[24:27], a[0:3], v[80:83], v[24:27]
ds_read_b64_tr_b16 a[32:33], v8 offset:20480
s_and_b32 s74, s74, 0x7fff
v_mfma_f32_16x16x32_bf16 v[40:43], a[0:3], v[84:87], v[40:43]
ds_read_b64_tr_b16 a[34:35], v8 offset:22528
s_waitcnt vmcnt(8)
v_mfma_f32_16x16x32_bf16 v[28:31], a[4:7], v[80:83], v[28:31]
ds_read_b64_tr_b16 a[36:37], v9 offset:20480
v_mfma_f32_16x16x32_bf16 v[44:47], a[4:7], v[84:87], v[44:47]
ds_read_b64_tr_b16 a[38:39], v9 offset:22528
v_max3_u32 v2, v88, v92, v96
v_mfma_f32_16x16x32_bf16 v[32:35], a[8:11], v[80:83], v[32:35]
ds_read_b64_tr_b16 a[40:41], v10 offset:20480
v_max_u32 v2, v2, v100
v_mfma_f32_16x16x32_bf16 v[48:51], a[8:11], v[84:87], v[48:51]
ds_read_b64_tr_b16 a[42:43], v10 offset:22528
v_mfma_f32_16x16x32_bf16 v[36:39], a[12:15], v[80:83], v[36:39]
ds_read_b64_tr_b16 a[44:45], v11 offset:20480
v_cmp_eq_u32 vcc, -1, v2
v_mfma_f32_16x16x32_bf16 v[52:55], a[12:15], v[84:87], v[52:55]
ds_read_b64_tr_b16 a[46:47], v11 offset:22528
s_cbranch_vccnz L_o2_rt
L_o2_ok:
s_waitcnt lgkmcnt(8)
v_mfma_f32_16x16x32_bf16 v[24:27], a[16:19], v[88:91], v[24:27]
ds_read_b64_tr_b16 a[0:1], v8 offset:24576
buffer_load_dwordx4 v[72:75], v6, s[12:15], s74 offen offset:0 sc1
v_mfma_f32_16x16x32_bf16 v[40:43], a[16:19], v[92:95], v[40:43]
ds_read_b64_tr_b16 a[2:3], v8 offset:26624
buffer_load_dwordx4 v[76:79], v19, s[12:15], s74 offen offset:0 sc1
v_mfma_f32_16x16x32_bf16 v[28:31], a[20:23], v[88:91], v[28:31]
ds_read_b64_tr_b16 a[4:5], v9 offset:24576
v_mfma_f32_16x16x32_bf16 v[44:47], a[20:23], v[92:95], v[44:47]
ds_read_b64_tr_b16 a[6:7], v9 offset:26624
buffer_load_dwordx4 v[80:83], v6, s[12:15], s74 offen offset:1024 sc1
v_mfma_f32_16x16x32_bf16 v[32:35], a[24:27], v[88:91], v[32:35]
ds_read_b64_tr_b16 a[8:9], v10 offset:24576
buffer_load_dwordx4 v[84:87], v19, s[12:15], s74 offen offset:1024 sc1
v_mfma_f32_16x16x32_bf16 v[48:51], a[24:27], v[92:95], v[48:51]
ds_read_b64_tr_b16 a[10:11], v10 offset:26624
v_mfma_f32_16x16x32_bf16 v[36:39], a[28:31], v[88:91], v[36:39]
ds_read_b64_tr_b16 a[12:13], v11 offset:24576
s_add_u32 s74, s74, 2048
v_mfma_f32_16x16x32_bf16 v[52:55], a[28:31], v[92:95], v[52:55]
ds_read_b64_tr_b16 a[14:15], v11 offset:26624
s_waitcnt lgkmcnt(8)
v_mfma_f32_16x16x32_bf16 v[24:27], a[32:35], v[96:99], v[24:27]
ds_read_b64_tr_b16 a[16:17], v8 offset:28672
s_and_b32 s74, s74, 0x7fff
v_mfma_f32_16x16x32_bf16 v[40:43], a[32:35], v[100:103], v[40:43]
ds_read_b64_tr_b16 a[18:19], v8 offset:30720
s_waitcnt vmcnt(8)
v_mfma_f32_16x16x32_bf16 v[28:31], a[36:39], v[96:99], v[28:31]
ds_read_b64_tr_b16 a[20:21], v9 offset:28672
v_mfma_f32_16x16x32_bf16 v[44:47], a[36:39], v[100:103], v[44:47]
ds_read_b64_tr_b16 a[22:23], v9 offset:30720
v_max3_u32 v2, v104, v108, v112
v_mfma_f32_16x16x32_bf16 v[32:35], a[40:43], v[96:99], v[32:35]
ds_read_b64_tr_b16 a[24:25], v10 offset:28672
v_max_u32 v2, v2, v116
v_mfma_f32_16x16x32_bf16 v[48:51], a[40:43], v[100:103], v[48:51]
ds_read_b64_tr_b16 a[26:27], v10 offset:30720
v_mfma_f32_16x16x32_bf16 v[36:39], a[44:47], v[96:99], v[36:39]
ds_read_b64_tr_b16 a[28:29], v11 offset:28672
v_cmp_eq_u32 vcc, -1, v2
v_mfma_f32_16x16x32_bf16 v[52:55], a[44:47], v[100:103], v[52:55]
ds_read_b64_tr_b16 a[30:31], v11 offset:30720
s_cbranch_vccnz L_o3_rt
L_o3_ok:
s_waitcnt lgkmcnt(8)
v_mfma_f32_16x16x32_bf16 v[24:27], a[0:3], v[104:107], v[24:27]
ds_read_b64_tr_b16 a[32:33], v8 offset:32768
buffer_load_dwordx4 v[88:91], v6, s[12:15], s74 offen offset:0 sc1
v_mfma_f32_16x16x32_bf16 v[40:43], a[0:3], v[108:111], v[40:43]
ds_read_b64_tr_b16 a[34:35], v8 offset:34816
buffer_load_dwordx4 v[92:95], v19, s[12:15], s74 offen offset:0 sc1
v_mfma_f32_16x16x32_bf16 v[28:31], a[4:7], v[104:107], v[28:31]
ds_read_b64_tr_b16 a[36:37], v9 offset:32768
v_mfma_f32_16x16x32_bf16 v[44:47], a[4:7], v[108:111], v[44:47]
ds_read_b64_tr_b16 a[38:39], v9 offset:34816
buffer_load_dwordx4 v[96:99], v6, s[12:15], s74 offen offset:1024 sc1
v_mfma_f32_16x16x32_bf16 v[32:35], a[8:11], v[104:107], v[32:35]
ds_read_b64_tr_b16 a[40:41], v10 offset:32768
buffer_load_dwordx4 v[100:103], v19, s[12:15], s74 offen offset:1024 sc1
v_mfma_f32_16x16x32_bf16 v[48:51], a[8:11], v[108:111], v[48:51]
ds_read_b64_tr_b16 a[42:43], v10 offset:34816
v_mfma_f32_16x16x32_bf16 v[36:39], a[12:15], v[104:107], v[36:39]
ds_read_b64_tr_b16 a[44:45], v11 offset:32768
s_add_u32 s74, s74, 2048
v_mfma_f32_16x16x32_bf16 v[52:55], a[12:15], v[108:111], v[52:55]
ds_read_b64_tr_b16 a[46:47], v11 offset:34816
s_waitcnt lgkmcnt(8)
v_mfma_f32_16x16x32_bf16 v[24:27], a[16:19], v[112:115], v[24:27]
ds_read_b64_tr_b16 a[0:1], v8 offset:36864
s_and_b32 s74, s74, 0x7fff
v_mfma_f32_16x16x32_bf16 v[40:43], a[16:19], v[116:119], v[40:43]
ds_read_b64_tr_b16 a[2:3], v8 offset:38912
s_waitcnt vmcnt(8)
v_mfma_f32_16x16x32_bf16 v[28:31], a[20:23], v[112:115], v[28:31]
ds_read_b64_tr_b16 a[4:5], v9 offset:36864
v_mfma_f32_16x16x32_bf16 v[44:47], a[20:23], v[116:119], v[44:47]
ds_read_b64_tr_b16 a[6:7], v9 offset:38912
v_max3_u32 v2, v56, v60, v64
v_mfma_f32_16x16x32_bf16 v[32:35], a[24:27], v[112:115], v[32:35]
ds_read_b64_tr_b16 a[8:9], v10 offset:36864
v_max_u32 v2, v2, v68
v_mfma_f32_16x16x32_bf16 v[48:51], a[24:27], v[116:119], v[48:51]
ds_read_b64_tr_b16 a[10:11], v10 offset:38912
v_mfma_f32_16x16x32_bf16 v[36:39], a[28:31], v[112:115], v[36:39]
ds_read_b64_tr_b16 a[12:13], v11 offset:36864
v_cmp_eq_u32 vcc, -1, v2
v_mfma_f32_16x16x32_bf16 v[52:55], a[28:31], v[116:119], v[52:55]
ds_read_b64_tr_b16 a[14:15], v11 offset:38912
s_cbranch_vccnz L_o4_rt
L_o4_ok:
s_waitcnt lgkmcnt(8)
v_mfma_f32_16x16x32_bf16 v[24:27], a[32:35], v[56:59], v[24:27]
ds_read_b64_tr_b16 a[16:17], v8 offset:40960
buffer_load_dwordx4 v[104:107], v6, s[12:15], s74 offen offset:0 sc1
v_mfma_f32_16x16x32_bf16 v[40:43], a[32:35], v[60:63], v[40:43]
ds_read_b64_tr_b16 a[18:19], v8 offset:43008
buffer_load_dwordx4 v[108:111], v19, s[12:15], s74 offen offset:0 sc1
v_mfma_f32_16x16x32_bf16 v[28:31], a[36:39], v[56:59], v[28:31]
ds_read_b64_tr_b16 a[20:21], v9 offset:40960
v_mfma_f32_16x16x32_bf16 v[44:47], a[36:39], v[60:63], v[44:47]
ds_read_b64_tr_b16 a[22:23], v9 offset:43008
buffer_load_dwordx4 v[112:115], v6, s[12:15], s74 offen offset:1024 sc1
v_mfma_f32_16x16x32_bf16 v[32:35], a[40:43], v[56:59], v[32:35]
ds_read_b64_tr_b16 a[24:25], v10 offset:40960
buffer_load_dwordx4 v[116:119], v19, s[12:15], s74 offen offset:1024 sc1
v_mfma_f32_16x16x32_bf16 v[48:51], a[40:43], v[60:63], v[48:51]
ds_read_b64_tr_b16 a[26:27], v10 offset:43008
v_mfma_f32_16x16x32_bf16 v[36:39], a[44:47], v[56:59], v[36:39]
ds_read_b64_tr_b16 a[28:29], v11 offset:40960
s_add_u32 s74, s74, 2048
v_mfma_f32_16x16x32_bf16 v[52:55], a[44:47], v[60:63], v[52:55]
ds_read_b64_tr_b16 a[30:31], v11 offset:43008
s_waitcnt lgkmcnt(8)
v_mfma_f32_16x16x32_bf16 v[24:27], a[0:3], v[64:67], v[24:27]
ds_read_b64_tr_b16 a[32:33], v8 offset:45056
s_and_b32 s74, s74, 0x7fff
v_mfma_f32_16x16x32_bf16 v[40:43], a[0:3], v[68:71], v[40:43]
ds_read_b64_tr_b16 a[34:35], v8 offset:47104
s_waitcnt vmcnt(8)
v_mfma_f32_16x16x32_bf16 v[28:31], a[4:7], v[64:67], v[28:31]
ds_read_b64_tr_b16 a[36:37], v9 offset:45056
v_mfma_f32_16x16x32_bf16 v[44:47], a[4:7], v[68:71], v[44:47]
ds_read_b64_tr_b16 a[38:39], v9 offset:47104
v_max3_u32 v2, v72, v76, v80
v_mfma_f32_16x16x32_bf16 v[32:35], a[8:11], v[64:67], v[32:35]
ds_read_b64_tr_b16 a[40:41], v10 offset:45056
v_max_u32 v2, v2, v84
v_mfma_f32_16x16x32_bf16 v[48:51], a[8:11], v[68:71], v[48:51]
ds_read_b64_tr_b16 a[42:43], v10 offset:47104
v_mfma_f32_16x16x32_bf16 v[36:39], a[12:15], v[64:67], v[36:39]
ds_read_b64_tr_b16 a[44:45], v11 offset:45056
v_cmp_eq_u32 vcc, -1, v2
v_mfma_f32_16x16x32_bf16 v[52:55], a[12:15], v[68:71], v[52:55]
ds_read_b64_tr_b16 a[46:47], v11 offset:47104
s_cbranch_vccnz L_o5_rt
L_o5_ok:
s_waitcnt lgkmcnt(8)
v_mfma_f32_16x16x32_bf16 v[24:27], a[16:19], v[72:75], v[24:27]
ds_read_b64_tr_b16 a[0:1], v8 offset:49152
buffer_load_dwordx4 v[56:59], v6, s[12:15], s74 offen offset:0 sc1
v_mfma_f32_16x16x32_bf16 v[40:43], a[16:19], v[76:79], v[40:43]
ds_read_b64_tr_b16 a[2:3], v8 offset:51200
buffer_load_dwordx4 v[60:63], v19, s[12:15], s74 offen offset:0 sc1
v_mfma_f32_16x16x32_bf16 v[28:31], a[20:23], v[72:75], v[28:31]
ds_read_b64_tr_b16 a[4:5], v9 offset:49152
v_mfma_f32_16x16x32_bf16 v[44:47], a[20:23], v[76:79], v[44:47]
ds_read_b64_tr_b16 a[6:7], v9 offset:51200
buffer_load_dwordx4 v[64:67], v6, s[12:15], s74 offen offset:1024 sc1
v_mfma_f32_16x16x32_bf16 v[32:35], a[24:27], v[72:75], v[32:35]
ds_read_b64_tr_b16 a[8:9], v10 offset:49152
buffer_load_dwordx4 v[68:71], v19, s[12:15], s74 offen offset:1024 sc1
v_mfma_f32_16x16x32_bf16 v[48:51], a[24:27], v[76:79], v[48:51]
ds_read_b64_tr_b16 a[10:11], v10 offset:51200
v_mfma_f32_16x16x32_bf16 v[36:39], a[28:31], v[72:75], v[36:39]
ds_read_b64_tr_b16 a[12:13], v11 offset:49152
s_add_u32 s74, s74, 2048
v_mfma_f32_16x16x32_bf16 v[52:55], a[28:31], v[76:79], v[52:55]
ds_read_b64_tr_b16 a[14:15], v11 offset:51200
s_waitcnt lgkmcnt(8)
v_mfma_f32_16x16x32_bf16 v[24:27], a[32:35], v[80:83], v[24:27]
ds_read_b64_tr_b16 a[16:17], v8 offset:53248
s_and_b32 s74, s74, 0x7fff
v_mfma_f32_16x16x32_bf16 v[40:43], a[32:35], v[84:87], v[40:43]
ds_read_b64_tr_b16 a[18:19], v8 offset:55296
s_waitcnt vmcnt(8)
v_mfma_f32_16x16x32_bf16 v[28:31], a[36:39], v[80:83], v[28:31]
ds_read_b64_tr_b16 a[20:21], v9 offset:53248
v_mfma_f32_16x16x32_bf16 v[44:47], a[36:39], v[84:87], v[44:47]
ds_read_b64_tr_b16 a[22:23], v9 offset:55296
v_max3_u32 v2, v88, v92, v96
v_mfma_f32_16x16x32_bf16 v[32:35], a[40:43], v[80:83], v[32:35]
ds_read_b64_tr_b16 a[24:25], v10 offset:53248
v_max_u32 v2, v2, v100
v_mfma_f32_16x16x32_bf16 v[48:51], a[40:43], v[84:87], v[48:51]
ds_read_b64_tr_b16 a[26:27], v10 offset:55296
v_mfma_f32_16x16x32_bf16 v[36:39], a[44:47], v[80:83], v[36:39]
ds_read_b64_tr_b16 a[28:29], v11 offset:53248
v_cmp_eq_u32 vcc, -1, v2
v_mfma_f32_16x16x32_bf16 v[52:55], a[44:47], v[84:87], v[52:55]
ds_read_b64_tr_b16 a[30:31], v11 offset:55296
s_cbranch_vccnz L_o6_rt
L_o6_ok:
s_waitcnt lgkmcnt(8)
v_mfma_f32_16x16x32_bf16 v[24:27], a[0:3], v[88:91], v[24:27]
ds_read_b64_tr_b16 a[32:33], v8 offset:57344
buffer_load_dwordx4 v[72:75], v6, s[12:15], s74 offen offset:0 sc1
v_mfma_f32_16x16x32_bf16 v[40:43], a[0:3], v[92:95], v[40:43]
ds_read_b64_tr_b16 a[34:35], v8 offset:59392
buffer_load_dwordx4 v[76:79], v19, s[12:15], s74 offen offset:0 sc1
v_mfma_f32_16x16x32_bf16 v[28:31], a[4:7], v[88:91], v[28:31]
ds_read_b64_tr_b16 a[36:37], v9 offset:57344
v_mfma_f32_16x16x32_bf16 v[44:47], a[4:7], v[92:95], v[44:47]
ds_read_b64_tr_b16 a[38:39], v9 offset:59392
buffer_load_dwordx4 v[80:83], v6, s[12:15], s74 offen offset:1024 sc1
v_mfma_f32_16x16x32_bf16 v[32:35], a[8:11], v[88:91], v[32:35]
ds_read_b64_tr_b16 a[40:41], v10 offset:57344
buffer_load_dwordx4 v[84:87], v19, s[12:15], s74 offen offset:1024 sc1
v_mfma_f32_16x16x32_bf16 v[48:51], a[8:11], v[92:95], v[48:51]
ds_read_b64_tr_b16 a[42:43], v10 offset:59392
v_mfma_f32_16x16x32_bf16 v[36:39], a[12:15], v[88:91], v[36:39]
ds_read_b64_tr_b16 a[44:45], v11 offset:57344
s_add_u32 s74, s74, 2048
v_mfma_f32_16x16x32_bf16 v[52:55], a[12:15], v[92:95], v[52:55]
ds_read_b64_tr_b16 a[46:47], v11 offset:59392
s_waitcnt lgkmcnt(8)
v_mfma_f32_16x16x32_bf16 v[24:27], a[16:19], v[96:99], v[24:27]
ds_read_b64_tr_b16 a[0:1], v8 offset:61440
s_and_b32 s74, s74, 0x7fff
v_mfma_f32_16x16x32_bf16 v[40:43], a[16:19], v[100:103], v[40:43]
ds_read_b64_tr_b16 a[2:3], v8 offset:63488
s_waitcnt vmcnt(8)
v_mfma_f32_16x16x32_bf16 v[28:31], a[20:23], v[96:99], v[28:31]
ds_read_b64_tr_b16 a[4:5], v9 offset:61440
v_mfma_f32_16x16x32_bf16 v[44:47], a[20:23], v[100:103], v[44:47]
ds_read_b64_tr_b16 a[6:7], v9 offset:63488
v_max3_u32 v2, v104, v108, v112
v_mfma_f32_16x16x32_bf16 v[32:35], a[24:27], v[96:99], v[32:35]
ds_read_b64_tr_b16 a[8:9], v10 offset:61440
v_max_u32 v2, v2, v116
v_mfma_f32_16x16x32_bf16 v[48:51], a[24:27], v[100:103], v[48:51]
ds_read_b64_tr_b16 a[10:11], v10 offset:63488
v_mfma_f32_16x16x32_bf16 v[36:39], a[28:31], v[96:99], v[36:39]
ds_read_b64_tr_b16 a[12:13], v11 offset:61440
v_cmp_eq_u32 vcc, -1, v2
v_mfma_f32_16x16x32_bf16 v[52:55], a[28:31], v[100:103], v[52:55]
ds_read_b64_tr_b16 a[14:15], v11 offset:63488
s_cbranch_vccnz L_o7_rt
L_o7_ok:
s_waitcnt lgkmcnt(8)
v_mfma_f32_16x16x32_bf16 v[24:27], a[32:35], v[104:107], v[24:27]
ds_read_b64_tr_b16 a[16:17], v12 offset:0
buffer_load_dwordx4 v[88:91], v6, s[12:15], s74 offen offset:0 sc1
v_mfma_f32_16x16x32_bf16 v[40:43], a[32:35], v[108:111], v[40:43]
ds_read_b64_tr_b16 a[18:19], v12 offset:2048
buffer_load_dwordx4 v[92:95], v19, s[12:15], s74 offen offset:0 sc1
v_mfma_f32_16x16x32_bf16 v[28:31], a[36:39], v[104:107], v[28:31]
ds_read_b64_tr_b16 a[20:21], v13 offset:0
v_mfma_f32_16x16x32_bf16 v[44:47], a[36:39], v[108:111], v[44:47]
ds_read_b64_tr_b16 a[22:23], v13 offset:2048
buffer_load_dwordx4 v[96:99], v6, s[12:15], s74 offen offset:1024 sc1
v_mfma_f32_16x16x32_bf16 v[32:35], a[40:43], v[104:107], v[32:35]
ds_read_b64_tr_b16 a[24:25], v14 offset:0
buffer_load_dwordx4 v[100:103], v19, s[12:15], s74 offen offset:1024 sc1
v_mfma_f32_16x16x32_bf16 v[48:51], a[40:43], v[108:111], v[48:51]
ds_read_b64_tr_b16 a[26:27], v14 offset:2048
v_mfma_f32_16x16x32_bf16 v[36:39], a[44:47], v[104:107], v[36:39]
ds_read_b64_tr_b16 a[28:29], v15 offset:0
s_add_u32 s74, s74, 2048
v_mfma_f32_16x16x32_bf16 v[52:55], a[44:47], v[108:111], v[52:55]
ds_read_b64_tr_b16 a[30:31], v15 offset:2048
s_waitcnt lgkmcnt(8)
v_mfma_f32_16x16x32_bf16 v[24:27], a[0:3], v[112:115], v[24:27]
ds_read_b64_tr_b16 a[32:33], v12 offset:4096
s_and_b32 s74, s74, 0x7fff
v_mfma_f32_16x16x32_bf16 v[40:43], a[0:3], v[116:119], v[40:43]
ds_read_b64_tr_b16 a[34:35], v12 offset:6144
s_waitcnt vmcnt(8)
v_mfma_f32_16x16x32_bf16 v[28:31], a[4:7], v[112:115], v[28:31]
ds_read_b64_tr_b16 a[36:37], v13 offset:4096
v_mfma_f32_16x16x32_bf16 v[44:47], a[4:7], v[116:119], v[44:47]
ds_read_b64_tr_b16 a[38:39], v13 offset:6144
v_max3_u32 v2, v56, v60, v64
v_mfma_f32_16x16x32_bf16 v[32:35], a[8:11], v[112:115], v[32:35]
ds_read_b64_tr_b16 a[40:41], v14 offset:4096
v_max_u32 v2, v2, v68
v_mfma_f32_16x16x32_bf16 v[48:51], a[8:11], v[116:119], v[48:51]
ds_read_b64_tr_b16 a[42:43], v14 offset:6144
v_mfma_f32_16x16x32_bf16 v[36:39], a[12:15], v[112:115], v[36:39]
ds_read_b64_tr_b16 a[44:45], v15 offset:4096
v_cmp_eq_u32 vcc, -1, v2
v_mfma_f32_16x16x32_bf16 v[52:55], a[12:15], v[116:119], v[52:55]
ds_read_b64_tr_b16 a[46:47], v15 offset:6144
s_cbranch_vccnz L_o8_rt
L_o8_ok:
s_waitcnt lgkmcnt(8)
v_mfma_f32_16x16x32_bf16 v[24:27], a[16:19], v[56:59], v[24:27]
ds_read_b64_tr_b16 a[0:1], v12 offset:8192
buffer_load_dwordx4 v[104:107], v6, s[12:15], s74 offen offset:0 sc1
v_mfma_f32_16x16x32_bf16 v[40:43], a[16:19], v[60:63], v[40:43]
ds_read_b64_tr_b16 a[2:3], v12 offset:10240
buffer_load_dwordx4 v[108:111], v19, s[12:15], s74 offen offset:0 sc1
v_mfma_f32_16x16x32_bf16 v[28:31], a[20:23], v[56:59], v[28:31]
ds_read_b64_tr_b16 a[4:5], v13 offset:8192
v_mfma_f32_16x16x32_bf16 v[44:47], a[20:23], v[60:63], v[44:47]
ds_read_b64_tr_b16 a[6:7], v13 offset:10240
buffer_load_dwordx4 v[112:115], v6, s[12:15], s74 offen offset:1024 sc1
v_mfma_f32_16x16x32_bf16 v[32:35], a[24:27], v[56:59], v[32:35]
ds_read_b64_tr_b16 a[8:9], v14 offset:8192
buffer_load_dwordx4 v[116:119], v19, s[12:15], s74 offen offset:1024 sc1
v_mfma_f32_16x16x32_bf16 v[48:51], a[24:27], v[60:63], v[48:51]
ds_read_b64_tr_b16 a[10:11], v14 offset:10240
v_mfma_f32_16x16x32_bf16 v[36:39], a[28:31], v[56:59], v[36:39]
ds_read_b64_tr_b16 a[12:13], v15 offset:8192
s_add_u32 s74, s74, 2048
v_mfma_f32_16x16x32_bf16 v[52:55], a[28:31], v[60:63], v[52:55]
ds_read_b64_tr_b16 a[14:15], v15 offset:10240
s_waitcnt lgkmcnt(8)
v_mfma_f32_16x16x32_bf16 v[24:27], a[32:35], v[64:67], v[24:27]
ds_read_b64_tr_b16 a[16:17], v12 offset:12288
s_and_b32 s74, s74, 0x7fff
v_mfma_f32_16x16x32_bf16 v[40:43], a[32:35], v[68:71], v[40:43]
ds_read_b64_tr_b16 a[18:19], v12 offset:14336
s_waitcnt vmcnt(8)
v_mfma_f32_16x16x32_bf16 v[28:31], a[36:39], v[64:67], v[28:31]
ds_read_b64_tr_b16 a[20:21], v13 offset:12288
v_mfma_f32_16x16x32_bf16 v[44:47], a[36:39], v[68:71], v[44:47]
ds_read_b64_tr_b16 a[22:23], v13 offset:14336
v_max3_u32 v2, v72, v76, v80
v_mfma_f32_16x16x32_bf16 v[32:35], a[40:43], v[64:67], v[32:35]
ds_read_b64_tr_b16 a[24:25], v14 offset:12288
v_max_u32 v2, v2, v84
v_mfma_f32_16x16x32_bf16 v[48:51], a[40:43], v[68:71], v[48:51]
ds_read_b64_tr_b16 a[26:27], v14 offset:14336
v_mfma_f32_16x16x32_bf16 v[36:39], a[44:47], v[64:67], v[36:39]
ds_read_b64_tr_b16 a[28:29], v15 offset:12288
v_cmp_eq_u32 vcc, -1, v2
v_mfma_f32_16x16x32_bf16 v[52:55], a[44:47], v[68:71], v[52:55]
ds_read_b64_tr_b16 a[30:31], v15 offset:14336
s_cbranch_vccnz L_o9_rt
L_o9_ok:
s_waitcnt lgkmcnt(8)
v_mfma_f32_16x16x32_bf16 v[24:27], a[0:3], v[72:75], v[24:27]
ds_read_b64_tr_b16 a[32:33], v12 offset:16384
buffer_load_dwordx4 v[56:59], v6, s[12:15], s74 offen offset:0 sc1
v_mfma_f32_16x16x32_bf16 v[40:43], a[0:3], v[76:79], v[40:43]
ds_read_b64_tr_b16 a[34:35], v12 offset:18432
buffer_load_dwordx4 v[60:63], v19, s[12:15], s74 offen offset:0 sc1
v_mfma_f32_16x16x32_bf16 v[28:31], a[4:7], v[72:75], v[28:31]
ds_read_b64_tr_b16 a[36:37], v13 offset:16384
v_mfma_f32_16x16x32_bf16 v[44:47], a[4:7], v[76:79], v[44:47]
ds_read_b64_tr_b16 a[38:39], v13 offset:18432
buffer_load_dwordx4 v[64:67], v6, s[12:15], s74 offen offset:1024 sc1
v_mfma_f32_16x16x32_bf16 v[32:35], a[8:11], v[72:75], v[32:35]
ds_read_b64_tr_b16 a[40:41], v14 offset:16384
buffer_load_dwordx4 v[68:71], v19, s[12:15], s74 offen offset:1024 sc1
v_mfma_f32_16x16x32_bf16 v[48:51], a[8:11], v[76:79], v[48:51]
ds_read_b64_tr_b16 a[42:43], v14 offset:18432
v_mfma_f32_16x16x32_bf16 v[36:39], a[12:15], v[72:75], v[36:39]
ds_read_b64_tr_b16 a[44:45], v15 offset:16384
s_add_u32 s74, s74, 2048
v_mfma_f32_16x16x32_bf16 v[52:55], a[12:15], v[76:79], v[52:55]
ds_read_b64_tr_b16 a[46:47], v15 offset:18432
s_waitcnt lgkmcnt(8)
v_mfma_f32_16x16x32_bf16 v[24:27], a[16:19], v[80:83], v[24:27]
ds_read_b64_tr_b16 a[0:1], v12 offset:20480
s_and_b32 s74, s74, 0x7fff
v_mfma_f32_16x16x32_bf16 v[40:43], a[16:19], v[84:87], v[40:43]
ds_read_b64_tr_b16 a[2:3], v12 offset:22528
s_waitcnt vmcnt(8)
v_mfma_f32_16x16x32_bf16 v[28:31], a[20:23], v[80:83], v[28:31]
ds_read_b64_tr_b16 a[4:5], v13 offset:20480
v_mfma_f32_16x16x32_bf16 v[44:47], a[20:23], v[84:87], v[44:47]
ds_read_b64_tr_b16 a[6:7], v13 offset:22528
v_max3_u32 v2, v88, v92, v96
v_mfma_f32_16x16x32_bf16 v[32:35], a[24:27], v[80:83], v[32:35]
ds_read_b64_tr_b16 a[8:9], v14 offset:20480
v_max_u32 v2, v2, v100
v_mfma_f32_16x16x32_bf16 v[48:51], a[24:27], v[84:87], v[48:51]
ds_read_b64_tr_b16 a[10:11], v14 offset:22528
v_mfma_f32_16x16x32_bf16 v[36:39], a[28:31], v[80:83], v[36:39]
ds_read_b64_tr_b16 a[12:13], v15 offset:20480
v_cmp_eq_u32 vcc, -1, v2
v_mfma_f32_16x16x32_bf16 v[52:55], a[28:31], v[84:87], v[52:55]
ds_read_b64_tr_b16 a[14:15], v15 offset:22528
s_cbranch_vccnz L_o10_rt
L_o10_ok:
s_waitcnt lgkmcnt(8)
v_mfma_f32_16x16x32_bf16 v[24:27], a[32:35], v[88:91], v[24:27]
ds_read_b64_tr_b16 a[16:17], v12 offset:24576
buffer_load_dwordx4 v[72:75], v6, s[12:15], s74 offen offset:0 sc1
v_mfma_f32_16x16x32_bf16 v[40:43], a[32:35], v[92:95], v[40:43]
ds_read_b64_tr_b16 a[18:19], v12 offset:26624
buffer_load_dwordx4 v[76:79], v19, s[12:15], s74 offen offset:0 sc1
v_mfma_f32_16x16x32_bf16 v[28:31], a[36:39], v[88:91], v[28:31]
ds_read_b64_tr_b16 a[20:21], v13 offset:24576
v_mfma_f32_16x16x32_bf16 v[44:47], a[36:39], v[92:95], v[44:47]
ds_read_b64_tr_b16 a[22:23], v13 offset:26624
buffer_load_dwordx4 v[80:83], v6, s[12:15], s74 offen offset:1024 sc1
v_mfma_f32_16x16x32_bf16 v[32:35], a[40:43], v[88:91], v[32:35]
ds_read_b64_tr_b16 a[24:25], v14 offset:24576
buffer_load_dwordx4 v[84:87], v19, s[12:15], s74 offen offset:1024 sc1
v_mfma_f32_16x16x32_bf16 v[48:51], a[40:43], v[92:95], v[48:51]
ds_read_b64_tr_b16 a[26:27], v14 offset:26624
v_mfma_f32_16x16x32_bf16 v[36:39], a[44:47], v[88:91], v[36:39]
ds_read_b64_tr_b16 a[28:29], v15 offset:24576
s_add_u32 s74, s74, 2048
v_mfma_f32_16x16x32_bf16 v[52:55], a[44:47], v[92:95], v[52:55]
ds_read_b64_tr_b16 a[30:31], v15 offset:26624
s_waitcnt lgkmcnt(8)
v_mfma_f32_16x16x32_bf16 v[24:27], a[0:3], v[96:99], v[24:27]
ds_read_b64_tr_b16 a[32:33], v12 offset:28672
s_and_b32 s74, s74, 0x7fff
v_mfma_f32_16x16x32_bf16 v[40:43], a[0:3], v[100:103], v[40:43]
ds_read_b64_tr_b16 a[34:35], v12 offset:30720
s_waitcnt vmcnt(8)
v_mfma_f32_16x16x32_bf16 v[28:31], a[4:7], v[96:99], v[28:31]
ds_read_b64_tr_b16 a[36:37], v13 offset:28672
v_mfma_f32_16x16x32_bf16 v[44:47], a[4:7], v[100:103], v[44:47]
ds_read_b64_tr_b16 a[38:39], v13 offset:30720
v_max3_u32 v2, v104, v108, v112
v_mfma_f32_16x16x32_bf16 v[32:35], a[8:11], v[96:99], v[32:35]
ds_read_b64_tr_b16 a[40:41], v14 offset:28672
v_max_u32 v2, v2, v116
v_mfma_f32_16x16x32_bf16 v[48:51], a[8:11], v[100:103], v[48:51]
ds_read_b64_tr_b16 a[42:43], v14 offset:30720
v_mfma_f32_16x16x32_bf16 v[36:39], a[12:15], v[96:99], v[36:39]
ds_read_b64_tr_b16 a[44:45], v15 offset:28672
v_cmp_eq_u32 vcc, -1, v2
v_mfma_f32_16x16x32_bf16 v[52:55], a[12:15], v[100:103], v[52:55]
ds_read_b64_tr_b16 a[46:47], v15 offset:30720
s_cbranch_vccnz L_o11_rt
L_o11_ok:
s_waitcnt lgkmcnt(8)
v_mfma_f32_16x16x32_bf16 v[24:27], a[16:19], v[104:107], v[24:27]
ds_read_b64_tr_b16 a[0:1], v12 offset:32768
buffer_load_dwordx4 v[88:91], v6, s[12:15], s74 offen offset:0 sc1
v_mfma_f32_16x16x32_bf16 v[40:43], a[16:19], v[108:111], v[40:43]
ds_read_b64_tr_b16 a[2:3], v12 offset:34816
buffer_load_dwordx4 v[92:95], v19, s[12:15], s74 offen offset:0 sc1
v_mfma_f32_16x16x32_bf16 v[28:31], a[20:23], v[104:107], v[28:31]
ds_read_b64_tr_b16 a[4:5], v13 offset:32768
v_mfma_f32_16x16x32_bf16 v[44:47], a[20:23], v[108:111], v[44:47]
ds_read_b64_tr_b16 a[6:7], v13 offset:34816
buffer_load_dwordx4 v[96:99], v6, s[12:15], s74 offen offset:1024 sc1
v_mfma_f32_16x16x32_bf16 v[32:35], a[24:27], v[104:107], v[32:35]
ds_read_b64_tr_b16 a[8:9], v14 offset:32768
buffer_load_dwordx4 v[100:103], v19, s[12:15], s74 offen offset:1024 sc1
v_mfma_f32_16x16x32_bf16 v[48:51], a[24:27], v[108:111], v[48:51]
ds_read_b64_tr_b16 a[10:11], v14 offset:34816
v_mfma_f32_16x16x32_bf16 v[36:39], a[28:31], v[104:107], v[36:39]
ds_read_b64_tr_b16 a[12:13], v15 offset:32768
s_add_u32 s74, s74, 2048
v_mfma_f32_16x16x32_bf16 v[52:55], a[28:31], v[108:111], v[52:55]
ds_read_b64_tr_b16 a[14:15], v15 offset:34816
s_waitcnt lgkmcnt(8)
v_mfma_f32_16x16x32_bf16 v[24:27], a[32:35], v[112:115], v[24:27]
ds_read_b64_tr_b16 a[16:17], v12 offset:36864
s_and_b32 s74, s74, 0x7fff
v_mfma_f32_16x16x32_bf16 v[40:43], a[32:35], v[116:119], v[40:43]
ds_read_b64_tr_b16 a[18:19], v12 offset:38912
s_waitcnt vmcnt(8)
v_mfma_f32_16x16x32_bf16 v[28:31], a[36:39], v[112:115], v[28:31]
ds_read_b64_tr_b16 a[20:21], v13 offset:36864
v_mfma_f32_16x16x32_bf16 v[44:47], a[36:39], v[116:119], v[44:47]
ds_read_b64_tr_b16 a[22:23], v13 offset:38912
v_max3_u32 v2, v56, v60, v64
v_mfma_f32_16x16x32_bf16 v[32:35], a[40:43], v[112:115], v[32:35]
ds_read_b64_tr_b16 a[24:25], v14 offset:36864
v_max_u32 v2, v2, v68
v_mfma_f32_16x16x32_bf16 v[48:51], a[40:43], v[116:119], v[48:51]
ds_read_b64_tr_b16 a[26:27], v14 offset:38912
v_mfma_f32_16x16x32_bf16 v[36:39], a[44:47], v[112:115], v[36:39]
ds_read_b64_tr_b16 a[28:29], v15 offset:36864
v_cmp_eq_u32 vcc, -1, v2
v_mfma_f32_16x16x32_bf16 v[52:55], a[44:47], v[116:119], v[52:55]
ds_read_b64_tr_b16 a[30:31], v15 offset:38912
s_cbranch_vccnz L_o12_rt
L_o12_ok:
s_waitcnt lgkmcnt(8)
v_mfma_f32_16x16x32_bf16 v[24:27], a[0:3], v[56:59], v[24:27]
ds_read_b64_tr_b16 a[32:33], v12 offset:40960
buffer_load_dwordx4 v[104:107], v6, s[12:15], s74 offen offset:0 sc1
v_mfma_f32_16x16x32_bf16 v[40:43], a[0:3], v[60:63], v[40:43]
ds_read_b64_tr_b16 a[34:35], v12 offset:43008
v_mfma_f32_16x16x32_bf16 v[28:31], a[4:7], v[56:59], v[28:31]
ds_read_b64_tr_b16 a[36:37], v13 offset:40960
buffer_load_dwordx4 v[108:111], v19, s[12:15], s74 offen offset:0 sc1
v_mfma_f32_16x16x32_bf16 v[44:47], a[4:7], v[60:63], v[44:47]
ds_read_b64_tr_b16 a[38:39], v13 offset:43008
v_mfma_f32_16x16x32_bf16 v[32:35], a[8:11], v[56:59], v[32:35]
ds_read_b64_tr_b16 a[40:41], v14 offset:40960
buffer_load_dwordx4 v[112:115], v6, s[12:15], s74 offen offset:1024 sc1
v_mfma_f32_16x16x32_bf16 v[48:51], a[8:11], v[60:63], v[48:51]
ds_read_b64_tr_b16 a[42:43], v14 offset:43008
v_mfma_f32_16x16x32_bf16 v[36:39], a[12:15], v[56:59], v[36:39]
ds_read_b64_tr_b16 a[44:45], v15 offset:40960
buffer_load_dwordx4 v[116:119], v19, s[12:15], s74 offen offset:1024 sc1
v_mfma_f32_16x16x32_bf16 v[52:55], a[12:15], v[60:63], v[52:55]
ds_read_b64_tr_b16 a[46:47], v15 offset:43008
s_waitcnt lgkmcnt(8)
v_mfma_f32_16x16x32_bf16 v[24:27], a[16:19], v[64:67], v[24:27]
ds_read_b64_tr_b16 a[0:1], v12 offset:45056
s_waitcnt vmcnt(8)
v_mfma_f32_16x16x32_bf16 v[40:43], a[16:19], v[68:71], v[40:43]
ds_read_b64_tr_b16 a[2:3], v12 offset:47104
v_mfma_f32_16x16x32_bf16 v[28:31], a[20:23], v[64:67], v[28:31]
ds_read_b64_tr_b16 a[4:5], v13 offset:45056
v_max3_u32 v2, v72, v76, v80
v_mfma_f32_16x16x32_bf16 v[44:47], a[20:23], v[68:71], v[44:47]
ds_read_b64_tr_b16 a[6:7], v13 offset:47104
v_mfma_f32_16x16x32_bf16 v[32:35], a[24:27], v[64:67], v[32:35]
ds_read_b64_tr_b16 a[8:9], v14 offset:45056
v_max_u32 v2, v2, v84
v_mfma_f32_16x16x32_bf16 v[48:51], a[24:27], v[68:71], v[48:51]
ds_read_b64_tr_b16 a[10:11], v14 offset:47104
v_mfma_f32_16x16x32_bf16 v[36:39], a[28:31], v[64:67], v[36:39]
ds_read_b64_tr_b16 a[12:13], v15 offset:45056
v_cmp_eq_u32 vcc, -1, v2
v_mfma_f32_16x16x32_bf16 v[52:55], a[28:31], v[68:71], v[52:55]
ds_read_b64_tr_b16 a[14:15], v15 offset:47104
s_cbranch_vccnz L_o13_rt
L_o13_ok:
s_waitcnt lgkmcnt(8)
v_mfma_f32_16x16x32_bf16 v[24:27], a[32:35], v[72:75], v[24:27]
ds_read_b64_tr_b16 a[16:17], v12 offset:49152
s_waitcnt vmcnt(4)
v_mfma_f32_16x16x32_bf16 v[40:43], a[32:35], v[76:79], v[40:43]
ds_read_b64_tr_b16 a[18:19], v12 offset:51200
v_mfma_f32_16x16x32_bf16 v[28:31], a[36:39], v[72:75], v[28:31]
ds_read_b64_tr_b16 a[20:21], v13 offset:49152
v_mfma_f32_16x16x32_bf16 v[44:47], a[36:39], v[76:79], v[44:47]
ds_read_b64_tr_b16 a[22:23], v13 offset:51200
v_mfma_f32_16x16x32_bf16 v[32:35], a[40:43], v[72:75], v[32:35]
ds_read_b64_tr_b16 a[24:25], v14 offset:49152
v_max3_u32 v2, v88, v92, v96
v_mfma_f32_16x16x32_bf16 v[48:51], a[40:43], v[76:79], v[48:51]
ds_read_b64_tr_b16 a[26:27], v14 offset:51200
v_mfma_f32_16x16x32_bf16 v[36:39], a[44:47], v[72:75], v[36:39]
ds_read_b64_tr_b16 a[28:29], v15 offset:49152
v_mfma_f32_16x16x32_bf16 v[52:55], a[44:47], v[76:79], v[52:55]
ds_read_b64_tr_b16 a[30:31], v15 offset:51200
s_waitcnt lgkmcnt(8)
v_mfma_f32_16x16x32_bf16 v[24:27], a[0:3], v[80:83], v[24:27]
ds_read_b64_tr_b16 a[32:33], v12 offset:53248
v_max_u32 v2, v2, v100
v_mfma_f32_16x16x32_bf16 v[40:43], a[0:3], v[84:87], v[40:43]
ds_read_b64_tr_b16 a[34:35], v12 offset:55296
v_mfma_f32_16x16x32_bf16 v[28:31], a[4:7], v[80:83], v[28:31]
ds_read_b64_tr_b16 a[36:37], v13 offset:53248
v_mfma_f32_16x16x32_bf16 v[44:47], a[4:7], v[84:87], v[44:47]
ds_read_b64_tr_b16 a[38:39], v13 offset:55296
v_mfma_f32_16x16x32_bf16 v[32:35], a[8:11], v[80:83], v[32:35]
ds_read_b64_tr_b16 a[40:41], v14 offset:53248
v_cmp_eq_u32 vcc, -1, v2
v_mfma_f32_16x16x32_bf16 v[48:51], a[8:11], v[84:87], v[48:51]
ds_read_b64_tr_b16 a[42:43], v14 offset:55296
v_mfma_f32_16x16x32_bf16 v[36:39], a[12:15], v[80:83], v[36:39]
ds_read_b64_tr_b16 a[44:45], v15 offset:53248
v_mfma_f32_16x16x32_bf16 v[52:55], a[12:15], v[84:87], v[52:55]
ds_read_b64_tr_b16 a[46:47], v15 offset:55296
s_cbranch_vccnz L_o14_rt
L_o14_ok:
s_waitcnt lgkmcnt(8)
v_mfma_f32_16x16x32_bf16 v[24:27], a[16:19], v[88:91], v[24:27]
ds_read_b64_tr_b16 a[0:1], v12 offset:57344
s_waitcnt vmcnt(0)
v_mfma_f32_16x16x32_bf16 v[40:43], a[16:19], v[92:95], v[40:43]
ds_read_b64_tr_b16 a[2:3], v12 offset:59392
v_mfma_f32_16x16x32_bf16 v[28:31], a[20:23], v[88:91], v[28:31]
ds_read_b64_tr_b16 a[4:5], v13 offset:57344
v_mfma_f32_16x16x32_bf16 v[44:47], a[20:23], v[92:95], v[44:47]
ds_read_b64_tr_b16 a[6:7], v13 offset:59392
v_mfma_f32_16x16x32_bf16 v[32:35], a[24:27], v[88:91], v[32:35]
ds_read_b64_tr_b16 a[8:9], v14 offset:57344
v_max3_u32 v2, v104, v108, v112
v_mfma_f32_16x16x32_bf16 v[48:51], a[24:27], v[92:95], v[48:51]
ds_read_b64_tr_b16 a[10:11], v14 offset:59392
v_mfma_f32_16x16x32_bf16 v[36:39], a[28:31], v[88:91], v[36:39]
ds_read_b64_tr_b16 a[12:13], v15 offset:57344
v_mfma_f32_16x16x32_bf16 v[52:55], a[28:31], v[92:95], v[52:55]
ds_read_b64_tr_b16 a[14:15], v15 offset:59392
s_waitcnt lgkmcnt(8)
v_mfma_f32_16x16x32_bf16 v[24:27], a[32:35], v[96:99], v[24:27]
ds_read_b64_tr_b16 a[16:17], v12 offset:61440
v_max_u32 v2, v2, v116
v_mfma_f32_16x16x32_bf16 v[40:43], a[32:35], v[100:103], v[40:43]
ds_read_b64_tr_b16 a[18:19], v12 offset:63488
v_mfma_f32_16x16x32_bf16 v[28:31], a[36:39], v[96:99], v[28:31]
ds_read_b64_tr_b16 a[20:21], v13 offset:61440
v_mfma_f32_16x16x32_bf16 v[44:47], a[36:39], v[100:103], v[44:47]
ds_read_b64_tr_b16 a[22:23], v13 offset:63488
v_mfma_f32_16x16x32_bf16 v[32:35], a[40:43], v[96:99], v[32:35]
ds_read_b64_tr_b16 a[24:25], v14 offset:61440
v_cmp_eq_u32 vcc, -1, v2
v_mfma_f32_16x16x32_bf16 v[48:51], a[40:43], v[100:103], v[48:51]
ds_read_b64_tr_b16 a[26:27], v14 offset:63488
v_mfma_f32_16x16x32_bf16 v[36:39], a[44:47], v[96:99], v[36:39]
ds_read_b64_tr_b16 a[28:29], v15 offset:61440
v_mfma_f32_16x16x32_bf16 v[52:55], a[44:47], v[100:103], v[52:55]
ds_read_b64_tr_b16 a[30:31], v15 offset:63488
s_cbranch_vccnz L_o15_rt
L_o15_ok:
s_waitcnt lgkmcnt(8)
v_mfma_f32_16x16x32_bf16 v[24:27], a[0:3], v[104:107], v[24:27]
v_mfma_f32_16x16x32_bf16 v[40:43], a[0:3], v[108:111], v[40:43]
v_mfma_f32_16x16x32_bf16 v[28:31], a[4:7], v[104:107], v[28:31]
v_mfma_f32_16x16x32_bf16 v[44:47], a[4:7], v[108:111], v[44:47]
v_mfma_f32_16x16x32_bf16 v[32:35], a[8:11], v[104:107], v[32:35]
v_mfma_f32_16x16x32_bf16 v[48:51], a[8:11], v[108:111], v[48:51]
v_mfma_f32_16x16x32_bf16 v[36:39], a[12:15], v[104:107], v[36:39]
v_mfma_f32_16x16x32_bf16 v[52:55], a[12:15], v[108:111], v[52:55]
s_waitcnt lgkmcnt(0)
v_mfma_f32_16x16x32_bf16 v[24:27], a[16:19], v[112:115], v[24:27]
v_mfma_f32_16x16x32_bf16 v[40:43], a[16:19], v[116:119], v[40:43]
v_mfma_f32_16x16x32_bf16 v[28:31], a[20:23], v[112:115], v[28:31]
v_mfma_f32_16x16x32_bf16 v[44:47], a[20:23], v[116:119], v[44:47]
v_mfma_f32_16x16x32_bf16 v[32:35], a[24:27], v[112:115], v[32:35]
v_mfma_f32_16x16x32_bf16 v[48:51], a[24:27], v[116:119], v[48:51]
v_mfma_f32_16x16x32_bf16 v[36:39], a[28:31], v[112:115], v[36:39]
v_mfma_f32_16x16x32_bf16 v[52:55], a[28:31], v[116:119], v[52:55]
s_nop 0
v_cvt_pk_bf16_f32 v128, v24, v25
v_cvt_pk_bf16_f32 v129, v26, v27
v_cvt_pk_bf16_f32 v130, v28, v29
v_cvt_pk_bf16_f32 v131, v30, v31
v_cvt_pk_bf16_f32 v132, v32, v33
v_cvt_pk_bf16_f32 v133, v34, v35
v_cvt_pk_bf16_f32 v134, v36, v37
v_cvt_pk_bf16_f32 v135, v38, v39
v_cvt_pk_bf16_f32 v136, v40, v41
v_cvt_pk_bf16_f32 v137, v42, v43
v_cvt_pk_bf16_f32 v138, v44, v45
v_cvt_pk_bf16_f32 v139, v46, v47
v_cvt_pk_bf16_f32 v140, v48, v49
v_cvt_pk_bf16_f32 v141, v50, v51
v_cvt_pk_bf16_f32 v142, v52, v53
v_cvt_pk_bf16_f32 v143, v54, v55
v_mfma_f32_16x16x32_bf16 v[80:83], v[128:131], v[128:131], 0
v_mfma_f32_16x16x32_bf16 v[72:75], v[120:123], v[128:131], 0
v_mfma_f32_16x16x32_bf16 v[80:83], v[132:135], v[132:135], v[80:83]
v_mfma_f32_16x16x32_bf16 v[72:75], v[124:127], v[132:135], v[72:75]
v_mfma_f32_16x16x32_bf16 v[84:87], v[136:139], v[136:139], 0
v_mfma_f32_16x16x32_bf16 v[76:79], v[120:123], v[136:139], 0
v_mfma_f32_16x16x32_bf16 v[84:87], v[140:143], v[140:143], v[84:87]
v_mfma_f32_16x16x32_bf16 v[76:79], v[124:127], v[140:143], v[76:79]
s_nop 2
v_cndmask_b32_e64 v80, v80, v81, s[80:81]
v_cndmask_b32_e64 v82, v82, v83, s[90:91]
s_or_b64 vcc, s[82:83], s[90:91]
v_mov_b32 v75, s68
v_cndmask_b32 v73, v80, v82, vcc
v_cndmask_b32_e64 v84, v84, v85, s[80:81]
v_cndmask_b32_e64 v86, v86, v87, s[90:91]
s_or_b64 vcc, s[82:83], s[90:91]
v_mov_b32 v79, s68
v_cndmask_b32 v77, v84, v86, vcc
s_mov_b64 exec, s[92:93]
s_cmp_eq_u32 s69, 0
s_cbranch_scc1 L_stp_s
buffer_store_dwordx4 v[72:75], v144, s[12:15], s72 offen offset:0
buffer_store_dwordx4 v[76:79], v144, s[12:15], s72 offen offset:256
L_stp_d:
s_mov_b64 exec, -1
s_add_u32 s70, s75, 0
buffer_load_dwordx4 v[96:99], v145, s[12:15], s70 offen sc1
s_add_u32 s70, s75, 4096
buffer_load_dwordx4 v[100:103], v145, s[12:15], s70 offen sc1
s_add_u32 s70, s75, 8192
buffer_load_dwordx4 v[104:107], v145, s[12:15], s70 offen sc1
s_add_u32 s70, s75, 12288
buffer_load_dwordx4 v[108:111], v145, s[12:15], s70 offen sc1
s_add_u32 s70, s75, 16384
buffer_load_dwordx4 v[112:115], v145, s[12:15], s70 offen sc1
s_add_u32 s70, s75, 20480
buffer_load_dwordx4 v[116:119], v145, s[12:15], s70 offen sc1
s_add_u32 s70, s75, 24576
buffer_load_dwordx4 v[120:123], v145, s[12:15], s70 offen sc1
s_add_u32 s70, s75, 28672
buffer_load_dwordx4 v[124:127], v145, s[12:15], s70 offen sc1
s_barrier
ds_write_b64 v20, v[128:129] offset:0
ds_write_b64 v21, v[130:131] offset:0
ds_write_b64 v22, v[132:133] offset:0
ds_write_b64 v23, v[134:135] offset:0
ds_write_b64 v20, v[136:137] offset:2048
ds_write_b64 v21, v[138:139] offset:2048
ds_write_b64 v22, v[140:141] offset:2048
ds_write_b64 v23, v[142:143] offset:2048
v_lshrrev_b32 v2, 3, v1
v_lshrrev_b32 v3, 4, v1
v_and_b32 v13, 7, v1
v_xor_b32 v3, v3, v13
v_lshlrev_b32 v3, 4, v3
v_lshl_add_u32 v3, v2, 7, v3
s_lshl_b32 s70, s60, 12
v_add_u32 v9, s70, v3
v_xor_b32 v10, 64, v9
v_lshlrev_b32 v11, 11, v2
v_lshl_add_u32 v11, v13, 4, v11
s_lshl_b32 s70, s60, 5
v_add_u32 v12, s70, v2
s_lshl_b32 s74, s64, 18
s_lshl_b32 s70, s60, 16
s_add_u32 s74, s74, s70
s_lshl_b32 s70, s65, 7
s_add_u32 s74, s74, s70
s_mov_b32 s80, 0xff00ff00
s_mov_b32 s81, 0xff00ff00
s_lshl_b32 s70, s60, 5
s_add_u32 s70, s70, 161920
v_mov_b32 v14, s70
v_add_u32 v15, 16, v14
v_add_u32 v8, 161920, v16
v_lshlrev_b32 v8, 4, v13
v_add_u32 v8, 161920, v8
s_waitcnt vmcnt(0)
L_st_chk:
v_xor_b32 v88, s68, v99
v_xor_b32 v89, s68, v103
v_xor_b32 v90, s68, v107
v_xor_b32 v91, s68, v111
v_xor_b32 v92, s68, v115
v_xor_b32 v93, s68, v119
v_xor_b32 v94, s68, v123
v_xor_b32 v95, s68, v127
v_or3_b32 v88, v88, v89, v90
v_or3_b32 v91, v91, v92, v93
v_or3_b32 v88, v88, v94, v95
v_or_b32 v88, v88, v91
v_cmp_ne_u32 vcc, 0, v88
s_cbranch_vccnz L_st_rt
L_st_ok:
v_pk_add_f32 v[96:97], v[96:97], v[100:101]
v_add_f32 v98, v98, v102
v_pk_add_f32 v[104:105], v[104:105], v[108:109]
v_add_f32 v106, v106, v110
v_pk_add_f32 v[112:113], v[112:113], v[116:117]
v_add_f32 v114, v114, v118
v_pk_add_f32 v[120:121], v[120:121], v[124:125]
v_add_f32 v122, v122, v126
v_pk_add_f32 v[96:97], v[96:97], v[104:105]
v_add_f32 v98, v98, v106
v_pk_add_f32 v[112:113], v[112:113], v[120:121]
v_add_f32 v114, v114, v122
v_pk_add_f32 v[96:97], v[96:97], v[112:113]
v_add_f32 v98, v98, v114
v_mov_b32 v100, v96
v_mov_b32 v101, v97
v_mov_b32 v102, v98
v_permlane32_swap_b32 v96, v100
v_permlane32_swap_b32 v97, v101
v_permlane32_swap_b32 v98, v102
v_add_f32 v96, v96, v100
v_add_f32 v97, v97, v101
v_add_f32 v98, v98, v102
v_mul_f32 v73, 0x3a800000, v96
v_mul_f32 v97, 0x3a800000, v97
v_fma_f32 v97, -v73, v73, v97
v_fma_f32 v98, -v73, s84, v98
v_max_f32 v97, 0, v97
v_add_f32 v97, 0x3727c5ac, v97
v_rsq_f32 v74, v97
v_mov_b32 v75, s68
v_mul_f32 v98, v98, v74
v_ashrrev_i32 v99, 31, v98
v_or_b32 v99, 0x80000000, v99
v_xor_b32 v98, v98, v99
s_mov_b32 s70, 0xfffff800
v_and_or_b32 v72, v98, s70, v146
s_nop 1
v_mov_b32_dpp v78, v72 row_ror:1 row_mask:0xf bank_mask:0xf
v_max_u32 v76, v72, v78
v_min_u32 v77, v72, v78
s_nop 0
v_mov_b32_dpp v78, v76 row_ror:2 row_mask:0xf bank_mask:0xf
v_max_u32_dpp v79, v77, v77 row_ror:2 row_mask:0xf bank_mask:0xf
v_med3_u32 v77, v76, v78, v79
v_max_u32 v76, v76, v78
s_nop 1
v_mov_b32_dpp v78, v76 row_ror:4 row_mask:0xf bank_mask:0xf
v_max_u32_dpp v79, v77, v77 row_ror:4 row_mask:0xf bank_mask:0xf
v_med3_u32 v77, v76, v78, v79
v_max_u32 v76, v76, v78
s_nop 1
v_mov_b32_dpp v78, v76 row_ror:8 row_mask:0xf bank_mask:0xf
v_max_u32_dpp v79, v77, v77 row_ror:8 row_mask:0xf bank_mask:0xf
v_med3_u32 v77, v76, v78, v79
v_max_u32 v76, v76, v78
v_mov_b32 v78, v76
v_mov_b32 v79, v77
s_nop 0
v_permlane16_swap_b32 v76, v78
v_permlane16_swap_b32 v77, v79
v_max_u32 v79, v77, v79
v_med3_u32 v77, v76, v78, v79
v_max_u32 v76, v76, v78
v_cmp_eq_u32 vcc, v72, v77
v_cmp_eq_u32_e64 s[92:93], v72, v76
s_nop 0
v_cndmask_b32 v2, v14, v15, vcc
s_or_b64 exec, vcc, s[92:93]
ds_write_b128 v2, v[72:75]
s_mov_b64 exec, -1
v_cndmask_b32_e64 v5, v76, v77, s[80:81]
v_not_b32 v5, v5
v_bfe_u32 v6, v5, 1, 3
v_and_b32 v5, 127, v5
v_xor_b32 v6, v6, v13
v_lshlrev_b32 v6, 4, v6
v_lshl_add_u32 v6, v5, 7, v6
ds_read_b128 v[88:91], v6
v_readfirstlane_b32 s86, v77
v_readfirstlane_b32 s85, v76
v_add_f32 v80, 1.0, v74
v_mul_f32_e64 v56, -v73, v74
v_mov_b32 v82, v80
v_mov_b32 v58, v56
s_nop 0
v_permlane16_swap_b32 v80, v82
v_permlane16_swap_b32 v56, v58
s_waitcnt lgkmcnt(1)
s_barrier
s_sub_u32 s70, s64, s65
s_or_b32 s70, s70, s60
s_cbranch_scc1 L_norec
ds_read_b128 v[92:95], v8
s_waitcnt lgkmcnt(0)
buffer_store_dwordx4 v[92:95], v11, s[12:15], s87 offen sc1
L_norec:
s_mov_b64 exec, 0xffff
s_waitcnt lgkmcnt(0)
buffer_store_dwordx4 v[88:91], v147, s[12:15], s88 offen sc1
s_mov_b64 exec, -1
s_not_b32 s95, s86
s_and_b32 s95, s95, 127
s_not_b32 s94, s85
s_and_b32 s94, s94, 127
v_pk_fma_f32 v[24:25], v[24:25], v[80:81], v[56:57] op_sel_hi:[1,0,0]
v_pk_fma_f32 v[26:27], v[26:27], v[80:81], v[56:57] op_sel_hi:[1,0,0]
v_cvt_pk_bf16_f32 v128, v24, v25
v_cvt_pk_bf16_f32 v129, v26, v27
ds_write_b64 v20, v[128:129] offset:32768
v_pk_fma_f32 v[28:29], v[28:29], v[80:81], v[56:57] op_sel_hi:[1,0,0]
v_pk_fma_f32 v[30:31], v[30:31], v[80:81], v[56:57] op_sel_hi:[1,0,0]
v_cvt_pk_bf16_f32 v130, v28, v29
v_cvt_pk_bf16_f32 v131, v30, v31
ds_write_b64 v21, v[130:131] offset:32768
v_pk_fma_f32 v[32:33], v[32:33], v[80:81], v[56:57] op_sel_hi:[1,0,0]
v_pk_fma_f32 v[34:35], v[34:35], v[80:81], v[56:57] op_sel_hi:[1,0,0]
v_cvt_pk_bf16_f32 v132, v32, v33
v_cvt_pk_bf16_f32 v133, v34, v35
ds_write_b64 v22, v[132:133] offset:32768
v_pk_fma_f32 v[36:37], v[36:37], v[80:81], v[56:57] op_sel_hi:[1,0,0]
v_pk_fma_f32 v[38:39], v[38:39], v[80:81], v[56:57] op_sel_hi:[1,0,0]
v_cvt_pk_bf16_f32 v134, v36, v37
v_cvt_pk_bf16_f32 v135, v38, v39
ds_write_b64 v23, v[134:135] offset:32768
v_pk_fma_f32 v[40:41], v[40:41], v[82:83], v[58:59] op_sel_hi:[1,0,0]
v_pk_fma_f32 v[42:43], v[42:43], v[82:83], v[58:59] op_sel_hi:[1,0,0]
v_cvt_pk_bf16_f32 v136, v40, v41
v_cvt_pk_bf16_f32 v137, v42, v43
ds_write_b64 v20, v[136:137] offset:34816
v_pk_fma_f32 v[44:45], v[44:45], v[82:83], v[58:59] op_sel_hi:[1,0,0]
v_pk_fma_f32 v[46:47], v[46:47], v[82:83], v[58:59] op_sel_hi:[1,0,0]
v_cvt_pk_bf16_f32 v138, v44, v45
v_cvt_pk_bf16_f32 v139, v46, v47
ds_write_b64 v21, v[138:139] offset:34816
v_pk_fma_f32 v[48:49], v[48:49], v[82:83], v[58:59] op_sel_hi:[1,0,0]
v_pk_fma_f32 v[50:51], v[50:51], v[82:83], v[58:59] op_sel_hi:[1,0,0]
v_cvt_pk_bf16_f32 v140, v48, v49
v_cvt_pk_bf16_f32 v141, v50, v51
ds_write_b64 v22, v[140:141] offset:34816
v_pk_fma_f32 v[52:53], v[52:53], v[82:83], v[58:59] op_sel_hi:[1,0,0]
v_pk_fma_f32 v[54:55], v[54:55], v[82:83], v[58:59] op_sel_hi:[1,0,0]
v_cvt_pk_bf16_f32 v142, v52, v53
v_cvt_pk_bf16_f32 v143, v54, v55
ds_write_b64 v23, v[142:143] offset:34816
s_waitcnt lgkmcnt(0)
ds_read_b128 v[96:99], v9 offset:32768
ds_read_b128 v[100:103], v10 offset:33792
ds_read_b128 v[104:107], v9 offset:34816
ds_read_b128 v[108:111], v10 offset:35840
v_add_u32 v2, 0, v12
v_cmp_ne_u32 vcc, s94, v2
v_cmp_ne_u32_e64 s[92:93], s95, v2
s_add_u32 s70, s74, 0
s_waitcnt lgkmcnt(3)
s_and_b64 exec, vcc, s[92:93]
buffer_store_dwordx4 v[96:99], v11, s[20:23], s70 offen nt
s_mov_b64 exec, -1
v_add_u32 v2, 8, v12
v_cmp_ne_u32 vcc, s94, v2
v_cmp_ne_u32_e64 s[92:93], s95, v2
s_add_u32 s70, s74, 16384
s_waitcnt lgkmcnt(2)
s_and_b64 exec, vcc, s[92:93]
buffer_store_dwordx4 v[100:103], v11, s[20:23], s70 offen nt
s_mov_b64 exec, -1
v_add_u32 v2, 16, v12
v_cmp_ne_u32 vcc, s94, v2
v_cmp_ne_u32_e64 s[92:93], s95, v2
s_add_u32 s70, s74, 32768
s_waitcnt lgkmcnt(1)
s_and_b64 exec, vcc, s[92:93]
buffer_store_dwordx4 v[104:107], v11, s[20:23], s70 offen nt
s_mov_b64 exec, -1
v_add_u32 v2, 24, v12
v_cmp_ne_u32 vcc, s94, v2
v_cmp_ne_u32_e64 s[92:93], s95, v2
s_add_u32 s70, s74, 49152
s_waitcnt lgkmcnt(0)
s_and_b64 exec, vcc, s[92:93]
buffer_store_dwordx4 v[108:111], v11, s[20:23], s70 offen nt
s_mov_b64 exec, -1
v_mov_b32 v2, 161792
s_barrier
ds_read_b32 v3, v2
ds_read_b32 v4, v2 offset:16
s_waitcnt lgkmcnt(0)
v_readfirstlane_b32 s72, v3
v_readfirstlane_b32 s73, v4
s_cmp_eq_u32 s85, s72
s_cselect_b32 s94, 255, s94
s_cmp_eq_u32 s85, s73
s_cselect_b32 s94, 255, s94
s_cmp_eq_u32 s86, s72
s_cselect_b32 s95, 255, s95
s_cmp_eq_u32 s86, s73
s_cselect_b32 s95, 255, s95
v_add_u32 v2, 0, v12
v_cmp_eq_u32 vcc, s94, v2
v_cmp_eq_u32_e64 s[92:93], s95, v2
s_add_u32 s70, s74, 0
s_or_b64 exec, vcc, s[92:93]
s_cbranch_execz L_nodef0
buffer_store_dwordx4 v[96:99], v11, s[20:23], s70 offen nt
L_nodef0:
s_mov_b64 exec, -1
v_add_u32 v2, 8, v12
v_cmp_eq_u32 vcc, s94, v2
v_cmp_eq_u32_e64 s[92:93], s95, v2
s_add_u32 s70, s74, 16384
s_or_b64 exec, vcc, s[92:93]
s_cbranch_execz L_nodef1
buffer_store_dwordx4 v[100:103], v11, s[20:23], s70 offen nt
L_nodef1:
s_mov_b64 exec, -1
v_add_u32 v2, 16, v12
v_cmp_eq_u32 vcc, s94, v2
v_cmp_eq_u32_e64 s[92:93], s95, v2
s_add_u32 s70, s74, 32768
s_or_b64 exec, vcc, s[92:93]
s_cbranch_execz L_nodef2
buffer_store_dwordx4 v[104:107], v11, s[20:23], s70 offen nt
L_nodef2:
s_mov_b64 exec, -1
v_add_u32 v2, 24, v12
v_cmp_eq_u32 vcc, s94, v2
v_cmp_eq_u32_e64 s[92:93], s95, v2
s_add_u32 s70, s74, 49152
s_or_b64 exec, vcc, s[92:93]
s_cbranch_execz L_nodef3
buffer_store_dwordx4 v[108:111], v11, s[20:23], s70 offen nt
L_nodef3:
s_mov_b64 exec, -1
L_end:
s_endpgm
L_eg_rt:
s_add_u32 s78, s78, 1
s_cmp_gt_u32 s78, 65536
s_cbranch_scc1 L_eg_ok
s_add_u32 s70, s87, 0
buffer_load_dwordx4 v[20:23], v44, s[12:15], s70 offen sc1
s_add_u32 s70, s87, 4096
buffer_load_dwordx4 v[24:27], v44, s[12:15], s70 offen sc1
s_add_u32 s70, s87, 8192
buffer_load_dwordx4 v[28:31], v44, s[12:15], s70 offen sc1
s_add_u32 s70, s87, 12288
buffer_load_dwordx4 v[32:35], v44, s[12:15], s70 offen sc1
buffer_load_dwordx4 v[36:39], v45, s[12:15], s88 offen sc1
buffer_load_dwordx4 v[40:43], v46, s[12:15], 0 offen offset:0 sc1
s_waitcnt vmcnt(0)
s_branch L_eg_chk
L_kvrt:
s_add_u32 s78, s78, 1
s_cmp_gt_u32 s78, 65536
s_cbranch_scc1 L_kvok
s_bitcmp1_b32 s73, 0
s_cbranch_scc0 L_kvn0
v_cmp_eq_u32 vcc, -1, v84
s_cbranch_vccz L_kv0_p0
s_add_u32 s70, s65, 1
s_and_b32 s70, s70, 15
s_mul_i32 s70, s70, 4352
s_add_u32 s70, s70, s87
buffer_load_dwordx4 v[84:87], v18, s[12:15], s70 offen sc1
L_kv0_p0:
v_cmp_eq_u32 vcc, -1, v88
s_cbranch_vccz L_kv0_p1
s_add_u32 s70, s65, 2
s_and_b32 s70, s70, 15
s_mul_i32 s70, s70, 4352
s_add_u32 s70, s70, s87
buffer_load_dwordx4 v[88:91], v18, s[12:15], s70 offen sc1
L_kv0_p1:
v_cmp_eq_u32 vcc, -1, v92
s_cbranch_vccz L_kv0_p2
s_add_u32 s70, s65, 3
s_and_b32 s70, s70, 15
s_mul_i32 s70, s70, 4352
s_add_u32 s70, s70, s87
buffer_load_dwordx4 v[92:95], v18, s[12:15], s70 offen sc1
L_kv0_p2:
v_cmp_eq_u32 vcc, -1, v96
s_cbranch_vccz L_kv0_p3
s_add_u32 s70, s65, 4
s_and_b32 s70, s70, 15
s_mul_i32 s70, s70, 4352
s_add_u32 s70, s70, s87
buffer_load_dwordx4 v[96:99], v18, s[12:15], s70 offen sc1
L_kv0_p3:
L_kvn0:
s_bitcmp1_b32 s73, 1
s_cbranch_scc0 L_kvn1
v_cmp_eq_u32 vcc, -1, v100
s_cbranch_vccz L_kv1_p0
s_add_u32 s70, s65, 5
s_and_b32 s70, s70, 15
s_mul_i32 s70, s70, 4352
s_add_u32 s70, s70, s87
buffer_load_dwordx4 v[100:103], v18, s[12:15], s70 offen sc1
L_kv1_p0:
v_cmp_eq_u32 vcc, -1, v104
s_cbranch_vccz L_kv1_p1
s_add_u32 s70, s65, 6
s_and_b32 s70, s70, 15
s_mul_i32 s70, s70, 4352
s_add_u32 s70, s70, s87
buffer_load_dwordx4 v[104:107], v18, s[12:15], s70 offen sc1
L_kv1_p1:
v_cmp_eq_u32 vcc, -1, v108
s_cbranch_vccz L_kv1_p2
s_add_u32 s70, s65, 7
s_and_b32 s70, s70, 15
s_mul_i32 s70, s70, 4352
s_add_u32 s70, s70, s87
buffer_load_dwordx4 v[108:111], v18, s[12:15], s70 offen sc1
L_kv1_p2:
v_cmp_eq_u32 vcc, -1, v112
s_cbranch_vccz L_kv1_p3
s_add_u32 s70, s65, 8
s_and_b32 s70, s70, 15
s_mul_i32 s70, s70, 4352
s_add_u32 s70, s70, s87
buffer_load_dwordx4 v[112:115], v18, s[12:15], s70 offen sc1
L_kv1_p3:
L_kvn1:
s_bitcmp1_b32 s73, 2
s_cbranch_scc0 L_kvn2
v_cmp_eq_u32 vcc, -1, v116
s_cbranch_vccz L_kv2_p0
s_add_u32 s70, s65, 9
s_and_b32 s70, s70, 15
s_mul_i32 s70, s70, 4352
s_add_u32 s70, s70, s87
buffer_load_dwordx4 v[116:119], v18, s[12:15], s70 offen sc1
L_kv2_p0:
v_cmp_eq_u32 vcc, -1, v120
s_cbranch_vccz L_kv2_p1
s_add_u32 s70, s65, 10
s_and_b32 s70, s70, 15
s_mul_i32 s70, s70, 4352
s_add_u32 s70, s70, s87
buffer_load_dwordx4 v[120:123], v18, s[12:15], s70 offen sc1
L_kv2_p1:
v_cmp_eq_u32 vcc, -1, v124
s_cbranch_vccz L_kv2_p2
s_add_u32 s70, s65, 11
s_and_b32 s70, s70, 15
s_mul_i32 s70, s70, 4352
s_add_u32 s70, s70, s87
buffer_load_dwordx4 v[124:127], v18, s[12:15], s70 offen sc1
L_kv2_p2:
v_cmp_eq_u32 vcc, -1, v128
s_cbranch_vccz L_kv2_p3
s_add_u32 s70, s65, 12
s_and_b32 s70, s70, 15
s_mul_i32 s70, s70, 4352
s_add_u32 s70, s70, s87
buffer_load_dwordx4 v[128:131], v18, s[12:15], s70 offen sc1
L_kv2_p3:
L_kvn2:
s_bitcmp1_b32 s73, 3
s_cbranch_scc0 L_kvn3
v_cmp_eq_u32 vcc, -1, v132
s_cbranch_vccz L_kv3_p0
s_add_u32 s70, s65, 13
s_and_b32 s70, s70, 15
s_mul_i32 s70, s70, 4352
s_add_u32 s70, s70, s87
buffer_load_dwordx4 v[132:135], v18, s[12:15], s70 offen sc1
L_kv3_p0:
v_cmp_eq_u32 vcc, -1, v136
s_cbranch_vccz L_kv3_p1
s_add_u32 s70, s65, 14
s_and_b32 s70, s70, 15
s_mul_i32 s70, s70, 4352
s_add_u32 s70, s70, s87
buffer_load_dwordx4 v[136:139], v18, s[12:15], s70 offen sc1
L_kv3_p1:
v_cmp_eq_u32 vcc, -1, v140
s_cbranch_vccz L_kv3_p2
s_add_u32 s70, s65, 15
s_and_b32 s70, s70, 15
s_mul_i32 s70, s70, 4352
s_add_u32 s70, s70, s87
buffer_load_dwordx4 v[140:143], v18, s[12:15], s70 offen sc1
L_kv3_p2:
v_cmp_eq_u32 vcc, -1, v144
s_cbranch_vccz L_kv3_p3
s_add_u32 s70, s65, 16
s_and_b32 s70, s70, 15
s_mul_i32 s70, s70, 4352
s_add_u32 s70, s70, s87
buffer_load_dwordx4 v[144:147], v18, s[12:15], s70 offen sc1
L_kv3_p3:
L_kvn3:
s_bitcmp1_b32 s73, 4
s_cbranch_scc0 L_kvn4
buffer_load_dwordx4 v[148:151], v55, s[12:15], s88 offen sc1
L_kvn4:
s_waitcnt vmcnt(0)
s_branch L_kvr
L_pksame:
s_cmp_eq_u32 s73, 0
s_cbranch_scc1 L_pkf
s_add_u32 s78, s78, 1
s_cmp_le_u32 s78, 65536
s_cbranch_scc1 L_pk
s_branch L_pkf
L_pkx_rt:
s_add_u32 s78, s78, 1
s_cmp_gt_u32 s78, 65536
s_cbranch_scc1 L_pkx_ok
s_mov_b64 exec, s[92:93]
buffer_load_dwordx4 v[24:27], v58, s[12:15], 0 offen offset:0 sc1
buffer_load_dwordx4 v[28:31], v58, s[12:15], 0 offen offset:64 sc1
buffer_load_dwordx4 v[32:35], v58, s[12:15], 0 offen offset:128 sc1
buffer_load_dwordx4 v[36:39], v58, s[12:15], 0 offen offset:192 sc1
buffer_load_dwordx4 v[40:43], v58, s[12:15], 0 offen offset:256 sc1
buffer_load_dwordx4 v[44:47], v58, s[12:15], 0 offen offset:320 sc1
buffer_load_dwordx4 v[48:51], v58, s[12:15], 0 offen offset:384 sc1
buffer_load_dwordx4 v[52:55], v58, s[12:15], 0 offen offset:448 sc1
s_mov_b64 exec, -1
s_waitcnt vmcnt(0)
s_branch L_pkx_chk
L_pxp_s:
buffer_store_dwordx4 v[84:87], v60, s[12:15], s85 offen sc1
s_branch L_pxp_d
L_px_rt:
s_add_u32 s78, s78, 1
s_cmp_gt_u32 s78, 65536
s_cbranch_scc1 L_px_ok
v_and_b32 v2, s91, v24
v_cmp_ne_u32 vcc, 0, v2
v_xor_b32 v24, s84, v24
s_cbranch_vccz L_px_p0
buffer_load_dwordx4 v[24:27], v61, s[12:15], s86 offen offset:0 sc1
L_px_p0:
v_and_b32 v2, s91, v28
v_cmp_ne_u32 vcc, 0, v2
v_xor_b32 v28, s84, v28
s_cbranch_vccz L_px_p1
buffer_load_dwordx4 v[28:31], v61, s[12:15], s86 offen offset:1024 sc1
L_px_p1:
v_and_b32 v2, s91, v32
v_cmp_ne_u32 vcc, 0, v2
v_xor_b32 v32, s84, v32
s_cbranch_vccz L_px_p2
buffer_load_dwordx4 v[32:35], v61, s[12:15], s86 offen offset:2048 sc1
L_px_p2:
v_and_b32 v2, s91, v36
v_cmp_ne_u32 vcc, 0, v2
v_xor_b32 v36, s84, v36
s_cbranch_vccz L_px_p3
buffer_load_dwordx4 v[36:39], v61, s[12:15], s86 offen offset:3072 sc1
L_px_p3:
s_waitcnt vmcnt(0)
s_branch L_px_chk
L_h_rt:
s_add_u32 s78, s78, 1
s_cmp_gt_u32 s78, 65536
s_cbranch_scc1 L_h_ok
buffer_load_dwordx2 v[84:85], v64, s[12:15], s72 offen sc1
s_waitcnt vmcnt(0)
s_branch L_h_chk
L_y_rt:
s_add_u32 s78, s78, 1
s_cmp_gt_u32 s78, 65536
s_cbranch_scc1 L_y_ok
v_mov_b32 v88, s84
v_and_b32 v2, s91, v120
v_cmp_ne_u32 vcc, 0, v2
v_xor_b32 v120, s84, v120
s_cbranch_vccz L_y_p0
buffer_load_dwordx4 v[120:123], v18, s[12:15], s88 offen offset:0 sc1
L_y_p0:
v_and_b32 v2, s91, v124
v_cmp_ne_u32 vcc, 0, v2
v_xor_b32 v124, s84, v124
s_cbranch_vccz L_y_p1
buffer_load_dwordx4 v[124:127], v18, s[12:15], s88 offen offset:1024 sc1
L_y_p1:
v_and_b32 v2, s91, v128
v_cmp_ne_u32 vcc, 0, v2
v_xor_b32 v128, s84, v128
s_cbranch_vccz L_y_p2
buffer_load_dwordx4 v[128:131], v18, s[12:15], s88 offen offset:2048 sc1
L_y_p2:
v_and_b32 v2, s91, v132
v_cmp_ne_u32 vcc, 0, v2
v_xor_b32 v132, s84, v132
s_cbranch_vccz L_y_p3
buffer_load_dwordx4 v[132:135], v18, s[12:15], s88 offen offset:3072 sc1
L_y_p3:
v_and_b32 v2, s91, v136
v_cmp_ne_u32 vcc, 0, v2
v_xor_b32 v136, s84, v136
s_cbranch_vccz L_y_p4
buffer_load_dwordx4 v[136:139], v18, s[12:15], s71 offen offset:0 sc1
L_y_p4:
v_and_b32 v2, s91, v140
v_cmp_ne_u32 vcc, 0, v2
v_xor_b32 v140, s84, v140
s_cbranch_vccz L_y_p5
buffer_load_dwordx4 v[140:143], v18, s[12:15], s71 offen offset:1024 sc1
L_y_p5:
v_and_b32 v2, s91, v144
v_cmp_ne_u32 vcc, 0, v2
v_xor_b32 v144, s84, v144
s_cbranch_vccz L_y_p6
buffer_load_dwordx4 v[144:147], v18, s[12:15], s71 offen offset:2048 sc1
L_y_p6:
s_waitcnt vmcnt(0)
s_branch L_y_chk
L_kvp_s:
buffer_store_dwordx4 v[140:143], v16, s[12:15], s72 offen sc1
s_mov_b64 exec, s[92:93]
buffer_store_dwordx4 v[136:139], v4, s[12:15], s73 offen sc1
s_mov_b64 exec, -1
s_branch L_kvp_d
L_o0_rt:
s_add_u32 s78, s78, 1
s_cmp_gt_u32 s78, 65536
s_cbranch_scc1 L_o0_ok
s_add_u32 s70, s89, 0
s_and_b32 s70, s70, 15
s_lshl_b32 s70, s70, 11
buffer_load_dwordx4 v[56:59], v6, s[12:15], s70 offen offset:0 sc1
buffer_load_dwordx4 v[60:63], v19, s[12:15], s70 offen offset:0 sc1
buffer_load_dwordx4 v[64:67], v6, s[12:15], s70 offen offset:1024 sc1
buffer_load_dwordx4 v[68:71], v19, s[12:15], s70 offen offset:1024 sc1
s_add_u32 s70, s89, 1
s_and_b32 s70, s70, 15
s_lshl_b32 s70, s70, 11
buffer_load_dwordx4 v[72:75], v6, s[12:15], s70 offen offset:0 sc1
buffer_load_dwordx4 v[76:79], v19, s[12:15], s70 offen offset:0 sc1
buffer_load_dwordx4 v[80:83], v6, s[12:15], s70 offen offset:1024 sc1
buffer_load_dwordx4 v[84:87], v19, s[12:15], s70 offen offset:1024 sc1
s_add_u32 s70, s89, 2
s_and_b32 s70, s70, 15
s_lshl_b32 s70, s70, 11
buffer_load_dwordx4 v[88:91], v6, s[12:15], s70 offen offset:0 sc1
buffer_load_dwordx4 v[92:95], v19, s[12:15], s70 offen offset:0 sc1
buffer_load_dwordx4 v[96:99], v6, s[12:15], s70 offen offset:1024 sc1
buffer_load_dwordx4 v[100:103], v19, s[12:15], s70 offen offset:1024 sc1
s_waitcnt vmcnt(0)
s_branch L_o0_chk
L_o1_rt:
s_add_u32 s78, s78, 1
s_cmp_gt_u32 s78, 65536
s_cbranch_scc1 L_o1_ok
s_add_u32 s70, s89, 1
s_and_b32 s70, s70, 15
s_lshl_b32 s70, s70, 11
buffer_load_dwordx4 v[72:75], v6, s[12:15], s70 offen offset:0 sc1
buffer_load_dwordx4 v[76:79], v19, s[12:15], s70 offen offset:0 sc1
buffer_load_dwordx4 v[80:83], v6, s[12:15], s70 offen offset:1024 sc1
buffer_load_dwordx4 v[84:87], v19, s[12:15], s70 offen offset:1024 sc1
s_add_u32 s70, s89, 2
s_and_b32 s70, s70, 15
s_lshl_b32 s70, s70, 11
buffer_load_dwordx4 v[88:91], v6, s[12:15], s70 offen offset:0 sc1
buffer_load_dwordx4 v[92:95], v19, s[12:15], s70 offen offset:0 sc1
buffer_load_dwordx4 v[96:99], v6, s[12:15], s70 offen offset:1024 sc1
buffer_load_dwordx4 v[100:103], v19, s[12:15], s70 offen offset:1024 sc1
s_waitcnt vmcnt(0)
v_max3_u32 v2, v72, v76, v80
v_max_u32 v2, v2, v84
v_cmp_eq_u32 vcc, -1, v2
s_cbranch_vccnz L_o1_rt
s_branch L_o1_ok
L_o2_rt:
s_add_u32 s78, s78, 1
s_cmp_gt_u32 s78, 65536
s_cbranch_scc1 L_o2_ok
s_add_u32 s70, s89, 2
s_and_b32 s70, s70, 15
s_lshl_b32 s70, s70, 11
buffer_load_dwordx4 v[88:91], v6, s[12:15], s70 offen offset:0 sc1
buffer_load_dwordx4 v[92:95], v19, s[12:15], s70 offen offset:0 sc1
buffer_load_dwordx4 v[96:99], v6, s[12:15], s70 offen offset:1024 sc1
buffer_load_dwordx4 v[100:103], v19, s[12:15], s70 offen offset:1024 sc1
s_add_u32 s70, s89, 3
s_and_b32 s70, s70, 15
s_lshl_b32 s70, s70, 11
buffer_load_dwordx4 v[104:107], v6, s[12:15], s70 offen offset:0 sc1
buffer_load_dwordx4 v[108:111], v19, s[12:15], s70 offen offset:0 sc1
buffer_load_dwordx4 v[112:115], v6, s[12:15], s70 offen offset:1024 sc1
buffer_load_dwordx4 v[116:119], v19, s[12:15], s70 offen offset:1024 sc1
s_waitcnt vmcnt(0)
v_max3_u32 v2, v88, v92, v96
v_max_u32 v2, v2, v100
v_cmp_eq_u32 vcc, -1, v2
s_cbranch_vccnz L_o2_rt
s_branch L_o2_ok
L_o3_rt:
s_add_u32 s78, s78, 1
s_cmp_gt_u32 s78, 65536
s_cbranch_scc1 L_o3_ok
s_add_u32 s70, s89, 3
s_and_b32 s70, s70, 15
s_lshl_b32 s70, s70, 11
buffer_load_dwordx4 v[104:107], v6, s[12:15], s70 offen offset:0 sc1
buffer_load_dwordx4 v[108:111], v19, s[12:15], s70 offen offset:0 sc1
buffer_load_dwordx4 v[112:115], v6, s[12:15], s70 offen offset:1024 sc1
buffer_load_dwordx4 v[116:119], v19, s[12:15], s70 offen offset:1024 sc1
s_add_u32 s70, s89, 4
s_and_b32 s70, s70, 15
s_lshl_b32 s70, s70, 11
buffer_load_dwordx4 v[56:59], v6, s[12:15], s70 offen offset:0 sc1
buffer_load_dwordx4 v[60:63], v19, s[12:15], s70 offen offset:0 sc1
buffer_load_dwordx4 v[64:67], v6, s[12:15], s70 offen offset:1024 sc1
buffer_load_dwordx4 v[68:71], v19, s[12:15], s70 offen offset:1024 sc1
s_waitcnt vmcnt(0)
v_max3_u32 v2, v104, v108, v112
v_max_u32 v2, v2, v116
v_cmp_eq_u32 vcc, -1, v2
s_cbranch_vccnz L_o3_rt
s_branch L_o3_ok
L_o4_rt:
s_add_u32 s78, s78, 1
s_cmp_gt_u32 s78, 65536
s_cbranch_scc1 L_o4_ok
s_add_u32 s70, s89, 4
s_and_b32 s70, s70, 15
s_lshl_b32 s70, s70, 11
buffer_load_dwordx4 v[56:59], v6, s[12:15], s70 offen offset:0 sc1
buffer_load_dwordx4 v[60:63], v19, s[12:15], s70 offen offset:0 sc1
buffer_load_dwordx4 v[64:67], v6, s[12:15], s70 offen offset:1024 sc1
buffer_load_dwordx4 v[68:71], v19, s[12:15], s70 offen offset:1024 sc1
s_add_u32 s70, s89, 5
s_and_b32 s70, s70, 15
s_lshl_b32 s70, s70, 11
buffer_load_dwordx4 v[72:75], v6, s[12:15], s70 offen offset:0 sc1
buffer_load_dwordx4 v[76:79], v19, s[12:15], s70 offen offset:0 sc1
buffer_load_dwordx4 v[80:83], v6, s[12:15], s70 offen offset:1024 sc1
buffer_load_dwordx4 v[84:87], v19, s[12:15], s70 offen offset:1024 sc1
s_waitcnt vmcnt(0)
v_max3_u32 v2, v56, v60, v64
v_max_u32 v2, v2, v68
v_cmp_eq_u32 vcc, -1, v2
s_cbranch_vccnz L_o4_rt
s_branch L_o4_ok
L_o5_rt:
s_add_u32 s78, s78, 1
s_cmp_gt_u32 s78, 65536
s_cbranch_scc1 L_o5_ok
s_add_u32 s70, s89, 5
s_and_b32 s70, s70, 15
s_lshl_b32 s70, s70, 11
buffer_load_dwordx4 v[72:75], v6, s[12:15], s70 offen offset:0 sc1
buffer_load_dwordx4 v[76:79], v19, s[12:15], s70 offen offset:0 sc1
buffer_load_dwordx4 v[80:83], v6, s[12:15], s70 offen offset:1024 sc1
buffer_load_dwordx4 v[84:87], v19, s[12:15], s70 offen offset:1024 sc1
s_add_u32 s70, s89, 6
s_and_b32 s70, s70, 15
s_lshl_b32 s70, s70, 11
buffer_load_dwordx4 v[88:91], v6, s[12:15], s70 offen offset:0 sc1
buffer_load_dwordx4 v[92:95], v19, s[12:15], s70 offen offset:0 sc1
buffer_load_dwordx4 v[96:99], v6, s[12:15], s70 offen offset:1024 sc1
buffer_load_dwordx4 v[100:103], v19, s[12:15], s70 offen offset:1024 sc1
s_waitcnt vmcnt(0)
v_max3_u32 v2, v72, v76, v80
v_max_u32 v2, v2, v84
v_cmp_eq_u32 vcc, -1, v2
s_cbranch_vccnz L_o5_rt
s_branch L_o5_ok
L_o6_rt:
s_add_u32 s78, s78, 1
s_cmp_gt_u32 s78, 65536
s_cbranch_scc1 L_o6_ok
s_add_u32 s70, s89, 6
s_and_b32 s70, s70, 15
s_lshl_b32 s70, s70, 11
buffer_load_dwordx4 v[88:91], v6, s[12:15], s70 offen offset:0 sc1
buffer_load_dwordx4 v[92:95], v19, s[12:15], s70 offen offset:0 sc1
buffer_load_dwordx4 v[96:99], v6, s[12:15], s70 offen offset:1024 sc1
buffer_load_dwordx4 v[100:103], v19, s[12:15], s70 offen offset:1024 sc1
s_add_u32 s70, s89, 7
s_and_b32 s70, s70, 15
s_lshl_b32 s70, s70, 11
buffer_load_dwordx4 v[104:107], v6, s[12:15], s70 offen offset:0 sc1
buffer_load_dwordx4 v[108:111], v19, s[12:15], s70 offen offset:0 sc1
buffer_load_dwordx4 v[112:115], v6, s[12:15], s70 offen offset:1024 sc1
buffer_load_dwordx4 v[116:119], v19, s[12:15], s70 offen offset:1024 sc1
s_waitcnt vmcnt(0)
v_max3_u32 v2, v88, v92, v96
v_max_u32 v2, v2, v100
v_cmp_eq_u32 vcc, -1, v2
s_cbranch_vccnz L_o6_rt
s_branch L_o6_ok
L_o7_rt:
s_add_u32 s78, s78, 1
s_cmp_gt_u32 s78, 65536
s_cbranch_scc1 L_o7_ok
s_add_u32 s70, s89, 7
s_and_b32 s70, s70, 15
s_lshl_b32 s70, s70, 11
buffer_load_dwordx4 v[104:107], v6, s[12:15], s70 offen offset:0 sc1
buffer_load_dwordx4 v[108:111], v19, s[12:15], s70 offen offset:0 sc1
buffer_load_dwordx4 v[112:115], v6, s[12:15], s70 offen offset:1024 sc1
buffer_load_dwordx4 v[116:119], v19, s[12:15], s70 offen offset:1024 sc1
s_add_u32 s70, s89, 8
s_and_b32 s70, s70, 15
s_lshl_b32 s70, s70, 11
buffer_load_dwordx4 v[56:59], v6, s[12:15], s70 offen offset:0 sc1
buffer_load_dwordx4 v[60:63], v19, s[12:15], s70 offen offset:0 sc1
buffer_load_dwordx4 v[64:67], v6, s[12:15], s70 offen offset:1024 sc1
buffer_load_dwordx4 v[68:71], v19, s[12:15], s70 offen offset:1024 sc1
s_waitcnt vmcnt(0)
v_max3_u32 v2, v104, v108, v112
v_max_u32 v2, v2, v116
v_cmp_eq_u32 vcc, -1, v2
s_cbranch_vccnz L_o7_rt
s_branch L_o7_ok
L_o8_rt:
s_add_u32 s78, s78, 1
s_cmp_gt_u32 s78, 65536
s_cbranch_scc1 L_o8_ok
s_add_u32 s70, s89, 8
s_and_b32 s70, s70, 15
s_lshl_b32 s70, s70, 11
buffer_load_dwordx4 v[56:59], v6, s[12:15], s70 offen offset:0 sc1
buffer_load_dwordx4 v[60:63], v19, s[12:15], s70 offen offset:0 sc1
buffer_load_dwordx4 v[64:67], v6, s[12:15], s70 offen offset:1024 sc1
buffer_load_dwordx4 v[68:71], v19, s[12:15], s70 offen offset:1024 sc1
s_add_u32 s70, s89, 9
s_and_b32 s70, s70, 15
s_lshl_b32 s70, s70, 11
buffer_load_dwordx4 v[72:75], v6, s[12:15], s70 offen offset:0 sc1
buffer_load_dwordx4 v[76:79], v19, s[12:15], s70 offen offset:0 sc1
buffer_load_dwordx4 v[80:83], v6, s[12:15], s70 offen offset:1024 sc1
buffer_load_dwordx4 v[84:87], v19, s[12:15], s70 offen offset:1024 sc1
s_waitcnt vmcnt(0)
v_max3_u32 v2, v56, v60, v64
v_max_u32 v2, v2, v68
v_cmp_eq_u32 vcc, -1, v2
s_cbranch_vccnz L_o8_rt
s_branch L_o8_ok
L_o9_rt:
s_add_u32 s78, s78, 1
s_cmp_gt_u32 s78, 65536
s_cbranch_scc1 L_o9_ok
s_add_u32 s70, s89, 9
s_and_b32 s70, s70, 15
s_lshl_b32 s70, s70, 11
buffer_load_dwordx4 v[72:75], v6, s[12:15], s70 offen offset:0 sc1
buffer_load_dwordx4 v[76:79], v19, s[12:15], s70 offen offset:0 sc1
buffer_load_dwordx4 v[80:83], v6, s[12:15], s70 offen offset:1024 sc1
buffer_load_dwordx4 v[84:87], v19, s[12:15], s70 offen offset:1024 sc1
s_add_u32 s70, s89, 10
s_and_b32 s70, s70, 15
s_lshl_b32 s70, s70, 11
buffer_load_dwordx4 v[88:91], v6, s[12:15], s70 offen offset:0 sc1
buffer_load_dwordx4 v[92:95], v19, s[12:15], s70 offen offset:0 sc1
buffer_load_dwordx4 v[96:99], v6, s[12:15], s70 offen offset:1024 sc1
buffer_load_dwordx4 v[100:103], v19, s[12:15], s70 offen offset:1024 sc1
s_waitcnt vmcnt(0)
v_max3_u32 v2, v72, v76, v80
v_max_u32 v2, v2, v84
v_cmp_eq_u32 vcc, -1, v2
s_cbranch_vccnz L_o9_rt
s_branch L_o9_ok
L_o10_rt:
s_add_u32 s78, s78, 1
s_cmp_gt_u32 s78, 65536
s_cbranch_scc1 L_o10_ok
s_add_u32 s70, s89, 10
s_and_b32 s70, s70, 15
s_lshl_b32 s70, s70, 11
buffer_load_dwordx4 v[88:91], v6, s[12:15], s70 offen offset:0 sc1
buffer_load_dwordx4 v[92:95], v19, s[12:15], s70 offen offset:0 sc1
buffer_load_dwordx4 v[96:99], v6, s[12:15], s70 offen offset:1024 sc1
buffer_load_dwordx4 v[100:103], v19, s[12:15], s70 offen offset:1024 sc1
s_add_u32 s70, s89, 11
s_and_b32 s70, s70, 15
s_lshl_b32 s70, s70, 11
buffer_load_dwordx4 v[104:107], v6, s[12:15], s70 offen offset:0 sc1
buffer_load_dwordx4 v[108:111], v19, s[12:15], s70 offen offset:0 sc1
buffer_load_dwordx4 v[112:115], v6, s[12:15], s70 offen offset:1024 sc1
buffer_load_dwordx4 v[116:119], v19, s[12:15], s70 offen offset:1024 sc1
s_waitcnt vmcnt(0)
v_max3_u32 v2, v88, v92, v96
v_max_u32 v2, v2, v100
v_cmp_eq_u32 vcc, -1, v2
s_cbranch_vccnz L_o10_rt
s_branch L_o10_ok
L_o11_rt:
s_add_u32 s78, s78, 1
s_cmp_gt_u32 s78, 65536
s_cbranch_scc1 L_o11_ok
s_add_u32 s70, s89, 11
s_and_b32 s70, s70, 15
s_lshl_b32 s70, s70, 11
buffer_load_dwordx4 v[104:107], v6, s[12:15], s70 offen offset:0 sc1
buffer_load_dwordx4 v[108:111], v19, s[12:15], s70 offen offset:0 sc1
buffer_load_dwordx4 v[112:115], v6, s[12:15], s70 offen offset:1024 sc1
buffer_load_dwordx4 v[116:119], v19, s[12:15], s70 offen offset:1024 sc1
s_add_u32 s70, s89, 12
s_and_b32 s70, s70, 15
s_lshl_b32 s70, s70, 11
buffer_load_dwordx4 v[56:59], v6, s[12:15], s70 offen offset:0 sc1
buffer_load_dwordx4 v[60:63], v19, s[12:15], s70 offen offset:0 sc1
buffer_load_dwordx4 v[64:67], v6, s[12:15], s70 offen offset:1024 sc1
buffer_load_dwordx4 v[68:71], v19, s[12:15], s70 offen offset:1024 sc1
s_waitcnt vmcnt(0)
v_max3_u32 v2, v104, v108, v112
v_max_u32 v2, v2, v116
v_cmp_eq_u32 vcc, -1, v2
s_cbranch_vccnz L_o11_rt
s_branch L_o11_ok
L_o12_rt:
s_add_u32 s78, s78, 1
s_cmp_gt_u32 s78, 65536
s_cbranch_scc1 L_o12_ok
s_add_u32 s70, s89, 12
s_and_b32 s70, s70, 15
s_lshl_b32 s70, s70, 11
buffer_load_dwordx4 v[56:59], v6, s[12:15], s70 offen offset:0 sc1
buffer_load_dwordx4 v[60:63], v19, s[12:15], s70 offen offset:0 sc1
buffer_load_dwordx4 v[64:67], v6, s[12:15], s70 offen offset:1024 sc1
buffer_load_dwordx4 v[68:71], v19, s[12:15], s70 offen offset:1024 sc1
s_add_u32 s70, s89, 13
s_and_b32 s70, s70, 15
s_lshl_b32 s70, s70, 11
buffer_load_dwordx4 v[72:75], v6, s[12:15], s70 offen offset:0 sc1
buffer_load_dwordx4 v[76:79], v19, s[12:15], s70 offen offset:0 sc1
buffer_load_dwordx4 v[80:83], v6, s[12:15], s70 offen offset:1024 sc1
buffer_load_dwordx4 v[84:87], v19, s[12:15], s70 offen offset:1024 sc1
s_waitcnt vmcnt(0)
v_max3_u32 v2, v56, v60, v64
v_max_u32 v2, v2, v68
v_cmp_eq_u32 vcc, -1, v2
s_cbranch_vccnz L_o12_rt
s_branch L_o12_ok
L_o13_rt:
s_add_u32 s78, s78, 1
s_cmp_gt_u32 s78, 65536
s_cbranch_scc1 L_o13_ok
s_add_u32 s70, s89, 13
s_and_b32 s70, s70, 15
s_lshl_b32 s70, s70, 11
buffer_load_dwordx4 v[72:75], v6, s[12:15], s70 offen offset:0 sc1
buffer_load_dwordx4 v[76:79], v19, s[12:15], s70 offen offset:0 sc1
buffer_load_dwordx4 v[80:83], v6, s[12:15], s70 offen offset:1024 sc1
buffer_load_dwordx4 v[84:87], v19, s[12:15], s70 offen offset:1024 sc1
s_add_u32 s70, s89, 14
s_and_b32 s70, s70, 15
s_lshl_b32 s70, s70, 11
buffer_load_dwordx4 v[88:91], v6, s[12:15], s70 offen offset:0 sc1
buffer_load_dwordx4 v[92:95], v19, s[12:15], s70 offen offset:0 sc1
buffer_load_dwordx4 v[96:99], v6, s[12:15], s70 offen offset:1024 sc1
buffer_load_dwordx4 v[100:103], v19, s[12:15], s70 offen offset:1024 sc1
s_waitcnt vmcnt(0)
v_max3_u32 v2, v72, v76, v80
v_max_u32 v2, v2, v84
v_cmp_eq_u32 vcc, -1, v2
s_cbranch_vccnz L_o13_rt
s_branch L_o13_ok
L_o14_rt:
s_add_u32 s78, s78, 1
s_cmp_gt_u32 s78, 65536
s_cbranch_scc1 L_o14_ok
s_add_u32 s70, s89, 14
s_and_b32 s70, s70, 15
s_lshl_b32 s70, s70, 11
buffer_load_dwordx4 v[88:91], v6, s[12:15], s70 offen offset:0 sc1
buffer_load_dwordx4 v[92:95], v19, s[12:15], s70 offen offset:0 sc1
buffer_load_dwordx4 v[96:99], v6, s[12:15], s70 offen offset:1024 sc1
buffer_load_dwordx4 v[100:103], v19, s[12:15], s70 offen offset:1024 sc1
s_add_u32 s70, s89, 15
s_and_b32 s70, s70, 15
s_lshl_b32 s70, s70, 11
buffer_load_dwordx4 v[104:107], v6, s[12:15], s70 offen offset:0 sc1
buffer_load_dwordx4 v[108:111], v19, s[12:15], s70 offen offset:0 sc1
buffer_load_dwordx4 v[112:115], v6, s[12:15], s70 offen offset:1024 sc1
buffer_load_dwordx4 v[116:119], v19, s[12:15], s70 offen offset:1024 sc1
s_waitcnt vmcnt(0)
v_max3_u32 v2, v88, v92, v96
v_max_u32 v2, v2, v100
v_cmp_eq_u32 vcc, -1, v2
s_cbranch_vccnz L_o14_rt
s_branch L_o14_ok
L_o15_rt:
s_add_u32 s78, s78, 1
s_cmp_gt_u32 s78, 65536
s_cbranch_scc1 L_o15_ok
s_add_u32 s70, s89, 15
s_and_b32 s70, s70, 15
s_lshl_b32 s70, s70, 11
buffer_load_dwordx4 v[104:107], v6, s[12:15], s70 offen offset:0 sc1
buffer_load_dwordx4 v[108:111], v19, s[12:15], s70 offen offset:0 sc1
buffer_load_dwordx4 v[112:115], v6, s[12:15], s70 offen offset:1024 sc1
buffer_load_dwordx4 v[116:119], v19, s[12:15], s70 offen offset:1024 sc1
s_waitcnt vmcnt(0)
v_max3_u32 v2, v104, v108, v112
v_max_u32 v2, v2, v116
v_cmp_eq_u32 vcc, -1, v2
s_cbranch_vccnz L_o15_rt
s_branch L_o15_ok
L_stp_s:
buffer_store_dwordx4 v[72:75], v144, s[12:15], s72 offen offset:0 sc1
buffer_store_dwordx4 v[76:79], v144, s[12:15], s72 offen offset:256 sc1
s_branch L_stp_d
L_st_rt:
s_add_u32 s78, s78, 1
s_cmp_gt_u32 s78, 65536
s_cbranch_scc1 L_st_ok
v_cmp_ne_u32 vcc, s68, v99
s_cbranch_vccz L_st_p0
s_add_u32 s70, s75, 0
buffer_load_dwordx4 v[96:99], v145, s[12:15], s70 offen sc1
L_st_p0:
v_cmp_ne_u32 vcc, s68, v103
s_cbranch_vccz L_st_p1
s_add_u32 s70, s75, 4096
buffer_load_dwordx4 v[100:103], v145, s[12:15], s70 offen sc1
L_st_p1:
v_cmp_ne_u32 vcc, s68, v107
s_cbranch_vccz L_st_p2
s_add_u32 s70, s75, 8192
buffer_load_dwordx4 v[104:107], v145, s[12:15], s70 offen sc1
L_st_p2:
v_cmp_ne_u32 vcc, s68, v111
s_cbranch_vccz L_st_p3
s_add_u32 s70, s75, 12288
buffer_load_dwordx4 v[108:111], v145, s[12:15], s70 offen sc1
L_st_p3:
v_cmp_ne_u32 vcc, s68, v115
s_cbranch_vccz L_st_p4
s_add_u32 s70, s75, 16384
buffer_load_dwordx4 v[112:115], v145, s[12:15], s70 offen sc1
L_st_p4:
v_cmp_ne_u32 vcc, s68, v119
s_cbranch_vccz L_st_p5
s_add_u32 s70, s75, 20480
buffer_load_dwordx4 v[116:119], v145, s[12:15], s70 offen sc1
L_st_p5:
v_cmp_ne_u32 vcc, s68, v123
s_cbranch_vccz L_st_p6
s_add_u32 s70, s75, 24576
buffer_load_dwordx4 v[120:123], v145, s[12:15], s70 offen sc1
L_st_p6:
v_cmp_ne_u32 vcc, s68, v127
s_cbranch_vccz L_st_p7
s_add_u32 s70, s75, 28672
buffer_load_dwordx4 v[124:127], v145, s[12:15], s70 offen sc1
L_st_p7:
s_waitcnt vmcnt(0)
s_branch L_st_chk
L_fin:
.section .rodata,"a"
.p2align 6
.amdhsa_kernel sequential_preLN__linear_attn_block__moe_arch_mod__prompt_kernel
  .amdhsa_next_free_vgpr 256
  .amdhsa_next_free_sgpr 102
  .amdhsa_accum_offset 152
  .amdhsa_group_segment_fixed_size 0
  .amdhsa_kernarg_size 88
  .amdhsa_user_sgpr_count 2
  .amdhsa_user_sgpr_kernarg_segment_ptr 1
  .amdhsa_system_sgpr_workgroup_id_x 1
  .amdhsa_float_denorm_mode_32 3
.end_amdhsa_kernel
```

```asm
; @launch grid=(256,1,1) block=(512,1,1) lds=163840
.amdgcn_target "amdgcn-amd-amdhsa--gfx950"
.text
.p2alignl 12, 0xbf810000
.fill 832, 4, 0xbf810000
.globl sequential_preLN__linear_attn_block__moe_arch_mod__prompt_kernel
.p2align 8
.type sequential_preLN__linear_attn_block__moe_arch_mod__prompt_kernel,@function
sequential_preLN__linear_attn_block__moe_arch_mod__prompt_kernel:
s_cmp_ge_u32 s2, 256
s_cbranch_scc1 L_end
s_load_dwordx16 s[40:55], s[0:1], 0
s_load_dwordx2 s[56:57], s[0:1], 64
s_load_dwordx2 s[58:59], s[0:1], 80
s_getpc_b64 s[20:21]
L_pc:
s_sub_u32 s20, s20, L_pc-sequential_preLN__linear_attn_block__moe_arch_mod__prompt_kernel
s_subb_u32 s21, s21, 0
s_and_b32 s21, s21, 0xffff
s_mov_b32 s22, L_fin-sequential_preLN__linear_attn_block__moe_arch_mod__prompt_kernel
s_mov_b32 s23, 0x20000
s_lshr_b32 s70, s2, 3
s_mul_i32 s70, s70, 1536
v_lshlrev_b32 v81, 7, v0
v_cmp_gt_u32 vcc, 12, v0
s_nop 0
s_mov_b64 exec, vcc
buffer_load_dword v81, v81, s[20:23], s70 offen
s_mov_b64 exec, -1
v_lshrrev_b32 v2, 6, v0
v_and_b32 v1, 63, v0
v_readfirstlane_b32 s60, v2
s_and_b32 s62, s2, 7
s_lshr_b32 s63, s2, 3
s_lshl_b32 s64, s62, 1
s_and_b32 s70, s63, 1
s_add_u32 s64, s64, s70
s_lshr_b32 s65, s63, 1
s_lshl_b32 s79, s64, 4
s_add_u32 s79, s79, s65
s_mov_b32 s78, 0
s_mov_b32 s89, s65
s_lshr_b32 s61, s60, 2
s_and_b32 s60, s60, 3
s_lshr_b32 s66, s60, 1
s_and_b32 s67, s60, 1
v_lshlrev_b32 v16, 4, v1
s_cmp_eq_u32 s61, 0
s_cbranch_scc1 L_compute
s_setprio 1
v_mov_b32 v18, v16
s_lshl_b32 s70, s65, 2
s_add_u32 s70, s70, s60
s_lshl_b32 s70, s70, 16
v_lshrrev_b32 v2, 3, v1
v_lshlrev_b32 v5, 11, v2
v_add_u32 v5, s70, v5
v_lshrrev_b32 v3, 4, v1
v_and_b32 v4, 7, v1
v_xor_b32 v3, v3, v4
v_xor_b32 v6, 0, v3
v_lshl_add_u32 v6, v6, 4, v5
v_add_u32 v8, 0, v6
v_xor_b32 v6, 4, v3
v_lshl_add_u32 v6, v6, 4, v5
v_add_u32 v9, 15360, v6
v_xor_b32 v6, 0, v3
v_lshl_add_u32 v6, v6, 4, v5
v_add_u32 v10, 30720, v6
v_xor_b32 v6, 4, v3
v_lshl_add_u32 v6, v6, 4, v5
v_add_u32 v11, 46080, v6
s_lshl_b32 s70, s60, 4
v_add_u32 v5, s70, v2
v_mul_u32_u24 v5, 6144, v5
s_lshl_b32 s70, s64, 7
v_add_u32 v5, s70, v5
v_bfe_u32 v3, v1, 4, 1
v_lshlrev_b32 v3, 1, v3
v_xor_b32 v3, v3, v4
v_xor_b32 v6, 0, v3
v_lshl_add_u32 v6, v6, 4, v5
v_add_u32 v12, 0, v6
v_xor_b32 v6, 4, v3
v_lshl_add_u32 v6, v6, 4, v5
v_add_u32 v13, 48128, v6
v_xor_b32 v6, 0, v3
v_lshl_add_u32 v6, v6, 4, v5
v_add_u32 v14, 0, v6
v_xor_b32 v6, 4, v3
v_lshl_add_u32 v6, v6, 4, v5
v_add_u32 v15, 48128, v6
v_xor_b32 v6, 0, v3
v_lshl_add_u32 v6, v6, 4, v5
v_add_u32 v16, 4096, v6
v_xor_b32 v6, 4, v3
v_lshl_add_u32 v6, v6, 4, v5
v_add_u32 v17, 52224, v6
s_lshl_b32 s76, s60, 12
s_mul_i32 s77, s60, 6144
s_and_b32 s70, s64, 1
s_lshl_b32 s70, s70, 3
s_mov_b32 s70, 0
s_andn2_b32 s71, s65, 1
s_add_u32 s70, s70, s71
s_and_b32 s70, s70, 15
s_mul_i32 s75, s70, 393216
s_lshl_b32 s74, s70, 7
s_waitcnt lgkmcnt(0)
s_load_dword s68, s[58:59], 0
s_mov_b32 s4, s40
s_and_b32 s5, s41, 0xffff
s_mov_b32 s6, 4194304
s_mov_b32 s7, 0x20000
s_mov_b32 s8, s42
s_and_b32 s9, s43, 0xffff
s_mov_b32 s10, 6291456
s_mov_b32 s11, 0x20000
s_add_u32 m0, s76, 122880
s_nop 0
buffer_load_dwordx4 v8, s[4:7], s74 offen offset:0 lds
buffer_load_dwordx4 v9, s[4:7], s74 offen offset:1024 lds
buffer_load_dwordx4 v10, s[4:7], s74 offen offset:2048 lds
buffer_load_dwordx4 v11, s[4:7], s74 offen offset:3072 lds
s_add_u32 s74, s74, 128
s_and_b32 s74, s74, 2047
s_add_u32 m0, s77, 0
s_nop 0
buffer_load_dwordx4 v12, s[8:11], s75 offen offset:0 lds
buffer_load_dwordx4 v13, s[8:11], s75 offen offset:1024 lds
buffer_load_dwordx4 v14, s[8:11], s75 offen offset:2048 lds
buffer_load_dwordx4 v15, s[8:11], s75 offen offset:3072 lds
s_add_u32 m0, s77, 4096
s_nop 0
buffer_load_dwordx4 v16, s[8:11], s75 offen offset:0 lds
buffer_load_dwordx4 v17, s[8:11], s75 offen offset:1024 lds
s_add_u32 s75, s75, 393216
s_cmp_eq_u32 s75, 6291456
s_cselect_b32 s75, 0, s75
s_mov_b32 s12, s58
s_and_b32 s13, s59, 0xffff
s_mov_b32 s14, 268435456
s_mov_b32 s15, 0x20000
s_mov_b32 s16, s44
s_and_b32 s17, s45, 0xffff
s_mov_b32 s18, 2097152
s_mov_b32 s19, 0x20000
s_mov_b32 s20, s56
s_and_b32 s21, s57, 0xffff
s_mov_b32 s22, 4194304
s_mov_b32 s23, 0x20000
s_mov_b32 s24, s50
s_and_b32 s25, s51, 0xffff
s_mov_b32 s26, 7340032
s_mov_b32 s27, 0x20000
s_mov_b32 s28, s52
s_and_b32 s29, s53, 0xffff
s_mov_b32 s30, 7340032
s_mov_b32 s31, 0x20000
s_mov_b32 s32, s54
s_and_b32 s33, s55, 0xffff
s_mov_b32 s34, 7340032
s_mov_b32 s35, 0x20000
s_mov_b32 s36, s48
s_and_b32 s37, s49, 0xffff
s_mov_b32 s38, 2048
s_mov_b32 s39, 0x20000
s_lshl_b32 s70, s65, 7
s_lshl_b32 s71, s64, 3
s_add_u32 s70, s70, s71
s_lshl_b32 s71, s60, 1
s_add_u32 s87, s70, s71
v_lshrrev_b32 v2, 3, v1
v_lshlrev_b32 v3, 11, v2
v_bfe_u32 v5, v1, 4, 2
v_lshlrev_b32 v5, 1, v5
v_and_b32 v4, 7, v1
v_xor_b32 v5, v5, v4
v_lshl_add_u32 v3, v5, 4, v3
s_lshl_b32 s70, s65, 7
v_add_u32 v80, s70, v3
v_mov_b32 v72, -1
v_mov_b32 v73, -1
v_mov_b32 v74, -1
v_mov_b32 v75, -1
s_mul_i32 s80, s79, 4352
s_add_u32 s80, s80, 524288
s_lshl_b32 s81, s65, 18
s_lshl_b32 s70, s66, 17
s_add_u32 s81, s81, s70
s_lshl_b32 s70, s64, 11
s_add_u32 s81, s81, s70
s_lshl_b32 s70, s67, 10
s_add_u32 s81, s81, s70
s_add_u32 s81, s81, 2097152
s_mov_b32 s72, 0x6543e210
s_mov_b32 s73, 0xdcbaf987
s_lshl_b32 s70, s64, 2
s_lshr_b64 s[72:73], s[72:73], s70
s_and_b32 s3, s72, 15
v_mul_u32_u24 v76, 7168, v2
v_lshl_add_u32 v76, v4, 4, v76
v_lshlrev_b32 v77, 11, v2
v_lshl_add_u32 v77, v4, 4, v77
s_and_b32 s70, s65, 3
s_lshl_b32 s70, s70, 2
s_add_u32 s70, s70, s60
s_mul_i32 s85, s70, 458752
s_lshr_b32 s70, s65, 2
s_lshl2_add_u32 s70, s3, s70
s_lshl_b32 s70, s70, 7
s_add_u32 s85, s85, s70
s_and_b32 s70, s65, 3
s_lshl2_add_u32 s70, s3, s70
s_and_b32 s71, s65, 12
s_add_u32 s71, s71, s60
s_lshl_b32 s86, s70, 17
s_lshl_b32 s70, s71, 7
s_add_u32 s86, s86, s70
s_cmp_lt_u32 s3, 14
s_cselect_b32 s26, s26, 0
s_cselect_b32 s30, s30, 0
s_cselect_b32 s34, s34, 0
s_mov_b32 s90, 0x10001
s_movk_i32 s91, 0xff
v_mov_b32 v79, 0
s_lshl_b32 s70, s87, 4
s_add_u32 s70, s70, 8192
v_writelane_b32 v79, s70, 0
s_lshl_b32 s70, s79, 4
s_add_u32 s70, s70, 4096
v_writelane_b32 v79, s70, 1
s_lshl_b32 s70, s64, 7
s_add_u32 s70, s70, 6815744
v_writelane_b32 v79, s70, 2
s_lshl_b32 s70, s79, 10
s_add_u32 s70, s70, 65536
v_writelane_b32 v79, s70, 3
s_lshl_b32 s70, s60, 10
s_add_u32 s70, s70, s80
v_writelane_b32 v79, s70, 4
s_lshl_b32 s70, s67, 7
s_add_u32 s70, s70, s80
s_add_u32 s70, s70, 4096
v_writelane_b32 v79, s70, 5
s_and_b32 s71, s65, 3
s_lshl2_add_u32 s71, s3, s71
s_and_b32 s70, s65, 12
s_add_u32 s70, s70, s60
s_lshl_b32 s71, s71, 7
s_lshl_b32 s70, s70, 15
s_add_u32 s70, s70, s71
s_add_u32 s70, s70, 7340032
v_writelane_b32 v79, s70, 6
s_lshl_b32 s71, s79, 2
s_add_u32 s71, s71, s60
s_lshl_b32 s70, s71, 9
s_add_u32 s70, s70, 6291456
v_writelane_b32 v79, s70, 7
s_lshl_b32 s71, s79, 2
s_add_u32 s71, s71, s60
s_lshl_b32 s70, s71, 8
s_add_u32 s70, s70, 6946816
v_writelane_b32 v79, s70, 8
s_add_u32 s70, s81, 0
v_writelane_b32 v79, s70, 9
s_add_u32 s70, s81, 32768
v_writelane_b32 v79, s70, 10
s_add_u32 s70, s81, 65536
v_writelane_b32 v79, s70, 11
s_add_u32 s70, s81, 98304
v_writelane_b32 v79, s70, 12
s_and_b32 s70, s65, 7
s_min_u32 s71, s60, 0
s_lshl_b32 s71, s71, 3
s_add_u32 s70, s70, s71
s_lshl_b32 s70, s70, 4
s_add_u32 s70, s70, s64
s_lshl_b32 s70, s70, 7
s_add_u32 s70, s70, 6815744
v_writelane_b32 v79, s70, 2
v_and_b32 v2, 7, v1
v_lshlrev_b32 v2, 7, v2
v_lshrrev_b32 v3, 3, v1
v_lshl_add_u32 v83, v3, 15, v2
v_add_u32 v83, s81, v83
s_mov_b32 exec_lo, 0
s_and_b32 s71, s65, 3
s_lshl2_add_u32 s71, s3, s71
s_and_b32 s70, s65, 12
s_add_u32 s70, s70, s60
s_lshl_b32 s71, s71, 7
s_lshl_b32 s70, s70, 15
s_add_u32 s70, s70, s71
s_add_u32 s70, s70, 7340032
s_mov_b32 exec_hi, 0xff
v_and_b32 v2, 3, v1
v_lshl_add_u32 v83, v2, 13, s70
s_lshl_b32 s70, s60, 10
s_add_u32 s70, s70, s80
s_mov_b32 exec_hi, 0xff0000
v_and_b32 v2, 7, v1
v_lshl_add_u32 v83, v2, 7, s70
s_lshl_b32 s71, s79, 2
s_add_u32 s71, s71, s60
s_lshl_b32 s70, s71, 9
s_add_u32 s70, s70, 6291456
s_mov_b32 exec_hi, 0xf000000
v_and_b32 v2, 3, v1
v_lshl_add_u32 v83, v2, 7, s70
s_lshl_b32 s71, s79, 2
s_add_u32 s71, s71, s60
s_lshl_b32 s70, s71, 8
s_add_u32 s70, s70, 6946816
s_mov_b32 exec_hi, 0x30000000
v_and_b32 v2, 1, v1
v_lshl_add_u32 v83, v2, 7, s70
s_lshl_b32 s70, s67, 7
s_add_u32 s70, s70, s80
s_add_u32 s70, s70, 4096
s_mov_b32 exec_hi, 0xc0000000
v_and_b32 v2, 0, v1
v_lshl_add_u32 v83, v2, 7, s70
s_mov_b64 exec, -1
s_add_u32 m0, s76, 106496
s_nop 0
buffer_load_dwordx4 v8, s[4:7], s74 offen offset:0 lds
buffer_load_dwordx4 v9, s[4:7], s74 offen offset:1024 lds
buffer_load_dwordx4 v10, s[4:7], s74 offen offset:2048 lds
buffer_load_dwordx4 v11, s[4:7], s74 offen offset:3072 lds
s_add_u32 s74, s74, 128
s_and_b32 s74, s74, 2047
s_add_u32 m0, s77, 81920
s_nop 0
buffer_load_dwordx4 v12, s[8:11], s75 offen offset:0 lds
buffer_load_dwordx4 v13, s[8:11], s75 offen offset:1024 lds
buffer_load_dwordx4 v14, s[8:11], s75 offen offset:2048 lds
buffer_load_dwordx4 v15, s[8:11], s75 offen offset:3072 lds
s_add_u32 m0, s77, 86016
s_nop 0
buffer_load_dwordx4 v16, s[8:11], s75 offen offset:0 lds
buffer_load_dwordx4 v17, s[8:11], s75 offen offset:1024 lds
s_add_u32 s75, s75, 393216
s_cmp_eq_u32 s75, 6291456
s_cselect_b32 s75, 0, s75
s_waitcnt vmcnt(10)
s_barrier
s_add_u32 m0, s76, 65536
s_nop 0
buffer_load_dwordx4 v8, s[4:7], s74 offen offset:0 lds
buffer_load_dwordx4 v9, s[4:7], s74 offen offset:1024 lds
buffer_load_dwordx4 v10, s[4:7], s74 offen offset:2048 lds
buffer_load_dwordx4 v11, s[4:7], s74 offen offset:3072 lds
s_add_u32 s74, s74, 128
s_and_b32 s74, s74, 2047
s_add_u32 m0, s77, 40960
s_nop 0
buffer_load_dwordx4 v12, s[8:11], s75 offen offset:0 lds
buffer_load_dwordx4 v13, s[8:11], s75 offen offset:1024 lds
buffer_load_dwordx4 v14, s[8:11], s75 offen offset:2048 lds
buffer_load_dwordx4 v15, s[8:11], s75 offen offset:3072 lds
s_add_u32 m0, s77, 45056
s_nop 0
buffer_load_dwordx4 v16, s[8:11], s75 offen offset:0 lds
buffer_load_dwordx4 v17, s[8:11], s75 offen offset:1024 lds
s_add_u32 s75, s75, 393216
s_cmp_eq_u32 s75, 6291456
s_cselect_b32 s75, 0, s75
s_waitcnt vmcnt(10)
s_barrier
s_add_u32 m0, s76, 24576
s_nop 0
buffer_load_dwordx4 v8, s[4:7], s74 offen offset:0 lds
buffer_load_dwordx4 v9, s[4:7], s74 offen offset:1024 lds
buffer_load_dwordx4 v10, s[4:7], s74 offen offset:2048 lds
buffer_load_dwordx4 v11, s[4:7], s74 offen offset:3072 lds
s_add_u32 s74, s74, 128
s_and_b32 s74, s74, 2047
s_add_u32 m0, s77, 0
s_nop 0
buffer_load_dwordx4 v12, s[8:11], s75 offen offset:0 lds
buffer_load_dwordx4 v13, s[8:11], s75 offen offset:1024 lds
buffer_load_dwordx4 v14, s[8:11], s75 offen offset:2048 lds
buffer_load_dwordx4 v15, s[8:11], s75 offen offset:3072 lds
s_add_u32 m0, s77, 4096
s_nop 0
buffer_load_dwordx4 v16, s[8:11], s75 offen offset:0 lds
buffer_load_dwordx4 v17, s[8:11], s75 offen offset:1024 lds
s_add_u32 s75, s75, 393216
s_cmp_eq_u32 s75, 6291456
s_cselect_b32 s75, 0, s75
s_add_u32 m0, s76, 122880
s_nop 0
buffer_load_dwordx4 v8, s[4:7], s74 offen offset:0 lds
buffer_load_dwordx4 v9, s[4:7], s74 offen offset:1024 lds
buffer_load_dwordx4 v10, s[4:7], s74 offen offset:2048 lds
buffer_load_dwordx4 v11, s[4:7], s74 offen offset:3072 lds
s_add_u32 s74, s74, 128
s_and_b32 s74, s74, 2047
v_lshlrev_b32 v2, 3, v1
s_lshl_b32 s70, s60, 9
buffer_load_dwordx2 v[88:89], v2, s[36:39], s70 offen
s_lshl_b32 s70, s87, 11
buffer_load_dwordx4 v[20:23], v18, s[4:7], s70 offen offset:0
s_lshl_b32 s70, s87, 11
buffer_load_dwordx4 v[24:27], v18, s[4:7], s70 offen offset:1024
s_lshl_b32 s70, s87, 11
buffer_load_dwordx4 v[28:31], v18, s[4:7], s70 offen offset:2048
s_lshl_b32 s70, s87, 11
buffer_load_dwordx4 v[32:35], v18, s[4:7], s70 offen offset:3072
s_mov_b64 exec, 0x1fff
buffer_load_dword v81, v79, s[12:15], 0 offen
s_mov_b64 exec, -1
s_lshl_b32 s70, s64, 2
s_add_u32 s70, s70, s60
s_lshl_b32 s70, s70, 12
s_lshl_b32 s71, s65, 7
s_add_u32 s70, s70, s71
s_add_u32 s70, s70, 7864320
s_mov_b64 exec, 0xffff
buffer_store_dwordx4 v[72:75], v77, s[12:15], s70 offen sc1
s_mov_b64 exec, -1
s_waitcnt vmcnt(21)
s_barrier
s_add_u32 m0, s77, 81920
s_nop 0
buffer_load_dwordx4 v12, s[8:11], s75 offen offset:0 lds
buffer_load_dwordx4 v13, s[8:11], s75 offen offset:1024 lds
buffer_load_dwordx4 v14, s[8:11], s75 offen offset:2048 lds
buffer_load_dwordx4 v15, s[8:11], s75 offen offset:3072 lds
s_add_u32 m0, s77, 86016
s_nop 0
buffer_load_dwordx4 v16, s[8:11], s75 offen offset:0 lds
buffer_load_dwordx4 v17, s[8:11], s75 offen offset:1024 lds
s_add_u32 s75, s75, 393216
s_cmp_eq_u32 s75, 6291456
s_cselect_b32 s75, 0, s75
s_add_u32 m0, s76, 106496
s_nop 0
buffer_load_dwordx4 v8, s[4:7], s74 offen offset:0 lds
buffer_load_dwordx4 v9, s[4:7], s74 offen offset:1024 lds
buffer_load_dwordx4 v10, s[4:7], s74 offen offset:2048 lds
buffer_load_dwordx4 v11, s[4:7], s74 offen offset:3072 lds
s_add_u32 s74, s74, 128
s_and_b32 s74, s74, 2047
s_waitcnt vmcnt(21)
s_barrier
s_add_u32 m0, s77, 40960
s_nop 0
buffer_load_dwordx4 v12, s[8:11], s75 offen offset:0 lds
s_waitcnt vmcnt(13)
s_waitcnt lgkmcnt(0)
s_add_u32 s68, s68, 1
s_and_b32 s84, s68, 0xff
s_not_b32 s70, s68
v_and_b32 v82, 3, v1
v_lshrrev_b32_e64 v82, v82, s70
v_and_b32 v82, 1, v82
v_mul_u32_u24 v82, 0x10001, v82
buffer_load_dwordx4 v13, s[8:11], s75 offen offset:1024 lds
v_lshlrev_b32 v36, 16, v20
v_and_b32 v37, 0xffff0000, v20
v_lshlrev_b32 v38, 16, v21
v_and_b32 v39, 0xffff0000, v21
v_lshlrev_b32 v40, 16, v22
buffer_load_dwordx4 v14, s[8:11], s75 offen offset:2048 lds
v_and_b32 v41, 0xffff0000, v22
v_lshlrev_b32 v42, 16, v23
v_and_b32 v43, 0xffff0000, v23
v_lshlrev_b32 v44, 16, v24
v_and_b32 v45, 0xffff0000, v24
buffer_load_dwordx4 v15, s[8:11], s75 offen offset:3072 lds
v_lshlrev_b32 v46, 16, v25
v_and_b32 v47, 0xffff0000, v25
v_lshlrev_b32 v48, 16, v26
v_and_b32 v49, 0xffff0000, v26
v_lshlrev_b32 v50, 16, v27
s_add_u32 m0, s77, 45056
s_nop 0
buffer_load_dwordx4 v16, s[8:11], s75 offen offset:0 lds
v_and_b32 v51, 0xffff0000, v27
v_lshlrev_b32 v52, 16, v28
v_and_b32 v53, 0xffff0000, v28
v_lshlrev_b32 v54, 16, v29
v_and_b32 v55, 0xffff0000, v29
buffer_load_dwordx4 v17, s[8:11], s75 offen offset:1024 lds
s_add_u32 s75, s75, 393216
s_cmp_eq_u32 s75, 6291456
s_cselect_b32 s75, 0, s75
v_lshlrev_b32 v56, 16, v30
v_and_b32 v57, 0xffff0000, v30
v_lshlrev_b32 v58, 16, v31
v_and_b32 v59, 0xffff0000, v31
v_lshlrev_b32 v60, 16, v32
s_add_u32 m0, s76, 65536
s_nop 0
buffer_load_dwordx4 v8, s[4:7], s74 offen offset:0 lds
v_and_b32 v61, 0xffff0000, v32
v_lshlrev_b32 v62, 16, v33
v_and_b32 v63, 0xffff0000, v33
v_lshlrev_b32 v64, 16, v34
v_and_b32 v65, 0xffff0000, v34
buffer_load_dwordx4 v9, s[4:7], s74 offen offset:1024 lds
v_lshlrev_b32 v66, 16, v35
v_and_b32 v67, 0xffff0000, v35
v_add_f32 v20, v36, v40
v_add_f32 v28, v52, v56
v_add_f32 v21, v37, v41
buffer_load_dwordx4 v10, s[4:7], s74 offen offset:2048 lds
v_add_f32 v29, v53, v57
v_add_f32 v22, v38, v42
v_add_f32 v30, v54, v58
v_add_f32 v23, v39, v43
v_add_f32 v31, v55, v59
buffer_load_dwordx4 v11, s[4:7], s74 offen offset:3072 lds
s_add_u32 s74, s74, 128
s_and_b32 s74, s74, 2047
v_add_f32 v20, v20, v44
v_add_f32 v28, v28, v60
s_waitcnt vmcnt(14)
s_barrier
s_add_u32 m0, s77, 0
s_nop 0
buffer_load_dwordx4 v12, s[8:11], s75 offen offset:0 lds
v_add_f32 v21, v21, v45
v_add_f32 v29, v29, v61
v_add_f32 v22, v22, v46
v_add_f32 v30, v30, v62
v_add_f32 v23, v23, v47
buffer_load_dwordx4 v13, s[8:11], s75 offen offset:1024 lds
v_add_f32 v31, v31, v63
v_add_f32 v20, v20, v48
v_add_f32 v28, v28, v64
v_add_f32 v21, v21, v49
v_add_f32 v29, v29, v65
buffer_load_dwordx4 v14, s[8:11], s75 offen offset:2048 lds
v_add_f32 v22, v22, v50
v_add_f32 v30, v30, v66
v_add_f32 v23, v23, v51
v_add_f32 v31, v31, v67
v_add_f32 v20, v20, v21
buffer_load_dwordx4 v15, s[8:11], s75 offen offset:3072 lds
v_add_f32 v22, v22, v23
v_add_f32 v28, v28, v29
v_add_f32 v30, v30, v31
v_add_f32 v2, v20, v22
v_add_f32 v4, v28, v30
s_add_u32 m0, s77, 4096
s_nop 0
buffer_load_dwordx4 v16, s[8:11], s75 offen offset:0 lds
v_add_f32_dpp v2, v2, v2 row_ror:1 row_mask:0xf bank_mask:0xf
v_add_f32_dpp v4, v4, v4 row_ror:1 row_mask:0xf bank_mask:0xf
s_nop 0
v_add_f32_dpp v2, v2, v2 row_ror:2 row_mask:0xf bank_mask:0xf
v_add_f32_dpp v4, v4, v4 row_ror:2 row_mask:0xf bank_mask:0xf
s_nop 0
v_add_f32_dpp v2, v2, v2 row_ror:4 row_mask:0xf bank_mask:0xf
buffer_load_dwordx4 v17, s[8:11], s75 offen offset:1024 lds
s_add_u32 s75, s75, 393216
s_cmp_eq_u32 s75, 6291456
s_cselect_b32 s75, 0, s75
v_add_f32_dpp v4, v4, v4 row_ror:4 row_mask:0xf bank_mask:0xf
v_add_f32_dpp v2, v2, v2 row_ror:8 row_mask:0xf bank_mask:0xf
s_nop 0
v_add_f32_dpp v4, v4, v4 row_ror:8 row_mask:0xf bank_mask:0xf
v_mov_b32 v6, v2
v_mov_b32 v7, v4
s_add_u32 m0, s76, 24576
s_nop 0
buffer_load_dwordx4 v8, s[4:7], s74 offen offset:0 lds
v_permlane16_swap_b32 v2, v6
v_permlane16_swap_b32 v4, v7
v_add_f32 v2, v2, v6
v_add_f32 v4, v4, v7
v_mov_b32 v6, v2
buffer_load_dwordx4 v9, s[4:7], s74 offen offset:1024 lds
v_mov_b32 v7, v4
v_permlane32_swap_b32 v2, v6
s_nop 0
v_permlane32_swap_b32 v4, v7
v_add_f32 v2, v2, v6
v_add_f32 v4, v4, v7
buffer_load_dwordx4 v10, s[4:7], s74 offen offset:2048 lds
v_mul_f32 v2, 0xba800000, v2
v_mul_f32 v4, 0xba800000, v4
v_add_f32 v36, v36, v2
v_add_f32 v52, v52, v4
v_add_f32 v37, v37, v2
buffer_load_dwordx4 v11, s[4:7], s74 offen offset:3072 lds
s_add_u32 s74, s74, 128
s_and_b32 s74, s74, 2047
v_add_f32 v53, v53, v4
v_add_f32 v38, v38, v2
s_cmp_eq_u32 s60, 0
s_cbranch_scc1 L_pad0
s_cmp_eq_u32 s60, 1
s_cbranch_scc1 L_pad3
s_cmp_eq_u32 s60, 2
s_cbranch_scc1 L_pad4
s_branch L_ret4
L_ret4:
s_waitcnt vmcnt(14)
s_barrier
s_add_u32 m0, s77, 81920
s_nop 0
buffer_load_dwordx4 v12, s[8:11], s75 offen offset:0 lds
v_add_f32 v54, v54, v4
v_add_f32 v39, v39, v2
v_add_f32 v55, v55, v4
v_add_f32 v40, v40, v2
v_add_f32 v56, v56, v4
buffer_load_dwordx4 v13, s[8:11], s75 offen offset:1024 lds
v_add_f32 v41, v41, v2
v_add_f32 v57, v57, v4
v_add_f32 v42, v42, v2
v_add_f32 v58, v58, v4
v_add_f32 v43, v43, v2
buffer_load_dwordx4 v14, s[8:11], s75 offen offset:2048 lds
v_add_f32 v59, v59, v4
v_add_f32 v44, v44, v2
v_add_f32 v60, v60, v4
v_add_f32 v45, v45, v2
v_add_f32 v61, v61, v4
buffer_load_dwordx4 v15, s[8:11], s75 offen offset:3072 lds
v_add_f32 v46, v46, v2
v_add_f32 v62, v62, v4
v_add_f32 v47, v47, v2
v_add_f32 v63, v63, v4
v_add_f32 v48, v48, v2
s_add_u32 m0, s77, 86016
s_nop 0
buffer_load_dwordx4 v16, s[8:11], s75 offen offset:0 lds
v_add_f32 v64, v64, v4
v_add_f32 v49, v49, v2
v_add_f32 v65, v65, v4
v_add_f32 v50, v50, v2
v_add_f32 v66, v66, v4
buffer_load_dwordx4 v17, s[8:11], s75 offen offset:1024 lds
s_add_u32 s75, s75, 393216
s_cmp_eq_u32 s75, 6291456
s_cselect_b32 s75, 0, s75
v_add_f32 v51, v51, v2
v_add_f32 v67, v67, v4
v_mul_f32 v20, v36, v36
v_mul_f32 v28, v52, v52
v_mul_f32 v21, v37, v37
s_add_u32 m0, s76, 122880
s_nop 0
buffer_load_dwordx4 v8, s[4:7], s74 offen offset:0 lds
v_mul_f32 v29, v53, v53
v_fmac_f32 v20, v38, v38
v_fmac_f32 v28, v54, v54
v_fmac_f32 v21, v39, v39
v_fmac_f32 v29, v55, v55
buffer_load_dwordx4 v9, s[4:7], s74 offen offset:1024 lds
v_fmac_f32 v20, v40, v40
v_fmac_f32 v28, v56, v56
v_fmac_f32 v21, v41, v41
v_fmac_f32 v29, v57, v57
v_fmac_f32 v20, v42, v42
buffer_load_dwordx4 v10, s[4:7], s74 offen offset:2048 lds
v_fmac_f32 v28, v58, v58
v_fmac_f32 v21, v43, v43
v_fmac_f32 v29, v59, v59
v_fmac_f32 v20, v44, v44
v_fmac_f32 v28, v60, v60
buffer_load_dwordx4 v11, s[4:7], s74 offen offset:3072 lds
s_add_u32 s74, s74, 128
s_and_b32 s74, s74, 2047
v_fmac_f32 v21, v45, v45
v_fmac_f32 v29, v61, v61
s_waitcnt vmcnt(14)
s_barrier
s_add_u32 m0, s77, 40960
s_nop 0
buffer_load_dwordx4 v12, s[8:11], s75 offen offset:0 lds
v_fmac_f32 v20, v46, v46
v_fmac_f32 v28, v62, v62
v_fmac_f32 v21, v47, v47
v_fmac_f32 v29, v63, v63
v_fmac_f32 v20, v48, v48
buffer_load_dwordx4 v13, s[8:11], s75 offen offset:1024 lds
v_fmac_f32 v28, v64, v64
v_fmac_f32 v21, v49, v49
v_fmac_f32 v29, v65, v65
v_fmac_f32 v20, v50, v50
v_fmac_f32 v28, v66, v66
buffer_load_dwordx4 v14, s[8:11], s75 offen offset:2048 lds
v_fmac_f32 v21, v51, v51
v_fmac_f32 v29, v67, v67
v_add_f32 v3, v20, v21
v_add_f32 v5, v28, v29
s_nop 0
v_add_f32_dpp v3, v3, v3 row_ror:1 row_mask:0xf bank_mask:0xf
buffer_load_dwordx4 v15, s[8:11], s75 offen offset:3072 lds
v_add_f32_dpp v5, v5, v5 row_ror:1 row_mask:0xf bank_mask:0xf
v_add_f32_dpp v3, v3, v3 row_ror:2 row_mask:0xf bank_mask:0xf
s_nop 0
v_add_f32_dpp v5, v5, v5 row_ror:2 row_mask:0xf bank_mask:0xf
v_add_f32_dpp v3, v3, v3 row_ror:4 row_mask:0xf bank_mask:0xf
s_nop 0
v_add_f32_dpp v5, v5, v5 row_ror:4 row_mask:0xf bank_mask:0xf
s_add_u32 m0, s77, 45056
s_nop 0
buffer_load_dwordx4 v16, s[8:11], s75 offen offset:0 lds
v_add_f32_dpp v3, v3, v3 row_ror:8 row_mask:0xf bank_mask:0xf
v_add_f32_dpp v5, v5, v5 row_ror:8 row_mask:0xf bank_mask:0xf
v_mov_b32 v6, v3
v_mov_b32 v7, v5
s_nop 0
v_permlane16_swap_b32 v3, v6
buffer_load_dwordx4 v17, s[8:11], s75 offen offset:1024 lds
s_add_u32 s75, s75, 393216
s_cmp_eq_u32 s75, 6291456
s_cselect_b32 s75, 0, s75
v_permlane16_swap_b32 v5, v7
v_add_f32 v3, v3, v6
v_add_f32 v5, v5, v7
v_mov_b32 v6, v3
v_mov_b32 v7, v5
s_add_u32 m0, s76, 106496
s_nop 0
buffer_load_dwordx4 v8, s[4:7], s74 offen offset:0 lds
v_permlane32_swap_b32 v3, v6
s_branch L_over0
L_pad0:
s_branch L_ret4
L_over0:
v_permlane32_swap_b32 v5, v7
v_add_f32 v3, v3, v6
v_add_f32 v5, v5, v7
v_mov_b32 v6, 0x3727c5ac
buffer_load_dwordx4 v9, s[4:7], s74 offen offset:1024 lds
v_fmac_f32 v6, 0x3a800000, v3
v_rsq_f32 v3, v6
v_mov_b32 v6, 0x3727c5ac
v_fmac_f32 v6, 0x3a800000, v5
v_rsq_f32 v5, v6
buffer_load_dwordx4 v10, s[4:7], s74 offen offset:2048 lds
v_cmp_eq_u32 vcc, 1, v1
s_nop 1
v_cndmask_b32 v20, v2, v4, vcc
v_cndmask_b32 v21, v3, v5, vcc
v_mov_b32 v22, 0
v_mov_b32 v23, s68
buffer_load_dwordx4 v11, s[4:7], s74 offen offset:3072 lds
s_add_u32 s74, s74, 128
s_and_b32 s74, s74, 2047
buffer_load_dwordx4 a[0:3], v76, s[24:27], s85 offen nt
buffer_load_dwordx4 a[32:35], v76, s[28:31], s85 offen nt
s_add_u32 s85, s85, 57344
buffer_load_dwordx4 a[4:7], v76, s[24:27], s85 offen nt
buffer_load_dwordx4 a[36:39], v76, s[28:31], s85 offen nt
s_add_u32 s85, s85, 57344
buffer_load_dwordx4 a[8:11], v76, s[24:27], s85 offen nt
buffer_load_dwordx4 a[40:43], v76, s[28:31], s85 offen nt
s_add_u32 s85, s85, 57344
s_lshl_b32 s70, s87, 4
s_add_u32 s70, s70, 8192
s_mov_b64 exec, 3
buffer_store_dwordx4 v[20:23], v18, s[12:15], s70 offen sc1
s_mov_b64 exec, -1
s_waitcnt vmcnt(21)
s_barrier
s_add_u32 m0, s77, 0
s_nop 0
buffer_load_dwordx4 v12, s[8:11], s75 offen offset:0 lds
v_lshlrev_b32 v2, 16, v88
v_and_b32 v3, 0xffff0000, v88
v_lshlrev_b32 v4, 16, v89
buffer_load_dwordx4 v13, s[8:11], s75 offen offset:1024 lds
v_and_b32 v5, 0xffff0000, v89
v_add_f32 v2, v2, v3
v_add_f32 v4, v4, v5
buffer_load_dwordx4 v14, s[8:11], s75 offen offset:2048 lds
v_add_f32 v2, v2, v4
s_nop 1
v_add_f32_dpp v2, v2, v2 row_ror:1 row_mask:0xf bank_mask:0xf
s_nop 1
v_add_f32_dpp v2, v2, v2 row_ror:2 row_mask:0xf bank_mask:0xf
buffer_load_dwordx4 v15, s[8:11], s75 offen offset:3072 lds
s_nop 0
v_add_f32_dpp v2, v2, v2 row_ror:4 row_mask:0xf bank_mask:0xf
s_nop 1
v_add_f32_dpp v2, v2, v2 row_ror:8 row_mask:0xf bank_mask:0xf
v_mov_b32 v3, v2
s_add_u32 m0, s77, 4096
s_nop 0
buffer_load_dwordx4 v16, s[8:11], s75 offen offset:0 lds
v_permlane16_swap_b32 v2, v3
v_add_f32 v2, v2, v3
v_mov_b32 v3, v2
buffer_load_dwordx4 v17, s[8:11], s75 offen offset:1024 lds
s_add_u32 s75, s75, 393216
s_cmp_eq_u32 s75, 6291456
s_cselect_b32 s75, 0, s75
v_permlane32_swap_b32 v2, v3
v_add_f32 v2, v2, v3
s_lshl_b32 s70, s60, 2
s_add_u32 s70, s70, 162176
v_mov_b32 v3, s70
s_add_u32 m0, s76, 65536
s_nop 0
buffer_load_dwordx4 v8, s[4:7], s74 offen offset:0 lds
ds_write_b32 v3, v2
s_lshl_b32 s70, s60, 2
s_sub_u32 s70, s70, s65
s_lshl_b32 s70, s70, 4
v_add_u32 v4, s70, v1
v_min_u32 v4, 18, v4
buffer_load_dwordx4 v9, s[4:7], s74 offen offset:1024 lds
v_cmp_gt_u32 vcc, 16, v4
s_nop 1
v_cndmask_b32 v4, 18, v4, vcc
v_lshlrev_b32 v4, 3, v4
buffer_load_dwordx4 v10, s[4:7], s74 offen offset:2048 lds
v_add_u32 v4, 162048, v4
ds_write_b64 v4, v[88:89]
buffer_load_dwordx4 v11, s[4:7], s74 offen offset:3072 lds
s_add_u32 s74, s74, 128
s_and_b32 s74, s74, 2047
s_waitcnt vmcnt(21)
s_barrier
s_add_u32 m0, s77, 81920
s_nop 0
buffer_load_dwordx4 v12, s[8:11], s75 offen offset:0 lds
s_getreg_b32 s71, hwreg(HW_REG_XCC_ID, 0, 4)
v_mov_b32 v84, s71
buffer_load_dwordx4 v13, s[8:11], s75 offen offset:1024 lds
v_mov_b32 v85, 0
buffer_load_dwordx4 v14, s[8:11], s75 offen offset:2048 lds
v_mov_b32 v86, 0
buffer_load_dwordx4 v15, s[8:11], s75 offen offset:3072 lds
v_mov_b32 v87, s68
s_add_u32 m0, s77, 86016
s_nop 0
buffer_load_dwordx4 v16, s[8:11], s75 offen offset:0 lds
buffer_load_dwordx4 v17, s[8:11], s75 offen offset:1024 lds
s_add_u32 s75, s75, 393216
s_cmp_eq_u32 s75, 6291456
s_cselect_b32 s75, 0, s75
s_add_u32 m0, s76, 24576
s_nop 0
buffer_load_dwordx4 v8, s[4:7], s74 offen offset:0 lds
buffer_load_dwordx4 v9, s[4:7], s74 offen offset:1024 lds
buffer_load_dwordx4 v10, s[4:7], s74 offen offset:2048 lds
buffer_load_dwordx4 v11, s[4:7], s74 offen offset:3072 lds
s_add_u32 s74, s74, 128
s_and_b32 s74, s74, 2047
buffer_load_dwordx4 a[12:15], v76, s[24:27], s85 offen nt
buffer_load_dwordx4 a[44:47], v76, s[28:31], s85 offen nt
s_add_u32 s85, s85, 57344
buffer_load_dwordx4 a[16:19], v76, s[24:27], s85 offen nt
buffer_load_dwordx4 a[48:51], v76, s[28:31], s85 offen nt
s_add_u32 s85, s85, 57344
buffer_load_dwordx4 a[20:23], v76, s[24:27], s85 offen nt
buffer_load_dwordx4 a[52:55], v76, s[28:31], s85 offen nt
s_add_u32 s85, s85, 57344
s_lshl_b32 s70, s79, 4
s_add_u32 s70, s70, 4096
s_mov_b64 exec, 1
buffer_store_dwordx4 v[84:87], v18, s[12:15], s70 offen sc1
s_mov_b64 exec, -1
s_waitcnt vmcnt(21)
s_barrier
s_add_u32 m0, s77, 40960
s_nop 0
buffer_load_dwordx4 v12, s[8:11], s75 offen offset:0 lds
buffer_load_dwordx4 v13, s[8:11], s75 offen offset:1024 lds
buffer_load_dwordx4 v14, s[8:11], s75 offen offset:2048 lds
buffer_load_dwordx4 v15, s[8:11], s75 offen offset:3072 lds
s_add_u32 m0, s77, 45056
s_nop 0
buffer_load_dwordx4 v16, s[8:11], s75 offen offset:0 lds
buffer_load_dwordx4 v17, s[8:11], s75 offen offset:1024 lds
s_add_u32 s75, s75, 393216
s_cmp_eq_u32 s75, 6291456
s_cselect_b32 s75, 0, s75
s_add_u32 m0, s76, 122880
s_nop 0
buffer_load_dwordx4 v8, s[4:7], s74 offen offset:0 lds
buffer_load_dwordx4 v9, s[4:7], s74 offen offset:1024 lds
buffer_load_dwordx4 v10, s[4:7], s74 offen offset:2048 lds
buffer_load_dwordx4 v11, s[4:7], s74 offen offset:3072 lds
s_add_u32 s74, s74, 128
s_and_b32 s74, s74, 2047
s_cmp_eq_u32 s60, 0
s_cbranch_scc1 L_pad5
s_cmp_eq_u32 s60, 1
s_cbranch_scc1 L_ret9
s_cmp_eq_u32 s60, 2
s_cbranch_scc1 L_ret9
s_branch L_ret9
L_ret9:
s_waitcnt vmcnt(21)
s_barrier
s_add_u32 m0, s77, 0
s_nop 0
buffer_load_dwordx4 v12, s[8:11], s75 offen offset:0 lds
buffer_load_dwordx4 v13, s[8:11], s75 offen offset:1024 lds
buffer_load_dwordx4 v14, s[8:11], s75 offen offset:2048 lds
buffer_load_dwordx4 v15, s[8:11], s75 offen offset:3072 lds
s_add_u32 m0, s77, 4096
s_nop 0
buffer_load_dwordx4 v16, s[8:11], s75 offen offset:0 lds
buffer_load_dwordx4 v17, s[8:11], s75 offen offset:1024 lds
s_add_u32 s75, s75, 393216
s_cmp_eq_u32 s75, 6291456
s_cselect_b32 s75, 0, s75
s_add_u32 m0, s76, 106496
s_nop 0
buffer_load_dwordx4 v8, s[4:7], s74 offen offset:0 lds
buffer_load_dwordx4 v9, s[4:7], s74 offen offset:1024 lds
buffer_load_dwordx4 v10, s[4:7], s74 offen offset:2048 lds
buffer_load_dwordx4 v11, s[4:7], s74 offen offset:3072 lds
s_add_u32 s74, s74, 128
s_and_b32 s74, s74, 2047
buffer_load_dwordx4 a[24:27], v76, s[24:27], s85 offen nt
buffer_load_dwordx4 a[56:59], v76, s[28:31], s85 offen nt
s_add_u32 s85, s85, 57344
buffer_load_dwordx4 a[28:31], v76, s[24:27], s85 offen nt
buffer_load_dwordx4 a[60:63], v76, s[28:31], s85 offen nt
s_add_u32 s85, s85, 57344
buffer_load_dwordx4 a[64:67], v77, s[32:35], s86 offen nt
s_add_u32 s86, s86, 16384
buffer_load_dwordx4 a[68:71], v77, s[32:35], s86 offen nt
s_add_u32 s86, s86, 16384
s_waitcnt vmcnt(20)
s_barrier
s_add_u32 m0, s77, 81920
s_nop 0
buffer_load_dwordx4 v12, s[8:11], s75 offen offset:0 lds
v_lshrrev_b32 v2, 4, v1
v_and_b32 v3, 15, v1
buffer_load_dwordx4 v13, s[8:11], s75 offen offset:1024 lds
v_lshlrev_b32 v44, 10, v2
v_lshl_add_u32 v44, v3, 4, v44
buffer_load_dwordx4 v14, s[8:11], s75 offen offset:2048 lds
s_lshl_b32 s70, s60, 8
v_add_u32 v44, s70, v44
s_lshl_b32 s87, s64, 14
s_add_u32 s87, s87, 65536
buffer_load_dwordx4 v15, s[8:11], s75 offen offset:3072 lds
v_and_b32 v45, 31, v1
v_lshlrev_b32 v45, 4, v45
s_add_u32 m0, s77, 86016
s_nop 0
buffer_load_dwordx4 v16, s[8:11], s75 offen offset:0 lds
s_lshl_b32 s88, s65, 11
s_lshl_b32 s70, s60, 9
s_add_u32 s88, s88, s70
s_add_u32 s88, s88, 8192
s_lshl_b32 s70, s64, 8
s_add_u32 s70, s70, 4096
v_lshlrev_b32 v4, 4, v3
v_add_u32 v4, s70, v4
buffer_load_dwordx4 v17, s[8:11], s75 offen offset:1024 lds
s_add_u32 s75, s75, 393216
s_cmp_eq_u32 s75, 6291456
s_cselect_b32 s75, 0, s75
s_lshl_b32 s70, s64, 4
s_add_u32 s70, s70, 4096
v_lshlrev_b32 v5, 8, v3
v_add_u32 v5, s70, v5
v_and_b32 v6, 1, v2
s_add_u32 m0, s76, 65536
s_nop 0
buffer_load_dwordx4 v8, s[4:7], s74 offen offset:0 lds
v_cmp_eq_u32 vcc, 1, v6
s_nop 1
v_cndmask_b32 v46, v4, v5, vcc
buffer_load_dwordx4 v9, s[4:7], s74 offen offset:1024 lds
buffer_load_dwordx4 v10, s[4:7], s74 offen offset:2048 lds
buffer_load_dwordx4 v11, s[4:7], s74 offen offset:3072 lds
s_add_u32 s74, s74, 128
s_and_b32 s74, s74, 2047
s_lshl_b32 s70, s63, 2
s_add_u32 s70, s70, s60
s_lshl_b32 s70, s70, 14
v_lshlrev_b32 v81, 10, v1
s_mov_b64 exec, 0xffff
buffer_load_dword v81, v81, s[16:19], s70 offen offset:384
s_mov_b64 exec, -1
s_add_u32 s70, s87, 0
buffer_load_dwordx4 v[20:23], v44, s[12:15], s70 offen sc1
s_add_u32 s70, s87, 4096
buffer_load_dwordx4 v[24:27], v44, s[12:15], s70 offen sc1
s_add_u32 s70, s87, 8192
buffer_load_dwordx4 v[28:31], v44, s[12:15], s70 offen sc1
s_add_u32 s70, s87, 12288
buffer_load_dwordx4 v[32:35], v44, s[12:15], s70 offen sc1
buffer_load_dwordx4 v[36:39], v45, s[12:15], s88 offen sc1
buffer_load_dwordx4 v[40:43], v46, s[12:15], 0 offen offset:0 sc1
s_waitcnt vmcnt(27)
s_barrier
s_add_u32 m0, s77, 40960
s_nop 0
buffer_load_dwordx4 v12, s[8:11], s75 offen offset:0 lds
buffer_load_dwordx4 v13, s[8:11], s75 offen offset:1024 lds
buffer_load_dwordx4 v14, s[8:11], s75 offen offset:2048 lds
buffer_load_dwordx4 v15, s[8:11], s75 offen offset:3072 lds
s_add_u32 m0, s77, 45056
s_nop 0
buffer_load_dwordx4 v16, s[8:11], s75 offen offset:0 lds
buffer_load_dwordx4 v17, s[8:11], s75 offen offset:1024 lds
s_add_u32 s75, s75, 393216
s_cmp_eq_u32 s75, 6291456
s_cselect_b32 s75, 0, s75
s_add_u32 m0, s76, 24576
s_nop 0
buffer_load_dwordx4 v8, s[4:7], s74 offen offset:0 lds
buffer_load_dwordx4 v9, s[4:7], s74 offen offset:1024 lds
buffer_load_dwordx4 v10, s[4:7], s74 offen offset:2048 lds
buffer_load_dwordx4 v11, s[4:7], s74 offen offset:3072 lds
s_add_u32 s74, s74, 128
s_and_b32 s74, s74, 2047
buffer_load_dwordx4 a[72:75], v77, s[32:35], s86 offen nt
s_add_u32 s86, s86, 16384
buffer_load_dwordx4 a[76:79], v77, s[32:35], s86 offen nt
s_add_u32 s86, s86, 16384
buffer_load_dwordx4 a[80:83], v77, s[32:35], s86 offen nt
s_add_u32 s86, s86, 16384
buffer_load_dwordx4 a[84:87], v77, s[32:35], s86 offen nt
s_add_u32 s86, s86, 16384
buffer_load_dwordx4 a[88:91], v77, s[32:35], s86 offen nt
s_add_u32 s86, s86, 16384
buffer_load_dwordx4 a[92:95], v77, s[32:35], s86 offen nt
s_add_u32 s86, s86, 16384
s_waitcnt vmcnt(27)
s_barrier
s_add_u32 m0, s77, 0
s_nop 0
buffer_load_dwordx4 v12, s[8:11], s75 offen offset:0 lds
s_waitcnt vmcnt(17)
L_eg_chk:
v_xor_b32 v2, s68, v23
v_xor_b32 v3, s68, v27
v_xor_b32 v4, s68, v31
v_or3_b32 v2, v2, v3, v4
v_xor_b32 v3, s68, v35
v_xor_b32 v4, s68, v39
v_or3_b32 v2, v2, v3, v4
v_xor_b32 v3, s68, v43
v_or_b32 v2, v2, v3
v_cmp_ne_u32 vcc, 0, v2
s_cbranch_vccnz L_eg_rt
L_eg_ok:
v_add_f32 v20, v20, v24
buffer_load_dwordx4 v13, s[8:11], s75 offen offset:1024 lds
v_add_f32 v28, v28, v32
v_add_f32 v21, v21, v25
buffer_load_dwordx4 v14, s[8:11], s75 offen offset:2048 lds
v_add_f32 v29, v29, v33
v_add_f32 v22, v22, v26
buffer_load_dwordx4 v15, s[8:11], s75 offen offset:3072 lds
v_add_f32 v30, v30, v34
v_add_f32 v20, v20, v28
s_add_u32 m0, s77, 4096
s_nop 0
buffer_load_dwordx4 v16, s[8:11], s75 offen offset:0 lds
v_add_f32 v21, v21, v29
v_add_f32 v22, v22, v30
buffer_load_dwordx4 v17, s[8:11], s75 offen offset:1024 lds
s_add_u32 s75, s75, 393216
s_cmp_eq_u32 s75, 6291456
s_cselect_b32 s75, 0, s75
v_mov_b32 v24, v20
v_mov_b32 v25, v21
s_mul_i32 s70, s60, 9
s_add_u32 s70, s70, 92
s_lshl_b32 s82, s89, 3
s_add_u32 s82, s82, s70
s_lshl_b32 s70, s70, 10
s_add_u32 m0, s70, 28672
s_and_b32 s82, s82, 127
s_lshl_b32 s82, s82, 14
buffer_load_dwordx4 v80, s[16:19], s82 offen lds
v_mov_b32 v26, v22
v_permlane16_swap_b32 v20, v24
s_add_u32 m0, m0, 1024
s_add_u32 s82, s82, 16384
s_and_b32 s82, s82, 0x1fffff
buffer_load_dwordx4 v80, s[16:19], s82 offen lds
v_permlane16_swap_b32 v21, v25
v_permlane16_swap_b32 v22, v26
s_add_u32 m0, m0, 1024
s_add_u32 s82, s82, 16384
s_and_b32 s82, s82, 0x1fffff
buffer_load_dwordx4 v80, s[16:19], s82 offen lds
v_add_f32 v20, v20, v24
v_add_f32 v21, v21, v25
s_add_u32 m0, m0, 1024
s_add_u32 s82, s82, 16384
s_and_b32 s82, s82, 0x1fffff
buffer_load_dwordx4 v80, s[16:19], s82 offen lds
v_add_f32 v22, v22, v26
v_mov_b32 v24, v20
s_add_u32 m0, m0, 1024
s_add_u32 s82, s82, 16384
s_and_b32 s82, s82, 0x1fffff
buffer_load_dwordx4 v80, s[16:19], s82 offen lds
v_mov_b32 v25, v21
s_add_u32 m0, m0, 1024
s_add_u32 s82, s82, 16384
s_and_b32 s82, s82, 0x1fffff
buffer_load_dwordx4 v80, s[16:19], s82 offen lds
s_add_u32 m0, m0, 1024
s_add_u32 s82, s82, 16384
s_and_b32 s82, s82, 0x1fffff
buffer_load_dwordx4 v80, s[16:19], s82 offen lds
s_add_u32 m0, m0, 1024
s_add_u32 s82, s82, 16384
s_and_b32 s82, s82, 0x1fffff
buffer_load_dwordx4 v80, s[16:19], s82 offen lds
s_add_u32 m0, m0, 1024
s_add_u32 s82, s82, 16384
s_and_b32 s82, s82, 0x1fffff
buffer_load_dwordx4 v80, s[16:19], s82 offen lds
s_waitcnt vmcnt(25)
s_barrier
s_mul_i32 s70, s60, 10
s_add_u32 s70, s70, 52
s_lshl_b32 s82, s89, 3
s_add_u32 s82, s82, s70
s_lshl_b32 s70, s70, 10
s_add_u32 m0, s70, 28672
s_and_b32 s82, s82, 127
s_lshl_b32 s82, s82, 14
buffer_load_dwordx4 v80, s[16:19], s82 offen lds
v_mov_b32 v26, v22
v_permlane32_swap_b32 v20, v24
v_permlane32_swap_b32 v21, v25
s_add_u32 m0, m0, 1024
s_add_u32 s82, s82, 16384
s_and_b32 s82, s82, 0x1fffff
buffer_load_dwordx4 v80, s[16:19], s82 offen lds
v_permlane32_swap_b32 v22, v26
v_add_f32 v20, v20, v24
v_add_f32 v21, v21, v25
s_add_u32 m0, m0, 1024
s_add_u32 s82, s82, 16384
s_and_b32 s82, s82, 0x1fffff
buffer_load_dwordx4 v80, s[16:19], s82 offen lds
v_add_f32 v22, v22, v26
v_and_b32 v3, 15, v1
v_lshlrev_b32 v3, 2, v3
s_add_u32 m0, m0, 1024
s_add_u32 s82, s82, 16384
s_and_b32 s82, s82, 0x1fffff
buffer_load_dwordx4 v80, s[16:19], s82 offen lds
s_lshl_b32 s70, s60, 6
s_add_u32 s70, s70, 160768
v_add_u32 v3, s70, v3
ds_write_b32 v3, v20 offset:0
ds_write_b32 v3, v21 offset:256
s_add_u32 m0, m0, 1024
s_add_u32 s82, s82, 16384
s_and_b32 s82, s82, 0x1fffff
buffer_load_dwordx4 v80, s[16:19], s82 offen lds
ds_write_b32 v3, v22 offset:512
v_lshrrev_b32 v4, 2, v45
s_lshl_b32 s70, s60, 7
s_add_u32 s70, s70, 159744
v_add_u32 v4, s70, v4
s_add_u32 m0, m0, 1024
s_add_u32 s82, s82, 16384
s_and_b32 s82, s82, 0x1fffff
buffer_load_dwordx4 v80, s[16:19], s82 offen lds
ds_write_b32 v4, v36
ds_write_b32 v4, v37 offset:512
s_getreg_b32 s71, hwreg(HW_REG_XCC_ID, 0, 4)
v_cmp_ne_u32 vcc, s71, v40
s_nop 0
s_and_b32 s70, vcc_lo, 0xffff
s_cselect_b32 s69, 0, 1
s_add_u32 m0, m0, 1024
s_add_u32 s82, s82, 16384
s_and_b32 s82, s82, 0x1fffff
buffer_load_dwordx4 v80, s[16:19], s82 offen lds
v_mov_b32 v5, s69
v_mov_b32 v6, 161536
ds_write_b32 v6, v5
s_add_u32 m0, m0, 1024
s_add_u32 s82, s82, 16384
s_and_b32 s82, s82, 0x1fffff
buffer_load_dwordx4 v80, s[16:19], s82 offen lds
s_add_u32 m0, m0, 1024
s_add_u32 s82, s82, 16384
s_and_b32 s82, s82, 0x1fffff
buffer_load_dwordx4 v80, s[16:19], s82 offen lds
s_add_u32 m0, m0, 1024
s_add_u32 s82, s82, 16384
s_and_b32 s82, s82, 0x1fffff
buffer_load_dwordx4 v80, s[16:19], s82 offen lds
s_waitcnt vmcnt(19)
s_barrier
s_mul_i32 s70, s60, 10
s_add_u32 s70, s70, 12
s_lshl_b32 s82, s89, 3
s_add_u32 s82, s82, s70
s_lshl_b32 s70, s70, 10
s_add_u32 m0, s70, 28672
s_and_b32 s82, s82, 127
s_lshl_b32 s82, s82, 14
buffer_load_dwordx4 v80, s[16:19], s82 offen lds
s_add_u32 m0, m0, 1024
s_add_u32 s82, s82, 16384
s_and_b32 s82, s82, 0x1fffff
buffer_load_dwordx4 v80, s[16:19], s82 offen lds
s_add_u32 m0, m0, 1024
s_add_u32 s82, s82, 16384
s_and_b32 s82, s82, 0x1fffff
buffer_load_dwordx4 v80, s[16:19], s82 offen lds
s_add_u32 m0, m0, 1024
s_add_u32 s82, s82, 16384
s_and_b32 s82, s82, 0x1fffff
buffer_load_dwordx4 v80, s[16:19], s82 offen lds
s_add_u32 m0, m0, 1024
s_add_u32 s82, s82, 16384
s_and_b32 s82, s82, 0x1fffff
buffer_load_dwordx4 v80, s[16:19], s82 offen lds
s_add_u32 m0, m0, 1024
s_add_u32 s82, s82, 16384
s_and_b32 s82, s82, 0x1fffff
buffer_load_dwordx4 v80, s[16:19], s82 offen lds
s_add_u32 m0, m0, 1024
s_add_u32 s82, s82, 16384
s_and_b32 s82, s82, 0x1fffff
buffer_load_dwordx4 v80, s[16:19], s82 offen lds
s_add_u32 m0, m0, 1024
s_add_u32 s82, s82, 16384
s_and_b32 s82, s82, 0x1fffff
buffer_load_dwordx4 v80, s[16:19], s82 offen lds
s_add_u32 m0, m0, 1024
s_add_u32 s82, s82, 16384
s_and_b32 s82, s82, 0x1fffff
buffer_load_dwordx4 v80, s[16:19], s82 offen lds
s_add_u32 m0, m0, 1024
s_add_u32 s82, s82, 16384
s_and_b32 s82, s82, 0x1fffff
buffer_load_dwordx4 v80, s[16:19], s82 offen lds
s_setprio 0
s_waitcnt lgkmcnt(0)
s_barrier
s_mov_b32 exec_lo, 0x0
s_mov_b32 exec_hi, 0xf
buffer_load_dword v81, v83, s[12:15], 0 offen
s_mov_b64 exec, -1
s_mul_i32 s70, s60, 3
s_add_u32 s70, s70, 0
s_lshl_b32 s82, s89, 3
s_add_u32 s82, s82, s70
s_lshl_b32 s70, s70, 10
s_add_u32 m0, s70, 28672
s_and_b32 s82, s82, 127
s_lshl_b32 s82, s82, 14
buffer_load_dwordx4 v80, s[16:19], s82 offen lds
s_add_u32 m0, m0, 1024
s_add_u32 s82, s82, 16384
s_and_b32 s82, s82, 0x1fffff
buffer_load_dwordx4 v80, s[16:19], s82 offen lds
s_add_u32 m0, m0, 1024
s_add_u32 s82, s82, 16384
s_and_b32 s82, s82, 0x1fffff
buffer_load_dwordx4 v80, s[16:19], s82 offen lds
s_sub_i32 s70, s64, s65
s_lshl_b32 s70, s70, 18
v_add_u32 v8, s70, v8
v_add_u32 v9, s70, v9
v_add_u32 v10, s70, v10
v_add_u32 v11, s70, v11
s_lshl_b32 s70, s65, 7
s_mov_b32 m0, s76
s_nop 0
buffer_load_dwordx4 v8, s[4:7], s70 offen offset:0 lds
buffer_load_dwordx4 v9, s[4:7], s70 offen offset:1024 lds
buffer_load_dwordx4 v10, s[4:7], s70 offen offset:2048 lds
buffer_load_dwordx4 v11, s[4:7], s70 offen offset:3072 lds
v_lshrrev_b32 v2, 4, v1
v_bfe_u32 v3, v1, 2, 2
v_and_b32 v4, 1, v1
v_lshlrev_b32 v4, 4, v4
v_mov_b32 v5, 0x3f80
v_lshlrev_b32 v4, v4, v5
v_cmp_eq_u32 vcc, v2, v3
s_nop 1
v_cndmask_b32 v4, 0, v4, vcc
v_and_b32 v5, 2, v1
v_cmp_eq_u32 vcc, 0, v5
s_nop 1
v_cndmask_b32 v58, 0, v4, vcc
v_cndmask_b32_e64 v59, v4, 0, vcc
v_mov_b32 v56, 0
v_mov_b32 v57, 0
v_mov_b32 v60, 0
v_mov_b32 v61, 0
v_and_b32 v3, 15, v1
v_mul_u32_u24 v55, 4352, v3
v_lshrrev_b32 v2, 4, v1
v_lshl_add_u32 v55, v2, 5, v55
s_mul_i32 s87, s64, 69632
s_add_u32 s87, s87, 524288
s_lshl_b32 s70, s66, 7
s_lshl_b32 s71, s67, 4
s_add_u32 s88, s70, s71
s_add_u32 s88, s88, s87
s_add_u32 s88, s88, 4096
s_lshl_b32 s70, s60, 10
s_add_u32 s87, s87, s70
s_cmp_eq_u32 s60, 0
s_cbranch_scc1 L_pad1
s_cmp_eq_u32 s60, 1
s_cbranch_scc1 L_pad8
s_cmp_eq_u32 s60, 2
s_cbranch_scc1 L_retF
s_branch L_retF
L_retF:
s_barrier
s_barrier
s_add_u32 s70, s65, 1
s_and_b32 s70, s70, 15
s_mul_i32 s70, s70, 4352
s_add_u32 s70, s70, s87
buffer_load_dwordx4 v[84:87], v18, s[12:15], s70 offen sc1
s_add_u32 s70, s65, 2
s_and_b32 s70, s70, 15
s_mul_i32 s70, s70, 4352
s_add_u32 s70, s70, s87
buffer_load_dwordx4 v[88:91], v18, s[12:15], s70 offen sc1
s_add_u32 s70, s65, 3
s_and_b32 s70, s70, 15
s_mul_i32 s70, s70, 4352
s_add_u32 s70, s70, s87
buffer_load_dwordx4 v[92:95], v18, s[12:15], s70 offen sc1
s_add_u32 s70, s65, 4
s_and_b32 s70, s70, 15
s_mul_i32 s70, s70, 4352
s_add_u32 s70, s70, s87
buffer_load_dwordx4 v[96:99], v18, s[12:15], s70 offen sc1
s_add_u32 s70, s65, 5
s_and_b32 s70, s70, 15
s_mul_i32 s70, s70, 4352
s_add_u32 s70, s70, s87
buffer_load_dwordx4 v[100:103], v18, s[12:15], s70 offen sc1
s_add_u32 s70, s65, 6
s_and_b32 s70, s70, 15
s_mul_i32 s70, s70, 4352
s_add_u32 s70, s70, s87
buffer_load_dwordx4 v[104:107], v18, s[12:15], s70 offen sc1
s_add_u32 s70, s65, 7
s_and_b32 s70, s70, 15
s_mul_i32 s70, s70, 4352
s_add_u32 s70, s70, s87
buffer_load_dwordx4 v[108:111], v18, s[12:15], s70 offen sc1
s_add_u32 s70, s65, 8
s_and_b32 s70, s70, 15
s_mul_i32 s70, s70, 4352
s_add_u32 s70, s70, s87
buffer_load_dwordx4 v[112:115], v18, s[12:15], s70 offen sc1
s_add_u32 s70, s65, 9
s_and_b32 s70, s70, 15
s_mul_i32 s70, s70, 4352
s_add_u32 s70, s70, s87
buffer_load_dwordx4 v[116:119], v18, s[12:15], s70 offen sc1
s_add_u32 s70, s65, 10
s_and_b32 s70, s70, 15
s_mul_i32 s70, s70, 4352
s_add_u32 s70, s70, s87
buffer_load_dwordx4 v[120:123], v18, s[12:15], s70 offen sc1
s_add_u32 s70, s65, 11
s_and_b32 s70, s70, 15
s_mul_i32 s70, s70, 4352
s_add_u32 s70, s70, s87
buffer_load_dwordx4 v[124:127], v18, s[12:15], s70 offen sc1
s_add_u32 s70, s65, 12
s_and_b32 s70, s70, 15
s_mul_i32 s70, s70, 4352
s_add_u32 s70, s70, s87
buffer_load_dwordx4 v[128:131], v18, s[12:15], s70 offen sc1
s_add_u32 s70, s65, 13
s_and_b32 s70, s70, 15
s_mul_i32 s70, s70, 4352
s_add_u32 s70, s70, s87
buffer_load_dwordx4 v[132:135], v18, s[12:15], s70 offen sc1
s_add_u32 s70, s65, 14
s_and_b32 s70, s70, 15
s_mul_i32 s70, s70, 4352
s_add_u32 s70, s70, s87
buffer_load_dwordx4 v[136:139], v18, s[12:15], s70 offen sc1
s_branch L_over1
L_pad1:
s_branch L_retF
L_over1:
s_add_u32 s70, s65, 15
s_and_b32 s70, s70, 15
s_mul_i32 s70, s70, 4352
s_add_u32 s70, s70, s87
buffer_load_dwordx4 v[140:143], v18, s[12:15], s70 offen sc1
s_add_u32 s70, s65, 16
s_and_b32 s70, s70, 15
s_mul_i32 s70, s70, 4352
s_add_u32 s70, s70, s87
buffer_load_dwordx4 v[144:147], v18, s[12:15], s70 offen sc1
buffer_load_dwordx4 v[148:151], v55, s[12:15], s88 offen sc1
s_lshl_b32 s70, s66, 6
s_lshl_b32 s71, s67, 3
s_add_u32 s70, s70, s71
s_add_u32 s70, s70, 161600
v_lshrrev_b32 v4, 4, v1
v_lshlrev_b32 v4, 4, v4
v_add_u32 v4, s70, v4
s_lshl_b32 s70, s60, 10
s_add_u32 s70, s70, 24576
v_add_u32 v3, s70, v18
s_mov_b32 s73, 31
L_kvr:
s_bitcmp1_b32 s73, 0
s_cbranch_scc0 L_kvs0
s_waitcnt vmcnt(13)
v_max3_u32 v2, v84, v88, v92
v_max_u32 v2, v2, v96
v_cmp_eq_u32 vcc, -1, v2
s_cbranch_vccnz L_kvs0
s_bitset0_b32 s73, 0
v_mfma_f32_16x16x32_bf16 v[20:23], v[58:61], v[84:87], 0
v_mfma_f32_16x16x32_bf16 v[24:27], v[56:59], v[84:87], 0
v_mfma_f32_16x16x32_bf16 v[20:23], v[58:61], v[88:91], v[20:23]
v_mfma_f32_16x16x32_bf16 v[24:27], v[56:59], v[88:91], v[24:27]
v_mfma_f32_16x16x32_bf16 v[20:23], v[58:61], v[92:95], v[20:23]
v_mfma_f32_16x16x32_bf16 v[24:27], v[56:59], v[92:95], v[24:27]
v_mfma_f32_16x16x32_bf16 v[20:23], v[58:61], v[96:99], v[20:23]
v_mfma_f32_16x16x32_bf16 v[24:27], v[56:59], v[96:99], v[24:27]
L_kvs0:
s_bitcmp1_b32 s73, 1
s_cbranch_scc0 L_kvs1
s_waitcnt vmcnt(9)
v_max3_u32 v2, v100, v104, v108
v_max_u32 v2, v2, v112
v_cmp_eq_u32 vcc, -1, v2
s_cbranch_vccnz L_kvs1
s_bitset0_b32 s73, 1
v_mfma_f32_16x16x32_bf16 v[28:31], v[58:61], v[100:103], 0
v_mfma_f32_16x16x32_bf16 v[32:35], v[56:59], v[100:103], 0
v_mfma_f32_16x16x32_bf16 v[28:31], v[58:61], v[104:107], v[28:31]
v_mfma_f32_16x16x32_bf16 v[32:35], v[56:59], v[104:107], v[32:35]
v_mfma_f32_16x16x32_bf16 v[28:31], v[58:61], v[108:111], v[28:31]
v_mfma_f32_16x16x32_bf16 v[32:35], v[56:59], v[108:111], v[32:35]
v_mfma_f32_16x16x32_bf16 v[28:31], v[58:61], v[112:115], v[28:31]
v_mfma_f32_16x16x32_bf16 v[32:35], v[56:59], v[112:115], v[32:35]
L_kvs1:
s_bitcmp1_b32 s73, 2
s_cbranch_scc0 L_kvs2
s_waitcnt vmcnt(5)
v_max3_u32 v2, v116, v120, v124
v_max_u32 v2, v2, v128
v_cmp_eq_u32 vcc, -1, v2
s_cbranch_vccnz L_kvs2
s_bitset0_b32 s73, 2
v_mfma_f32_16x16x32_bf16 v[36:39], v[58:61], v[116:119], 0
v_mfma_f32_16x16x32_bf16 v[40:43], v[56:59], v[116:119], 0
v_mfma_f32_16x16x32_bf16 v[36:39], v[58:61], v[120:123], v[36:39]
v_mfma_f32_16x16x32_bf16 v[40:43], v[56:59], v[120:123], v[40:43]
v_mfma_f32_16x16x32_bf16 v[36:39], v[58:61], v[124:127], v[36:39]
v_mfma_f32_16x16x32_bf16 v[40:43], v[56:59], v[124:127], v[40:43]
v_mfma_f32_16x16x32_bf16 v[36:39], v[58:61], v[128:131], v[36:39]
v_mfma_f32_16x16x32_bf16 v[40:43], v[56:59], v[128:131], v[40:43]
L_kvs2:
s_bitcmp1_b32 s73, 3
s_cbranch_scc0 L_kvs3
s_waitcnt vmcnt(1)
v_max3_u32 v2, v132, v136, v140
v_max_u32 v2, v2, v144
v_cmp_eq_u32 vcc, -1, v2
s_cbranch_vccnz L_kvs3
s_bitset0_b32 s73, 3
v_mfma_f32_16x16x32_bf16 v[44:47], v[58:61], v[132:135], 0
v_mfma_f32_16x16x32_bf16 v[48:51], v[56:59], v[132:135], 0
v_mfma_f32_16x16x32_bf16 v[44:47], v[58:61], v[136:139], v[44:47]
v_mfma_f32_16x16x32_bf16 v[48:51], v[56:59], v[136:139], v[48:51]
v_mfma_f32_16x16x32_bf16 v[44:47], v[58:61], v[140:143], v[44:47]
v_mfma_f32_16x16x32_bf16 v[48:51], v[56:59], v[140:143], v[48:51]
v_mfma_f32_16x16x32_bf16 v[44:47], v[58:61], v[144:147], v[44:47]
v_mfma_f32_16x16x32_bf16 v[48:51], v[56:59], v[144:147], v[48:51]
L_kvs3:
s_bitcmp1_b32 s73, 4
s_cbranch_scc0 L_kvs4
s_waitcnt vmcnt(0)
v_xor_b32 v148, s84, v148
v_xor_b32 v149, s84, v149
v_xor_b32 v150, s84, v150
v_xor_b32 v151, s84, v151
v_or3_b32 v2, v148, v149, v150
v_bitop3_b32 v2, v2, v151, s91 bitop3:0xa8
v_cmp_ne_u32 vcc, 0, v2
s_cbranch_vccnz L_kvs4
s_bitset0_b32 s73, 4
v_add_f32_dpp v148, v148, v148 row_ror:1 row_mask:0xf bank_mask:0xf
v_add_f32_dpp v149, v149, v149 row_ror:1 row_mask:0xf bank_mask:0xf
v_add_f32_dpp v150, v150, v150 row_ror:1 row_mask:0xf bank_mask:0xf
v_add_f32_dpp v151, v151, v151 row_ror:1 row_mask:0xf bank_mask:0xf
v_add_f32_dpp v148, v148, v148 row_ror:2 row_mask:0xf bank_mask:0xf
v_add_f32_dpp v149, v149, v149 row_ror:2 row_mask:0xf bank_mask:0xf
v_add_f32_dpp v150, v150, v150 row_ror:2 row_mask:0xf bank_mask:0xf
v_add_f32_dpp v151, v151, v151 row_ror:2 row_mask:0xf bank_mask:0xf
v_add_f32_dpp v148, v148, v148 row_ror:4 row_mask:0xf bank_mask:0xf
v_add_f32_dpp v149, v149, v149 row_ror:4 row_mask:0xf bank_mask:0xf
v_add_f32_dpp v150, v150, v150 row_ror:4 row_mask:0xf bank_mask:0xf
v_add_f32_dpp v151, v151, v151 row_ror:4 row_mask:0xf bank_mask:0xf
v_add_f32_dpp v148, v148, v148 row_ror:8 row_mask:0xf bank_mask:0xf
v_add_f32_dpp v149, v149, v149 row_ror:8 row_mask:0xf bank_mask:0xf
v_add_f32_dpp v150, v150, v150 row_ror:8 row_mask:0xf bank_mask:0xf
v_add_f32_dpp v151, v151, v151 row_ror:8 row_mask:0xf bank_mask:0xf
v_cvt_pk_bf16_f32 v148, v148, v149
v_cvt_pk_bf16_f32 v149, v150, v151
ds_write_b64 v4, v[148:149]
L_kvs4:
s_cmp_lg_u32 s73, 0
s_cbranch_scc1 L_kvrt
L_kvok:
s_nop 3
v_pk_add_f32 v[20:21], v[20:21], v[28:29]
v_pk_add_f32 v[22:23], v[22:23], v[30:31]
v_pk_add_f32 v[24:25], v[24:25], v[32:33]
v_pk_add_f32 v[26:27], v[26:27], v[34:35]
v_pk_add_f32 v[36:37], v[36:37], v[44:45]
v_pk_add_f32 v[38:39], v[38:39], v[46:47]
v_pk_add_f32 v[40:41], v[40:41], v[48:49]
v_pk_add_f32 v[42:43], v[42:43], v[50:51]
v_pk_add_f32 v[20:21], v[20:21], v[36:37]
v_pk_add_f32 v[22:23], v[22:23], v[38:39]
v_pk_add_f32 v[24:25], v[24:25], v[40:41]
v_pk_add_f32 v[26:27], v[26:27], v[42:43]
v_cvt_pk_bf16_f32 v20, v20, v21
v_cvt_pk_bf16_f32 v21, v22, v23
v_cvt_pk_bf16_f32 v22, v24, v25
v_cvt_pk_bf16_f32 v23, v26, v27
ds_write_b128 v3, v[20:23]
s_waitcnt lgkmcnt(0)
s_barrier
s_mov_b32 exec_lo, 0x0
s_mov_b32 exec_hi, 0x3f000000
buffer_load_dword v81, v83, s[12:15], 0 offen
s_mov_b64 exec, -1
s_cmp_eq_u32 s60, 0
s_cbranch_scc1 L_pad2
s_cmp_eq_u32 s60, 1
s_cbranch_scc1 L_pad6
s_cmp_eq_u32 s60, 2
s_cbranch_scc1 L_pad7
s_branch L_pad9
L_retG:
v_lshrrev_b32 v2, 5, v1
v_lshlrev_b32 v2, 11, v2
v_bfe_u32 v3, v1, 3, 2
v_lshl_add_u32 v2, v3, 7, v2
v_bfe_u32 v3, v1, 4, 1
v_bfe_u32 v4, v1, 1, 2
v_xor_b32 v3, v3, v4
v_lshl_add_u32 v2, v3, 5, v2
v_and_b32 v3, 1, v1
v_lshl_add_u32 v2, v3, 4, v2
s_lshl_b32 s70, s60, 13
s_add_u32 s71, s70, 65536
v_add_u32 v100, s71, v2
v_xor_b32 v101, 64, v100
v_lshrrev_b32 v2, 2, v1
v_bfe_u32 v5, v1, 3, 2
v_xor_b32 v6, s60, v5
v_lshlrev_b32 v6, 5, v6
v_lshl_add_u32 v6, v2, 7, v6
v_and_b32 v7, 3, v1
v_lshl_add_u32 v6, v7, 3, v6
v_add_u32 v102, 65536, v6
s_lshl_b32 s71, s66, 16
s_add_u32 s70, s70, s71
s_add_u32 s70, s70, 49152
v_lshlrev_b32 v6, 5, v5
v_lshl_add_u32 v6, v2, 7, v6
v_lshl_add_u32 v6, v7, 3, v6
v_add_u32 v104, s70, v6
v_xor_b32 v105, 32, v104
v_xor_b32 v106, 64, v104
v_xor_b32 v107, 96, v104
v_lshrrev_b32 v5, 4, v1
v_xor_b32 v4, v4, v5
v_lshlrev_b32 v4, 5, v4
v_lshrrev_b32 v6, 3, v1
v_lshl_add_u32 v4, v6, 7, v4
v_lshl_add_u32 v4, v3, 4, v4
v_add_u32 v103, s70, v4
s_lshl_b32 s70, s60, 5
s_add_u32 s70, s70, 161792
v_mov_b32 v63, s70
v_add_u32 v114, 16, v63
v_lshl_add_u32 v56, v3, 4, v63
s_and_b32 s70, s65, 3
s_lshl_b32 s70, s70, 9
s_add_u32 s70, s70, 7864320
v_lshl_add_u32 v57, v5, 4, s70
v_lshlrev_b32 v60, 6, v5
v_lshl_add_u32 v60, v7, 4, v60
v_and_b32 v2, 3, v2
v_lshl_add_u32 v61, v2, 8, v60
v_lshlrev_b32 v62, 4, v3
v_lshl_add_u32 v62, v5, 5, v62
v_mov_b32 v59, s68
s_lshl_b32 s71, s79, 2
s_add_u32 s71, s71, s60
s_lshl_b32 s70, s71, 8
s_add_u32 s70, s70, 6946816
s_mov_b32 s85, s70
s_and_b32 s71, s65, 3
s_lshl2_add_u32 s71, s3, s71
s_and_b32 s70, s65, 12
s_add_u32 s70, s70, s60
s_lshl_b32 s71, s71, 7
s_lshl_b32 s70, s70, 15
s_add_u32 s70, s70, s71
s_add_u32 s70, s70, 7340032
s_mov_b32 s88, s70
s_and_b32 s70, s65, 3
s_lshl2_add_u32 s70, s64, s70
s_and_b32 s71, s65, 12
s_add_u32 s71, s71, s60
s_lshl_b32 s70, s70, 12
s_add_u32 s86, s70, 6946816
s_lshl_b32 s87, s62, 11
s_add_u32 s87, s87, 6815744
s_mov_b32 s94, 0
s_mov_b32 s95, 0
s_mov_b32 s92, 0x000f000f
s_mov_b32 s93, 0x000f000f
s_mov_b32 s38, 0
v_mov_b32 v64, 0x3f803f80
v_mov_b32 v65, 0x3f803f80
v_mov_b32 v66, 0x3f803f80
v_mov_b32 v67, 0x3f803f80
v_add_u32 v115, 64, v1
v_mov_b32 v2, 0
v_mov_b32 v95, 0
v_mov_b32 v99, 0
s_waitcnt vmcnt(0) lgkmcnt(0)
s_barrier
ds_write_b128 v100, a[0:3] offset:0
ds_write_b128 v101, a[4:7] offset:512
ds_write_b128 v100, a[8:11] offset:1024
ds_write_b128 v101, a[12:15] offset:1536
ds_write_b128 v100, a[16:19] offset:4096
ds_write_b128 v101, a[20:23] offset:4608
ds_write_b128 v100, a[24:27] offset:5120
ds_write_b128 v101, a[28:31] offset:5632
ds_write_b128 v100, a[32:35] offset:32768
ds_write_b128 v101, a[36:39] offset:33280
ds_write_b128 v100, a[40:43] offset:33792
ds_write_b128 v101, a[44:47] offset:34304
ds_write_b128 v100, a[48:51] offset:36864
ds_write_b128 v101, a[52:55] offset:37376
ds_write_b128 v100, a[56:59] offset:37888
ds_write_b128 v101, a[60:63] offset:38400
ds_write_b128 v103, a[64:67] offset:0
ds_write_b128 v103, a[68:71] offset:1024
ds_write_b128 v103, a[72:75] offset:2048
ds_write_b128 v103, a[76:79] offset:3072
ds_write_b128 v103, a[80:83] offset:4096
ds_write_b128 v103, a[84:87] offset:5120
ds_write_b128 v103, a[88:91] offset:6144
ds_write_b128 v103, a[92:95] offset:7168
s_waitcnt lgkmcnt(0)
ds_read_b64_tr_b16 a[64:65], v104 offset:0
ds_read_b64_tr_b16 a[66:67], v104 offset:2048
ds_read_b64_tr_b16 a[68:69], v104 offset:4096
ds_read_b64_tr_b16 a[70:71], v104 offset:6144
ds_read_b64_tr_b16 a[72:73], v105 offset:0
ds_read_b64_tr_b16 a[74:75], v105 offset:2048
ds_read_b64_tr_b16 a[76:77], v105 offset:4096
ds_read_b64_tr_b16 a[78:79], v105 offset:6144
ds_read_b64_tr_b16 a[80:81], v106 offset:0
ds_read_b64_tr_b16 a[82:83], v106 offset:2048
ds_read_b64_tr_b16 a[84:85], v106 offset:4096
ds_read_b64_tr_b16 a[86:87], v106 offset:6144
ds_read_b64_tr_b16 a[88:89], v107 offset:0
ds_read_b64_tr_b16 a[90:91], v107 offset:2048
ds_read_b64_tr_b16 a[92:93], v107 offset:4096
ds_read_b64_tr_b16 a[94:95], v107 offset:6144
s_barrier
ds_read_b64_tr_b16 a[0:1], v102 offset:0
ds_read_b64_tr_b16 a[2:3], v102 offset:2048
ds_read_b64_tr_b16 a[32:33], v102 offset:32768
ds_read_b64_tr_b16 a[34:35], v102 offset:34816
ds_read_b64_tr_b16 a[4:5], v102 offset:4096
ds_read_b64_tr_b16 a[6:7], v102 offset:6144
ds_read_b64_tr_b16 a[36:37], v102 offset:36864
ds_read_b64_tr_b16 a[38:39], v102 offset:38912
ds_read_b64_tr_b16 a[8:9], v102 offset:8192
ds_read_b64_tr_b16 a[10:11], v102 offset:10240
ds_read_b64_tr_b16 a[40:41], v102 offset:40960
ds_read_b64_tr_b16 a[42:43], v102 offset:43008
ds_read_b64_tr_b16 a[12:13], v102 offset:12288
ds_read_b64_tr_b16 a[14:15], v102 offset:14336
ds_read_b64_tr_b16 a[44:45], v102 offset:45056
ds_read_b64_tr_b16 a[46:47], v102 offset:47104
ds_read_b64_tr_b16 a[16:17], v102 offset:16384
ds_read_b64_tr_b16 a[18:19], v102 offset:18432
ds_read_b64_tr_b16 a[48:49], v102 offset:49152
ds_read_b64_tr_b16 a[50:51], v102 offset:51200
ds_read_b64_tr_b16 a[20:21], v102 offset:20480
ds_read_b64_tr_b16 a[22:23], v102 offset:22528
ds_read_b64_tr_b16 a[52:53], v102 offset:53248
ds_read_b64_tr_b16 a[54:55], v102 offset:55296
ds_read_b64_tr_b16 a[24:25], v102 offset:24576
ds_read_b64_tr_b16 a[26:27], v102 offset:26624
ds_read_b64_tr_b16 a[56:57], v102 offset:57344
ds_read_b64_tr_b16 a[58:59], v102 offset:59392
ds_read_b64_tr_b16 a[28:29], v102 offset:28672
ds_read_b64_tr_b16 a[30:31], v102 offset:30720
ds_read_b64_tr_b16 a[60:61], v102 offset:61440
ds_read_b64_tr_b16 a[62:63], v102 offset:63488
s_waitcnt lgkmcnt(0)
buffer_load_dwordx4 v[92:95], v18, s[12:15], s87 offen offset:0 sc1
buffer_load_dwordx4 v[96:99], v18, s[12:15], s87 offen offset:1024 sc1
v_mfma_f32_16x16x32_bf16 v[68:71], a[0:3], v[64:67], 0
v_mfma_f32_16x16x32_bf16 v[72:75], a[32:35], v[64:67], 0
v_mfma_f32_16x16x32_bf16 v[68:71], a[4:7], v[64:67], v[68:71]
v_mfma_f32_16x16x32_bf16 v[72:75], a[36:39], v[64:67], v[72:75]
v_mfma_f32_16x16x32_bf16 v[68:71], a[8:11], v[64:67], v[68:71]
v_mfma_f32_16x16x32_bf16 v[72:75], a[40:43], v[64:67], v[72:75]
v_mfma_f32_16x16x32_bf16 v[68:71], a[12:15], v[64:67], v[68:71]
v_mfma_f32_16x16x32_bf16 v[72:75], a[44:47], v[64:67], v[72:75]
v_mfma_f32_16x16x32_bf16 v[68:71], a[16:19], v[64:67], v[68:71]
v_mfma_f32_16x16x32_bf16 v[72:75], a[48:51], v[64:67], v[72:75]
v_mfma_f32_16x16x32_bf16 v[68:71], a[20:23], v[64:67], v[68:71]
v_mfma_f32_16x16x32_bf16 v[72:75], a[52:55], v[64:67], v[72:75]
v_mfma_f32_16x16x32_bf16 v[68:71], a[24:27], v[64:67], v[68:71]
v_mfma_f32_16x16x32_bf16 v[72:75], a[56:59], v[64:67], v[72:75]
v_mfma_f32_16x16x32_bf16 v[68:71], a[28:31], v[64:67], v[68:71]
v_mfma_f32_16x16x32_bf16 v[72:75], a[60:63], v[64:67], v[72:75]
L_pk:
s_waitcnt vmcnt(0)
L_pk2:
v_cmp_eq_u32_e64 s[80:81], s68, v95
v_cmp_eq_u32_e64 s[82:83], s68, v99
s_nop 0
v_cndmask_b32_e64 v108, 0, v92, s[80:81]
v_cndmask_b32_e64 v109, 0, v96, s[82:83]
s_and_b64 s[76:77], s[80:81], s[82:83]
v_max_u32 v110, v108, v109
v_min_u32 v111, v108, v109
s_cmp_eq_u64 s[76:77], -1
s_cselect_b32 s73, 0, 1
s_cbranch_scc1 L_pkc
s_not_b64 exec, s[80:81]
s_cselect_b64 exec, exec, 1
buffer_load_dwordx4 v[92:95], v18, s[12:15], s87 offen offset:0 sc1
s_not_b64 exec, s[82:83]
s_cselect_b64 exec, exec, 1
buffer_load_dwordx4 v[96:99], v18, s[12:15], s87 offen offset:1024 sc1
s_mov_b64 exec, -1
L_pkc:
v_cmp_le_u32 vcc, s95, v110
v_cmp_le_u32_e64 s[76:77], s95, v111
s_bcnt1_i32_b64 s70, vcc
s_bcnt1_i32_b64 s71, s[76:77]
s_add_u32 s70, s70, s71
s_cmp_eq_u32 s70, 2
s_cbranch_scc1 L_pksame
v_mov_b32_dpp v112, v110 row_ror:1 row_mask:0xf bank_mask:0xf
v_max_u32_dpp v113, v111, v111 row_ror:1 row_mask:0xf bank_mask:0xf
v_med3_u32 v111, v110, v112, v113
v_max_u32 v110, v110, v112
s_nop 1
v_mov_b32_dpp v112, v110 row_ror:2 row_mask:0xf bank_mask:0xf
v_max_u32_dpp v113, v111, v111 row_ror:2 row_mask:0xf bank_mask:0xf
v_med3_u32 v111, v110, v112, v113
v_max_u32 v110, v110, v112
s_nop 1
v_mov_b32_dpp v112, v110 row_ror:4 row_mask:0xf bank_mask:0xf
v_max_u32_dpp v113, v111, v111 row_ror:4 row_mask:0xf bank_mask:0xf
v_med3_u32 v111, v110, v112, v113
v_max_u32 v110, v110, v112
s_nop 1
v_mov_b32_dpp v112, v110 row_ror:8 row_mask:0xf bank_mask:0xf
v_max_u32_dpp v113, v111, v111 row_ror:8 row_mask:0xf bank_mask:0xf
v_med3_u32 v111, v110, v112, v113
v_max_u32 v110, v110, v112
v_mov_b32 v112, v110
v_mov_b32 v113, v111
s_nop 0
v_permlane16_swap_b32 v110, v112
v_permlane16_swap_b32 v111, v113
v_max_u32 v113, v111, v113
v_med3_u32 v111, v110, v112, v113
v_max_u32 v110, v110, v112
v_mov_b32 v112, v110
v_mov_b32 v113, v111
s_nop 0
v_permlane32_swap_b32 v110, v112
v_permlane32_swap_b32 v111, v113
v_max_u32 v113, v111, v113
v_med3_u32 v111, v110, v112, v113
v_max_u32 v110, v110, v112
v_readfirstlane_b32 s95, v111
s_nop 0
s_cmp_eq_u32 s95, 0
s_cbranch_scc1 L_pksame
v_cmp_eq_u32 vcc, v108, v111
v_cmp_eq_u32_e64 s[76:77], v108, v110
s_nop 0
v_cndmask_b32 v112, v63, v114, vcc
s_or_b64 exec, vcc, s[76:77]
ds_write_b96 v112, v[92:94]
ds_write_b32 v112, v1 offset:12
s_mov_b64 exec, -1
v_cmp_eq_u32 vcc, v109, v111
v_cmp_eq_u32_e64 s[76:77], v109, v110
s_nop 0
v_cndmask_b32 v113, v63, v114, vcc
s_or_b64 exec, vcc, s[76:77]
ds_write_b96 v113, v[96:98]
ds_write_b32 v113, v115 offset:12
s_mov_b64 exec, -1
ds_read_b128 v[20:23], v56
s_waitcnt lgkmcnt(0)
v_lshl_add_u32 v58, v23, 11, v57
s_mov_b64 exec, s[92:93]
buffer_load_dwordx4 v[24:27], v58, s[12:15], 0 offen offset:0 sc1
buffer_load_dwordx4 v[28:31], v58, s[12:15], 0 offen offset:64 sc1
buffer_load_dwordx4 v[32:35], v58, s[12:15], 0 offen offset:128 sc1
buffer_load_dwordx4 v[36:39], v58, s[12:15], 0 offen offset:192 sc1
buffer_load_dwordx4 v[40:43], v58, s[12:15], 0 offen offset:256 sc1
buffer_load_dwordx4 v[44:47], v58, s[12:15], 0 offen offset:320 sc1
buffer_load_dwordx4 v[48:51], v58, s[12:15], 0 offen offset:384 sc1
buffer_load_dwordx4 v[52:55], v58, s[12:15], 0 offen offset:448 sc1
s_mov_b64 exec, -1
v_mul_f32_e64 v84, v68, -v21
v_mul_f32_e64 v85, v69, -v21
v_mul_f32_e64 v86, v70, -v21
v_mul_f32_e64 v87, v71, -v21
v_mul_f32_e64 v88, v72, -v21
v_mul_f32_e64 v89, v73, -v21
v_mul_f32_e64 v90, v74, -v21
v_mul_f32_e64 v91, v75, -v21
s_cmp_eq_u32 s73, 0
s_cbranch_scc1 L_pkf
s_waitcnt vmcnt(8)
s_add_u32 s78, s78, 1
s_cmp_le_u32 s78, 65536
s_cbranch_scc1 L_pk2
L_pkf:
s_waitcnt vmcnt(0)
L_pkx_chk:
v_max3_u32 v2, v24, v28, v32
v_max3_u32 v3, v36, v40, v44
v_max3_u32 v2, v2, v48, v52
v_max_u32 v2, v2, v3
v_cmp_eq_u32 vcc, -1, v2
s_nop 0
s_and_b64 vcc, vcc, s[92:93]
s_cbranch_vccnz L_pkx_rt
L_pkx_ok:
v_mfma_f32_16x16x32_bf16 v[84:87], a[0:3], v[24:27], v[84:87]
v_mfma_f32_16x16x32_bf16 v[88:91], a[32:35], v[24:27], v[88:91]
v_mfma_f32_16x16x32_bf16 v[84:87], a[4:7], v[28:31], v[84:87]
v_mfma_f32_16x16x32_bf16 v[88:91], a[36:39], v[28:31], v[88:91]
v_mfma_f32_16x16x32_bf16 v[84:87], a[8:11], v[32:35], v[84:87]
v_mfma_f32_16x16x32_bf16 v[88:91], a[40:43], v[32:35], v[88:91]
v_mfma_f32_16x16x32_bf16 v[84:87], a[12:15], v[36:39], v[84:87]
v_mfma_f32_16x16x32_bf16 v[88:91], a[44:47], v[36:39], v[88:91]
v_mfma_f32_16x16x32_bf16 v[84:87], a[16:19], v[40:43], v[84:87]
v_mfma_f32_16x16x32_bf16 v[88:91], a[48:51], v[40:43], v[88:91]
v_mfma_f32_16x16x32_bf16 v[84:87], a[20:23], v[44:47], v[84:87]
v_mfma_f32_16x16x32_bf16 v[88:91], a[52:55], v[44:47], v[88:91]
v_mfma_f32_16x16x32_bf16 v[84:87], a[24:27], v[48:51], v[84:87]
v_mfma_f32_16x16x32_bf16 v[88:91], a[56:59], v[48:51], v[88:91]
v_mfma_f32_16x16x32_bf16 v[84:87], a[28:31], v[52:55], v[84:87]
v_mfma_f32_16x16x32_bf16 v[88:91], a[60:63], v[52:55], v[88:91]
s_mov_b32 s76, 0xcccccccc
s_mov_b32 s77, 0xcccccccc
s_nop 5
v_cndmask_b32_e64 v84, v84, v88, s[76:77]
v_cndmask_b32_e64 v85, v85, v89, s[76:77]
v_cndmask_b32_e64 v86, v86, v90, s[76:77]
v_cndmask_b32_e64 v87, v87, v91, s[76:77]
v_bfi_b32 v84, s91, v59, v84
s_mov_b64 exec, s[92:93]
s_cmp_eq_u32 s69, 0
s_cbranch_scc1 L_pxp_s
buffer_store_dwordx4 v[84:87], v60, s[12:15], s85 offen
L_pxp_d:
s_mov_b64 exec, -1
buffer_load_dwordx4 v[24:27], v61, s[12:15], s86 offen offset:0 sc1
buffer_load_dwordx4 v[28:31], v61, s[12:15], s86 offen offset:1024 sc1
buffer_load_dwordx4 v[32:35], v61, s[12:15], s86 offen offset:2048 sc1
buffer_load_dwordx4 v[36:39], v61, s[12:15], s86 offen offset:3072 sc1
s_barrier
s_mov_b32 s92, 0x00030003
s_mov_b32 s93, 0x00030003
s_waitcnt vmcnt(0)
L_px_chk:
v_xor_b32 v24, s84, v24
v_xor_b32 v28, s84, v28
v_xor_b32 v32, s84, v32
v_xor_b32 v36, s84, v36
v_or3_b32 v2, v24, v28, v32
v_bitop3_b32 v2, v2, v36, s91 bitop3:0xa8
v_cmp_ne_u32 vcc, 0, v2
s_cbranch_vccnz L_px_rt
L_px_ok:
v_pk_add_f32 v[24:25], v[24:25], v[28:29]
v_pk_add_f32 v[32:33], v[32:33], v[36:37]
v_pk_add_f32 v[26:27], v[26:27], v[30:31]
v_pk_add_f32 v[34:35], v[34:35], v[38:39]
v_pk_add_f32 v[24:25], v[24:25], v[32:33]
v_pk_add_f32 v[26:27], v[26:27], v[34:35]
v_pk_mul_f32 v[24:25], v[24:25], v[22:23] op_sel_hi:[1,0]
v_pk_mul_f32 v[26:27], v[26:27], v[22:23] op_sel_hi:[1,0]
v_mul_f32 v28, 0xbfb8aa3b, v24
v_mul_f32 v29, 0xbfb8aa3b, v25
v_mul_f32 v30, 0xbfb8aa3b, v26
v_mul_f32 v31, 0xbfb8aa3b, v27
v_exp_f32 v28, v28
v_exp_f32 v29, v29
v_exp_f32 v30, v30
v_exp_f32 v31, v31
v_mul_f32_dpp v32, v24, v24 quad_perm:[2,3,0,1] row_mask:0xf bank_mask:0xf
v_mul_f32_dpp v33, v25, v25 quad_perm:[2,3,0,1] row_mask:0xf bank_mask:0xf
v_mul_f32_dpp v34, v26, v26 quad_perm:[2,3,0,1] row_mask:0xf bank_mask:0xf
v_mul_f32_dpp v35, v27, v27 quad_perm:[2,3,0,1] row_mask:0xf bank_mask:0xf
v_add_f32 v28, 1.0, v28
v_add_f32 v29, 1.0, v29
v_add_f32 v30, 1.0, v30
v_add_f32 v31, 1.0, v31
v_rcp_f32 v28, v28
v_rcp_f32 v29, v29
v_rcp_f32 v30, v30
v_rcp_f32 v31, v31
v_mul_f32 v24, v32, v28
v_mul_f32 v25, v33, v29
v_mul_f32 v26, v34, v30
v_mul_f32 v27, v35, v31
v_cvt_pk_bf16_f32 v28, v24, v25
v_cvt_pk_bf16_f32 v29, v26, v27
s_nop 0
v_mov_b32_dpp v30, v28 row_shl:4 row_mask:0xf bank_mask:0xf
v_mov_b32_dpp v31, v29 row_shl:4 row_mask:0xf bank_mask:0xf
v_mov_b32_dpp v32, v28 row_shl:8 row_mask:0xf bank_mask:0xf
v_mov_b32_dpp v33, v29 row_shl:8 row_mask:0xf bank_mask:0xf
v_mov_b32_dpp v34, v28 row_shl:12 row_mask:0xf bank_mask:0xf
v_mov_b32_dpp v35, v29 row_shl:12 row_mask:0xf bank_mask:0xf
v_mfma_f32_16x16x32_bf16 v[40:43], a[64:67], v[28:31], 0
v_mfma_f32_16x16x32_bf16 v[44:47], a[72:75], v[28:31], 0
v_mfma_f32_16x16x32_bf16 v[48:51], a[80:83], v[28:31], 0
v_mfma_f32_16x16x32_bf16 v[52:55], a[88:91], v[28:31], 0
v_mfma_f32_16x16x32_bf16 v[40:43], a[68:71], v[32:35], v[40:43]
v_mfma_f32_16x16x32_bf16 v[44:47], a[76:79], v[32:35], v[44:47]
v_mfma_f32_16x16x32_bf16 v[48:51], a[84:87], v[32:35], v[48:51]
v_mfma_f32_16x16x32_bf16 v[52:55], a[92:95], v[32:35], v[52:55]
s_cmp_ge_u32 s3, 14
s_cbranch_scc1 L_noy
s_mov_b64 exec, s[92:93]
s_nop 1
v_bfi_b32 v40, s91, v59, v40
buffer_store_dwordx4 v[40:43], v62, s[12:15], s88 offen sc1
s_add_u32 s88, s88, 8192
v_bfi_b32 v44, s91, v59, v44
buffer_store_dwordx4 v[44:47], v62, s[12:15], s88 offen sc1
s_add_u32 s88, s88, 8192
v_bfi_b32 v48, s91, v59, v48
buffer_store_dwordx4 v[48:51], v62, s[12:15], s88 offen sc1
s_add_u32 s88, s88, 8192
v_bfi_b32 v52, s91, v59, v52
buffer_store_dwordx4 v[52:55], v62, s[12:15], s88 offen sc1
s_mov_b64 exec, -1
L_noy:
s_or_b32 s70, s2, s60
s_cbranch_scc1 L_noep
v_mov_b32 v3, 0
s_mov_b64 exec, 1
buffer_store_dword v59, v3, s[12:15], 0 offen sc1
s_mov_b64 exec, -1
L_noep:
s_cmp_lt_u32 s63, 24
s_cbranch_scc1 L_ldone
s_cmp_lg_u32 s60, 1
s_cbranch_scc1 L_ldone
s_lshl_b32 s87, s62, 3
s_add_u32 s87, s87, s63
s_sub_u32 s87, s87, 24
s_lshl_b32 s88, s87, 13
s_add_u32 s88, s88, 7340032
s_add_u32 s71, s88, 4096
s_lshl_b32 s70, s87, 5
v_bfe_u32 v3, v1, 1, 2
v_lshl_add_u32 v7, v3, 3, s70
s_mov_b32 s72, 7864320
v_lshl_add_u32 v64, v23, 11, v7
buffer_load_dwordx2 v[84:85], v64, s[12:15], s72 offen sc1
buffer_load_dwordx4 v[120:123], v18, s[12:15], s88 offen offset:0 sc1
buffer_load_dwordx4 v[124:127], v18, s[12:15], s88 offen offset:1024 sc1
buffer_load_dwordx4 v[128:131], v18, s[12:15], s88 offen offset:2048 sc1
buffer_load_dwordx4 v[132:135], v18, s[12:15], s88 offen offset:3072 sc1
buffer_load_dwordx4 v[136:139], v18, s[12:15], s71 offen offset:0 sc1
buffer_load_dwordx4 v[140:143], v18, s[12:15], s71 offen offset:1024 sc1
buffer_load_dwordx4 v[144:147], v18, s[12:15], s71 offen offset:2048 sc1
v_mov_b32 v88, s84
v_and_b32 v65, 0xfffff800, v20
v_not_b32 v4, v65
v_ashrrev_i32 v4, 31, v4
v_or_b32 v4, 0x80000000, v4
v_xor_b32 v65, v65, v4
v_mul_f32 v65, 0xbfb8aa3b, v65
v_exp_f32 v65, v65
s_nop 0
v_add_f32 v65, 1.0, v65
v_rcp_f32 v65, v65
v_and_b32 v66, 0x7ff, v20
v_sub_u32 v66, 2047, v66
v_lshl_add_u32 v66, v66, 11, v7
v_add_f32 v67, 1.0, v22
v_mul_f32_e64 v21, -v21, v22
s_waitcnt vmcnt(7)
L_h_chk:
v_cmp_eq_u32 vcc, -1, v84
s_cbranch_vccnz L_h_rt
L_h_ok:
v_lshlrev_b32 v86, 16, v85
v_and_b32 v87, 0xffff0000, v85
v_and_b32 v85, 0xffff0000, v84
v_lshlrev_b32 v84, 16, v84
v_fma_f32 v84, v84, v67, v21
v_fma_f32 v85, v85, v67, v21
v_fma_f32 v86, v86, v67, v21
v_fma_f32 v87, v87, v67, v21
s_waitcnt vmcnt(0)
L_y_chk:
v_xor_b32 v120, s84, v120
v_xor_b32 v124, s84, v124
v_xor_b32 v128, s84, v128
v_xor_b32 v132, s84, v132
v_or3_b32 v2, v120, v124, v128
v_xor_b32 v136, s84, v136
v_xor_b32 v140, s84, v140
v_or3_b32 v2, v2, v132, v136
v_xor_b32 v144, s84, v144
v_xor_b32 v88, s84, v88
v_or3_b32 v2, v2, v140, v144
v_bitop3_b32 v2, v2, v88, s91 bitop3:0xa8
v_cmp_ne_u32 vcc, 0, v2
s_cbranch_vccnz L_y_rt
L_y_ok:
v_pk_add_f32 v[120:121], v[120:121], v[124:125]
v_pk_add_f32 v[122:123], v[122:123], v[126:127]
v_pk_add_f32 v[128:129], v[128:129], v[132:133]
v_pk_add_f32 v[130:131], v[130:131], v[134:135]
v_pk_add_f32 v[136:137], v[136:137], v[140:141]
v_pk_add_f32 v[138:139], v[138:139], v[142:143]
v_pk_add_f32 v[120:121], v[120:121], v[128:129]
v_pk_add_f32 v[122:123], v[122:123], v[130:131]
v_pk_add_f32 v[136:137], v[136:137], v[144:145]
v_pk_add_f32 v[138:139], v[138:139], v[146:147]
v_pk_add_f32 v[120:121], v[120:121], v[136:137]
v_pk_add_f32 v[122:123], v[122:123], v[138:139]
s_nop 0
v_add_f32_dpp v120, v120, v120 row_ror:8 row_mask:0xf bank_mask:0xf
s_branch L_over2
L_pad2:
s_branch L_pad10
L_over2:
v_add_f32_dpp v121, v121, v121 row_ror:8 row_mask:0xf bank_mask:0xf
v_add_f32_dpp v122, v122, v122 row_ror:8 row_mask:0xf bank_mask:0xf
v_add_f32_dpp v123, v123, v123 row_ror:8 row_mask:0xf bank_mask:0xf
v_mov_b32 v124, v120
v_mov_b32 v125, v121
v_mov_b32 v126, v122
v_mov_b32 v127, v123
v_permlane16_swap_b32 v120, v124
v_permlane16_swap_b32 v121, v125
v_permlane16_swap_b32 v122, v126
v_permlane16_swap_b32 v123, v127
v_add_f32 v120, v120, v124
v_add_f32 v121, v121, v125
v_add_f32 v122, v122, v126
v_add_f32 v123, v123, v127
v_mov_b32 v124, v120
v_mov_b32 v125, v121
v_mov_b32 v126, v122
v_mov_b32 v127, v123
v_permlane32_swap_b32 v120, v124
v_permlane32_swap_b32 v121, v125
v_permlane32_swap_b32 v122, v126
v_permlane32_swap_b32 v123, v127
v_add_f32 v120, v120, v124
v_add_f32 v121, v121, v125
v_add_f32 v122, v122, v126
v_add_f32 v123, v123, v127
v_fmac_f32 v84, v120, v65
v_fmac_f32 v85, v121, v65
v_fmac_f32 v86, v122, v65
v_fmac_f32 v87, v123, v65
v_cvt_pk_bf16_f32 v84, v84, v85
v_cvt_pk_bf16_f32 v85, v86, v87
s_mov_b64 exec, 0xff
buffer_store_dwordx2 v[84:85], v66, s[20:23], 0 offen sc1
L_ldone:
s_endpgm
.p2alignl 12, 0xbf810000
.fill 0, 4, 0xbf810000
L_compute:
v_and_b32 v2, 15, v1
v_lshrrev_b32 v4, 4, v1
v_lshrrev_b32 v3, 1, v2
v_xor_b32 v3, v3, v4
v_lshlrev_b32 v2, 7, v2
s_lshl_b32 s70, s66, 13
v_add_u32 v2, s70, v2
v_xor_b32 v5, 0, v3
v_lshl_add_u32 v8, v5, 4, v2
v_add_u32 v10, 65536, v8
v_xor_b32 v5, 4, v3
v_lshl_add_u32 v9, v5, 4, v2
v_add_u32 v11, 65536, v9
v_lshrrev_b32 v2, 5, v1
v_mul_u32_u24 v2, 6144, v2
v_bfe_u32 v3, v1, 4, 1
v_lshl_add_u32 v2, v3, 10, v2
v_bfe_u32 v4, v1, 2, 2
v_lshl_add_u32 v2, v4, 7, v2
v_lshlrev_b32 v3, 1, v3
v_bfe_u32 v4, v1, 3, 1
v_or_b32 v3, v3, v4
s_lshl_b32 s70, s67, 1
v_xor_b32 v3, s70, v3
v_and_b32 v4, 3, v1
v_lshl_add_u32 v2, v4, 3, v2
v_xor_b32 v4, 0, v3
v_lshl_add_u32 v12, v4, 5, v2
v_add_u32 v14, 65536, v12
v_xor_b32 v4, 1, v3
v_lshl_add_u32 v13, v4, 5, v2
v_add_u32 v15, 65536, v13
s_waitcnt lgkmcnt(0)
s_mov_b32 s12, s58
s_and_b32 s13, s59, 0xffff
s_mov_b32 s14, 268435456
s_mov_b32 s15, 0x20000
s_load_dword s68, s[58:59], 0
s_mov_b32 s20, s56
s_and_b32 s21, s57, 0xffff
s_mov_b32 s22, 4194304
s_mov_b32 s23, 0x20000
s_lshl_b32 s87, s64, 4
s_add_u32 s87, s87, s65
s_mul_i32 s87, s87, 4352
s_add_u32 s87, s87, 524288
s_lshl_b32 s88, s65, 18
s_lshl_b32 s70, s66, 17
s_add_u32 s88, s88, s70
s_lshl_b32 s70, s64, 11
s_add_u32 s88, s88, s70
s_lshl_b32 s70, s67, 10
s_add_u32 s88, s88, s70
s_add_u32 s88, s88, 2097152
s_mov_b32 s70, 0x3f803f80
v_accvgpr_write_b32 a80, s70
v_accvgpr_write_b32 a81, s70
v_accvgpr_write_b32 a82, s70
v_accvgpr_write_b32 a83, s70
s_mov_b32 s80, 0x358637bd
s_mov_b32 s81, 0x358637bd
s_mov_b32 s82, 0x3f800008
s_mov_b32 s83, 0x3f800008
s_mov_b32 s90, 0x3fb8aa3b
s_mov_b32 s91, 0x3fb8aa3b
s_waitcnt lgkmcnt(0)
s_add_u32 s68, s68, 1
v_and_b32 v7, 3, v1
v_lshrrev_b32_e64 v7, v7, s68
v_and_b32 v7, 1, v7
v_mul_u32_u24 v7, 0x10001, v7
s_mov_b32 s76, 0x10001
s_mov_b32 s77, 0x07060302
s_movk_i32 s85, 0xff
v_mov_b32 v28, -1
v_mov_b32 v29, -1
v_mov_b32 v30, -1
v_mov_b32 v31, -1
s_and_b32 s94, s65, 1
s_lshl_b32 s70, s66, 4
s_add_u32 s94, s94, s70
s_barrier
ds_read_b128 a[0:3], v10 offset:57344
ds_read_b64_tr_b16 a[32:33], v12 offset:0
ds_read_b64_tr_b16 a[34:35], v12 offset:512
ds_read_b128 a[4:7], v10 offset:59392
ds_read_b128 a[8:11], v10 offset:61440
ds_read_b128 a[12:15], v10 offset:63488
ds_read_b64_tr_b16 a[36:37], v13 offset:0
ds_read_b64_tr_b16 a[38:39], v13 offset:512
ds_read_b64_tr_b16 a[40:41], v12 offset:2048
ds_read_b64_tr_b16 a[42:43], v12 offset:2560
ds_read_b64_tr_b16 a[44:45], v13 offset:2048
ds_read_b64_tr_b16 a[46:47], v13 offset:2560
ds_read_b64_tr_b16 a[48:49], v12 offset:4096
ds_read_b64_tr_b16 a[50:51], v12 offset:4608
ds_read_b64_tr_b16 a[52:53], v13 offset:4096
ds_read_b64_tr_b16 a[54:55], v13 offset:4608
s_waitcnt lgkmcnt(0)
s_cmp_lg_u32 s94, 0
s_cbranch_scc1 L_nocs0_0
v_mfma_f32_16x16x32_bf16 v[128:131], a[80:83], a[32:35], 0
v_mfma_f32_16x16x32_bf16 v[132:135], a[80:83], a[36:39], 0
v_mfma_f32_16x16x32_bf16 v[136:139], a[80:83], a[40:43], 0
v_mfma_f32_16x16x32_bf16 v[140:143], a[80:83], a[44:47], 0
v_mfma_f32_16x16x32_bf16 v[144:147], a[80:83], a[48:51], 0
v_mfma_f32_16x16x32_bf16 v[148:151], a[80:83], a[52:55], 0
L_nocs0_0:
v_mfma_f32_16x16x32_bf16 v[32:35], a[32:35], a[0:3], 0
ds_read_b128 a[16:19], v11 offset:57344
v_mfma_f32_16x16x32_bf16 v[56:59], a[32:35], a[4:7], 0
ds_read_b64_tr_b16 a[56:57], v12 offset:12288
v_mfma_f32_16x16x32_bf16 v[80:83], a[32:35], a[8:11], 0
ds_read_b64_tr_b16 a[58:59], v12 offset:12800
v_mfma_f32_16x16x32_bf16 v[104:107], a[32:35], a[12:15], 0
ds_read_b128 a[20:23], v11 offset:59392
v_mfma_f32_16x16x32_bf16 v[36:39], a[36:39], a[0:3], 0
ds_read_b128 a[24:27], v11 offset:61440
v_mfma_f32_16x16x32_bf16 v[60:63], a[36:39], a[4:7], 0
ds_read_b128 a[28:31], v11 offset:63488
v_mfma_f32_16x16x32_bf16 v[84:87], a[36:39], a[8:11], 0
ds_read_b64_tr_b16 a[60:61], v13 offset:12288
v_mfma_f32_16x16x32_bf16 v[108:111], a[36:39], a[12:15], 0
ds_read_b64_tr_b16 a[62:63], v13 offset:12800
v_mfma_f32_16x16x32_bf16 v[40:43], a[0:3], a[40:43], 0
ds_read_b64_tr_b16 a[64:65], v12 offset:14336
v_mfma_f32_16x16x32_bf16 v[64:67], a[4:7], a[40:43], 0
ds_read_b64_tr_b16 a[66:67], v12 offset:14848
v_mfma_f32_16x16x32_bf16 v[88:91], a[8:11], a[40:43], 0
ds_read_b64_tr_b16 a[68:69], v13 offset:14336
v_mfma_f32_16x16x32_bf16 v[112:115], a[12:15], a[40:43], 0
ds_read_b64_tr_b16 a[70:71], v13 offset:14848
v_mfma_f32_16x16x32_bf16 v[44:47], a[0:3], a[44:47], 0
ds_read_b64_tr_b16 a[72:73], v12 offset:16384
v_mfma_f32_16x16x32_bf16 v[68:71], a[4:7], a[44:47], 0
ds_read_b64_tr_b16 a[74:75], v12 offset:16896
v_mfma_f32_16x16x32_bf16 v[92:95], a[8:11], a[44:47], 0
ds_read_b64_tr_b16 a[76:77], v13 offset:16384
v_mfma_f32_16x16x32_bf16 v[116:119], a[12:15], a[44:47], 0
ds_read_b64_tr_b16 a[78:79], v13 offset:16896
v_mfma_f32_16x16x32_bf16 v[48:51], a[0:3], a[48:51], 0
v_mfma_f32_16x16x32_bf16 v[72:75], a[4:7], a[48:51], 0
v_mfma_f32_16x16x32_bf16 v[96:99], a[8:11], a[48:51], 0
v_mfma_f32_16x16x32_bf16 v[120:123], a[12:15], a[48:51], 0
v_mfma_f32_16x16x32_bf16 v[52:55], a[0:3], a[52:55], 0
v_mfma_f32_16x16x32_bf16 v[76:79], a[4:7], a[52:55], 0
v_mfma_f32_16x16x32_bf16 v[100:103], a[8:11], a[52:55], 0
v_mfma_f32_16x16x32_bf16 v[124:127], a[12:15], a[52:55], 0
s_waitcnt lgkmcnt(0)
s_cmp_lg_u32 s94, 0
s_cbranch_scc1 L_nocs0_1
v_mfma_f32_16x16x32_bf16 v[128:131], a[80:83], a[56:59], v[128:131]
v_mfma_f32_16x16x32_bf16 v[132:135], a[80:83], a[60:63], v[132:135]
v_mfma_f32_16x16x32_bf16 v[136:139], a[80:83], a[64:67], v[136:139]
v_mfma_f32_16x16x32_bf16 v[140:143], a[80:83], a[68:71], v[140:143]
v_mfma_f32_16x16x32_bf16 v[144:147], a[80:83], a[72:75], v[144:147]
v_mfma_f32_16x16x32_bf16 v[148:151], a[80:83], a[76:79], v[148:151]
L_nocs0_1:
v_mfma_f32_16x16x32_bf16 v[32:35], a[56:59], a[16:19], v[32:35]
s_barrier
ds_read_b128 a[0:3], v10 offset:40960
v_mfma_f32_16x16x32_bf16 v[56:59], a[56:59], a[20:23], v[56:59]
ds_read_b64_tr_b16 a[32:33], v14 offset:16384
v_mfma_f32_16x16x32_bf16 v[80:83], a[56:59], a[24:27], v[80:83]
ds_read_b64_tr_b16 a[34:35], v14 offset:16896
v_mfma_f32_16x16x32_bf16 v[104:107], a[56:59], a[28:31], v[104:107]
ds_read_b128 a[4:7], v10 offset:43008
v_mfma_f32_16x16x32_bf16 v[36:39], a[60:63], a[16:19], v[36:39]
ds_read_b128 a[8:11], v10 offset:45056
v_mfma_f32_16x16x32_bf16 v[60:63], a[60:63], a[20:23], v[60:63]
ds_read_b128 a[12:15], v10 offset:47104
v_mfma_f32_16x16x32_bf16 v[84:87], a[60:63], a[24:27], v[84:87]
ds_read_b64_tr_b16 a[36:37], v15 offset:16384
v_mfma_f32_16x16x32_bf16 v[108:111], a[60:63], a[28:31], v[108:111]
ds_read_b64_tr_b16 a[38:39], v15 offset:16896
v_mfma_f32_16x16x32_bf16 v[40:43], a[16:19], a[64:67], v[40:43]
ds_read_b64_tr_b16 a[40:41], v14 offset:18432
v_mfma_f32_16x16x32_bf16 v[64:67], a[20:23], a[64:67], v[64:67]
ds_read_b64_tr_b16 a[42:43], v14 offset:18944
v_mfma_f32_16x16x32_bf16 v[88:91], a[24:27], a[64:67], v[88:91]
ds_read_b64_tr_b16 a[44:45], v15 offset:18432
v_mfma_f32_16x16x32_bf16 v[112:115], a[28:31], a[64:67], v[112:115]
ds_read_b64_tr_b16 a[46:47], v15 offset:18944
v_mfma_f32_16x16x32_bf16 v[44:47], a[16:19], a[68:71], v[44:47]
ds_read_b64_tr_b16 a[48:49], v14 offset:20480
v_mfma_f32_16x16x32_bf16 v[68:71], a[20:23], a[68:71], v[68:71]
ds_read_b64_tr_b16 a[50:51], v14 offset:20992
v_mfma_f32_16x16x32_bf16 v[92:95], a[24:27], a[68:71], v[92:95]
ds_read_b64_tr_b16 a[52:53], v15 offset:20480
v_mfma_f32_16x16x32_bf16 v[116:119], a[28:31], a[68:71], v[116:119]
ds_read_b64_tr_b16 a[54:55], v15 offset:20992
v_mfma_f32_16x16x32_bf16 v[48:51], a[16:19], a[72:75], v[48:51]
v_mfma_f32_16x16x32_bf16 v[72:75], a[20:23], a[72:75], v[72:75]
v_mfma_f32_16x16x32_bf16 v[96:99], a[24:27], a[72:75], v[96:99]
v_mfma_f32_16x16x32_bf16 v[120:123], a[28:31], a[72:75], v[120:123]
v_mfma_f32_16x16x32_bf16 v[52:55], a[16:19], a[76:79], v[52:55]
v_mfma_f32_16x16x32_bf16 v[76:79], a[20:23], a[76:79], v[76:79]
v_mfma_f32_16x16x32_bf16 v[100:103], a[24:27], a[76:79], v[100:103]
v_mfma_f32_16x16x32_bf16 v[124:127], a[28:31], a[76:79], v[124:127]
s_waitcnt lgkmcnt(0)
s_cmp_lg_u32 s94, 1
s_cbranch_scc1 L_nocs1_0
v_mfma_f32_16x16x32_bf16 v[128:131], a[80:83], a[32:35], 0
v_mfma_f32_16x16x32_bf16 v[132:135], a[80:83], a[36:39], 0
v_mfma_f32_16x16x32_bf16 v[136:139], a[80:83], a[40:43], 0
v_mfma_f32_16x16x32_bf16 v[140:143], a[80:83], a[44:47], 0
v_mfma_f32_16x16x32_bf16 v[144:147], a[80:83], a[48:51], 0
v_mfma_f32_16x16x32_bf16 v[148:151], a[80:83], a[52:55], 0
L_nocs1_0:
v_mfma_f32_16x16x32_bf16 v[32:35], a[32:35], a[0:3], v[32:35]
ds_read_b128 a[16:19], v11 offset:40960
v_mfma_f32_16x16x32_bf16 v[56:59], a[32:35], a[4:7], v[56:59]
ds_read_b64_tr_b16 a[56:57], v14 offset:28672
v_mfma_f32_16x16x32_bf16 v[80:83], a[32:35], a[8:11], v[80:83]
ds_read_b64_tr_b16 a[58:59], v14 offset:29184
v_mfma_f32_16x16x32_bf16 v[104:107], a[32:35], a[12:15], v[104:107]
ds_read_b128 a[20:23], v11 offset:43008
v_mfma_f32_16x16x32_bf16 v[36:39], a[36:39], a[0:3], v[36:39]
ds_read_b128 a[24:27], v11 offset:45056
v_mfma_f32_16x16x32_bf16 v[60:63], a[36:39], a[4:7], v[60:63]
ds_read_b128 a[28:31], v11 offset:47104
v_mfma_f32_16x16x32_bf16 v[84:87], a[36:39], a[8:11], v[84:87]
ds_read_b64_tr_b16 a[60:61], v15 offset:28672
v_mfma_f32_16x16x32_bf16 v[108:111], a[36:39], a[12:15], v[108:111]
ds_read_b64_tr_b16 a[62:63], v15 offset:29184
v_mfma_f32_16x16x32_bf16 v[40:43], a[0:3], a[40:43], v[40:43]
ds_read_b64_tr_b16 a[64:65], v14 offset:30720
v_mfma_f32_16x16x32_bf16 v[64:67], a[4:7], a[40:43], v[64:67]
ds_read_b64_tr_b16 a[66:67], v14 offset:31232
v_mfma_f32_16x16x32_bf16 v[88:91], a[8:11], a[40:43], v[88:91]
ds_read_b64_tr_b16 a[68:69], v15 offset:30720
v_mfma_f32_16x16x32_bf16 v[112:115], a[12:15], a[40:43], v[112:115]
ds_read_b64_tr_b16 a[70:71], v15 offset:31232
v_mfma_f32_16x16x32_bf16 v[44:47], a[0:3], a[44:47], v[44:47]
ds_read_b64_tr_b16 a[72:73], v14 offset:32768
v_mfma_f32_16x16x32_bf16 v[68:71], a[4:7], a[44:47], v[68:71]
ds_read_b64_tr_b16 a[74:75], v14 offset:33280
v_mfma_f32_16x16x32_bf16 v[92:95], a[8:11], a[44:47], v[92:95]
ds_read_b64_tr_b16 a[76:77], v15 offset:32768
v_mfma_f32_16x16x32_bf16 v[116:119], a[12:15], a[44:47], v[116:119]
ds_read_b64_tr_b16 a[78:79], v15 offset:33280
v_mfma_f32_16x16x32_bf16 v[48:51], a[0:3], a[48:51], v[48:51]
v_mfma_f32_16x16x32_bf16 v[72:75], a[4:7], a[48:51], v[72:75]
v_mfma_f32_16x16x32_bf16 v[96:99], a[8:11], a[48:51], v[96:99]
v_mfma_f32_16x16x32_bf16 v[120:123], a[12:15], a[48:51], v[120:123]
v_mfma_f32_16x16x32_bf16 v[52:55], a[0:3], a[52:55], v[52:55]
v_mfma_f32_16x16x32_bf16 v[76:79], a[4:7], a[52:55], v[76:79]
v_mfma_f32_16x16x32_bf16 v[100:103], a[8:11], a[52:55], v[100:103]
v_mfma_f32_16x16x32_bf16 v[124:127], a[12:15], a[52:55], v[124:127]
s_waitcnt lgkmcnt(0)
s_cmp_lg_u32 s94, 1
s_cbranch_scc1 L_nocs1_1
v_mfma_f32_16x16x32_bf16 v[128:131], a[80:83], a[56:59], v[128:131]
v_mfma_f32_16x16x32_bf16 v[132:135], a[80:83], a[60:63], v[132:135]
v_mfma_f32_16x16x32_bf16 v[136:139], a[80:83], a[64:67], v[136:139]
v_mfma_f32_16x16x32_bf16 v[140:143], a[80:83], a[68:71], v[140:143]
v_mfma_f32_16x16x32_bf16 v[144:147], a[80:83], a[72:75], v[144:147]
v_mfma_f32_16x16x32_bf16 v[148:151], a[80:83], a[76:79], v[148:151]
L_nocs1_1:
v_mfma_f32_16x16x32_bf16 v[32:35], a[56:59], a[16:19], v[32:35]
s_barrier
ds_read_b128 a[0:3], v10 offset:0
v_mfma_f32_16x16x32_bf16 v[56:59], a[56:59], a[20:23], v[56:59]
ds_read_b64_tr_b16 a[32:33], v12 offset:40960
v_mfma_f32_16x16x32_bf16 v[80:83], a[56:59], a[24:27], v[80:83]
ds_read_b64_tr_b16 a[34:35], v12 offset:41472
v_mfma_f32_16x16x32_bf16 v[104:107], a[56:59], a[28:31], v[104:107]
ds_read_b128 a[4:7], v10 offset:2048
v_mfma_f32_16x16x32_bf16 v[36:39], a[60:63], a[16:19], v[36:39]
ds_read_b128 a[8:11], v10 offset:4096
v_mfma_f32_16x16x32_bf16 v[60:63], a[60:63], a[20:23], v[60:63]
ds_read_b128 a[12:15], v10 offset:6144
v_mfma_f32_16x16x32_bf16 v[84:87], a[60:63], a[24:27], v[84:87]
ds_read_b64_tr_b16 a[36:37], v13 offset:40960
v_mfma_f32_16x16x32_bf16 v[108:111], a[60:63], a[28:31], v[108:111]
ds_read_b64_tr_b16 a[38:39], v13 offset:41472
v_mfma_f32_16x16x32_bf16 v[40:43], a[16:19], a[64:67], v[40:43]
ds_read_b64_tr_b16 a[40:41], v12 offset:43008
v_mfma_f32_16x16x32_bf16 v[64:67], a[20:23], a[64:67], v[64:67]
ds_read_b64_tr_b16 a[42:43], v12 offset:43520
v_mfma_f32_16x16x32_bf16 v[88:91], a[24:27], a[64:67], v[88:91]
ds_read_b64_tr_b16 a[44:45], v13 offset:43008
v_mfma_f32_16x16x32_bf16 v[112:115], a[28:31], a[64:67], v[112:115]
ds_read_b64_tr_b16 a[46:47], v13 offset:43520
v_mfma_f32_16x16x32_bf16 v[44:47], a[16:19], a[68:71], v[44:47]
ds_read_b64_tr_b16 a[48:49], v12 offset:45056
v_mfma_f32_16x16x32_bf16 v[68:71], a[20:23], a[68:71], v[68:71]
ds_read_b64_tr_b16 a[50:51], v12 offset:45568
v_mfma_f32_16x16x32_bf16 v[92:95], a[24:27], a[68:71], v[92:95]
ds_read_b64_tr_b16 a[52:53], v13 offset:45056
v_mfma_f32_16x16x32_bf16 v[116:119], a[28:31], a[68:71], v[116:119]
ds_read_b64_tr_b16 a[54:55], v13 offset:45568
v_mfma_f32_16x16x32_bf16 v[48:51], a[16:19], a[72:75], v[48:51]
v_mfma_f32_16x16x32_bf16 v[72:75], a[20:23], a[72:75], v[72:75]
v_mfma_f32_16x16x32_bf16 v[96:99], a[24:27], a[72:75], v[96:99]
v_mfma_f32_16x16x32_bf16 v[120:123], a[28:31], a[72:75], v[120:123]
v_mfma_f32_16x16x32_bf16 v[52:55], a[16:19], a[76:79], v[52:55]
v_mfma_f32_16x16x32_bf16 v[76:79], a[20:23], a[76:79], v[76:79]
v_mfma_f32_16x16x32_bf16 v[100:103], a[24:27], a[76:79], v[100:103]
v_mfma_f32_16x16x32_bf16 v[124:127], a[28:31], a[76:79], v[124:127]
s_waitcnt lgkmcnt(0)
v_mfma_f32_16x16x32_bf16 v[32:35], a[32:35], a[0:3], v[32:35]
ds_read_b128 a[16:19], v11 offset:0
v_mfma_f32_16x16x32_bf16 v[56:59], a[32:35], a[4:7], v[56:59]
ds_read_b64_tr_b16 a[56:57], v12 offset:53248
v_mfma_f32_16x16x32_bf16 v[80:83], a[32:35], a[8:11], v[80:83]
ds_read_b64_tr_b16 a[58:59], v12 offset:53760
v_mfma_f32_16x16x32_bf16 v[104:107], a[32:35], a[12:15], v[104:107]
ds_read_b128 a[20:23], v11 offset:2048
v_mfma_f32_16x16x32_bf16 v[36:39], a[36:39], a[0:3], v[36:39]
ds_read_b128 a[24:27], v11 offset:4096
v_mfma_f32_16x16x32_bf16 v[60:63], a[36:39], a[4:7], v[60:63]
ds_read_b128 a[28:31], v11 offset:6144
v_mfma_f32_16x16x32_bf16 v[84:87], a[36:39], a[8:11], v[84:87]
ds_read_b64_tr_b16 a[60:61], v13 offset:53248
v_mfma_f32_16x16x32_bf16 v[108:111], a[36:39], a[12:15], v[108:111]
ds_read_b64_tr_b16 a[62:63], v13 offset:53760
v_mfma_f32_16x16x32_bf16 v[40:43], a[0:3], a[40:43], v[40:43]
ds_read_b64_tr_b16 a[64:65], v12 offset:55296
v_mfma_f32_16x16x32_bf16 v[64:67], a[4:7], a[40:43], v[64:67]
ds_read_b64_tr_b16 a[66:67], v12 offset:55808
v_mfma_f32_16x16x32_bf16 v[88:91], a[8:11], a[40:43], v[88:91]
ds_read_b64_tr_b16 a[68:69], v13 offset:55296
v_mfma_f32_16x16x32_bf16 v[112:115], a[12:15], a[40:43], v[112:115]
ds_read_b64_tr_b16 a[70:71], v13 offset:55808
v_mfma_f32_16x16x32_bf16 v[44:47], a[0:3], a[44:47], v[44:47]
ds_read_b64_tr_b16 a[72:73], v12 offset:57344
v_mfma_f32_16x16x32_bf16 v[68:71], a[4:7], a[44:47], v[68:71]
ds_read_b64_tr_b16 a[74:75], v12 offset:57856
v_mfma_f32_16x16x32_bf16 v[92:95], a[8:11], a[44:47], v[92:95]
ds_read_b64_tr_b16 a[76:77], v13 offset:57344
v_mfma_f32_16x16x32_bf16 v[116:119], a[12:15], a[44:47], v[116:119]
ds_read_b64_tr_b16 a[78:79], v13 offset:57856
v_mfma_f32_16x16x32_bf16 v[48:51], a[0:3], a[48:51], v[48:51]
s_lshl_b32 s70, s60, 10
s_add_u32 s70, s70, s87
buffer_store_dwordx4 v[28:31], v16, s[12:15], s70 offen sc1
v_mfma_f32_16x16x32_bf16 v[72:75], a[4:7], a[48:51], v[72:75]
v_mfma_f32_16x16x32_bf16 v[96:99], a[8:11], a[48:51], v[96:99]
v_mfma_f32_16x16x32_bf16 v[120:123], a[12:15], a[48:51], v[120:123]
v_mfma_f32_16x16x32_bf16 v[52:55], a[0:3], a[52:55], v[52:55]
v_mfma_f32_16x16x32_bf16 v[76:79], a[4:7], a[52:55], v[76:79]
v_mfma_f32_16x16x32_bf16 v[100:103], a[8:11], a[52:55], v[100:103]
v_mfma_f32_16x16x32_bf16 v[124:127], a[12:15], a[52:55], v[124:127]
s_waitcnt lgkmcnt(0)
v_mfma_f32_16x16x32_bf16 v[32:35], a[56:59], a[16:19], v[32:35]
s_barrier
ds_read_b128 a[0:3], v8 offset:24576
v_mfma_f32_16x16x32_bf16 v[56:59], a[56:59], a[20:23], v[56:59]
ds_read_b64_tr_b16 a[32:33], v12 offset:0
v_mfma_f32_16x16x32_bf16 v[80:83], a[56:59], a[24:27], v[80:83]
ds_read_b64_tr_b16 a[34:35], v12 offset:512
v_mfma_f32_16x16x32_bf16 v[104:107], a[56:59], a[28:31], v[104:107]
ds_read_b128 a[4:7], v8 offset:26624
v_mfma_f32_16x16x32_bf16 v[36:39], a[60:63], a[16:19], v[36:39]
ds_read_b128 a[8:11], v8 offset:28672
v_mfma_f32_16x16x32_bf16 v[60:63], a[60:63], a[20:23], v[60:63]
ds_read_b128 a[12:15], v8 offset:30720
v_mfma_f32_16x16x32_bf16 v[84:87], a[60:63], a[24:27], v[84:87]
ds_read_b64_tr_b16 a[36:37], v13 offset:0
v_mfma_f32_16x16x32_bf16 v[108:111], a[60:63], a[28:31], v[108:111]
ds_read_b64_tr_b16 a[38:39], v13 offset:512
v_mfma_f32_16x16x32_bf16 v[40:43], a[16:19], a[64:67], v[40:43]
ds_read_b64_tr_b16 a[40:41], v12 offset:2048
v_mfma_f32_16x16x32_bf16 v[64:67], a[20:23], a[64:67], v[64:67]
ds_read_b64_tr_b16 a[42:43], v12 offset:2560
v_mfma_f32_16x16x32_bf16 v[88:91], a[24:27], a[64:67], v[88:91]
ds_read_b64_tr_b16 a[44:45], v13 offset:2048
v_mfma_f32_16x16x32_bf16 v[112:115], a[28:31], a[64:67], v[112:115]
ds_read_b64_tr_b16 a[46:47], v13 offset:2560
v_mfma_f32_16x16x32_bf16 v[44:47], a[16:19], a[68:71], v[44:47]
ds_read_b64_tr_b16 a[48:49], v12 offset:4096
v_mfma_f32_16x16x32_bf16 v[68:71], a[20:23], a[68:71], v[68:71]
ds_read_b64_tr_b16 a[50:51], v12 offset:4608
v_mfma_f32_16x16x32_bf16 v[92:95], a[24:27], a[68:71], v[92:95]
ds_read_b64_tr_b16 a[52:53], v13 offset:4096
v_mfma_f32_16x16x32_bf16 v[116:119], a[28:31], a[68:71], v[116:119]
ds_read_b64_tr_b16 a[54:55], v13 offset:4608
v_mfma_f32_16x16x32_bf16 v[48:51], a[16:19], a[72:75], v[48:51]
v_mfma_f32_16x16x32_bf16 v[72:75], a[20:23], a[72:75], v[72:75]
v_mfma_f32_16x16x32_bf16 v[96:99], a[24:27], a[72:75], v[96:99]
v_mfma_f32_16x16x32_bf16 v[120:123], a[28:31], a[72:75], v[120:123]
v_mfma_f32_16x16x32_bf16 v[52:55], a[16:19], a[76:79], v[52:55]
v_mfma_f32_16x16x32_bf16 v[76:79], a[20:23], a[76:79], v[76:79]
v_mfma_f32_16x16x32_bf16 v[100:103], a[24:27], a[76:79], v[100:103]
v_mfma_f32_16x16x32_bf16 v[124:127], a[28:31], a[76:79], v[124:127]
s_waitcnt lgkmcnt(0)
v_mfma_f32_16x16x32_bf16 v[32:35], a[32:35], a[0:3], v[32:35]
ds_read_b128 a[16:19], v9 offset:24576
v_mfma_f32_16x16x32_bf16 v[56:59], a[32:35], a[4:7], v[56:59]
ds_read_b64_tr_b16 a[56:57], v12 offset:12288
v_mfma_f32_16x16x32_bf16 v[80:83], a[32:35], a[8:11], v[80:83]
ds_read_b64_tr_b16 a[58:59], v12 offset:12800
v_mfma_f32_16x16x32_bf16 v[104:107], a[32:35], a[12:15], v[104:107]
ds_read_b128 a[20:23], v9 offset:26624
v_mfma_f32_16x16x32_bf16 v[36:39], a[36:39], a[0:3], v[36:39]
ds_read_b128 a[24:27], v9 offset:28672
v_mfma_f32_16x16x32_bf16 v[60:63], a[36:39], a[4:7], v[60:63]
ds_read_b128 a[28:31], v9 offset:30720
v_mfma_f32_16x16x32_bf16 v[84:87], a[36:39], a[8:11], v[84:87]
ds_read_b64_tr_b16 a[60:61], v13 offset:12288
v_mfma_f32_16x16x32_bf16 v[108:111], a[36:39], a[12:15], v[108:111]
ds_read_b64_tr_b16 a[62:63], v13 offset:12800
v_mfma_f32_16x16x32_bf16 v[40:43], a[0:3], a[40:43], v[40:43]
ds_read_b64_tr_b16 a[64:65], v12 offset:14336
v_mfma_f32_16x16x32_bf16 v[64:67], a[4:7], a[40:43], v[64:67]
ds_read_b64_tr_b16 a[66:67], v12 offset:14848
v_mfma_f32_16x16x32_bf16 v[88:91], a[8:11], a[40:43], v[88:91]
ds_read_b64_tr_b16 a[68:69], v13 offset:14336
v_mfma_f32_16x16x32_bf16 v[112:115], a[12:15], a[40:43], v[112:115]
ds_read_b64_tr_b16 a[70:71], v13 offset:14848
v_mfma_f32_16x16x32_bf16 v[44:47], a[0:3], a[44:47], v[44:47]
ds_read_b64_tr_b16 a[72:73], v12 offset:16384
v_mfma_f32_16x16x32_bf16 v[68:71], a[4:7], a[44:47], v[68:71]
ds_read_b64_tr_b16 a[74:75], v12 offset:16896
v_mfma_f32_16x16x32_bf16 v[92:95], a[8:11], a[44:47], v[92:95]
ds_read_b64_tr_b16 a[76:77], v13 offset:16384
v_mfma_f32_16x16x32_bf16 v[116:119], a[12:15], a[44:47], v[116:119]
ds_read_b64_tr_b16 a[78:79], v13 offset:16896
v_mfma_f32_16x16x32_bf16 v[48:51], a[0:3], a[48:51], v[48:51]
s_cmp_lg_u32 s66, 0
s_cbranch_scc1 L_nocsp
v_and_b32 v2, 16, v1
v_cmp_ne_u32 vcc, 0, v2
s_nop 1
v_cndmask_b32 v24, v128, v132, vcc
v_cndmask_b32 v25, v136, v140, vcc
v_cndmask_b32 v26, v144, v148, vcc
v_mov_b32 v27, s68
s_lshl_b32 s70, s64, 4
s_add_u32 s70, s70, s65
s_lshl_b32 s70, s70, 10
s_lshl_b32 s71, s67, 9
s_add_u32 s70, s70, s71
s_add_u32 s70, s70, 65536
s_mov_b64 exec, 0xffffffff
buffer_store_dwordx4 v[24:27], v16, s[12:15], s70 offen sc1
s_mov_b64 exec, -1
L_nocsp:
v_mfma_f32_16x16x32_bf16 v[72:75], a[4:7], a[48:51], v[72:75]
v_mfma_f32_16x16x32_bf16 v[96:99], a[8:11], a[48:51], v[96:99]
v_mfma_f32_16x16x32_bf16 v[120:123], a[12:15], a[48:51], v[120:123]
v_mfma_f32_16x16x32_bf16 v[52:55], a[0:3], a[52:55], v[52:55]
v_mfma_f32_16x16x32_bf16 v[76:79], a[4:7], a[52:55], v[76:79]
v_mfma_f32_16x16x32_bf16 v[100:103], a[8:11], a[52:55], v[100:103]
v_mfma_f32_16x16x32_bf16 v[124:127], a[12:15], a[52:55], v[124:127]
s_waitcnt lgkmcnt(0)
v_mfma_f32_16x16x32_bf16 v[32:35], a[56:59], a[16:19], v[32:35]
s_barrier
ds_read_b128 a[0:3], v10 offset:57344
v_mfma_f32_16x16x32_bf16 v[56:59], a[56:59], a[20:23], v[56:59]
ds_read_b64_tr_b16 a[32:33], v14 offset:16384
v_mfma_f32_16x16x32_bf16 v[80:83], a[56:59], a[24:27], v[80:83]
ds_read_b64_tr_b16 a[34:35], v14 offset:16896
v_mfma_f32_16x16x32_bf16 v[104:107], a[56:59], a[28:31], v[104:107]
ds_read_b128 a[4:7], v10 offset:59392
v_mfma_f32_16x16x32_bf16 v[36:39], a[60:63], a[16:19], v[36:39]
ds_read_b128 a[8:11], v10 offset:61440
v_mfma_f32_16x16x32_bf16 v[60:63], a[60:63], a[20:23], v[60:63]
ds_read_b128 a[12:15], v10 offset:63488
v_mfma_f32_16x16x32_bf16 v[84:87], a[60:63], a[24:27], v[84:87]
ds_read_b64_tr_b16 a[36:37], v15 offset:16384
v_mfma_f32_16x16x32_bf16 v[108:111], a[60:63], a[28:31], v[108:111]
ds_read_b64_tr_b16 a[38:39], v15 offset:16896
v_mfma_f32_16x16x32_bf16 v[40:43], a[16:19], a[64:67], v[40:43]
ds_read_b64_tr_b16 a[40:41], v14 offset:18432
v_mfma_f32_16x16x32_bf16 v[64:67], a[20:23], a[64:67], v[64:67]
ds_read_b64_tr_b16 a[42:43], v14 offset:18944
v_mfma_f32_16x16x32_bf16 v[88:91], a[24:27], a[64:67], v[88:91]
ds_read_b64_tr_b16 a[44:45], v15 offset:18432
v_mfma_f32_16x16x32_bf16 v[112:115], a[28:31], a[64:67], v[112:115]
ds_read_b64_tr_b16 a[46:47], v15 offset:18944
v_mfma_f32_16x16x32_bf16 v[44:47], a[16:19], a[68:71], v[44:47]
ds_read_b64_tr_b16 a[48:49], v14 offset:20480
v_mfma_f32_16x16x32_bf16 v[68:71], a[20:23], a[68:71], v[68:71]
ds_read_b64_tr_b16 a[50:51], v14 offset:20992
v_mfma_f32_16x16x32_bf16 v[92:95], a[24:27], a[68:71], v[92:95]
ds_read_b64_tr_b16 a[52:53], v15 offset:20480
v_mfma_f32_16x16x32_bf16 v[116:119], a[28:31], a[68:71], v[116:119]
ds_read_b64_tr_b16 a[54:55], v15 offset:20992
v_mfma_f32_16x16x32_bf16 v[48:51], a[16:19], a[72:75], v[48:51]
v_mfma_f32_16x16x32_bf16 v[72:75], a[20:23], a[72:75], v[72:75]
v_mfma_f32_16x16x32_bf16 v[96:99], a[24:27], a[72:75], v[96:99]
v_mfma_f32_16x16x32_bf16 v[120:123], a[28:31], a[72:75], v[120:123]
v_mfma_f32_16x16x32_bf16 v[52:55], a[16:19], a[76:79], v[52:55]
v_mfma_f32_16x16x32_bf16 v[76:79], a[20:23], a[76:79], v[76:79]
v_mfma_f32_16x16x32_bf16 v[100:103], a[24:27], a[76:79], v[100:103]
v_mfma_f32_16x16x32_bf16 v[124:127], a[28:31], a[76:79], v[124:127]
s_waitcnt lgkmcnt(0)
v_mfma_f32_16x16x32_bf16 v[32:35], a[32:35], a[0:3], v[32:35]
ds_read_b128 a[16:19], v11 offset:57344
v_mfma_f32_16x16x32_bf16 v[56:59], a[32:35], a[4:7], v[56:59]
ds_read_b64_tr_b16 a[56:57], v14 offset:28672
v_mfma_f32_16x16x32_bf16 v[80:83], a[32:35], a[8:11], v[80:83]
ds_read_b64_tr_b16 a[58:59], v14 offset:29184
v_mfma_f32_16x16x32_bf16 v[104:107], a[32:35], a[12:15], v[104:107]
ds_read_b128 a[20:23], v11 offset:59392
v_mfma_f32_16x16x32_bf16 v[36:39], a[36:39], a[0:3], v[36:39]
ds_read_b128 a[24:27], v11 offset:61440
v_mfma_f32_16x16x32_bf16 v[60:63], a[36:39], a[4:7], v[60:63]
ds_read_b128 a[28:31], v11 offset:63488
v_mfma_f32_16x16x32_bf16 v[84:87], a[36:39], a[8:11], v[84:87]
ds_read_b64_tr_b16 a[60:61], v15 offset:28672
v_mfma_f32_16x16x32_bf16 v[108:111], a[36:39], a[12:15], v[108:111]
ds_read_b64_tr_b16 a[62:63], v15 offset:29184
v_mfma_f32_16x16x32_bf16 v[40:43], a[0:3], a[40:43], v[40:43]
ds_read_b64_tr_b16 a[64:65], v14 offset:30720
v_mfma_f32_16x16x32_bf16 v[64:67], a[4:7], a[40:43], v[64:67]
ds_read_b64_tr_b16 a[66:67], v14 offset:31232
v_mfma_f32_16x16x32_bf16 v[88:91], a[8:11], a[40:43], v[88:91]
ds_read_b64_tr_b16 a[68:69], v15 offset:30720
v_mfma_f32_16x16x32_bf16 v[112:115], a[12:15], a[40:43], v[112:115]
ds_read_b64_tr_b16 a[70:71], v15 offset:31232
v_mfma_f32_16x16x32_bf16 v[44:47], a[0:3], a[44:47], v[44:47]
ds_read_b64_tr_b16 a[72:73], v14 offset:32768
v_mfma_f32_16x16x32_bf16 v[68:71], a[4:7], a[44:47], v[68:71]
ds_read_b64_tr_b16 a[74:75], v14 offset:33280
v_mfma_f32_16x16x32_bf16 v[92:95], a[8:11], a[44:47], v[92:95]
ds_read_b64_tr_b16 a[76:77], v15 offset:32768
v_mfma_f32_16x16x32_bf16 v[116:119], a[12:15], a[44:47], v[116:119]
ds_read_b64_tr_b16 a[78:79], v15 offset:33280
v_mfma_f32_16x16x32_bf16 v[48:51], a[0:3], a[48:51], v[48:51]
s_add_u32 s70, s88, 0
buffer_store_dwordx4 v[28:31], v16, s[12:15], s70 offen sc1
v_mfma_f32_16x16x32_bf16 v[72:75], a[4:7], a[48:51], v[72:75]
v_mfma_f32_16x16x32_bf16 v[96:99], a[8:11], a[48:51], v[96:99]
s_add_u32 s70, s88, 32768
buffer_store_dwordx4 v[28:31], v16, s[12:15], s70 offen sc1
v_mfma_f32_16x16x32_bf16 v[120:123], a[12:15], a[48:51], v[120:123]
v_mfma_f32_16x16x32_bf16 v[52:55], a[0:3], a[52:55], v[52:55]
v_mfma_f32_16x16x32_bf16 v[76:79], a[4:7], a[52:55], v[76:79]
v_mfma_f32_16x16x32_bf16 v[100:103], a[8:11], a[52:55], v[100:103]
v_mfma_f32_16x16x32_bf16 v[124:127], a[12:15], a[52:55], v[124:127]
s_waitcnt lgkmcnt(0)
v_mfma_f32_16x16x32_bf16 v[32:35], a[56:59], a[16:19], v[32:35]
s_barrier
ds_read_b128 a[0:3], v10 offset:40960
v_mfma_f32_16x16x32_bf16 v[56:59], a[56:59], a[20:23], v[56:59]
ds_read_b64_tr_b16 a[32:33], v12 offset:40960
v_mfma_f32_16x16x32_bf16 v[80:83], a[56:59], a[24:27], v[80:83]
ds_read_b64_tr_b16 a[34:35], v12 offset:41472
v_mfma_f32_16x16x32_bf16 v[104:107], a[56:59], a[28:31], v[104:107]
ds_read_b128 a[4:7], v10 offset:43008
v_mfma_f32_16x16x32_bf16 v[36:39], a[60:63], a[16:19], v[36:39]
ds_read_b128 a[8:11], v10 offset:45056
v_mfma_f32_16x16x32_bf16 v[60:63], a[60:63], a[20:23], v[60:63]
ds_read_b128 a[12:15], v10 offset:47104
v_mfma_f32_16x16x32_bf16 v[84:87], a[60:63], a[24:27], v[84:87]
ds_read_b64_tr_b16 a[36:37], v13 offset:40960
v_mfma_f32_16x16x32_bf16 v[108:111], a[60:63], a[28:31], v[108:111]
ds_read_b64_tr_b16 a[38:39], v13 offset:41472
v_mfma_f32_16x16x32_bf16 v[40:43], a[16:19], a[64:67], v[40:43]
ds_read_b64_tr_b16 a[40:41], v12 offset:43008
v_mfma_f32_16x16x32_bf16 v[64:67], a[20:23], a[64:67], v[64:67]
ds_read_b64_tr_b16 a[42:43], v12 offset:43520
v_mfma_f32_16x16x32_bf16 v[88:91], a[24:27], a[64:67], v[88:91]
ds_read_b64_tr_b16 a[44:45], v13 offset:43008
v_mfma_f32_16x16x32_bf16 v[112:115], a[28:31], a[64:67], v[112:115]
s_branch L_over3
L_pad3:
s_branch L_ret4
L_over3:
ds_read_b64_tr_b16 a[46:47], v13 offset:43520
v_mfma_f32_16x16x32_bf16 v[44:47], a[16:19], a[68:71], v[44:47]
ds_read_b64_tr_b16 a[48:49], v12 offset:45056
v_mfma_f32_16x16x32_bf16 v[68:71], a[20:23], a[68:71], v[68:71]
ds_read_b64_tr_b16 a[50:51], v12 offset:45568
v_mfma_f32_16x16x32_bf16 v[92:95], a[24:27], a[68:71], v[92:95]
ds_read_b64_tr_b16 a[52:53], v13 offset:45056
v_mfma_f32_16x16x32_bf16 v[116:119], a[28:31], a[68:71], v[116:119]
ds_read_b64_tr_b16 a[54:55], v13 offset:45568
v_mfma_f32_16x16x32_bf16 v[48:51], a[16:19], a[72:75], v[48:51]
v_mfma_f32_16x16x32_bf16 v[72:75], a[20:23], a[72:75], v[72:75]
v_mfma_f32_16x16x32_bf16 v[96:99], a[24:27], a[72:75], v[96:99]
v_mfma_f32_16x16x32_bf16 v[120:123], a[28:31], a[72:75], v[120:123]
v_mfma_f32_16x16x32_bf16 v[52:55], a[16:19], a[76:79], v[52:55]
v_mfma_f32_16x16x32_bf16 v[76:79], a[20:23], a[76:79], v[76:79]
v_mfma_f32_16x16x32_bf16 v[100:103], a[24:27], a[76:79], v[100:103]
v_mfma_f32_16x16x32_bf16 v[124:127], a[28:31], a[76:79], v[124:127]
s_waitcnt lgkmcnt(0)
v_mfma_f32_16x16x32_bf16 v[32:35], a[32:35], a[0:3], v[32:35]
ds_read_b128 a[16:19], v11 offset:40960
v_mfma_f32_16x16x32_bf16 v[56:59], a[32:35], a[4:7], v[56:59]
ds_read_b64_tr_b16 a[56:57], v12 offset:53248
v_mfma_f32_16x16x32_bf16 v[80:83], a[32:35], a[8:11], v[80:83]
ds_read_b64_tr_b16 a[58:59], v12 offset:53760
v_mfma_f32_16x16x32_bf16 v[104:107], a[32:35], a[12:15], v[104:107]
ds_read_b128 a[20:23], v11 offset:43008
v_mfma_f32_16x16x32_bf16 v[36:39], a[36:39], a[0:3], v[36:39]
ds_read_b128 a[24:27], v11 offset:45056
v_mfma_f32_16x16x32_bf16 v[60:63], a[36:39], a[4:7], v[60:63]
ds_read_b128 a[28:31], v11 offset:47104
v_mfma_f32_16x16x32_bf16 v[84:87], a[36:39], a[8:11], v[84:87]
ds_read_b64_tr_b16 a[60:61], v13 offset:53248
v_mfma_f32_16x16x32_bf16 v[108:111], a[36:39], a[12:15], v[108:111]
ds_read_b64_tr_b16 a[62:63], v13 offset:53760
v_mfma_f32_16x16x32_bf16 v[40:43], a[0:3], a[40:43], v[40:43]
ds_read_b64_tr_b16 a[64:65], v12 offset:55296
v_mfma_f32_16x16x32_bf16 v[64:67], a[4:7], a[40:43], v[64:67]
ds_read_b64_tr_b16 a[66:67], v12 offset:55808
v_mfma_f32_16x16x32_bf16 v[88:91], a[8:11], a[40:43], v[88:91]
ds_read_b64_tr_b16 a[68:69], v13 offset:55296
v_mfma_f32_16x16x32_bf16 v[112:115], a[12:15], a[40:43], v[112:115]
ds_read_b64_tr_b16 a[70:71], v13 offset:55808
v_mfma_f32_16x16x32_bf16 v[44:47], a[0:3], a[44:47], v[44:47]
ds_read_b64_tr_b16 a[72:73], v12 offset:57344
v_mfma_f32_16x16x32_bf16 v[68:71], a[4:7], a[44:47], v[68:71]
ds_read_b64_tr_b16 a[74:75], v12 offset:57856
v_mfma_f32_16x16x32_bf16 v[92:95], a[8:11], a[44:47], v[92:95]
ds_read_b64_tr_b16 a[76:77], v13 offset:57344
v_mfma_f32_16x16x32_bf16 v[116:119], a[12:15], a[44:47], v[116:119]
ds_read_b64_tr_b16 a[78:79], v13 offset:57856
v_mfma_f32_16x16x32_bf16 v[48:51], a[0:3], a[48:51], v[48:51]
s_add_u32 s70, s88, 65536
buffer_store_dwordx4 v[28:31], v16, s[12:15], s70 offen sc1
v_mfma_f32_16x16x32_bf16 v[72:75], a[4:7], a[48:51], v[72:75]
v_mfma_f32_16x16x32_bf16 v[96:99], a[8:11], a[48:51], v[96:99]
s_add_u32 s70, s88, 98304
buffer_store_dwordx4 v[28:31], v16, s[12:15], s70 offen sc1
v_mfma_f32_16x16x32_bf16 v[120:123], a[12:15], a[48:51], v[120:123]
v_mfma_f32_16x16x32_bf16 v[52:55], a[0:3], a[52:55], v[52:55]
v_mfma_f32_16x16x32_bf16 v[76:79], a[4:7], a[52:55], v[76:79]
v_mfma_f32_16x16x32_bf16 v[100:103], a[8:11], a[52:55], v[100:103]
v_mfma_f32_16x16x32_bf16 v[124:127], a[12:15], a[52:55], v[124:127]
s_waitcnt lgkmcnt(0)
v_mfma_f32_16x16x32_bf16 v[32:35], a[56:59], a[16:19], v[32:35]
s_barrier
ds_read_b128 a[0:3], v10 offset:0
v_mfma_f32_16x16x32_bf16 v[56:59], a[56:59], a[20:23], v[56:59]
ds_read_b64_tr_b16 a[32:33], v12 offset:0
v_mfma_f32_16x16x32_bf16 v[80:83], a[56:59], a[24:27], v[80:83]
ds_read_b64_tr_b16 a[34:35], v12 offset:512
v_mfma_f32_16x16x32_bf16 v[104:107], a[56:59], a[28:31], v[104:107]
ds_read_b128 a[4:7], v10 offset:2048
v_mfma_f32_16x16x32_bf16 v[36:39], a[60:63], a[16:19], v[36:39]
ds_read_b128 a[8:11], v10 offset:4096
v_mfma_f32_16x16x32_bf16 v[60:63], a[60:63], a[20:23], v[60:63]
ds_read_b128 a[12:15], v10 offset:6144
v_mfma_f32_16x16x32_bf16 v[84:87], a[60:63], a[24:27], v[84:87]
ds_read_b64_tr_b16 a[36:37], v13 offset:0
v_mfma_f32_16x16x32_bf16 v[108:111], a[60:63], a[28:31], v[108:111]
ds_read_b64_tr_b16 a[38:39], v13 offset:512
v_mfma_f32_16x16x32_bf16 v[40:43], a[16:19], a[64:67], v[40:43]
ds_read_b64_tr_b16 a[40:41], v12 offset:2048
v_mfma_f32_16x16x32_bf16 v[64:67], a[20:23], a[64:67], v[64:67]
ds_read_b64_tr_b16 a[42:43], v12 offset:2560
v_mfma_f32_16x16x32_bf16 v[88:91], a[24:27], a[64:67], v[88:91]
ds_read_b64_tr_b16 a[44:45], v13 offset:2048
v_mfma_f32_16x16x32_bf16 v[112:115], a[28:31], a[64:67], v[112:115]
ds_read_b64_tr_b16 a[46:47], v13 offset:2560
v_mfma_f32_16x16x32_bf16 v[44:47], a[16:19], a[68:71], v[44:47]
ds_read_b64_tr_b16 a[48:49], v12 offset:4096
v_mfma_f32_16x16x32_bf16 v[68:71], a[20:23], a[68:71], v[68:71]
ds_read_b64_tr_b16 a[50:51], v12 offset:4608
v_mfma_f32_16x16x32_bf16 v[92:95], a[24:27], a[68:71], v[92:95]
ds_read_b64_tr_b16 a[52:53], v13 offset:4096
v_mfma_f32_16x16x32_bf16 v[116:119], a[28:31], a[68:71], v[116:119]
ds_read_b64_tr_b16 a[54:55], v13 offset:4608
v_mfma_f32_16x16x32_bf16 v[48:51], a[16:19], a[72:75], v[48:51]
v_mfma_f32_16x16x32_bf16 v[72:75], a[20:23], a[72:75], v[72:75]
v_mfma_f32_16x16x32_bf16 v[96:99], a[24:27], a[72:75], v[96:99]
v_mfma_f32_16x16x32_bf16 v[120:123], a[28:31], a[72:75], v[120:123]
v_mfma_f32_16x16x32_bf16 v[52:55], a[16:19], a[76:79], v[52:55]
v_mfma_f32_16x16x32_bf16 v[76:79], a[20:23], a[76:79], v[76:79]
v_mfma_f32_16x16x32_bf16 v[100:103], a[24:27], a[76:79], v[100:103]
v_mfma_f32_16x16x32_bf16 v[124:127], a[28:31], a[76:79], v[124:127]
s_waitcnt lgkmcnt(0)
v_mfma_f32_16x16x32_bf16 v[32:35], a[32:35], a[0:3], v[32:35]
ds_read_b128 a[16:19], v11 offset:0
v_mfma_f32_16x16x32_bf16 v[56:59], a[32:35], a[4:7], v[56:59]
ds_read_b64_tr_b16 a[56:57], v12 offset:12288
v_mfma_f32_16x16x32_bf16 v[80:83], a[32:35], a[8:11], v[80:83]
ds_read_b64_tr_b16 a[58:59], v12 offset:12800
v_mfma_f32_16x16x32_bf16 v[104:107], a[32:35], a[12:15], v[104:107]
ds_read_b128 a[20:23], v11 offset:2048
v_mfma_f32_16x16x32_bf16 v[36:39], a[36:39], a[0:3], v[36:39]
ds_read_b128 a[24:27], v11 offset:4096
v_mfma_f32_16x16x32_bf16 v[60:63], a[36:39], a[4:7], v[60:63]
ds_read_b128 a[28:31], v11 offset:6144
v_mfma_f32_16x16x32_bf16 v[84:87], a[36:39], a[8:11], v[84:87]
ds_read_b64_tr_b16 a[60:61], v13 offset:12288
v_mfma_f32_16x16x32_bf16 v[108:111], a[36:39], a[12:15], v[108:111]
ds_read_b64_tr_b16 a[62:63], v13 offset:12800
v_mfma_f32_16x16x32_bf16 v[40:43], a[0:3], a[40:43], v[40:43]
ds_read_b64_tr_b16 a[64:65], v12 offset:14336
v_mfma_f32_16x16x32_bf16 v[64:67], a[4:7], a[40:43], v[64:67]
ds_read_b64_tr_b16 a[66:67], v12 offset:14848
v_mfma_f32_16x16x32_bf16 v[88:91], a[8:11], a[40:43], v[88:91]
ds_read_b64_tr_b16 a[68:69], v13 offset:14336
v_mfma_f32_16x16x32_bf16 v[112:115], a[12:15], a[40:43], v[112:115]
ds_read_b64_tr_b16 a[70:71], v13 offset:14848
v_mfma_f32_16x16x32_bf16 v[44:47], a[0:3], a[44:47], v[44:47]
ds_read_b64_tr_b16 a[72:73], v12 offset:16384
v_mfma_f32_16x16x32_bf16 v[68:71], a[4:7], a[44:47], v[68:71]
ds_read_b64_tr_b16 a[74:75], v12 offset:16896
v_mfma_f32_16x16x32_bf16 v[92:95], a[8:11], a[44:47], v[92:95]
ds_read_b64_tr_b16 a[76:77], v13 offset:16384
v_mfma_f32_16x16x32_bf16 v[116:119], a[12:15], a[44:47], v[116:119]
ds_read_b64_tr_b16 a[78:79], v13 offset:16896
v_mfma_f32_16x16x32_bf16 v[48:51], a[0:3], a[48:51], v[48:51]
v_mfma_f32_16x16x32_bf16 v[72:75], a[4:7], a[48:51], v[72:75]
v_mfma_f32_16x16x32_bf16 v[96:99], a[8:11], a[48:51], v[96:99]
v_mfma_f32_16x16x32_bf16 v[120:123], a[12:15], a[48:51], v[120:123]
v_mfma_f32_16x16x32_bf16 v[52:55], a[0:3], a[52:55], v[52:55]
v_mfma_f32_16x16x32_bf16 v[76:79], a[4:7], a[52:55], v[76:79]
v_mfma_f32_16x16x32_bf16 v[100:103], a[8:11], a[52:55], v[100:103]
v_mfma_f32_16x16x32_bf16 v[124:127], a[12:15], a[52:55], v[124:127]
s_waitcnt lgkmcnt(0)
v_mfma_f32_16x16x32_bf16 v[32:35], a[56:59], a[16:19], v[32:35]
s_barrier
ds_read_b128 a[0:3], v8 offset:24576
v_mfma_f32_16x16x32_bf16 v[56:59], a[56:59], a[20:23], v[56:59]
ds_read_b64_tr_b16 a[32:33], v14 offset:16384
v_mfma_f32_16x16x32_bf16 v[80:83], a[56:59], a[24:27], v[80:83]
ds_read_b64_tr_b16 a[34:35], v14 offset:16896
v_mfma_f32_16x16x32_bf16 v[104:107], a[56:59], a[28:31], v[104:107]
ds_read_b128 a[4:7], v8 offset:26624
v_mfma_f32_16x16x32_bf16 v[36:39], a[60:63], a[16:19], v[36:39]
ds_read_b128 a[8:11], v8 offset:28672
v_mfma_f32_16x16x32_bf16 v[60:63], a[60:63], a[20:23], v[60:63]
ds_read_b128 a[12:15], v8 offset:30720
v_mfma_f32_16x16x32_bf16 v[84:87], a[60:63], a[24:27], v[84:87]
ds_read_b64_tr_b16 a[36:37], v15 offset:16384
v_mfma_f32_16x16x32_bf16 v[108:111], a[60:63], a[28:31], v[108:111]
ds_read_b64_tr_b16 a[38:39], v15 offset:16896
v_mfma_f32_16x16x32_bf16 v[40:43], a[16:19], a[64:67], v[40:43]
ds_read_b64_tr_b16 a[40:41], v14 offset:18432
v_mfma_f32_16x16x32_bf16 v[64:67], a[20:23], a[64:67], v[64:67]
ds_read_b64_tr_b16 a[42:43], v14 offset:18944
v_mfma_f32_16x16x32_bf16 v[88:91], a[24:27], a[64:67], v[88:91]
ds_read_b64_tr_b16 a[44:45], v15 offset:18432
v_mfma_f32_16x16x32_bf16 v[112:115], a[28:31], a[64:67], v[112:115]
ds_read_b64_tr_b16 a[46:47], v15 offset:18944
v_mfma_f32_16x16x32_bf16 v[44:47], a[16:19], a[68:71], v[44:47]
ds_read_b64_tr_b16 a[48:49], v14 offset:20480
v_mfma_f32_16x16x32_bf16 v[68:71], a[20:23], a[68:71], v[68:71]
ds_read_b64_tr_b16 a[50:51], v14 offset:20992
v_mfma_f32_16x16x32_bf16 v[92:95], a[24:27], a[68:71], v[92:95]
ds_read_b64_tr_b16 a[52:53], v15 offset:20480
v_mfma_f32_16x16x32_bf16 v[116:119], a[28:31], a[68:71], v[116:119]
ds_read_b64_tr_b16 a[54:55], v15 offset:20992
v_mfma_f32_16x16x32_bf16 v[48:51], a[16:19], a[72:75], v[48:51]
v_mfma_f32_16x16x32_bf16 v[72:75], a[20:23], a[72:75], v[72:75]
v_mfma_f32_16x16x32_bf16 v[96:99], a[24:27], a[72:75], v[96:99]
v_mfma_f32_16x16x32_bf16 v[120:123], a[28:31], a[72:75], v[120:123]
v_mfma_f32_16x16x32_bf16 v[52:55], a[16:19], a[76:79], v[52:55]
v_mfma_f32_16x16x32_bf16 v[76:79], a[20:23], a[76:79], v[76:79]
v_mfma_f32_16x16x32_bf16 v[100:103], a[24:27], a[76:79], v[100:103]
v_mfma_f32_16x16x32_bf16 v[124:127], a[28:31], a[76:79], v[124:127]
s_waitcnt lgkmcnt(0)
v_mfma_f32_16x16x32_bf16 v[32:35], a[32:35], a[0:3], v[32:35]
ds_read_b128 a[16:19], v9 offset:24576
v_mfma_f32_16x16x32_bf16 v[56:59], a[32:35], a[4:7], v[56:59]
ds_read_b64_tr_b16 a[56:57], v14 offset:28672
v_mfma_f32_16x16x32_bf16 v[80:83], a[32:35], a[8:11], v[80:83]
ds_read_b64_tr_b16 a[58:59], v14 offset:29184
v_mfma_f32_16x16x32_bf16 v[104:107], a[32:35], a[12:15], v[104:107]
ds_read_b128 a[20:23], v9 offset:26624
v_mfma_f32_16x16x32_bf16 v[36:39], a[36:39], a[0:3], v[36:39]
ds_read_b128 a[24:27], v9 offset:28672
v_mfma_f32_16x16x32_bf16 v[60:63], a[36:39], a[4:7], v[60:63]
ds_read_b128 a[28:31], v9 offset:30720
v_mfma_f32_16x16x32_bf16 v[84:87], a[36:39], a[8:11], v[84:87]
ds_read_b64_tr_b16 a[60:61], v15 offset:28672
v_mfma_f32_16x16x32_bf16 v[108:111], a[36:39], a[12:15], v[108:111]
ds_read_b64_tr_b16 a[62:63], v15 offset:29184
v_mfma_f32_16x16x32_bf16 v[40:43], a[0:3], a[40:43], v[40:43]
ds_read_b64_tr_b16 a[64:65], v14 offset:30720
v_mfma_f32_16x16x32_bf16 v[64:67], a[4:7], a[40:43], v[64:67]
ds_read_b64_tr_b16 a[66:67], v14 offset:31232
v_mfma_f32_16x16x32_bf16 v[88:91], a[8:11], a[40:43], v[88:91]
ds_read_b64_tr_b16 a[68:69], v15 offset:30720
v_mfma_f32_16x16x32_bf16 v[112:115], a[12:15], a[40:43], v[112:115]
ds_read_b64_tr_b16 a[70:71], v15 offset:31232
v_mfma_f32_16x16x32_bf16 v[44:47], a[0:3], a[44:47], v[44:47]
ds_read_b64_tr_b16 a[72:73], v14 offset:32768
v_mfma_f32_16x16x32_bf16 v[68:71], a[4:7], a[44:47], v[68:71]
ds_read_b64_tr_b16 a[74:75], v14 offset:33280
v_mfma_f32_16x16x32_bf16 v[92:95], a[8:11], a[44:47], v[92:95]
ds_read_b64_tr_b16 a[76:77], v15 offset:32768
v_mfma_f32_16x16x32_bf16 v[116:119], a[12:15], a[44:47], v[116:119]
ds_read_b64_tr_b16 a[78:79], v15 offset:33280
v_mfma_f32_16x16x32_bf16 v[48:51], a[0:3], a[48:51], v[48:51]
s_waitcnt vmcnt(0)
v_mfma_f32_16x16x32_bf16 v[72:75], a[4:7], a[48:51], v[72:75]
v_mfma_f32_16x16x32_bf16 v[96:99], a[8:11], a[48:51], v[96:99]
v_mfma_f32_16x16x32_bf16 v[120:123], a[12:15], a[48:51], v[120:123]
v_mfma_f32_16x16x32_bf16 v[52:55], a[0:3], a[52:55], v[52:55]
v_mfma_f32_16x16x32_bf16 v[76:79], a[4:7], a[52:55], v[76:79]
v_mfma_f32_16x16x32_bf16 v[100:103], a[8:11], a[52:55], v[100:103]
v_mfma_f32_16x16x32_bf16 v[124:127], a[12:15], a[52:55], v[124:127]
s_waitcnt lgkmcnt(0)
v_mfma_f32_16x16x32_bf16 v[32:35], a[56:59], a[16:19], v[32:35]
s_barrier
ds_read_b128 a[0:3], v10 offset:57344
v_mfma_f32_16x16x32_bf16 v[56:59], a[56:59], a[20:23], v[56:59]
ds_read_b64_tr_b16 a[32:33], v12 offset:40960
v_mfma_f32_16x16x32_bf16 v[80:83], a[56:59], a[24:27], v[80:83]
ds_read_b64_tr_b16 a[34:35], v12 offset:41472
v_mfma_f32_16x16x32_bf16 v[104:107], a[56:59], a[28:31], v[104:107]
ds_read_b128 a[4:7], v10 offset:59392
v_mfma_f32_16x16x32_bf16 v[36:39], a[60:63], a[16:19], v[36:39]
ds_read_b128 a[8:11], v10 offset:61440
v_mfma_f32_16x16x32_bf16 v[60:63], a[60:63], a[20:23], v[60:63]
ds_read_b128 a[12:15], v10 offset:63488
v_mfma_f32_16x16x32_bf16 v[84:87], a[60:63], a[24:27], v[84:87]
ds_read_b64_tr_b16 a[36:37], v13 offset:40960
v_mfma_f32_16x16x32_bf16 v[108:111], a[60:63], a[28:31], v[108:111]
ds_read_b64_tr_b16 a[38:39], v13 offset:41472
v_mfma_f32_16x16x32_bf16 v[40:43], a[16:19], a[64:67], v[40:43]
ds_read_b64_tr_b16 a[40:41], v12 offset:43008
v_mfma_f32_16x16x32_bf16 v[64:67], a[20:23], a[64:67], v[64:67]
ds_read_b64_tr_b16 a[42:43], v12 offset:43520
v_mfma_f32_16x16x32_bf16 v[88:91], a[24:27], a[64:67], v[88:91]
ds_read_b64_tr_b16 a[44:45], v13 offset:43008
v_mfma_f32_16x16x32_bf16 v[112:115], a[28:31], a[64:67], v[112:115]
ds_read_b64_tr_b16 a[46:47], v13 offset:43520
v_mfma_f32_16x16x32_bf16 v[44:47], a[16:19], a[68:71], v[44:47]
ds_read_b64_tr_b16 a[48:49], v12 offset:45056
v_mfma_f32_16x16x32_bf16 v[68:71], a[20:23], a[68:71], v[68:71]
ds_read_b64_tr_b16 a[50:51], v12 offset:45568
v_mfma_f32_16x16x32_bf16 v[92:95], a[24:27], a[68:71], v[92:95]
ds_read_b64_tr_b16 a[52:53], v13 offset:45056
v_mfma_f32_16x16x32_bf16 v[116:119], a[28:31], a[68:71], v[116:119]
ds_read_b64_tr_b16 a[54:55], v13 offset:45568
v_mfma_f32_16x16x32_bf16 v[48:51], a[16:19], a[72:75], v[48:51]
v_mfma_f32_16x16x32_bf16 v[72:75], a[20:23], a[72:75], v[72:75]
v_mfma_f32_16x16x32_bf16 v[96:99], a[24:27], a[72:75], v[96:99]
v_mfma_f32_16x16x32_bf16 v[120:123], a[28:31], a[72:75], v[120:123]
v_mfma_f32_16x16x32_bf16 v[52:55], a[16:19], a[76:79], v[52:55]
v_mfma_f32_16x16x32_bf16 v[76:79], a[20:23], a[76:79], v[76:79]
v_mfma_f32_16x16x32_bf16 v[100:103], a[24:27], a[76:79], v[100:103]
v_mfma_f32_16x16x32_bf16 v[124:127], a[28:31], a[76:79], v[124:127]
s_waitcnt lgkmcnt(0)
v_mfma_f32_16x16x32_bf16 v[32:35], a[32:35], a[0:3], v[32:35]
ds_read_b128 a[16:19], v11 offset:57344
v_mfma_f32_16x16x32_bf16 v[56:59], a[32:35], a[4:7], v[56:59]
ds_read_b64_tr_b16 a[56:57], v12 offset:53248
v_mfma_f32_16x16x32_bf16 v[80:83], a[32:35], a[8:11], v[80:83]
ds_read_b64_tr_b16 a[58:59], v12 offset:53760
v_mfma_f32_16x16x32_bf16 v[104:107], a[32:35], a[12:15], v[104:107]
ds_read_b128 a[20:23], v11 offset:59392
v_mfma_f32_16x16x32_bf16 v[36:39], a[36:39], a[0:3], v[36:39]
ds_read_b128 a[24:27], v11 offset:61440
v_mfma_f32_16x16x32_bf16 v[60:63], a[36:39], a[4:7], v[60:63]
ds_read_b128 a[28:31], v11 offset:63488
v_mfma_f32_16x16x32_bf16 v[84:87], a[36:39], a[8:11], v[84:87]
ds_read_b64_tr_b16 a[60:61], v13 offset:53248
v_mfma_f32_16x16x32_bf16 v[108:111], a[36:39], a[12:15], v[108:111]
ds_read_b64_tr_b16 a[62:63], v13 offset:53760
v_mfma_f32_16x16x32_bf16 v[40:43], a[0:3], a[40:43], v[40:43]
ds_read_b64_tr_b16 a[64:65], v12 offset:55296
v_mfma_f32_16x16x32_bf16 v[64:67], a[4:7], a[40:43], v[64:67]
ds_read_b64_tr_b16 a[66:67], v12 offset:55808
v_mfma_f32_16x16x32_bf16 v[88:91], a[8:11], a[40:43], v[88:91]
ds_read_b64_tr_b16 a[68:69], v13 offset:55296
v_mfma_f32_16x16x32_bf16 v[112:115], a[12:15], a[40:43], v[112:115]
ds_read_b64_tr_b16 a[70:71], v13 offset:55808
v_mfma_f32_16x16x32_bf16 v[44:47], a[0:3], a[44:47], v[44:47]
ds_read_b64_tr_b16 a[72:73], v12 offset:57344
v_mfma_f32_16x16x32_bf16 v[68:71], a[4:7], a[44:47], v[68:71]
ds_read_b64_tr_b16 a[74:75], v12 offset:57856
v_mfma_f32_16x16x32_bf16 v[92:95], a[8:11], a[44:47], v[92:95]
ds_read_b64_tr_b16 a[76:77], v13 offset:57344
v_mfma_f32_16x16x32_bf16 v[116:119], a[12:15], a[44:47], v[116:119]
ds_read_b64_tr_b16 a[78:79], v13 offset:57856
v_mfma_f32_16x16x32_bf16 v[48:51], a[0:3], a[48:51], v[48:51]
v_mfma_f32_16x16x32_bf16 v[72:75], a[4:7], a[48:51], v[72:75]
v_mfma_f32_16x16x32_bf16 v[96:99], a[8:11], a[48:51], v[96:99]
v_mfma_f32_16x16x32_bf16 v[120:123], a[12:15], a[48:51], v[120:123]
v_mfma_f32_16x16x32_bf16 v[52:55], a[0:3], a[52:55], v[52:55]
v_mfma_f32_16x16x32_bf16 v[76:79], a[4:7], a[52:55], v[76:79]
v_mfma_f32_16x16x32_bf16 v[100:103], a[8:11], a[52:55], v[100:103]
v_mfma_f32_16x16x32_bf16 v[124:127], a[12:15], a[52:55], v[124:127]
s_waitcnt lgkmcnt(0)
v_mfma_f32_16x16x32_bf16 v[32:35], a[56:59], a[16:19], v[32:35]
s_barrier
ds_read_b128 a[0:3], v10 offset:40960
v_mfma_f32_16x16x32_bf16 v[56:59], a[56:59], a[20:23], v[56:59]
ds_read_b64_tr_b16 a[32:33], v12 offset:0
v_mfma_f32_16x16x32_bf16 v[80:83], a[56:59], a[24:27], v[80:83]
ds_read_b64_tr_b16 a[34:35], v12 offset:512
v_mfma_f32_16x16x32_bf16 v[104:107], a[56:59], a[28:31], v[104:107]
ds_read_b128 a[4:7], v10 offset:43008
v_mfma_f32_16x16x32_bf16 v[36:39], a[60:63], a[16:19], v[36:39]
ds_read_b128 a[8:11], v10 offset:45056
v_mfma_f32_16x16x32_bf16 v[60:63], a[60:63], a[20:23], v[60:63]
ds_read_b128 a[12:15], v10 offset:47104
v_mfma_f32_16x16x32_bf16 v[84:87], a[60:63], a[24:27], v[84:87]
ds_read_b64_tr_b16 a[36:37], v13 offset:0
v_mfma_f32_16x16x32_bf16 v[108:111], a[60:63], a[28:31], v[108:111]
ds_read_b64_tr_b16 a[38:39], v13 offset:512
v_mfma_f32_16x16x32_bf16 v[40:43], a[16:19], a[64:67], v[40:43]
ds_read_b64_tr_b16 a[40:41], v12 offset:2048
v_mfma_f32_16x16x32_bf16 v[64:67], a[20:23], a[64:67], v[64:67]
ds_read_b64_tr_b16 a[42:43], v12 offset:2560
v_mfma_f32_16x16x32_bf16 v[88:91], a[24:27], a[64:67], v[88:91]
ds_read_b64_tr_b16 a[44:45], v13 offset:2048
v_mfma_f32_16x16x32_bf16 v[112:115], a[28:31], a[64:67], v[112:115]
ds_read_b64_tr_b16 a[46:47], v13 offset:2560
v_mfma_f32_16x16x32_bf16 v[44:47], a[16:19], a[68:71], v[44:47]
ds_read_b64_tr_b16 a[48:49], v12 offset:4096
v_mfma_f32_16x16x32_bf16 v[68:71], a[20:23], a[68:71], v[68:71]
ds_read_b64_tr_b16 a[50:51], v12 offset:4608
v_mfma_f32_16x16x32_bf16 v[92:95], a[24:27], a[68:71], v[92:95]
ds_read_b64_tr_b16 a[52:53], v13 offset:4096
v_mfma_f32_16x16x32_bf16 v[116:119], a[28:31], a[68:71], v[116:119]
ds_read_b64_tr_b16 a[54:55], v13 offset:4608
v_mfma_f32_16x16x32_bf16 v[48:51], a[16:19], a[72:75], v[48:51]
v_mfma_f32_16x16x32_bf16 v[72:75], a[20:23], a[72:75], v[72:75]
v_mfma_f32_16x16x32_bf16 v[96:99], a[24:27], a[72:75], v[96:99]
v_mfma_f32_16x16x32_bf16 v[120:123], a[28:31], a[72:75], v[120:123]
v_mfma_f32_16x16x32_bf16 v[52:55], a[16:19], a[76:79], v[52:55]
v_mfma_f32_16x16x32_bf16 v[76:79], a[20:23], a[76:79], v[76:79]
v_mfma_f32_16x16x32_bf16 v[100:103], a[24:27], a[76:79], v[100:103]
v_mfma_f32_16x16x32_bf16 v[124:127], a[28:31], a[76:79], v[124:127]
s_waitcnt lgkmcnt(0)
v_mfma_f32_16x16x32_bf16 v[32:35], a[32:35], a[0:3], v[32:35]
ds_read_b128 a[16:19], v11 offset:40960
v_mfma_f32_16x16x32_bf16 v[56:59], a[32:35], a[4:7], v[56:59]
ds_read_b64_tr_b16 a[56:57], v12 offset:12288
v_mfma_f32_16x16x32_bf16 v[80:83], a[32:35], a[8:11], v[80:83]
ds_read_b64_tr_b16 a[58:59], v12 offset:12800
v_mfma_f32_16x16x32_bf16 v[104:107], a[32:35], a[12:15], v[104:107]
ds_read_b128 a[20:23], v11 offset:43008
v_mfma_f32_16x16x32_bf16 v[36:39], a[36:39], a[0:3], v[36:39]
ds_read_b128 a[24:27], v11 offset:45056
v_mfma_f32_16x16x32_bf16 v[60:63], a[36:39], a[4:7], v[60:63]
ds_read_b128 a[28:31], v11 offset:47104
v_mfma_f32_16x16x32_bf16 v[84:87], a[36:39], a[8:11], v[84:87]
ds_read_b64_tr_b16 a[60:61], v13 offset:12288
v_mfma_f32_16x16x32_bf16 v[108:111], a[36:39], a[12:15], v[108:111]
ds_read_b64_tr_b16 a[62:63], v13 offset:12800
v_mfma_f32_16x16x32_bf16 v[40:43], a[0:3], a[40:43], v[40:43]
ds_read_b64_tr_b16 a[64:65], v12 offset:14336
v_mfma_f32_16x16x32_bf16 v[64:67], a[4:7], a[40:43], v[64:67]
ds_read_b64_tr_b16 a[66:67], v12 offset:14848
v_mfma_f32_16x16x32_bf16 v[88:91], a[8:11], a[40:43], v[88:91]
ds_read_b64_tr_b16 a[68:69], v13 offset:14336
v_mfma_f32_16x16x32_bf16 v[112:115], a[12:15], a[40:43], v[112:115]
ds_read_b64_tr_b16 a[70:71], v13 offset:14848
v_mfma_f32_16x16x32_bf16 v[44:47], a[0:3], a[44:47], v[44:47]
ds_read_b64_tr_b16 a[72:73], v12 offset:16384
v_mfma_f32_16x16x32_bf16 v[68:71], a[4:7], a[44:47], v[68:71]
ds_read_b64_tr_b16 a[74:75], v12 offset:16896
v_mfma_f32_16x16x32_bf16 v[92:95], a[8:11], a[44:47], v[92:95]
ds_read_b64_tr_b16 a[76:77], v13 offset:16384
v_mfma_f32_16x16x32_bf16 v[116:119], a[12:15], a[44:47], v[116:119]
ds_read_b64_tr_b16 a[78:79], v13 offset:16896
v_mfma_f32_16x16x32_bf16 v[48:51], a[0:3], a[48:51], v[48:51]
v_mfma_f32_16x16x32_bf16 v[72:75], a[4:7], a[48:51], v[72:75]
v_mfma_f32_16x16x32_bf16 v[96:99], a[8:11], a[48:51], v[96:99]
v_mfma_f32_16x16x32_bf16 v[120:123], a[12:15], a[48:51], v[120:123]
v_mfma_f32_16x16x32_bf16 v[52:55], a[0:3], a[52:55], v[52:55]
v_mfma_f32_16x16x32_bf16 v[76:79], a[4:7], a[52:55], v[76:79]
v_mfma_f32_16x16x32_bf16 v[100:103], a[8:11], a[52:55], v[100:103]
v_mfma_f32_16x16x32_bf16 v[124:127], a[12:15], a[52:55], v[124:127]
s_waitcnt lgkmcnt(0)
v_mfma_f32_16x16x32_bf16 v[32:35], a[56:59], a[16:19], v[32:35]
s_barrier
ds_read_b128 a[0:3], v10 offset:0
v_mfma_f32_16x16x32_bf16 v[56:59], a[56:59], a[20:23], v[56:59]
ds_read_b64_tr_b16 a[32:33], v14 offset:16384
v_mfma_f32_16x16x32_bf16 v[80:83], a[56:59], a[24:27], v[80:83]
ds_read_b64_tr_b16 a[34:35], v14 offset:16896
v_mfma_f32_16x16x32_bf16 v[104:107], a[56:59], a[28:31], v[104:107]
ds_read_b128 a[4:7], v10 offset:2048
v_mfma_f32_16x16x32_bf16 v[36:39], a[60:63], a[16:19], v[36:39]
ds_read_b128 a[8:11], v10 offset:4096
v_mfma_f32_16x16x32_bf16 v[60:63], a[60:63], a[20:23], v[60:63]
ds_read_b128 a[12:15], v10 offset:6144
v_mfma_f32_16x16x32_bf16 v[84:87], a[60:63], a[24:27], v[84:87]
ds_read_b64_tr_b16 a[36:37], v15 offset:16384
v_mfma_f32_16x16x32_bf16 v[108:111], a[60:63], a[28:31], v[108:111]
ds_read_b64_tr_b16 a[38:39], v15 offset:16896
v_mfma_f32_16x16x32_bf16 v[40:43], a[16:19], a[64:67], v[40:43]
ds_read_b64_tr_b16 a[40:41], v14 offset:18432
v_mfma_f32_16x16x32_bf16 v[64:67], a[20:23], a[64:67], v[64:67]
ds_read_b64_tr_b16 a[42:43], v14 offset:18944
v_mfma_f32_16x16x32_bf16 v[88:91], a[24:27], a[64:67], v[88:91]
ds_read_b64_tr_b16 a[44:45], v15 offset:18432
v_mfma_f32_16x16x32_bf16 v[112:115], a[28:31], a[64:67], v[112:115]
ds_read_b64_tr_b16 a[46:47], v15 offset:18944
v_mfma_f32_16x16x32_bf16 v[44:47], a[16:19], a[68:71], v[44:47]
ds_read_b64_tr_b16 a[48:49], v14 offset:20480
v_mfma_f32_16x16x32_bf16 v[68:71], a[20:23], a[68:71], v[68:71]
ds_read_b64_tr_b16 a[50:51], v14 offset:20992
v_mfma_f32_16x16x32_bf16 v[92:95], a[24:27], a[68:71], v[92:95]
ds_read_b64_tr_b16 a[52:53], v15 offset:20480
v_mfma_f32_16x16x32_bf16 v[116:119], a[28:31], a[68:71], v[116:119]
ds_read_b64_tr_b16 a[54:55], v15 offset:20992
v_mfma_f32_16x16x32_bf16 v[48:51], a[16:19], a[72:75], v[48:51]
v_mfma_f32_16x16x32_bf16 v[72:75], a[20:23], a[72:75], v[72:75]
v_mfma_f32_16x16x32_bf16 v[96:99], a[24:27], a[72:75], v[96:99]
v_mfma_f32_16x16x32_bf16 v[120:123], a[28:31], a[72:75], v[120:123]
v_mfma_f32_16x16x32_bf16 v[52:55], a[16:19], a[76:79], v[52:55]
v_mfma_f32_16x16x32_bf16 v[76:79], a[20:23], a[76:79], v[76:79]
v_mfma_f32_16x16x32_bf16 v[100:103], a[24:27], a[76:79], v[100:103]
v_mfma_f32_16x16x32_bf16 v[124:127], a[28:31], a[76:79], v[124:127]
s_waitcnt lgkmcnt(0)
v_mfma_f32_16x16x32_bf16 v[32:35], a[32:35], a[0:3], v[32:35]
ds_read_b128 a[16:19], v11 offset:0
v_mfma_f32_16x16x32_bf16 v[56:59], a[32:35], a[4:7], v[56:59]
ds_read_b64_tr_b16 a[56:57], v14 offset:28672
v_mfma_f32_16x16x32_bf16 v[80:83], a[32:35], a[8:11], v[80:83]
ds_read_b64_tr_b16 a[58:59], v14 offset:29184
v_mfma_f32_16x16x32_bf16 v[104:107], a[32:35], a[12:15], v[104:107]
ds_read_b128 a[20:23], v11 offset:2048
v_mfma_f32_16x16x32_bf16 v[36:39], a[36:39], a[0:3], v[36:39]
ds_read_b128 a[24:27], v11 offset:4096
v_mfma_f32_16x16x32_bf16 v[60:63], a[36:39], a[4:7], v[60:63]
ds_read_b128 a[28:31], v11 offset:6144
v_mfma_f32_16x16x32_bf16 v[84:87], a[36:39], a[8:11], v[84:87]
ds_read_b64_tr_b16 a[60:61], v15 offset:28672
v_mfma_f32_16x16x32_bf16 v[108:111], a[36:39], a[12:15], v[108:111]
ds_read_b64_tr_b16 a[62:63], v15 offset:29184
v_mfma_f32_16x16x32_bf16 v[40:43], a[0:3], a[40:43], v[40:43]
ds_read_b64_tr_b16 a[64:65], v14 offset:30720
v_mfma_f32_16x16x32_bf16 v[64:67], a[4:7], a[40:43], v[64:67]
ds_read_b64_tr_b16 a[66:67], v14 offset:31232
v_mfma_f32_16x16x32_bf16 v[88:91], a[8:11], a[40:43], v[88:91]
ds_read_b64_tr_b16 a[68:69], v15 offset:30720
v_mfma_f32_16x16x32_bf16 v[112:115], a[12:15], a[40:43], v[112:115]
ds_read_b64_tr_b16 a[70:71], v15 offset:31232
v_mfma_f32_16x16x32_bf16 v[44:47], a[0:3], a[44:47], v[44:47]
ds_read_b64_tr_b16 a[72:73], v14 offset:32768
v_mfma_f32_16x16x32_bf16 v[68:71], a[4:7], a[44:47], v[68:71]
ds_read_b64_tr_b16 a[74:75], v14 offset:33280
v_mfma_f32_16x16x32_bf16 v[92:95], a[8:11], a[44:47], v[92:95]
ds_read_b64_tr_b16 a[76:77], v15 offset:32768
v_mfma_f32_16x16x32_bf16 v[116:119], a[12:15], a[44:47], v[116:119]
ds_read_b64_tr_b16 a[78:79], v15 offset:33280
v_mfma_f32_16x16x32_bf16 v[48:51], a[0:3], a[48:51], v[48:51]
v_mfma_f32_16x16x32_bf16 v[72:75], a[4:7], a[48:51], v[72:75]
v_mfma_f32_16x16x32_bf16 v[96:99], a[8:11], a[48:51], v[96:99]
v_mfma_f32_16x16x32_bf16 v[120:123], a[12:15], a[48:51], v[120:123]
v_mfma_f32_16x16x32_bf16 v[52:55], a[0:3], a[52:55], v[52:55]
v_mfma_f32_16x16x32_bf16 v[76:79], a[4:7], a[52:55], v[76:79]
v_mfma_f32_16x16x32_bf16 v[100:103], a[8:11], a[52:55], v[100:103]
v_mfma_f32_16x16x32_bf16 v[124:127], a[12:15], a[52:55], v[124:127]
s_waitcnt lgkmcnt(0)
v_mfma_f32_16x16x32_bf16 v[32:35], a[56:59], a[16:19], v[32:35]
s_barrier
ds_read_b128 a[0:3], v8 offset:24576
v_mfma_f32_16x16x32_bf16 v[56:59], a[56:59], a[20:23], v[56:59]
ds_read_b64_tr_b16 a[32:33], v12 offset:40960
v_mfma_f32_16x16x32_bf16 v[80:83], a[56:59], a[24:27], v[80:83]
ds_read_b64_tr_b16 a[34:35], v12 offset:41472
v_mfma_f32_16x16x32_bf16 v[104:107], a[56:59], a[28:31], v[104:107]
ds_read_b128 a[4:7], v8 offset:26624
v_mfma_f32_16x16x32_bf16 v[36:39], a[60:63], a[16:19], v[36:39]
ds_read_b128 a[8:11], v8 offset:28672
v_mfma_f32_16x16x32_bf16 v[60:63], a[60:63], a[20:23], v[60:63]
ds_read_b128 a[12:15], v8 offset:30720
v_mfma_f32_16x16x32_bf16 v[84:87], a[60:63], a[24:27], v[84:87]
ds_read_b64_tr_b16 a[36:37], v13 offset:40960
v_mfma_f32_16x16x32_bf16 v[108:111], a[60:63], a[28:31], v[108:111]
ds_read_b64_tr_b16 a[38:39], v13 offset:41472
v_mfma_f32_16x16x32_bf16 v[40:43], a[16:19], a[64:67], v[40:43]
ds_read_b64_tr_b16 a[40:41], v12 offset:43008
v_mfma_f32_16x16x32_bf16 v[64:67], a[20:23], a[64:67], v[64:67]
ds_read_b64_tr_b16 a[42:43], v12 offset:43520
v_mfma_f32_16x16x32_bf16 v[88:91], a[24:27], a[64:67], v[88:91]
ds_read_b64_tr_b16 a[44:45], v13 offset:43008
v_mfma_f32_16x16x32_bf16 v[112:115], a[28:31], a[64:67], v[112:115]
ds_read_b64_tr_b16 a[46:47], v13 offset:43520
v_mfma_f32_16x16x32_bf16 v[44:47], a[16:19], a[68:71], v[44:47]
ds_read_b64_tr_b16 a[48:49], v12 offset:45056
v_mfma_f32_16x16x32_bf16 v[68:71], a[20:23], a[68:71], v[68:71]
ds_read_b64_tr_b16 a[50:51], v12 offset:45568
v_mfma_f32_16x16x32_bf16 v[92:95], a[24:27], a[68:71], v[92:95]
ds_read_b64_tr_b16 a[52:53], v13 offset:45056
v_mfma_f32_16x16x32_bf16 v[116:119], a[28:31], a[68:71], v[116:119]
ds_read_b64_tr_b16 a[54:55], v13 offset:45568
v_mfma_f32_16x16x32_bf16 v[48:51], a[16:19], a[72:75], v[48:51]
v_mfma_f32_16x16x32_bf16 v[72:75], a[20:23], a[72:75], v[72:75]
v_mfma_f32_16x16x32_bf16 v[96:99], a[24:27], a[72:75], v[96:99]
v_mfma_f32_16x16x32_bf16 v[120:123], a[28:31], a[72:75], v[120:123]
v_mfma_f32_16x16x32_bf16 v[52:55], a[16:19], a[76:79], v[52:55]
v_mfma_f32_16x16x32_bf16 v[76:79], a[20:23], a[76:79], v[76:79]
v_mfma_f32_16x16x32_bf16 v[100:103], a[24:27], a[76:79], v[100:103]
v_mfma_f32_16x16x32_bf16 v[124:127], a[28:31], a[76:79], v[124:127]
s_waitcnt lgkmcnt(0)
s_branch L_over4
L_pad4:
s_branch L_ret4
L_over4:
v_mfma_f32_16x16x32_bf16 v[32:35], a[32:35], a[0:3], v[32:35]
ds_read_b128 a[16:19], v9 offset:24576
v_mfma_f32_16x16x32_bf16 v[56:59], a[32:35], a[4:7], v[56:59]
ds_read_b64_tr_b16 a[56:57], v12 offset:53248
v_mfma_f32_16x16x32_bf16 v[80:83], a[32:35], a[8:11], v[80:83]
ds_read_b64_tr_b16 a[58:59], v12 offset:53760
v_mfma_f32_16x16x32_bf16 v[104:107], a[32:35], a[12:15], v[104:107]
ds_read_b128 a[20:23], v9 offset:26624
v_mfma_f32_16x16x32_bf16 v[36:39], a[36:39], a[0:3], v[36:39]
ds_read_b128 a[24:27], v9 offset:28672
v_mfma_f32_16x16x32_bf16 v[60:63], a[36:39], a[4:7], v[60:63]
ds_read_b128 a[28:31], v9 offset:30720
v_mfma_f32_16x16x32_bf16 v[84:87], a[36:39], a[8:11], v[84:87]
ds_read_b64_tr_b16 a[60:61], v13 offset:53248
v_mfma_f32_16x16x32_bf16 v[108:111], a[36:39], a[12:15], v[108:111]
ds_read_b64_tr_b16 a[62:63], v13 offset:53760
v_mfma_f32_16x16x32_bf16 v[40:43], a[0:3], a[40:43], v[40:43]
ds_read_b64_tr_b16 a[64:65], v12 offset:55296
v_mfma_f32_16x16x32_bf16 v[64:67], a[4:7], a[40:43], v[64:67]
ds_read_b64_tr_b16 a[66:67], v12 offset:55808
v_mfma_f32_16x16x32_bf16 v[88:91], a[8:11], a[40:43], v[88:91]
ds_read_b64_tr_b16 a[68:69], v13 offset:55296
v_mfma_f32_16x16x32_bf16 v[112:115], a[12:15], a[40:43], v[112:115]
ds_read_b64_tr_b16 a[70:71], v13 offset:55808
v_mfma_f32_16x16x32_bf16 v[44:47], a[0:3], a[44:47], v[44:47]
ds_read_b64_tr_b16 a[72:73], v12 offset:57344
v_mfma_f32_16x16x32_bf16 v[68:71], a[4:7], a[44:47], v[68:71]
ds_read_b64_tr_b16 a[74:75], v12 offset:57856
v_mfma_f32_16x16x32_bf16 v[92:95], a[8:11], a[44:47], v[92:95]
ds_read_b64_tr_b16 a[76:77], v13 offset:57344
v_mfma_f32_16x16x32_bf16 v[116:119], a[12:15], a[44:47], v[116:119]
ds_read_b64_tr_b16 a[78:79], v13 offset:57856
v_mfma_f32_16x16x32_bf16 v[48:51], a[0:3], a[48:51], v[48:51]
v_mfma_f32_16x16x32_bf16 v[72:75], a[4:7], a[48:51], v[72:75]
v_mfma_f32_16x16x32_bf16 v[96:99], a[8:11], a[48:51], v[96:99]
v_mfma_f32_16x16x32_bf16 v[120:123], a[12:15], a[48:51], v[120:123]
v_mfma_f32_16x16x32_bf16 v[52:55], a[0:3], a[52:55], v[52:55]
v_mfma_f32_16x16x32_bf16 v[76:79], a[4:7], a[52:55], v[76:79]
v_mfma_f32_16x16x32_bf16 v[100:103], a[8:11], a[52:55], v[100:103]
v_mfma_f32_16x16x32_bf16 v[124:127], a[12:15], a[52:55], v[124:127]
s_waitcnt lgkmcnt(0)
v_mfma_f32_16x16x32_bf16 v[32:35], a[56:59], a[16:19], v[32:35]
s_barrier
ds_read_b128 a[0:3], v10 offset:57344
v_mfma_f32_16x16x32_bf16 v[56:59], a[56:59], a[20:23], v[56:59]
ds_read_b64_tr_b16 a[32:33], v12 offset:0
v_mfma_f32_16x16x32_bf16 v[80:83], a[56:59], a[24:27], v[80:83]
ds_read_b64_tr_b16 a[34:35], v12 offset:512
v_mfma_f32_16x16x32_bf16 v[104:107], a[56:59], a[28:31], v[104:107]
ds_read_b128 a[4:7], v10 offset:59392
v_mfma_f32_16x16x32_bf16 v[36:39], a[60:63], a[16:19], v[36:39]
ds_read_b128 a[8:11], v10 offset:61440
v_mfma_f32_16x16x32_bf16 v[60:63], a[60:63], a[20:23], v[60:63]
ds_read_b128 a[12:15], v10 offset:63488
v_mfma_f32_16x16x32_bf16 v[84:87], a[60:63], a[24:27], v[84:87]
ds_read_b64_tr_b16 a[36:37], v13 offset:0
v_mfma_f32_16x16x32_bf16 v[108:111], a[60:63], a[28:31], v[108:111]
ds_read_b64_tr_b16 a[38:39], v13 offset:512
v_mfma_f32_16x16x32_bf16 v[40:43], a[16:19], a[64:67], v[40:43]
ds_read_b64_tr_b16 a[40:41], v12 offset:2048
v_mfma_f32_16x16x32_bf16 v[64:67], a[20:23], a[64:67], v[64:67]
ds_read_b64_tr_b16 a[42:43], v12 offset:2560
v_mfma_f32_16x16x32_bf16 v[88:91], a[24:27], a[64:67], v[88:91]
ds_read_b64_tr_b16 a[44:45], v13 offset:2048
v_mfma_f32_16x16x32_bf16 v[112:115], a[28:31], a[64:67], v[112:115]
ds_read_b64_tr_b16 a[46:47], v13 offset:2560
v_mfma_f32_16x16x32_bf16 v[44:47], a[16:19], a[68:71], v[44:47]
ds_read_b64_tr_b16 a[48:49], v12 offset:4096
v_mfma_f32_16x16x32_bf16 v[68:71], a[20:23], a[68:71], v[68:71]
ds_read_b64_tr_b16 a[50:51], v12 offset:4608
v_mfma_f32_16x16x32_bf16 v[92:95], a[24:27], a[68:71], v[92:95]
ds_read_b64_tr_b16 a[52:53], v13 offset:4096
v_mfma_f32_16x16x32_bf16 v[116:119], a[28:31], a[68:71], v[116:119]
ds_read_b64_tr_b16 a[54:55], v13 offset:4608
v_mfma_f32_16x16x32_bf16 v[48:51], a[16:19], a[72:75], v[48:51]
v_mfma_f32_16x16x32_bf16 v[72:75], a[20:23], a[72:75], v[72:75]
v_mfma_f32_16x16x32_bf16 v[96:99], a[24:27], a[72:75], v[96:99]
v_mfma_f32_16x16x32_bf16 v[120:123], a[28:31], a[72:75], v[120:123]
v_mfma_f32_16x16x32_bf16 v[52:55], a[16:19], a[76:79], v[52:55]
v_mfma_f32_16x16x32_bf16 v[76:79], a[20:23], a[76:79], v[76:79]
v_mfma_f32_16x16x32_bf16 v[100:103], a[24:27], a[76:79], v[100:103]
v_mfma_f32_16x16x32_bf16 v[124:127], a[28:31], a[76:79], v[124:127]
s_waitcnt lgkmcnt(0)
v_mfma_f32_16x16x32_bf16 v[32:35], a[32:35], a[0:3], v[32:35]
ds_read_b128 a[16:19], v11 offset:57344
v_mfma_f32_16x16x32_bf16 v[56:59], a[32:35], a[4:7], v[56:59]
ds_read_b64_tr_b16 a[56:57], v12 offset:12288
v_mfma_f32_16x16x32_bf16 v[80:83], a[32:35], a[8:11], v[80:83]
ds_read_b64_tr_b16 a[58:59], v12 offset:12800
v_mfma_f32_16x16x32_bf16 v[104:107], a[32:35], a[12:15], v[104:107]
ds_read_b128 a[20:23], v11 offset:59392
v_mfma_f32_16x16x32_bf16 v[36:39], a[36:39], a[0:3], v[36:39]
ds_read_b128 a[24:27], v11 offset:61440
v_mfma_f32_16x16x32_bf16 v[60:63], a[36:39], a[4:7], v[60:63]
ds_read_b128 a[28:31], v11 offset:63488
v_mfma_f32_16x16x32_bf16 v[84:87], a[36:39], a[8:11], v[84:87]
ds_read_b64_tr_b16 a[60:61], v13 offset:12288
v_mfma_f32_16x16x32_bf16 v[108:111], a[36:39], a[12:15], v[108:111]
ds_read_b64_tr_b16 a[62:63], v13 offset:12800
v_mfma_f32_16x16x32_bf16 v[40:43], a[0:3], a[40:43], v[40:43]
ds_read_b64_tr_b16 a[64:65], v12 offset:14336
v_mfma_f32_16x16x32_bf16 v[64:67], a[4:7], a[40:43], v[64:67]
ds_read_b64_tr_b16 a[66:67], v12 offset:14848
v_mfma_f32_16x16x32_bf16 v[88:91], a[8:11], a[40:43], v[88:91]
ds_read_b64_tr_b16 a[68:69], v13 offset:14336
v_mfma_f32_16x16x32_bf16 v[112:115], a[12:15], a[40:43], v[112:115]
ds_read_b64_tr_b16 a[70:71], v13 offset:14848
v_mfma_f32_16x16x32_bf16 v[44:47], a[0:3], a[44:47], v[44:47]
ds_read_b64_tr_b16 a[72:73], v12 offset:16384
v_mfma_f32_16x16x32_bf16 v[68:71], a[4:7], a[44:47], v[68:71]
ds_read_b64_tr_b16 a[74:75], v12 offset:16896
v_mfma_f32_16x16x32_bf16 v[92:95], a[8:11], a[44:47], v[92:95]
ds_read_b64_tr_b16 a[76:77], v13 offset:16384
v_mfma_f32_16x16x32_bf16 v[116:119], a[12:15], a[44:47], v[116:119]
ds_read_b64_tr_b16 a[78:79], v13 offset:16896
v_mfma_f32_16x16x32_bf16 v[48:51], a[0:3], a[48:51], v[48:51]
v_mfma_f32_16x16x32_bf16 v[72:75], a[4:7], a[48:51], v[72:75]
v_mfma_f32_16x16x32_bf16 v[96:99], a[8:11], a[48:51], v[96:99]
v_mfma_f32_16x16x32_bf16 v[120:123], a[12:15], a[48:51], v[120:123]
v_mfma_f32_16x16x32_bf16 v[52:55], a[0:3], a[52:55], v[52:55]
v_mfma_f32_16x16x32_bf16 v[76:79], a[4:7], a[52:55], v[76:79]
v_mfma_f32_16x16x32_bf16 v[100:103], a[8:11], a[52:55], v[100:103]
v_mfma_f32_16x16x32_bf16 v[124:127], a[12:15], a[52:55], v[124:127]
s_waitcnt lgkmcnt(0)
v_mfma_f32_16x16x32_bf16 v[32:35], a[56:59], a[16:19], v[32:35]
s_barrier
ds_read_b128 a[0:3], v10 offset:40960
v_mfma_f32_16x16x32_bf16 v[56:59], a[56:59], a[20:23], v[56:59]
ds_read_b64_tr_b16 a[32:33], v14 offset:16384
v_mfma_f32_16x16x32_bf16 v[80:83], a[56:59], a[24:27], v[80:83]
ds_read_b64_tr_b16 a[34:35], v14 offset:16896
v_mfma_f32_16x16x32_bf16 v[104:107], a[56:59], a[28:31], v[104:107]
ds_read_b128 a[4:7], v10 offset:43008
v_mfma_f32_16x16x32_bf16 v[36:39], a[60:63], a[16:19], v[36:39]
ds_read_b128 a[8:11], v10 offset:45056
v_mfma_f32_16x16x32_bf16 v[60:63], a[60:63], a[20:23], v[60:63]
ds_read_b128 a[12:15], v10 offset:47104
v_mfma_f32_16x16x32_bf16 v[84:87], a[60:63], a[24:27], v[84:87]
ds_read_b64_tr_b16 a[36:37], v15 offset:16384
v_mfma_f32_16x16x32_bf16 v[108:111], a[60:63], a[28:31], v[108:111]
ds_read_b64_tr_b16 a[38:39], v15 offset:16896
v_mfma_f32_16x16x32_bf16 v[40:43], a[16:19], a[64:67], v[40:43]
ds_read_b64_tr_b16 a[40:41], v14 offset:18432
v_mfma_f32_16x16x32_bf16 v[64:67], a[20:23], a[64:67], v[64:67]
ds_read_b64_tr_b16 a[42:43], v14 offset:18944
v_mfma_f32_16x16x32_bf16 v[88:91], a[24:27], a[64:67], v[88:91]
ds_read_b64_tr_b16 a[44:45], v15 offset:18432
v_mfma_f32_16x16x32_bf16 v[112:115], a[28:31], a[64:67], v[112:115]
ds_read_b64_tr_b16 a[46:47], v15 offset:18944
v_mfma_f32_16x16x32_bf16 v[44:47], a[16:19], a[68:71], v[44:47]
ds_read_b64_tr_b16 a[48:49], v14 offset:20480
v_mfma_f32_16x16x32_bf16 v[68:71], a[20:23], a[68:71], v[68:71]
ds_read_b64_tr_b16 a[50:51], v14 offset:20992
v_mfma_f32_16x16x32_bf16 v[92:95], a[24:27], a[68:71], v[92:95]
ds_read_b64_tr_b16 a[52:53], v15 offset:20480
v_mfma_f32_16x16x32_bf16 v[116:119], a[28:31], a[68:71], v[116:119]
ds_read_b64_tr_b16 a[54:55], v15 offset:20992
v_mfma_f32_16x16x32_bf16 v[48:51], a[16:19], a[72:75], v[48:51]
v_mfma_f32_16x16x32_bf16 v[72:75], a[20:23], a[72:75], v[72:75]
v_mfma_f32_16x16x32_bf16 v[96:99], a[24:27], a[72:75], v[96:99]
v_mfma_f32_16x16x32_bf16 v[120:123], a[28:31], a[72:75], v[120:123]
v_mfma_f32_16x16x32_bf16 v[52:55], a[16:19], a[76:79], v[52:55]
v_mfma_f32_16x16x32_bf16 v[76:79], a[20:23], a[76:79], v[76:79]
v_mfma_f32_16x16x32_bf16 v[100:103], a[24:27], a[76:79], v[100:103]
v_mfma_f32_16x16x32_bf16 v[124:127], a[28:31], a[76:79], v[124:127]
s_waitcnt lgkmcnt(0)
v_mfma_f32_16x16x32_bf16 v[32:35], a[32:35], a[0:3], v[32:35]
ds_read_b128 a[16:19], v11 offset:40960
v_mfma_f32_16x16x32_bf16 v[56:59], a[32:35], a[4:7], v[56:59]
ds_read_b64_tr_b16 a[56:57], v14 offset:28672
v_mfma_f32_16x16x32_bf16 v[80:83], a[32:35], a[8:11], v[80:83]
ds_read_b64_tr_b16 a[58:59], v14 offset:29184
v_mfma_f32_16x16x32_bf16 v[104:107], a[32:35], a[12:15], v[104:107]
ds_read_b128 a[20:23], v11 offset:43008
v_mfma_f32_16x16x32_bf16 v[36:39], a[36:39], a[0:3], v[36:39]
ds_read_b128 a[24:27], v11 offset:45056
v_mfma_f32_16x16x32_bf16 v[60:63], a[36:39], a[4:7], v[60:63]
ds_read_b128 a[28:31], v11 offset:47104
v_mfma_f32_16x16x32_bf16 v[84:87], a[36:39], a[8:11], v[84:87]
ds_read_b64_tr_b16 a[60:61], v15 offset:28672
v_mfma_f32_16x16x32_bf16 v[108:111], a[36:39], a[12:15], v[108:111]
ds_read_b64_tr_b16 a[62:63], v15 offset:29184
v_mfma_f32_16x16x32_bf16 v[40:43], a[0:3], a[40:43], v[40:43]
ds_read_b64_tr_b16 a[64:65], v14 offset:30720
v_mfma_f32_16x16x32_bf16 v[64:67], a[4:7], a[40:43], v[64:67]
ds_read_b64_tr_b16 a[66:67], v14 offset:31232
v_mfma_f32_16x16x32_bf16 v[88:91], a[8:11], a[40:43], v[88:91]
ds_read_b64_tr_b16 a[68:69], v15 offset:30720
v_mfma_f32_16x16x32_bf16 v[112:115], a[12:15], a[40:43], v[112:115]
ds_read_b64_tr_b16 a[70:71], v15 offset:31232
v_mfma_f32_16x16x32_bf16 v[44:47], a[0:3], a[44:47], v[44:47]
ds_read_b64_tr_b16 a[72:73], v14 offset:32768
v_mfma_f32_16x16x32_bf16 v[68:71], a[4:7], a[44:47], v[68:71]
ds_read_b64_tr_b16 a[74:75], v14 offset:33280
v_mfma_f32_16x16x32_bf16 v[92:95], a[8:11], a[44:47], v[92:95]
ds_read_b64_tr_b16 a[76:77], v15 offset:32768
v_mfma_f32_16x16x32_bf16 v[116:119], a[12:15], a[44:47], v[116:119]
ds_read_b64_tr_b16 a[78:79], v15 offset:33280
v_mfma_f32_16x16x32_bf16 v[48:51], a[0:3], a[48:51], v[48:51]
v_mfma_f32_16x16x32_bf16 v[72:75], a[4:7], a[48:51], v[72:75]
v_mfma_f32_16x16x32_bf16 v[96:99], a[8:11], a[48:51], v[96:99]
v_mfma_f32_16x16x32_bf16 v[120:123], a[12:15], a[48:51], v[120:123]
v_mfma_f32_16x16x32_bf16 v[52:55], a[0:3], a[52:55], v[52:55]
v_mfma_f32_16x16x32_bf16 v[76:79], a[4:7], a[52:55], v[76:79]
v_mfma_f32_16x16x32_bf16 v[100:103], a[8:11], a[52:55], v[100:103]
v_mfma_f32_16x16x32_bf16 v[124:127], a[12:15], a[52:55], v[124:127]
s_waitcnt lgkmcnt(0)
v_mfma_f32_16x16x32_bf16 v[32:35], a[56:59], a[16:19], v[32:35]
s_barrier
ds_read_b128 a[0:3], v10 offset:0
v_mfma_f32_16x16x32_bf16 v[56:59], a[56:59], a[20:23], v[56:59]
ds_read_b64_tr_b16 a[32:33], v12 offset:40960
v_mfma_f32_16x16x32_bf16 v[80:83], a[56:59], a[24:27], v[80:83]
ds_read_b64_tr_b16 a[34:35], v12 offset:41472
v_mfma_f32_16x16x32_bf16 v[104:107], a[56:59], a[28:31], v[104:107]
ds_read_b128 a[4:7], v10 offset:2048
v_mfma_f32_16x16x32_bf16 v[36:39], a[60:63], a[16:19], v[36:39]
ds_read_b128 a[8:11], v10 offset:4096
v_mfma_f32_16x16x32_bf16 v[60:63], a[60:63], a[20:23], v[60:63]
ds_read_b128 a[12:15], v10 offset:6144
v_mfma_f32_16x16x32_bf16 v[84:87], a[60:63], a[24:27], v[84:87]
ds_read_b64_tr_b16 a[36:37], v13 offset:40960
v_mfma_f32_16x16x32_bf16 v[108:111], a[60:63], a[28:31], v[108:111]
ds_read_b64_tr_b16 a[38:39], v13 offset:41472
v_mfma_f32_16x16x32_bf16 v[40:43], a[16:19], a[64:67], v[40:43]
ds_read_b64_tr_b16 a[40:41], v12 offset:43008
v_mfma_f32_16x16x32_bf16 v[64:67], a[20:23], a[64:67], v[64:67]
ds_read_b64_tr_b16 a[42:43], v12 offset:43520
v_mfma_f32_16x16x32_bf16 v[88:91], a[24:27], a[64:67], v[88:91]
ds_read_b64_tr_b16 a[44:45], v13 offset:43008
v_mfma_f32_16x16x32_bf16 v[112:115], a[28:31], a[64:67], v[112:115]
ds_read_b64_tr_b16 a[46:47], v13 offset:43520
v_mfma_f32_16x16x32_bf16 v[44:47], a[16:19], a[68:71], v[44:47]
ds_read_b64_tr_b16 a[48:49], v12 offset:45056
v_mfma_f32_16x16x32_bf16 v[68:71], a[20:23], a[68:71], v[68:71]
ds_read_b64_tr_b16 a[50:51], v12 offset:45568
v_mfma_f32_16x16x32_bf16 v[92:95], a[24:27], a[68:71], v[92:95]
ds_read_b64_tr_b16 a[52:53], v13 offset:45056
v_mfma_f32_16x16x32_bf16 v[116:119], a[28:31], a[68:71], v[116:119]
ds_read_b64_tr_b16 a[54:55], v13 offset:45568
v_mfma_f32_16x16x32_bf16 v[48:51], a[16:19], a[72:75], v[48:51]
v_mfma_f32_16x16x32_bf16 v[72:75], a[20:23], a[72:75], v[72:75]
v_mfma_f32_16x16x32_bf16 v[96:99], a[24:27], a[72:75], v[96:99]
v_mfma_f32_16x16x32_bf16 v[120:123], a[28:31], a[72:75], v[120:123]
v_mfma_f32_16x16x32_bf16 v[52:55], a[16:19], a[76:79], v[52:55]
v_mfma_f32_16x16x32_bf16 v[76:79], a[20:23], a[76:79], v[76:79]
v_mfma_f32_16x16x32_bf16 v[100:103], a[24:27], a[76:79], v[100:103]
v_mfma_f32_16x16x32_bf16 v[124:127], a[28:31], a[76:79], v[124:127]
s_waitcnt lgkmcnt(0)
v_mfma_f32_16x16x32_bf16 v[32:35], a[32:35], a[0:3], v[32:35]
ds_read_b128 a[16:19], v11 offset:0
v_mfma_f32_16x16x32_bf16 v[56:59], a[32:35], a[4:7], v[56:59]
ds_read_b64_tr_b16 a[56:57], v12 offset:53248
v_mfma_f32_16x16x32_bf16 v[80:83], a[32:35], a[8:11], v[80:83]
ds_read_b64_tr_b16 a[58:59], v12 offset:53760
v_mfma_f32_16x16x32_bf16 v[104:107], a[32:35], a[12:15], v[104:107]
ds_read_b128 a[20:23], v11 offset:2048
v_mfma_f32_16x16x32_bf16 v[36:39], a[36:39], a[0:3], v[36:39]
ds_read_b128 a[24:27], v11 offset:4096
v_mfma_f32_16x16x32_bf16 v[60:63], a[36:39], a[4:7], v[60:63]
ds_read_b128 a[28:31], v11 offset:6144
v_mfma_f32_16x16x32_bf16 v[84:87], a[36:39], a[8:11], v[84:87]
ds_read_b64_tr_b16 a[60:61], v13 offset:53248
v_mfma_f32_16x16x32_bf16 v[108:111], a[36:39], a[12:15], v[108:111]
ds_read_b64_tr_b16 a[62:63], v13 offset:53760
v_mfma_f32_16x16x32_bf16 v[40:43], a[0:3], a[40:43], v[40:43]
ds_read_b64_tr_b16 a[64:65], v12 offset:55296
v_mfma_f32_16x16x32_bf16 v[64:67], a[4:7], a[40:43], v[64:67]
ds_read_b64_tr_b16 a[66:67], v12 offset:55808
v_mfma_f32_16x16x32_bf16 v[88:91], a[8:11], a[40:43], v[88:91]
ds_read_b64_tr_b16 a[68:69], v13 offset:55296
v_mfma_f32_16x16x32_bf16 v[112:115], a[12:15], a[40:43], v[112:115]
ds_read_b64_tr_b16 a[70:71], v13 offset:55808
v_mfma_f32_16x16x32_bf16 v[44:47], a[0:3], a[44:47], v[44:47]
ds_read_b64_tr_b16 a[72:73], v12 offset:57344
v_mfma_f32_16x16x32_bf16 v[68:71], a[4:7], a[44:47], v[68:71]
ds_read_b64_tr_b16 a[74:75], v12 offset:57856
v_mfma_f32_16x16x32_bf16 v[92:95], a[8:11], a[44:47], v[92:95]
ds_read_b64_tr_b16 a[76:77], v13 offset:57344
v_mfma_f32_16x16x32_bf16 v[116:119], a[12:15], a[44:47], v[116:119]
ds_read_b64_tr_b16 a[78:79], v13 offset:57856
v_mfma_f32_16x16x32_bf16 v[48:51], a[0:3], a[48:51], v[48:51]
v_lshrrev_b32 v2, 4, v1
v_lshlrev_b32 v2, 4, v2
s_lshl_b32 s70, s66, 8
s_add_u32 s70, s70, 159744
v_add_u32 v17, s70, v2
v_mfma_f32_16x16x32_bf16 v[72:75], a[4:7], a[48:51], v[72:75]
v_mfma_f32_16x16x32_bf16 v[96:99], a[8:11], a[48:51], v[96:99]
v_and_b32 v2, 15, v1
v_lshlrev_b32 v2, 2, v2
s_lshl_b32 s70, s67, 7
s_add_u32 s70, s70, 160768
v_add_u32 v18, s70, v2
v_mfma_f32_16x16x32_bf16 v[120:123], a[12:15], a[48:51], v[120:123]
v_mfma_f32_16x16x32_bf16 v[52:55], a[0:3], a[52:55], v[52:55]
v_mfma_f32_16x16x32_bf16 v[76:79], a[4:7], a[52:55], v[76:79]
v_mfma_f32_16x16x32_bf16 v[100:103], a[8:11], a[52:55], v[100:103]
v_mfma_f32_16x16x32_bf16 v[124:127], a[12:15], a[52:55], v[124:127]
s_waitcnt lgkmcnt(0)
v_mfma_f32_16x16x32_bf16 v[32:35], a[56:59], a[16:19], v[32:35]
s_barrier
ds_read_b128 a[0:3], v8 offset:24576
v_mfma_f32_16x16x32_bf16 v[56:59], a[56:59], a[20:23], v[56:59]
ds_read_b64_tr_b16 a[32:33], v12 offset:0
v_mfma_f32_16x16x32_bf16 v[80:83], a[56:59], a[24:27], v[80:83]
ds_read_b64_tr_b16 a[34:35], v12 offset:512
v_mfma_f32_16x16x32_bf16 v[104:107], a[56:59], a[28:31], v[104:107]
ds_read_b128 a[4:7], v8 offset:26624
v_mfma_f32_16x16x32_bf16 v[36:39], a[60:63], a[16:19], v[36:39]
ds_read_b128 a[8:11], v8 offset:28672
v_mfma_f32_16x16x32_bf16 v[60:63], a[60:63], a[20:23], v[60:63]
ds_read_b128 a[12:15], v8 offset:30720
v_mfma_f32_16x16x32_bf16 v[84:87], a[60:63], a[24:27], v[84:87]
ds_read_b64_tr_b16 a[36:37], v13 offset:0
v_mfma_f32_16x16x32_bf16 v[108:111], a[60:63], a[28:31], v[108:111]
ds_read_b64_tr_b16 a[38:39], v13 offset:512
v_mfma_f32_16x16x32_bf16 v[40:43], a[16:19], a[64:67], v[40:43]
ds_read_b64_tr_b16 a[40:41], v12 offset:2048
v_mfma_f32_16x16x32_bf16 v[64:67], a[20:23], a[64:67], v[64:67]
ds_read_b64_tr_b16 a[42:43], v12 offset:2560
v_mfma_f32_16x16x32_bf16 v[88:91], a[24:27], a[64:67], v[88:91]
ds_read_b64_tr_b16 a[44:45], v13 offset:2048
v_mfma_f32_16x16x32_bf16 v[112:115], a[28:31], a[64:67], v[112:115]
ds_read_b64_tr_b16 a[46:47], v13 offset:2560
v_mfma_f32_16x16x32_bf16 v[44:47], a[16:19], a[68:71], v[44:47]
ds_read_b64_tr_b16 a[48:49], v12 offset:4096
v_mfma_f32_16x16x32_bf16 v[68:71], a[20:23], a[68:71], v[68:71]
ds_read_b64_tr_b16 a[50:51], v12 offset:4608
v_mfma_f32_16x16x32_bf16 v[92:95], a[24:27], a[68:71], v[92:95]
ds_read_b64_tr_b16 a[52:53], v13 offset:4096
v_mfma_f32_16x16x32_bf16 v[116:119], a[28:31], a[68:71], v[116:119]
ds_read_b64_tr_b16 a[54:55], v13 offset:4608
v_mfma_f32_16x16x32_bf16 v[48:51], a[16:19], a[72:75], v[48:51]
v_mfma_f32_16x16x32_bf16 v[72:75], a[20:23], a[72:75], v[72:75]
v_mfma_f32_16x16x32_bf16 v[96:99], a[24:27], a[72:75], v[96:99]
v_mfma_f32_16x16x32_bf16 v[120:123], a[28:31], a[72:75], v[120:123]
v_mfma_f32_16x16x32_bf16 v[52:55], a[16:19], a[76:79], v[52:55]
v_mfma_f32_16x16x32_bf16 v[76:79], a[20:23], a[76:79], v[76:79]
v_mfma_f32_16x16x32_bf16 v[100:103], a[24:27], a[76:79], v[100:103]
v_mfma_f32_16x16x32_bf16 v[124:127], a[28:31], a[76:79], v[124:127]
s_waitcnt lgkmcnt(0)
v_mfma_f32_16x16x32_bf16 v[32:35], a[32:35], a[0:3], v[32:35]
ds_read_b128 a[16:19], v9 offset:24576
v_mfma_f32_16x16x32_bf16 v[56:59], a[32:35], a[4:7], v[56:59]
ds_read_b64_tr_b16 a[56:57], v12 offset:12288
v_mfma_f32_16x16x32_bf16 v[80:83], a[32:35], a[8:11], v[80:83]
ds_read_b64_tr_b16 a[58:59], v12 offset:12800
v_mfma_f32_16x16x32_bf16 v[104:107], a[32:35], a[12:15], v[104:107]
ds_read_b128 a[20:23], v9 offset:26624
v_mfma_f32_16x16x32_bf16 v[36:39], a[36:39], a[0:3], v[36:39]
ds_read_b128 a[24:27], v9 offset:28672
v_mfma_f32_16x16x32_bf16 v[60:63], a[36:39], a[4:7], v[60:63]
ds_read_b128 a[28:31], v9 offset:30720
v_mfma_f32_16x16x32_bf16 v[84:87], a[36:39], a[8:11], v[84:87]
ds_read_b64_tr_b16 a[60:61], v13 offset:12288
v_mfma_f32_16x16x32_bf16 v[108:111], a[36:39], a[12:15], v[108:111]
ds_read_b64_tr_b16 a[62:63], v13 offset:12800
v_mfma_f32_16x16x32_bf16 v[40:43], a[0:3], a[40:43], v[40:43]
ds_read_b64_tr_b16 a[64:65], v12 offset:14336
v_mfma_f32_16x16x32_bf16 v[64:67], a[4:7], a[40:43], v[64:67]
ds_read_b64_tr_b16 a[66:67], v12 offset:14848
v_mfma_f32_16x16x32_bf16 v[88:91], a[8:11], a[40:43], v[88:91]
ds_read_b64_tr_b16 a[68:69], v13 offset:14336
v_mfma_f32_16x16x32_bf16 v[112:115], a[12:15], a[40:43], v[112:115]
ds_read_b64_tr_b16 a[70:71], v13 offset:14848
v_mfma_f32_16x16x32_bf16 v[44:47], a[0:3], a[44:47], v[44:47]
ds_read_b64_tr_b16 a[72:73], v12 offset:16384
v_mfma_f32_16x16x32_bf16 v[68:71], a[4:7], a[44:47], v[68:71]
ds_read_b64_tr_b16 a[74:75], v12 offset:16896
v_mfma_f32_16x16x32_bf16 v[92:95], a[8:11], a[44:47], v[92:95]
ds_read_b64_tr_b16 a[76:77], v13 offset:16384
v_mfma_f32_16x16x32_bf16 v[116:119], a[12:15], a[44:47], v[116:119]
ds_read_b64_tr_b16 a[78:79], v13 offset:16896
v_mfma_f32_16x16x32_bf16 v[48:51], a[0:3], a[48:51], v[48:51]
v_mfma_f32_16x16x32_bf16 v[72:75], a[4:7], a[48:51], v[72:75]
v_mfma_f32_16x16x32_bf16 v[96:99], a[8:11], a[48:51], v[96:99]
v_mfma_f32_16x16x32_bf16 v[120:123], a[12:15], a[48:51], v[120:123]
v_mfma_f32_16x16x32_bf16 v[52:55], a[0:3], a[52:55], v[52:55]
v_mfma_f32_16x16x32_bf16 v[76:79], a[4:7], a[52:55], v[76:79]
v_mfma_f32_16x16x32_bf16 v[100:103], a[8:11], a[52:55], v[100:103]
v_mfma_f32_16x16x32_bf16 v[124:127], a[12:15], a[52:55], v[124:127]
s_waitcnt lgkmcnt(0)
v_mfma_f32_16x16x32_bf16 v[40:43], a[16:19], a[64:67], v[40:43]
s_barrier
ds_read_b128 v[20:23], v17 offset:0
v_mfma_f32_16x16x32_bf16 v[64:67], a[20:23], a[64:67], v[64:67]
ds_read_b128 v[24:27], v17 offset:512
v_mfma_f32_16x16x32_bf16 v[88:91], a[24:27], a[64:67], v[88:91]
ds_read_b32 v6, v18 offset:256
v_mfma_f32_16x16x32_bf16 v[112:115], a[28:31], a[64:67], v[112:115]
ds_read_b32 v8, v18 offset:320
v_mfma_f32_16x16x32_bf16 v[44:47], a[16:19], a[68:71], v[44:47]
ds_read_b32 v10, v18 offset:512
v_mfma_f32_16x16x32_bf16 v[68:71], a[20:23], a[68:71], v[68:71]
ds_read_b32 v18, v18 offset:576
v_mfma_f32_16x16x32_bf16 v[92:95], a[24:27], a[68:71], v[92:95]
v_mov_b32 v19, 161536
ds_read_b32 v19, v19
v_mfma_f32_16x16x32_bf16 v[116:119], a[28:31], a[68:71], v[116:119]
ds_read_b128 v[128:131], v17 offset:64
v_mfma_f32_16x16x32_bf16 v[48:51], a[16:19], a[72:75], v[48:51]
ds_read_b128 v[132:135], v17 offset:576
v_mfma_f32_16x16x32_bf16 v[72:75], a[20:23], a[72:75], v[72:75]
ds_read_b128 v[136:139], v17 offset:128
v_mfma_f32_16x16x32_bf16 v[96:99], a[24:27], a[72:75], v[96:99]
ds_read_b128 v[140:143], v17 offset:640
v_mfma_f32_16x16x32_bf16 v[120:123], a[28:31], a[72:75], v[120:123]
ds_read_b128 v[144:147], v17 offset:192
v_mfma_f32_16x16x32_bf16 v[52:55], a[16:19], a[76:79], v[52:55]
ds_read_b128 v[148:151], v17 offset:704
v_mfma_f32_16x16x32_bf16 v[76:79], a[20:23], a[76:79], v[76:79]
v_mfma_f32_16x16x32_bf16 v[100:103], a[24:27], a[76:79], v[100:103]
v_mfma_f32_16x16x32_bf16 v[124:127], a[28:31], a[76:79], v[124:127]
v_mfma_f32_16x16x32_bf16 v[32:35], a[56:59], a[16:19], v[32:35]
v_mfma_f32_16x16x32_bf16 v[56:59], a[56:59], a[20:23], v[56:59]
v_mfma_f32_16x16x32_bf16 v[80:83], a[56:59], a[24:27], v[80:83]
v_mfma_f32_16x16x32_bf16 v[104:107], a[56:59], a[28:31], v[104:107]
v_mfma_f32_16x16x32_bf16 v[36:39], a[60:63], a[16:19], v[36:39]
v_mfma_f32_16x16x32_bf16 v[60:63], a[60:63], a[20:23], v[60:63]
v_mfma_f32_16x16x32_bf16 v[84:87], a[60:63], a[24:27], v[84:87]
v_mfma_f32_16x16x32_bf16 v[108:111], a[60:63], a[28:31], v[108:111]
s_waitcnt lgkmcnt(0)
v_readfirstlane_b32 s69, v19
v_pk_mul_f32 v[28:29], v[24:25], s[90:91]
v_pk_mul_f32 v[30:31], v[26:27], s[90:91]
v_pk_fma_f32 v[40:41], v[20:21], v[6:7], v[40:41] op_sel:[0,0,0] op_sel_hi:[1,0,1]
v_pk_fma_f32 v[44:45], v[20:21], v[8:9], v[44:45] op_sel:[0,0,0] op_sel_hi:[1,0,1]
v_pk_fma_f32 v[42:43], v[22:23], v[6:7], v[42:43] op_sel:[0,0,0] op_sel_hi:[1,0,1]
v_pk_fma_f32 v[46:47], v[22:23], v[8:9], v[46:47] op_sel:[0,0,0] op_sel_hi:[1,0,1]
v_pk_mul_f32 v[2:3], v[40:41], v[28:29]
v_pk_mul_f32 v[12:13], v[44:45], v[28:29]
v_pk_mul_f32 v[4:5], v[42:43], v[30:31]
v_pk_mul_f32 v[14:15], v[46:47], v[30:31]
v_pk_fma_f32 v[40:41], v[40:41], v[24:25], s[82:83]
v_pk_fma_f32 v[44:45], v[44:45], v[24:25], s[82:83]
v_pk_fma_f32 v[42:43], v[42:43], v[26:27], s[82:83]
v_pk_fma_f32 v[46:47], v[46:47], v[26:27], s[82:83]
v_exp_f32_e64 v2, v2 clamp
v_exp_f32_e64 v12, v12 clamp
v_exp_f32_e64 v3, v3 clamp
v_exp_f32_e64 v13, v13 clamp
v_exp_f32_e64 v4, v4 clamp
v_exp_f32_e64 v14, v14 clamp
v_exp_f32_e64 v5, v5 clamp
v_exp_f32_e64 v15, v15 clamp
v_pk_add_f32 v[2:3], v[2:3], s[80:81]
v_pk_add_f32 v[12:13], v[12:13], s[80:81]
v_pk_add_f32 v[4:5], v[4:5], s[80:81]
v_pk_add_f32 v[14:15], v[14:15], s[80:81]
v_max_f32 v40, v40, v2
v_max_f32 v44, v44, v12
v_max_f32 v41, v41, v3
v_max_f32 v45, v45, v13
v_max_f32 v42, v42, v4
v_max_f32 v46, v46, v14
v_max_f32 v43, v43, v5
v_max_f32 v47, v47, v15
v_cvt_pk_bf16_f32 v40, v40, v41
v_cvt_pk_bf16_f32 v44, v44, v45
v_cvt_pk_bf16_f32 v41, v42, v43
v_cvt_pk_bf16_f32 v45, v46, v47
v_pk_fma_f32 v[48:49], v[20:21], v[10:11], v[48:49] op_sel:[0,0,0] op_sel_hi:[1,0,1]
v_pk_fma_f32 v[52:53], v[20:21], v[18:19], v[52:53] op_sel:[0,0,0] op_sel_hi:[1,0,1]
v_pk_fma_f32 v[50:51], v[22:23], v[10:11], v[50:51] op_sel:[0,0,0] op_sel_hi:[1,0,1]
v_pk_fma_f32 v[54:55], v[22:23], v[18:19], v[54:55] op_sel:[0,0,0] op_sel_hi:[1,0,1]
v_pk_mul_f32 v[48:49], v[48:49], v[24:25]
v_pk_mul_f32 v[52:53], v[52:53], v[24:25]
v_pk_mul_f32 v[50:51], v[50:51], v[26:27]
v_pk_mul_f32 v[54:55], v[54:55], v[26:27]
v_cvt_pk_bf16_f32 v48, v48, v49
v_cvt_pk_bf16_f32 v52, v52, v53
v_cvt_pk_bf16_f32 v49, v50, v51
v_cvt_pk_bf16_f32 v53, v54, v55
v_pk_mul_f32 v[28:29], v[132:133], s[90:91]
v_pk_mul_f32 v[30:31], v[134:135], s[90:91]
v_pk_fma_f32 v[64:65], v[128:129], v[6:7], v[64:65] op_sel:[0,0,0] op_sel_hi:[1,0,1]
v_pk_fma_f32 v[68:69], v[128:129], v[8:9], v[68:69] op_sel:[0,0,0] op_sel_hi:[1,0,1]
v_pk_fma_f32 v[66:67], v[130:131], v[6:7], v[66:67] op_sel:[0,0,0] op_sel_hi:[1,0,1]
v_pk_fma_f32 v[70:71], v[130:131], v[8:9], v[70:71] op_sel:[0,0,0] op_sel_hi:[1,0,1]
v_pk_mul_f32 v[2:3], v[64:65], v[28:29]
v_pk_mul_f32 v[12:13], v[68:69], v[28:29]
v_pk_mul_f32 v[4:5], v[66:67], v[30:31]
v_pk_mul_f32 v[14:15], v[70:71], v[30:31]
v_pk_fma_f32 v[64:65], v[64:65], v[132:133], s[82:83]
v_pk_fma_f32 v[68:69], v[68:69], v[132:133], s[82:83]
v_pk_fma_f32 v[66:67], v[66:67], v[134:135], s[82:83]
v_pk_fma_f32 v[70:71], v[70:71], v[134:135], s[82:83]
v_exp_f32_e64 v2, v2 clamp
v_exp_f32_e64 v12, v12 clamp
v_exp_f32_e64 v3, v3 clamp
v_exp_f32_e64 v13, v13 clamp
v_exp_f32_e64 v4, v4 clamp
v_exp_f32_e64 v14, v14 clamp
v_exp_f32_e64 v5, v5 clamp
v_exp_f32_e64 v15, v15 clamp
v_pk_add_f32 v[2:3], v[2:3], s[80:81]
v_pk_add_f32 v[12:13], v[12:13], s[80:81]
v_pk_add_f32 v[4:5], v[4:5], s[80:81]
v_pk_add_f32 v[14:15], v[14:15], s[80:81]
v_max_f32 v64, v64, v2
v_max_f32 v68, v68, v12
v_max_f32 v65, v65, v3
v_max_f32 v69, v69, v13
v_max_f32 v66, v66, v4
v_max_f32 v70, v70, v14
v_max_f32 v67, v67, v5
v_max_f32 v71, v71, v15
v_cvt_pk_bf16_f32 v42, v64, v65
v_cvt_pk_bf16_f32 v46, v68, v69
v_cvt_pk_bf16_f32 v43, v66, v67
v_cvt_pk_bf16_f32 v47, v70, v71
v_pk_fma_f32 v[72:73], v[128:129], v[10:11], v[72:73] op_sel:[0,0,0] op_sel_hi:[1,0,1]
v_pk_fma_f32 v[76:77], v[128:129], v[18:19], v[76:77] op_sel:[0,0,0] op_sel_hi:[1,0,1]
v_pk_fma_f32 v[74:75], v[130:131], v[10:11], v[74:75] op_sel:[0,0,0] op_sel_hi:[1,0,1]
v_pk_fma_f32 v[78:79], v[130:131], v[18:19], v[78:79] op_sel:[0,0,0] op_sel_hi:[1,0,1]
v_pk_mul_f32 v[72:73], v[72:73], v[132:133]
v_pk_mul_f32 v[76:77], v[76:77], v[132:133]
v_pk_mul_f32 v[74:75], v[74:75], v[134:135]
v_pk_mul_f32 v[78:79], v[78:79], v[134:135]
v_cvt_pk_bf16_f32 v50, v72, v73
v_cvt_pk_bf16_f32 v54, v76, v77
v_cvt_pk_bf16_f32 v51, v74, v75
v_cvt_pk_bf16_f32 v55, v78, v79
s_nop 0
v_mfma_f32_16x16x32_bf16 v[64:67], v[40:43], v[48:51], 0
v_mfma_f32_16x16x32_bf16 v[68:71], v[40:43], v[52:55], 0
v_mfma_f32_16x16x32_bf16 v[20:23], v[40:43], a[80:83], 0
v_mfma_f32_16x16x32_bf16 v[72:75], v[44:47], v[48:51], 0
v_mfma_f32_16x16x32_bf16 v[76:79], v[44:47], v[52:55], 0
v_mfma_f32_16x16x32_bf16 v[24:27], v[44:47], a[80:83], 0
v_pk_mul_f32 v[28:29], v[140:141], s[90:91]
s_branch L_over5
L_pad5:
s_branch L_ret9
L_over5:
v_pk_mul_f32 v[30:31], v[142:143], s[90:91]
v_pk_fma_f32 v[88:89], v[136:137], v[6:7], v[88:89] op_sel:[0,0,0] op_sel_hi:[1,0,1]
v_pk_fma_f32 v[92:93], v[136:137], v[8:9], v[92:93] op_sel:[0,0,0] op_sel_hi:[1,0,1]
v_pk_fma_f32 v[90:91], v[138:139], v[6:7], v[90:91] op_sel:[0,0,0] op_sel_hi:[1,0,1]
v_pk_fma_f32 v[94:95], v[138:139], v[8:9], v[94:95] op_sel:[0,0,0] op_sel_hi:[1,0,1]
v_pk_mul_f32 v[2:3], v[88:89], v[28:29]
v_pk_mul_f32 v[12:13], v[92:93], v[28:29]
v_pk_mul_f32 v[4:5], v[90:91], v[30:31]
v_pk_mul_f32 v[14:15], v[94:95], v[30:31]
v_pk_fma_f32 v[88:89], v[88:89], v[140:141], s[82:83]
v_pk_fma_f32 v[92:93], v[92:93], v[140:141], s[82:83]
v_pk_fma_f32 v[90:91], v[90:91], v[142:143], s[82:83]
v_pk_fma_f32 v[94:95], v[94:95], v[142:143], s[82:83]
v_exp_f32_e64 v2, v2 clamp
v_exp_f32_e64 v12, v12 clamp
v_exp_f32_e64 v3, v3 clamp
v_exp_f32_e64 v13, v13 clamp
v_exp_f32_e64 v4, v4 clamp
v_exp_f32_e64 v14, v14 clamp
v_exp_f32_e64 v5, v5 clamp
v_exp_f32_e64 v15, v15 clamp
v_pk_add_f32 v[2:3], v[2:3], s[80:81]
v_pk_add_f32 v[12:13], v[12:13], s[80:81]
v_pk_add_f32 v[4:5], v[4:5], s[80:81]
v_pk_add_f32 v[14:15], v[14:15], s[80:81]
v_max_f32 v88, v88, v2
v_max_f32 v92, v92, v12
v_max_f32 v89, v89, v3
v_max_f32 v93, v93, v13
v_max_f32 v90, v90, v4
v_max_f32 v94, v94, v14
v_max_f32 v91, v91, v5
v_max_f32 v95, v95, v15
v_cvt_pk_bf16_f32 v88, v88, v89
v_cvt_pk_bf16_f32 v92, v92, v93
v_cvt_pk_bf16_f32 v89, v90, v91
v_cvt_pk_bf16_f32 v93, v94, v95
v_pk_fma_f32 v[96:97], v[136:137], v[10:11], v[96:97] op_sel:[0,0,0] op_sel_hi:[1,0,1]
v_pk_fma_f32 v[100:101], v[136:137], v[18:19], v[100:101] op_sel:[0,0,0] op_sel_hi:[1,0,1]
v_pk_fma_f32 v[98:99], v[138:139], v[10:11], v[98:99] op_sel:[0,0,0] op_sel_hi:[1,0,1]
v_pk_fma_f32 v[102:103], v[138:139], v[18:19], v[102:103] op_sel:[0,0,0] op_sel_hi:[1,0,1]
v_pk_mul_f32 v[96:97], v[96:97], v[140:141]
v_pk_mul_f32 v[100:101], v[100:101], v[140:141]
v_pk_mul_f32 v[98:99], v[98:99], v[142:143]
v_pk_mul_f32 v[102:103], v[102:103], v[142:143]
v_cvt_pk_bf16_f32 v96, v96, v97
v_cvt_pk_bf16_f32 v100, v100, v101
v_cvt_pk_bf16_f32 v97, v98, v99
v_cvt_pk_bf16_f32 v101, v102, v103
v_pk_mul_f32 v[28:29], v[148:149], s[90:91]
v_pk_mul_f32 v[30:31], v[150:151], s[90:91]
v_pk_fma_f32 v[112:113], v[144:145], v[6:7], v[112:113] op_sel:[0,0,0] op_sel_hi:[1,0,1]
v_pk_fma_f32 v[116:117], v[144:145], v[8:9], v[116:117] op_sel:[0,0,0] op_sel_hi:[1,0,1]
v_pk_fma_f32 v[114:115], v[146:147], v[6:7], v[114:115] op_sel:[0,0,0] op_sel_hi:[1,0,1]
v_pk_fma_f32 v[118:119], v[146:147], v[8:9], v[118:119] op_sel:[0,0,0] op_sel_hi:[1,0,1]
v_pk_mul_f32 v[2:3], v[112:113], v[28:29]
v_pk_mul_f32 v[12:13], v[116:117], v[28:29]
v_pk_mul_f32 v[4:5], v[114:115], v[30:31]
v_pk_mul_f32 v[14:15], v[118:119], v[30:31]
v_pk_fma_f32 v[112:113], v[112:113], v[148:149], s[82:83]
v_pk_fma_f32 v[116:117], v[116:117], v[148:149], s[82:83]
v_pk_fma_f32 v[114:115], v[114:115], v[150:151], s[82:83]
v_pk_fma_f32 v[118:119], v[118:119], v[150:151], s[82:83]
v_exp_f32_e64 v2, v2 clamp
v_exp_f32_e64 v12, v12 clamp
v_exp_f32_e64 v3, v3 clamp
v_exp_f32_e64 v13, v13 clamp
v_exp_f32_e64 v4, v4 clamp
v_exp_f32_e64 v14, v14 clamp
v_exp_f32_e64 v5, v5 clamp
v_exp_f32_e64 v15, v15 clamp
v_pk_add_f32 v[2:3], v[2:3], s[80:81]
v_pk_add_f32 v[12:13], v[12:13], s[80:81]
v_pk_add_f32 v[4:5], v[4:5], s[80:81]
v_pk_add_f32 v[14:15], v[14:15], s[80:81]
v_max_f32 v112, v112, v2
v_max_f32 v116, v116, v12
v_max_f32 v113, v113, v3
v_max_f32 v117, v117, v13
v_max_f32 v114, v114, v4
v_max_f32 v118, v118, v14
v_max_f32 v115, v115, v5
v_max_f32 v119, v119, v15
v_cvt_pk_bf16_f32 v90, v112, v113
v_cvt_pk_bf16_f32 v94, v116, v117
v_cvt_pk_bf16_f32 v91, v114, v115
v_cvt_pk_bf16_f32 v95, v118, v119
v_pk_fma_f32 v[120:121], v[144:145], v[10:11], v[120:121] op_sel:[0,0,0] op_sel_hi:[1,0,1]
v_pk_fma_f32 v[124:125], v[144:145], v[18:19], v[124:125] op_sel:[0,0,0] op_sel_hi:[1,0,1]
v_pk_fma_f32 v[122:123], v[146:147], v[10:11], v[122:123] op_sel:[0,0,0] op_sel_hi:[1,0,1]
v_pk_fma_f32 v[126:127], v[146:147], v[18:19], v[126:127] op_sel:[0,0,0] op_sel_hi:[1,0,1]
v_pk_mul_f32 v[120:121], v[120:121], v[148:149]
v_pk_mul_f32 v[124:125], v[124:125], v[148:149]
v_pk_mul_f32 v[122:123], v[122:123], v[150:151]
v_pk_mul_f32 v[126:127], v[126:127], v[150:151]
v_cvt_pk_bf16_f32 v98, v120, v121
v_cvt_pk_bf16_f32 v102, v124, v125
v_cvt_pk_bf16_f32 v99, v122, v123
v_cvt_pk_bf16_f32 v103, v126, v127
s_nop 0
v_mfma_f32_16x16x32_bf16 v[64:67], v[88:91], v[96:99], v[64:67]
v_mfma_f32_16x16x32_bf16 v[68:71], v[88:91], v[100:103], v[68:71]
v_mfma_f32_16x16x32_bf16 v[20:23], v[88:91], a[80:83], v[20:23]
v_mfma_f32_16x16x32_bf16 v[72:75], v[92:95], v[96:99], v[72:75]
v_mfma_f32_16x16x32_bf16 v[76:79], v[92:95], v[100:103], v[76:79]
v_mfma_f32_16x16x32_bf16 v[24:27], v[92:95], a[80:83], v[24:27]
s_lshl_b32 s70, s60, 11
s_add_u32 s70, s70, 16384
v_add_u32 v2, s70, v16
v_xor_b32 v3, 4096, v2
v_lshrrev_b32 v4, 4, v1
v_lshlrev_b32 v5, 4, v4
v_lshlrev_b32 v4, 5, v4
s_lshl_b32 s70, s60, 6
s_add_u32 s70, s70, 163584
v_add_u32 v5, s70, v5
v_xor_b32 v6, 128, v5
s_lshl_b32 s72, s67, 1
s_add_u32 s72, s72, s66
s_lshl_b32 s72, s72, 10
s_add_u32 s72, s72, s87
s_lshl_b32 s73, s67, 7
s_lshl_b32 s70, s66, 4
s_add_u32 s73, s73, s70
s_add_u32 s73, s73, s87
s_add_u32 s73, s73, 4096
s_mov_b32 s92, 0x00010001
s_mov_b32 s93, 0x00010001
v_mov_b32 v15, s68
s_cmp_eq_u32 s66, 0
s_cbranch_scc0 L_ex1
ds_write_b128 v2, v[68:71]
ds_write_b128 v2, v[76:79] offset:1024
ds_write_b128 v5, v[24:27]
s_waitcnt lgkmcnt(0)
s_barrier
ds_read_b128 v[128:131], v3
ds_read_b128 v[132:135], v3 offset:1024
ds_read_b128 v[136:139], v6
s_waitcnt lgkmcnt(1)
v_pk_add_f32 v[128:129], v[128:129], v[64:65]
v_pk_add_f32 v[130:131], v[130:131], v[66:67]
v_pk_add_f32 v[132:133], v[132:133], v[72:73]
v_pk_add_f32 v[134:135], v[134:135], v[74:75]
s_waitcnt lgkmcnt(0)
v_pk_add_f32 v[136:137], v[136:137], v[20:21]
v_pk_add_f32 v[138:139], v[138:139], v[22:23]
s_branch L_ex_d
L_ex1:
ds_write_b128 v2, v[64:67]
ds_write_b128 v2, v[72:75] offset:1024
ds_write_b128 v5, v[20:23]
s_waitcnt lgkmcnt(0)
s_barrier
ds_read_b128 v[128:131], v3
ds_read_b128 v[132:135], v3 offset:1024
ds_read_b128 v[136:139], v6
s_waitcnt lgkmcnt(1)
v_pk_add_f32 v[128:129], v[128:129], v[68:69]
v_pk_add_f32 v[130:131], v[130:131], v[70:71]
v_pk_add_f32 v[132:133], v[132:133], v[76:77]
v_pk_add_f32 v[134:135], v[134:135], v[78:79]
s_waitcnt lgkmcnt(0)
v_pk_add_f32 v[136:137], v[136:137], v[24:25]
v_pk_add_f32 v[138:139], v[138:139], v[26:27]
L_ex_d:
v_cvt_pk_bf16_f32 v140, v128, v129
v_cvt_pk_bf16_f32 v141, v130, v131
v_cvt_pk_bf16_f32 v142, v132, v133
v_cvt_pk_bf16_f32 v143, v134, v135
v_bfi_b32 v136, s85, v15, v136
v_bfi_b32 v137, s85, v15, v137
v_bfi_b32 v138, s85, v15, v138
v_bfi_b32 v139, s85, v15, v139
s_cmp_eq_u32 s69, 0
s_cbranch_scc1 L_kvp_s
buffer_store_dwordx4 v[140:143], v16, s[12:15], s72 offen
s_mov_b64 exec, s[92:93]
buffer_store_dwordx4 v[136:139], v4, s[12:15], s73 offen
s_mov_b64 exec, -1
L_kvp_d:
s_barrier
v_and_b32 v2, 15, v1
v_lshlrev_b32 v2, 2, v2
s_lshl_b32 s70, s66, 8
s_add_u32 s70, s70, 159744
v_add_u32 v2, s70, v2
v_lshrrev_b32 v3, 4, v1
v_lshlrev_b32 v3, 4, v3
s_lshl_b32 s70, s67, 7
s_add_u32 s70, s70, 160768
v_add_u32 v5, s70, v3
ds_read_b32 v8, v2 offset:0
ds_read_b32 v128, v2 offset:512
ds_read_b32 v10, v2 offset:64
ds_read_b32 v130, v2 offset:576
ds_read_b32 v12, v2 offset:128
ds_read_b32 v132, v2 offset:640
ds_read_b32 v14, v2 offset:192
ds_read_b32 v134, v2 offset:704
ds_read_b128 v[144:147], v5 offset:0
ds_read_b128 v[148:151], v5 offset:64
s_lshl_b32 s70, s67, 11
s_add_u32 s70, s70, 24576
v_add_u32 v17, s70, v16
s_lshl_b32 s70, s67, 6
s_add_u32 s70, s70, 161600
v_add_u32 v18, s70, v3
s_waitcnt lgkmcnt(0)
v_mul_f32 v20, s90, v128
v_mul_f32 v22, s90, v130
v_mul_f32 v4, s90, v132
v_mul_f32 v6, s90, v134
v_pk_fma_f32 v[32:33], v[144:145], v[8:9], v[32:33] op_sel:[0,0,0] op_sel_hi:[1,0,1]
v_pk_fma_f32 v[36:37], v[148:149], v[8:9], v[36:37] op_sel:[0,0,0] op_sel_hi:[1,0,1]
v_pk_fma_f32 v[34:35], v[146:147], v[8:9], v[34:35] op_sel:[0,0,0] op_sel_hi:[1,0,1]
v_pk_fma_f32 v[38:39], v[150:151], v[8:9], v[38:39] op_sel:[0,0,0] op_sel_hi:[1,0,1]
v_pk_mul_f32 v[24:25], v[32:33], v[20:21] op_sel:[0,0] op_sel_hi:[1,0]
v_pk_mul_f32 v[28:29], v[36:37], v[20:21] op_sel:[0,0] op_sel_hi:[1,0]
v_pk_mul_f32 v[26:27], v[34:35], v[20:21] op_sel:[0,0] op_sel_hi:[1,0]
v_pk_mul_f32 v[30:31], v[38:39], v[20:21] op_sel:[0,0] op_sel_hi:[1,0]
v_pk_fma_f32 v[32:33], v[32:33], v[128:129], s[82:83] op_sel:[0,0,0] op_sel_hi:[1,0,1]
v_pk_fma_f32 v[36:37], v[36:37], v[128:129], s[82:83] op_sel:[0,0,0] op_sel_hi:[1,0,1]
v_pk_fma_f32 v[34:35], v[34:35], v[128:129], s[82:83] op_sel:[0,0,0] op_sel_hi:[1,0,1]
v_pk_fma_f32 v[38:39], v[38:39], v[128:129], s[82:83] op_sel:[0,0,0] op_sel_hi:[1,0,1]
v_exp_f32_e64 v24, v24 clamp
v_exp_f32_e64 v28, v28 clamp
v_exp_f32_e64 v25, v25 clamp
v_exp_f32_e64 v29, v29 clamp
v_exp_f32_e64 v26, v26 clamp
v_exp_f32_e64 v30, v30 clamp
v_exp_f32_e64 v27, v27 clamp
v_exp_f32_e64 v31, v31 clamp
v_pk_add_f32 v[24:25], v[24:25], s[80:81]
v_pk_add_f32 v[28:29], v[28:29], s[80:81]
v_pk_add_f32 v[26:27], v[26:27], s[80:81]
v_pk_add_f32 v[30:31], v[30:31], s[80:81]
v_max_f32 v32, v32, v24
v_max_f32 v36, v36, v28
v_max_f32 v33, v33, v25
v_max_f32 v37, v37, v29
v_max_f32 v34, v34, v26
v_max_f32 v38, v38, v30
v_max_f32 v35, v35, v27
v_max_f32 v39, v39, v31
v_cvt_pk_bf16_f32 v32, v32, v33
v_cvt_pk_bf16_f32 v33, v34, v35
v_cvt_pk_bf16_f32 v34, v36, v37
v_cvt_pk_bf16_f32 v35, v38, v39
v_pk_fma_f32 v[56:57], v[144:145], v[10:11], v[56:57] op_sel:[0,0,0] op_sel_hi:[1,0,1]
v_pk_fma_f32 v[60:61], v[148:149], v[10:11], v[60:61] op_sel:[0,0,0] op_sel_hi:[1,0,1]
v_pk_fma_f32 v[58:59], v[146:147], v[10:11], v[58:59] op_sel:[0,0,0] op_sel_hi:[1,0,1]
v_pk_fma_f32 v[62:63], v[150:151], v[10:11], v[62:63] op_sel:[0,0,0] op_sel_hi:[1,0,1]
v_pk_mul_f32 v[24:25], v[56:57], v[22:23] op_sel:[0,0] op_sel_hi:[1,0]
v_pk_mul_f32 v[28:29], v[60:61], v[22:23] op_sel:[0,0] op_sel_hi:[1,0]
v_pk_mul_f32 v[26:27], v[58:59], v[22:23] op_sel:[0,0] op_sel_hi:[1,0]
v_pk_mul_f32 v[30:31], v[62:63], v[22:23] op_sel:[0,0] op_sel_hi:[1,0]
v_pk_fma_f32 v[56:57], v[56:57], v[130:131], s[82:83] op_sel:[0,0,0] op_sel_hi:[1,0,1]
v_pk_fma_f32 v[60:61], v[60:61], v[130:131], s[82:83] op_sel:[0,0,0] op_sel_hi:[1,0,1]
v_pk_fma_f32 v[58:59], v[58:59], v[130:131], s[82:83] op_sel:[0,0,0] op_sel_hi:[1,0,1]
v_pk_fma_f32 v[62:63], v[62:63], v[130:131], s[82:83] op_sel:[0,0,0] op_sel_hi:[1,0,1]
v_exp_f32_e64 v24, v24 clamp
v_exp_f32_e64 v28, v28 clamp
v_exp_f32_e64 v25, v25 clamp
v_exp_f32_e64 v29, v29 clamp
v_exp_f32_e64 v26, v26 clamp
v_exp_f32_e64 v30, v30 clamp
v_exp_f32_e64 v27, v27 clamp
v_exp_f32_e64 v31, v31 clamp
v_pk_add_f32 v[24:25], v[24:25], s[80:81]
v_pk_add_f32 v[28:29], v[28:29], s[80:81]
v_pk_add_f32 v[26:27], v[26:27], s[80:81]
v_pk_add_f32 v[30:31], v[30:31], s[80:81]
v_max_f32 v56, v56, v24
v_max_f32 v60, v60, v28
v_max_f32 v57, v57, v25
v_max_f32 v61, v61, v29
v_max_f32 v58, v58, v26
v_max_f32 v62, v62, v30
v_max_f32 v59, v59, v27
v_max_f32 v63, v63, v31
v_cvt_pk_bf16_f32 v56, v56, v57
v_cvt_pk_bf16_f32 v57, v58, v59
v_cvt_pk_bf16_f32 v58, v60, v61
v_cvt_pk_bf16_f32 v59, v62, v63
v_pk_fma_f32 v[80:81], v[144:145], v[12:13], v[80:81] op_sel:[0,0,0] op_sel_hi:[1,0,1]
v_pk_fma_f32 v[84:85], v[148:149], v[12:13], v[84:85] op_sel:[0,0,0] op_sel_hi:[1,0,1]
v_pk_fma_f32 v[82:83], v[146:147], v[12:13], v[82:83] op_sel:[0,0,0] op_sel_hi:[1,0,1]
v_pk_fma_f32 v[86:87], v[150:151], v[12:13], v[86:87] op_sel:[0,0,0] op_sel_hi:[1,0,1]
v_pk_mul_f32 v[24:25], v[80:81], v[4:5] op_sel:[0,0] op_sel_hi:[1,0]
v_pk_mul_f32 v[28:29], v[84:85], v[4:5] op_sel:[0,0] op_sel_hi:[1,0]
v_pk_mul_f32 v[26:27], v[82:83], v[4:5] op_sel:[0,0] op_sel_hi:[1,0]
v_pk_mul_f32 v[30:31], v[86:87], v[4:5] op_sel:[0,0] op_sel_hi:[1,0]
v_pk_fma_f32 v[80:81], v[80:81], v[132:133], s[82:83] op_sel:[0,0,0] op_sel_hi:[1,0,1]
v_pk_fma_f32 v[84:85], v[84:85], v[132:133], s[82:83] op_sel:[0,0,0] op_sel_hi:[1,0,1]
v_pk_fma_f32 v[82:83], v[82:83], v[132:133], s[82:83] op_sel:[0,0,0] op_sel_hi:[1,0,1]
v_pk_fma_f32 v[86:87], v[86:87], v[132:133], s[82:83] op_sel:[0,0,0] op_sel_hi:[1,0,1]
v_exp_f32_e64 v24, v24 clamp
v_exp_f32_e64 v28, v28 clamp
v_exp_f32_e64 v25, v25 clamp
v_exp_f32_e64 v29, v29 clamp
v_exp_f32_e64 v26, v26 clamp
v_exp_f32_e64 v30, v30 clamp
v_exp_f32_e64 v27, v27 clamp
v_exp_f32_e64 v31, v31 clamp
v_pk_add_f32 v[24:25], v[24:25], s[80:81]
v_pk_add_f32 v[28:29], v[28:29], s[80:81]
v_pk_add_f32 v[26:27], v[26:27], s[80:81]
v_pk_add_f32 v[30:31], v[30:31], s[80:81]
v_max_f32 v80, v80, v24
v_max_f32 v84, v84, v28
v_max_f32 v81, v81, v25
v_max_f32 v85, v85, v29
v_max_f32 v82, v82, v26
v_max_f32 v86, v86, v30
v_max_f32 v83, v83, v27
v_max_f32 v87, v87, v31
v_cvt_pk_bf16_f32 v80, v80, v81
v_cvt_pk_bf16_f32 v81, v82, v83
v_cvt_pk_bf16_f32 v82, v84, v85
v_cvt_pk_bf16_f32 v83, v86, v87
v_pk_fma_f32 v[104:105], v[144:145], v[14:15], v[104:105] op_sel:[0,0,0] op_sel_hi:[1,0,1]
v_pk_fma_f32 v[108:109], v[148:149], v[14:15], v[108:109] op_sel:[0,0,0] op_sel_hi:[1,0,1]
v_pk_fma_f32 v[106:107], v[146:147], v[14:15], v[106:107] op_sel:[0,0,0] op_sel_hi:[1,0,1]
v_pk_fma_f32 v[110:111], v[150:151], v[14:15], v[110:111] op_sel:[0,0,0] op_sel_hi:[1,0,1]
v_pk_mul_f32 v[24:25], v[104:105], v[6:7] op_sel:[0,0] op_sel_hi:[1,0]
v_pk_mul_f32 v[28:29], v[108:109], v[6:7] op_sel:[0,0] op_sel_hi:[1,0]
v_pk_mul_f32 v[26:27], v[106:107], v[6:7] op_sel:[0,0] op_sel_hi:[1,0]
v_pk_mul_f32 v[30:31], v[110:111], v[6:7] op_sel:[0,0] op_sel_hi:[1,0]
v_pk_fma_f32 v[104:105], v[104:105], v[134:135], s[82:83] op_sel:[0,0,0] op_sel_hi:[1,0,1]
v_pk_fma_f32 v[108:109], v[108:109], v[134:135], s[82:83] op_sel:[0,0,0] op_sel_hi:[1,0,1]
v_pk_fma_f32 v[106:107], v[106:107], v[134:135], s[82:83] op_sel:[0,0,0] op_sel_hi:[1,0,1]
v_pk_fma_f32 v[110:111], v[110:111], v[134:135], s[82:83] op_sel:[0,0,0] op_sel_hi:[1,0,1]
v_exp_f32_e64 v24, v24 clamp
v_exp_f32_e64 v28, v28 clamp
v_exp_f32_e64 v25, v25 clamp
v_exp_f32_e64 v29, v29 clamp
v_exp_f32_e64 v26, v26 clamp
v_exp_f32_e64 v30, v30 clamp
v_exp_f32_e64 v27, v27 clamp
v_exp_f32_e64 v31, v31 clamp
v_pk_add_f32 v[24:25], v[24:25], s[80:81]
v_pk_add_f32 v[28:29], v[28:29], s[80:81]
v_pk_add_f32 v[26:27], v[26:27], s[80:81]
v_pk_add_f32 v[30:31], v[30:31], s[80:81]
v_max_f32 v104, v104, v24
v_max_f32 v108, v108, v28
v_max_f32 v105, v105, v25
v_max_f32 v109, v109, v29
v_max_f32 v106, v106, v26
v_max_f32 v110, v110, v30
v_max_f32 v107, v107, v27
v_max_f32 v111, v111, v31
v_cvt_pk_bf16_f32 v104, v104, v105
v_cvt_pk_bf16_f32 v105, v106, v107
v_cvt_pk_bf16_f32 v106, v108, v109
v_cvt_pk_bf16_f32 v107, v110, v111
v_lshrrev_b32 v2, 4, v1
v_bfe_u32 v3, v1, 2, 2
v_lshl_add_u32 v4, v2, 2, v3
v_lshlrev_b32 v5, 7, v4
v_bfe_u32 v4, v4, 1, 2
v_lshl_add_u32 v5, v4, 5, v5
v_and_b32 v4, 3, v1
v_lshl_add_u32 v5, v4, 3, v5
v_add_u32 v8, 28672, v5
v_xor_b32 v9, 32, v8
v_xor_b32 v10, 64, v8
v_xor_b32 v11, 96, v8
v_add_u32 v12, 65536, v8
v_add_u32 v13, 65536, v9
v_add_u32 v14, 65536, v10
v_add_u32 v15, 65536, v11
v_and_b32 v3, 15, v1
v_lshrrev_b32 v4, 1, v3
v_lshrrev_b32 v5, 1, v2
v_xor_b32 v4, v4, v5
v_lshlrev_b32 v4, 4, v4
v_lshl_add_u32 v4, v3, 7, v4
v_and_b32 v5, 1, v2
v_lshl_add_u32 v4, v5, 3, v4
s_lshl_b32 s70, s60, 12
v_add_u32 v20, s70, v4
v_xor_b32 v21, 32, v20
v_xor_b32 v22, 64, v20
v_xor_b32 v23, 96, v20
s_lshl_b32 s74, s64, 18
s_lshl_b32 s70, s60, 16
s_add_u32 s74, s74, s70
s_add_u32 s74, s74, 2097152
v_add_u32 v6, s74, v16
v_add_u32 v19, 32768, v6
s_lshl_b32 s74, s89, 11
s_barrier
ds_read_b128 a[0:3], v17
ds_read_b128 a[4:7], v17 offset:1024
ds_read_b128 a[8:11], v18
s_waitcnt lgkmcnt(0)
v_mfma_f32_16x16x32_bf16 v[48:51], a[8:11], v[32:35], 0
v_mfma_f32_16x16x32_bf16 v[40:43], a[0:3], v[32:35], 0
v_mfma_f32_16x16x32_bf16 v[44:47], a[4:7], v[32:35], 0
v_mfma_f32_16x16x32_bf16 v[72:75], a[8:11], v[56:59], 0
v_mfma_f32_16x16x32_bf16 v[64:67], a[0:3], v[56:59], 0
v_mfma_f32_16x16x32_bf16 v[68:71], a[4:7], v[56:59], 0
v_mfma_f32_16x16x32_bf16 v[96:99], a[8:11], v[80:83], 0
v_mfma_f32_16x16x32_bf16 v[88:91], a[0:3], v[80:83], 0
v_mfma_f32_16x16x32_bf16 v[92:95], a[4:7], v[80:83], 0
v_mfma_f32_16x16x32_bf16 v[120:123], a[8:11], v[104:107], 0
v_mfma_f32_16x16x32_bf16 v[112:115], a[0:3], v[104:107], 0
v_mfma_f32_16x16x32_bf16 v[116:119], a[4:7], v[104:107], 0
v_add_f32 v48, s80, v48
v_rcp_f32 v48, v48
s_nop 0
v_pk_mul_f32 v[40:41], v[40:41], v[48:49] op_sel_hi:[1,0]
v_pk_mul_f32 v[42:43], v[42:43], v[48:49] op_sel_hi:[1,0]
v_pk_mul_f32 v[44:45], v[44:45], v[48:49] op_sel_hi:[1,0]
v_pk_mul_f32 v[46:47], v[46:47], v[48:49] op_sel_hi:[1,0]
v_cvt_pk_bf16_f32 v52, v40, v41
v_cvt_pk_bf16_f32 v53, v42, v43
v_cvt_pk_bf16_f32 v54, v44, v45
v_cvt_pk_bf16_f32 v55, v46, v47
s_add_u32 s70, s88, 0
buffer_store_dwordx4 v[52:55], v16, s[12:15], s70 offen sc1
v_add_f32 v72, s80, v72
v_rcp_f32 v72, v72
s_nop 0
v_pk_mul_f32 v[64:65], v[64:65], v[72:73] op_sel_hi:[1,0]
v_pk_mul_f32 v[66:67], v[66:67], v[72:73] op_sel_hi:[1,0]
v_pk_mul_f32 v[68:69], v[68:69], v[72:73] op_sel_hi:[1,0]
v_pk_mul_f32 v[70:71], v[70:71], v[72:73] op_sel_hi:[1,0]
v_cvt_pk_bf16_f32 v76, v64, v65
v_cvt_pk_bf16_f32 v77, v66, v67
v_cvt_pk_bf16_f32 v78, v68, v69
v_cvt_pk_bf16_f32 v79, v70, v71
s_add_u32 s70, s88, 32768
buffer_store_dwordx4 v[76:79], v16, s[12:15], s70 offen sc1
v_add_f32 v96, s80, v96
v_rcp_f32 v96, v96
s_nop 0
v_pk_mul_f32 v[88:89], v[88:89], v[96:97] op_sel_hi:[1,0]
v_pk_mul_f32 v[90:91], v[90:91], v[96:97] op_sel_hi:[1,0]
v_pk_mul_f32 v[92:93], v[92:93], v[96:97] op_sel_hi:[1,0]
v_pk_mul_f32 v[94:95], v[94:95], v[96:97] op_sel_hi:[1,0]
v_cvt_pk_bf16_f32 v100, v88, v89
v_cvt_pk_bf16_f32 v101, v90, v91
v_cvt_pk_bf16_f32 v102, v92, v93
v_cvt_pk_bf16_f32 v103, v94, v95
s_add_u32 s70, s88, 65536
buffer_store_dwordx4 v[100:103], v16, s[12:15], s70 offen sc1
v_add_f32 v120, s80, v120
v_rcp_f32 v120, v120
s_nop 0
v_pk_mul_f32 v[112:113], v[112:113], v[120:121] op_sel_hi:[1,0]
v_pk_mul_f32 v[114:115], v[114:115], v[120:121] op_sel_hi:[1,0]
v_pk_mul_f32 v[116:117], v[116:117], v[120:121] op_sel_hi:[1,0]
v_pk_mul_f32 v[118:119], v[118:119], v[120:121] op_sel_hi:[1,0]
v_cvt_pk_bf16_f32 v124, v112, v113
v_cvt_pk_bf16_f32 v125, v114, v115
v_cvt_pk_bf16_f32 v126, v116, v117
v_cvt_pk_bf16_f32 v127, v118, v119
s_add_u32 s70, s88, 98304
buffer_store_dwordx4 v[124:127], v16, s[12:15], s70 offen sc1
v_xor_b32 v7, s76, v7
ds_read_b64 v[26:27], v20 offset:0
ds_read_b64 v[30:31], v21 offset:0
ds_read_b64 v[34:35], v22 offset:0
ds_read_b64 v[38:39], v23 offset:0
ds_read_b64 v[42:43], v20 offset:2048
ds_read_b64 v[46:47], v21 offset:2048
ds_read_b64 v[50:51], v22 offset:2048
ds_read_b64 v[54:55], v23 offset:2048
s_waitcnt lgkmcnt(0)
ds_read_b64_tr_b16 a[0:1], v8 offset:0
ds_read_b64_tr_b16 a[2:3], v8 offset:2048
ds_read_b64_tr_b16 a[4:5], v9 offset:0
ds_read_b64_tr_b16 a[6:7], v9 offset:2048
ds_read_b64_tr_b16 a[8:9], v10 offset:0
ds_read_b64_tr_b16 a[10:11], v10 offset:2048
ds_read_b64_tr_b16 a[12:13], v11 offset:0
ds_read_b64_tr_b16 a[14:15], v11 offset:2048
ds_read_b64_tr_b16 a[16:17], v8 offset:4096
ds_read_b64_tr_b16 a[18:19], v8 offset:6144
ds_read_b64_tr_b16 a[20:21], v9 offset:4096
ds_read_b64_tr_b16 a[22:23], v9 offset:6144
ds_read_b64_tr_b16 a[24:25], v10 offset:4096
ds_read_b64_tr_b16 a[26:27], v10 offset:6144
ds_read_b64_tr_b16 a[28:29], v11 offset:4096
ds_read_b64_tr_b16 a[30:31], v11 offset:6144
v_lshlrev_b32 v24, 16, v26
v_and_b32 v25, 0xffff0000, v26
v_lshlrev_b32 v26, 16, v27
v_and_b32 v27, 0xffff0000, v27
v_lshlrev_b32 v28, 16, v30
v_and_b32 v29, 0xffff0000, v30
v_lshlrev_b32 v30, 16, v31
v_and_b32 v31, 0xffff0000, v31
v_lshlrev_b32 v32, 16, v34
v_and_b32 v33, 0xffff0000, v34
v_lshlrev_b32 v34, 16, v35
v_and_b32 v35, 0xffff0000, v35
v_lshlrev_b32 v36, 16, v38
v_and_b32 v37, 0xffff0000, v38
v_lshlrev_b32 v38, 16, v39
v_and_b32 v39, 0xffff0000, v39
v_lshlrev_b32 v40, 16, v42
v_and_b32 v41, 0xffff0000, v42
v_lshlrev_b32 v42, 16, v43
v_and_b32 v43, 0xffff0000, v43
v_lshlrev_b32 v44, 16, v46
v_and_b32 v45, 0xffff0000, v46
v_lshlrev_b32 v46, 16, v47
v_and_b32 v47, 0xffff0000, v47
v_lshlrev_b32 v48, 16, v50
v_and_b32 v49, 0xffff0000, v50
v_lshlrev_b32 v50, 16, v51
v_and_b32 v51, 0xffff0000, v51
v_lshlrev_b32 v52, 16, v54
v_and_b32 v53, 0xffff0000, v54
v_lshlrev_b32 v54, 16, v55
v_and_b32 v55, 0xffff0000, v55
v_lshrrev_b32 v2, 4, v1
v_lshlrev_b32 v2, 3, v2
v_add_u32 v2, 162048, v2
v_mov_b32 v3, 162176
ds_read_b64 v[136:137], v2 offset:0
ds_read_b64 v[138:139], v2 offset:32
ds_read_b64 v[140:141], v2 offset:64
ds_read_b64 v[142:143], v2 offset:96
ds_read_b128 v[148:151], v3
s_waitcnt lgkmcnt(0)
v_add_f32 v148, v148, v149
v_add_f32 v150, v150, v151
v_add_f32 v148, v148, v150
s_nop 0
v_readfirstlane_b32 s84, v148
v_and_b32 v2, 3, v1
v_cmp_eq_u32 vcc, 0, v2
v_mov_b32 v3, 0x3f803f80
s_nop 0
v_cndmask_b32 v3, 0, v3, vcc
v_cmp_eq_u32 vcc, 2, v2
s_nop 1
v_cndmask_b32 v120, v3, v136, vcc
v_cndmask_b32 v121, v3, v137, vcc
v_cndmask_b32 v122, v3, v138, vcc
v_cndmask_b32 v123, v3, v139, vcc
v_cndmask_b32 v124, v3, v140, vcc
v_cndmask_b32 v125, v3, v141, vcc
v_cndmask_b32 v126, v3, v142, vcc
v_cndmask_b32 v127, v3, v143, vcc
v_and_b32 v2, 15, v1
v_lshrrev_b32 v3, 5, v1
v_lshlrev_b32 v4, 4, v2
v_mov_b32 v144, v4
s_lshl_b32 s75, s64, 15
s_lshl_b32 s70, s60, 9
s_add_u32 s75, s75, s70
s_add_u32 s75, s75, 6291456
s_lshl_b32 s70, s65, 11
s_add_u32 s72, s75, s70
s_mov_b32 s92, 0x00f0000f
s_mov_b32 s93, 0xf0000f00
s_mov_b32 s80, 0x22222222
s_mov_b32 s81, 0x22222222
s_mov_b32 s82, 0x44444444
s_mov_b32 s83, 0x44444444
s_mov_b32 s90, 0x88888888
s_mov_b32 s91, 0x88888888
v_and_b32 v2, 31, v1
v_lshlrev_b32 v5, 4, v2
v_lshl_add_u32 v145, v3, 11, v5
s_lshl_b32 s70, s64, 7
s_lshl_b32 s71, s60, 5
s_add_u32 s70, s70, s71
s_add_u32 s87, s70, 6815744
s_sub_u32 s70, 2047, s70
v_sub_u32 v146, s70, v2
s_lshl_b32 s70, s64, 2
s_add_u32 s70, s70, s60
s_lshl_b32 s70, s70, 12
s_lshl_b32 s71, s65, 7
s_add_u32 s70, s70, s71
s_add_u32 s88, s70, 7864320
v_lshrrev_b32 v2, 3, v1
v_and_b32 v3, 7, v1
v_lshlrev_b32 v147, 11, v2
v_lshl_add_u32 v147, v3, 4, v147
s_waitcnt vmcnt(0)
buffer_load_dwordx4 v[56:59], v6, s[12:15], s74 offen offset:0 sc1
buffer_load_dwordx4 v[60:63], v19, s[12:15], s74 offen offset:0 sc1
buffer_load_dwordx4 v[64:67], v6, s[12:15], s74 offen offset:1024 sc1
buffer_load_dwordx4 v[68:71], v19, s[12:15], s74 offen offset:1024 sc1
s_add_u32 s74, s74, 2048
s_and_b32 s74, s74, 0x7fff
buffer_load_dwordx4 v[72:75], v6, s[12:15], s74 offen offset:0 sc1
buffer_load_dwordx4 v[76:79], v19, s[12:15], s74 offen offset:0 sc1
buffer_load_dwordx4 v[80:83], v6, s[12:15], s74 offen offset:1024 sc1
buffer_load_dwordx4 v[84:87], v19, s[12:15], s74 offen offset:1024 sc1
s_add_u32 s74, s74, 2048
s_and_b32 s74, s74, 0x7fff
buffer_load_dwordx4 v[88:91], v6, s[12:15], s74 offen offset:0 sc1
buffer_load_dwordx4 v[92:95], v19, s[12:15], s74 offen offset:0 sc1
buffer_load_dwordx4 v[96:99], v6, s[12:15], s74 offen offset:1024 sc1
buffer_load_dwordx4 v[100:103], v19, s[12:15], s74 offen offset:1024 sc1
s_add_u32 s74, s74, 2048
s_and_b32 s74, s74, 0x7fff
s_waitcnt vmcnt(8)
L_o0_chk:
v_max3_u32 v2, v56, v60, v64
v_max_u32 v2, v2, v68
v_cmp_eq_u32 vcc, -1, v2
s_cbranch_vccnz L_o0_rt
L_o0_ok:
s_waitcnt lgkmcnt(8)
v_mfma_f32_16x16x32_bf16 v[24:27], a[0:3], v[56:59], v[24:27]
ds_read_b64_tr_b16 a[32:33], v8 offset:8192
buffer_load_dwordx4 v[104:107], v6, s[12:15], s74 offen offset:0 sc1
s_branch L_over6
L_pad6:
s_branch L_pad11
L_over6:
v_mfma_f32_16x16x32_bf16 v[40:43], a[0:3], v[60:63], v[40:43]
ds_read_b64_tr_b16 a[34:35], v8 offset:10240
buffer_load_dwordx4 v[108:111], v19, s[12:15], s74 offen offset:0 sc1
v_mfma_f32_16x16x32_bf16 v[28:31], a[4:7], v[56:59], v[28:31]
ds_read_b64_tr_b16 a[36:37], v9 offset:8192
v_mfma_f32_16x16x32_bf16 v[44:47], a[4:7], v[60:63], v[44:47]
ds_read_b64_tr_b16 a[38:39], v9 offset:10240
buffer_load_dwordx4 v[112:115], v6, s[12:15], s74 offen offset:1024 sc1
v_mfma_f32_16x16x32_bf16 v[32:35], a[8:11], v[56:59], v[32:35]
ds_read_b64_tr_b16 a[40:41], v10 offset:8192
buffer_load_dwordx4 v[116:119], v19, s[12:15], s74 offen offset:1024 sc1
v_mfma_f32_16x16x32_bf16 v[48:51], a[8:11], v[60:63], v[48:51]
ds_read_b64_tr_b16 a[42:43], v10 offset:10240
v_mfma_f32_16x16x32_bf16 v[36:39], a[12:15], v[56:59], v[36:39]
ds_read_b64_tr_b16 a[44:45], v11 offset:8192
s_add_u32 s74, s74, 2048
v_mfma_f32_16x16x32_bf16 v[52:55], a[12:15], v[60:63], v[52:55]
ds_read_b64_tr_b16 a[46:47], v11 offset:10240
s_waitcnt lgkmcnt(8)
v_mfma_f32_16x16x32_bf16 v[24:27], a[16:19], v[64:67], v[24:27]
ds_read_b64_tr_b16 a[0:1], v8 offset:12288
s_and_b32 s74, s74, 0x7fff
v_mfma_f32_16x16x32_bf16 v[40:43], a[16:19], v[68:71], v[40:43]
ds_read_b64_tr_b16 a[2:3], v8 offset:14336
s_waitcnt vmcnt(8)
v_mfma_f32_16x16x32_bf16 v[28:31], a[20:23], v[64:67], v[28:31]
ds_read_b64_tr_b16 a[4:5], v9 offset:12288
v_mfma_f32_16x16x32_bf16 v[44:47], a[20:23], v[68:71], v[44:47]
ds_read_b64_tr_b16 a[6:7], v9 offset:14336
v_max3_u32 v2, v72, v76, v80
v_mfma_f32_16x16x32_bf16 v[32:35], a[24:27], v[64:67], v[32:35]
ds_read_b64_tr_b16 a[8:9], v10 offset:12288
v_max_u32 v2, v2, v84
v_mfma_f32_16x16x32_bf16 v[48:51], a[24:27], v[68:71], v[48:51]
ds_read_b64_tr_b16 a[10:11], v10 offset:14336
v_mfma_f32_16x16x32_bf16 v[36:39], a[28:31], v[64:67], v[36:39]
ds_read_b64_tr_b16 a[12:13], v11 offset:12288
v_cmp_eq_u32 vcc, -1, v2
v_mfma_f32_16x16x32_bf16 v[52:55], a[28:31], v[68:71], v[52:55]
ds_read_b64_tr_b16 a[14:15], v11 offset:14336
s_cbranch_vccnz L_o1_rt
L_o1_ok:
s_waitcnt lgkmcnt(8)
v_mfma_f32_16x16x32_bf16 v[24:27], a[32:35], v[72:75], v[24:27]
ds_read_b64_tr_b16 a[16:17], v8 offset:16384
buffer_load_dwordx4 v[56:59], v6, s[12:15], s74 offen offset:0 sc1
v_mfma_f32_16x16x32_bf16 v[40:43], a[32:35], v[76:79], v[40:43]
ds_read_b64_tr_b16 a[18:19], v8 offset:18432
buffer_load_dwordx4 v[60:63], v19, s[12:15], s74 offen offset:0 sc1
v_mfma_f32_16x16x32_bf16 v[28:31], a[36:39], v[72:75], v[28:31]
ds_read_b64_tr_b16 a[20:21], v9 offset:16384
v_mfma_f32_16x16x32_bf16 v[44:47], a[36:39], v[76:79], v[44:47]
ds_read_b64_tr_b16 a[22:23], v9 offset:18432
buffer_load_dwordx4 v[64:67], v6, s[12:15], s74 offen offset:1024 sc1
v_mfma_f32_16x16x32_bf16 v[32:35], a[40:43], v[72:75], v[32:35]
ds_read_b64_tr_b16 a[24:25], v10 offset:16384
buffer_load_dwordx4 v[68:71], v19, s[12:15], s74 offen offset:1024 sc1
v_mfma_f32_16x16x32_bf16 v[48:51], a[40:43], v[76:79], v[48:51]
ds_read_b64_tr_b16 a[26:27], v10 offset:18432
v_mfma_f32_16x16x32_bf16 v[36:39], a[44:47], v[72:75], v[36:39]
ds_read_b64_tr_b16 a[28:29], v11 offset:16384
s_add_u32 s74, s74, 2048
v_mfma_f32_16x16x32_bf16 v[52:55], a[44:47], v[76:79], v[52:55]
ds_read_b64_tr_b16 a[30:31], v11 offset:18432
s_waitcnt lgkmcnt(8)
v_mfma_f32_16x16x32_bf16 v[24:27], a[0:3], v[80:83], v[24:27]
ds_read_b64_tr_b16 a[32:33], v8 offset:20480
s_and_b32 s74, s74, 0x7fff
v_mfma_f32_16x16x32_bf16 v[40:43], a[0:3], v[84:87], v[40:43]
ds_read_b64_tr_b16 a[34:35], v8 offset:22528
s_waitcnt vmcnt(8)
v_mfma_f32_16x16x32_bf16 v[28:31], a[4:7], v[80:83], v[28:31]
ds_read_b64_tr_b16 a[36:37], v9 offset:20480
v_mfma_f32_16x16x32_bf16 v[44:47], a[4:7], v[84:87], v[44:47]
ds_read_b64_tr_b16 a[38:39], v9 offset:22528
v_max3_u32 v2, v88, v92, v96
v_mfma_f32_16x16x32_bf16 v[32:35], a[8:11], v[80:83], v[32:35]
ds_read_b64_tr_b16 a[40:41], v10 offset:20480
v_max_u32 v2, v2, v100
v_mfma_f32_16x16x32_bf16 v[48:51], a[8:11], v[84:87], v[48:51]
ds_read_b64_tr_b16 a[42:43], v10 offset:22528
v_mfma_f32_16x16x32_bf16 v[36:39], a[12:15], v[80:83], v[36:39]
ds_read_b64_tr_b16 a[44:45], v11 offset:20480
v_cmp_eq_u32 vcc, -1, v2
v_mfma_f32_16x16x32_bf16 v[52:55], a[12:15], v[84:87], v[52:55]
ds_read_b64_tr_b16 a[46:47], v11 offset:22528
s_cbranch_vccnz L_o2_rt
L_o2_ok:
s_waitcnt lgkmcnt(8)
v_mfma_f32_16x16x32_bf16 v[24:27], a[16:19], v[88:91], v[24:27]
ds_read_b64_tr_b16 a[0:1], v8 offset:24576
buffer_load_dwordx4 v[72:75], v6, s[12:15], s74 offen offset:0 sc1
v_mfma_f32_16x16x32_bf16 v[40:43], a[16:19], v[92:95], v[40:43]
ds_read_b64_tr_b16 a[2:3], v8 offset:26624
buffer_load_dwordx4 v[76:79], v19, s[12:15], s74 offen offset:0 sc1
v_mfma_f32_16x16x32_bf16 v[28:31], a[20:23], v[88:91], v[28:31]
ds_read_b64_tr_b16 a[4:5], v9 offset:24576
v_mfma_f32_16x16x32_bf16 v[44:47], a[20:23], v[92:95], v[44:47]
ds_read_b64_tr_b16 a[6:7], v9 offset:26624
buffer_load_dwordx4 v[80:83], v6, s[12:15], s74 offen offset:1024 sc1
v_mfma_f32_16x16x32_bf16 v[32:35], a[24:27], v[88:91], v[32:35]
ds_read_b64_tr_b16 a[8:9], v10 offset:24576
buffer_load_dwordx4 v[84:87], v19, s[12:15], s74 offen offset:1024 sc1
v_mfma_f32_16x16x32_bf16 v[48:51], a[24:27], v[92:95], v[48:51]
ds_read_b64_tr_b16 a[10:11], v10 offset:26624
v_mfma_f32_16x16x32_bf16 v[36:39], a[28:31], v[88:91], v[36:39]
ds_read_b64_tr_b16 a[12:13], v11 offset:24576
s_add_u32 s74, s74, 2048
v_mfma_f32_16x16x32_bf16 v[52:55], a[28:31], v[92:95], v[52:55]
ds_read_b64_tr_b16 a[14:15], v11 offset:26624
s_waitcnt lgkmcnt(8)
v_mfma_f32_16x16x32_bf16 v[24:27], a[32:35], v[96:99], v[24:27]
ds_read_b64_tr_b16 a[16:17], v8 offset:28672
s_and_b32 s74, s74, 0x7fff
v_mfma_f32_16x16x32_bf16 v[40:43], a[32:35], v[100:103], v[40:43]
ds_read_b64_tr_b16 a[18:19], v8 offset:30720
s_waitcnt vmcnt(8)
v_mfma_f32_16x16x32_bf16 v[28:31], a[36:39], v[96:99], v[28:31]
ds_read_b64_tr_b16 a[20:21], v9 offset:28672
v_mfma_f32_16x16x32_bf16 v[44:47], a[36:39], v[100:103], v[44:47]
ds_read_b64_tr_b16 a[22:23], v9 offset:30720
v_max3_u32 v2, v104, v108, v112
v_mfma_f32_16x16x32_bf16 v[32:35], a[40:43], v[96:99], v[32:35]
ds_read_b64_tr_b16 a[24:25], v10 offset:28672
v_max_u32 v2, v2, v116
v_mfma_f32_16x16x32_bf16 v[48:51], a[40:43], v[100:103], v[48:51]
ds_read_b64_tr_b16 a[26:27], v10 offset:30720
v_mfma_f32_16x16x32_bf16 v[36:39], a[44:47], v[96:99], v[36:39]
ds_read_b64_tr_b16 a[28:29], v11 offset:28672
v_cmp_eq_u32 vcc, -1, v2
v_mfma_f32_16x16x32_bf16 v[52:55], a[44:47], v[100:103], v[52:55]
ds_read_b64_tr_b16 a[30:31], v11 offset:30720
s_cbranch_vccnz L_o3_rt
L_o3_ok:
s_waitcnt lgkmcnt(8)
v_mfma_f32_16x16x32_bf16 v[24:27], a[0:3], v[104:107], v[24:27]
ds_read_b64_tr_b16 a[32:33], v8 offset:32768
buffer_load_dwordx4 v[88:91], v6, s[12:15], s74 offen offset:0 sc1
v_mfma_f32_16x16x32_bf16 v[40:43], a[0:3], v[108:111], v[40:43]
ds_read_b64_tr_b16 a[34:35], v8 offset:34816
buffer_load_dwordx4 v[92:95], v19, s[12:15], s74 offen offset:0 sc1
v_mfma_f32_16x16x32_bf16 v[28:31], a[4:7], v[104:107], v[28:31]
ds_read_b64_tr_b16 a[36:37], v9 offset:32768
v_mfma_f32_16x16x32_bf16 v[44:47], a[4:7], v[108:111], v[44:47]
ds_read_b64_tr_b16 a[38:39], v9 offset:34816
buffer_load_dwordx4 v[96:99], v6, s[12:15], s74 offen offset:1024 sc1
v_mfma_f32_16x16x32_bf16 v[32:35], a[8:11], v[104:107], v[32:35]
ds_read_b64_tr_b16 a[40:41], v10 offset:32768
buffer_load_dwordx4 v[100:103], v19, s[12:15], s74 offen offset:1024 sc1
v_mfma_f32_16x16x32_bf16 v[48:51], a[8:11], v[108:111], v[48:51]
ds_read_b64_tr_b16 a[42:43], v10 offset:34816
v_mfma_f32_16x16x32_bf16 v[36:39], a[12:15], v[104:107], v[36:39]
ds_read_b64_tr_b16 a[44:45], v11 offset:32768
s_add_u32 s74, s74, 2048
v_mfma_f32_16x16x32_bf16 v[52:55], a[12:15], v[108:111], v[52:55]
ds_read_b64_tr_b16 a[46:47], v11 offset:34816
s_waitcnt lgkmcnt(8)
v_mfma_f32_16x16x32_bf16 v[24:27], a[16:19], v[112:115], v[24:27]
ds_read_b64_tr_b16 a[0:1], v8 offset:36864
s_and_b32 s74, s74, 0x7fff
v_mfma_f32_16x16x32_bf16 v[40:43], a[16:19], v[116:119], v[40:43]
ds_read_b64_tr_b16 a[2:3], v8 offset:38912
s_waitcnt vmcnt(8)
v_mfma_f32_16x16x32_bf16 v[28:31], a[20:23], v[112:115], v[28:31]
ds_read_b64_tr_b16 a[4:5], v9 offset:36864
v_mfma_f32_16x16x32_bf16 v[44:47], a[20:23], v[116:119], v[44:47]
ds_read_b64_tr_b16 a[6:7], v9 offset:38912
v_max3_u32 v2, v56, v60, v64
v_mfma_f32_16x16x32_bf16 v[32:35], a[24:27], v[112:115], v[32:35]
ds_read_b64_tr_b16 a[8:9], v10 offset:36864
v_max_u32 v2, v2, v68
v_mfma_f32_16x16x32_bf16 v[48:51], a[24:27], v[116:119], v[48:51]
ds_read_b64_tr_b16 a[10:11], v10 offset:38912
v_mfma_f32_16x16x32_bf16 v[36:39], a[28:31], v[112:115], v[36:39]
ds_read_b64_tr_b16 a[12:13], v11 offset:36864
v_cmp_eq_u32 vcc, -1, v2
v_mfma_f32_16x16x32_bf16 v[52:55], a[28:31], v[116:119], v[52:55]
ds_read_b64_tr_b16 a[14:15], v11 offset:38912
s_cbranch_vccnz L_o4_rt
L_o4_ok:
s_waitcnt lgkmcnt(8)
v_mfma_f32_16x16x32_bf16 v[24:27], a[32:35], v[56:59], v[24:27]
ds_read_b64_tr_b16 a[16:17], v8 offset:40960
buffer_load_dwordx4 v[104:107], v6, s[12:15], s74 offen offset:0 sc1
v_mfma_f32_16x16x32_bf16 v[40:43], a[32:35], v[60:63], v[40:43]
ds_read_b64_tr_b16 a[18:19], v8 offset:43008
buffer_load_dwordx4 v[108:111], v19, s[12:15], s74 offen offset:0 sc1
v_mfma_f32_16x16x32_bf16 v[28:31], a[36:39], v[56:59], v[28:31]
ds_read_b64_tr_b16 a[20:21], v9 offset:40960
v_mfma_f32_16x16x32_bf16 v[44:47], a[36:39], v[60:63], v[44:47]
ds_read_b64_tr_b16 a[22:23], v9 offset:43008
buffer_load_dwordx4 v[112:115], v6, s[12:15], s74 offen offset:1024 sc1
v_mfma_f32_16x16x32_bf16 v[32:35], a[40:43], v[56:59], v[32:35]
ds_read_b64_tr_b16 a[24:25], v10 offset:40960
buffer_load_dwordx4 v[116:119], v19, s[12:15], s74 offen offset:1024 sc1
v_mfma_f32_16x16x32_bf16 v[48:51], a[40:43], v[60:63], v[48:51]
ds_read_b64_tr_b16 a[26:27], v10 offset:43008
v_mfma_f32_16x16x32_bf16 v[36:39], a[44:47], v[56:59], v[36:39]
ds_read_b64_tr_b16 a[28:29], v11 offset:40960
s_add_u32 s74, s74, 2048
v_mfma_f32_16x16x32_bf16 v[52:55], a[44:47], v[60:63], v[52:55]
ds_read_b64_tr_b16 a[30:31], v11 offset:43008
s_waitcnt lgkmcnt(8)
v_mfma_f32_16x16x32_bf16 v[24:27], a[0:3], v[64:67], v[24:27]
ds_read_b64_tr_b16 a[32:33], v8 offset:45056
s_and_b32 s74, s74, 0x7fff
v_mfma_f32_16x16x32_bf16 v[40:43], a[0:3], v[68:71], v[40:43]
ds_read_b64_tr_b16 a[34:35], v8 offset:47104
s_waitcnt vmcnt(8)
v_mfma_f32_16x16x32_bf16 v[28:31], a[4:7], v[64:67], v[28:31]
ds_read_b64_tr_b16 a[36:37], v9 offset:45056
v_mfma_f32_16x16x32_bf16 v[44:47], a[4:7], v[68:71], v[44:47]
ds_read_b64_tr_b16 a[38:39], v9 offset:47104
v_max3_u32 v2, v72, v76, v80
v_mfma_f32_16x16x32_bf16 v[32:35], a[8:11], v[64:67], v[32:35]
ds_read_b64_tr_b16 a[40:41], v10 offset:45056
v_max_u32 v2, v2, v84
v_mfma_f32_16x16x32_bf16 v[48:51], a[8:11], v[68:71], v[48:51]
ds_read_b64_tr_b16 a[42:43], v10 offset:47104
v_mfma_f32_16x16x32_bf16 v[36:39], a[12:15], v[64:67], v[36:39]
ds_read_b64_tr_b16 a[44:45], v11 offset:45056
v_cmp_eq_u32 vcc, -1, v2
v_mfma_f32_16x16x32_bf16 v[52:55], a[12:15], v[68:71], v[52:55]
ds_read_b64_tr_b16 a[46:47], v11 offset:47104
s_cbranch_vccnz L_o5_rt
L_o5_ok:
s_waitcnt lgkmcnt(8)
v_mfma_f32_16x16x32_bf16 v[24:27], a[16:19], v[72:75], v[24:27]
ds_read_b64_tr_b16 a[0:1], v8 offset:49152
buffer_load_dwordx4 v[56:59], v6, s[12:15], s74 offen offset:0 sc1
v_mfma_f32_16x16x32_bf16 v[40:43], a[16:19], v[76:79], v[40:43]
ds_read_b64_tr_b16 a[2:3], v8 offset:51200
buffer_load_dwordx4 v[60:63], v19, s[12:15], s74 offen offset:0 sc1
v_mfma_f32_16x16x32_bf16 v[28:31], a[20:23], v[72:75], v[28:31]
ds_read_b64_tr_b16 a[4:5], v9 offset:49152
v_mfma_f32_16x16x32_bf16 v[44:47], a[20:23], v[76:79], v[44:47]
ds_read_b64_tr_b16 a[6:7], v9 offset:51200
buffer_load_dwordx4 v[64:67], v6, s[12:15], s74 offen offset:1024 sc1
v_mfma_f32_16x16x32_bf16 v[32:35], a[24:27], v[72:75], v[32:35]
ds_read_b64_tr_b16 a[8:9], v10 offset:49152
buffer_load_dwordx4 v[68:71], v19, s[12:15], s74 offen offset:1024 sc1
v_mfma_f32_16x16x32_bf16 v[48:51], a[24:27], v[76:79], v[48:51]
ds_read_b64_tr_b16 a[10:11], v10 offset:51200
v_mfma_f32_16x16x32_bf16 v[36:39], a[28:31], v[72:75], v[36:39]
ds_read_b64_tr_b16 a[12:13], v11 offset:49152
s_add_u32 s74, s74, 2048
v_mfma_f32_16x16x32_bf16 v[52:55], a[28:31], v[76:79], v[52:55]
ds_read_b64_tr_b16 a[14:15], v11 offset:51200
s_waitcnt lgkmcnt(8)
v_mfma_f32_16x16x32_bf16 v[24:27], a[32:35], v[80:83], v[24:27]
ds_read_b64_tr_b16 a[16:17], v8 offset:53248
s_and_b32 s74, s74, 0x7fff
v_mfma_f32_16x16x32_bf16 v[40:43], a[32:35], v[84:87], v[40:43]
ds_read_b64_tr_b16 a[18:19], v8 offset:55296
s_waitcnt vmcnt(8)
v_mfma_f32_16x16x32_bf16 v[28:31], a[36:39], v[80:83], v[28:31]
ds_read_b64_tr_b16 a[20:21], v9 offset:53248
v_mfma_f32_16x16x32_bf16 v[44:47], a[36:39], v[84:87], v[44:47]
ds_read_b64_tr_b16 a[22:23], v9 offset:55296
v_max3_u32 v2, v88, v92, v96
v_mfma_f32_16x16x32_bf16 v[32:35], a[40:43], v[80:83], v[32:35]
ds_read_b64_tr_b16 a[24:25], v10 offset:53248
v_max_u32 v2, v2, v100
v_mfma_f32_16x16x32_bf16 v[48:51], a[40:43], v[84:87], v[48:51]
ds_read_b64_tr_b16 a[26:27], v10 offset:55296
v_mfma_f32_16x16x32_bf16 v[36:39], a[44:47], v[80:83], v[36:39]
ds_read_b64_tr_b16 a[28:29], v11 offset:53248
v_cmp_eq_u32 vcc, -1, v2
v_mfma_f32_16x16x32_bf16 v[52:55], a[44:47], v[84:87], v[52:55]
ds_read_b64_tr_b16 a[30:31], v11 offset:55296
s_cbranch_vccnz L_o6_rt
L_o6_ok:
s_waitcnt lgkmcnt(8)
v_mfma_f32_16x16x32_bf16 v[24:27], a[0:3], v[88:91], v[24:27]
ds_read_b64_tr_b16 a[32:33], v8 offset:57344
buffer_load_dwordx4 v[72:75], v6, s[12:15], s74 offen offset:0 sc1
v_mfma_f32_16x16x32_bf16 v[40:43], a[0:3], v[92:95], v[40:43]
ds_read_b64_tr_b16 a[34:35], v8 offset:59392
buffer_load_dwordx4 v[76:79], v19, s[12:15], s74 offen offset:0 sc1
v_mfma_f32_16x16x32_bf16 v[28:31], a[4:7], v[88:91], v[28:31]
ds_read_b64_tr_b16 a[36:37], v9 offset:57344
v_mfma_f32_16x16x32_bf16 v[44:47], a[4:7], v[92:95], v[44:47]
ds_read_b64_tr_b16 a[38:39], v9 offset:59392
buffer_load_dwordx4 v[80:83], v6, s[12:15], s74 offen offset:1024 sc1
v_mfma_f32_16x16x32_bf16 v[32:35], a[8:11], v[88:91], v[32:35]
ds_read_b64_tr_b16 a[40:41], v10 offset:57344
buffer_load_dwordx4 v[84:87], v19, s[12:15], s74 offen offset:1024 sc1
v_mfma_f32_16x16x32_bf16 v[48:51], a[8:11], v[92:95], v[48:51]
ds_read_b64_tr_b16 a[42:43], v10 offset:59392
v_mfma_f32_16x16x32_bf16 v[36:39], a[12:15], v[88:91], v[36:39]
ds_read_b64_tr_b16 a[44:45], v11 offset:57344
s_add_u32 s74, s74, 2048
v_mfma_f32_16x16x32_bf16 v[52:55], a[12:15], v[92:95], v[52:55]
ds_read_b64_tr_b16 a[46:47], v11 offset:59392
s_waitcnt lgkmcnt(8)
v_mfma_f32_16x16x32_bf16 v[24:27], a[16:19], v[96:99], v[24:27]
ds_read_b64_tr_b16 a[0:1], v8 offset:61440
s_and_b32 s74, s74, 0x7fff
v_mfma_f32_16x16x32_bf16 v[40:43], a[16:19], v[100:103], v[40:43]
ds_read_b64_tr_b16 a[2:3], v8 offset:63488
s_waitcnt vmcnt(8)
v_mfma_f32_16x16x32_bf16 v[28:31], a[20:23], v[96:99], v[28:31]
ds_read_b64_tr_b16 a[4:5], v9 offset:61440
v_mfma_f32_16x16x32_bf16 v[44:47], a[20:23], v[100:103], v[44:47]
ds_read_b64_tr_b16 a[6:7], v9 offset:63488
v_max3_u32 v2, v104, v108, v112
v_mfma_f32_16x16x32_bf16 v[32:35], a[24:27], v[96:99], v[32:35]
ds_read_b64_tr_b16 a[8:9], v10 offset:61440
v_max_u32 v2, v2, v116
v_mfma_f32_16x16x32_bf16 v[48:51], a[24:27], v[100:103], v[48:51]
ds_read_b64_tr_b16 a[10:11], v10 offset:63488
v_mfma_f32_16x16x32_bf16 v[36:39], a[28:31], v[96:99], v[36:39]
ds_read_b64_tr_b16 a[12:13], v11 offset:61440
v_cmp_eq_u32 vcc, -1, v2
v_mfma_f32_16x16x32_bf16 v[52:55], a[28:31], v[100:103], v[52:55]
ds_read_b64_tr_b16 a[14:15], v11 offset:63488
s_cbranch_vccnz L_o7_rt
L_o7_ok:
s_waitcnt lgkmcnt(8)
v_mfma_f32_16x16x32_bf16 v[24:27], a[32:35], v[104:107], v[24:27]
ds_read_b64_tr_b16 a[16:17], v12 offset:0
buffer_load_dwordx4 v[88:91], v6, s[12:15], s74 offen offset:0 sc1
v_mfma_f32_16x16x32_bf16 v[40:43], a[32:35], v[108:111], v[40:43]
ds_read_b64_tr_b16 a[18:19], v12 offset:2048
buffer_load_dwordx4 v[92:95], v19, s[12:15], s74 offen offset:0 sc1
v_mfma_f32_16x16x32_bf16 v[28:31], a[36:39], v[104:107], v[28:31]
ds_read_b64_tr_b16 a[20:21], v13 offset:0
v_mfma_f32_16x16x32_bf16 v[44:47], a[36:39], v[108:111], v[44:47]
ds_read_b64_tr_b16 a[22:23], v13 offset:2048
buffer_load_dwordx4 v[96:99], v6, s[12:15], s74 offen offset:1024 sc1
v_mfma_f32_16x16x32_bf16 v[32:35], a[40:43], v[104:107], v[32:35]
ds_read_b64_tr_b16 a[24:25], v14 offset:0
buffer_load_dwordx4 v[100:103], v19, s[12:15], s74 offen offset:1024 sc1
v_mfma_f32_16x16x32_bf16 v[48:51], a[40:43], v[108:111], v[48:51]
ds_read_b64_tr_b16 a[26:27], v14 offset:2048
v_mfma_f32_16x16x32_bf16 v[36:39], a[44:47], v[104:107], v[36:39]
ds_read_b64_tr_b16 a[28:29], v15 offset:0
s_add_u32 s74, s74, 2048
v_mfma_f32_16x16x32_bf16 v[52:55], a[44:47], v[108:111], v[52:55]
ds_read_b64_tr_b16 a[30:31], v15 offset:2048
s_waitcnt lgkmcnt(8)
v_mfma_f32_16x16x32_bf16 v[24:27], a[0:3], v[112:115], v[24:27]
ds_read_b64_tr_b16 a[32:33], v12 offset:4096
s_and_b32 s74, s74, 0x7fff
v_mfma_f32_16x16x32_bf16 v[40:43], a[0:3], v[116:119], v[40:43]
ds_read_b64_tr_b16 a[34:35], v12 offset:6144
s_waitcnt vmcnt(8)
v_mfma_f32_16x16x32_bf16 v[28:31], a[4:7], v[112:115], v[28:31]
ds_read_b64_tr_b16 a[36:37], v13 offset:4096
v_mfma_f32_16x16x32_bf16 v[44:47], a[4:7], v[116:119], v[44:47]
ds_read_b64_tr_b16 a[38:39], v13 offset:6144
v_max3_u32 v2, v56, v60, v64
v_mfma_f32_16x16x32_bf16 v[32:35], a[8:11], v[112:115], v[32:35]
ds_read_b64_tr_b16 a[40:41], v14 offset:4096
v_max_u32 v2, v2, v68
v_mfma_f32_16x16x32_bf16 v[48:51], a[8:11], v[116:119], v[48:51]
ds_read_b64_tr_b16 a[42:43], v14 offset:6144
v_mfma_f32_16x16x32_bf16 v[36:39], a[12:15], v[112:115], v[36:39]
ds_read_b64_tr_b16 a[44:45], v15 offset:4096
v_cmp_eq_u32 vcc, -1, v2
v_mfma_f32_16x16x32_bf16 v[52:55], a[12:15], v[116:119], v[52:55]
ds_read_b64_tr_b16 a[46:47], v15 offset:6144
s_cbranch_vccnz L_o8_rt
L_o8_ok:
s_waitcnt lgkmcnt(8)
v_mfma_f32_16x16x32_bf16 v[24:27], a[16:19], v[56:59], v[24:27]
ds_read_b64_tr_b16 a[0:1], v12 offset:8192
buffer_load_dwordx4 v[104:107], v6, s[12:15], s74 offen offset:0 sc1
v_mfma_f32_16x16x32_bf16 v[40:43], a[16:19], v[60:63], v[40:43]
ds_read_b64_tr_b16 a[2:3], v12 offset:10240
buffer_load_dwordx4 v[108:111], v19, s[12:15], s74 offen offset:0 sc1
v_mfma_f32_16x16x32_bf16 v[28:31], a[20:23], v[56:59], v[28:31]
ds_read_b64_tr_b16 a[4:5], v13 offset:8192
v_mfma_f32_16x16x32_bf16 v[44:47], a[20:23], v[60:63], v[44:47]
ds_read_b64_tr_b16 a[6:7], v13 offset:10240
buffer_load_dwordx4 v[112:115], v6, s[12:15], s74 offen offset:1024 sc1
v_mfma_f32_16x16x32_bf16 v[32:35], a[24:27], v[56:59], v[32:35]
ds_read_b64_tr_b16 a[8:9], v14 offset:8192
buffer_load_dwordx4 v[116:119], v19, s[12:15], s74 offen offset:1024 sc1
v_mfma_f32_16x16x32_bf16 v[48:51], a[24:27], v[60:63], v[48:51]
ds_read_b64_tr_b16 a[10:11], v14 offset:10240
v_mfma_f32_16x16x32_bf16 v[36:39], a[28:31], v[56:59], v[36:39]
ds_read_b64_tr_b16 a[12:13], v15 offset:8192
s_add_u32 s74, s74, 2048
v_mfma_f32_16x16x32_bf16 v[52:55], a[28:31], v[60:63], v[52:55]
ds_read_b64_tr_b16 a[14:15], v15 offset:10240
s_waitcnt lgkmcnt(8)
v_mfma_f32_16x16x32_bf16 v[24:27], a[32:35], v[64:67], v[24:27]
ds_read_b64_tr_b16 a[16:17], v12 offset:12288
s_and_b32 s74, s74, 0x7fff
v_mfma_f32_16x16x32_bf16 v[40:43], a[32:35], v[68:71], v[40:43]
ds_read_b64_tr_b16 a[18:19], v12 offset:14336
s_waitcnt vmcnt(8)
v_mfma_f32_16x16x32_bf16 v[28:31], a[36:39], v[64:67], v[28:31]
ds_read_b64_tr_b16 a[20:21], v13 offset:12288
v_mfma_f32_16x16x32_bf16 v[44:47], a[36:39], v[68:71], v[44:47]
ds_read_b64_tr_b16 a[22:23], v13 offset:14336
v_max3_u32 v2, v72, v76, v80
v_mfma_f32_16x16x32_bf16 v[32:35], a[40:43], v[64:67], v[32:35]
ds_read_b64_tr_b16 a[24:25], v14 offset:12288
v_max_u32 v2, v2, v84
v_mfma_f32_16x16x32_bf16 v[48:51], a[40:43], v[68:71], v[48:51]
ds_read_b64_tr_b16 a[26:27], v14 offset:14336
v_mfma_f32_16x16x32_bf16 v[36:39], a[44:47], v[64:67], v[36:39]
ds_read_b64_tr_b16 a[28:29], v15 offset:12288
v_cmp_eq_u32 vcc, -1, v2
v_mfma_f32_16x16x32_bf16 v[52:55], a[44:47], v[68:71], v[52:55]
ds_read_b64_tr_b16 a[30:31], v15 offset:14336
s_cbranch_vccnz L_o9_rt
L_o9_ok:
s_waitcnt lgkmcnt(8)
v_mfma_f32_16x16x32_bf16 v[24:27], a[0:3], v[72:75], v[24:27]
ds_read_b64_tr_b16 a[32:33], v12 offset:16384
buffer_load_dwordx4 v[56:59], v6, s[12:15], s74 offen offset:0 sc1
v_mfma_f32_16x16x32_bf16 v[40:43], a[0:3], v[76:79], v[40:43]
ds_read_b64_tr_b16 a[34:35], v12 offset:18432
buffer_load_dwordx4 v[60:63], v19, s[12:15], s74 offen offset:0 sc1
v_mfma_f32_16x16x32_bf16 v[28:31], a[4:7], v[72:75], v[28:31]
ds_read_b64_tr_b16 a[36:37], v13 offset:16384
v_mfma_f32_16x16x32_bf16 v[44:47], a[4:7], v[76:79], v[44:47]
ds_read_b64_tr_b16 a[38:39], v13 offset:18432
buffer_load_dwordx4 v[64:67], v6, s[12:15], s74 offen offset:1024 sc1
v_mfma_f32_16x16x32_bf16 v[32:35], a[8:11], v[72:75], v[32:35]
ds_read_b64_tr_b16 a[40:41], v14 offset:16384
buffer_load_dwordx4 v[68:71], v19, s[12:15], s74 offen offset:1024 sc1
v_mfma_f32_16x16x32_bf16 v[48:51], a[8:11], v[76:79], v[48:51]
ds_read_b64_tr_b16 a[42:43], v14 offset:18432
v_mfma_f32_16x16x32_bf16 v[36:39], a[12:15], v[72:75], v[36:39]
ds_read_b64_tr_b16 a[44:45], v15 offset:16384
s_add_u32 s74, s74, 2048
v_mfma_f32_16x16x32_bf16 v[52:55], a[12:15], v[76:79], v[52:55]
ds_read_b64_tr_b16 a[46:47], v15 offset:18432
s_waitcnt lgkmcnt(8)
v_mfma_f32_16x16x32_bf16 v[24:27], a[16:19], v[80:83], v[24:27]
ds_read_b64_tr_b16 a[0:1], v12 offset:20480
s_and_b32 s74, s74, 0x7fff
v_mfma_f32_16x16x32_bf16 v[40:43], a[16:19], v[84:87], v[40:43]
ds_read_b64_tr_b16 a[2:3], v12 offset:22528
s_waitcnt vmcnt(8)
v_mfma_f32_16x16x32_bf16 v[28:31], a[20:23], v[80:83], v[28:31]
ds_read_b64_tr_b16 a[4:5], v13 offset:20480
v_mfma_f32_16x16x32_bf16 v[44:47], a[20:23], v[84:87], v[44:47]
ds_read_b64_tr_b16 a[6:7], v13 offset:22528
v_max3_u32 v2, v88, v92, v96
v_mfma_f32_16x16x32_bf16 v[32:35], a[24:27], v[80:83], v[32:35]
ds_read_b64_tr_b16 a[8:9], v14 offset:20480
v_max_u32 v2, v2, v100
v_mfma_f32_16x16x32_bf16 v[48:51], a[24:27], v[84:87], v[48:51]
ds_read_b64_tr_b16 a[10:11], v14 offset:22528
v_mfma_f32_16x16x32_bf16 v[36:39], a[28:31], v[80:83], v[36:39]
ds_read_b64_tr_b16 a[12:13], v15 offset:20480
v_cmp_eq_u32 vcc, -1, v2
v_mfma_f32_16x16x32_bf16 v[52:55], a[28:31], v[84:87], v[52:55]
ds_read_b64_tr_b16 a[14:15], v15 offset:22528
s_cbranch_vccnz L_o10_rt
L_o10_ok:
s_waitcnt lgkmcnt(8)
v_mfma_f32_16x16x32_bf16 v[24:27], a[32:35], v[88:91], v[24:27]
ds_read_b64_tr_b16 a[16:17], v12 offset:24576
buffer_load_dwordx4 v[72:75], v6, s[12:15], s74 offen offset:0 sc1
v_mfma_f32_16x16x32_bf16 v[40:43], a[32:35], v[92:95], v[40:43]
ds_read_b64_tr_b16 a[18:19], v12 offset:26624
buffer_load_dwordx4 v[76:79], v19, s[12:15], s74 offen offset:0 sc1
v_mfma_f32_16x16x32_bf16 v[28:31], a[36:39], v[88:91], v[28:31]
ds_read_b64_tr_b16 a[20:21], v13 offset:24576
v_mfma_f32_16x16x32_bf16 v[44:47], a[36:39], v[92:95], v[44:47]
ds_read_b64_tr_b16 a[22:23], v13 offset:26624
buffer_load_dwordx4 v[80:83], v6, s[12:15], s74 offen offset:1024 sc1
v_mfma_f32_16x16x32_bf16 v[32:35], a[40:43], v[88:91], v[32:35]
ds_read_b64_tr_b16 a[24:25], v14 offset:24576
buffer_load_dwordx4 v[84:87], v19, s[12:15], s74 offen offset:1024 sc1
v_mfma_f32_16x16x32_bf16 v[48:51], a[40:43], v[92:95], v[48:51]
ds_read_b64_tr_b16 a[26:27], v14 offset:26624
v_mfma_f32_16x16x32_bf16 v[36:39], a[44:47], v[88:91], v[36:39]
ds_read_b64_tr_b16 a[28:29], v15 offset:24576
s_add_u32 s74, s74, 2048
v_mfma_f32_16x16x32_bf16 v[52:55], a[44:47], v[92:95], v[52:55]
ds_read_b64_tr_b16 a[30:31], v15 offset:26624
s_waitcnt lgkmcnt(8)
v_mfma_f32_16x16x32_bf16 v[24:27], a[0:3], v[96:99], v[24:27]
ds_read_b64_tr_b16 a[32:33], v12 offset:28672
s_and_b32 s74, s74, 0x7fff
v_mfma_f32_16x16x32_bf16 v[40:43], a[0:3], v[100:103], v[40:43]
ds_read_b64_tr_b16 a[34:35], v12 offset:30720
s_waitcnt vmcnt(8)
v_mfma_f32_16x16x32_bf16 v[28:31], a[4:7], v[96:99], v[28:31]
ds_read_b64_tr_b16 a[36:37], v13 offset:28672
v_mfma_f32_16x16x32_bf16 v[44:47], a[4:7], v[100:103], v[44:47]
ds_read_b64_tr_b16 a[38:39], v13 offset:30720
v_max3_u32 v2, v104, v108, v112
v_mfma_f32_16x16x32_bf16 v[32:35], a[8:11], v[96:99], v[32:35]
ds_read_b64_tr_b16 a[40:41], v14 offset:28672
v_max_u32 v2, v2, v116
v_mfma_f32_16x16x32_bf16 v[48:51], a[8:11], v[100:103], v[48:51]
ds_read_b64_tr_b16 a[42:43], v14 offset:30720
v_mfma_f32_16x16x32_bf16 v[36:39], a[12:15], v[96:99], v[36:39]
ds_read_b64_tr_b16 a[44:45], v15 offset:28672
v_cmp_eq_u32 vcc, -1, v2
v_mfma_f32_16x16x32_bf16 v[52:55], a[12:15], v[100:103], v[52:55]
ds_read_b64_tr_b16 a[46:47], v15 offset:30720
s_cbranch_vccnz L_o11_rt
L_o11_ok:
s_waitcnt lgkmcnt(8)
v_mfma_f32_16x16x32_bf16 v[24:27], a[16:19], v[104:107], v[24:27]
ds_read_b64_tr_b16 a[0:1], v12 offset:32768
buffer_load_dwordx4 v[88:91], v6, s[12:15], s74 offen offset:0 sc1
v_mfma_f32_16x16x32_bf16 v[40:43], a[16:19], v[108:111], v[40:43]
ds_read_b64_tr_b16 a[2:3], v12 offset:34816
buffer_load_dwordx4 v[92:95], v19, s[12:15], s74 offen offset:0 sc1
v_mfma_f32_16x16x32_bf16 v[28:31], a[20:23], v[104:107], v[28:31]
ds_read_b64_tr_b16 a[4:5], v13 offset:32768
v_mfma_f32_16x16x32_bf16 v[44:47], a[20:23], v[108:111], v[44:47]
ds_read_b64_tr_b16 a[6:7], v13 offset:34816
buffer_load_dwordx4 v[96:99], v6, s[12:15], s74 offen offset:1024 sc1
v_mfma_f32_16x16x32_bf16 v[32:35], a[24:27], v[104:107], v[32:35]
ds_read_b64_tr_b16 a[8:9], v14 offset:32768
buffer_load_dwordx4 v[100:103], v19, s[12:15], s74 offen offset:1024 sc1
v_mfma_f32_16x16x32_bf16 v[48:51], a[24:27], v[108:111], v[48:51]
ds_read_b64_tr_b16 a[10:11], v14 offset:34816
v_mfma_f32_16x16x32_bf16 v[36:39], a[28:31], v[104:107], v[36:39]
ds_read_b64_tr_b16 a[12:13], v15 offset:32768
s_add_u32 s74, s74, 2048
v_mfma_f32_16x16x32_bf16 v[52:55], a[28:31], v[108:111], v[52:55]
ds_read_b64_tr_b16 a[14:15], v15 offset:34816
s_waitcnt lgkmcnt(8)
v_mfma_f32_16x16x32_bf16 v[24:27], a[32:35], v[112:115], v[24:27]
ds_read_b64_tr_b16 a[16:17], v12 offset:36864
s_and_b32 s74, s74, 0x7fff
v_mfma_f32_16x16x32_bf16 v[40:43], a[32:35], v[116:119], v[40:43]
ds_read_b64_tr_b16 a[18:19], v12 offset:38912
s_waitcnt vmcnt(8)
v_mfma_f32_16x16x32_bf16 v[28:31], a[36:39], v[112:115], v[28:31]
ds_read_b64_tr_b16 a[20:21], v13 offset:36864
v_mfma_f32_16x16x32_bf16 v[44:47], a[36:39], v[116:119], v[44:47]
ds_read_b64_tr_b16 a[22:23], v13 offset:38912
v_max3_u32 v2, v56, v60, v64
v_mfma_f32_16x16x32_bf16 v[32:35], a[40:43], v[112:115], v[32:35]
ds_read_b64_tr_b16 a[24:25], v14 offset:36864
v_max_u32 v2, v2, v68
v_mfma_f32_16x16x32_bf16 v[48:51], a[40:43], v[116:119], v[48:51]
ds_read_b64_tr_b16 a[26:27], v14 offset:38912
v_mfma_f32_16x16x32_bf16 v[36:39], a[44:47], v[112:115], v[36:39]
ds_read_b64_tr_b16 a[28:29], v15 offset:36864
v_cmp_eq_u32 vcc, -1, v2
v_mfma_f32_16x16x32_bf16 v[52:55], a[44:47], v[116:119], v[52:55]
ds_read_b64_tr_b16 a[30:31], v15 offset:38912
s_cbranch_vccnz L_o12_rt
L_o12_ok:
s_waitcnt lgkmcnt(8)
v_mfma_f32_16x16x32_bf16 v[24:27], a[0:3], v[56:59], v[24:27]
ds_read_b64_tr_b16 a[32:33], v12 offset:40960
buffer_load_dwordx4 v[104:107], v6, s[12:15], s74 offen offset:0 sc1
v_mfma_f32_16x16x32_bf16 v[40:43], a[0:3], v[60:63], v[40:43]
ds_read_b64_tr_b16 a[34:35], v12 offset:43008
v_mfma_f32_16x16x32_bf16 v[28:31], a[4:7], v[56:59], v[28:31]
ds_read_b64_tr_b16 a[36:37], v13 offset:40960
buffer_load_dwordx4 v[108:111], v19, s[12:15], s74 offen offset:0 sc1
v_mfma_f32_16x16x32_bf16 v[44:47], a[4:7], v[60:63], v[44:47]
ds_read_b64_tr_b16 a[38:39], v13 offset:43008
s_branch L_over7
L_pad7:
s_branch L_pad12
L_over7:
v_mfma_f32_16x16x32_bf16 v[32:35], a[8:11], v[56:59], v[32:35]
ds_read_b64_tr_b16 a[40:41], v14 offset:40960
buffer_load_dwordx4 v[112:115], v6, s[12:15], s74 offen offset:1024 sc1
v_mfma_f32_16x16x32_bf16 v[48:51], a[8:11], v[60:63], v[48:51]
ds_read_b64_tr_b16 a[42:43], v14 offset:43008
v_mfma_f32_16x16x32_bf16 v[36:39], a[12:15], v[56:59], v[36:39]
ds_read_b64_tr_b16 a[44:45], v15 offset:40960
buffer_load_dwordx4 v[116:119], v19, s[12:15], s74 offen offset:1024 sc1
v_mfma_f32_16x16x32_bf16 v[52:55], a[12:15], v[60:63], v[52:55]
ds_read_b64_tr_b16 a[46:47], v15 offset:43008
s_waitcnt lgkmcnt(8)
v_mfma_f32_16x16x32_bf16 v[24:27], a[16:19], v[64:67], v[24:27]
ds_read_b64_tr_b16 a[0:1], v12 offset:45056
s_waitcnt vmcnt(8)
v_mfma_f32_16x16x32_bf16 v[40:43], a[16:19], v[68:71], v[40:43]
ds_read_b64_tr_b16 a[2:3], v12 offset:47104
v_mfma_f32_16x16x32_bf16 v[28:31], a[20:23], v[64:67], v[28:31]
ds_read_b64_tr_b16 a[4:5], v13 offset:45056
v_max3_u32 v2, v72, v76, v80
v_mfma_f32_16x16x32_bf16 v[44:47], a[20:23], v[68:71], v[44:47]
ds_read_b64_tr_b16 a[6:7], v13 offset:47104
v_mfma_f32_16x16x32_bf16 v[32:35], a[24:27], v[64:67], v[32:35]
ds_read_b64_tr_b16 a[8:9], v14 offset:45056
v_max_u32 v2, v2, v84
v_mfma_f32_16x16x32_bf16 v[48:51], a[24:27], v[68:71], v[48:51]
ds_read_b64_tr_b16 a[10:11], v14 offset:47104
v_mfma_f32_16x16x32_bf16 v[36:39], a[28:31], v[64:67], v[36:39]
ds_read_b64_tr_b16 a[12:13], v15 offset:45056
v_cmp_eq_u32 vcc, -1, v2
v_mfma_f32_16x16x32_bf16 v[52:55], a[28:31], v[68:71], v[52:55]
ds_read_b64_tr_b16 a[14:15], v15 offset:47104
s_cbranch_vccnz L_o13_rt
L_o13_ok:
s_waitcnt lgkmcnt(8)
v_mfma_f32_16x16x32_bf16 v[24:27], a[32:35], v[72:75], v[24:27]
ds_read_b64_tr_b16 a[16:17], v12 offset:49152
s_waitcnt vmcnt(4)
v_mfma_f32_16x16x32_bf16 v[40:43], a[32:35], v[76:79], v[40:43]
ds_read_b64_tr_b16 a[18:19], v12 offset:51200
v_mfma_f32_16x16x32_bf16 v[28:31], a[36:39], v[72:75], v[28:31]
ds_read_b64_tr_b16 a[20:21], v13 offset:49152
v_mfma_f32_16x16x32_bf16 v[44:47], a[36:39], v[76:79], v[44:47]
ds_read_b64_tr_b16 a[22:23], v13 offset:51200
v_mfma_f32_16x16x32_bf16 v[32:35], a[40:43], v[72:75], v[32:35]
ds_read_b64_tr_b16 a[24:25], v14 offset:49152
v_max3_u32 v2, v88, v92, v96
v_mfma_f32_16x16x32_bf16 v[48:51], a[40:43], v[76:79], v[48:51]
ds_read_b64_tr_b16 a[26:27], v14 offset:51200
v_mfma_f32_16x16x32_bf16 v[36:39], a[44:47], v[72:75], v[36:39]
ds_read_b64_tr_b16 a[28:29], v15 offset:49152
v_mfma_f32_16x16x32_bf16 v[52:55], a[44:47], v[76:79], v[52:55]
ds_read_b64_tr_b16 a[30:31], v15 offset:51200
s_waitcnt lgkmcnt(8)
v_mfma_f32_16x16x32_bf16 v[24:27], a[0:3], v[80:83], v[24:27]
ds_read_b64_tr_b16 a[32:33], v12 offset:53248
v_max_u32 v2, v2, v100
v_mfma_f32_16x16x32_bf16 v[40:43], a[0:3], v[84:87], v[40:43]
ds_read_b64_tr_b16 a[34:35], v12 offset:55296
v_mfma_f32_16x16x32_bf16 v[28:31], a[4:7], v[80:83], v[28:31]
ds_read_b64_tr_b16 a[36:37], v13 offset:53248
v_mfma_f32_16x16x32_bf16 v[44:47], a[4:7], v[84:87], v[44:47]
ds_read_b64_tr_b16 a[38:39], v13 offset:55296
v_mfma_f32_16x16x32_bf16 v[32:35], a[8:11], v[80:83], v[32:35]
ds_read_b64_tr_b16 a[40:41], v14 offset:53248
v_cmp_eq_u32 vcc, -1, v2
v_mfma_f32_16x16x32_bf16 v[48:51], a[8:11], v[84:87], v[48:51]
ds_read_b64_tr_b16 a[42:43], v14 offset:55296
v_mfma_f32_16x16x32_bf16 v[36:39], a[12:15], v[80:83], v[36:39]
ds_read_b64_tr_b16 a[44:45], v15 offset:53248
v_mfma_f32_16x16x32_bf16 v[52:55], a[12:15], v[84:87], v[52:55]
ds_read_b64_tr_b16 a[46:47], v15 offset:55296
s_cbranch_vccnz L_o14_rt
L_o14_ok:
s_waitcnt lgkmcnt(8)
v_mfma_f32_16x16x32_bf16 v[24:27], a[16:19], v[88:91], v[24:27]
ds_read_b64_tr_b16 a[0:1], v12 offset:57344
s_waitcnt vmcnt(0)
v_mfma_f32_16x16x32_bf16 v[40:43], a[16:19], v[92:95], v[40:43]
ds_read_b64_tr_b16 a[2:3], v12 offset:59392
v_mfma_f32_16x16x32_bf16 v[28:31], a[20:23], v[88:91], v[28:31]
ds_read_b64_tr_b16 a[4:5], v13 offset:57344
v_mfma_f32_16x16x32_bf16 v[44:47], a[20:23], v[92:95], v[44:47]
ds_read_b64_tr_b16 a[6:7], v13 offset:59392
v_mfma_f32_16x16x32_bf16 v[32:35], a[24:27], v[88:91], v[32:35]
ds_read_b64_tr_b16 a[8:9], v14 offset:57344
v_max3_u32 v2, v104, v108, v112
v_mfma_f32_16x16x32_bf16 v[48:51], a[24:27], v[92:95], v[48:51]
ds_read_b64_tr_b16 a[10:11], v14 offset:59392
v_mfma_f32_16x16x32_bf16 v[36:39], a[28:31], v[88:91], v[36:39]
ds_read_b64_tr_b16 a[12:13], v15 offset:57344
v_mfma_f32_16x16x32_bf16 v[52:55], a[28:31], v[92:95], v[52:55]
ds_read_b64_tr_b16 a[14:15], v15 offset:59392
s_waitcnt lgkmcnt(8)
v_mfma_f32_16x16x32_bf16 v[24:27], a[32:35], v[96:99], v[24:27]
ds_read_b64_tr_b16 a[16:17], v12 offset:61440
v_max_u32 v2, v2, v116
v_mfma_f32_16x16x32_bf16 v[40:43], a[32:35], v[100:103], v[40:43]
ds_read_b64_tr_b16 a[18:19], v12 offset:63488
v_mfma_f32_16x16x32_bf16 v[28:31], a[36:39], v[96:99], v[28:31]
ds_read_b64_tr_b16 a[20:21], v13 offset:61440
v_mfma_f32_16x16x32_bf16 v[44:47], a[36:39], v[100:103], v[44:47]
ds_read_b64_tr_b16 a[22:23], v13 offset:63488
v_mfma_f32_16x16x32_bf16 v[32:35], a[40:43], v[96:99], v[32:35]
ds_read_b64_tr_b16 a[24:25], v14 offset:61440
v_cmp_eq_u32 vcc, -1, v2
v_mfma_f32_16x16x32_bf16 v[48:51], a[40:43], v[100:103], v[48:51]
ds_read_b64_tr_b16 a[26:27], v14 offset:63488
v_mfma_f32_16x16x32_bf16 v[36:39], a[44:47], v[96:99], v[36:39]
ds_read_b64_tr_b16 a[28:29], v15 offset:61440
v_mfma_f32_16x16x32_bf16 v[52:55], a[44:47], v[100:103], v[52:55]
ds_read_b64_tr_b16 a[30:31], v15 offset:63488
s_cbranch_vccnz L_o15_rt
L_o15_ok:
s_waitcnt lgkmcnt(8)
v_mfma_f32_16x16x32_bf16 v[24:27], a[0:3], v[104:107], v[24:27]
v_mfma_f32_16x16x32_bf16 v[40:43], a[0:3], v[108:111], v[40:43]
v_mfma_f32_16x16x32_bf16 v[28:31], a[4:7], v[104:107], v[28:31]
v_mfma_f32_16x16x32_bf16 v[44:47], a[4:7], v[108:111], v[44:47]
v_mfma_f32_16x16x32_bf16 v[32:35], a[8:11], v[104:107], v[32:35]
v_mfma_f32_16x16x32_bf16 v[48:51], a[8:11], v[108:111], v[48:51]
v_mfma_f32_16x16x32_bf16 v[36:39], a[12:15], v[104:107], v[36:39]
v_mfma_f32_16x16x32_bf16 v[52:55], a[12:15], v[108:111], v[52:55]
s_waitcnt lgkmcnt(0)
v_mfma_f32_16x16x32_bf16 v[24:27], a[16:19], v[112:115], v[24:27]
v_mfma_f32_16x16x32_bf16 v[40:43], a[16:19], v[116:119], v[40:43]
v_mfma_f32_16x16x32_bf16 v[28:31], a[20:23], v[112:115], v[28:31]
v_mfma_f32_16x16x32_bf16 v[44:47], a[20:23], v[116:119], v[44:47]
v_mfma_f32_16x16x32_bf16 v[32:35], a[24:27], v[112:115], v[32:35]
v_mfma_f32_16x16x32_bf16 v[48:51], a[24:27], v[116:119], v[48:51]
v_mfma_f32_16x16x32_bf16 v[36:39], a[28:31], v[112:115], v[36:39]
v_mfma_f32_16x16x32_bf16 v[52:55], a[28:31], v[116:119], v[52:55]
s_nop 0
v_cvt_pk_bf16_f32 v128, v24, v25
v_cvt_pk_bf16_f32 v129, v26, v27
v_cvt_pk_bf16_f32 v130, v28, v29
v_cvt_pk_bf16_f32 v131, v30, v31
v_cvt_pk_bf16_f32 v132, v32, v33
v_cvt_pk_bf16_f32 v133, v34, v35
v_cvt_pk_bf16_f32 v134, v36, v37
v_cvt_pk_bf16_f32 v135, v38, v39
v_cvt_pk_bf16_f32 v136, v40, v41
v_cvt_pk_bf16_f32 v137, v42, v43
v_cvt_pk_bf16_f32 v138, v44, v45
v_cvt_pk_bf16_f32 v139, v46, v47
v_cvt_pk_bf16_f32 v140, v48, v49
v_cvt_pk_bf16_f32 v141, v50, v51
v_cvt_pk_bf16_f32 v142, v52, v53
v_cvt_pk_bf16_f32 v143, v54, v55
v_mfma_f32_16x16x32_bf16 v[80:83], v[128:131], v[128:131], 0
v_mfma_f32_16x16x32_bf16 v[72:75], v[120:123], v[128:131], 0
v_mfma_f32_16x16x32_bf16 v[80:83], v[132:135], v[132:135], v[80:83]
v_mfma_f32_16x16x32_bf16 v[72:75], v[124:127], v[132:135], v[72:75]
v_mfma_f32_16x16x32_bf16 v[84:87], v[136:139], v[136:139], 0
v_mfma_f32_16x16x32_bf16 v[76:79], v[120:123], v[136:139], 0
v_mfma_f32_16x16x32_bf16 v[84:87], v[140:143], v[140:143], v[84:87]
v_mfma_f32_16x16x32_bf16 v[76:79], v[124:127], v[140:143], v[76:79]
s_nop 2
v_cndmask_b32_e64 v80, v80, v81, s[80:81]
v_cndmask_b32_e64 v82, v82, v83, s[90:91]
s_or_b64 vcc, s[82:83], s[90:91]
v_mov_b32 v75, s68
v_cndmask_b32 v73, v80, v82, vcc
v_cndmask_b32_e64 v84, v84, v85, s[80:81]
v_cndmask_b32_e64 v86, v86, v87, s[90:91]
s_or_b64 vcc, s[82:83], s[90:91]
v_mov_b32 v79, s68
v_cndmask_b32 v77, v84, v86, vcc
s_mov_b64 exec, s[92:93]
s_cmp_eq_u32 s69, 0
s_cbranch_scc1 L_stp_s
buffer_store_dwordx4 v[72:75], v144, s[12:15], s72 offen offset:0
buffer_store_dwordx4 v[76:79], v144, s[12:15], s72 offen offset:256
L_stp_d:
s_mov_b64 exec, -1
s_add_u32 s70, s75, 0
buffer_load_dwordx4 v[96:99], v145, s[12:15], s70 offen sc1
s_add_u32 s70, s75, 4096
buffer_load_dwordx4 v[100:103], v145, s[12:15], s70 offen sc1
s_add_u32 s70, s75, 8192
buffer_load_dwordx4 v[104:107], v145, s[12:15], s70 offen sc1
s_add_u32 s70, s75, 12288
buffer_load_dwordx4 v[108:111], v145, s[12:15], s70 offen sc1
s_add_u32 s70, s75, 16384
buffer_load_dwordx4 v[112:115], v145, s[12:15], s70 offen sc1
s_add_u32 s70, s75, 20480
buffer_load_dwordx4 v[116:119], v145, s[12:15], s70 offen sc1
s_add_u32 s70, s75, 24576
buffer_load_dwordx4 v[120:123], v145, s[12:15], s70 offen sc1
s_add_u32 s70, s75, 28672
buffer_load_dwordx4 v[124:127], v145, s[12:15], s70 offen sc1
s_barrier
ds_write_b64 v20, v[128:129] offset:0
ds_write_b64 v21, v[130:131] offset:0
ds_write_b64 v22, v[132:133] offset:0
ds_write_b64 v23, v[134:135] offset:0
ds_write_b64 v20, v[136:137] offset:2048
ds_write_b64 v21, v[138:139] offset:2048
ds_write_b64 v22, v[140:141] offset:2048
ds_write_b64 v23, v[142:143] offset:2048
v_lshrrev_b32 v2, 3, v1
v_lshrrev_b32 v3, 4, v1
v_and_b32 v13, 7, v1
v_xor_b32 v3, v3, v13
v_lshlrev_b32 v3, 4, v3
v_lshl_add_u32 v3, v2, 7, v3
s_lshl_b32 s70, s60, 12
v_add_u32 v9, s70, v3
v_xor_b32 v10, 64, v9
v_lshlrev_b32 v11, 11, v2
v_lshl_add_u32 v11, v13, 4, v11
s_lshl_b32 s70, s60, 5
v_add_u32 v12, s70, v2
s_lshl_b32 s74, s64, 18
s_lshl_b32 s70, s60, 16
s_add_u32 s74, s74, s70
s_lshl_b32 s70, s65, 7
s_add_u32 s74, s74, s70
s_mov_b32 s80, 0xff00ff00
s_mov_b32 s81, 0xff00ff00
s_lshl_b32 s70, s60, 5
s_add_u32 s70, s70, 161920
v_mov_b32 v14, s70
v_add_u32 v15, 16, v14
v_add_u32 v8, 161920, v16
v_lshlrev_b32 v8, 4, v13
v_add_u32 v8, 161920, v8
s_waitcnt vmcnt(0)
L_st_chk:
v_xor_b32 v88, s68, v99
v_xor_b32 v89, s68, v103
v_xor_b32 v90, s68, v107
v_xor_b32 v91, s68, v111
v_xor_b32 v92, s68, v115
v_xor_b32 v93, s68, v119
v_xor_b32 v94, s68, v123
v_xor_b32 v95, s68, v127
v_or3_b32 v88, v88, v89, v90
v_or3_b32 v91, v91, v92, v93
v_or3_b32 v88, v88, v94, v95
v_or_b32 v88, v88, v91
v_cmp_ne_u32 vcc, 0, v88
s_cbranch_vccnz L_st_rt
L_st_ok:
v_pk_add_f32 v[96:97], v[96:97], v[100:101]
v_add_f32 v98, v98, v102
v_pk_add_f32 v[104:105], v[104:105], v[108:109]
v_add_f32 v106, v106, v110
v_pk_add_f32 v[112:113], v[112:113], v[116:117]
v_add_f32 v114, v114, v118
v_pk_add_f32 v[120:121], v[120:121], v[124:125]
v_add_f32 v122, v122, v126
v_pk_add_f32 v[96:97], v[96:97], v[104:105]
v_add_f32 v98, v98, v106
v_pk_add_f32 v[112:113], v[112:113], v[120:121]
v_add_f32 v114, v114, v122
v_pk_add_f32 v[96:97], v[96:97], v[112:113]
v_add_f32 v98, v98, v114
v_mov_b32 v100, v96
v_mov_b32 v101, v97
v_mov_b32 v102, v98
v_permlane32_swap_b32 v96, v100
v_permlane32_swap_b32 v97, v101
v_permlane32_swap_b32 v98, v102
v_add_f32 v96, v96, v100
v_add_f32 v97, v97, v101
v_add_f32 v98, v98, v102
v_mul_f32 v73, 0x3a800000, v96
v_mul_f32 v97, 0x3a800000, v97
v_fma_f32 v97, -v73, v73, v97
v_fma_f32 v98, -v73, s84, v98
v_max_f32 v97, 0, v97
v_add_f32 v97, 0x3727c5ac, v97
v_rsq_f32 v74, v97
v_mov_b32 v75, s68
v_mul_f32 v98, v98, v74
v_ashrrev_i32 v99, 31, v98
v_or_b32 v99, 0x80000000, v99
v_xor_b32 v98, v98, v99
s_mov_b32 s70, 0xfffff800
v_and_or_b32 v72, v98, s70, v146
s_nop 1
v_mov_b32_dpp v78, v72 row_ror:1 row_mask:0xf bank_mask:0xf
v_max_u32 v76, v72, v78
v_min_u32 v77, v72, v78
s_nop 0
v_mov_b32_dpp v78, v76 row_ror:2 row_mask:0xf bank_mask:0xf
v_max_u32_dpp v79, v77, v77 row_ror:2 row_mask:0xf bank_mask:0xf
v_med3_u32 v77, v76, v78, v79
v_max_u32 v76, v76, v78
s_nop 1
v_mov_b32_dpp v78, v76 row_ror:4 row_mask:0xf bank_mask:0xf
v_max_u32_dpp v79, v77, v77 row_ror:4 row_mask:0xf bank_mask:0xf
v_med3_u32 v77, v76, v78, v79
v_max_u32 v76, v76, v78
s_nop 1
v_mov_b32_dpp v78, v76 row_ror:8 row_mask:0xf bank_mask:0xf
v_max_u32_dpp v79, v77, v77 row_ror:8 row_mask:0xf bank_mask:0xf
v_med3_u32 v77, v76, v78, v79
v_max_u32 v76, v76, v78
v_mov_b32 v78, v76
v_mov_b32 v79, v77
s_nop 0
v_permlane16_swap_b32 v76, v78
v_permlane16_swap_b32 v77, v79
v_max_u32 v79, v77, v79
v_med3_u32 v77, v76, v78, v79
v_max_u32 v76, v76, v78
v_cmp_eq_u32 vcc, v72, v77
v_cmp_eq_u32_e64 s[92:93], v72, v76
s_nop 0
v_cndmask_b32 v2, v14, v15, vcc
s_or_b64 exec, vcc, s[92:93]
ds_write_b128 v2, v[72:75]
s_mov_b64 exec, -1
v_cndmask_b32_e64 v5, v76, v77, s[80:81]
v_not_b32 v5, v5
v_bfe_u32 v6, v5, 1, 3
v_and_b32 v5, 127, v5
v_xor_b32 v6, v6, v13
v_lshlrev_b32 v6, 4, v6
v_lshl_add_u32 v6, v5, 7, v6
ds_read_b128 v[88:91], v6
v_readfirstlane_b32 s86, v77
v_readfirstlane_b32 s85, v76
v_add_f32 v80, 1.0, v74
v_mul_f32_e64 v56, -v73, v74
v_mov_b32 v82, v80
v_mov_b32 v58, v56
s_nop 0
v_permlane16_swap_b32 v80, v82
v_permlane16_swap_b32 v56, v58
s_waitcnt lgkmcnt(1)
s_barrier
s_sub_u32 s70, s64, s65
s_or_b32 s70, s70, s60
s_cbranch_scc1 L_norec
ds_read_b128 v[92:95], v8
s_waitcnt lgkmcnt(0)
buffer_store_dwordx4 v[92:95], v11, s[12:15], s87 offen sc1
L_norec:
s_mov_b64 exec, 0xffff
s_waitcnt lgkmcnt(0)
buffer_store_dwordx4 v[88:91], v147, s[12:15], s88 offen sc1
s_mov_b64 exec, -1
s_not_b32 s95, s86
s_and_b32 s95, s95, 127
s_not_b32 s94, s85
s_and_b32 s94, s94, 127
v_pk_fma_f32 v[24:25], v[24:25], v[80:81], v[56:57] op_sel_hi:[1,0,0]
v_pk_fma_f32 v[26:27], v[26:27], v[80:81], v[56:57] op_sel_hi:[1,0,0]
v_cvt_pk_bf16_f32 v128, v24, v25
v_cvt_pk_bf16_f32 v129, v26, v27
ds_write_b64 v20, v[128:129] offset:32768
v_pk_fma_f32 v[28:29], v[28:29], v[80:81], v[56:57] op_sel_hi:[1,0,0]
v_pk_fma_f32 v[30:31], v[30:31], v[80:81], v[56:57] op_sel_hi:[1,0,0]
v_cvt_pk_bf16_f32 v130, v28, v29
v_cvt_pk_bf16_f32 v131, v30, v31
ds_write_b64 v21, v[130:131] offset:32768
v_pk_fma_f32 v[32:33], v[32:33], v[80:81], v[56:57] op_sel_hi:[1,0,0]
v_pk_fma_f32 v[34:35], v[34:35], v[80:81], v[56:57] op_sel_hi:[1,0,0]
v_cvt_pk_bf16_f32 v132, v32, v33
v_cvt_pk_bf16_f32 v133, v34, v35
ds_write_b64 v22, v[132:133] offset:32768
v_pk_fma_f32 v[36:37], v[36:37], v[80:81], v[56:57] op_sel_hi:[1,0,0]
v_pk_fma_f32 v[38:39], v[38:39], v[80:81], v[56:57] op_sel_hi:[1,0,0]
v_cvt_pk_bf16_f32 v134, v36, v37
v_cvt_pk_bf16_f32 v135, v38, v39
ds_write_b64 v23, v[134:135] offset:32768
v_pk_fma_f32 v[40:41], v[40:41], v[82:83], v[58:59] op_sel_hi:[1,0,0]
v_pk_fma_f32 v[42:43], v[42:43], v[82:83], v[58:59] op_sel_hi:[1,0,0]
v_cvt_pk_bf16_f32 v136, v40, v41
v_cvt_pk_bf16_f32 v137, v42, v43
ds_write_b64 v20, v[136:137] offset:34816
v_pk_fma_f32 v[44:45], v[44:45], v[82:83], v[58:59] op_sel_hi:[1,0,0]
v_pk_fma_f32 v[46:47], v[46:47], v[82:83], v[58:59] op_sel_hi:[1,0,0]
v_cvt_pk_bf16_f32 v138, v44, v45
v_cvt_pk_bf16_f32 v139, v46, v47
ds_write_b64 v21, v[138:139] offset:34816
v_pk_fma_f32 v[48:49], v[48:49], v[82:83], v[58:59] op_sel_hi:[1,0,0]
v_pk_fma_f32 v[50:51], v[50:51], v[82:83], v[58:59] op_sel_hi:[1,0,0]
v_cvt_pk_bf16_f32 v140, v48, v49
v_cvt_pk_bf16_f32 v141, v50, v51
ds_write_b64 v22, v[140:141] offset:34816
v_pk_fma_f32 v[52:53], v[52:53], v[82:83], v[58:59] op_sel_hi:[1,0,0]
v_pk_fma_f32 v[54:55], v[54:55], v[82:83], v[58:59] op_sel_hi:[1,0,0]
v_cvt_pk_bf16_f32 v142, v52, v53
v_cvt_pk_bf16_f32 v143, v54, v55
ds_write_b64 v23, v[142:143] offset:34816
s_waitcnt lgkmcnt(0)
ds_read_b128 v[96:99], v9 offset:32768
ds_read_b128 v[100:103], v10 offset:33792
ds_read_b128 v[104:107], v9 offset:34816
ds_read_b128 v[108:111], v10 offset:35840
v_add_u32 v2, 0, v12
v_cmp_ne_u32 vcc, s94, v2
v_cmp_ne_u32_e64 s[92:93], s95, v2
s_add_u32 s70, s74, 0
s_waitcnt lgkmcnt(3)
s_and_b64 exec, vcc, s[92:93]
buffer_store_dwordx4 v[96:99], v11, s[20:23], s70 offen nt
s_mov_b64 exec, -1
v_add_u32 v2, 8, v12
v_cmp_ne_u32 vcc, s94, v2
v_cmp_ne_u32_e64 s[92:93], s95, v2
s_add_u32 s70, s74, 16384
s_waitcnt lgkmcnt(2)
s_and_b64 exec, vcc, s[92:93]
buffer_store_dwordx4 v[100:103], v11, s[20:23], s70 offen nt
s_mov_b64 exec, -1
v_add_u32 v2, 16, v12
v_cmp_ne_u32 vcc, s94, v2
v_cmp_ne_u32_e64 s[92:93], s95, v2
s_add_u32 s70, s74, 32768
s_waitcnt lgkmcnt(1)
s_and_b64 exec, vcc, s[92:93]
buffer_store_dwordx4 v[104:107], v11, s[20:23], s70 offen nt
s_mov_b64 exec, -1
v_add_u32 v2, 24, v12
v_cmp_ne_u32 vcc, s94, v2
v_cmp_ne_u32_e64 s[92:93], s95, v2
s_add_u32 s70, s74, 49152
s_waitcnt lgkmcnt(0)
s_and_b64 exec, vcc, s[92:93]
buffer_store_dwordx4 v[108:111], v11, s[20:23], s70 offen nt
s_mov_b64 exec, -1
v_mov_b32 v2, 161792
s_barrier
ds_read_b32 v3, v2
ds_read_b32 v4, v2 offset:16
s_waitcnt lgkmcnt(0)
v_readfirstlane_b32 s72, v3
v_readfirstlane_b32 s73, v4
s_cmp_eq_u32 s85, s72
s_cselect_b32 s94, 255, s94
s_cmp_eq_u32 s85, s73
s_cselect_b32 s94, 255, s94
s_cmp_eq_u32 s86, s72
s_cselect_b32 s95, 255, s95
s_cmp_eq_u32 s86, s73
s_cselect_b32 s95, 255, s95
v_add_u32 v2, 0, v12
v_cmp_eq_u32 vcc, s94, v2
v_cmp_eq_u32_e64 s[92:93], s95, v2
s_add_u32 s70, s74, 0
s_or_b64 exec, vcc, s[92:93]
s_cbranch_execz L_nodef0
buffer_store_dwordx4 v[96:99], v11, s[20:23], s70 offen nt
L_nodef0:
s_mov_b64 exec, -1
v_add_u32 v2, 8, v12
v_cmp_eq_u32 vcc, s94, v2
v_cmp_eq_u32_e64 s[92:93], s95, v2
s_add_u32 s70, s74, 16384
s_or_b64 exec, vcc, s[92:93]
s_cbranch_execz L_nodef1
buffer_store_dwordx4 v[100:103], v11, s[20:23], s70 offen nt
L_nodef1:
s_mov_b64 exec, -1
v_add_u32 v2, 16, v12
v_cmp_eq_u32 vcc, s94, v2
v_cmp_eq_u32_e64 s[92:93], s95, v2
s_add_u32 s70, s74, 32768
s_or_b64 exec, vcc, s[92:93]
s_cbranch_execz L_nodef2
buffer_store_dwordx4 v[104:107], v11, s[20:23], s70 offen nt
L_nodef2:
s_mov_b64 exec, -1
v_add_u32 v2, 24, v12
v_cmp_eq_u32 vcc, s94, v2
v_cmp_eq_u32_e64 s[92:93], s95, v2
s_add_u32 s70, s74, 49152
s_or_b64 exec, vcc, s[92:93]
s_cbranch_execz L_nodef3
buffer_store_dwordx4 v[108:111], v11, s[20:23], s70 offen nt
L_nodef3:
s_mov_b64 exec, -1
L_end:
s_endpgm
L_eg_rt:
s_add_u32 s78, s78, 1
s_cmp_gt_u32 s78, 65536
s_cbranch_scc1 L_eg_ok
s_add_u32 s70, s87, 0
buffer_load_dwordx4 v[20:23], v44, s[12:15], s70 offen sc1
s_add_u32 s70, s87, 4096
buffer_load_dwordx4 v[24:27], v44, s[12:15], s70 offen sc1
s_add_u32 s70, s87, 8192
buffer_load_dwordx4 v[28:31], v44, s[12:15], s70 offen sc1
s_add_u32 s70, s87, 12288
buffer_load_dwordx4 v[32:35], v44, s[12:15], s70 offen sc1
buffer_load_dwordx4 v[36:39], v45, s[12:15], s88 offen sc1
buffer_load_dwordx4 v[40:43], v46, s[12:15], 0 offen offset:0 sc1
s_waitcnt vmcnt(0)
s_branch L_eg_chk
L_pad8:
s_branch L_retF
L_kvrt:
s_add_u32 s78, s78, 1
s_cmp_gt_u32 s78, 65536
s_cbranch_scc1 L_kvok
s_bitcmp1_b32 s73, 0
s_cbranch_scc0 L_kvn0
v_cmp_eq_u32 vcc, -1, v84
s_cbranch_vccz L_kv0_p0
s_add_u32 s70, s65, 1
s_and_b32 s70, s70, 15
s_mul_i32 s70, s70, 4352
s_add_u32 s70, s70, s87
buffer_load_dwordx4 v[84:87], v18, s[12:15], s70 offen sc1
L_kv0_p0:
v_cmp_eq_u32 vcc, -1, v88
s_cbranch_vccz L_kv0_p1
s_add_u32 s70, s65, 2
s_and_b32 s70, s70, 15
s_mul_i32 s70, s70, 4352
s_add_u32 s70, s70, s87
buffer_load_dwordx4 v[88:91], v18, s[12:15], s70 offen sc1
L_kv0_p1:
v_cmp_eq_u32 vcc, -1, v92
s_cbranch_vccz L_kv0_p2
s_add_u32 s70, s65, 3
s_and_b32 s70, s70, 15
s_mul_i32 s70, s70, 4352
s_add_u32 s70, s70, s87
buffer_load_dwordx4 v[92:95], v18, s[12:15], s70 offen sc1
L_kv0_p2:
v_cmp_eq_u32 vcc, -1, v96
s_cbranch_vccz L_kv0_p3
s_add_u32 s70, s65, 4
s_and_b32 s70, s70, 15
s_mul_i32 s70, s70, 4352
s_add_u32 s70, s70, s87
buffer_load_dwordx4 v[96:99], v18, s[12:15], s70 offen sc1
L_kv0_p3:
L_kvn0:
s_bitcmp1_b32 s73, 1
s_cbranch_scc0 L_kvn1
v_cmp_eq_u32 vcc, -1, v100
s_cbranch_vccz L_kv1_p0
s_add_u32 s70, s65, 5
s_and_b32 s70, s70, 15
s_mul_i32 s70, s70, 4352
s_add_u32 s70, s70, s87
buffer_load_dwordx4 v[100:103], v18, s[12:15], s70 offen sc1
L_kv1_p0:
v_cmp_eq_u32 vcc, -1, v104
s_cbranch_vccz L_kv1_p1
s_add_u32 s70, s65, 6
s_and_b32 s70, s70, 15
s_mul_i32 s70, s70, 4352
s_add_u32 s70, s70, s87
buffer_load_dwordx4 v[104:107], v18, s[12:15], s70 offen sc1
L_kv1_p1:
v_cmp_eq_u32 vcc, -1, v108
s_cbranch_vccz L_kv1_p2
s_add_u32 s70, s65, 7
s_and_b32 s70, s70, 15
s_mul_i32 s70, s70, 4352
s_add_u32 s70, s70, s87
buffer_load_dwordx4 v[108:111], v18, s[12:15], s70 offen sc1
L_kv1_p2:
v_cmp_eq_u32 vcc, -1, v112
s_cbranch_vccz L_kv1_p3
s_add_u32 s70, s65, 8
s_and_b32 s70, s70, 15
s_mul_i32 s70, s70, 4352
s_add_u32 s70, s70, s87
buffer_load_dwordx4 v[112:115], v18, s[12:15], s70 offen sc1
L_kv1_p3:
L_kvn1:
s_bitcmp1_b32 s73, 2
s_cbranch_scc0 L_kvn2
v_cmp_eq_u32 vcc, -1, v116
s_cbranch_vccz L_kv2_p0
s_add_u32 s70, s65, 9
s_and_b32 s70, s70, 15
s_mul_i32 s70, s70, 4352
s_add_u32 s70, s70, s87
buffer_load_dwordx4 v[116:119], v18, s[12:15], s70 offen sc1
L_kv2_p0:
v_cmp_eq_u32 vcc, -1, v120
s_cbranch_vccz L_kv2_p1
s_add_u32 s70, s65, 10
s_and_b32 s70, s70, 15
s_mul_i32 s70, s70, 4352
s_add_u32 s70, s70, s87
buffer_load_dwordx4 v[120:123], v18, s[12:15], s70 offen sc1
L_kv2_p1:
v_cmp_eq_u32 vcc, -1, v124
s_cbranch_vccz L_kv2_p2
s_add_u32 s70, s65, 11
s_and_b32 s70, s70, 15
s_mul_i32 s70, s70, 4352
s_add_u32 s70, s70, s87
buffer_load_dwordx4 v[124:127], v18, s[12:15], s70 offen sc1
L_kv2_p2:
v_cmp_eq_u32 vcc, -1, v128
s_cbranch_vccz L_kv2_p3
s_add_u32 s70, s65, 12
s_and_b32 s70, s70, 15
s_mul_i32 s70, s70, 4352
s_add_u32 s70, s70, s87
buffer_load_dwordx4 v[128:131], v18, s[12:15], s70 offen sc1
L_kv2_p3:
L_kvn2:
s_bitcmp1_b32 s73, 3
s_cbranch_scc0 L_kvn3
v_cmp_eq_u32 vcc, -1, v132
s_cbranch_vccz L_kv3_p0
s_add_u32 s70, s65, 13
s_and_b32 s70, s70, 15
s_mul_i32 s70, s70, 4352
s_add_u32 s70, s70, s87
buffer_load_dwordx4 v[132:135], v18, s[12:15], s70 offen sc1
L_kv3_p0:
v_cmp_eq_u32 vcc, -1, v136
s_cbranch_vccz L_kv3_p1
s_add_u32 s70, s65, 14
s_and_b32 s70, s70, 15
s_mul_i32 s70, s70, 4352
s_add_u32 s70, s70, s87
buffer_load_dwordx4 v[136:139], v18, s[12:15], s70 offen sc1
L_kv3_p1:
v_cmp_eq_u32 vcc, -1, v140
s_cbranch_vccz L_kv3_p2
s_add_u32 s70, s65, 15
s_and_b32 s70, s70, 15
s_mul_i32 s70, s70, 4352
s_add_u32 s70, s70, s87
buffer_load_dwordx4 v[140:143], v18, s[12:15], s70 offen sc1
L_kv3_p2:
v_cmp_eq_u32 vcc, -1, v144
s_cbranch_vccz L_kv3_p3
s_add_u32 s70, s65, 16
s_and_b32 s70, s70, 15
s_mul_i32 s70, s70, 4352
s_add_u32 s70, s70, s87
buffer_load_dwordx4 v[144:147], v18, s[12:15], s70 offen sc1
L_kv3_p3:
L_kvn3:
s_bitcmp1_b32 s73, 4
s_cbranch_scc0 L_kvn4
buffer_load_dwordx4 v[148:151], v55, s[12:15], s88 offen sc1
L_kvn4:
s_waitcnt vmcnt(0)
s_branch L_kvr
L_pad9:
s_branch L_pad13
L_pksame:
s_cmp_eq_u32 s73, 0
s_cbranch_scc1 L_pkf
s_add_u32 s78, s78, 1
s_cmp_le_u32 s78, 65536
s_cbranch_scc1 L_pk
s_branch L_pkf
L_pkx_rt:
s_add_u32 s78, s78, 1
s_cmp_gt_u32 s78, 65536
s_cbranch_scc1 L_pkx_ok
s_mov_b64 exec, s[92:93]
buffer_load_dwordx4 v[24:27], v58, s[12:15], 0 offen offset:0 sc1
buffer_load_dwordx4 v[28:31], v58, s[12:15], 0 offen offset:64 sc1
buffer_load_dwordx4 v[32:35], v58, s[12:15], 0 offen offset:128 sc1
buffer_load_dwordx4 v[36:39], v58, s[12:15], 0 offen offset:192 sc1
buffer_load_dwordx4 v[40:43], v58, s[12:15], 0 offen offset:256 sc1
buffer_load_dwordx4 v[44:47], v58, s[12:15], 0 offen offset:320 sc1
buffer_load_dwordx4 v[48:51], v58, s[12:15], 0 offen offset:384 sc1
buffer_load_dwordx4 v[52:55], v58, s[12:15], 0 offen offset:448 sc1
s_mov_b64 exec, -1
s_waitcnt vmcnt(0)
s_branch L_pkx_chk
L_pxp_s:
buffer_store_dwordx4 v[84:87], v60, s[12:15], s85 offen sc1
s_branch L_pxp_d
L_pad10:
s_branch L_pad14
L_px_rt:
s_add_u32 s78, s78, 1
s_cmp_gt_u32 s78, 65536
s_cbranch_scc1 L_px_ok
v_and_b32 v2, s91, v24
v_cmp_ne_u32 vcc, 0, v2
v_xor_b32 v24, s84, v24
s_cbranch_vccz L_px_p0
buffer_load_dwordx4 v[24:27], v61, s[12:15], s86 offen offset:0 sc1
L_px_p0:
v_and_b32 v2, s91, v28
v_cmp_ne_u32 vcc, 0, v2
v_xor_b32 v28, s84, v28
s_cbranch_vccz L_px_p1
buffer_load_dwordx4 v[28:31], v61, s[12:15], s86 offen offset:1024 sc1
L_px_p1:
v_and_b32 v2, s91, v32
v_cmp_ne_u32 vcc, 0, v2
v_xor_b32 v32, s84, v32
s_cbranch_vccz L_px_p2
buffer_load_dwordx4 v[32:35], v61, s[12:15], s86 offen offset:2048 sc1
L_px_p2:
v_and_b32 v2, s91, v36
v_cmp_ne_u32 vcc, 0, v2
v_xor_b32 v36, s84, v36
s_cbranch_vccz L_px_p3
buffer_load_dwordx4 v[36:39], v61, s[12:15], s86 offen offset:3072 sc1
L_px_p3:
s_waitcnt vmcnt(0)
s_branch L_px_chk
L_h_rt:
s_add_u32 s78, s78, 1
s_cmp_gt_u32 s78, 65536
s_cbranch_scc1 L_h_ok
buffer_load_dwordx2 v[84:85], v64, s[12:15], s72 offen sc1
s_waitcnt vmcnt(0)
s_branch L_h_chk
L_pad11:
s_branch L_pad15
L_y_rt:
s_add_u32 s78, s78, 1
s_cmp_gt_u32 s78, 65536
s_cbranch_scc1 L_y_ok
v_mov_b32 v88, s84
v_and_b32 v2, s91, v120
v_cmp_ne_u32 vcc, 0, v2
s_branch L_over12
L_pad12:
s_branch L_retG
L_over12:
v_xor_b32 v120, s84, v120
s_cbranch_vccz L_y_p0
buffer_load_dwordx4 v[120:123], v18, s[12:15], s88 offen offset:0 sc1
L_y_p0:
v_and_b32 v2, s91, v124
v_cmp_ne_u32 vcc, 0, v2
v_xor_b32 v124, s84, v124
s_cbranch_vccz L_y_p1
buffer_load_dwordx4 v[124:127], v18, s[12:15], s88 offen offset:1024 sc1
L_y_p1:
v_and_b32 v2, s91, v128
v_cmp_ne_u32 vcc, 0, v2
v_xor_b32 v128, s84, v128
s_cbranch_vccz L_y_p2
buffer_load_dwordx4 v[128:131], v18, s[12:15], s88 offen offset:2048 sc1
L_y_p2:
v_and_b32 v2, s91, v132
v_cmp_ne_u32 vcc, 0, v2
v_xor_b32 v132, s84, v132
s_cbranch_vccz L_y_p3
buffer_load_dwordx4 v[132:135], v18, s[12:15], s88 offen offset:3072 sc1
L_y_p3:
v_and_b32 v2, s91, v136
v_cmp_ne_u32 vcc, 0, v2
v_xor_b32 v136, s84, v136
s_cbranch_vccz L_y_p4
buffer_load_dwordx4 v[136:139], v18, s[12:15], s71 offen offset:0 sc1
L_y_p4:
v_and_b32 v2, s91, v140
v_cmp_ne_u32 vcc, 0, v2
v_xor_b32 v140, s84, v140
s_cbranch_vccz L_y_p5
buffer_load_dwordx4 v[140:143], v18, s[12:15], s71 offen offset:1024 sc1
L_y_p5:
v_and_b32 v2, s91, v144
v_cmp_ne_u32 vcc, 0, v2
v_xor_b32 v144, s84, v144
s_cbranch_vccz L_y_p6
buffer_load_dwordx4 v[144:147], v18, s[12:15], s71 offen offset:2048 sc1
L_y_p6:
s_waitcnt vmcnt(0)
s_branch L_y_chk
L_kvp_s:
buffer_store_dwordx4 v[140:143], v16, s[12:15], s72 offen sc1
s_mov_b64 exec, s[92:93]
buffer_store_dwordx4 v[136:139], v4, s[12:15], s73 offen sc1
s_mov_b64 exec, -1
s_branch L_kvp_d
L_pad13:
s_branch L_retG
L_o0_rt:
s_add_u32 s78, s78, 1
s_cmp_gt_u32 s78, 65536
s_cbranch_scc1 L_o0_ok
s_add_u32 s70, s89, 0
s_and_b32 s70, s70, 15
s_lshl_b32 s70, s70, 11
buffer_load_dwordx4 v[56:59], v6, s[12:15], s70 offen offset:0 sc1
buffer_load_dwordx4 v[60:63], v19, s[12:15], s70 offen offset:0 sc1
buffer_load_dwordx4 v[64:67], v6, s[12:15], s70 offen offset:1024 sc1
buffer_load_dwordx4 v[68:71], v19, s[12:15], s70 offen offset:1024 sc1
s_add_u32 s70, s89, 1
s_and_b32 s70, s70, 15
s_lshl_b32 s70, s70, 11
buffer_load_dwordx4 v[72:75], v6, s[12:15], s70 offen offset:0 sc1
buffer_load_dwordx4 v[76:79], v19, s[12:15], s70 offen offset:0 sc1
buffer_load_dwordx4 v[80:83], v6, s[12:15], s70 offen offset:1024 sc1
buffer_load_dwordx4 v[84:87], v19, s[12:15], s70 offen offset:1024 sc1
s_add_u32 s70, s89, 2
s_and_b32 s70, s70, 15
s_lshl_b32 s70, s70, 11
buffer_load_dwordx4 v[88:91], v6, s[12:15], s70 offen offset:0 sc1
buffer_load_dwordx4 v[92:95], v19, s[12:15], s70 offen offset:0 sc1
buffer_load_dwordx4 v[96:99], v6, s[12:15], s70 offen offset:1024 sc1
buffer_load_dwordx4 v[100:103], v19, s[12:15], s70 offen offset:1024 sc1
s_waitcnt vmcnt(0)
s_branch L_o0_chk
L_pad14:
s_branch L_retG
L_o1_rt:
s_add_u32 s78, s78, 1
s_cmp_gt_u32 s78, 65536
s_cbranch_scc1 L_o1_ok
s_add_u32 s70, s89, 1
s_and_b32 s70, s70, 15
s_lshl_b32 s70, s70, 11
buffer_load_dwordx4 v[72:75], v6, s[12:15], s70 offen offset:0 sc1
buffer_load_dwordx4 v[76:79], v19, s[12:15], s70 offen offset:0 sc1
buffer_load_dwordx4 v[80:83], v6, s[12:15], s70 offen offset:1024 sc1
buffer_load_dwordx4 v[84:87], v19, s[12:15], s70 offen offset:1024 sc1
s_add_u32 s70, s89, 2
s_and_b32 s70, s70, 15
s_lshl_b32 s70, s70, 11
buffer_load_dwordx4 v[88:91], v6, s[12:15], s70 offen offset:0 sc1
buffer_load_dwordx4 v[92:95], v19, s[12:15], s70 offen offset:0 sc1
buffer_load_dwordx4 v[96:99], v6, s[12:15], s70 offen offset:1024 sc1
buffer_load_dwordx4 v[100:103], v19, s[12:15], s70 offen offset:1024 sc1
s_waitcnt vmcnt(0)
v_max3_u32 v2, v72, v76, v80
v_max_u32 v2, v2, v84
v_cmp_eq_u32 vcc, -1, v2
s_cbranch_vccnz L_o1_rt
s_branch L_o1_ok
L_o2_rt:
s_add_u32 s78, s78, 1
s_cmp_gt_u32 s78, 65536
s_cbranch_scc1 L_o2_ok
s_add_u32 s70, s89, 2
s_and_b32 s70, s70, 15
s_lshl_b32 s70, s70, 11
buffer_load_dwordx4 v[88:91], v6, s[12:15], s70 offen offset:0 sc1
buffer_load_dwordx4 v[92:95], v19, s[12:15], s70 offen offset:0 sc1
buffer_load_dwordx4 v[96:99], v6, s[12:15], s70 offen offset:1024 sc1
buffer_load_dwordx4 v[100:103], v19, s[12:15], s70 offen offset:1024 sc1
s_add_u32 s70, s89, 3
s_and_b32 s70, s70, 15
s_lshl_b32 s70, s70, 11
buffer_load_dwordx4 v[104:107], v6, s[12:15], s70 offen offset:0 sc1
buffer_load_dwordx4 v[108:111], v19, s[12:15], s70 offen offset:0 sc1
buffer_load_dwordx4 v[112:115], v6, s[12:15], s70 offen offset:1024 sc1
buffer_load_dwordx4 v[116:119], v19, s[12:15], s70 offen offset:1024 sc1
s_waitcnt vmcnt(0)
v_max3_u32 v2, v88, v92, v96
v_max_u32 v2, v2, v100
v_cmp_eq_u32 vcc, -1, v2
s_cbranch_vccnz L_o2_rt
s_branch L_o2_ok
L_o3_rt:
s_add_u32 s78, s78, 1
s_cmp_gt_u32 s78, 65536
s_cbranch_scc1 L_o3_ok
s_add_u32 s70, s89, 3
s_and_b32 s70, s70, 15
s_lshl_b32 s70, s70, 11
buffer_load_dwordx4 v[104:107], v6, s[12:15], s70 offen offset:0 sc1
buffer_load_dwordx4 v[108:111], v19, s[12:15], s70 offen offset:0 sc1
buffer_load_dwordx4 v[112:115], v6, s[12:15], s70 offen offset:1024 sc1
buffer_load_dwordx4 v[116:119], v19, s[12:15], s70 offen offset:1024 sc1
s_add_u32 s70, s89, 4
s_and_b32 s70, s70, 15
s_lshl_b32 s70, s70, 11
buffer_load_dwordx4 v[56:59], v6, s[12:15], s70 offen offset:0 sc1
buffer_load_dwordx4 v[60:63], v19, s[12:15], s70 offen offset:0 sc1
buffer_load_dwordx4 v[64:67], v6, s[12:15], s70 offen offset:1024 sc1
buffer_load_dwordx4 v[68:71], v19, s[12:15], s70 offen offset:1024 sc1
s_waitcnt vmcnt(0)
v_max3_u32 v2, v104, v108, v112
v_max_u32 v2, v2, v116
v_cmp_eq_u32 vcc, -1, v2
s_cbranch_vccnz L_o3_rt
s_branch L_o3_ok
L_o4_rt:
s_add_u32 s78, s78, 1
s_cmp_gt_u32 s78, 65536
s_cbranch_scc1 L_o4_ok
s_add_u32 s70, s89, 4
s_and_b32 s70, s70, 15
s_lshl_b32 s70, s70, 11
buffer_load_dwordx4 v[56:59], v6, s[12:15], s70 offen offset:0 sc1
buffer_load_dwordx4 v[60:63], v19, s[12:15], s70 offen offset:0 sc1
buffer_load_dwordx4 v[64:67], v6, s[12:15], s70 offen offset:1024 sc1
buffer_load_dwordx4 v[68:71], v19, s[12:15], s70 offen offset:1024 sc1
s_add_u32 s70, s89, 5
s_and_b32 s70, s70, 15
s_lshl_b32 s70, s70, 11
buffer_load_dwordx4 v[72:75], v6, s[12:15], s70 offen offset:0 sc1
buffer_load_dwordx4 v[76:79], v19, s[12:15], s70 offen offset:0 sc1
buffer_load_dwordx4 v[80:83], v6, s[12:15], s70 offen offset:1024 sc1
buffer_load_dwordx4 v[84:87], v19, s[12:15], s70 offen offset:1024 sc1
s_waitcnt vmcnt(0)
v_max3_u32 v2, v56, v60, v64
v_max_u32 v2, v2, v68
v_cmp_eq_u32 vcc, -1, v2
s_cbranch_vccnz L_o4_rt
s_branch L_o4_ok
L_o5_rt:
s_add_u32 s78, s78, 1
s_cmp_gt_u32 s78, 65536
s_cbranch_scc1 L_o5_ok
s_add_u32 s70, s89, 5
s_and_b32 s70, s70, 15
s_lshl_b32 s70, s70, 11
buffer_load_dwordx4 v[72:75], v6, s[12:15], s70 offen offset:0 sc1
buffer_load_dwordx4 v[76:79], v19, s[12:15], s70 offen offset:0 sc1
buffer_load_dwordx4 v[80:83], v6, s[12:15], s70 offen offset:1024 sc1
buffer_load_dwordx4 v[84:87], v19, s[12:15], s70 offen offset:1024 sc1
s_add_u32 s70, s89, 6
s_and_b32 s70, s70, 15
s_lshl_b32 s70, s70, 11
buffer_load_dwordx4 v[88:91], v6, s[12:15], s70 offen offset:0 sc1
buffer_load_dwordx4 v[92:95], v19, s[12:15], s70 offen offset:0 sc1
buffer_load_dwordx4 v[96:99], v6, s[12:15], s70 offen offset:1024 sc1
buffer_load_dwordx4 v[100:103], v19, s[12:15], s70 offen offset:1024 sc1
s_waitcnt vmcnt(0)
v_max3_u32 v2, v72, v76, v80
v_max_u32 v2, v2, v84
v_cmp_eq_u32 vcc, -1, v2
s_cbranch_vccnz L_o5_rt
s_branch L_o5_ok
L_o6_rt:
s_add_u32 s78, s78, 1
s_cmp_gt_u32 s78, 65536
s_cbranch_scc1 L_o6_ok
s_add_u32 s70, s89, 6
s_and_b32 s70, s70, 15
s_lshl_b32 s70, s70, 11
buffer_load_dwordx4 v[88:91], v6, s[12:15], s70 offen offset:0 sc1
buffer_load_dwordx4 v[92:95], v19, s[12:15], s70 offen offset:0 sc1
buffer_load_dwordx4 v[96:99], v6, s[12:15], s70 offen offset:1024 sc1
buffer_load_dwordx4 v[100:103], v19, s[12:15], s70 offen offset:1024 sc1
s_add_u32 s70, s89, 7
s_and_b32 s70, s70, 15
s_lshl_b32 s70, s70, 11
buffer_load_dwordx4 v[104:107], v6, s[12:15], s70 offen offset:0 sc1
buffer_load_dwordx4 v[108:111], v19, s[12:15], s70 offen offset:0 sc1
buffer_load_dwordx4 v[112:115], v6, s[12:15], s70 offen offset:1024 sc1
buffer_load_dwordx4 v[116:119], v19, s[12:15], s70 offen offset:1024 sc1
s_waitcnt vmcnt(0)
v_max3_u32 v2, v88, v92, v96
v_max_u32 v2, v2, v100
v_cmp_eq_u32 vcc, -1, v2
s_cbranch_vccnz L_o6_rt
s_branch L_o6_ok
L_o7_rt:
s_add_u32 s78, s78, 1
s_cmp_gt_u32 s78, 65536
s_cbranch_scc1 L_o7_ok
s_add_u32 s70, s89, 7
s_and_b32 s70, s70, 15
s_lshl_b32 s70, s70, 11
buffer_load_dwordx4 v[104:107], v6, s[12:15], s70 offen offset:0 sc1
buffer_load_dwordx4 v[108:111], v19, s[12:15], s70 offen offset:0 sc1
buffer_load_dwordx4 v[112:115], v6, s[12:15], s70 offen offset:1024 sc1
buffer_load_dwordx4 v[116:119], v19, s[12:15], s70 offen offset:1024 sc1
s_add_u32 s70, s89, 8
s_and_b32 s70, s70, 15
s_lshl_b32 s70, s70, 11
buffer_load_dwordx4 v[56:59], v6, s[12:15], s70 offen offset:0 sc1
buffer_load_dwordx4 v[60:63], v19, s[12:15], s70 offen offset:0 sc1
buffer_load_dwordx4 v[64:67], v6, s[12:15], s70 offen offset:1024 sc1
buffer_load_dwordx4 v[68:71], v19, s[12:15], s70 offen offset:1024 sc1
s_waitcnt vmcnt(0)
v_max3_u32 v2, v104, v108, v112
v_max_u32 v2, v2, v116
v_cmp_eq_u32 vcc, -1, v2
s_cbranch_vccnz L_o7_rt
s_branch L_o7_ok
L_o8_rt:
s_add_u32 s78, s78, 1
s_cmp_gt_u32 s78, 65536
s_cbranch_scc1 L_o8_ok
s_add_u32 s70, s89, 8
s_and_b32 s70, s70, 15
s_lshl_b32 s70, s70, 11
buffer_load_dwordx4 v[56:59], v6, s[12:15], s70 offen offset:0 sc1
buffer_load_dwordx4 v[60:63], v19, s[12:15], s70 offen offset:0 sc1
buffer_load_dwordx4 v[64:67], v6, s[12:15], s70 offen offset:1024 sc1
buffer_load_dwordx4 v[68:71], v19, s[12:15], s70 offen offset:1024 sc1
s_add_u32 s70, s89, 9
s_and_b32 s70, s70, 15
s_lshl_b32 s70, s70, 11
buffer_load_dwordx4 v[72:75], v6, s[12:15], s70 offen offset:0 sc1
buffer_load_dwordx4 v[76:79], v19, s[12:15], s70 offen offset:0 sc1
buffer_load_dwordx4 v[80:83], v6, s[12:15], s70 offen offset:1024 sc1
buffer_load_dwordx4 v[84:87], v19, s[12:15], s70 offen offset:1024 sc1
s_waitcnt vmcnt(0)
v_max3_u32 v2, v56, v60, v64
v_max_u32 v2, v2, v68
v_cmp_eq_u32 vcc, -1, v2
s_cbranch_vccnz L_o8_rt
s_branch L_o8_ok
L_o9_rt:
s_add_u32 s78, s78, 1
s_cmp_gt_u32 s78, 65536
s_cbranch_scc1 L_o9_ok
s_add_u32 s70, s89, 9
s_and_b32 s70, s70, 15
s_lshl_b32 s70, s70, 11
buffer_load_dwordx4 v[72:75], v6, s[12:15], s70 offen offset:0 sc1
buffer_load_dwordx4 v[76:79], v19, s[12:15], s70 offen offset:0 sc1
buffer_load_dwordx4 v[80:83], v6, s[12:15], s70 offen offset:1024 sc1
buffer_load_dwordx4 v[84:87], v19, s[12:15], s70 offen offset:1024 sc1
s_add_u32 s70, s89, 10
s_and_b32 s70, s70, 15
s_lshl_b32 s70, s70, 11
buffer_load_dwordx4 v[88:91], v6, s[12:15], s70 offen offset:0 sc1
buffer_load_dwordx4 v[92:95], v19, s[12:15], s70 offen offset:0 sc1
buffer_load_dwordx4 v[96:99], v6, s[12:15], s70 offen offset:1024 sc1
buffer_load_dwordx4 v[100:103], v19, s[12:15], s70 offen offset:1024 sc1
s_waitcnt vmcnt(0)
v_max3_u32 v2, v72, v76, v80
v_max_u32 v2, v2, v84
v_cmp_eq_u32 vcc, -1, v2
s_cbranch_vccnz L_o9_rt
s_branch L_o9_ok
L_o10_rt:
s_add_u32 s78, s78, 1
s_cmp_gt_u32 s78, 65536
s_cbranch_scc1 L_o10_ok
s_add_u32 s70, s89, 10
s_and_b32 s70, s70, 15
s_lshl_b32 s70, s70, 11
buffer_load_dwordx4 v[88:91], v6, s[12:15], s70 offen offset:0 sc1
buffer_load_dwordx4 v[92:95], v19, s[12:15], s70 offen offset:0 sc1
buffer_load_dwordx4 v[96:99], v6, s[12:15], s70 offen offset:1024 sc1
buffer_load_dwordx4 v[100:103], v19, s[12:15], s70 offen offset:1024 sc1
s_add_u32 s70, s89, 11
s_and_b32 s70, s70, 15
s_lshl_b32 s70, s70, 11
buffer_load_dwordx4 v[104:107], v6, s[12:15], s70 offen offset:0 sc1
buffer_load_dwordx4 v[108:111], v19, s[12:15], s70 offen offset:0 sc1
buffer_load_dwordx4 v[112:115], v6, s[12:15], s70 offen offset:1024 sc1
buffer_load_dwordx4 v[116:119], v19, s[12:15], s70 offen offset:1024 sc1
s_waitcnt vmcnt(0)
v_max3_u32 v2, v88, v92, v96
v_max_u32 v2, v2, v100
v_cmp_eq_u32 vcc, -1, v2
s_cbranch_vccnz L_o10_rt
s_branch L_o10_ok
L_o11_rt:
s_add_u32 s78, s78, 1
s_cmp_gt_u32 s78, 65536
s_cbranch_scc1 L_o11_ok
s_add_u32 s70, s89, 11
s_and_b32 s70, s70, 15
s_lshl_b32 s70, s70, 11
buffer_load_dwordx4 v[104:107], v6, s[12:15], s70 offen offset:0 sc1
buffer_load_dwordx4 v[108:111], v19, s[12:15], s70 offen offset:0 sc1
buffer_load_dwordx4 v[112:115], v6, s[12:15], s70 offen offset:1024 sc1
buffer_load_dwordx4 v[116:119], v19, s[12:15], s70 offen offset:1024 sc1
s_add_u32 s70, s89, 12
s_and_b32 s70, s70, 15
s_lshl_b32 s70, s70, 11
buffer_load_dwordx4 v[56:59], v6, s[12:15], s70 offen offset:0 sc1
buffer_load_dwordx4 v[60:63], v19, s[12:15], s70 offen offset:0 sc1
buffer_load_dwordx4 v[64:67], v6, s[12:15], s70 offen offset:1024 sc1
buffer_load_dwordx4 v[68:71], v19, s[12:15], s70 offen offset:1024 sc1
s_waitcnt vmcnt(0)
v_max3_u32 v2, v104, v108, v112
v_max_u32 v2, v2, v116
v_cmp_eq_u32 vcc, -1, v2
s_cbranch_vccnz L_o11_rt
s_branch L_o11_ok
L_o12_rt:
s_add_u32 s78, s78, 1
s_cmp_gt_u32 s78, 65536
s_cbranch_scc1 L_o12_ok
s_add_u32 s70, s89, 12
s_and_b32 s70, s70, 15
s_lshl_b32 s70, s70, 11
buffer_load_dwordx4 v[56:59], v6, s[12:15], s70 offen offset:0 sc1
buffer_load_dwordx4 v[60:63], v19, s[12:15], s70 offen offset:0 sc1
buffer_load_dwordx4 v[64:67], v6, s[12:15], s70 offen offset:1024 sc1
buffer_load_dwordx4 v[68:71], v19, s[12:15], s70 offen offset:1024 sc1
s_add_u32 s70, s89, 13
s_and_b32 s70, s70, 15
s_lshl_b32 s70, s70, 11
buffer_load_dwordx4 v[72:75], v6, s[12:15], s70 offen offset:0 sc1
buffer_load_dwordx4 v[76:79], v19, s[12:15], s70 offen offset:0 sc1
buffer_load_dwordx4 v[80:83], v6, s[12:15], s70 offen offset:1024 sc1
buffer_load_dwordx4 v[84:87], v19, s[12:15], s70 offen offset:1024 sc1
s_waitcnt vmcnt(0)
v_max3_u32 v2, v56, v60, v64
v_max_u32 v2, v2, v68
v_cmp_eq_u32 vcc, -1, v2
s_cbranch_vccnz L_o12_rt
s_branch L_o12_ok
L_o13_rt:
s_add_u32 s78, s78, 1
s_cmp_gt_u32 s78, 65536
s_cbranch_scc1 L_o13_ok
s_add_u32 s70, s89, 13
s_and_b32 s70, s70, 15
s_lshl_b32 s70, s70, 11
buffer_load_dwordx4 v[72:75], v6, s[12:15], s70 offen offset:0 sc1
buffer_load_dwordx4 v[76:79], v19, s[12:15], s70 offen offset:0 sc1
buffer_load_dwordx4 v[80:83], v6, s[12:15], s70 offen offset:1024 sc1
buffer_load_dwordx4 v[84:87], v19, s[12:15], s70 offen offset:1024 sc1
s_add_u32 s70, s89, 14
s_and_b32 s70, s70, 15
s_lshl_b32 s70, s70, 11
buffer_load_dwordx4 v[88:91], v6, s[12:15], s70 offen offset:0 sc1
buffer_load_dwordx4 v[92:95], v19, s[12:15], s70 offen offset:0 sc1
buffer_load_dwordx4 v[96:99], v6, s[12:15], s70 offen offset:1024 sc1
buffer_load_dwordx4 v[100:103], v19, s[12:15], s70 offen offset:1024 sc1
s_waitcnt vmcnt(0)
v_max3_u32 v2, v72, v76, v80
v_max_u32 v2, v2, v84
v_cmp_eq_u32 vcc, -1, v2
s_cbranch_vccnz L_o13_rt
s_branch L_o13_ok
L_o14_rt:
s_add_u32 s78, s78, 1
s_cmp_gt_u32 s78, 65536
s_cbranch_scc1 L_o14_ok
s_add_u32 s70, s89, 14
s_and_b32 s70, s70, 15
s_lshl_b32 s70, s70, 11
buffer_load_dwordx4 v[88:91], v6, s[12:15], s70 offen offset:0 sc1
buffer_load_dwordx4 v[92:95], v19, s[12:15], s70 offen offset:0 sc1
buffer_load_dwordx4 v[96:99], v6, s[12:15], s70 offen offset:1024 sc1
buffer_load_dwordx4 v[100:103], v19, s[12:15], s70 offen offset:1024 sc1
s_add_u32 s70, s89, 15
s_and_b32 s70, s70, 15
s_lshl_b32 s70, s70, 11
buffer_load_dwordx4 v[104:107], v6, s[12:15], s70 offen offset:0 sc1
buffer_load_dwordx4 v[108:111], v19, s[12:15], s70 offen offset:0 sc1
buffer_load_dwordx4 v[112:115], v6, s[12:15], s70 offen offset:1024 sc1
buffer_load_dwordx4 v[116:119], v19, s[12:15], s70 offen offset:1024 sc1
s_waitcnt vmcnt(0)
v_max3_u32 v2, v88, v92, v96
v_max_u32 v2, v2, v100
v_cmp_eq_u32 vcc, -1, v2
s_cbranch_vccnz L_o14_rt
s_branch L_o14_ok
L_o15_rt:
s_add_u32 s78, s78, 1
s_cmp_gt_u32 s78, 65536
s_cbranch_scc1 L_o15_ok
s_add_u32 s70, s89, 15
s_and_b32 s70, s70, 15
s_lshl_b32 s70, s70, 11
buffer_load_dwordx4 v[104:107], v6, s[12:15], s70 offen offset:0 sc1
buffer_load_dwordx4 v[108:111], v19, s[12:15], s70 offen offset:0 sc1
buffer_load_dwordx4 v[112:115], v6, s[12:15], s70 offen offset:1024 sc1
buffer_load_dwordx4 v[116:119], v19, s[12:15], s70 offen offset:1024 sc1
s_waitcnt vmcnt(0)
v_max3_u32 v2, v104, v108, v112
v_max_u32 v2, v2, v116
v_cmp_eq_u32 vcc, -1, v2
s_cbranch_vccnz L_o15_rt
s_branch L_o15_ok
L_stp_s:
buffer_store_dwordx4 v[72:75], v144, s[12:15], s72 offen offset:0 sc1
buffer_store_dwordx4 v[76:79], v144, s[12:15], s72 offen offset:256 sc1
s_branch L_stp_d
L_pad15:
s_branch L_retG
L_st_rt:
s_add_u32 s78, s78, 1
s_cmp_gt_u32 s78, 65536
s_cbranch_scc1 L_st_ok
v_cmp_ne_u32 vcc, s68, v99
s_cbranch_vccz L_st_p0
s_add_u32 s70, s75, 0
buffer_load_dwordx4 v[96:99], v145, s[12:15], s70 offen sc1
L_st_p0:
v_cmp_ne_u32 vcc, s68, v103
s_cbranch_vccz L_st_p1
s_add_u32 s70, s75, 4096
buffer_load_dwordx4 v[100:103], v145, s[12:15], s70 offen sc1
L_st_p1:
v_cmp_ne_u32 vcc, s68, v107
s_cbranch_vccz L_st_p2
s_add_u32 s70, s75, 8192
buffer_load_dwordx4 v[104:107], v145, s[12:15], s70 offen sc1
L_st_p2:
v_cmp_ne_u32 vcc, s68, v111
s_cbranch_vccz L_st_p3
s_add_u32 s70, s75, 12288
buffer_load_dwordx4 v[108:111], v145, s[12:15], s70 offen sc1
L_st_p3:
v_cmp_ne_u32 vcc, s68, v115
s_cbranch_vccz L_st_p4
s_add_u32 s70, s75, 16384
buffer_load_dwordx4 v[112:115], v145, s[12:15], s70 offen sc1
L_st_p4:
v_cmp_ne_u32 vcc, s68, v119
s_cbranch_vccz L_st_p5
s_add_u32 s70, s75, 20480
buffer_load_dwordx4 v[116:119], v145, s[12:15], s70 offen sc1
L_st_p5:
v_cmp_ne_u32 vcc, s68, v123
s_cbranch_vccz L_st_p6
s_add_u32 s70, s75, 24576
buffer_load_dwordx4 v[120:123], v145, s[12:15], s70 offen sc1
L_st_p6:
v_cmp_ne_u32 vcc, s68, v127
s_cbranch_vccz L_st_p7
s_add_u32 s70, s75, 28672
buffer_load_dwordx4 v[124:127], v145, s[12:15], s70 offen sc1
L_st_p7:
s_waitcnt vmcnt(0)
s_branch L_st_chk
L_fin:
.section .rodata,"a"
.p2align 6
.amdhsa_kernel sequential_preLN__linear_attn_block__moe_arch_mod__prompt_kernel
  .amdhsa_next_free_vgpr 256
  .amdhsa_next_free_sgpr 102
  .amdhsa_accum_offset 152
  .amdhsa_group_segment_fixed_size 0
  .amdhsa_kernarg_size 88
  .amdhsa_user_sgpr_count 2
  .amdhsa_user_sgpr_kernarg_segment_ptr 1
  .amdhsa_system_sgpr_workgroup_id_x 1
  .amdhsa_float_denorm_mode_32 3
.end_amdhsa_kernel
```

```asm
; @launch grid=(256,1,1) block=(512,1,1) lds=163840
.amdgcn_target "amdgcn-amd-amdhsa--gfx950"
.text
.p2alignl 12, 0xbf810000
.fill 832, 4, 0xbf810000
.globl sequential_preLN__linear_attn_block__moe_arch_mod__prompt_kernel
.p2align 8
.type sequential_preLN__linear_attn_block__moe_arch_mod__prompt_kernel,@function
sequential_preLN__linear_attn_block__moe_arch_mod__prompt_kernel:
s_cmp_ge_u32 s2, 256
s_cbranch_scc1 L_end
s_load_dwordx16 s[40:55], s[0:1], 0
s_load_dwordx2 s[56:57], s[0:1], 64
s_load_dwordx2 s[58:59], s[0:1], 80
s_getpc_b64 s[20:21]
L_pc:
s_sub_u32 s20, s20, L_pc-sequential_preLN__linear_attn_block__moe_arch_mod__prompt_kernel
s_subb_u32 s21, s21, 0
s_and_b32 s21, s21, 0xffff
s_mov_b32 s22, L_fin-sequential_preLN__linear_attn_block__moe_arch_mod__prompt_kernel
s_mov_b32 s23, 0x20000
s_lshr_b32 s70, s2, 3
s_mul_i32 s70, s70, 1536
v_lshlrev_b32 v81, 7, v0
v_cmp_gt_u32 vcc, 12, v0
s_nop 0
s_mov_b64 exec, vcc
buffer_load_dword v81, v81, s[20:23], s70 offen
s_mov_b64 exec, -1
v_lshrrev_b32 v2, 6, v0
v_and_b32 v1, 63, v0
v_readfirstlane_b32 s60, v2
s_and_b32 s62, s2, 7
s_lshr_b32 s63, s2, 3
s_lshl_b32 s64, s62, 1
s_and_b32 s70, s63, 1
s_add_u32 s64, s64, s70
s_lshr_b32 s65, s63, 1
s_lshl_b32 s79, s64, 4
s_add_u32 s79, s79, s65
s_mov_b32 s78, 0
s_mov_b32 s89, s65
s_lshr_b32 s61, s60, 2
s_and_b32 s60, s60, 3
s_lshr_b32 s66, s60, 1
s_and_b32 s67, s60, 1
v_lshlrev_b32 v16, 4, v1
s_cmp_eq_u32 s61, 0
s_cbranch_scc1 L_compute
s_setprio 1
v_mov_b32 v18, v16
s_lshl_b32 s70, s65, 2
s_add_u32 s70, s70, s60
s_lshl_b32 s70, s70, 16
v_lshrrev_b32 v2, 3, v1
v_lshlrev_b32 v5, 11, v2
v_add_u32 v5, s70, v5
v_lshrrev_b32 v3, 4, v1
v_and_b32 v4, 7, v1
v_xor_b32 v3, v3, v4
v_xor_b32 v6, 0, v3
v_lshl_add_u32 v6, v6, 4, v5
v_add_u32 v8, 0, v6
v_xor_b32 v6, 4, v3
v_lshl_add_u32 v6, v6, 4, v5
v_add_u32 v9, 15360, v6
v_xor_b32 v6, 0, v3
v_lshl_add_u32 v6, v6, 4, v5
v_add_u32 v10, 30720, v6
v_xor_b32 v6, 4, v3
v_lshl_add_u32 v6, v6, 4, v5
v_add_u32 v11, 46080, v6
s_lshl_b32 s70, s60, 4
v_add_u32 v5, s70, v2
v_mul_u32_u24 v5, 6144, v5
s_lshl_b32 s70, s64, 7
v_add_u32 v5, s70, v5
v_bfe_u32 v3, v1, 4, 1
v_lshlrev_b32 v3, 1, v3
v_xor_b32 v3, v3, v4
v_xor_b32 v6, 0, v3
v_lshl_add_u32 v6, v6, 4, v5
v_add_u32 v12, 0, v6
v_xor_b32 v6, 4, v3
v_lshl_add_u32 v6, v6, 4, v5
v_add_u32 v13, 48128, v6
v_xor_b32 v6, 0, v3
v_lshl_add_u32 v6, v6, 4, v5
v_add_u32 v14, 0, v6
v_xor_b32 v6, 4, v3
v_lshl_add_u32 v6, v6, 4, v5
v_add_u32 v15, 48128, v6
v_xor_b32 v6, 0, v3
v_lshl_add_u32 v6, v6, 4, v5
v_add_u32 v16, 4096, v6
v_xor_b32 v6, 4, v3
v_lshl_add_u32 v6, v6, 4, v5
v_add_u32 v17, 52224, v6
s_lshl_b32 s76, s60, 12
s_mul_i32 s77, s60, 6144
s_and_b32 s70, s64, 1
s_lshl_b32 s70, s70, 3
s_mov_b32 s70, 0
s_andn2_b32 s71, s65, 1
s_add_u32 s70, s70, s71
s_and_b32 s70, s70, 15
s_mul_i32 s75, s70, 393216
s_lshl_b32 s74, s70, 7
s_waitcnt lgkmcnt(0)
s_load_dword s68, s[58:59], 0
s_mov_b32 s4, s40
s_and_b32 s5, s41, 0xffff
s_mov_b32 s6, 4194304
s_mov_b32 s7, 0x20000
s_mov_b32 s8, s42
s_and_b32 s9, s43, 0xffff
s_mov_b32 s10, 6291456
s_mov_b32 s11, 0x20000
s_add_u32 m0, s76, 122880
s_nop 0
buffer_load_dwordx4 v8, s[4:7], s74 offen offset:0 lds
buffer_load_dwordx4 v9, s[4:7], s74 offen offset:1024 lds
buffer_load_dwordx4 v10, s[4:7], s74 offen offset:2048 lds
buffer_load_dwordx4 v11, s[4:7], s74 offen offset:3072 lds
s_add_u32 s74, s74, 128
s_and_b32 s74, s74, 2047
s_add_u32 m0, s77, 0
s_nop 0
buffer_load_dwordx4 v12, s[8:11], s75 offen offset:0 lds
buffer_load_dwordx4 v13, s[8:11], s75 offen offset:1024 lds
buffer_load_dwordx4 v14, s[8:11], s75 offen offset:2048 lds
buffer_load_dwordx4 v15, s[8:11], s75 offen offset:3072 lds
s_add_u32 m0, s77, 4096
s_nop 0
buffer_load_dwordx4 v16, s[8:11], s75 offen offset:0 lds
buffer_load_dwordx4 v17, s[8:11], s75 offen offset:1024 lds
s_add_u32 s75, s75, 393216
s_cmp_eq_u32 s75, 6291456
s_cselect_b32 s75, 0, s75
s_mov_b32 s12, s58
s_and_b32 s13, s59, 0xffff
s_mov_b32 s14, 268435456
s_mov_b32 s15, 0x20000
s_mov_b32 s16, s44
s_and_b32 s17, s45, 0xffff
s_mov_b32 s18, 2097152
s_mov_b32 s19, 0x20000
s_mov_b32 s20, s56
s_and_b32 s21, s57, 0xffff
s_mov_b32 s22, 4194304
s_mov_b32 s23, 0x20000
s_mov_b32 s24, s50
s_and_b32 s25, s51, 0xffff
s_mov_b32 s26, 7340032
s_mov_b32 s27, 0x20000
s_mov_b32 s28, s52
s_and_b32 s29, s53, 0xffff
s_mov_b32 s30, 7340032
s_mov_b32 s31, 0x20000
s_mov_b32 s32, s54
s_and_b32 s33, s55, 0xffff
s_mov_b32 s34, 7340032
s_mov_b32 s35, 0x20000
s_mov_b32 s36, s48
s_and_b32 s37, s49, 0xffff
s_mov_b32 s38, 2048
s_mov_b32 s39, 0x20000
s_lshl_b32 s70, s65, 7
s_lshl_b32 s71, s64, 3
s_add_u32 s70, s70, s71
s_lshl_b32 s71, s60, 1
s_add_u32 s87, s70, s71
v_lshrrev_b32 v2, 3, v1
v_lshlrev_b32 v3, 11, v2
v_bfe_u32 v5, v1, 4, 2
v_lshlrev_b32 v5, 1, v5
v_and_b32 v4, 7, v1
v_xor_b32 v5, v5, v4
v_lshl_add_u32 v3, v5, 4, v3
s_lshl_b32 s70, s65, 7
v_add_u32 v80, s70, v3
v_mov_b32 v72, -1
v_mov_b32 v73, -1
v_mov_b32 v74, -1
v_mov_b32 v75, -1
s_mul_i32 s80, s79, 4352
s_add_u32 s80, s80, 524288
s_lshl_b32 s81, s65, 18
s_lshl_b32 s70, s66, 17
s_add_u32 s81, s81, s70
s_lshl_b32 s70, s64, 11
s_add_u32 s81, s81, s70
s_lshl_b32 s70, s67, 10
s_add_u32 s81, s81, s70
s_add_u32 s81, s81, 2097152
s_mov_b32 s72, 0x6543e210
s_mov_b32 s73, 0xdcbaf987
s_lshl_b32 s70, s64, 2
s_lshr_b64 s[72:73], s[72:73], s70
s_and_b32 s3, s72, 15
v_mul_u32_u24 v76, 7168, v2
v_lshl_add_u32 v76, v4, 4, v76
v_lshlrev_b32 v77, 11, v2
v_lshl_add_u32 v77, v4, 4, v77
s_and_b32 s70, s65, 3
s_lshl_b32 s70, s70, 2
s_add_u32 s70, s70, s60
s_mul_i32 s85, s70, 458752
s_lshl_b32 s70, s3, 9
s_add_u32 s85, s85, s70
s_lshr_b32 s70, s65, 2
s_lshl_b32 s70, s70, 7
s_xor_b32 s71, s70, 128
v_add_u32 v78, s71, v76
v_add_u32 v76, s70, v76
s_and_b32 s70, s65, 3
s_lshl2_add_u32 s70, s3, s70
s_and_b32 s71, s65, 12
s_add_u32 s71, s71, s60
s_lshl_b32 s86, s70, 17
s_lshl_b32 s70, s71, 7
s_add_u32 s86, s86, s70
s_cmp_lt_u32 s3, 14
s_cselect_b32 s26, s26, 0
s_cselect_b32 s30, s30, 0
s_cselect_b32 s34, s34, 0
s_mov_b32 s90, 0x10001
s_movk_i32 s91, 0xff
v_mov_b32 v79, 0
s_lshl_b32 s70, s87, 4
s_add_u32 s70, s70, 8192
v_writelane_b32 v79, s70, 0
s_lshl_b32 s70, s79, 4
s_add_u32 s70, s70, 4096
v_writelane_b32 v79, s70, 1
s_lshl_b32 s70, s64, 7
s_add_u32 s70, s70, 6815744
v_writelane_b32 v79, s70, 2
s_lshl_b32 s70, s79, 10
s_add_u32 s70, s70, 65536
v_writelane_b32 v79, s70, 3
s_lshl_b32 s70, s60, 10
s_add_u32 s70, s70, s80
v_writelane_b32 v79, s70, 4
s_lshl_b32 s70, s67, 7
s_add_u32 s70, s70, s80
s_add_u32 s70, s70, 4096
v_writelane_b32 v79, s70, 5
s_and_b32 s71, s65, 3
s_lshl2_add_u32 s71, s3, s71
s_and_b32 s70, s65, 12
s_add_u32 s70, s70, s60
s_lshl_b32 s71, s71, 7
s_lshl_b32 s70, s70, 15
s_add_u32 s70, s70, s71
s_add_u32 s70, s70, 7340032
v_writelane_b32 v79, s70, 6
s_lshl_b32 s71, s79, 2
s_add_u32 s71, s71, s60
s_lshl_b32 s70, s71, 9
s_add_u32 s70, s70, 6291456
v_writelane_b32 v79, s70, 7
s_lshl_b32 s71, s79, 2
s_add_u32 s71, s71, s60
s_lshl_b32 s70, s71, 8
s_add_u32 s70, s70, 6946816
v_writelane_b32 v79, s70, 8
s_add_u32 s70, s81, 0
v_writelane_b32 v79, s70, 9
s_add_u32 s70, s81, 32768
v_writelane_b32 v79, s70, 10
s_add_u32 s70, s81, 65536
v_writelane_b32 v79, s70, 11
s_add_u32 s70, s81, 98304
v_writelane_b32 v79, s70, 12
s_and_b32 s70, s65, 7
s_min_u32 s71, s60, 0
s_lshl_b32 s71, s71, 3
s_add_u32 s70, s70, s71
s_lshl_b32 s70, s70, 4
s_add_u32 s70, s70, s64
s_lshl_b32 s70, s70, 7
s_add_u32 s70, s70, 6815744
v_writelane_b32 v79, s70, 2
v_and_b32 v2, 7, v1
v_lshlrev_b32 v2, 7, v2
v_lshrrev_b32 v3, 3, v1
v_lshl_add_u32 v83, v3, 15, v2
v_add_u32 v83, s81, v83
s_mov_b32 exec_lo, 0
s_and_b32 s71, s65, 3
s_lshl2_add_u32 s71, s3, s71
s_and_b32 s70, s65, 12
s_add_u32 s70, s70, s60
s_lshl_b32 s71, s71, 7
s_lshl_b32 s70, s70, 15
s_add_u32 s70, s70, s71
s_add_u32 s70, s70, 7340032
s_mov_b32 exec_hi, 0xff
v_and_b32 v2, 3, v1
v_lshl_add_u32 v83, v2, 13, s70
s_lshl_b32 s70, s60, 10
s_add_u32 s70, s70, s80
s_mov_b32 exec_hi, 0xff0000
v_and_b32 v2, 7, v1
v_lshl_add_u32 v83, v2, 7, s70
s_lshl_b32 s71, s79, 2
s_add_u32 s71, s71, s60
s_lshl_b32 s70, s71, 9
s_add_u32 s70, s70, 6291456
s_mov_b32 exec_hi, 0xf000000
v_and_b32 v2, 3, v1
v_lshl_add_u32 v83, v2, 7, s70
s_lshl_b32 s71, s79, 2
s_add_u32 s71, s71, s60
s_lshl_b32 s70, s71, 8
s_add_u32 s70, s70, 6946816
s_mov_b32 exec_hi, 0x30000000
v_and_b32 v2, 1, v1
v_lshl_add_u32 v83, v2, 7, s70
s_lshl_b32 s70, s67, 7
s_add_u32 s70, s70, s80
s_add_u32 s70, s70, 4096
s_mov_b32 exec_hi, 0xc0000000
v_and_b32 v2, 0, v1
v_lshl_add_u32 v83, v2, 7, s70
s_mov_b64 exec, -1
s_add_u32 m0, s76, 106496
s_nop 0
buffer_load_dwordx4 v8, s[4:7], s74 offen offset:0 lds
buffer_load_dwordx4 v9, s[4:7], s74 offen offset:1024 lds
buffer_load_dwordx4 v10, s[4:7], s74 offen offset:2048 lds
buffer_load_dwordx4 v11, s[4:7], s74 offen offset:3072 lds
s_add_u32 s74, s74, 128
s_and_b32 s74, s74, 2047
s_add_u32 m0, s77, 81920
s_nop 0
buffer_load_dwordx4 v12, s[8:11], s75 offen offset:0 lds
buffer_load_dwordx4 v13, s[8:11], s75 offen offset:1024 lds
buffer_load_dwordx4 v14, s[8:11], s75 offen offset:2048 lds
buffer_load_dwordx4 v15, s[8:11], s75 offen offset:3072 lds
s_add_u32 m0, s77, 86016
s_nop 0
buffer_load_dwordx4 v16, s[8:11], s75 offen offset:0 lds
buffer_load_dwordx4 v17, s[8:11], s75 offen offset:1024 lds
s_add_u32 s75, s75, 393216
s_cmp_eq_u32 s75, 6291456
s_cselect_b32 s75, 0, s75
s_waitcnt vmcnt(10)
s_barrier
s_add_u32 m0, s76, 65536
s_nop 0
buffer_load_dwordx4 v8, s[4:7], s74 offen offset:0 lds
buffer_load_dwordx4 v9, s[4:7], s74 offen offset:1024 lds
buffer_load_dwordx4 v10, s[4:7], s74 offen offset:2048 lds
buffer_load_dwordx4 v11, s[4:7], s74 offen offset:3072 lds
s_add_u32 s74, s74, 128
s_and_b32 s74, s74, 2047
s_add_u32 m0, s77, 40960
s_nop 0
buffer_load_dwordx4 v12, s[8:11], s75 offen offset:0 lds
buffer_load_dwordx4 v13, s[8:11], s75 offen offset:1024 lds
buffer_load_dwordx4 v14, s[8:11], s75 offen offset:2048 lds
buffer_load_dwordx4 v15, s[8:11], s75 offen offset:3072 lds
s_add_u32 m0, s77, 45056
s_nop 0
buffer_load_dwordx4 v16, s[8:11], s75 offen offset:0 lds
buffer_load_dwordx4 v17, s[8:11], s75 offen offset:1024 lds
s_add_u32 s75, s75, 393216
s_cmp_eq_u32 s75, 6291456
s_cselect_b32 s75, 0, s75
s_waitcnt vmcnt(10)
s_barrier
s_add_u32 m0, s76, 24576
s_nop 0
buffer_load_dwordx4 v8, s[4:7], s74 offen offset:0 lds
buffer_load_dwordx4 v9, s[4:7], s74 offen offset:1024 lds
buffer_load_dwordx4 v10, s[4:7], s74 offen offset:2048 lds
buffer_load_dwordx4 v11, s[4:7], s74 offen offset:3072 lds
s_add_u32 s74, s74, 128
s_and_b32 s74, s74, 2047
s_add_u32 m0, s77, 0
s_nop 0
buffer_load_dwordx4 v12, s[8:11], s75 offen offset:0 lds
buffer_load_dwordx4 v13, s[8:11], s75 offen offset:1024 lds
buffer_load_dwordx4 v14, s[8:11], s75 offen offset:2048 lds
buffer_load_dwordx4 v15, s[8:11], s75 offen offset:3072 lds
s_add_u32 m0, s77, 4096
s_nop 0
buffer_load_dwordx4 v16, s[8:11], s75 offen offset:0 lds
buffer_load_dwordx4 v17, s[8:11], s75 offen offset:1024 lds
s_add_u32 s75, s75, 393216
s_cmp_eq_u32 s75, 6291456
s_cselect_b32 s75, 0, s75
s_add_u32 m0, s76, 122880
s_nop 0
buffer_load_dwordx4 v8, s[4:7], s74 offen offset:0 lds
buffer_load_dwordx4 v9, s[4:7], s74 offen offset:1024 lds
buffer_load_dwordx4 v10, s[4:7], s74 offen offset:2048 lds
buffer_load_dwordx4 v11, s[4:7], s74 offen offset:3072 lds
s_add_u32 s74, s74, 128
s_and_b32 s74, s74, 2047
v_lshlrev_b32 v2, 3, v1
s_lshl_b32 s70, s60, 9
buffer_load_dwordx2 v[88:89], v2, s[36:39], s70 offen
s_lshl_b32 s70, s87, 11
buffer_load_dwordx4 v[20:23], v18, s[4:7], s70 offen offset:0
s_lshl_b32 s70, s87, 11
buffer_load_dwordx4 v[24:27], v18, s[4:7], s70 offen offset:1024
s_lshl_b32 s70, s87, 11
buffer_load_dwordx4 v[28:31], v18, s[4:7], s70 offen offset:2048
s_lshl_b32 s70, s87, 11
buffer_load_dwordx4 v[32:35], v18, s[4:7], s70 offen offset:3072
s_mov_b64 exec, 0x1fff
buffer_load_dword v81, v79, s[12:15], 0 offen
s_mov_b64 exec, -1
s_lshl_b32 s70, s64, 2
s_add_u32 s70, s70, s60
s_lshl_b32 s70, s70, 12
s_lshl_b32 s71, s65, 7
s_add_u32 s70, s70, s71
s_add_u32 s70, s70, 7864320
s_mov_b64 exec, 0xffff
buffer_store_dwordx4 v[72:75], v77, s[12:15], s70 offen sc1
s_mov_b64 exec, -1
s_waitcnt vmcnt(21)
s_barrier
s_add_u32 m0, s77, 81920
s_nop 0
buffer_load_dwordx4 v12, s[8:11], s75 offen offset:0 lds
buffer_load_dwordx4 v13, s[8:11], s75 offen offset:1024 lds
buffer_load_dwordx4 v14, s[8:11], s75 offen offset:2048 lds
buffer_load_dwordx4 v15, s[8:11], s75 offen offset:3072 lds
s_add_u32 m0, s77, 86016
s_nop 0
buffer_load_dwordx4 v16, s[8:11], s75 offen offset:0 lds
buffer_load_dwordx4 v17, s[8:11], s75 offen offset:1024 lds
s_add_u32 s75, s75, 393216
s_cmp_eq_u32 s75, 6291456
s_cselect_b32 s75, 0, s75
s_add_u32 m0, s76, 106496
s_nop 0
buffer_load_dwordx4 v8, s[4:7], s74 offen offset:0 lds
buffer_load_dwordx4 v9, s[4:7], s74 offen offset:1024 lds
buffer_load_dwordx4 v10, s[4:7], s74 offen offset:2048 lds
buffer_load_dwordx4 v11, s[4:7], s74 offen offset:3072 lds
s_add_u32 s74, s74, 128
s_and_b32 s74, s74, 2047
s_waitcnt vmcnt(21)
s_barrier
s_add_u32 m0, s77, 40960
s_nop 0
buffer_load_dwordx4 v12, s[8:11], s75 offen offset:0 lds
s_waitcnt vmcnt(13)
s_waitcnt lgkmcnt(0)
s_add_u32 s68, s68, 1
s_and_b32 s84, s68, 0xff
s_not_b32 s70, s68
v_and_b32 v82, 3, v1
v_lshrrev_b32_e64 v82, v82, s70
v_and_b32 v82, 1, v82
v_mul_u32_u24 v82, 0x10001, v82
buffer_load_dwordx4 v13, s[8:11], s75 offen offset:1024 lds
v_lshlrev_b32 v36, 16, v20
v_and_b32 v37, 0xffff0000, v20
v_lshlrev_b32 v38, 16, v21
v_and_b32 v39, 0xffff0000, v21
v_lshlrev_b32 v40, 16, v22
buffer_load_dwordx4 v14, s[8:11], s75 offen offset:2048 lds
v_and_b32 v41, 0xffff0000, v22
v_lshlrev_b32 v42, 16, v23
v_and_b32 v43, 0xffff0000, v23
v_lshlrev_b32 v44, 16, v24
v_and_b32 v45, 0xffff0000, v24
buffer_load_dwordx4 v15, s[8:11], s75 offen offset:3072 lds
v_lshlrev_b32 v46, 16, v25
v_and_b32 v47, 0xffff0000, v25
v_lshlrev_b32 v48, 16, v26
v_and_b32 v49, 0xffff0000, v26
v_lshlrev_b32 v50, 16, v27
s_add_u32 m0, s77, 45056
s_nop 0
buffer_load_dwordx4 v16, s[8:11], s75 offen offset:0 lds
v_and_b32 v51, 0xffff0000, v27
v_lshlrev_b32 v52, 16, v28
v_and_b32 v53, 0xffff0000, v28
v_lshlrev_b32 v54, 16, v29
v_and_b32 v55, 0xffff0000, v29
buffer_load_dwordx4 v17, s[8:11], s75 offen offset:1024 lds
s_add_u32 s75, s75, 393216
s_cmp_eq_u32 s75, 6291456
s_cselect_b32 s75, 0, s75
v_lshlrev_b32 v56, 16, v30
v_and_b32 v57, 0xffff0000, v30
v_lshlrev_b32 v58, 16, v31
v_and_b32 v59, 0xffff0000, v31
v_lshlrev_b32 v60, 16, v32
s_add_u32 m0, s76, 65536
s_nop 0
buffer_load_dwordx4 v8, s[4:7], s74 offen offset:0 lds
v_and_b32 v61, 0xffff0000, v32
v_lshlrev_b32 v62, 16, v33
v_and_b32 v63, 0xffff0000, v33
v_lshlrev_b32 v64, 16, v34
v_and_b32 v65, 0xffff0000, v34
buffer_load_dwordx4 v9, s[4:7], s74 offen offset:1024 lds
v_lshlrev_b32 v66, 16, v35
v_and_b32 v67, 0xffff0000, v35
v_add_f32 v20, v36, v40
v_add_f32 v28, v52, v56
v_add_f32 v21, v37, v41
buffer_load_dwordx4 v10, s[4:7], s74 offen offset:2048 lds
v_add_f32 v29, v53, v57
v_add_f32 v22, v38, v42
v_add_f32 v30, v54, v58
v_add_f32 v23, v39, v43
v_add_f32 v31, v55, v59
buffer_load_dwordx4 v11, s[4:7], s74 offen offset:3072 lds
s_add_u32 s74, s74, 128
s_and_b32 s74, s74, 2047
v_add_f32 v20, v20, v44
v_add_f32 v28, v28, v60
s_waitcnt vmcnt(14)
s_barrier
s_add_u32 m0, s77, 0
s_nop 0
buffer_load_dwordx4 v12, s[8:11], s75 offen offset:0 lds
v_add_f32 v21, v21, v45
v_add_f32 v29, v29, v61
v_add_f32 v22, v22, v46
v_add_f32 v30, v30, v62
v_add_f32 v23, v23, v47
buffer_load_dwordx4 v13, s[8:11], s75 offen offset:1024 lds
v_add_f32 v31, v31, v63
v_add_f32 v20, v20, v48
v_add_f32 v28, v28, v64
v_add_f32 v21, v21, v49
v_add_f32 v29, v29, v65
buffer_load_dwordx4 v14, s[8:11], s75 offen offset:2048 lds
v_add_f32 v22, v22, v50
v_add_f32 v30, v30, v66
v_add_f32 v23, v23, v51
v_add_f32 v31, v31, v67
v_add_f32 v20, v20, v21
buffer_load_dwordx4 v15, s[8:11], s75 offen offset:3072 lds
v_add_f32 v22, v22, v23
v_add_f32 v28, v28, v29
v_add_f32 v30, v30, v31
v_add_f32 v2, v20, v22
v_add_f32 v4, v28, v30
s_add_u32 m0, s77, 4096
s_nop 0
buffer_load_dwordx4 v16, s[8:11], s75 offen offset:0 lds
v_add_f32_dpp v2, v2, v2 row_ror:1 row_mask:0xf bank_mask:0xf
v_add_f32_dpp v4, v4, v4 row_ror:1 row_mask:0xf bank_mask:0xf
s_nop 0
v_add_f32_dpp v2, v2, v2 row_ror:2 row_mask:0xf bank_mask:0xf
v_add_f32_dpp v4, v4, v4 row_ror:2 row_mask:0xf bank_mask:0xf
s_nop 0
v_add_f32_dpp v2, v2, v2 row_ror:4 row_mask:0xf bank_mask:0xf
buffer_load_dwordx4 v17, s[8:11], s75 offen offset:1024 lds
s_add_u32 s75, s75, 393216
s_cmp_eq_u32 s75, 6291456
s_cselect_b32 s75, 0, s75
v_add_f32_dpp v4, v4, v4 row_ror:4 row_mask:0xf bank_mask:0xf
v_add_f32_dpp v2, v2, v2 row_ror:8 row_mask:0xf bank_mask:0xf
s_nop 0
v_add_f32_dpp v4, v4, v4 row_ror:8 row_mask:0xf bank_mask:0xf
v_mov_b32 v6, v2
v_mov_b32 v7, v4
s_add_u32 m0, s76, 24576
s_nop 0
buffer_load_dwordx4 v8, s[4:7], s74 offen offset:0 lds
v_permlane16_swap_b32 v2, v6
v_permlane16_swap_b32 v4, v7
v_add_f32 v2, v2, v6
v_add_f32 v4, v4, v7
v_mov_b32 v6, v2
buffer_load_dwordx4 v9, s[4:7], s74 offen offset:1024 lds
v_mov_b32 v7, v4
v_permlane32_swap_b32 v2, v6
s_nop 0
v_permlane32_swap_b32 v4, v7
v_add_f32 v2, v2, v6
v_add_f32 v4, v4, v7
buffer_load_dwordx4 v10, s[4:7], s74 offen offset:2048 lds
v_mul_f32 v2, 0xba800000, v2
v_mul_f32 v4, 0xba800000, v4
v_add_f32 v36, v36, v2
v_add_f32 v52, v52, v4
v_add_f32 v37, v37, v2
buffer_load_dwordx4 v11, s[4:7], s74 offen offset:3072 lds
s_add_u32 s74, s74, 128
s_and_b32 s74, s74, 2047
v_add_f32 v53, v53, v4
v_add_f32 v38, v38, v2
s_cmp_eq_u32 s60, 0
s_cbranch_scc1 L_pad0
s_cmp_eq_u32 s60, 1
s_cbranch_scc1 L_pad3
s_cmp_eq_u32 s60, 2
s_cbranch_scc1 L_pad4
s_branch L_ret4
L_ret4:
s_waitcnt vmcnt(14)
s_barrier
s_add_u32 m0, s77, 81920
s_nop 0
buffer_load_dwordx4 v12, s[8:11], s75 offen offset:0 lds
v_add_f32 v54, v54, v4
v_add_f32 v39, v39, v2
v_add_f32 v55, v55, v4
v_add_f32 v40, v40, v2
v_add_f32 v56, v56, v4
buffer_load_dwordx4 v13, s[8:11], s75 offen offset:1024 lds
v_add_f32 v41, v41, v2
v_add_f32 v57, v57, v4
v_add_f32 v42, v42, v2
v_add_f32 v58, v58, v4
v_add_f32 v43, v43, v2
buffer_load_dwordx4 v14, s[8:11], s75 offen offset:2048 lds
v_add_f32 v59, v59, v4
v_add_f32 v44, v44, v2
v_add_f32 v60, v60, v4
v_add_f32 v45, v45, v2
v_add_f32 v61, v61, v4
buffer_load_dwordx4 v15, s[8:11], s75 offen offset:3072 lds
v_add_f32 v46, v46, v2
v_add_f32 v62, v62, v4
v_add_f32 v47, v47, v2
v_add_f32 v63, v63, v4
v_add_f32 v48, v48, v2
s_add_u32 m0, s77, 86016
s_nop 0
buffer_load_dwordx4 v16, s[8:11], s75 offen offset:0 lds
v_add_f32 v64, v64, v4
v_add_f32 v49, v49, v2
v_add_f32 v65, v65, v4
v_add_f32 v50, v50, v2
v_add_f32 v66, v66, v4
buffer_load_dwordx4 v17, s[8:11], s75 offen offset:1024 lds
s_add_u32 s75, s75, 393216
s_cmp_eq_u32 s75, 6291456
s_cselect_b32 s75, 0, s75
v_add_f32 v51, v51, v2
v_add_f32 v67, v67, v4
v_mul_f32 v20, v36, v36
v_mul_f32 v28, v52, v52
v_mul_f32 v21, v37, v37
s_add_u32 m0, s76, 122880
s_nop 0
buffer_load_dwordx4 v8, s[4:7], s74 offen offset:0 lds
v_mul_f32 v29, v53, v53
v_fmac_f32 v20, v38, v38
v_fmac_f32 v28, v54, v54
v_fmac_f32 v21, v39, v39
v_fmac_f32 v29, v55, v55
buffer_load_dwordx4 v9, s[4:7], s74 offen offset:1024 lds
v_fmac_f32 v20, v40, v40
v_fmac_f32 v28, v56, v56
v_fmac_f32 v21, v41, v41
v_fmac_f32 v29, v57, v57
v_fmac_f32 v20, v42, v42
buffer_load_dwordx4 v10, s[4:7], s74 offen offset:2048 lds
v_fmac_f32 v28, v58, v58
v_fmac_f32 v21, v43, v43
v_fmac_f32 v29, v59, v59
v_fmac_f32 v20, v44, v44
v_fmac_f32 v28, v60, v60
buffer_load_dwordx4 v11, s[4:7], s74 offen offset:3072 lds
s_add_u32 s74, s74, 128
s_and_b32 s74, s74, 2047
v_fmac_f32 v21, v45, v45
v_fmac_f32 v29, v61, v61
s_waitcnt vmcnt(14)
s_barrier
s_add_u32 m0, s77, 40960
s_nop 0
buffer_load_dwordx4 v12, s[8:11], s75 offen offset:0 lds
v_fmac_f32 v20, v46, v46
v_fmac_f32 v28, v62, v62
v_fmac_f32 v21, v47, v47
v_fmac_f32 v29, v63, v63
v_fmac_f32 v20, v48, v48
buffer_load_dwordx4 v13, s[8:11], s75 offen offset:1024 lds
v_fmac_f32 v28, v64, v64
v_fmac_f32 v21, v49, v49
v_fmac_f32 v29, v65, v65
v_fmac_f32 v20, v50, v50
v_fmac_f32 v28, v66, v66
buffer_load_dwordx4 v14, s[8:11], s75 offen offset:2048 lds
v_fmac_f32 v21, v51, v51
v_fmac_f32 v29, v67, v67
v_add_f32 v3, v20, v21
v_add_f32 v5, v28, v29
s_nop 0
v_add_f32_dpp v3, v3, v3 row_ror:1 row_mask:0xf bank_mask:0xf
buffer_load_dwordx4 v15, s[8:11], s75 offen offset:3072 lds
v_add_f32_dpp v5, v5, v5 row_ror:1 row_mask:0xf bank_mask:0xf
v_add_f32_dpp v3, v3, v3 row_ror:2 row_mask:0xf bank_mask:0xf
s_nop 0
v_add_f32_dpp v5, v5, v5 row_ror:2 row_mask:0xf bank_mask:0xf
v_add_f32_dpp v3, v3, v3 row_ror:4 row_mask:0xf bank_mask:0xf
s_nop 0
v_add_f32_dpp v5, v5, v5 row_ror:4 row_mask:0xf bank_mask:0xf
s_add_u32 m0, s77, 45056
s_nop 0
buffer_load_dwordx4 v16, s[8:11], s75 offen offset:0 lds
v_add_f32_dpp v3, v3, v3 row_ror:8 row_mask:0xf bank_mask:0xf
v_add_f32_dpp v5, v5, v5 row_ror:8 row_mask:0xf bank_mask:0xf
v_mov_b32 v6, v3
v_mov_b32 v7, v5
s_nop 0
v_permlane16_swap_b32 v3, v6
buffer_load_dwordx4 v17, s[8:11], s75 offen offset:1024 lds
s_add_u32 s75, s75, 393216
s_cmp_eq_u32 s75, 6291456
s_cselect_b32 s75, 0, s75
v_permlane16_swap_b32 v5, v7
v_add_f32 v3, v3, v6
v_add_f32 v5, v5, v7
v_mov_b32 v6, v3
v_mov_b32 v7, v5
s_add_u32 m0, s76, 106496
s_branch L_over0
L_pad0:
s_branch L_ret4
L_over0:
s_nop 0
buffer_load_dwordx4 v8, s[4:7], s74 offen offset:0 lds
v_permlane32_swap_b32 v3, v6
v_permlane32_swap_b32 v5, v7
v_add_f32 v3, v3, v6
v_add_f32 v5, v5, v7
v_mov_b32 v6, 0x3727c5ac
buffer_load_dwordx4 v9, s[4:7], s74 offen offset:1024 lds
v_fmac_f32 v6, 0x3a800000, v3
v_rsq_f32 v3, v6
v_mov_b32 v6, 0x3727c5ac
v_fmac_f32 v6, 0x3a800000, v5
v_rsq_f32 v5, v6
buffer_load_dwordx4 v10, s[4:7], s74 offen offset:2048 lds
v_cmp_eq_u32 vcc, 1, v1
s_nop 1
v_cndmask_b32 v20, v2, v4, vcc
v_cndmask_b32 v21, v3, v5, vcc
v_mov_b32 v22, 0
v_mov_b32 v23, s68
buffer_load_dwordx4 v11, s[4:7], s74 offen offset:3072 lds
s_add_u32 s74, s74, 128
s_and_b32 s74, s74, 2047
buffer_load_dwordx4 a[0:3], v76, s[24:27], s85 offen nt
buffer_load_dwordx4 a[32:35], v78, s[28:31], s85 offen nt
s_add_u32 s85, s85, 57344
buffer_load_dwordx4 a[4:7], v76, s[24:27], s85 offen nt
buffer_load_dwordx4 a[36:39], v78, s[28:31], s85 offen nt
s_add_u32 s85, s85, 57344
buffer_load_dwordx4 a[8:11], v76, s[24:27], s85 offen nt
buffer_load_dwordx4 a[40:43], v78, s[28:31], s85 offen nt
s_add_u32 s85, s85, 57344
s_lshl_b32 s70, s87, 4
s_add_u32 s70, s70, 8192
s_mov_b64 exec, 3
buffer_store_dwordx4 v[20:23], v18, s[12:15], s70 offen sc1
s_mov_b64 exec, -1
s_waitcnt vmcnt(21)
s_barrier
s_add_u32 m0, s77, 0
s_nop 0
buffer_load_dwordx4 v12, s[8:11], s75 offen offset:0 lds
v_lshlrev_b32 v2, 16, v88
v_and_b32 v3, 0xffff0000, v88
v_lshlrev_b32 v4, 16, v89
buffer_load_dwordx4 v13, s[8:11], s75 offen offset:1024 lds
v_and_b32 v5, 0xffff0000, v89
v_add_f32 v2, v2, v3
v_add_f32 v4, v4, v5
buffer_load_dwordx4 v14, s[8:11], s75 offen offset:2048 lds
v_add_f32 v2, v2, v4
s_nop 1
v_add_f32_dpp v2, v2, v2 row_ror:1 row_mask:0xf bank_mask:0xf
s_nop 1
v_add_f32_dpp v2, v2, v2 row_ror:2 row_mask:0xf bank_mask:0xf
buffer_load_dwordx4 v15, s[8:11], s75 offen offset:3072 lds
s_nop 0
v_add_f32_dpp v2, v2, v2 row_ror:4 row_mask:0xf bank_mask:0xf
s_nop 1
v_add_f32_dpp v2, v2, v2 row_ror:8 row_mask:0xf bank_mask:0xf
v_mov_b32 v3, v2
s_add_u32 m0, s77, 4096
s_nop 0
buffer_load_dwordx4 v16, s[8:11], s75 offen offset:0 lds
v_permlane16_swap_b32 v2, v3
v_add_f32 v2, v2, v3
v_mov_b32 v3, v2
buffer_load_dwordx4 v17, s[8:11], s75 offen offset:1024 lds
s_add_u32 s75, s75, 393216
s_cmp_eq_u32 s75, 6291456
s_cselect_b32 s75, 0, s75
v_permlane32_swap_b32 v2, v3
v_add_f32 v2, v2, v3
s_lshl_b32 s70, s60, 2
s_add_u32 s70, s70, 162176
v_mov_b32 v3, s70
s_add_u32 m0, s76, 65536
s_nop 0
buffer_load_dwordx4 v8, s[4:7], s74 offen offset:0 lds
ds_write_b32 v3, v2
s_lshl_b32 s70, s60, 2
s_sub_u32 s70, s70, s65
s_lshl_b32 s70, s70, 4
v_add_u32 v4, s70, v1
v_min_u32 v4, 18, v4
buffer_load_dwordx4 v9, s[4:7], s74 offen offset:1024 lds
v_cmp_gt_u32 vcc, 16, v4
s_nop 1
v_cndmask_b32 v4, 18, v4, vcc
v_lshlrev_b32 v4, 3, v4
buffer_load_dwordx4 v10, s[4:7], s74 offen offset:2048 lds
v_add_u32 v4, 162048, v4
ds_write_b64 v4, v[88:89]
buffer_load_dwordx4 v11, s[4:7], s74 offen offset:3072 lds
s_add_u32 s74, s74, 128
s_and_b32 s74, s74, 2047
s_waitcnt vmcnt(21)
s_barrier
s_add_u32 m0, s77, 81920
s_nop 0
buffer_load_dwordx4 v12, s[8:11], s75 offen offset:0 lds
s_getreg_b32 s71, hwreg(HW_REG_XCC_ID, 0, 4)
v_mov_b32 v84, s71
buffer_load_dwordx4 v13, s[8:11], s75 offen offset:1024 lds
v_mov_b32 v85, 0
buffer_load_dwordx4 v14, s[8:11], s75 offen offset:2048 lds
v_mov_b32 v86, 0
buffer_load_dwordx4 v15, s[8:11], s75 offen offset:3072 lds
v_mov_b32 v87, s68
s_add_u32 m0, s77, 86016
s_nop 0
buffer_load_dwordx4 v16, s[8:11], s75 offen offset:0 lds
s_lshl_b32 s70, s79, 4
s_add_u32 s70, s70, 4096
v_mov_b32 v19, s70
buffer_load_dwordx4 v17, s[8:11], s75 offen offset:1024 lds
s_add_u32 s75, s75, 393216
s_cmp_eq_u32 s75, 6291456
s_cselect_b32 s75, 0, s75
s_lshl_b32 s70, s65, 4
s_add_u32 s70, s70, s64
s_lshl_b32 s70, s70, 4
s_add_u32 s70, s70, 40960
v_writelane_b32 v19, s70, 1
s_add_u32 m0, s76, 24576
s_nop 0
buffer_load_dwordx4 v8, s[4:7], s74 offen offset:0 lds
buffer_load_dwordx4 v9, s[4:7], s74 offen offset:1024 lds
buffer_load_dwordx4 v10, s[4:7], s74 offen offset:2048 lds
buffer_load_dwordx4 v11, s[4:7], s74 offen offset:3072 lds
s_add_u32 s74, s74, 128
s_and_b32 s74, s74, 2047
buffer_load_dwordx4 a[12:15], v76, s[24:27], s85 offen nt
buffer_load_dwordx4 a[44:47], v78, s[28:31], s85 offen nt
s_add_u32 s85, s85, 57344
buffer_load_dwordx4 a[16:19], v76, s[24:27], s85 offen nt
buffer_load_dwordx4 a[48:51], v78, s[28:31], s85 offen nt
s_add_u32 s85, s85, 57344
buffer_load_dwordx4 a[20:23], v76, s[24:27], s85 offen nt
buffer_load_dwordx4 a[52:55], v78, s[28:31], s85 offen nt
s_add_u32 s85, s85, 57344
s_mov_b64 exec, 3
buffer_store_dwordx4 v[84:87], v19, s[12:15], 0 offen sc1
s_mov_b64 exec, -1
s_waitcnt vmcnt(21)
s_barrier
s_add_u32 m0, s77, 40960
s_nop 0
buffer_load_dwordx4 v12, s[8:11], s75 offen offset:0 lds
buffer_load_dwordx4 v13, s[8:11], s75 offen offset:1024 lds
buffer_load_dwordx4 v14, s[8:11], s75 offen offset:2048 lds
buffer_load_dwordx4 v15, s[8:11], s75 offen offset:3072 lds
s_add_u32 m0, s77, 45056
s_nop 0
buffer_load_dwordx4 v16, s[8:11], s75 offen offset:0 lds
buffer_load_dwordx4 v17, s[8:11], s75 offen offset:1024 lds
s_add_u32 s75, s75, 393216
s_cmp_eq_u32 s75, 6291456
s_cselect_b32 s75, 0, s75
s_add_u32 m0, s76, 122880
s_nop 0
buffer_load_dwordx4 v8, s[4:7], s74 offen offset:0 lds
buffer_load_dwordx4 v9, s[4:7], s74 offen offset:1024 lds
buffer_load_dwordx4 v10, s[4:7], s74 offen offset:2048 lds
buffer_load_dwordx4 v11, s[4:7], s74 offen offset:3072 lds
s_add_u32 s74, s74, 128
s_and_b32 s74, s74, 2047
s_cmp_eq_u32 s60, 0
s_cbranch_scc1 L_pad5
s_cmp_eq_u32 s60, 1
s_cbranch_scc1 L_ret9
s_cmp_eq_u32 s60, 2
s_cbranch_scc1 L_ret9
s_branch L_ret9
L_ret9:
s_waitcnt vmcnt(21)
s_barrier
s_add_u32 m0, s77, 0
s_nop 0
buffer_load_dwordx4 v12, s[8:11], s75 offen offset:0 lds
buffer_load_dwordx4 v13, s[8:11], s75 offen offset:1024 lds
buffer_load_dwordx4 v14, s[8:11], s75 offen offset:2048 lds
buffer_load_dwordx4 v15, s[8:11], s75 offen offset:3072 lds
s_add_u32 m0, s77, 4096
s_nop 0
buffer_load_dwordx4 v16, s[8:11], s75 offen offset:0 lds
buffer_load_dwordx4 v17, s[8:11], s75 offen offset:1024 lds
s_add_u32 s75, s75, 393216
s_cmp_eq_u32 s75, 6291456
s_cselect_b32 s75, 0, s75
s_add_u32 m0, s76, 106496
s_nop 0
buffer_load_dwordx4 v8, s[4:7], s74 offen offset:0 lds
buffer_load_dwordx4 v9, s[4:7], s74 offen offset:1024 lds
buffer_load_dwordx4 v10, s[4:7], s74 offen offset:2048 lds
buffer_load_dwordx4 v11, s[4:7], s74 offen offset:3072 lds
s_add_u32 s74, s74, 128
s_and_b32 s74, s74, 2047
buffer_load_dwordx4 a[24:27], v76, s[24:27], s85 offen nt
buffer_load_dwordx4 a[56:59], v78, s[28:31], s85 offen nt
s_add_u32 s85, s85, 57344
buffer_load_dwordx4 a[28:31], v76, s[24:27], s85 offen nt
buffer_load_dwordx4 a[60:63], v78, s[28:31], s85 offen nt
s_add_u32 s85, s85, 57344
buffer_load_dwordx4 a[64:67], v77, s[32:35], s86 offen nt
s_add_u32 s86, s86, 16384
buffer_load_dwordx4 a[68:71], v77, s[32:35], s86 offen nt
s_add_u32 s86, s86, 16384
s_waitcnt vmcnt(20)
s_barrier
s_add_u32 m0, s77, 81920
s_nop 0
buffer_load_dwordx4 v12, s[8:11], s75 offen offset:0 lds
v_lshrrev_b32 v2, 4, v1
v_and_b32 v3, 15, v1
buffer_load_dwordx4 v13, s[8:11], s75 offen offset:1024 lds
v_lshlrev_b32 v44, 10, v2
v_lshl_add_u32 v44, v3, 4, v44
buffer_load_dwordx4 v14, s[8:11], s75 offen offset:2048 lds
s_lshl_b32 s70, s60, 8
v_add_u32 v44, s70, v44
s_lshl_b32 s87, s64, 14
s_add_u32 s87, s87, 65536
buffer_load_dwordx4 v15, s[8:11], s75 offen offset:3072 lds
v_and_b32 v45, 31, v1
v_lshlrev_b32 v45, 4, v45
s_add_u32 m0, s77, 86016
s_nop 0
buffer_load_dwordx4 v16, s[8:11], s75 offen offset:0 lds
s_lshl_b32 s88, s65, 11
s_lshl_b32 s70, s60, 9
s_add_u32 s88, s88, s70
s_add_u32 s88, s88, 8192
s_lshl_b32 s70, s64, 8
s_add_u32 s70, s70, 4096
v_lshlrev_b32 v4, 4, v3
v_add_u32 v4, s70, v4
buffer_load_dwordx4 v17, s[8:11], s75 offen offset:1024 lds
s_add_u32 s75, s75, 393216
s_cmp_eq_u32 s75, 6291456
s_cselect_b32 s75, 0, s75
v_add_u32 v5, 36864, v4
v_and_b32 v6, 1, v2
s_add_u32 m0, s76, 65536
s_nop 0
buffer_load_dwordx4 v8, s[4:7], s74 offen offset:0 lds
v_cmp_eq_u32 vcc, 1, v6
s_nop 1
v_cndmask_b32 v46, v4, v5, vcc
buffer_load_dwordx4 v9, s[4:7], s74 offen offset:1024 lds
buffer_load_dwordx4 v10, s[4:7], s74 offen offset:2048 lds
buffer_load_dwordx4 v11, s[4:7], s74 offen offset:3072 lds
s_add_u32 s74, s74, 128
s_and_b32 s74, s74, 2047
s_add_u32 s70, s87, 0
buffer_load_dwordx4 v[20:23], v44, s[12:15], s70 offen sc1
buffer_load_dwordx4 v[36:39], v45, s[12:15], s88 offen sc1
buffer_load_dwordx4 v[40:43], v46, s[12:15], 0 offen offset:0 sc1
s_waitcnt vmcnt(23)
s_barrier
s_add_u32 m0, s77, 40960
s_nop 0
buffer_load_dwordx4 v12, s[8:11], s75 offen offset:0 lds
buffer_load_dwordx4 v13, s[8:11], s75 offen offset:1024 lds
buffer_load_dwordx4 v14, s[8:11], s75 offen offset:2048 lds
buffer_load_dwordx4 v15, s[8:11], s75 offen offset:3072 lds
s_add_u32 m0, s77, 45056
s_nop 0
buffer_load_dwordx4 v16, s[8:11], s75 offen offset:0 lds
buffer_load_dwordx4 v17, s[8:11], s75 offen offset:1024 lds
s_add_u32 s75, s75, 393216
s_cmp_eq_u32 s75, 6291456
s_cselect_b32 s75, 0, s75
s_add_u32 m0, s76, 24576
s_nop 0
buffer_load_dwordx4 v8, s[4:7], s74 offen offset:0 lds
buffer_load_dwordx4 v9, s[4:7], s74 offen offset:1024 lds
buffer_load_dwordx4 v10, s[4:7], s74 offen offset:2048 lds
buffer_load_dwordx4 v11, s[4:7], s74 offen offset:3072 lds
s_add_u32 s74, s74, 128
s_and_b32 s74, s74, 2047
buffer_load_dwordx4 a[72:75], v77, s[32:35], s86 offen nt
s_add_u32 s86, s86, 16384
buffer_load_dwordx4 a[76:79], v77, s[32:35], s86 offen nt
s_add_u32 s86, s86, 16384
buffer_load_dwordx4 a[80:83], v77, s[32:35], s86 offen nt
s_add_u32 s86, s86, 16384
s_waitcnt vmcnt(20)
s_barrier
s_add_u32 m0, s77, 0
s_nop 0
buffer_load_dwordx4 v12, s[8:11], s75 offen offset:0 lds
s_waitcnt vmcnt(14)
L_eg_chk:
v_xor_b32 v2, s68, v23
v_xor_b32 v3, s68, v39
v_xor_b32 v4, s68, v43
v_or3_b32 v2, v2, v3, v4
v_cmp_ne_u32 vcc, 0, v2
s_cbranch_vccnz L_eg_rt
L_eg_ok:
v_mov_b32 v24, v20
v_mov_b32 v25, v21
buffer_load_dwordx4 v13, s[8:11], s75 offen offset:1024 lds
v_mov_b32 v26, v22
v_permlane16_swap_b32 v20, v24
v_permlane16_swap_b32 v21, v25
buffer_load_dwordx4 v14, s[8:11], s75 offen offset:2048 lds
v_permlane16_swap_b32 v22, v26
v_add_f32 v20, v20, v24
v_add_f32 v21, v21, v25
buffer_load_dwordx4 v15, s[8:11], s75 offen offset:3072 lds
v_add_f32 v22, v22, v26
v_mov_b32 v24, v20
v_mov_b32 v25, v21
s_add_u32 m0, s77, 4096
s_nop 0
buffer_load_dwordx4 v16, s[8:11], s75 offen offset:0 lds
v_mov_b32 v26, v22
v_permlane32_swap_b32 v20, v24
v_permlane32_swap_b32 v21, v25
buffer_load_dwordx4 v17, s[8:11], s75 offen offset:1024 lds
s_add_u32 s75, s75, 393216
s_cmp_eq_u32 s75, 6291456
s_cselect_b32 s75, 0, s75
v_permlane32_swap_b32 v22, v26
v_add_f32 v20, v20, v24
s_lshl_b32 s70, s63, 2
s_add_u32 s70, s70, s60
s_lshl_b32 s70, s70, 14
v_lshlrev_b32 v81, 10, v1
s_mov_b64 exec, 0xffff
buffer_load_dword v81, v81, s[16:19], s70 offen offset:384
s_mov_b64 exec, -1
buffer_load_dwordx4 a[84:87], v77, s[32:35], s86 offen nt
s_add_u32 s86, s86, 16384
buffer_load_dwordx4 a[88:91], v77, s[32:35], s86 offen nt
s_add_u32 s86, s86, 16384
buffer_load_dwordx4 a[92:95], v77, s[32:35], s86 offen nt
s_add_u32 s86, s86, 16384
s_waitcnt vmcnt(17)
s_barrier
s_mul_i32 s70, s60, 2
s_add_u32 s70, s70, 120
s_lshl_b32 s82, s89, 3
s_add_u32 s82, s82, s70
s_lshl_b32 s70, s70, 10
s_add_u32 m0, s70, 28672
s_and_b32 s82, s82, 127
s_lshl_b32 s82, s82, 14
buffer_load_dwordx4 v80, s[16:19], s82 offen lds
v_add_f32 v21, v21, v25
v_add_f32 v22, v22, v26
v_and_b32 v3, 15, v1
v_lshlrev_b32 v3, 2, v3
s_lshl_b32 s70, s60, 6
s_add_u32 s70, s70, 160768
v_add_u32 v3, s70, v3
ds_write_b32 v3, v20 offset:0
ds_write_b32 v3, v21 offset:256
ds_write_b32 v3, v22 offset:512
s_add_u32 m0, m0, 1024
s_add_u32 s82, s82, 16384
s_and_b32 s82, s82, 0x1fffff
buffer_load_dwordx4 v80, s[16:19], s82 offen lds
v_lshrrev_b32 v4, 2, v45
s_lshl_b32 s70, s60, 7
s_add_u32 s70, s70, 159744
v_add_u32 v4, s70, v4
ds_write_b32 v4, v36
ds_write_b32 v4, v37 offset:512
s_getreg_b32 s71, hwreg(HW_REG_XCC_ID, 0, 4)
v_cmp_ne_u32 vcc, s71, v40
s_nop 0
s_and_b32 s70, vcc_lo, 0xffff
s_cselect_b32 s69, 0, 1
v_mov_b32 v5, s69
v_mov_b32 v6, 161536
ds_write_b32 v6, v5
s_waitcnt vmcnt(6)
s_barrier
s_mul_i32 s70, s60, 10
s_add_u32 s70, s70, 80
s_lshl_b32 s82, s89, 3
s_add_u32 s82, s82, s70
s_lshl_b32 s70, s70, 10
s_add_u32 m0, s70, 28672
s_and_b32 s82, s82, 127
s_lshl_b32 s82, s82, 14
buffer_load_dwordx4 v80, s[16:19], s82 offen lds
s_add_u32 m0, m0, 1024
s_add_u32 s82, s82, 16384
s_and_b32 s82, s82, 0x1fffff
buffer_load_dwordx4 v80, s[16:19], s82 offen lds
s_add_u32 m0, m0, 1024
s_add_u32 s82, s82, 16384
s_and_b32 s82, s82, 0x1fffff
buffer_load_dwordx4 v80, s[16:19], s82 offen lds
s_add_u32 m0, m0, 1024
s_add_u32 s82, s82, 16384
s_and_b32 s82, s82, 0x1fffff
buffer_load_dwordx4 v80, s[16:19], s82 offen lds
s_add_u32 m0, m0, 1024
s_add_u32 s82, s82, 16384
s_and_b32 s82, s82, 0x1fffff
buffer_load_dwordx4 v80, s[16:19], s82 offen lds
s_add_u32 m0, m0, 1024
s_add_u32 s82, s82, 16384
s_and_b32 s82, s82, 0x1fffff
buffer_load_dwordx4 v80, s[16:19], s82 offen lds
s_add_u32 m0, m0, 1024
s_add_u32 s82, s82, 16384
s_and_b32 s82, s82, 0x1fffff
buffer_load_dwordx4 v80, s[16:19], s82 offen lds
s_add_u32 m0, m0, 1024
s_add_u32 s82, s82, 16384
s_and_b32 s82, s82, 0x1fffff
buffer_load_dwordx4 v80, s[16:19], s82 offen lds
s_add_u32 m0, m0, 1024
s_add_u32 s82, s82, 16384
s_and_b32 s82, s82, 0x1fffff
buffer_load_dwordx4 v80, s[16:19], s82 offen lds
s_add_u32 m0, m0, 1024
s_add_u32 s82, s82, 16384
s_and_b32 s82, s82, 0x1fffff
buffer_load_dwordx4 v80, s[16:19], s82 offen lds
s_setprio 0
s_waitcnt lgkmcnt(0)
s_barrier
s_mov_b32 exec_lo, 0x0
s_mov_b32 exec_hi, 0xf
buffer_load_dword v81, v83, s[12:15], 0 offen
s_mov_b64 exec, -1
s_mul_i32 s70, s60, 14
s_add_u32 s70, s70, 24
s_lshl_b32 s82, s89, 3
s_add_u32 s82, s82, s70
s_lshl_b32 s70, s70, 10
s_add_u32 m0, s70, 28672
s_and_b32 s82, s82, 127
s_lshl_b32 s82, s82, 14
buffer_load_dwordx4 v80, s[16:19], s82 offen lds
s_add_u32 m0, m0, 1024
s_add_u32 s82, s82, 16384
s_and_b32 s82, s82, 0x1fffff
buffer_load_dwordx4 v80, s[16:19], s82 offen lds
s_add_u32 m0, m0, 1024
s_add_u32 s82, s82, 16384
s_and_b32 s82, s82, 0x1fffff
buffer_load_dwordx4 v80, s[16:19], s82 offen lds
s_add_u32 m0, m0, 1024
s_add_u32 s82, s82, 16384
s_and_b32 s82, s82, 0x1fffff
buffer_load_dwordx4 v80, s[16:19], s82 offen lds
s_add_u32 m0, m0, 1024
s_add_u32 s82, s82, 16384
s_and_b32 s82, s82, 0x1fffff
buffer_load_dwordx4 v80, s[16:19], s82 offen lds
s_add_u32 m0, m0, 1024
s_add_u32 s82, s82, 16384
s_and_b32 s82, s82, 0x1fffff
buffer_load_dwordx4 v80, s[16:19], s82 offen lds
s_add_u32 m0, m0, 1024
s_add_u32 s82, s82, 16384
s_and_b32 s82, s82, 0x1fffff
buffer_load_dwordx4 v80, s[16:19], s82 offen lds
s_add_u32 m0, m0, 1024
s_add_u32 s82, s82, 16384
s_and_b32 s82, s82, 0x1fffff
buffer_load_dwordx4 v80, s[16:19], s82 offen lds
s_add_u32 m0, m0, 1024
s_add_u32 s82, s82, 16384
s_and_b32 s82, s82, 0x1fffff
buffer_load_dwordx4 v80, s[16:19], s82 offen lds
s_add_u32 m0, m0, 1024
s_add_u32 s82, s82, 16384
s_and_b32 s82, s82, 0x1fffff
buffer_load_dwordx4 v80, s[16:19], s82 offen lds
s_add_u32 m0, m0, 1024
s_add_u32 s82, s82, 16384
s_and_b32 s82, s82, 0x1fffff
buffer_load_dwordx4 v80, s[16:19], s82 offen lds
s_add_u32 m0, m0, 1024
s_add_u32 s82, s82, 16384
s_and_b32 s82, s82, 0x1fffff
buffer_load_dwordx4 v80, s[16:19], s82 offen lds
s_add_u32 m0, m0, 1024
s_add_u32 s82, s82, 16384
s_and_b32 s82, s82, 0x1fffff
buffer_load_dwordx4 v80, s[16:19], s82 offen lds
s_add_u32 m0, m0, 1024
s_add_u32 s82, s82, 16384
s_and_b32 s82, s82, 0x1fffff
buffer_load_dwordx4 v80, s[16:19], s82 offen lds
s_sub_i32 s70, s64, s65
s_lshl_b32 s70, s70, 18
v_add_u32 v8, s70, v8
v_add_u32 v9, s70, v9
v_add_u32 v10, s70, v10
v_add_u32 v11, s70, v11
v_lshrrev_b32 v2, 4, v1
v_bfe_u32 v3, v1, 2, 2
v_and_b32 v4, 1, v1
v_lshlrev_b32 v4, 4, v4
v_mov_b32 v5, 0x3f80
v_lshlrev_b32 v4, v4, v5
v_cmp_eq_u32 vcc, v2, v3
s_nop 1
v_cndmask_b32 v4, 0, v4, vcc
v_and_b32 v5, 2, v1
v_cmp_eq_u32 vcc, 0, v5
s_nop 1
v_cndmask_b32 v58, 0, v4, vcc
v_cndmask_b32_e64 v59, v4, 0, vcc
v_mov_b32 v56, 0
v_mov_b32 v57, 0
v_mov_b32 v60, 0
v_mov_b32 v61, 0
v_and_b32 v3, 15, v1
v_mul_u32_u24 v55, 4352, v3
v_lshrrev_b32 v2, 4, v1
v_lshl_add_u32 v55, v2, 5, v55
s_mul_i32 s87, s64, 69632
s_add_u32 s87, s87, 524288
s_lshl_b32 s70, s66, 7
s_lshl_b32 s71, s67, 4
s_add_u32 s88, s70, s71
s_add_u32 s88, s88, s87
s_add_u32 s88, s88, 4096
s_lshl_b32 s70, s60, 10
s_add_u32 s87, s87, s70
s_cmp_eq_u32 s60, 0
s_cbranch_scc1 L_pad1
s_cmp_eq_u32 s60, 1
s_cbranch_scc1 L_pad8
s_cmp_eq_u32 s60, 2
s_cbranch_scc1 L_retF
s_branch L_retF
L_retF:
s_barrier
s_barrier
s_mul_i32 s70, s60, 6
s_add_u32 s70, s70, 0
s_lshl_b32 s82, s89, 3
s_add_u32 s82, s82, s70
s_lshl_b32 s70, s70, 10
s_add_u32 m0, s70, 28672
s_and_b32 s82, s82, 127
s_lshl_b32 s82, s82, 14
buffer_load_dwordx4 v80, s[16:19], s82 offen lds
s_add_u32 m0, m0, 1024
s_add_u32 s82, s82, 16384
s_and_b32 s82, s82, 0x1fffff
buffer_load_dwordx4 v80, s[16:19], s82 offen lds
s_add_u32 m0, m0, 1024
s_add_u32 s82, s82, 16384
s_and_b32 s82, s82, 0x1fffff
buffer_load_dwordx4 v80, s[16:19], s82 offen lds
s_add_u32 m0, m0, 1024
s_add_u32 s82, s82, 16384
s_and_b32 s82, s82, 0x1fffff
buffer_load_dwordx4 v80, s[16:19], s82 offen lds
s_add_u32 m0, m0, 1024
s_add_u32 s82, s82, 16384
s_and_b32 s82, s82, 0x1fffff
buffer_load_dwordx4 v80, s[16:19], s82 offen lds
s_add_u32 m0, m0, 1024
s_add_u32 s82, s82, 16384
s_and_b32 s82, s82, 0x1fffff
buffer_load_dwordx4 v80, s[16:19], s82 offen lds
s_lshl_b32 s70, s65, 7
s_mov_b32 m0, s76
s_nop 0
buffer_load_dwordx4 v8, s[4:7], s70 offen offset:0 lds
buffer_load_dwordx4 v9, s[4:7], s70 offen offset:1024 lds
buffer_load_dwordx4 v10, s[4:7], s70 offen offset:2048 lds
buffer_load_dwordx4 v11, s[4:7], s70 offen offset:3072 lds
s_add_u32 s70, s65, 1
s_and_b32 s70, s70, 15
s_mul_i32 s70, s70, 4352
s_add_u32 s70, s70, s87
buffer_load_dwordx4 v[84:87], v18, s[12:15], s70 offen sc1
s_add_u32 s70, s65, 2
s_and_b32 s70, s70, 15
s_mul_i32 s70, s70, 4352
s_add_u32 s70, s70, s87
buffer_load_dwordx4 v[88:91], v18, s[12:15], s70 offen sc1
s_add_u32 s70, s65, 3
s_and_b32 s70, s70, 15
s_mul_i32 s70, s70, 4352
s_add_u32 s70, s70, s87
buffer_load_dwordx4 v[92:95], v18, s[12:15], s70 offen sc1
s_add_u32 s70, s65, 4
s_and_b32 s70, s70, 15
s_mul_i32 s70, s70, 4352
s_add_u32 s70, s70, s87
buffer_load_dwordx4 v[96:99], v18, s[12:15], s70 offen sc1
s_add_u32 s70, s65, 5
s_and_b32 s70, s70, 15
s_mul_i32 s70, s70, 4352
s_add_u32 s70, s70, s87
buffer_load_dwordx4 v[100:103], v18, s[12:15], s70 offen sc1
s_add_u32 s70, s65, 6
s_and_b32 s70, s70, 15
s_mul_i32 s70, s70, 4352
s_add_u32 s70, s70, s87
buffer_load_dwordx4 v[104:107], v18, s[12:15], s70 offen sc1
s_add_u32 s70, s65, 7
s_and_b32 s70, s70, 15
s_mul_i32 s70, s70, 4352
s_add_u32 s70, s70, s87
buffer_load_dwordx4 v[108:111], v18, s[12:15], s70 offen sc1
s_add_u32 s70, s65, 8
s_and_b32 s70, s70, 15
s_mul_i32 s70, s70, 4352
s_add_u32 s70, s70, s87
buffer_load_dwordx4 v[112:115], v18, s[12:15], s70 offen sc1
s_add_u32 s70, s65, 9
s_and_b32 s70, s70, 15
s_mul_i32 s70, s70, 4352
s_add_u32 s70, s70, s87
buffer_load_dwordx4 v[116:119], v18, s[12:15], s70 offen sc1
s_add_u32 s70, s65, 10
s_and_b32 s70, s70, 15
s_mul_i32 s70, s70, 4352
s_add_u32 s70, s70, s87
buffer_load_dwordx4 v[120:123], v18, s[12:15], s70 offen sc1
s_add_u32 s70, s65, 11
s_and_b32 s70, s70, 15
s_mul_i32 s70, s70, 4352
s_add_u32 s70, s70, s87
buffer_load_dwordx4 v[124:127], v18, s[12:15], s70 offen sc1
s_add_u32 s70, s65, 12
s_and_b32 s70, s70, 15
s_mul_i32 s70, s70, 4352
s_add_u32 s70, s70, s87
buffer_load_dwordx4 v[128:131], v18, s[12:15], s70 offen sc1
s_add_u32 s70, s65, 13
s_and_b32 s70, s70, 15
s_mul_i32 s70, s70, 4352
s_add_u32 s70, s70, s87
buffer_load_dwordx4 v[132:135], v18, s[12:15], s70 offen sc1
s_add_u32 s70, s65, 14
s_and_b32 s70, s70, 15
s_mul_i32 s70, s70, 4352
s_add_u32 s70, s70, s87
buffer_load_dwordx4 v[136:139], v18, s[12:15], s70 offen sc1
s_add_u32 s70, s65, 15
s_and_b32 s70, s70, 15
s_mul_i32 s70, s70, 4352
s_add_u32 s70, s70, s87
buffer_load_dwordx4 v[140:143], v18, s[12:15], s70 offen sc1
s_add_u32 s70, s65, 16
s_and_b32 s70, s70, 15
s_mul_i32 s70, s70, 4352
s_add_u32 s70, s70, s87
buffer_load_dwordx4 v[144:147], v18, s[12:15], s70 offen sc1
buffer_load_dwordx4 v[148:151], v55, s[12:15], s88 offen sc1
s_branch L_over1
L_pad1:
s_branch L_retF
L_over1:
s_lshl_b32 s70, s66, 6
s_lshl_b32 s71, s67, 3
s_add_u32 s70, s70, s71
s_add_u32 s70, s70, 161600
v_lshrrev_b32 v4, 4, v1
v_lshlrev_b32 v4, 4, v4
v_add_u32 v4, s70, v4
s_lshl_b32 s70, s60, 10
s_add_u32 s70, s70, 24576
v_add_u32 v3, s70, v18
s_mov_b32 s73, 31
L_kvr:
s_bitcmp1_b32 s73, 0
s_cbranch_scc0 L_kvs0
s_waitcnt vmcnt(13)
v_max3_u32 v2, v84, v88, v92
v_max_u32 v2, v2, v96
v_cmp_eq_u32 vcc, -1, v2
s_cbranch_vccnz L_kvs0
s_bitset0_b32 s73, 0
v_mfma_f32_16x16x32_bf16 v[20:23], v[58:61], v[84:87], 0
v_mfma_f32_16x16x32_bf16 v[24:27], v[56:59], v[84:87], 0
v_mfma_f32_16x16x32_bf16 v[20:23], v[58:61], v[88:91], v[20:23]
v_mfma_f32_16x16x32_bf16 v[24:27], v[56:59], v[88:91], v[24:27]
v_mfma_f32_16x16x32_bf16 v[20:23], v[58:61], v[92:95], v[20:23]
v_mfma_f32_16x16x32_bf16 v[24:27], v[56:59], v[92:95], v[24:27]
v_mfma_f32_16x16x32_bf16 v[20:23], v[58:61], v[96:99], v[20:23]
v_mfma_f32_16x16x32_bf16 v[24:27], v[56:59], v[96:99], v[24:27]
L_kvs0:
s_bitcmp1_b32 s73, 1
s_cbranch_scc0 L_kvs1
s_waitcnt vmcnt(9)
v_max3_u32 v2, v100, v104, v108
v_max_u32 v2, v2, v112
v_cmp_eq_u32 vcc, -1, v2
s_cbranch_vccnz L_kvs1
s_bitset0_b32 s73, 1
v_mfma_f32_16x16x32_bf16 v[28:31], v[58:61], v[100:103], 0
v_mfma_f32_16x16x32_bf16 v[32:35], v[56:59], v[100:103], 0
v_mfma_f32_16x16x32_bf16 v[28:31], v[58:61], v[104:107], v[28:31]
v_mfma_f32_16x16x32_bf16 v[32:35], v[56:59], v[104:107], v[32:35]
v_mfma_f32_16x16x32_bf16 v[28:31], v[58:61], v[108:111], v[28:31]
v_mfma_f32_16x16x32_bf16 v[32:35], v[56:59], v[108:111], v[32:35]
v_mfma_f32_16x16x32_bf16 v[28:31], v[58:61], v[112:115], v[28:31]
v_mfma_f32_16x16x32_bf16 v[32:35], v[56:59], v[112:115], v[32:35]
L_kvs1:
s_bitcmp1_b32 s73, 2
s_cbranch_scc0 L_kvs2
s_waitcnt vmcnt(5)
v_max3_u32 v2, v116, v120, v124
v_max_u32 v2, v2, v128
v_cmp_eq_u32 vcc, -1, v2
s_cbranch_vccnz L_kvs2
s_bitset0_b32 s73, 2
v_mfma_f32_16x16x32_bf16 v[36:39], v[58:61], v[116:119], 0
v_mfma_f32_16x16x32_bf16 v[40:43], v[56:59], v[116:119], 0
v_mfma_f32_16x16x32_bf16 v[36:39], v[58:61], v[120:123], v[36:39]
v_mfma_f32_16x16x32_bf16 v[40:43], v[56:59], v[120:123], v[40:43]
v_mfma_f32_16x16x32_bf16 v[36:39], v[58:61], v[124:127], v[36:39]
v_mfma_f32_16x16x32_bf16 v[40:43], v[56:59], v[124:127], v[40:43]
v_mfma_f32_16x16x32_bf16 v[36:39], v[58:61], v[128:131], v[36:39]
v_mfma_f32_16x16x32_bf16 v[40:43], v[56:59], v[128:131], v[40:43]
L_kvs2:
s_bitcmp1_b32 s73, 3
s_cbranch_scc0 L_kvs3
s_waitcnt vmcnt(1)
v_max3_u32 v2, v132, v136, v140
v_max_u32 v2, v2, v144
v_cmp_eq_u32 vcc, -1, v2
s_cbranch_vccnz L_kvs3
s_bitset0_b32 s73, 3
v_mfma_f32_16x16x32_bf16 v[44:47], v[58:61], v[132:135], 0
v_mfma_f32_16x16x32_bf16 v[48:51], v[56:59], v[132:135], 0
v_mfma_f32_16x16x32_bf16 v[44:47], v[58:61], v[136:139], v[44:47]
v_mfma_f32_16x16x32_bf16 v[48:51], v[56:59], v[136:139], v[48:51]
v_mfma_f32_16x16x32_bf16 v[44:47], v[58:61], v[140:143], v[44:47]
v_mfma_f32_16x16x32_bf16 v[48:51], v[56:59], v[140:143], v[48:51]
v_mfma_f32_16x16x32_bf16 v[44:47], v[58:61], v[144:147], v[44:47]
v_mfma_f32_16x16x32_bf16 v[48:51], v[56:59], v[144:147], v[48:51]
L_kvs3:
s_bitcmp1_b32 s73, 4
s_cbranch_scc0 L_kvs4
s_waitcnt vmcnt(0)
v_xor_b32 v148, s84, v148
v_xor_b32 v149, s84, v149
v_xor_b32 v150, s84, v150
v_xor_b32 v151, s84, v151
v_or3_b32 v2, v148, v149, v150
v_bitop3_b32 v2, v2, v151, s91 bitop3:0xa8
v_cmp_ne_u32 vcc, 0, v2
s_cbranch_vccnz L_kvs4
s_bitset0_b32 s73, 4
v_add_f32_dpp v148, v148, v148 row_ror:1 row_mask:0xf bank_mask:0xf
v_add_f32_dpp v149, v149, v149 row_ror:1 row_mask:0xf bank_mask:0xf
v_add_f32_dpp v150, v150, v150 row_ror:1 row_mask:0xf bank_mask:0xf
v_add_f32_dpp v151, v151, v151 row_ror:1 row_mask:0xf bank_mask:0xf
v_add_f32_dpp v148, v148, v148 row_ror:2 row_mask:0xf bank_mask:0xf
v_add_f32_dpp v149, v149, v149 row_ror:2 row_mask:0xf bank_mask:0xf
v_add_f32_dpp v150, v150, v150 row_ror:2 row_mask:0xf bank_mask:0xf
v_add_f32_dpp v151, v151, v151 row_ror:2 row_mask:0xf bank_mask:0xf
v_add_f32_dpp v148, v148, v148 row_ror:4 row_mask:0xf bank_mask:0xf
v_add_f32_dpp v149, v149, v149 row_ror:4 row_mask:0xf bank_mask:0xf
v_add_f32_dpp v150, v150, v150 row_ror:4 row_mask:0xf bank_mask:0xf
v_add_f32_dpp v151, v151, v151 row_ror:4 row_mask:0xf bank_mask:0xf
v_add_f32_dpp v148, v148, v148 row_ror:8 row_mask:0xf bank_mask:0xf
v_add_f32_dpp v149, v149, v149 row_ror:8 row_mask:0xf bank_mask:0xf
v_add_f32_dpp v150, v150, v150 row_ror:8 row_mask:0xf bank_mask:0xf
v_add_f32_dpp v151, v151, v151 row_ror:8 row_mask:0xf bank_mask:0xf
v_cvt_pk_bf16_f32 v148, v148, v149
v_cvt_pk_bf16_f32 v149, v150, v151
ds_write_b64 v4, v[148:149]
L_kvs4:
s_cmp_lg_u32 s73, 0
s_cbranch_scc1 L_kvrt
L_kvok:
s_nop 3
v_pk_add_f32 v[20:21], v[20:21], v[28:29]
v_pk_add_f32 v[22:23], v[22:23], v[30:31]
v_pk_add_f32 v[24:25], v[24:25], v[32:33]
v_pk_add_f32 v[26:27], v[26:27], v[34:35]
v_pk_add_f32 v[36:37], v[36:37], v[44:45]
v_pk_add_f32 v[38:39], v[38:39], v[46:47]
v_pk_add_f32 v[40:41], v[40:41], v[48:49]
v_pk_add_f32 v[42:43], v[42:43], v[50:51]
v_pk_add_f32 v[20:21], v[20:21], v[36:37]
v_pk_add_f32 v[22:23], v[22:23], v[38:39]
v_pk_add_f32 v[24:25], v[24:25], v[40:41]
v_pk_add_f32 v[26:27], v[26:27], v[42:43]
v_cvt_pk_bf16_f32 v20, v20, v21
v_cvt_pk_bf16_f32 v21, v22, v23
v_cvt_pk_bf16_f32 v22, v24, v25
v_cvt_pk_bf16_f32 v23, v26, v27
ds_write_b128 v3, v[20:23]
s_waitcnt lgkmcnt(0)
s_barrier
s_mov_b32 exec_lo, 0x0
s_mov_b32 exec_hi, 0x3f000000
buffer_load_dword v81, v83, s[12:15], 0 offen
s_mov_b64 exec, -1
s_cmp_eq_u32 s60, 0
s_cbranch_scc1 L_pad2
s_cmp_eq_u32 s60, 1
s_cbranch_scc1 L_pad6
s_cmp_eq_u32 s60, 2
s_cbranch_scc1 L_pad7
s_branch L_pad9
L_retG:
v_lshrrev_b32 v2, 5, v1
v_lshlrev_b32 v2, 11, v2
v_bfe_u32 v3, v1, 3, 2
v_lshl_add_u32 v2, v3, 7, v2
v_bfe_u32 v3, v1, 4, 1
v_bfe_u32 v4, v1, 1, 2
v_xor_b32 v3, v3, v4
v_lshl_add_u32 v2, v3, 5, v2
v_and_b32 v3, 1, v1
v_lshl_add_u32 v2, v3, 4, v2
s_lshl_b32 s70, s60, 13
s_add_u32 s71, s70, 65536
v_add_u32 v100, s71, v2
v_xor_b32 v101, 64, v100
v_lshrrev_b32 v2, 2, v1
v_bfe_u32 v5, v1, 3, 2
v_xor_b32 v6, s60, v5
v_lshlrev_b32 v6, 5, v6
v_lshl_add_u32 v6, v2, 7, v6
v_and_b32 v7, 3, v1
v_lshl_add_u32 v6, v7, 3, v6
v_add_u32 v102, 65536, v6
s_lshl_b32 s71, s66, 16
s_add_u32 s70, s70, s71
s_add_u32 s70, s70, 49152
v_lshlrev_b32 v6, 5, v5
v_lshl_add_u32 v6, v2, 7, v6
v_lshl_add_u32 v6, v7, 3, v6
v_add_u32 v104, s70, v6
v_xor_b32 v105, 32, v104
v_xor_b32 v106, 64, v104
v_xor_b32 v107, 96, v104
v_lshrrev_b32 v5, 4, v1
v_xor_b32 v4, v4, v5
v_lshlrev_b32 v4, 5, v4
v_lshrrev_b32 v6, 3, v1
v_lshl_add_u32 v4, v6, 7, v4
v_lshl_add_u32 v4, v3, 4, v4
v_add_u32 v103, s70, v4
s_lshl_b32 s70, s60, 5
s_add_u32 s70, s70, 161792
v_mov_b32 v63, s70
v_add_u32 v114, 16, v63
v_lshl_add_u32 v56, v3, 4, v63
s_and_b32 s70, s65, 3
s_lshl_b32 s70, s70, 9
s_add_u32 s70, s70, 7864320
v_lshl_add_u32 v57, v5, 4, s70
v_lshlrev_b32 v60, 5, v5
v_lshl_add_u32 v60, v3, 4, v60
v_bfe_u32 v7, v1, 1, 1
v_lshl_add_u32 v60, v7, 7, v60
v_and_b32 v2, 3, v2
v_lshl_add_u32 v61, v2, 8, v60
v_lshlrev_b32 v62, 4, v3
v_lshl_add_u32 v62, v5, 5, v62
v_mov_b32 v59, s68
s_lshl_b32 s71, s79, 2
s_add_u32 s71, s71, s60
s_lshl_b32 s70, s71, 8
s_add_u32 s70, s70, 6946816
s_mov_b32 s85, s70
s_and_b32 s71, s65, 3
s_lshl2_add_u32 s71, s3, s71
s_and_b32 s70, s65, 12
s_add_u32 s70, s70, s60
s_lshl_b32 s71, s71, 7
s_lshl_b32 s70, s70, 15
s_add_u32 s70, s70, s71
s_add_u32 s70, s70, 7340032
s_mov_b32 s88, s70
s_lshl_b32 s70, s64, 14
s_add_u32 s86, s70, 6946816
s_and_b32 s70, s65, 3
v_mul_u32_u24 v2, 1, v7
v_xor_b32 v2, s70, v2
v_lshl_add_u32 v61, v2, 12, v61
s_lshl_b32 s87, s62, 11
s_add_u32 s87, s87, 6815744
s_mov_b32 s94, 0
s_mov_b32 s95, 0
s_mov_b32 s92, 0x000f000f
s_mov_b32 s93, 0x000f000f
s_mov_b32 s38, 0
v_mov_b32 v64, 0x3f803f80
v_mov_b32 v65, 0x3f803f80
v_mov_b32 v66, 0x3f803f80
v_mov_b32 v67, 0x3f803f80
v_add_u32 v115, 64, v1
v_mov_b32 v2, 0
v_mov_b32 v95, 0
v_mov_b32 v99, 0
s_waitcnt vmcnt(0) lgkmcnt(0)
s_barrier
ds_write_b128 v100, a[0:3] offset:0
ds_write_b128 v101, a[4:7] offset:512
ds_write_b128 v100, a[8:11] offset:1024
ds_write_b128 v101, a[12:15] offset:1536
ds_write_b128 v100, a[16:19] offset:4096
ds_write_b128 v101, a[20:23] offset:4608
ds_write_b128 v100, a[24:27] offset:5120
ds_write_b128 v101, a[28:31] offset:5632
ds_write_b128 v100, a[32:35] offset:32768
ds_write_b128 v101, a[36:39] offset:33280
ds_write_b128 v100, a[40:43] offset:33792
ds_write_b128 v101, a[44:47] offset:34304
ds_write_b128 v100, a[48:51] offset:36864
ds_write_b128 v101, a[52:55] offset:37376
ds_write_b128 v100, a[56:59] offset:37888
ds_write_b128 v101, a[60:63] offset:38400
ds_write_b128 v103, a[64:67] offset:0
ds_write_b128 v103, a[68:71] offset:1024
ds_write_b128 v103, a[72:75] offset:2048
ds_write_b128 v103, a[76:79] offset:3072
ds_write_b128 v103, a[80:83] offset:4096
ds_write_b128 v103, a[84:87] offset:5120
ds_write_b128 v103, a[88:91] offset:6144
ds_write_b128 v103, a[92:95] offset:7168
s_waitcnt lgkmcnt(0)
ds_read_b64_tr_b16 a[64:65], v104 offset:0
ds_read_b64_tr_b16 a[66:67], v104 offset:2048
ds_read_b64_tr_b16 a[68:69], v104 offset:4096
ds_read_b64_tr_b16 a[70:71], v104 offset:6144
ds_read_b64_tr_b16 a[72:73], v105 offset:0
ds_read_b64_tr_b16 a[74:75], v105 offset:2048
ds_read_b64_tr_b16 a[76:77], v105 offset:4096
ds_read_b64_tr_b16 a[78:79], v105 offset:6144
ds_read_b64_tr_b16 a[80:81], v106 offset:0
ds_read_b64_tr_b16 a[82:83], v106 offset:2048
ds_read_b64_tr_b16 a[84:85], v106 offset:4096
ds_read_b64_tr_b16 a[86:87], v106 offset:6144
ds_read_b64_tr_b16 a[88:89], v107 offset:0
ds_read_b64_tr_b16 a[90:91], v107 offset:2048
ds_read_b64_tr_b16 a[92:93], v107 offset:4096
ds_read_b64_tr_b16 a[94:95], v107 offset:6144
s_barrier
ds_read_b64_tr_b16 a[0:1], v102 offset:0
ds_read_b64_tr_b16 a[2:3], v102 offset:2048
ds_read_b64_tr_b16 a[32:33], v102 offset:32768
ds_read_b64_tr_b16 a[34:35], v102 offset:34816
ds_read_b64_tr_b16 a[4:5], v102 offset:4096
ds_read_b64_tr_b16 a[6:7], v102 offset:6144
ds_read_b64_tr_b16 a[36:37], v102 offset:36864
ds_read_b64_tr_b16 a[38:39], v102 offset:38912
ds_read_b64_tr_b16 a[8:9], v102 offset:8192
ds_read_b64_tr_b16 a[10:11], v102 offset:10240
ds_read_b64_tr_b16 a[40:41], v102 offset:40960
ds_read_b64_tr_b16 a[42:43], v102 offset:43008
ds_read_b64_tr_b16 a[12:13], v102 offset:12288
ds_read_b64_tr_b16 a[14:15], v102 offset:14336
ds_read_b64_tr_b16 a[44:45], v102 offset:45056
ds_read_b64_tr_b16 a[46:47], v102 offset:47104
ds_read_b64_tr_b16 a[16:17], v102 offset:16384
ds_read_b64_tr_b16 a[18:19], v102 offset:18432
ds_read_b64_tr_b16 a[48:49], v102 offset:49152
ds_read_b64_tr_b16 a[50:51], v102 offset:51200
ds_read_b64_tr_b16 a[20:21], v102 offset:20480
ds_read_b64_tr_b16 a[22:23], v102 offset:22528
ds_read_b64_tr_b16 a[52:53], v102 offset:53248
ds_read_b64_tr_b16 a[54:55], v102 offset:55296
ds_read_b64_tr_b16 a[24:25], v102 offset:24576
ds_read_b64_tr_b16 a[26:27], v102 offset:26624
ds_read_b64_tr_b16 a[56:57], v102 offset:57344
ds_read_b64_tr_b16 a[58:59], v102 offset:59392
ds_read_b64_tr_b16 a[28:29], v102 offset:28672
ds_read_b64_tr_b16 a[30:31], v102 offset:30720
ds_read_b64_tr_b16 a[60:61], v102 offset:61440
ds_read_b64_tr_b16 a[62:63], v102 offset:63488
s_waitcnt lgkmcnt(0)
buffer_load_dwordx4 v[92:95], v18, s[12:15], s87 offen offset:0 sc1
buffer_load_dwordx4 v[96:99], v18, s[12:15], s87 offen offset:1024 sc1
v_mfma_f32_16x16x32_bf16 v[68:71], a[0:3], v[64:67], 0
v_mfma_f32_16x16x32_bf16 v[72:75], a[32:35], v[64:67], 0
v_mfma_f32_16x16x32_bf16 v[68:71], a[4:7], v[64:67], v[68:71]
v_mfma_f32_16x16x32_bf16 v[72:75], a[36:39], v[64:67], v[72:75]
v_mfma_f32_16x16x32_bf16 v[68:71], a[8:11], v[64:67], v[68:71]
v_mfma_f32_16x16x32_bf16 v[72:75], a[40:43], v[64:67], v[72:75]
v_mfma_f32_16x16x32_bf16 v[68:71], a[12:15], v[64:67], v[68:71]
v_mfma_f32_16x16x32_bf16 v[72:75], a[44:47], v[64:67], v[72:75]
v_mfma_f32_16x16x32_bf16 v[68:71], a[16:19], v[64:67], v[68:71]
v_mfma_f32_16x16x32_bf16 v[72:75], a[48:51], v[64:67], v[72:75]
v_mfma_f32_16x16x32_bf16 v[68:71], a[20:23], v[64:67], v[68:71]
v_mfma_f32_16x16x32_bf16 v[72:75], a[52:55], v[64:67], v[72:75]
v_mfma_f32_16x16x32_bf16 v[68:71], a[24:27], v[64:67], v[68:71]
v_mfma_f32_16x16x32_bf16 v[72:75], a[56:59], v[64:67], v[72:75]
v_mfma_f32_16x16x32_bf16 v[68:71], a[28:31], v[64:67], v[68:71]
v_mfma_f32_16x16x32_bf16 v[72:75], a[60:63], v[64:67], v[72:75]
L_pk:
s_waitcnt vmcnt(0)
L_pk2:
v_cmp_eq_u32_e64 s[80:81], s68, v95
v_cmp_eq_u32_e64 s[82:83], s68, v99
s_nop 0
v_cndmask_b32_e64 v108, 0, v92, s[80:81]
v_cndmask_b32_e64 v109, 0, v96, s[82:83]
s_and_b64 s[76:77], s[80:81], s[82:83]
v_max_u32 v110, v108, v109
v_min_u32 v111, v108, v109
s_cmp_eq_u64 s[76:77], -1
s_cselect_b32 s73, 0, 1
s_cbranch_scc1 L_pkc
s_not_b64 exec, s[80:81]
s_cselect_b64 exec, exec, 1
buffer_load_dwordx4 v[92:95], v18, s[12:15], s87 offen offset:0 sc1
s_not_b64 exec, s[82:83]
s_cselect_b64 exec, exec, 1
buffer_load_dwordx4 v[96:99], v18, s[12:15], s87 offen offset:1024 sc1
s_mov_b64 exec, -1
L_pkc:
v_cmp_le_u32 vcc, s95, v110
v_cmp_le_u32_e64 s[76:77], s95, v111
s_bcnt1_i32_b64 s70, vcc
s_bcnt1_i32_b64 s71, s[76:77]
s_add_u32 s70, s70, s71
s_cmp_eq_u32 s70, 2
s_cbranch_scc1 L_pksame
v_mov_b32_dpp v112, v110 row_ror:1 row_mask:0xf bank_mask:0xf
v_max_u32_dpp v113, v111, v111 row_ror:1 row_mask:0xf bank_mask:0xf
v_med3_u32 v111, v110, v112, v113
v_max_u32 v110, v110, v112
s_nop 1
v_mov_b32_dpp v112, v110 row_ror:2 row_mask:0xf bank_mask:0xf
v_max_u32_dpp v113, v111, v111 row_ror:2 row_mask:0xf bank_mask:0xf
v_med3_u32 v111, v110, v112, v113
v_max_u32 v110, v110, v112
s_nop 1
v_mov_b32_dpp v112, v110 row_ror:4 row_mask:0xf bank_mask:0xf
v_max_u32_dpp v113, v111, v111 row_ror:4 row_mask:0xf bank_mask:0xf
v_med3_u32 v111, v110, v112, v113
v_max_u32 v110, v110, v112
s_nop 1
v_mov_b32_dpp v112, v110 row_ror:8 row_mask:0xf bank_mask:0xf
v_max_u32_dpp v113, v111, v111 row_ror:8 row_mask:0xf bank_mask:0xf
v_med3_u32 v111, v110, v112, v113
v_max_u32 v110, v110, v112
v_mov_b32 v112, v110
v_mov_b32 v113, v111
s_nop 0
v_permlane16_swap_b32 v110, v112
v_permlane16_swap_b32 v111, v113
v_max_u32 v113, v111, v113
v_med3_u32 v111, v110, v112, v113
v_max_u32 v110, v110, v112
v_mov_b32 v112, v110
v_mov_b32 v113, v111
s_nop 0
v_permlane32_swap_b32 v110, v112
v_permlane32_swap_b32 v111, v113
v_max_u32 v113, v111, v113
v_med3_u32 v111, v110, v112, v113
v_max_u32 v110, v110, v112
v_readfirstlane_b32 s95, v111
s_nop 0
s_cmp_eq_u32 s95, 0
s_cbranch_scc1 L_pksame
v_cmp_eq_u32 vcc, v108, v111
v_cmp_eq_u32_e64 s[76:77], v108, v110
s_nop 0
v_cndmask_b32 v112, v63, v114, vcc
s_or_b64 exec, vcc, s[76:77]
ds_write_b96 v112, v[92:94]
ds_write_b32 v112, v1 offset:12
s_mov_b64 exec, -1
v_cmp_eq_u32 vcc, v109, v111
v_cmp_eq_u32_e64 s[76:77], v109, v110
s_nop 0
v_cndmask_b32 v113, v63, v114, vcc
s_or_b64 exec, vcc, s[76:77]
ds_write_b96 v113, v[96:98]
ds_write_b32 v113, v115 offset:12
s_mov_b64 exec, -1
ds_read_b128 v[20:23], v56
s_waitcnt lgkmcnt(0)
v_lshl_add_u32 v58, v23, 11, v57
s_mov_b64 exec, s[92:93]
buffer_load_dwordx4 v[24:27], v58, s[12:15], 0 offen offset:0 sc1
buffer_load_dwordx4 v[28:31], v58, s[12:15], 0 offen offset:64 sc1
buffer_load_dwordx4 v[32:35], v58, s[12:15], 0 offen offset:128 sc1
buffer_load_dwordx4 v[36:39], v58, s[12:15], 0 offen offset:192 sc1
buffer_load_dwordx4 v[40:43], v58, s[12:15], 0 offen offset:256 sc1
buffer_load_dwordx4 v[44:47], v58, s[12:15], 0 offen offset:320 sc1
buffer_load_dwordx4 v[48:51], v58, s[12:15], 0 offen offset:384 sc1
buffer_load_dwordx4 v[52:55], v58, s[12:15], 0 offen offset:448 sc1
s_mov_b64 exec, -1
v_mul_f32_e64 v84, v68, -v21
v_mul_f32_e64 v85, v69, -v21
v_mul_f32_e64 v86, v70, -v21
v_mul_f32_e64 v87, v71, -v21
v_mul_f32_e64 v88, v72, -v21
v_mul_f32_e64 v89, v73, -v21
v_mul_f32_e64 v90, v74, -v21
v_mul_f32_e64 v91, v75, -v21
s_cmp_eq_u32 s73, 0
s_cbranch_scc1 L_pkf
s_waitcnt vmcnt(8)
s_add_u32 s78, s78, 1
s_cmp_le_u32 s78, 65536
s_cbranch_scc1 L_pk2
L_pkf:
s_waitcnt vmcnt(0)
L_pkx_chk:
v_max3_u32 v2, v24, v28, v32
v_max3_u32 v3, v36, v40, v44
v_max3_u32 v2, v2, v48, v52
v_max_u32 v2, v2, v3
v_cmp_eq_u32 vcc, -1, v2
s_nop 0
s_and_b64 vcc, vcc, s[92:93]
s_cbranch_vccnz L_pkx_rt
L_pkx_ok:
v_mfma_f32_16x16x32_bf16 v[84:87], a[0:3], v[24:27], v[84:87]
v_mfma_f32_16x16x32_bf16 v[88:91], a[32:35], v[24:27], v[88:91]
v_mfma_f32_16x16x32_bf16 v[84:87], a[4:7], v[28:31], v[84:87]
v_mfma_f32_16x16x32_bf16 v[88:91], a[36:39], v[28:31], v[88:91]
v_mfma_f32_16x16x32_bf16 v[84:87], a[8:11], v[32:35], v[84:87]
v_mfma_f32_16x16x32_bf16 v[88:91], a[40:43], v[32:35], v[88:91]
v_mfma_f32_16x16x32_bf16 v[84:87], a[12:15], v[36:39], v[84:87]
v_mfma_f32_16x16x32_bf16 v[88:91], a[44:47], v[36:39], v[88:91]
v_mfma_f32_16x16x32_bf16 v[84:87], a[16:19], v[40:43], v[84:87]
v_mfma_f32_16x16x32_bf16 v[88:91], a[48:51], v[40:43], v[88:91]
v_mfma_f32_16x16x32_bf16 v[84:87], a[20:23], v[44:47], v[84:87]
v_mfma_f32_16x16x32_bf16 v[88:91], a[52:55], v[44:47], v[88:91]
v_mfma_f32_16x16x32_bf16 v[84:87], a[24:27], v[48:51], v[84:87]
v_mfma_f32_16x16x32_bf16 v[88:91], a[56:59], v[48:51], v[88:91]
v_mfma_f32_16x16x32_bf16 v[84:87], a[28:31], v[52:55], v[84:87]
v_mfma_f32_16x16x32_bf16 v[88:91], a[60:63], v[52:55], v[88:91]
s_mov_b32 s76, 0xcccccccc
s_mov_b32 s77, 0xcccccccc
s_nop 5
v_cndmask_b32_e64 v84, v84, v88, s[76:77]
v_cndmask_b32_e64 v85, v85, v89, s[76:77]
v_cndmask_b32_e64 v86, v86, v90, s[76:77]
v_cndmask_b32_e64 v87, v87, v91, s[76:77]
v_bfi_b32 v84, s91, v59, v84
s_mov_b64 exec, s[92:93]
s_cmp_eq_u32 s69, 0
s_cbranch_scc1 L_pxp_s
buffer_store_dwordx4 v[84:87], v60, s[12:15], s85 offen
L_pxp_d:
s_mov_b64 exec, -1
buffer_load_dwordx4 v[24:27], v61, s[12:15], s86 offen offset:0 sc1
buffer_load_dwordx4 v[28:31], v61, s[12:15], s86 offen offset:1024 sc1
buffer_load_dwordx4 v[32:35], v61, s[12:15], s86 offen offset:2048 sc1
buffer_load_dwordx4 v[36:39], v61, s[12:15], s86 offen offset:3072 sc1
s_barrier
s_mov_b32 s92, 0x00030003
s_mov_b32 s93, 0x00030003
s_waitcnt vmcnt(0)
L_px_chk:
v_xor_b32 v24, s84, v24
v_xor_b32 v28, s84, v28
v_xor_b32 v32, s84, v32
v_xor_b32 v36, s84, v36
v_or3_b32 v2, v24, v28, v32
v_bitop3_b32 v2, v2, v36, s91 bitop3:0xa8
v_cmp_ne_u32 vcc, 0, v2
s_cbranch_vccnz L_px_rt
L_px_ok:
v_pk_add_f32 v[24:25], v[24:25], v[28:29]
v_pk_add_f32 v[32:33], v[32:33], v[36:37]
v_pk_add_f32 v[26:27], v[26:27], v[30:31]
v_pk_add_f32 v[34:35], v[34:35], v[38:39]
v_pk_add_f32 v[24:25], v[24:25], v[32:33]
v_pk_add_f32 v[26:27], v[26:27], v[34:35]
v_pk_mul_f32 v[24:25], v[24:25], v[22:23] op_sel_hi:[1,0]
v_pk_mul_f32 v[26:27], v[26:27], v[22:23] op_sel_hi:[1,0]
v_mul_f32 v28, 0xbfb8aa3b, v24
v_mul_f32 v29, 0xbfb8aa3b, v25
v_mul_f32 v30, 0xbfb8aa3b, v26
v_mul_f32 v31, 0xbfb8aa3b, v27
v_exp_f32 v28, v28
v_exp_f32 v29, v29
v_exp_f32 v30, v30
v_exp_f32 v31, v31
v_mul_f32_dpp v32, v24, v24 quad_perm:[2,3,0,1] row_mask:0xf bank_mask:0xf
v_mul_f32_dpp v33, v25, v25 quad_perm:[2,3,0,1] row_mask:0xf bank_mask:0xf
v_mul_f32_dpp v34, v26, v26 quad_perm:[2,3,0,1] row_mask:0xf bank_mask:0xf
v_mul_f32_dpp v35, v27, v27 quad_perm:[2,3,0,1] row_mask:0xf bank_mask:0xf
v_add_f32 v28, 1.0, v28
v_add_f32 v29, 1.0, v29
v_add_f32 v30, 1.0, v30
v_add_f32 v31, 1.0, v31
v_rcp_f32 v28, v28
v_rcp_f32 v29, v29
v_rcp_f32 v30, v30
v_rcp_f32 v31, v31
v_mul_f32 v24, v32, v28
v_mul_f32 v25, v33, v29
v_mul_f32 v26, v34, v30
v_mul_f32 v27, v35, v31
v_cvt_pk_bf16_f32 v28, v24, v25
v_cvt_pk_bf16_f32 v29, v26, v27
s_nop 0
v_mov_b32_dpp v30, v28 row_shl:4 row_mask:0xf bank_mask:0xf
v_mov_b32_dpp v31, v29 row_shl:4 row_mask:0xf bank_mask:0xf
v_mov_b32_dpp v32, v28 row_shl:8 row_mask:0xf bank_mask:0xf
v_mov_b32_dpp v33, v29 row_shl:8 row_mask:0xf bank_mask:0xf
v_mov_b32_dpp v34, v28 row_shl:12 row_mask:0xf bank_mask:0xf
v_mov_b32_dpp v35, v29 row_shl:12 row_mask:0xf bank_mask:0xf
v_mfma_f32_16x16x32_bf16 v[40:43], a[64:67], v[28:31], 0
v_mfma_f32_16x16x32_bf16 v[44:47], a[72:75], v[28:31], 0
v_mfma_f32_16x16x32_bf16 v[48:51], a[80:83], v[28:31], 0
v_mfma_f32_16x16x32_bf16 v[52:55], a[88:91], v[28:31], 0
v_mfma_f32_16x16x32_bf16 v[40:43], a[68:71], v[32:35], v[40:43]
v_mfma_f32_16x16x32_bf16 v[44:47], a[76:79], v[32:35], v[44:47]
v_mfma_f32_16x16x32_bf16 v[48:51], a[84:87], v[32:35], v[48:51]
v_mfma_f32_16x16x32_bf16 v[52:55], a[92:95], v[32:35], v[52:55]
s_cmp_ge_u32 s3, 14
s_cbranch_scc1 L_noy
s_mov_b64 exec, s[92:93]
s_nop 1
v_bfi_b32 v40, s91, v59, v40
buffer_store_dwordx4 v[40:43], v62, s[12:15], s88 offen sc1
s_add_u32 s88, s88, 8192
v_bfi_b32 v44, s91, v59, v44
buffer_store_dwordx4 v[44:47], v62, s[12:15], s88 offen sc1
s_add_u32 s88, s88, 8192
v_bfi_b32 v48, s91, v59, v48
buffer_store_dwordx4 v[48:51], v62, s[12:15], s88 offen sc1
s_add_u32 s88, s88, 8192
v_bfi_b32 v52, s91, v59, v52
buffer_store_dwordx4 v[52:55], v62, s[12:15], s88 offen sc1
s_mov_b64 exec, -1
L_noy:
s_or_b32 s70, s2, s60
s_cbranch_scc1 L_noep
v_mov_b32 v3, 0
s_mov_b64 exec, 1
buffer_store_dword v59, v3, s[12:15], 0 offen sc1
s_mov_b64 exec, -1
L_noep:
s_cmp_lt_u32 s63, 24
s_cbranch_scc1 L_ldone
s_cmp_lg_u32 s60, 1
s_cbranch_scc1 L_ldone
s_lshl_b32 s87, s62, 3
s_add_u32 s87, s87, s63
s_sub_u32 s87, s87, 24
s_lshl_b32 s88, s87, 13
s_add_u32 s88, s88, 7340032
s_add_u32 s71, s88, 4096
s_lshl_b32 s70, s87, 5
v_bfe_u32 v3, v1, 1, 2
v_lshl_add_u32 v7, v3, 3, s70
s_mov_b32 s72, 7864320
v_lshl_add_u32 v64, v23, 11, v7
buffer_load_dwordx2 v[84:85], v64, s[12:15], s72 offen sc1
buffer_load_dwordx4 v[120:123], v18, s[12:15], s88 offen offset:0 sc1
buffer_load_dwordx4 v[124:127], v18, s[12:15], s88 offen offset:1024 sc1
buffer_load_dwordx4 v[128:131], v18, s[12:15], s88 offen offset:2048 sc1
buffer_load_dwordx4 v[132:135], v18, s[12:15], s88 offen offset:3072 sc1
buffer_load_dwordx4 v[136:139], v18, s[12:15], s71 offen offset:0 sc1
buffer_load_dwordx4 v[140:143], v18, s[12:15], s71 offen offset:1024 sc1
buffer_load_dwordx4 v[144:147], v18, s[12:15], s71 offen offset:2048 sc1
v_mov_b32 v88, s84
v_and_b32 v65, 0xfffff800, v20
v_not_b32 v4, v65
v_ashrrev_i32 v4, 31, v4
v_or_b32 v4, 0x80000000, v4
v_xor_b32 v65, v65, v4
v_mul_f32 v65, 0xbfb8aa3b, v65
v_exp_f32 v65, v65
s_nop 0
v_add_f32 v65, 1.0, v65
v_rcp_f32 v65, v65
v_and_b32 v66, 0x7ff, v20
v_sub_u32 v66, 2047, v66
v_lshl_add_u32 v66, v66, 11, v7
v_add_f32 v67, 1.0, v22
v_mul_f32_e64 v21, -v21, v22
s_waitcnt vmcnt(7)
L_h_chk:
v_cmp_eq_u32 vcc, -1, v84
s_cbranch_vccnz L_h_rt
L_h_ok:
v_lshlrev_b32 v86, 16, v85
v_and_b32 v87, 0xffff0000, v85
v_and_b32 v85, 0xffff0000, v84
v_lshlrev_b32 v84, 16, v84
v_fma_f32 v84, v84, v67, v21
v_fma_f32 v85, v85, v67, v21
v_fma_f32 v86, v86, v67, v21
v_fma_f32 v87, v87, v67, v21
s_waitcnt vmcnt(0)
L_y_chk:
v_xor_b32 v120, s84, v120
v_xor_b32 v124, s84, v124
v_xor_b32 v128, s84, v128
v_xor_b32 v132, s84, v132
v_or3_b32 v2, v120, v124, v128
v_xor_b32 v136, s84, v136
v_xor_b32 v140, s84, v140
v_or3_b32 v2, v2, v132, v136
v_xor_b32 v144, s84, v144
v_xor_b32 v88, s84, v88
v_or3_b32 v2, v2, v140, v144
v_bitop3_b32 v2, v2, v88, s91 bitop3:0xa8
v_cmp_ne_u32 vcc, 0, v2
s_cbranch_vccnz L_y_rt
L_y_ok:
v_pk_add_f32 v[120:121], v[120:121], v[124:125]
v_pk_add_f32 v[122:123], v[122:123], v[126:127]
v_pk_add_f32 v[128:129], v[128:129], v[132:133]
v_pk_add_f32 v[130:131], v[130:131], v[134:135]
v_pk_add_f32 v[136:137], v[136:137], v[140:141]
v_pk_add_f32 v[138:139], v[138:139], v[142:143]
v_pk_add_f32 v[120:121], v[120:121], v[128:129]
v_pk_add_f32 v[122:123], v[122:123], v[130:131]
v_pk_add_f32 v[136:137], v[136:137], v[144:145]
v_pk_add_f32 v[138:139], v[138:139], v[146:147]
v_pk_add_f32 v[120:121], v[120:121], v[136:137]
v_pk_add_f32 v[122:123], v[122:123], v[138:139]
s_nop 0
v_add_f32_dpp v120, v120, v120 row_ror:8 row_mask:0xf bank_mask:0xf
v_add_f32_dpp v121, v121, v121 row_ror:8 row_mask:0xf bank_mask:0xf
v_add_f32_dpp v122, v122, v122 row_ror:8 row_mask:0xf bank_mask:0xf
v_add_f32_dpp v123, v123, v123 row_ror:8 row_mask:0xf bank_mask:0xf
v_mov_b32 v124, v120
v_mov_b32 v125, v121
v_mov_b32 v126, v122
v_mov_b32 v127, v123
v_permlane16_swap_b32 v120, v124
s_branch L_over2
L_pad2:
s_branch L_pad10
L_over2:
v_permlane16_swap_b32 v121, v125
v_permlane16_swap_b32 v122, v126
v_permlane16_swap_b32 v123, v127
v_add_f32 v120, v120, v124
v_add_f32 v121, v121, v125
v_add_f32 v122, v122, v126
v_add_f32 v123, v123, v127
v_mov_b32 v124, v120
v_mov_b32 v125, v121
v_mov_b32 v126, v122
v_mov_b32 v127, v123
v_permlane32_swap_b32 v120, v124
v_permlane32_swap_b32 v121, v125
v_permlane32_swap_b32 v122, v126
v_permlane32_swap_b32 v123, v127
v_add_f32 v120, v120, v124
v_add_f32 v121, v121, v125
v_add_f32 v122, v122, v126
v_add_f32 v123, v123, v127
v_fmac_f32 v84, v120, v65
v_fmac_f32 v85, v121, v65
v_fmac_f32 v86, v122, v65
v_fmac_f32 v87, v123, v65
v_cvt_pk_bf16_f32 v84, v84, v85
v_cvt_pk_bf16_f32 v85, v86, v87
s_mov_b64 exec, 0xff
buffer_store_dwordx2 v[84:85], v66, s[20:23], 0 offen sc1
L_ldone:
s_endpgm
.p2alignl 12, 0xbf810000
.fill 0, 4, 0xbf810000
L_compute:
v_and_b32 v2, 15, v1
v_lshrrev_b32 v4, 4, v1
v_lshrrev_b32 v3, 1, v2
v_xor_b32 v3, v3, v4
v_lshlrev_b32 v2, 7, v2
s_lshl_b32 s70, s66, 13
v_add_u32 v2, s70, v2
v_xor_b32 v5, 0, v3
v_lshl_add_u32 v8, v5, 4, v2
v_add_u32 v10, 65536, v8
v_xor_b32 v5, 4, v3
v_lshl_add_u32 v9, v5, 4, v2
v_add_u32 v11, 65536, v9
v_lshrrev_b32 v2, 5, v1
v_mul_u32_u24 v2, 6144, v2
v_bfe_u32 v3, v1, 4, 1
v_lshl_add_u32 v2, v3, 10, v2
v_bfe_u32 v4, v1, 2, 2
v_lshl_add_u32 v2, v4, 7, v2
v_lshlrev_b32 v3, 1, v3
v_bfe_u32 v4, v1, 3, 1
v_or_b32 v3, v3, v4
s_lshl_b32 s70, s67, 1
v_xor_b32 v3, s70, v3
v_and_b32 v4, 3, v1
v_lshl_add_u32 v2, v4, 3, v2
v_xor_b32 v4, 0, v3
v_lshl_add_u32 v12, v4, 5, v2
v_add_u32 v14, 65536, v12
v_xor_b32 v4, 1, v3
v_lshl_add_u32 v13, v4, 5, v2
v_add_u32 v15, 65536, v13
s_waitcnt lgkmcnt(0)
s_mov_b32 s12, s58
s_and_b32 s13, s59, 0xffff
s_mov_b32 s14, 268435456
s_mov_b32 s15, 0x20000
s_load_dword s68, s[58:59], 0
s_mov_b32 s20, s56
s_and_b32 s21, s57, 0xffff
s_mov_b32 s22, 4194304
s_mov_b32 s23, 0x20000
s_lshl_b32 s87, s64, 4
s_add_u32 s87, s87, s65
s_mul_i32 s87, s87, 4352
s_add_u32 s87, s87, 524288
s_lshl_b32 s88, s65, 18
s_lshl_b32 s70, s66, 17
s_add_u32 s88, s88, s70
s_lshl_b32 s70, s64, 11
s_add_u32 s88, s88, s70
s_lshl_b32 s70, s67, 10
s_add_u32 s88, s88, s70
s_add_u32 s88, s88, 2097152
s_mov_b32 s70, 0x3f803f80
v_accvgpr_write_b32 a80, s70
v_accvgpr_write_b32 a81, s70
v_accvgpr_write_b32 a82, s70
v_accvgpr_write_b32 a83, s70
s_mov_b32 s80, 0x358637bd
s_mov_b32 s81, 0x358637bd
s_mov_b32 s82, 0x3f800008
s_mov_b32 s83, 0x3f800008
s_mov_b32 s90, 0x3fb8aa3b
s_mov_b32 s91, 0x3fb8aa3b
s_waitcnt lgkmcnt(0)
s_add_u32 s68, s68, 1
v_and_b32 v7, 3, v1
v_lshrrev_b32_e64 v7, v7, s68
v_and_b32 v7, 1, v7
v_mul_u32_u24 v7, 0x10001, v7
s_mov_b32 s76, 0x10001
s_mov_b32 s77, 0x07060302
s_movk_i32 s85, 0xff
v_mov_b32 v28, -1
v_mov_b32 v29, -1
v_mov_b32 v30, -1
v_mov_b32 v31, -1
s_and_b32 s94, s65, 3
s_or_b32 s94, s94, s66
s_barrier
ds_read_b128 a[0:3], v10 offset:57344
ds_read_b64_tr_b16 a[32:33], v12 offset:0
ds_read_b64_tr_b16 a[34:35], v12 offset:512
ds_read_b128 a[4:7], v10 offset:59392
ds_read_b128 a[8:11], v10 offset:61440
ds_read_b128 a[12:15], v10 offset:63488
ds_read_b64_tr_b16 a[36:37], v13 offset:0
ds_read_b64_tr_b16 a[38:39], v13 offset:512
ds_read_b64_tr_b16 a[40:41], v12 offset:2048
ds_read_b64_tr_b16 a[42:43], v12 offset:2560
ds_read_b64_tr_b16 a[44:45], v13 offset:2048
ds_read_b64_tr_b16 a[46:47], v13 offset:2560
ds_read_b64_tr_b16 a[48:49], v12 offset:4096
ds_read_b64_tr_b16 a[50:51], v12 offset:4608
ds_read_b64_tr_b16 a[52:53], v13 offset:4096
ds_read_b64_tr_b16 a[54:55], v13 offset:4608
s_waitcnt lgkmcnt(0)
s_cmp_lg_u32 s94, 0
s_cbranch_scc1 L_nocs0_0
v_mfma_f32_16x16x32_bf16 v[128:131], a[80:83], a[32:35], 0
v_mfma_f32_16x16x32_bf16 v[132:135], a[80:83], a[36:39], 0
v_mfma_f32_16x16x32_bf16 v[136:139], a[80:83], a[40:43], 0
v_mfma_f32_16x16x32_bf16 v[140:143], a[80:83], a[44:47], 0
v_mfma_f32_16x16x32_bf16 v[144:147], a[80:83], a[48:51], 0
v_mfma_f32_16x16x32_bf16 v[148:151], a[80:83], a[52:55], 0
L_nocs0_0:
v_mfma_f32_16x16x32_bf16 v[32:35], a[32:35], a[0:3], 0
ds_read_b128 a[16:19], v11 offset:57344
v_mfma_f32_16x16x32_bf16 v[56:59], a[32:35], a[4:7], 0
ds_read_b64_tr_b16 a[56:57], v12 offset:12288
v_mfma_f32_16x16x32_bf16 v[80:83], a[32:35], a[8:11], 0
ds_read_b64_tr_b16 a[58:59], v12 offset:12800
v_mfma_f32_16x16x32_bf16 v[104:107], a[32:35], a[12:15], 0
ds_read_b128 a[20:23], v11 offset:59392
v_mfma_f32_16x16x32_bf16 v[36:39], a[36:39], a[0:3], 0
ds_read_b128 a[24:27], v11 offset:61440
v_mfma_f32_16x16x32_bf16 v[60:63], a[36:39], a[4:7], 0
ds_read_b128 a[28:31], v11 offset:63488
v_mfma_f32_16x16x32_bf16 v[84:87], a[36:39], a[8:11], 0
ds_read_b64_tr_b16 a[60:61], v13 offset:12288
v_mfma_f32_16x16x32_bf16 v[108:111], a[36:39], a[12:15], 0
ds_read_b64_tr_b16 a[62:63], v13 offset:12800
v_mfma_f32_16x16x32_bf16 v[40:43], a[0:3], a[40:43], 0
ds_read_b64_tr_b16 a[64:65], v12 offset:14336
v_mfma_f32_16x16x32_bf16 v[64:67], a[4:7], a[40:43], 0
ds_read_b64_tr_b16 a[66:67], v12 offset:14848
v_mfma_f32_16x16x32_bf16 v[88:91], a[8:11], a[40:43], 0
ds_read_b64_tr_b16 a[68:69], v13 offset:14336
v_mfma_f32_16x16x32_bf16 v[112:115], a[12:15], a[40:43], 0
ds_read_b64_tr_b16 a[70:71], v13 offset:14848
v_mfma_f32_16x16x32_bf16 v[44:47], a[0:3], a[44:47], 0
ds_read_b64_tr_b16 a[72:73], v12 offset:16384
v_mfma_f32_16x16x32_bf16 v[68:71], a[4:7], a[44:47], 0
ds_read_b64_tr_b16 a[74:75], v12 offset:16896
v_mfma_f32_16x16x32_bf16 v[92:95], a[8:11], a[44:47], 0
ds_read_b64_tr_b16 a[76:77], v13 offset:16384
v_mfma_f32_16x16x32_bf16 v[116:119], a[12:15], a[44:47], 0
ds_read_b64_tr_b16 a[78:79], v13 offset:16896
v_mfma_f32_16x16x32_bf16 v[48:51], a[0:3], a[48:51], 0
v_mfma_f32_16x16x32_bf16 v[72:75], a[4:7], a[48:51], 0
v_mfma_f32_16x16x32_bf16 v[96:99], a[8:11], a[48:51], 0
v_mfma_f32_16x16x32_bf16 v[120:123], a[12:15], a[48:51], 0
v_mfma_f32_16x16x32_bf16 v[52:55], a[0:3], a[52:55], 0
v_mfma_f32_16x16x32_bf16 v[76:79], a[4:7], a[52:55], 0
v_mfma_f32_16x16x32_bf16 v[100:103], a[8:11], a[52:55], 0
v_mfma_f32_16x16x32_bf16 v[124:127], a[12:15], a[52:55], 0
s_waitcnt lgkmcnt(0)
s_cmp_lg_u32 s94, 0
s_cbranch_scc1 L_nocs0_1
v_mfma_f32_16x16x32_bf16 v[128:131], a[80:83], a[56:59], v[128:131]
v_mfma_f32_16x16x32_bf16 v[132:135], a[80:83], a[60:63], v[132:135]
v_mfma_f32_16x16x32_bf16 v[136:139], a[80:83], a[64:67], v[136:139]
v_mfma_f32_16x16x32_bf16 v[140:143], a[80:83], a[68:71], v[140:143]
v_mfma_f32_16x16x32_bf16 v[144:147], a[80:83], a[72:75], v[144:147]
v_mfma_f32_16x16x32_bf16 v[148:151], a[80:83], a[76:79], v[148:151]
L_nocs0_1:
v_mfma_f32_16x16x32_bf16 v[32:35], a[56:59], a[16:19], v[32:35]
s_barrier
ds_read_b128 a[0:3], v10 offset:40960
v_mfma_f32_16x16x32_bf16 v[56:59], a[56:59], a[20:23], v[56:59]
ds_read_b64_tr_b16 a[32:33], v14 offset:16384
v_mfma_f32_16x16x32_bf16 v[80:83], a[56:59], a[24:27], v[80:83]
ds_read_b64_tr_b16 a[34:35], v14 offset:16896
v_mfma_f32_16x16x32_bf16 v[104:107], a[56:59], a[28:31], v[104:107]
ds_read_b128 a[4:7], v10 offset:43008
v_mfma_f32_16x16x32_bf16 v[36:39], a[60:63], a[16:19], v[36:39]
ds_read_b128 a[8:11], v10 offset:45056
v_mfma_f32_16x16x32_bf16 v[60:63], a[60:63], a[20:23], v[60:63]
ds_read_b128 a[12:15], v10 offset:47104
v_mfma_f32_16x16x32_bf16 v[84:87], a[60:63], a[24:27], v[84:87]
ds_read_b64_tr_b16 a[36:37], v15 offset:16384
v_mfma_f32_16x16x32_bf16 v[108:111], a[60:63], a[28:31], v[108:111]
ds_read_b64_tr_b16 a[38:39], v15 offset:16896
v_mfma_f32_16x16x32_bf16 v[40:43], a[16:19], a[64:67], v[40:43]
ds_read_b64_tr_b16 a[40:41], v14 offset:18432
v_mfma_f32_16x16x32_bf16 v[64:67], a[20:23], a[64:67], v[64:67]
ds_read_b64_tr_b16 a[42:43], v14 offset:18944
v_mfma_f32_16x16x32_bf16 v[88:91], a[24:27], a[64:67], v[88:91]
ds_read_b64_tr_b16 a[44:45], v15 offset:18432
v_mfma_f32_16x16x32_bf16 v[112:115], a[28:31], a[64:67], v[112:115]
ds_read_b64_tr_b16 a[46:47], v15 offset:18944
v_mfma_f32_16x16x32_bf16 v[44:47], a[16:19], a[68:71], v[44:47]
ds_read_b64_tr_b16 a[48:49], v14 offset:20480
v_mfma_f32_16x16x32_bf16 v[68:71], a[20:23], a[68:71], v[68:71]
ds_read_b64_tr_b16 a[50:51], v14 offset:20992
v_mfma_f32_16x16x32_bf16 v[92:95], a[24:27], a[68:71], v[92:95]
ds_read_b64_tr_b16 a[52:53], v15 offset:20480
v_mfma_f32_16x16x32_bf16 v[116:119], a[28:31], a[68:71], v[116:119]
ds_read_b64_tr_b16 a[54:55], v15 offset:20992
v_mfma_f32_16x16x32_bf16 v[48:51], a[16:19], a[72:75], v[48:51]
v_mfma_f32_16x16x32_bf16 v[72:75], a[20:23], a[72:75], v[72:75]
v_mfma_f32_16x16x32_bf16 v[96:99], a[24:27], a[72:75], v[96:99]
v_mfma_f32_16x16x32_bf16 v[120:123], a[28:31], a[72:75], v[120:123]
v_mfma_f32_16x16x32_bf16 v[52:55], a[16:19], a[76:79], v[52:55]
v_mfma_f32_16x16x32_bf16 v[76:79], a[20:23], a[76:79], v[76:79]
v_mfma_f32_16x16x32_bf16 v[100:103], a[24:27], a[76:79], v[100:103]
v_mfma_f32_16x16x32_bf16 v[124:127], a[28:31], a[76:79], v[124:127]
s_waitcnt lgkmcnt(0)
s_cmp_lg_u32 s94, 0
s_cbranch_scc1 L_nocs1_0
v_mfma_f32_16x16x32_bf16 v[128:131], a[80:83], a[32:35], v[128:131]
v_mfma_f32_16x16x32_bf16 v[132:135], a[80:83], a[36:39], v[132:135]
v_mfma_f32_16x16x32_bf16 v[136:139], a[80:83], a[40:43], v[136:139]
v_mfma_f32_16x16x32_bf16 v[140:143], a[80:83], a[44:47], v[140:143]
v_mfma_f32_16x16x32_bf16 v[144:147], a[80:83], a[48:51], v[144:147]
v_mfma_f32_16x16x32_bf16 v[148:151], a[80:83], a[52:55], v[148:151]
L_nocs1_0:
v_mfma_f32_16x16x32_bf16 v[32:35], a[32:35], a[0:3], v[32:35]
ds_read_b128 a[16:19], v11 offset:40960
v_mfma_f32_16x16x32_bf16 v[56:59], a[32:35], a[4:7], v[56:59]
ds_read_b64_tr_b16 a[56:57], v14 offset:28672
v_mfma_f32_16x16x32_bf16 v[80:83], a[32:35], a[8:11], v[80:83]
ds_read_b64_tr_b16 a[58:59], v14 offset:29184
v_mfma_f32_16x16x32_bf16 v[104:107], a[32:35], a[12:15], v[104:107]
ds_read_b128 a[20:23], v11 offset:43008
v_mfma_f32_16x16x32_bf16 v[36:39], a[36:39], a[0:3], v[36:39]
ds_read_b128 a[24:27], v11 offset:45056
v_mfma_f32_16x16x32_bf16 v[60:63], a[36:39], a[4:7], v[60:63]
ds_read_b128 a[28:31], v11 offset:47104
v_mfma_f32_16x16x32_bf16 v[84:87], a[36:39], a[8:11], v[84:87]
ds_read_b64_tr_b16 a[60:61], v15 offset:28672
v_mfma_f32_16x16x32_bf16 v[108:111], a[36:39], a[12:15], v[108:111]
ds_read_b64_tr_b16 a[62:63], v15 offset:29184
v_mfma_f32_16x16x32_bf16 v[40:43], a[0:3], a[40:43], v[40:43]
ds_read_b64_tr_b16 a[64:65], v14 offset:30720
v_mfma_f32_16x16x32_bf16 v[64:67], a[4:7], a[40:43], v[64:67]
ds_read_b64_tr_b16 a[66:67], v14 offset:31232
v_mfma_f32_16x16x32_bf16 v[88:91], a[8:11], a[40:43], v[88:91]
ds_read_b64_tr_b16 a[68:69], v15 offset:30720
v_mfma_f32_16x16x32_bf16 v[112:115], a[12:15], a[40:43], v[112:115]
ds_read_b64_tr_b16 a[70:71], v15 offset:31232
v_mfma_f32_16x16x32_bf16 v[44:47], a[0:3], a[44:47], v[44:47]
ds_read_b64_tr_b16 a[72:73], v14 offset:32768
v_mfma_f32_16x16x32_bf16 v[68:71], a[4:7], a[44:47], v[68:71]
ds_read_b64_tr_b16 a[74:75], v14 offset:33280
v_mfma_f32_16x16x32_bf16 v[92:95], a[8:11], a[44:47], v[92:95]
ds_read_b64_tr_b16 a[76:77], v15 offset:32768
v_mfma_f32_16x16x32_bf16 v[116:119], a[12:15], a[44:47], v[116:119]
ds_read_b64_tr_b16 a[78:79], v15 offset:33280
v_mfma_f32_16x16x32_bf16 v[48:51], a[0:3], a[48:51], v[48:51]
v_mfma_f32_16x16x32_bf16 v[72:75], a[4:7], a[48:51], v[72:75]
v_mfma_f32_16x16x32_bf16 v[96:99], a[8:11], a[48:51], v[96:99]
v_mfma_f32_16x16x32_bf16 v[120:123], a[12:15], a[48:51], v[120:123]
v_mfma_f32_16x16x32_bf16 v[52:55], a[0:3], a[52:55], v[52:55]
v_mfma_f32_16x16x32_bf16 v[76:79], a[4:7], a[52:55], v[76:79]
v_mfma_f32_16x16x32_bf16 v[100:103], a[8:11], a[52:55], v[100:103]
v_mfma_f32_16x16x32_bf16 v[124:127], a[12:15], a[52:55], v[124:127]
s_waitcnt lgkmcnt(0)
s_cmp_lg_u32 s94, 0
s_cbranch_scc1 L_nocs1_1
v_mfma_f32_16x16x32_bf16 v[128:131], a[80:83], a[56:59], v[128:131]
v_mfma_f32_16x16x32_bf16 v[132:135], a[80:83], a[60:63], v[132:135]
v_mfma_f32_16x16x32_bf16 v[136:139], a[80:83], a[64:67], v[136:139]
v_mfma_f32_16x16x32_bf16 v[140:143], a[80:83], a[68:71], v[140:143]
v_mfma_f32_16x16x32_bf16 v[144:147], a[80:83], a[72:75], v[144:147]
v_mfma_f32_16x16x32_bf16 v[148:151], a[80:83], a[76:79], v[148:151]
L_nocs1_1:
v_mfma_f32_16x16x32_bf16 v[32:35], a[56:59], a[16:19], v[32:35]
s_barrier
ds_read_b128 a[0:3], v10 offset:0
v_mfma_f32_16x16x32_bf16 v[56:59], a[56:59], a[20:23], v[56:59]
ds_read_b64_tr_b16 a[32:33], v12 offset:40960
v_mfma_f32_16x16x32_bf16 v[80:83], a[56:59], a[24:27], v[80:83]
ds_read_b64_tr_b16 a[34:35], v12 offset:41472
v_mfma_f32_16x16x32_bf16 v[104:107], a[56:59], a[28:31], v[104:107]
ds_read_b128 a[4:7], v10 offset:2048
v_mfma_f32_16x16x32_bf16 v[36:39], a[60:63], a[16:19], v[36:39]
ds_read_b128 a[8:11], v10 offset:4096
v_mfma_f32_16x16x32_bf16 v[60:63], a[60:63], a[20:23], v[60:63]
ds_read_b128 a[12:15], v10 offset:6144
v_mfma_f32_16x16x32_bf16 v[84:87], a[60:63], a[24:27], v[84:87]
ds_read_b64_tr_b16 a[36:37], v13 offset:40960
v_mfma_f32_16x16x32_bf16 v[108:111], a[60:63], a[28:31], v[108:111]
ds_read_b64_tr_b16 a[38:39], v13 offset:41472
v_mfma_f32_16x16x32_bf16 v[40:43], a[16:19], a[64:67], v[40:43]
ds_read_b64_tr_b16 a[40:41], v12 offset:43008
v_mfma_f32_16x16x32_bf16 v[64:67], a[20:23], a[64:67], v[64:67]
ds_read_b64_tr_b16 a[42:43], v12 offset:43520
v_mfma_f32_16x16x32_bf16 v[88:91], a[24:27], a[64:67], v[88:91]
ds_read_b64_tr_b16 a[44:45], v13 offset:43008
v_mfma_f32_16x16x32_bf16 v[112:115], a[28:31], a[64:67], v[112:115]
ds_read_b64_tr_b16 a[46:47], v13 offset:43520
v_mfma_f32_16x16x32_bf16 v[44:47], a[16:19], a[68:71], v[44:47]
ds_read_b64_tr_b16 a[48:49], v12 offset:45056
v_mfma_f32_16x16x32_bf16 v[68:71], a[20:23], a[68:71], v[68:71]
ds_read_b64_tr_b16 a[50:51], v12 offset:45568
v_mfma_f32_16x16x32_bf16 v[92:95], a[24:27], a[68:71], v[92:95]
ds_read_b64_tr_b16 a[52:53], v13 offset:45056
v_mfma_f32_16x16x32_bf16 v[116:119], a[28:31], a[68:71], v[116:119]
ds_read_b64_tr_b16 a[54:55], v13 offset:45568
v_mfma_f32_16x16x32_bf16 v[48:51], a[16:19], a[72:75], v[48:51]
v_mfma_f32_16x16x32_bf16 v[72:75], a[20:23], a[72:75], v[72:75]
v_mfma_f32_16x16x32_bf16 v[96:99], a[24:27], a[72:75], v[96:99]
v_mfma_f32_16x16x32_bf16 v[120:123], a[28:31], a[72:75], v[120:123]
v_mfma_f32_16x16x32_bf16 v[52:55], a[16:19], a[76:79], v[52:55]
v_mfma_f32_16x16x32_bf16 v[76:79], a[20:23], a[76:79], v[76:79]
v_mfma_f32_16x16x32_bf16 v[100:103], a[24:27], a[76:79], v[100:103]
v_mfma_f32_16x16x32_bf16 v[124:127], a[28:31], a[76:79], v[124:127]
s_waitcnt lgkmcnt(0)
s_cmp_lg_u32 s94, 0
s_cbranch_scc1 L_nocs2_0
v_mfma_f32_16x16x32_bf16 v[128:131], a[80:83], a[32:35], v[128:131]
v_mfma_f32_16x16x32_bf16 v[132:135], a[80:83], a[36:39], v[132:135]
v_mfma_f32_16x16x32_bf16 v[136:139], a[80:83], a[40:43], v[136:139]
v_mfma_f32_16x16x32_bf16 v[140:143], a[80:83], a[44:47], v[140:143]
v_mfma_f32_16x16x32_bf16 v[144:147], a[80:83], a[48:51], v[144:147]
v_mfma_f32_16x16x32_bf16 v[148:151], a[80:83], a[52:55], v[148:151]
L_nocs2_0:
v_mfma_f32_16x16x32_bf16 v[32:35], a[32:35], a[0:3], v[32:35]
ds_read_b128 a[16:19], v11 offset:0
v_mfma_f32_16x16x32_bf16 v[56:59], a[32:35], a[4:7], v[56:59]
ds_read_b64_tr_b16 a[56:57], v12 offset:53248
v_mfma_f32_16x16x32_bf16 v[80:83], a[32:35], a[8:11], v[80:83]
ds_read_b64_tr_b16 a[58:59], v12 offset:53760
v_mfma_f32_16x16x32_bf16 v[104:107], a[32:35], a[12:15], v[104:107]
ds_read_b128 a[20:23], v11 offset:2048
v_mfma_f32_16x16x32_bf16 v[36:39], a[36:39], a[0:3], v[36:39]
ds_read_b128 a[24:27], v11 offset:4096
v_mfma_f32_16x16x32_bf16 v[60:63], a[36:39], a[4:7], v[60:63]
ds_read_b128 a[28:31], v11 offset:6144
v_mfma_f32_16x16x32_bf16 v[84:87], a[36:39], a[8:11], v[84:87]
ds_read_b64_tr_b16 a[60:61], v13 offset:53248
v_mfma_f32_16x16x32_bf16 v[108:111], a[36:39], a[12:15], v[108:111]
ds_read_b64_tr_b16 a[62:63], v13 offset:53760
v_mfma_f32_16x16x32_bf16 v[40:43], a[0:3], a[40:43], v[40:43]
ds_read_b64_tr_b16 a[64:65], v12 offset:55296
v_mfma_f32_16x16x32_bf16 v[64:67], a[4:7], a[40:43], v[64:67]
ds_read_b64_tr_b16 a[66:67], v12 offset:55808
v_mfma_f32_16x16x32_bf16 v[88:91], a[8:11], a[40:43], v[88:91]
ds_read_b64_tr_b16 a[68:69], v13 offset:55296
v_mfma_f32_16x16x32_bf16 v[112:115], a[12:15], a[40:43], v[112:115]
ds_read_b64_tr_b16 a[70:71], v13 offset:55808
v_mfma_f32_16x16x32_bf16 v[44:47], a[0:3], a[44:47], v[44:47]
ds_read_b64_tr_b16 a[72:73], v12 offset:57344
v_mfma_f32_16x16x32_bf16 v[68:71], a[4:7], a[44:47], v[68:71]
ds_read_b64_tr_b16 a[74:75], v12 offset:57856
v_mfma_f32_16x16x32_bf16 v[92:95], a[8:11], a[44:47], v[92:95]
ds_read_b64_tr_b16 a[76:77], v13 offset:57344
v_mfma_f32_16x16x32_bf16 v[116:119], a[12:15], a[44:47], v[116:119]
ds_read_b64_tr_b16 a[78:79], v13 offset:57856
v_mfma_f32_16x16x32_bf16 v[48:51], a[0:3], a[48:51], v[48:51]
s_lshl_b32 s70, s60, 10
s_add_u32 s70, s70, s87
buffer_store_dwordx4 v[28:31], v16, s[12:15], s70 offen sc1
v_mfma_f32_16x16x32_bf16 v[72:75], a[4:7], a[48:51], v[72:75]
v_mfma_f32_16x16x32_bf16 v[96:99], a[8:11], a[48:51], v[96:99]
v_mfma_f32_16x16x32_bf16 v[120:123], a[12:15], a[48:51], v[120:123]
v_mfma_f32_16x16x32_bf16 v[52:55], a[0:3], a[52:55], v[52:55]
v_mfma_f32_16x16x32_bf16 v[76:79], a[4:7], a[52:55], v[76:79]
v_mfma_f32_16x16x32_bf16 v[100:103], a[8:11], a[52:55], v[100:103]
v_mfma_f32_16x16x32_bf16 v[124:127], a[12:15], a[52:55], v[124:127]
s_waitcnt lgkmcnt(0)
s_cmp_lg_u32 s94, 0
s_cbranch_scc1 L_nocs2_1
v_mfma_f32_16x16x32_bf16 v[128:131], a[80:83], a[56:59], v[128:131]
v_mfma_f32_16x16x32_bf16 v[132:135], a[80:83], a[60:63], v[132:135]
v_mfma_f32_16x16x32_bf16 v[136:139], a[80:83], a[64:67], v[136:139]
v_mfma_f32_16x16x32_bf16 v[140:143], a[80:83], a[68:71], v[140:143]
v_mfma_f32_16x16x32_bf16 v[144:147], a[80:83], a[72:75], v[144:147]
v_mfma_f32_16x16x32_bf16 v[148:151], a[80:83], a[76:79], v[148:151]
L_nocs2_1:
v_mfma_f32_16x16x32_bf16 v[32:35], a[56:59], a[16:19], v[32:35]
s_barrier
ds_read_b128 a[0:3], v8 offset:24576
v_mfma_f32_16x16x32_bf16 v[56:59], a[56:59], a[20:23], v[56:59]
ds_read_b64_tr_b16 a[32:33], v12 offset:0
v_mfma_f32_16x16x32_bf16 v[80:83], a[56:59], a[24:27], v[80:83]
ds_read_b64_tr_b16 a[34:35], v12 offset:512
v_mfma_f32_16x16x32_bf16 v[104:107], a[56:59], a[28:31], v[104:107]
ds_read_b128 a[4:7], v8 offset:26624
v_mfma_f32_16x16x32_bf16 v[36:39], a[60:63], a[16:19], v[36:39]
ds_read_b128 a[8:11], v8 offset:28672
v_mfma_f32_16x16x32_bf16 v[60:63], a[60:63], a[20:23], v[60:63]
ds_read_b128 a[12:15], v8 offset:30720
v_mfma_f32_16x16x32_bf16 v[84:87], a[60:63], a[24:27], v[84:87]
ds_read_b64_tr_b16 a[36:37], v13 offset:0
v_mfma_f32_16x16x32_bf16 v[108:111], a[60:63], a[28:31], v[108:111]
ds_read_b64_tr_b16 a[38:39], v13 offset:512
v_mfma_f32_16x16x32_bf16 v[40:43], a[16:19], a[64:67], v[40:43]
ds_read_b64_tr_b16 a[40:41], v12 offset:2048
v_mfma_f32_16x16x32_bf16 v[64:67], a[20:23], a[64:67], v[64:67]
ds_read_b64_tr_b16 a[42:43], v12 offset:2560
v_mfma_f32_16x16x32_bf16 v[88:91], a[24:27], a[64:67], v[88:91]
ds_read_b64_tr_b16 a[44:45], v13 offset:2048
v_mfma_f32_16x16x32_bf16 v[112:115], a[28:31], a[64:67], v[112:115]
ds_read_b64_tr_b16 a[46:47], v13 offset:2560
v_mfma_f32_16x16x32_bf16 v[44:47], a[16:19], a[68:71], v[44:47]
ds_read_b64_tr_b16 a[48:49], v12 offset:4096
v_mfma_f32_16x16x32_bf16 v[68:71], a[20:23], a[68:71], v[68:71]
ds_read_b64_tr_b16 a[50:51], v12 offset:4608
v_mfma_f32_16x16x32_bf16 v[92:95], a[24:27], a[68:71], v[92:95]
ds_read_b64_tr_b16 a[52:53], v13 offset:4096
v_mfma_f32_16x16x32_bf16 v[116:119], a[28:31], a[68:71], v[116:119]
ds_read_b64_tr_b16 a[54:55], v13 offset:4608
v_mfma_f32_16x16x32_bf16 v[48:51], a[16:19], a[72:75], v[48:51]
v_mfma_f32_16x16x32_bf16 v[72:75], a[20:23], a[72:75], v[72:75]
v_mfma_f32_16x16x32_bf16 v[96:99], a[24:27], a[72:75], v[96:99]
v_mfma_f32_16x16x32_bf16 v[120:123], a[28:31], a[72:75], v[120:123]
v_mfma_f32_16x16x32_bf16 v[52:55], a[16:19], a[76:79], v[52:55]
v_mfma_f32_16x16x32_bf16 v[76:79], a[20:23], a[76:79], v[76:79]
v_mfma_f32_16x16x32_bf16 v[100:103], a[24:27], a[76:79], v[100:103]
v_mfma_f32_16x16x32_bf16 v[124:127], a[28:31], a[76:79], v[124:127]
s_waitcnt lgkmcnt(0)
s_cmp_lg_u32 s94, 0
s_cbranch_scc1 L_nocs3_0
v_mfma_f32_16x16x32_bf16 v[128:131], a[80:83], a[32:35], v[128:131]
v_mfma_f32_16x16x32_bf16 v[132:135], a[80:83], a[36:39], v[132:135]
v_mfma_f32_16x16x32_bf16 v[136:139], a[80:83], a[40:43], v[136:139]
v_mfma_f32_16x16x32_bf16 v[140:143], a[80:83], a[44:47], v[140:143]
v_mfma_f32_16x16x32_bf16 v[144:147], a[80:83], a[48:51], v[144:147]
v_mfma_f32_16x16x32_bf16 v[148:151], a[80:83], a[52:55], v[148:151]
L_nocs3_0:
v_mfma_f32_16x16x32_bf16 v[32:35], a[32:35], a[0:3], v[32:35]
ds_read_b128 a[16:19], v9 offset:24576
v_mfma_f32_16x16x32_bf16 v[56:59], a[32:35], a[4:7], v[56:59]
ds_read_b64_tr_b16 a[56:57], v12 offset:12288
v_mfma_f32_16x16x32_bf16 v[80:83], a[32:35], a[8:11], v[80:83]
ds_read_b64_tr_b16 a[58:59], v12 offset:12800
v_mfma_f32_16x16x32_bf16 v[104:107], a[32:35], a[12:15], v[104:107]
ds_read_b128 a[20:23], v9 offset:26624
v_mfma_f32_16x16x32_bf16 v[36:39], a[36:39], a[0:3], v[36:39]
ds_read_b128 a[24:27], v9 offset:28672
v_mfma_f32_16x16x32_bf16 v[60:63], a[36:39], a[4:7], v[60:63]
ds_read_b128 a[28:31], v9 offset:30720
v_mfma_f32_16x16x32_bf16 v[84:87], a[36:39], a[8:11], v[84:87]
ds_read_b64_tr_b16 a[60:61], v13 offset:12288
v_mfma_f32_16x16x32_bf16 v[108:111], a[36:39], a[12:15], v[108:111]
ds_read_b64_tr_b16 a[62:63], v13 offset:12800
v_mfma_f32_16x16x32_bf16 v[40:43], a[0:3], a[40:43], v[40:43]
ds_read_b64_tr_b16 a[64:65], v12 offset:14336
v_mfma_f32_16x16x32_bf16 v[64:67], a[4:7], a[40:43], v[64:67]
ds_read_b64_tr_b16 a[66:67], v12 offset:14848
v_mfma_f32_16x16x32_bf16 v[88:91], a[8:11], a[40:43], v[88:91]
ds_read_b64_tr_b16 a[68:69], v13 offset:14336
v_mfma_f32_16x16x32_bf16 v[112:115], a[12:15], a[40:43], v[112:115]
ds_read_b64_tr_b16 a[70:71], v13 offset:14848
v_mfma_f32_16x16x32_bf16 v[44:47], a[0:3], a[44:47], v[44:47]
ds_read_b64_tr_b16 a[72:73], v12 offset:16384
v_mfma_f32_16x16x32_bf16 v[68:71], a[4:7], a[44:47], v[68:71]
ds_read_b64_tr_b16 a[74:75], v12 offset:16896
v_mfma_f32_16x16x32_bf16 v[92:95], a[8:11], a[44:47], v[92:95]
ds_read_b64_tr_b16 a[76:77], v13 offset:16384
v_mfma_f32_16x16x32_bf16 v[116:119], a[12:15], a[44:47], v[116:119]
ds_read_b64_tr_b16 a[78:79], v13 offset:16896
v_mfma_f32_16x16x32_bf16 v[48:51], a[0:3], a[48:51], v[48:51]
v_mfma_f32_16x16x32_bf16 v[72:75], a[4:7], a[48:51], v[72:75]
v_mfma_f32_16x16x32_bf16 v[96:99], a[8:11], a[48:51], v[96:99]
v_mfma_f32_16x16x32_bf16 v[120:123], a[12:15], a[48:51], v[120:123]
v_mfma_f32_16x16x32_bf16 v[52:55], a[0:3], a[52:55], v[52:55]
v_mfma_f32_16x16x32_bf16 v[76:79], a[4:7], a[52:55], v[76:79]
v_mfma_f32_16x16x32_bf16 v[100:103], a[8:11], a[52:55], v[100:103]
v_mfma_f32_16x16x32_bf16 v[124:127], a[12:15], a[52:55], v[124:127]
s_waitcnt lgkmcnt(0)
s_cmp_lg_u32 s94, 0
s_cbranch_scc1 L_nocs3_1
v_mfma_f32_16x16x32_bf16 v[128:131], a[80:83], a[56:59], v[128:131]
v_mfma_f32_16x16x32_bf16 v[132:135], a[80:83], a[60:63], v[132:135]
v_mfma_f32_16x16x32_bf16 v[136:139], a[80:83], a[64:67], v[136:139]
v_mfma_f32_16x16x32_bf16 v[140:143], a[80:83], a[68:71], v[140:143]
v_mfma_f32_16x16x32_bf16 v[144:147], a[80:83], a[72:75], v[144:147]
v_mfma_f32_16x16x32_bf16 v[148:151], a[80:83], a[76:79], v[148:151]
L_nocs3_1:
v_mfma_f32_16x16x32_bf16 v[32:35], a[56:59], a[16:19], v[32:35]
s_barrier
ds_read_b128 a[0:3], v10 offset:57344
v_mfma_f32_16x16x32_bf16 v[56:59], a[56:59], a[20:23], v[56:59]
ds_read_b64_tr_b16 a[32:33], v14 offset:16384
v_mfma_f32_16x16x32_bf16 v[80:83], a[56:59], a[24:27], v[80:83]
ds_read_b64_tr_b16 a[34:35], v14 offset:16896
v_mfma_f32_16x16x32_bf16 v[104:107], a[56:59], a[28:31], v[104:107]
ds_read_b128 a[4:7], v10 offset:59392
v_mfma_f32_16x16x32_bf16 v[36:39], a[60:63], a[16:19], v[36:39]
ds_read_b128 a[8:11], v10 offset:61440
v_mfma_f32_16x16x32_bf16 v[60:63], a[60:63], a[20:23], v[60:63]
ds_read_b128 a[12:15], v10 offset:63488
v_mfma_f32_16x16x32_bf16 v[84:87], a[60:63], a[24:27], v[84:87]
ds_read_b64_tr_b16 a[36:37], v15 offset:16384
v_mfma_f32_16x16x32_bf16 v[108:111], a[60:63], a[28:31], v[108:111]
ds_read_b64_tr_b16 a[38:39], v15 offset:16896
v_mfma_f32_16x16x32_bf16 v[40:43], a[16:19], a[64:67], v[40:43]
ds_read_b64_tr_b16 a[40:41], v14 offset:18432
v_mfma_f32_16x16x32_bf16 v[64:67], a[20:23], a[64:67], v[64:67]
ds_read_b64_tr_b16 a[42:43], v14 offset:18944
v_mfma_f32_16x16x32_bf16 v[88:91], a[24:27], a[64:67], v[88:91]
ds_read_b64_tr_b16 a[44:45], v15 offset:18432
v_mfma_f32_16x16x32_bf16 v[112:115], a[28:31], a[64:67], v[112:115]
ds_read_b64_tr_b16 a[46:47], v15 offset:18944
v_mfma_f32_16x16x32_bf16 v[44:47], a[16:19], a[68:71], v[44:47]
ds_read_b64_tr_b16 a[48:49], v14 offset:20480
v_mfma_f32_16x16x32_bf16 v[68:71], a[20:23], a[68:71], v[68:71]
ds_read_b64_tr_b16 a[50:51], v14 offset:20992
v_mfma_f32_16x16x32_bf16 v[92:95], a[24:27], a[68:71], v[92:95]
ds_read_b64_tr_b16 a[52:53], v15 offset:20480
v_mfma_f32_16x16x32_bf16 v[116:119], a[28:31], a[68:71], v[116:119]
ds_read_b64_tr_b16 a[54:55], v15 offset:20992
v_mfma_f32_16x16x32_bf16 v[48:51], a[16:19], a[72:75], v[48:51]
v_mfma_f32_16x16x32_bf16 v[72:75], a[20:23], a[72:75], v[72:75]
v_mfma_f32_16x16x32_bf16 v[96:99], a[24:27], a[72:75], v[96:99]
v_mfma_f32_16x16x32_bf16 v[120:123], a[28:31], a[72:75], v[120:123]
v_mfma_f32_16x16x32_bf16 v[52:55], a[16:19], a[76:79], v[52:55]
v_mfma_f32_16x16x32_bf16 v[76:79], a[20:23], a[76:79], v[76:79]
v_mfma_f32_16x16x32_bf16 v[100:103], a[24:27], a[76:79], v[100:103]
v_mfma_f32_16x16x32_bf16 v[124:127], a[28:31], a[76:79], v[124:127]
s_waitcnt lgkmcnt(0)
v_mfma_f32_16x16x32_bf16 v[32:35], a[32:35], a[0:3], v[32:35]
ds_read_b128 a[16:19], v11 offset:57344
v_mfma_f32_16x16x32_bf16 v[56:59], a[32:35], a[4:7], v[56:59]
ds_read_b64_tr_b16 a[56:57], v14 offset:28672
v_mfma_f32_16x16x32_bf16 v[80:83], a[32:35], a[8:11], v[80:83]
ds_read_b64_tr_b16 a[58:59], v14 offset:29184
v_mfma_f32_16x16x32_bf16 v[104:107], a[32:35], a[12:15], v[104:107]
ds_read_b128 a[20:23], v11 offset:59392
v_mfma_f32_16x16x32_bf16 v[36:39], a[36:39], a[0:3], v[36:39]
ds_read_b128 a[24:27], v11 offset:61440
v_mfma_f32_16x16x32_bf16 v[60:63], a[36:39], a[4:7], v[60:63]
ds_read_b128 a[28:31], v11 offset:63488
v_mfma_f32_16x16x32_bf16 v[84:87], a[36:39], a[8:11], v[84:87]
ds_read_b64_tr_b16 a[60:61], v15 offset:28672
v_mfma_f32_16x16x32_bf16 v[108:111], a[36:39], a[12:15], v[108:111]
ds_read_b64_tr_b16 a[62:63], v15 offset:29184
v_mfma_f32_16x16x32_bf16 v[40:43], a[0:3], a[40:43], v[40:43]
ds_read_b64_tr_b16 a[64:65], v14 offset:30720
v_mfma_f32_16x16x32_bf16 v[64:67], a[4:7], a[40:43], v[64:67]
ds_read_b64_tr_b16 a[66:67], v14 offset:31232
v_mfma_f32_16x16x32_bf16 v[88:91], a[8:11], a[40:43], v[88:91]
ds_read_b64_tr_b16 a[68:69], v15 offset:30720
v_mfma_f32_16x16x32_bf16 v[112:115], a[12:15], a[40:43], v[112:115]
ds_read_b64_tr_b16 a[70:71], v15 offset:31232
v_mfma_f32_16x16x32_bf16 v[44:47], a[0:3], a[44:47], v[44:47]
ds_read_b64_tr_b16 a[72:73], v14 offset:32768
v_mfma_f32_16x16x32_bf16 v[68:71], a[4:7], a[44:47], v[68:71]
ds_read_b64_tr_b16 a[74:75], v14 offset:33280
v_mfma_f32_16x16x32_bf16 v[92:95], a[8:11], a[44:47], v[92:95]
ds_read_b64_tr_b16 a[76:77], v15 offset:32768
v_mfma_f32_16x16x32_bf16 v[116:119], a[12:15], a[44:47], v[116:119]
ds_read_b64_tr_b16 a[78:79], v15 offset:33280
v_mfma_f32_16x16x32_bf16 v[48:51], a[0:3], a[48:51], v[48:51]
s_add_u32 s70, s88, 0
buffer_store_dwordx4 v[28:31], v16, s[12:15], s70 offen sc1
v_mfma_f32_16x16x32_bf16 v[72:75], a[4:7], a[48:51], v[72:75]
v_mfma_f32_16x16x32_bf16 v[96:99], a[8:11], a[48:51], v[96:99]
s_add_u32 s70, s88, 32768
buffer_store_dwordx4 v[28:31], v16, s[12:15], s70 offen sc1
v_mfma_f32_16x16x32_bf16 v[120:123], a[12:15], a[48:51], v[120:123]
v_mfma_f32_16x16x32_bf16 v[52:55], a[0:3], a[52:55], v[52:55]
v_mfma_f32_16x16x32_bf16 v[76:79], a[4:7], a[52:55], v[76:79]
v_mfma_f32_16x16x32_bf16 v[100:103], a[8:11], a[52:55], v[100:103]
v_mfma_f32_16x16x32_bf16 v[124:127], a[12:15], a[52:55], v[124:127]
s_waitcnt lgkmcnt(0)
v_mfma_f32_16x16x32_bf16 v[32:35], a[56:59], a[16:19], v[32:35]
s_barrier
ds_read_b128 a[0:3], v10 offset:40960
v_mfma_f32_16x16x32_bf16 v[56:59], a[56:59], a[20:23], v[56:59]
ds_read_b64_tr_b16 a[32:33], v12 offset:40960
v_mfma_f32_16x16x32_bf16 v[80:83], a[56:59], a[24:27], v[80:83]
ds_read_b64_tr_b16 a[34:35], v12 offset:41472
s_branch L_over3
L_pad3:
s_branch L_ret4
L_over3:
v_mfma_f32_16x16x32_bf16 v[104:107], a[56:59], a[28:31], v[104:107]
ds_read_b128 a[4:7], v10 offset:43008
v_mfma_f32_16x16x32_bf16 v[36:39], a[60:63], a[16:19], v[36:39]
ds_read_b128 a[8:11], v10 offset:45056
v_mfma_f32_16x16x32_bf16 v[60:63], a[60:63], a[20:23], v[60:63]
ds_read_b128 a[12:15], v10 offset:47104
v_mfma_f32_16x16x32_bf16 v[84:87], a[60:63], a[24:27], v[84:87]
ds_read_b64_tr_b16 a[36:37], v13 offset:40960
v_mfma_f32_16x16x32_bf16 v[108:111], a[60:63], a[28:31], v[108:111]
ds_read_b64_tr_b16 a[38:39], v13 offset:41472
v_mfma_f32_16x16x32_bf16 v[40:43], a[16:19], a[64:67], v[40:43]
ds_read_b64_tr_b16 a[40:41], v12 offset:43008
v_mfma_f32_16x16x32_bf16 v[64:67], a[20:23], a[64:67], v[64:67]
ds_read_b64_tr_b16 a[42:43], v12 offset:43520
v_mfma_f32_16x16x32_bf16 v[88:91], a[24:27], a[64:67], v[88:91]
ds_read_b64_tr_b16 a[44:45], v13 offset:43008
v_mfma_f32_16x16x32_bf16 v[112:115], a[28:31], a[64:67], v[112:115]
ds_read_b64_tr_b16 a[46:47], v13 offset:43520
v_mfma_f32_16x16x32_bf16 v[44:47], a[16:19], a[68:71], v[44:47]
ds_read_b64_tr_b16 a[48:49], v12 offset:45056
v_mfma_f32_16x16x32_bf16 v[68:71], a[20:23], a[68:71], v[68:71]
ds_read_b64_tr_b16 a[50:51], v12 offset:45568
v_mfma_f32_16x16x32_bf16 v[92:95], a[24:27], a[68:71], v[92:95]
ds_read_b64_tr_b16 a[52:53], v13 offset:45056
v_mfma_f32_16x16x32_bf16 v[116:119], a[28:31], a[68:71], v[116:119]
ds_read_b64_tr_b16 a[54:55], v13 offset:45568
v_mfma_f32_16x16x32_bf16 v[48:51], a[16:19], a[72:75], v[48:51]
v_mfma_f32_16x16x32_bf16 v[72:75], a[20:23], a[72:75], v[72:75]
v_mfma_f32_16x16x32_bf16 v[96:99], a[24:27], a[72:75], v[96:99]
v_mfma_f32_16x16x32_bf16 v[120:123], a[28:31], a[72:75], v[120:123]
v_mfma_f32_16x16x32_bf16 v[52:55], a[16:19], a[76:79], v[52:55]
v_mfma_f32_16x16x32_bf16 v[76:79], a[20:23], a[76:79], v[76:79]
v_mfma_f32_16x16x32_bf16 v[100:103], a[24:27], a[76:79], v[100:103]
v_mfma_f32_16x16x32_bf16 v[124:127], a[28:31], a[76:79], v[124:127]
s_waitcnt lgkmcnt(0)
v_mfma_f32_16x16x32_bf16 v[32:35], a[32:35], a[0:3], v[32:35]
ds_read_b128 a[16:19], v11 offset:40960
v_mfma_f32_16x16x32_bf16 v[56:59], a[32:35], a[4:7], v[56:59]
ds_read_b64_tr_b16 a[56:57], v12 offset:53248
v_mfma_f32_16x16x32_bf16 v[80:83], a[32:35], a[8:11], v[80:83]
ds_read_b64_tr_b16 a[58:59], v12 offset:53760
v_mfma_f32_16x16x32_bf16 v[104:107], a[32:35], a[12:15], v[104:107]
ds_read_b128 a[20:23], v11 offset:43008
v_mfma_f32_16x16x32_bf16 v[36:39], a[36:39], a[0:3], v[36:39]
ds_read_b128 a[24:27], v11 offset:45056
v_mfma_f32_16x16x32_bf16 v[60:63], a[36:39], a[4:7], v[60:63]
ds_read_b128 a[28:31], v11 offset:47104
v_mfma_f32_16x16x32_bf16 v[84:87], a[36:39], a[8:11], v[84:87]
ds_read_b64_tr_b16 a[60:61], v13 offset:53248
v_mfma_f32_16x16x32_bf16 v[108:111], a[36:39], a[12:15], v[108:111]
ds_read_b64_tr_b16 a[62:63], v13 offset:53760
v_mfma_f32_16x16x32_bf16 v[40:43], a[0:3], a[40:43], v[40:43]
ds_read_b64_tr_b16 a[64:65], v12 offset:55296
v_mfma_f32_16x16x32_bf16 v[64:67], a[4:7], a[40:43], v[64:67]
ds_read_b64_tr_b16 a[66:67], v12 offset:55808
v_mfma_f32_16x16x32_bf16 v[88:91], a[8:11], a[40:43], v[88:91]
ds_read_b64_tr_b16 a[68:69], v13 offset:55296
v_mfma_f32_16x16x32_bf16 v[112:115], a[12:15], a[40:43], v[112:115]
ds_read_b64_tr_b16 a[70:71], v13 offset:55808
v_mfma_f32_16x16x32_bf16 v[44:47], a[0:3], a[44:47], v[44:47]
ds_read_b64_tr_b16 a[72:73], v12 offset:57344
v_mfma_f32_16x16x32_bf16 v[68:71], a[4:7], a[44:47], v[68:71]
ds_read_b64_tr_b16 a[74:75], v12 offset:57856
v_mfma_f32_16x16x32_bf16 v[92:95], a[8:11], a[44:47], v[92:95]
ds_read_b64_tr_b16 a[76:77], v13 offset:57344
v_mfma_f32_16x16x32_bf16 v[116:119], a[12:15], a[44:47], v[116:119]
ds_read_b64_tr_b16 a[78:79], v13 offset:57856
v_mfma_f32_16x16x32_bf16 v[48:51], a[0:3], a[48:51], v[48:51]
s_cmp_lg_u32 s94, 0
s_cbranch_scc1 L_nocsp
v_and_b32 v2, 16, v1
v_cmp_ne_u32 vcc, 0, v2
s_nop 1
v_cndmask_b32 v24, v128, v132, vcc
v_cndmask_b32 v25, v136, v140, vcc
v_cndmask_b32 v26, v144, v148, vcc
v_mov_b32 v27, s68
s_lshl_b32 s70, s64, 4
s_lshr_b32 s71, s65, 2
s_add_u32 s70, s70, s71
s_lshl_b32 s70, s70, 10
s_lshl_b32 s71, s67, 9
s_add_u32 s70, s70, s71
s_add_u32 s70, s70, 65536
s_mov_b64 exec, 0xffffffff
buffer_store_dwordx4 v[24:27], v16, s[12:15], s70 offen sc1
s_mov_b64 exec, -1
L_nocsp:
v_mfma_f32_16x16x32_bf16 v[72:75], a[4:7], a[48:51], v[72:75]
v_mfma_f32_16x16x32_bf16 v[96:99], a[8:11], a[48:51], v[96:99]
s_add_u32 s70, s88, 65536
buffer_store_dwordx4 v[28:31], v16, s[12:15], s70 offen sc1
v_mfma_f32_16x16x32_bf16 v[120:123], a[12:15], a[48:51], v[120:123]
v_mfma_f32_16x16x32_bf16 v[52:55], a[0:3], a[52:55], v[52:55]
s_add_u32 s70, s88, 98304
buffer_store_dwordx4 v[28:31], v16, s[12:15], s70 offen sc1
v_mfma_f32_16x16x32_bf16 v[76:79], a[4:7], a[52:55], v[76:79]
v_mfma_f32_16x16x32_bf16 v[100:103], a[8:11], a[52:55], v[100:103]
v_mfma_f32_16x16x32_bf16 v[124:127], a[12:15], a[52:55], v[124:127]
s_waitcnt lgkmcnt(0)
v_mfma_f32_16x16x32_bf16 v[32:35], a[56:59], a[16:19], v[32:35]
s_barrier
ds_read_b128 a[0:3], v10 offset:0
v_mfma_f32_16x16x32_bf16 v[56:59], a[56:59], a[20:23], v[56:59]
ds_read_b64_tr_b16 a[32:33], v12 offset:0
v_mfma_f32_16x16x32_bf16 v[80:83], a[56:59], a[24:27], v[80:83]
ds_read_b64_tr_b16 a[34:35], v12 offset:512
v_mfma_f32_16x16x32_bf16 v[104:107], a[56:59], a[28:31], v[104:107]
ds_read_b128 a[4:7], v10 offset:2048
v_mfma_f32_16x16x32_bf16 v[36:39], a[60:63], a[16:19], v[36:39]
ds_read_b128 a[8:11], v10 offset:4096
v_mfma_f32_16x16x32_bf16 v[60:63], a[60:63], a[20:23], v[60:63]
ds_read_b128 a[12:15], v10 offset:6144
v_mfma_f32_16x16x32_bf16 v[84:87], a[60:63], a[24:27], v[84:87]
ds_read_b64_tr_b16 a[36:37], v13 offset:0
v_mfma_f32_16x16x32_bf16 v[108:111], a[60:63], a[28:31], v[108:111]
ds_read_b64_tr_b16 a[38:39], v13 offset:512
v_mfma_f32_16x16x32_bf16 v[40:43], a[16:19], a[64:67], v[40:43]
ds_read_b64_tr_b16 a[40:41], v12 offset:2048
v_mfma_f32_16x16x32_bf16 v[64:67], a[20:23], a[64:67], v[64:67]
ds_read_b64_tr_b16 a[42:43], v12 offset:2560
v_mfma_f32_16x16x32_bf16 v[88:91], a[24:27], a[64:67], v[88:91]
ds_read_b64_tr_b16 a[44:45], v13 offset:2048
v_mfma_f32_16x16x32_bf16 v[112:115], a[28:31], a[64:67], v[112:115]
ds_read_b64_tr_b16 a[46:47], v13 offset:2560
v_mfma_f32_16x16x32_bf16 v[44:47], a[16:19], a[68:71], v[44:47]
ds_read_b64_tr_b16 a[48:49], v12 offset:4096
v_mfma_f32_16x16x32_bf16 v[68:71], a[20:23], a[68:71], v[68:71]
ds_read_b64_tr_b16 a[50:51], v12 offset:4608
v_mfma_f32_16x16x32_bf16 v[92:95], a[24:27], a[68:71], v[92:95]
ds_read_b64_tr_b16 a[52:53], v13 offset:4096
v_mfma_f32_16x16x32_bf16 v[116:119], a[28:31], a[68:71], v[116:119]
ds_read_b64_tr_b16 a[54:55], v13 offset:4608
v_mfma_f32_16x16x32_bf16 v[48:51], a[16:19], a[72:75], v[48:51]
v_mfma_f32_16x16x32_bf16 v[72:75], a[20:23], a[72:75], v[72:75]
v_mfma_f32_16x16x32_bf16 v[96:99], a[24:27], a[72:75], v[96:99]
v_mfma_f32_16x16x32_bf16 v[120:123], a[28:31], a[72:75], v[120:123]
v_mfma_f32_16x16x32_bf16 v[52:55], a[16:19], a[76:79], v[52:55]
v_mfma_f32_16x16x32_bf16 v[76:79], a[20:23], a[76:79], v[76:79]
v_mfma_f32_16x16x32_bf16 v[100:103], a[24:27], a[76:79], v[100:103]
v_mfma_f32_16x16x32_bf16 v[124:127], a[28:31], a[76:79], v[124:127]
s_waitcnt lgkmcnt(0)
v_mfma_f32_16x16x32_bf16 v[32:35], a[32:35], a[0:3], v[32:35]
ds_read_b128 a[16:19], v11 offset:0
v_mfma_f32_16x16x32_bf16 v[56:59], a[32:35], a[4:7], v[56:59]
ds_read_b64_tr_b16 a[56:57], v12 offset:12288
v_mfma_f32_16x16x32_bf16 v[80:83], a[32:35], a[8:11], v[80:83]
ds_read_b64_tr_b16 a[58:59], v12 offset:12800
v_mfma_f32_16x16x32_bf16 v[104:107], a[32:35], a[12:15], v[104:107]
ds_read_b128 a[20:23], v11 offset:2048
v_mfma_f32_16x16x32_bf16 v[36:39], a[36:39], a[0:3], v[36:39]
ds_read_b128 a[24:27], v11 offset:4096
v_mfma_f32_16x16x32_bf16 v[60:63], a[36:39], a[4:7], v[60:63]
ds_read_b128 a[28:31], v11 offset:6144
v_mfma_f32_16x16x32_bf16 v[84:87], a[36:39], a[8:11], v[84:87]
ds_read_b64_tr_b16 a[60:61], v13 offset:12288
v_mfma_f32_16x16x32_bf16 v[108:111], a[36:39], a[12:15], v[108:111]
ds_read_b64_tr_b16 a[62:63], v13 offset:12800
v_mfma_f32_16x16x32_bf16 v[40:43], a[0:3], a[40:43], v[40:43]
ds_read_b64_tr_b16 a[64:65], v12 offset:14336
v_mfma_f32_16x16x32_bf16 v[64:67], a[4:7], a[40:43], v[64:67]
ds_read_b64_tr_b16 a[66:67], v12 offset:14848
v_mfma_f32_16x16x32_bf16 v[88:91], a[8:11], a[40:43], v[88:91]
ds_read_b64_tr_b16 a[68:69], v13 offset:14336
v_mfma_f32_16x16x32_bf16 v[112:115], a[12:15], a[40:43], v[112:115]
ds_read_b64_tr_b16 a[70:71], v13 offset:14848
v_mfma_f32_16x16x32_bf16 v[44:47], a[0:3], a[44:47], v[44:47]
ds_read_b64_tr_b16 a[72:73], v12 offset:16384
v_mfma_f32_16x16x32_bf16 v[68:71], a[4:7], a[44:47], v[68:71]
ds_read_b64_tr_b16 a[74:75], v12 offset:16896
v_mfma_f32_16x16x32_bf16 v[92:95], a[8:11], a[44:47], v[92:95]
ds_read_b64_tr_b16 a[76:77], v13 offset:16384
v_mfma_f32_16x16x32_bf16 v[116:119], a[12:15], a[44:47], v[116:119]
ds_read_b64_tr_b16 a[78:79], v13 offset:16896
v_mfma_f32_16x16x32_bf16 v[48:51], a[0:3], a[48:51], v[48:51]
v_mfma_f32_16x16x32_bf16 v[72:75], a[4:7], a[48:51], v[72:75]
v_mfma_f32_16x16x32_bf16 v[96:99], a[8:11], a[48:51], v[96:99]
v_mfma_f32_16x16x32_bf16 v[120:123], a[12:15], a[48:51], v[120:123]
v_mfma_f32_16x16x32_bf16 v[52:55], a[0:3], a[52:55], v[52:55]
v_mfma_f32_16x16x32_bf16 v[76:79], a[4:7], a[52:55], v[76:79]
v_mfma_f32_16x16x32_bf16 v[100:103], a[8:11], a[52:55], v[100:103]
v_mfma_f32_16x16x32_bf16 v[124:127], a[12:15], a[52:55], v[124:127]
s_waitcnt lgkmcnt(0)
v_mfma_f32_16x16x32_bf16 v[32:35], a[56:59], a[16:19], v[32:35]
s_barrier
ds_read_b128 a[0:3], v8 offset:24576
v_mfma_f32_16x16x32_bf16 v[56:59], a[56:59], a[20:23], v[56:59]
ds_read_b64_tr_b16 a[32:33], v14 offset:16384
v_mfma_f32_16x16x32_bf16 v[80:83], a[56:59], a[24:27], v[80:83]
ds_read_b64_tr_b16 a[34:35], v14 offset:16896
v_mfma_f32_16x16x32_bf16 v[104:107], a[56:59], a[28:31], v[104:107]
ds_read_b128 a[4:7], v8 offset:26624
v_mfma_f32_16x16x32_bf16 v[36:39], a[60:63], a[16:19], v[36:39]
ds_read_b128 a[8:11], v8 offset:28672
v_mfma_f32_16x16x32_bf16 v[60:63], a[60:63], a[20:23], v[60:63]
ds_read_b128 a[12:15], v8 offset:30720
v_mfma_f32_16x16x32_bf16 v[84:87], a[60:63], a[24:27], v[84:87]
ds_read_b64_tr_b16 a[36:37], v15 offset:16384
v_mfma_f32_16x16x32_bf16 v[108:111], a[60:63], a[28:31], v[108:111]
ds_read_b64_tr_b16 a[38:39], v15 offset:16896
v_mfma_f32_16x16x32_bf16 v[40:43], a[16:19], a[64:67], v[40:43]
ds_read_b64_tr_b16 a[40:41], v14 offset:18432
v_mfma_f32_16x16x32_bf16 v[64:67], a[20:23], a[64:67], v[64:67]
ds_read_b64_tr_b16 a[42:43], v14 offset:18944
v_mfma_f32_16x16x32_bf16 v[88:91], a[24:27], a[64:67], v[88:91]
ds_read_b64_tr_b16 a[44:45], v15 offset:18432
v_mfma_f32_16x16x32_bf16 v[112:115], a[28:31], a[64:67], v[112:115]
ds_read_b64_tr_b16 a[46:47], v15 offset:18944
v_mfma_f32_16x16x32_bf16 v[44:47], a[16:19], a[68:71], v[44:47]
ds_read_b64_tr_b16 a[48:49], v14 offset:20480
v_mfma_f32_16x16x32_bf16 v[68:71], a[20:23], a[68:71], v[68:71]
ds_read_b64_tr_b16 a[50:51], v14 offset:20992
v_mfma_f32_16x16x32_bf16 v[92:95], a[24:27], a[68:71], v[92:95]
ds_read_b64_tr_b16 a[52:53], v15 offset:20480
v_mfma_f32_16x16x32_bf16 v[116:119], a[28:31], a[68:71], v[116:119]
ds_read_b64_tr_b16 a[54:55], v15 offset:20992
v_mfma_f32_16x16x32_bf16 v[48:51], a[16:19], a[72:75], v[48:51]
v_mfma_f32_16x16x32_bf16 v[72:75], a[20:23], a[72:75], v[72:75]
v_mfma_f32_16x16x32_bf16 v[96:99], a[24:27], a[72:75], v[96:99]
v_mfma_f32_16x16x32_bf16 v[120:123], a[28:31], a[72:75], v[120:123]
v_mfma_f32_16x16x32_bf16 v[52:55], a[16:19], a[76:79], v[52:55]
v_mfma_f32_16x16x32_bf16 v[76:79], a[20:23], a[76:79], v[76:79]
v_mfma_f32_16x16x32_bf16 v[100:103], a[24:27], a[76:79], v[100:103]
v_mfma_f32_16x16x32_bf16 v[124:127], a[28:31], a[76:79], v[124:127]
s_waitcnt lgkmcnt(0)
v_mfma_f32_16x16x32_bf16 v[32:35], a[32:35], a[0:3], v[32:35]
ds_read_b128 a[16:19], v9 offset:24576
v_mfma_f32_16x16x32_bf16 v[56:59], a[32:35], a[4:7], v[56:59]
ds_read_b64_tr_b16 a[56:57], v14 offset:28672
v_mfma_f32_16x16x32_bf16 v[80:83], a[32:35], a[8:11], v[80:83]
ds_read_b64_tr_b16 a[58:59], v14 offset:29184
v_mfma_f32_16x16x32_bf16 v[104:107], a[32:35], a[12:15], v[104:107]
ds_read_b128 a[20:23], v9 offset:26624
v_mfma_f32_16x16x32_bf16 v[36:39], a[36:39], a[0:3], v[36:39]
ds_read_b128 a[24:27], v9 offset:28672
v_mfma_f32_16x16x32_bf16 v[60:63], a[36:39], a[4:7], v[60:63]
ds_read_b128 a[28:31], v9 offset:30720
v_mfma_f32_16x16x32_bf16 v[84:87], a[36:39], a[8:11], v[84:87]
ds_read_b64_tr_b16 a[60:61], v15 offset:28672
v_mfma_f32_16x16x32_bf16 v[108:111], a[36:39], a[12:15], v[108:111]
ds_read_b64_tr_b16 a[62:63], v15 offset:29184
v_mfma_f32_16x16x32_bf16 v[40:43], a[0:3], a[40:43], v[40:43]
ds_read_b64_tr_b16 a[64:65], v14 offset:30720
v_mfma_f32_16x16x32_bf16 v[64:67], a[4:7], a[40:43], v[64:67]
ds_read_b64_tr_b16 a[66:67], v14 offset:31232
v_mfma_f32_16x16x32_bf16 v[88:91], a[8:11], a[40:43], v[88:91]
ds_read_b64_tr_b16 a[68:69], v15 offset:30720
v_mfma_f32_16x16x32_bf16 v[112:115], a[12:15], a[40:43], v[112:115]
ds_read_b64_tr_b16 a[70:71], v15 offset:31232
v_mfma_f32_16x16x32_bf16 v[44:47], a[0:3], a[44:47], v[44:47]
ds_read_b64_tr_b16 a[72:73], v14 offset:32768
v_mfma_f32_16x16x32_bf16 v[68:71], a[4:7], a[44:47], v[68:71]
ds_read_b64_tr_b16 a[74:75], v14 offset:33280
v_mfma_f32_16x16x32_bf16 v[92:95], a[8:11], a[44:47], v[92:95]
ds_read_b64_tr_b16 a[76:77], v15 offset:32768
v_mfma_f32_16x16x32_bf16 v[116:119], a[12:15], a[44:47], v[116:119]
ds_read_b64_tr_b16 a[78:79], v15 offset:33280
v_mfma_f32_16x16x32_bf16 v[48:51], a[0:3], a[48:51], v[48:51]
s_waitcnt vmcnt(0)
v_mfma_f32_16x16x32_bf16 v[72:75], a[4:7], a[48:51], v[72:75]
v_mfma_f32_16x16x32_bf16 v[96:99], a[8:11], a[48:51], v[96:99]
v_mfma_f32_16x16x32_bf16 v[120:123], a[12:15], a[48:51], v[120:123]
v_mfma_f32_16x16x32_bf16 v[52:55], a[0:3], a[52:55], v[52:55]
v_mfma_f32_16x16x32_bf16 v[76:79], a[4:7], a[52:55], v[76:79]
v_mfma_f32_16x16x32_bf16 v[100:103], a[8:11], a[52:55], v[100:103]
v_mfma_f32_16x16x32_bf16 v[124:127], a[12:15], a[52:55], v[124:127]
s_waitcnt lgkmcnt(0)
v_mfma_f32_16x16x32_bf16 v[32:35], a[56:59], a[16:19], v[32:35]
s_barrier
ds_read_b128 a[0:3], v10 offset:57344
v_mfma_f32_16x16x32_bf16 v[56:59], a[56:59], a[20:23], v[56:59]
ds_read_b64_tr_b16 a[32:33], v12 offset:40960
v_mfma_f32_16x16x32_bf16 v[80:83], a[56:59], a[24:27], v[80:83]
ds_read_b64_tr_b16 a[34:35], v12 offset:41472
v_mfma_f32_16x16x32_bf16 v[104:107], a[56:59], a[28:31], v[104:107]
ds_read_b128 a[4:7], v10 offset:59392
v_mfma_f32_16x16x32_bf16 v[36:39], a[60:63], a[16:19], v[36:39]
ds_read_b128 a[8:11], v10 offset:61440
v_mfma_f32_16x16x32_bf16 v[60:63], a[60:63], a[20:23], v[60:63]
ds_read_b128 a[12:15], v10 offset:63488
v_mfma_f32_16x16x32_bf16 v[84:87], a[60:63], a[24:27], v[84:87]
ds_read_b64_tr_b16 a[36:37], v13 offset:40960
v_mfma_f32_16x16x32_bf16 v[108:111], a[60:63], a[28:31], v[108:111]
ds_read_b64_tr_b16 a[38:39], v13 offset:41472
v_mfma_f32_16x16x32_bf16 v[40:43], a[16:19], a[64:67], v[40:43]
ds_read_b64_tr_b16 a[40:41], v12 offset:43008
v_mfma_f32_16x16x32_bf16 v[64:67], a[20:23], a[64:67], v[64:67]
ds_read_b64_tr_b16 a[42:43], v12 offset:43520
v_mfma_f32_16x16x32_bf16 v[88:91], a[24:27], a[64:67], v[88:91]
ds_read_b64_tr_b16 a[44:45], v13 offset:43008
v_mfma_f32_16x16x32_bf16 v[112:115], a[28:31], a[64:67], v[112:115]
ds_read_b64_tr_b16 a[46:47], v13 offset:43520
v_mfma_f32_16x16x32_bf16 v[44:47], a[16:19], a[68:71], v[44:47]
ds_read_b64_tr_b16 a[48:49], v12 offset:45056
v_mfma_f32_16x16x32_bf16 v[68:71], a[20:23], a[68:71], v[68:71]
ds_read_b64_tr_b16 a[50:51], v12 offset:45568
v_mfma_f32_16x16x32_bf16 v[92:95], a[24:27], a[68:71], v[92:95]
ds_read_b64_tr_b16 a[52:53], v13 offset:45056
v_mfma_f32_16x16x32_bf16 v[116:119], a[28:31], a[68:71], v[116:119]
ds_read_b64_tr_b16 a[54:55], v13 offset:45568
v_mfma_f32_16x16x32_bf16 v[48:51], a[16:19], a[72:75], v[48:51]
v_mfma_f32_16x16x32_bf16 v[72:75], a[20:23], a[72:75], v[72:75]
v_mfma_f32_16x16x32_bf16 v[96:99], a[24:27], a[72:75], v[96:99]
v_mfma_f32_16x16x32_bf16 v[120:123], a[28:31], a[72:75], v[120:123]
v_mfma_f32_16x16x32_bf16 v[52:55], a[16:19], a[76:79], v[52:55]
v_mfma_f32_16x16x32_bf16 v[76:79], a[20:23], a[76:79], v[76:79]
v_mfma_f32_16x16x32_bf16 v[100:103], a[24:27], a[76:79], v[100:103]
v_mfma_f32_16x16x32_bf16 v[124:127], a[28:31], a[76:79], v[124:127]
s_waitcnt lgkmcnt(0)
v_mfma_f32_16x16x32_bf16 v[32:35], a[32:35], a[0:3], v[32:35]
ds_read_b128 a[16:19], v11 offset:57344
v_mfma_f32_16x16x32_bf16 v[56:59], a[32:35], a[4:7], v[56:59]
ds_read_b64_tr_b16 a[56:57], v12 offset:53248
v_mfma_f32_16x16x32_bf16 v[80:83], a[32:35], a[8:11], v[80:83]
ds_read_b64_tr_b16 a[58:59], v12 offset:53760
v_mfma_f32_16x16x32_bf16 v[104:107], a[32:35], a[12:15], v[104:107]
ds_read_b128 a[20:23], v11 offset:59392
v_mfma_f32_16x16x32_bf16 v[36:39], a[36:39], a[0:3], v[36:39]
ds_read_b128 a[24:27], v11 offset:61440
v_mfma_f32_16x16x32_bf16 v[60:63], a[36:39], a[4:7], v[60:63]
ds_read_b128 a[28:31], v11 offset:63488
v_mfma_f32_16x16x32_bf16 v[84:87], a[36:39], a[8:11], v[84:87]
ds_read_b64_tr_b16 a[60:61], v13 offset:53248
v_mfma_f32_16x16x32_bf16 v[108:111], a[36:39], a[12:15], v[108:111]
ds_read_b64_tr_b16 a[62:63], v13 offset:53760
v_mfma_f32_16x16x32_bf16 v[40:43], a[0:3], a[40:43], v[40:43]
ds_read_b64_tr_b16 a[64:65], v12 offset:55296
v_mfma_f32_16x16x32_bf16 v[64:67], a[4:7], a[40:43], v[64:67]
ds_read_b64_tr_b16 a[66:67], v12 offset:55808
v_mfma_f32_16x16x32_bf16 v[88:91], a[8:11], a[40:43], v[88:91]
ds_read_b64_tr_b16 a[68:69], v13 offset:55296
v_mfma_f32_16x16x32_bf16 v[112:115], a[12:15], a[40:43], v[112:115]
ds_read_b64_tr_b16 a[70:71], v13 offset:55808
v_mfma_f32_16x16x32_bf16 v[44:47], a[0:3], a[44:47], v[44:47]
ds_read_b64_tr_b16 a[72:73], v12 offset:57344
v_mfma_f32_16x16x32_bf16 v[68:71], a[4:7], a[44:47], v[68:71]
ds_read_b64_tr_b16 a[74:75], v12 offset:57856
v_mfma_f32_16x16x32_bf16 v[92:95], a[8:11], a[44:47], v[92:95]
ds_read_b64_tr_b16 a[76:77], v13 offset:57344
v_mfma_f32_16x16x32_bf16 v[116:119], a[12:15], a[44:47], v[116:119]
ds_read_b64_tr_b16 a[78:79], v13 offset:57856
v_mfma_f32_16x16x32_bf16 v[48:51], a[0:3], a[48:51], v[48:51]
v_mfma_f32_16x16x32_bf16 v[72:75], a[4:7], a[48:51], v[72:75]
v_mfma_f32_16x16x32_bf16 v[96:99], a[8:11], a[48:51], v[96:99]
v_mfma_f32_16x16x32_bf16 v[120:123], a[12:15], a[48:51], v[120:123]
v_mfma_f32_16x16x32_bf16 v[52:55], a[0:3], a[52:55], v[52:55]
v_mfma_f32_16x16x32_bf16 v[76:79], a[4:7], a[52:55], v[76:79]
v_mfma_f32_16x16x32_bf16 v[100:103], a[8:11], a[52:55], v[100:103]
v_mfma_f32_16x16x32_bf16 v[124:127], a[12:15], a[52:55], v[124:127]
s_waitcnt lgkmcnt(0)
v_mfma_f32_16x16x32_bf16 v[32:35], a[56:59], a[16:19], v[32:35]
s_barrier
ds_read_b128 a[0:3], v10 offset:40960
v_mfma_f32_16x16x32_bf16 v[56:59], a[56:59], a[20:23], v[56:59]
ds_read_b64_tr_b16 a[32:33], v12 offset:0
v_mfma_f32_16x16x32_bf16 v[80:83], a[56:59], a[24:27], v[80:83]
ds_read_b64_tr_b16 a[34:35], v12 offset:512
v_mfma_f32_16x16x32_bf16 v[104:107], a[56:59], a[28:31], v[104:107]
ds_read_b128 a[4:7], v10 offset:43008
v_mfma_f32_16x16x32_bf16 v[36:39], a[60:63], a[16:19], v[36:39]
ds_read_b128 a[8:11], v10 offset:45056
v_mfma_f32_16x16x32_bf16 v[60:63], a[60:63], a[20:23], v[60:63]
ds_read_b128 a[12:15], v10 offset:47104
v_mfma_f32_16x16x32_bf16 v[84:87], a[60:63], a[24:27], v[84:87]
ds_read_b64_tr_b16 a[36:37], v13 offset:0
v_mfma_f32_16x16x32_bf16 v[108:111], a[60:63], a[28:31], v[108:111]
ds_read_b64_tr_b16 a[38:39], v13 offset:512
v_mfma_f32_16x16x32_bf16 v[40:43], a[16:19], a[64:67], v[40:43]
ds_read_b64_tr_b16 a[40:41], v12 offset:2048
v_mfma_f32_16x16x32_bf16 v[64:67], a[20:23], a[64:67], v[64:67]
ds_read_b64_tr_b16 a[42:43], v12 offset:2560
v_mfma_f32_16x16x32_bf16 v[88:91], a[24:27], a[64:67], v[88:91]
ds_read_b64_tr_b16 a[44:45], v13 offset:2048
v_mfma_f32_16x16x32_bf16 v[112:115], a[28:31], a[64:67], v[112:115]
ds_read_b64_tr_b16 a[46:47], v13 offset:2560
v_mfma_f32_16x16x32_bf16 v[44:47], a[16:19], a[68:71], v[44:47]
ds_read_b64_tr_b16 a[48:49], v12 offset:4096
v_mfma_f32_16x16x32_bf16 v[68:71], a[20:23], a[68:71], v[68:71]
ds_read_b64_tr_b16 a[50:51], v12 offset:4608
v_mfma_f32_16x16x32_bf16 v[92:95], a[24:27], a[68:71], v[92:95]
ds_read_b64_tr_b16 a[52:53], v13 offset:4096
v_mfma_f32_16x16x32_bf16 v[116:119], a[28:31], a[68:71], v[116:119]
ds_read_b64_tr_b16 a[54:55], v13 offset:4608
v_mfma_f32_16x16x32_bf16 v[48:51], a[16:19], a[72:75], v[48:51]
v_mfma_f32_16x16x32_bf16 v[72:75], a[20:23], a[72:75], v[72:75]
v_mfma_f32_16x16x32_bf16 v[96:99], a[24:27], a[72:75], v[96:99]
v_mfma_f32_16x16x32_bf16 v[120:123], a[28:31], a[72:75], v[120:123]
v_mfma_f32_16x16x32_bf16 v[52:55], a[16:19], a[76:79], v[52:55]
v_mfma_f32_16x16x32_bf16 v[76:79], a[20:23], a[76:79], v[76:79]
v_mfma_f32_16x16x32_bf16 v[100:103], a[24:27], a[76:79], v[100:103]
v_mfma_f32_16x16x32_bf16 v[124:127], a[28:31], a[76:79], v[124:127]
s_waitcnt lgkmcnt(0)
v_mfma_f32_16x16x32_bf16 v[32:35], a[32:35], a[0:3], v[32:35]
ds_read_b128 a[16:19], v11 offset:40960
v_mfma_f32_16x16x32_bf16 v[56:59], a[32:35], a[4:7], v[56:59]
ds_read_b64_tr_b16 a[56:57], v12 offset:12288
v_mfma_f32_16x16x32_bf16 v[80:83], a[32:35], a[8:11], v[80:83]
ds_read_b64_tr_b16 a[58:59], v12 offset:12800
v_mfma_f32_16x16x32_bf16 v[104:107], a[32:35], a[12:15], v[104:107]
ds_read_b128 a[20:23], v11 offset:43008
v_mfma_f32_16x16x32_bf16 v[36:39], a[36:39], a[0:3], v[36:39]
ds_read_b128 a[24:27], v11 offset:45056
v_mfma_f32_16x16x32_bf16 v[60:63], a[36:39], a[4:7], v[60:63]
ds_read_b128 a[28:31], v11 offset:47104
v_mfma_f32_16x16x32_bf16 v[84:87], a[36:39], a[8:11], v[84:87]
ds_read_b64_tr_b16 a[60:61], v13 offset:12288
v_mfma_f32_16x16x32_bf16 v[108:111], a[36:39], a[12:15], v[108:111]
ds_read_b64_tr_b16 a[62:63], v13 offset:12800
v_mfma_f32_16x16x32_bf16 v[40:43], a[0:3], a[40:43], v[40:43]
ds_read_b64_tr_b16 a[64:65], v12 offset:14336
v_mfma_f32_16x16x32_bf16 v[64:67], a[4:7], a[40:43], v[64:67]
ds_read_b64_tr_b16 a[66:67], v12 offset:14848
v_mfma_f32_16x16x32_bf16 v[88:91], a[8:11], a[40:43], v[88:91]
ds_read_b64_tr_b16 a[68:69], v13 offset:14336
v_mfma_f32_16x16x32_bf16 v[112:115], a[12:15], a[40:43], v[112:115]
ds_read_b64_tr_b16 a[70:71], v13 offset:14848
v_mfma_f32_16x16x32_bf16 v[44:47], a[0:3], a[44:47], v[44:47]
ds_read_b64_tr_b16 a[72:73], v12 offset:16384
v_mfma_f32_16x16x32_bf16 v[68:71], a[4:7], a[44:47], v[68:71]
ds_read_b64_tr_b16 a[74:75], v12 offset:16896
v_mfma_f32_16x16x32_bf16 v[92:95], a[8:11], a[44:47], v[92:95]
ds_read_b64_tr_b16 a[76:77], v13 offset:16384
v_mfma_f32_16x16x32_bf16 v[116:119], a[12:15], a[44:47], v[116:119]
ds_read_b64_tr_b16 a[78:79], v13 offset:16896
v_mfma_f32_16x16x32_bf16 v[48:51], a[0:3], a[48:51], v[48:51]
v_mfma_f32_16x16x32_bf16 v[72:75], a[4:7], a[48:51], v[72:75]
v_mfma_f32_16x16x32_bf16 v[96:99], a[8:11], a[48:51], v[96:99]
v_mfma_f32_16x16x32_bf16 v[120:123], a[12:15], a[48:51], v[120:123]
v_mfma_f32_16x16x32_bf16 v[52:55], a[0:3], a[52:55], v[52:55]
v_mfma_f32_16x16x32_bf16 v[76:79], a[4:7], a[52:55], v[76:79]
v_mfma_f32_16x16x32_bf16 v[100:103], a[8:11], a[52:55], v[100:103]
v_mfma_f32_16x16x32_bf16 v[124:127], a[12:15], a[52:55], v[124:127]
s_waitcnt lgkmcnt(0)
v_mfma_f32_16x16x32_bf16 v[32:35], a[56:59], a[16:19], v[32:35]
s_barrier
ds_read_b128 a[0:3], v10 offset:0
v_mfma_f32_16x16x32_bf16 v[56:59], a[56:59], a[20:23], v[56:59]
ds_read_b64_tr_b16 a[32:33], v14 offset:16384
v_mfma_f32_16x16x32_bf16 v[80:83], a[56:59], a[24:27], v[80:83]
ds_read_b64_tr_b16 a[34:35], v14 offset:16896
v_mfma_f32_16x16x32_bf16 v[104:107], a[56:59], a[28:31], v[104:107]
ds_read_b128 a[4:7], v10 offset:2048
v_mfma_f32_16x16x32_bf16 v[36:39], a[60:63], a[16:19], v[36:39]
ds_read_b128 a[8:11], v10 offset:4096
v_mfma_f32_16x16x32_bf16 v[60:63], a[60:63], a[20:23], v[60:63]
ds_read_b128 a[12:15], v10 offset:6144
v_mfma_f32_16x16x32_bf16 v[84:87], a[60:63], a[24:27], v[84:87]
ds_read_b64_tr_b16 a[36:37], v15 offset:16384
v_mfma_f32_16x16x32_bf16 v[108:111], a[60:63], a[28:31], v[108:111]
ds_read_b64_tr_b16 a[38:39], v15 offset:16896
v_mfma_f32_16x16x32_bf16 v[40:43], a[16:19], a[64:67], v[40:43]
ds_read_b64_tr_b16 a[40:41], v14 offset:18432
v_mfma_f32_16x16x32_bf16 v[64:67], a[20:23], a[64:67], v[64:67]
ds_read_b64_tr_b16 a[42:43], v14 offset:18944
v_mfma_f32_16x16x32_bf16 v[88:91], a[24:27], a[64:67], v[88:91]
ds_read_b64_tr_b16 a[44:45], v15 offset:18432
v_mfma_f32_16x16x32_bf16 v[112:115], a[28:31], a[64:67], v[112:115]
ds_read_b64_tr_b16 a[46:47], v15 offset:18944
v_mfma_f32_16x16x32_bf16 v[44:47], a[16:19], a[68:71], v[44:47]
ds_read_b64_tr_b16 a[48:49], v14 offset:20480
v_mfma_f32_16x16x32_bf16 v[68:71], a[20:23], a[68:71], v[68:71]
ds_read_b64_tr_b16 a[50:51], v14 offset:20992
v_mfma_f32_16x16x32_bf16 v[92:95], a[24:27], a[68:71], v[92:95]
ds_read_b64_tr_b16 a[52:53], v15 offset:20480
v_mfma_f32_16x16x32_bf16 v[116:119], a[28:31], a[68:71], v[116:119]
ds_read_b64_tr_b16 a[54:55], v15 offset:20992
v_mfma_f32_16x16x32_bf16 v[48:51], a[16:19], a[72:75], v[48:51]
v_mfma_f32_16x16x32_bf16 v[72:75], a[20:23], a[72:75], v[72:75]
v_mfma_f32_16x16x32_bf16 v[96:99], a[24:27], a[72:75], v[96:99]
v_mfma_f32_16x16x32_bf16 v[120:123], a[28:31], a[72:75], v[120:123]
v_mfma_f32_16x16x32_bf16 v[52:55], a[16:19], a[76:79], v[52:55]
v_mfma_f32_16x16x32_bf16 v[76:79], a[20:23], a[76:79], v[76:79]
v_mfma_f32_16x16x32_bf16 v[100:103], a[24:27], a[76:79], v[100:103]
v_mfma_f32_16x16x32_bf16 v[124:127], a[28:31], a[76:79], v[124:127]
s_waitcnt lgkmcnt(0)
v_mfma_f32_16x16x32_bf16 v[32:35], a[32:35], a[0:3], v[32:35]
ds_read_b128 a[16:19], v11 offset:0
v_mfma_f32_16x16x32_bf16 v[56:59], a[32:35], a[4:7], v[56:59]
ds_read_b64_tr_b16 a[56:57], v14 offset:28672
v_mfma_f32_16x16x32_bf16 v[80:83], a[32:35], a[8:11], v[80:83]
ds_read_b64_tr_b16 a[58:59], v14 offset:29184
v_mfma_f32_16x16x32_bf16 v[104:107], a[32:35], a[12:15], v[104:107]
ds_read_b128 a[20:23], v11 offset:2048
v_mfma_f32_16x16x32_bf16 v[36:39], a[36:39], a[0:3], v[36:39]
ds_read_b128 a[24:27], v11 offset:4096
v_mfma_f32_16x16x32_bf16 v[60:63], a[36:39], a[4:7], v[60:63]
ds_read_b128 a[28:31], v11 offset:6144
v_mfma_f32_16x16x32_bf16 v[84:87], a[36:39], a[8:11], v[84:87]
ds_read_b64_tr_b16 a[60:61], v15 offset:28672
v_mfma_f32_16x16x32_bf16 v[108:111], a[36:39], a[12:15], v[108:111]
ds_read_b64_tr_b16 a[62:63], v15 offset:29184
v_mfma_f32_16x16x32_bf16 v[40:43], a[0:3], a[40:43], v[40:43]
ds_read_b64_tr_b16 a[64:65], v14 offset:30720
v_mfma_f32_16x16x32_bf16 v[64:67], a[4:7], a[40:43], v[64:67]
ds_read_b64_tr_b16 a[66:67], v14 offset:31232
v_mfma_f32_16x16x32_bf16 v[88:91], a[8:11], a[40:43], v[88:91]
ds_read_b64_tr_b16 a[68:69], v15 offset:30720
v_mfma_f32_16x16x32_bf16 v[112:115], a[12:15], a[40:43], v[112:115]
ds_read_b64_tr_b16 a[70:71], v15 offset:31232
v_mfma_f32_16x16x32_bf16 v[44:47], a[0:3], a[44:47], v[44:47]
ds_read_b64_tr_b16 a[72:73], v14 offset:32768
v_mfma_f32_16x16x32_bf16 v[68:71], a[4:7], a[44:47], v[68:71]
ds_read_b64_tr_b16 a[74:75], v14 offset:33280
v_mfma_f32_16x16x32_bf16 v[92:95], a[8:11], a[44:47], v[92:95]
ds_read_b64_tr_b16 a[76:77], v15 offset:32768
v_mfma_f32_16x16x32_bf16 v[116:119], a[12:15], a[44:47], v[116:119]
ds_read_b64_tr_b16 a[78:79], v15 offset:33280
v_mfma_f32_16x16x32_bf16 v[48:51], a[0:3], a[48:51], v[48:51]
v_mfma_f32_16x16x32_bf16 v[72:75], a[4:7], a[48:51], v[72:75]
v_mfma_f32_16x16x32_bf16 v[96:99], a[8:11], a[48:51], v[96:99]
v_mfma_f32_16x16x32_bf16 v[120:123], a[12:15], a[48:51], v[120:123]
v_mfma_f32_16x16x32_bf16 v[52:55], a[0:3], a[52:55], v[52:55]
v_mfma_f32_16x16x32_bf16 v[76:79], a[4:7], a[52:55], v[76:79]
v_mfma_f32_16x16x32_bf16 v[100:103], a[8:11], a[52:55], v[100:103]
v_mfma_f32_16x16x32_bf16 v[124:127], a[12:15], a[52:55], v[124:127]
s_waitcnt lgkmcnt(0)
v_mfma_f32_16x16x32_bf16 v[32:35], a[56:59], a[16:19], v[32:35]
s_barrier
ds_read_b128 a[0:3], v8 offset:24576
v_mfma_f32_16x16x32_bf16 v[56:59], a[56:59], a[20:23], v[56:59]
ds_read_b64_tr_b16 a[32:33], v12 offset:40960
v_mfma_f32_16x16x32_bf16 v[80:83], a[56:59], a[24:27], v[80:83]
ds_read_b64_tr_b16 a[34:35], v12 offset:41472
v_mfma_f32_16x16x32_bf16 v[104:107], a[56:59], a[28:31], v[104:107]
ds_read_b128 a[4:7], v8 offset:26624
v_mfma_f32_16x16x32_bf16 v[36:39], a[60:63], a[16:19], v[36:39]
ds_read_b128 a[8:11], v8 offset:28672
v_mfma_f32_16x16x32_bf16 v[60:63], a[60:63], a[20:23], v[60:63]
ds_read_b128 a[12:15], v8 offset:30720
v_mfma_f32_16x16x32_bf16 v[84:87], a[60:63], a[24:27], v[84:87]
s_branch L_over4
L_pad4:
s_branch L_ret4
L_over4:
ds_read_b64_tr_b16 a[36:37], v13 offset:40960
v_mfma_f32_16x16x32_bf16 v[108:111], a[60:63], a[28:31], v[108:111]
ds_read_b64_tr_b16 a[38:39], v13 offset:41472
v_mfma_f32_16x16x32_bf16 v[40:43], a[16:19], a[64:67], v[40:43]
ds_read_b64_tr_b16 a[40:41], v12 offset:43008
v_mfma_f32_16x16x32_bf16 v[64:67], a[20:23], a[64:67], v[64:67]
ds_read_b64_tr_b16 a[42:43], v12 offset:43520
v_mfma_f32_16x16x32_bf16 v[88:91], a[24:27], a[64:67], v[88:91]
ds_read_b64_tr_b16 a[44:45], v13 offset:43008
v_mfma_f32_16x16x32_bf16 v[112:115], a[28:31], a[64:67], v[112:115]
ds_read_b64_tr_b16 a[46:47], v13 offset:43520
v_mfma_f32_16x16x32_bf16 v[44:47], a[16:19], a[68:71], v[44:47]
ds_read_b64_tr_b16 a[48:49], v12 offset:45056
v_mfma_f32_16x16x32_bf16 v[68:71], a[20:23], a[68:71], v[68:71]
ds_read_b64_tr_b16 a[50:51], v12 offset:45568
v_mfma_f32_16x16x32_bf16 v[92:95], a[24:27], a[68:71], v[92:95]
ds_read_b64_tr_b16 a[52:53], v13 offset:45056
v_mfma_f32_16x16x32_bf16 v[116:119], a[28:31], a[68:71], v[116:119]
ds_read_b64_tr_b16 a[54:55], v13 offset:45568
v_mfma_f32_16x16x32_bf16 v[48:51], a[16:19], a[72:75], v[48:51]
v_mfma_f32_16x16x32_bf16 v[72:75], a[20:23], a[72:75], v[72:75]
v_mfma_f32_16x16x32_bf16 v[96:99], a[24:27], a[72:75], v[96:99]
v_mfma_f32_16x16x32_bf16 v[120:123], a[28:31], a[72:75], v[120:123]
v_mfma_f32_16x16x32_bf16 v[52:55], a[16:19], a[76:79], v[52:55]
v_mfma_f32_16x16x32_bf16 v[76:79], a[20:23], a[76:79], v[76:79]
v_mfma_f32_16x16x32_bf16 v[100:103], a[24:27], a[76:79], v[100:103]
v_mfma_f32_16x16x32_bf16 v[124:127], a[28:31], a[76:79], v[124:127]
s_waitcnt lgkmcnt(0)
v_mfma_f32_16x16x32_bf16 v[32:35], a[32:35], a[0:3], v[32:35]
ds_read_b128 a[16:19], v9 offset:24576
v_mfma_f32_16x16x32_bf16 v[56:59], a[32:35], a[4:7], v[56:59]
ds_read_b64_tr_b16 a[56:57], v12 offset:53248
v_mfma_f32_16x16x32_bf16 v[80:83], a[32:35], a[8:11], v[80:83]
ds_read_b64_tr_b16 a[58:59], v12 offset:53760
v_mfma_f32_16x16x32_bf16 v[104:107], a[32:35], a[12:15], v[104:107]
ds_read_b128 a[20:23], v9 offset:26624
v_mfma_f32_16x16x32_bf16 v[36:39], a[36:39], a[0:3], v[36:39]
ds_read_b128 a[24:27], v9 offset:28672
v_mfma_f32_16x16x32_bf16 v[60:63], a[36:39], a[4:7], v[60:63]
ds_read_b128 a[28:31], v9 offset:30720
v_mfma_f32_16x16x32_bf16 v[84:87], a[36:39], a[8:11], v[84:87]
ds_read_b64_tr_b16 a[60:61], v13 offset:53248
v_mfma_f32_16x16x32_bf16 v[108:111], a[36:39], a[12:15], v[108:111]
ds_read_b64_tr_b16 a[62:63], v13 offset:53760
v_mfma_f32_16x16x32_bf16 v[40:43], a[0:3], a[40:43], v[40:43]
ds_read_b64_tr_b16 a[64:65], v12 offset:55296
v_mfma_f32_16x16x32_bf16 v[64:67], a[4:7], a[40:43], v[64:67]
ds_read_b64_tr_b16 a[66:67], v12 offset:55808
v_mfma_f32_16x16x32_bf16 v[88:91], a[8:11], a[40:43], v[88:91]
ds_read_b64_tr_b16 a[68:69], v13 offset:55296
v_mfma_f32_16x16x32_bf16 v[112:115], a[12:15], a[40:43], v[112:115]
ds_read_b64_tr_b16 a[70:71], v13 offset:55808
v_mfma_f32_16x16x32_bf16 v[44:47], a[0:3], a[44:47], v[44:47]
ds_read_b64_tr_b16 a[72:73], v12 offset:57344
v_mfma_f32_16x16x32_bf16 v[68:71], a[4:7], a[44:47], v[68:71]
ds_read_b64_tr_b16 a[74:75], v12 offset:57856
v_mfma_f32_16x16x32_bf16 v[92:95], a[8:11], a[44:47], v[92:95]
ds_read_b64_tr_b16 a[76:77], v13 offset:57344
v_mfma_f32_16x16x32_bf16 v[116:119], a[12:15], a[44:47], v[116:119]
ds_read_b64_tr_b16 a[78:79], v13 offset:57856
v_mfma_f32_16x16x32_bf16 v[48:51], a[0:3], a[48:51], v[48:51]
v_mfma_f32_16x16x32_bf16 v[72:75], a[4:7], a[48:51], v[72:75]
v_mfma_f32_16x16x32_bf16 v[96:99], a[8:11], a[48:51], v[96:99]
v_mfma_f32_16x16x32_bf16 v[120:123], a[12:15], a[48:51], v[120:123]
v_mfma_f32_16x16x32_bf16 v[52:55], a[0:3], a[52:55], v[52:55]
v_mfma_f32_16x16x32_bf16 v[76:79], a[4:7], a[52:55], v[76:79]
v_mfma_f32_16x16x32_bf16 v[100:103], a[8:11], a[52:55], v[100:103]
v_mfma_f32_16x16x32_bf16 v[124:127], a[12:15], a[52:55], v[124:127]
s_waitcnt lgkmcnt(0)
v_mfma_f32_16x16x32_bf16 v[32:35], a[56:59], a[16:19], v[32:35]
s_barrier
ds_read_b128 a[0:3], v10 offset:57344
v_mfma_f32_16x16x32_bf16 v[56:59], a[56:59], a[20:23], v[56:59]
ds_read_b64_tr_b16 a[32:33], v12 offset:0
v_mfma_f32_16x16x32_bf16 v[80:83], a[56:59], a[24:27], v[80:83]
ds_read_b64_tr_b16 a[34:35], v12 offset:512
v_mfma_f32_16x16x32_bf16 v[104:107], a[56:59], a[28:31], v[104:107]
ds_read_b128 a[4:7], v10 offset:59392
v_mfma_f32_16x16x32_bf16 v[36:39], a[60:63], a[16:19], v[36:39]
ds_read_b128 a[8:11], v10 offset:61440
v_mfma_f32_16x16x32_bf16 v[60:63], a[60:63], a[20:23], v[60:63]
ds_read_b128 a[12:15], v10 offset:63488
v_mfma_f32_16x16x32_bf16 v[84:87], a[60:63], a[24:27], v[84:87]
ds_read_b64_tr_b16 a[36:37], v13 offset:0
v_mfma_f32_16x16x32_bf16 v[108:111], a[60:63], a[28:31], v[108:111]
ds_read_b64_tr_b16 a[38:39], v13 offset:512
v_mfma_f32_16x16x32_bf16 v[40:43], a[16:19], a[64:67], v[40:43]
ds_read_b64_tr_b16 a[40:41], v12 offset:2048
v_mfma_f32_16x16x32_bf16 v[64:67], a[20:23], a[64:67], v[64:67]
ds_read_b64_tr_b16 a[42:43], v12 offset:2560
v_mfma_f32_16x16x32_bf16 v[88:91], a[24:27], a[64:67], v[88:91]
ds_read_b64_tr_b16 a[44:45], v13 offset:2048
v_mfma_f32_16x16x32_bf16 v[112:115], a[28:31], a[64:67], v[112:115]
ds_read_b64_tr_b16 a[46:47], v13 offset:2560
v_mfma_f32_16x16x32_bf16 v[44:47], a[16:19], a[68:71], v[44:47]
ds_read_b64_tr_b16 a[48:49], v12 offset:4096
v_mfma_f32_16x16x32_bf16 v[68:71], a[20:23], a[68:71], v[68:71]
ds_read_b64_tr_b16 a[50:51], v12 offset:4608
v_mfma_f32_16x16x32_bf16 v[92:95], a[24:27], a[68:71], v[92:95]
ds_read_b64_tr_b16 a[52:53], v13 offset:4096
v_mfma_f32_16x16x32_bf16 v[116:119], a[28:31], a[68:71], v[116:119]
ds_read_b64_tr_b16 a[54:55], v13 offset:4608
v_mfma_f32_16x16x32_bf16 v[48:51], a[16:19], a[72:75], v[48:51]
v_mfma_f32_16x16x32_bf16 v[72:75], a[20:23], a[72:75], v[72:75]
v_mfma_f32_16x16x32_bf16 v[96:99], a[24:27], a[72:75], v[96:99]
v_mfma_f32_16x16x32_bf16 v[120:123], a[28:31], a[72:75], v[120:123]
v_mfma_f32_16x16x32_bf16 v[52:55], a[16:19], a[76:79], v[52:55]
v_mfma_f32_16x16x32_bf16 v[76:79], a[20:23], a[76:79], v[76:79]
v_mfma_f32_16x16x32_bf16 v[100:103], a[24:27], a[76:79], v[100:103]
v_mfma_f32_16x16x32_bf16 v[124:127], a[28:31], a[76:79], v[124:127]
s_waitcnt lgkmcnt(0)
v_mfma_f32_16x16x32_bf16 v[32:35], a[32:35], a[0:3], v[32:35]
ds_read_b128 a[16:19], v11 offset:57344
v_mfma_f32_16x16x32_bf16 v[56:59], a[32:35], a[4:7], v[56:59]
ds_read_b64_tr_b16 a[56:57], v12 offset:12288
v_mfma_f32_16x16x32_bf16 v[80:83], a[32:35], a[8:11], v[80:83]
ds_read_b64_tr_b16 a[58:59], v12 offset:12800
v_mfma_f32_16x16x32_bf16 v[104:107], a[32:35], a[12:15], v[104:107]
ds_read_b128 a[20:23], v11 offset:59392
v_mfma_f32_16x16x32_bf16 v[36:39], a[36:39], a[0:3], v[36:39]
ds_read_b128 a[24:27], v11 offset:61440
v_mfma_f32_16x16x32_bf16 v[60:63], a[36:39], a[4:7], v[60:63]
ds_read_b128 a[28:31], v11 offset:63488
v_mfma_f32_16x16x32_bf16 v[84:87], a[36:39], a[8:11], v[84:87]
ds_read_b64_tr_b16 a[60:61], v13 offset:12288
v_mfma_f32_16x16x32_bf16 v[108:111], a[36:39], a[12:15], v[108:111]
ds_read_b64_tr_b16 a[62:63], v13 offset:12800
v_mfma_f32_16x16x32_bf16 v[40:43], a[0:3], a[40:43], v[40:43]
ds_read_b64_tr_b16 a[64:65], v12 offset:14336
v_mfma_f32_16x16x32_bf16 v[64:67], a[4:7], a[40:43], v[64:67]
ds_read_b64_tr_b16 a[66:67], v12 offset:14848
v_mfma_f32_16x16x32_bf16 v[88:91], a[8:11], a[40:43], v[88:91]
ds_read_b64_tr_b16 a[68:69], v13 offset:14336
v_mfma_f32_16x16x32_bf16 v[112:115], a[12:15], a[40:43], v[112:115]
ds_read_b64_tr_b16 a[70:71], v13 offset:14848
v_mfma_f32_16x16x32_bf16 v[44:47], a[0:3], a[44:47], v[44:47]
ds_read_b64_tr_b16 a[72:73], v12 offset:16384
v_mfma_f32_16x16x32_bf16 v[68:71], a[4:7], a[44:47], v[68:71]
ds_read_b64_tr_b16 a[74:75], v12 offset:16896
v_mfma_f32_16x16x32_bf16 v[92:95], a[8:11], a[44:47], v[92:95]
ds_read_b64_tr_b16 a[76:77], v13 offset:16384
v_mfma_f32_16x16x32_bf16 v[116:119], a[12:15], a[44:47], v[116:119]
ds_read_b64_tr_b16 a[78:79], v13 offset:16896
v_mfma_f32_16x16x32_bf16 v[48:51], a[0:3], a[48:51], v[48:51]
v_mfma_f32_16x16x32_bf16 v[72:75], a[4:7], a[48:51], v[72:75]
v_mfma_f32_16x16x32_bf16 v[96:99], a[8:11], a[48:51], v[96:99]
v_mfma_f32_16x16x32_bf16 v[120:123], a[12:15], a[48:51], v[120:123]
v_mfma_f32_16x16x32_bf16 v[52:55], a[0:3], a[52:55], v[52:55]
v_mfma_f32_16x16x32_bf16 v[76:79], a[4:7], a[52:55], v[76:79]
v_mfma_f32_16x16x32_bf16 v[100:103], a[8:11], a[52:55], v[100:103]
v_mfma_f32_16x16x32_bf16 v[124:127], a[12:15], a[52:55], v[124:127]
s_waitcnt lgkmcnt(0)
v_mfma_f32_16x16x32_bf16 v[32:35], a[56:59], a[16:19], v[32:35]
s_barrier
ds_read_b128 a[0:3], v10 offset:40960
v_mfma_f32_16x16x32_bf16 v[56:59], a[56:59], a[20:23], v[56:59]
ds_read_b64_tr_b16 a[32:33], v14 offset:16384
v_mfma_f32_16x16x32_bf16 v[80:83], a[56:59], a[24:27], v[80:83]
ds_read_b64_tr_b16 a[34:35], v14 offset:16896
v_mfma_f32_16x16x32_bf16 v[104:107], a[56:59], a[28:31], v[104:107]
ds_read_b128 a[4:7], v10 offset:43008
v_mfma_f32_16x16x32_bf16 v[36:39], a[60:63], a[16:19], v[36:39]
ds_read_b128 a[8:11], v10 offset:45056
v_mfma_f32_16x16x32_bf16 v[60:63], a[60:63], a[20:23], v[60:63]
ds_read_b128 a[12:15], v10 offset:47104
v_mfma_f32_16x16x32_bf16 v[84:87], a[60:63], a[24:27], v[84:87]
ds_read_b64_tr_b16 a[36:37], v15 offset:16384
v_mfma_f32_16x16x32_bf16 v[108:111], a[60:63], a[28:31], v[108:111]
ds_read_b64_tr_b16 a[38:39], v15 offset:16896
v_mfma_f32_16x16x32_bf16 v[40:43], a[16:19], a[64:67], v[40:43]
ds_read_b64_tr_b16 a[40:41], v14 offset:18432
v_mfma_f32_16x16x32_bf16 v[64:67], a[20:23], a[64:67], v[64:67]
ds_read_b64_tr_b16 a[42:43], v14 offset:18944
v_mfma_f32_16x16x32_bf16 v[88:91], a[24:27], a[64:67], v[88:91]
ds_read_b64_tr_b16 a[44:45], v15 offset:18432
v_mfma_f32_16x16x32_bf16 v[112:115], a[28:31], a[64:67], v[112:115]
ds_read_b64_tr_b16 a[46:47], v15 offset:18944
v_mfma_f32_16x16x32_bf16 v[44:47], a[16:19], a[68:71], v[44:47]
ds_read_b64_tr_b16 a[48:49], v14 offset:20480
v_mfma_f32_16x16x32_bf16 v[68:71], a[20:23], a[68:71], v[68:71]
ds_read_b64_tr_b16 a[50:51], v14 offset:20992
v_mfma_f32_16x16x32_bf16 v[92:95], a[24:27], a[68:71], v[92:95]
ds_read_b64_tr_b16 a[52:53], v15 offset:20480
v_mfma_f32_16x16x32_bf16 v[116:119], a[28:31], a[68:71], v[116:119]
ds_read_b64_tr_b16 a[54:55], v15 offset:20992
v_mfma_f32_16x16x32_bf16 v[48:51], a[16:19], a[72:75], v[48:51]
v_mfma_f32_16x16x32_bf16 v[72:75], a[20:23], a[72:75], v[72:75]
v_mfma_f32_16x16x32_bf16 v[96:99], a[24:27], a[72:75], v[96:99]
v_mfma_f32_16x16x32_bf16 v[120:123], a[28:31], a[72:75], v[120:123]
v_mfma_f32_16x16x32_bf16 v[52:55], a[16:19], a[76:79], v[52:55]
v_mfma_f32_16x16x32_bf16 v[76:79], a[20:23], a[76:79], v[76:79]
v_mfma_f32_16x16x32_bf16 v[100:103], a[24:27], a[76:79], v[100:103]
v_mfma_f32_16x16x32_bf16 v[124:127], a[28:31], a[76:79], v[124:127]
s_waitcnt lgkmcnt(0)
v_mfma_f32_16x16x32_bf16 v[32:35], a[32:35], a[0:3], v[32:35]
ds_read_b128 a[16:19], v11 offset:40960
v_mfma_f32_16x16x32_bf16 v[56:59], a[32:35], a[4:7], v[56:59]
ds_read_b64_tr_b16 a[56:57], v14 offset:28672
v_mfma_f32_16x16x32_bf16 v[80:83], a[32:35], a[8:11], v[80:83]
ds_read_b64_tr_b16 a[58:59], v14 offset:29184
v_mfma_f32_16x16x32_bf16 v[104:107], a[32:35], a[12:15], v[104:107]
ds_read_b128 a[20:23], v11 offset:43008
v_mfma_f32_16x16x32_bf16 v[36:39], a[36:39], a[0:3], v[36:39]
ds_read_b128 a[24:27], v11 offset:45056
v_mfma_f32_16x16x32_bf16 v[60:63], a[36:39], a[4:7], v[60:63]
ds_read_b128 a[28:31], v11 offset:47104
v_mfma_f32_16x16x32_bf16 v[84:87], a[36:39], a[8:11], v[84:87]
ds_read_b64_tr_b16 a[60:61], v15 offset:28672
v_mfma_f32_16x16x32_bf16 v[108:111], a[36:39], a[12:15], v[108:111]
ds_read_b64_tr_b16 a[62:63], v15 offset:29184
v_mfma_f32_16x16x32_bf16 v[40:43], a[0:3], a[40:43], v[40:43]
ds_read_b64_tr_b16 a[64:65], v14 offset:30720
v_mfma_f32_16x16x32_bf16 v[64:67], a[4:7], a[40:43], v[64:67]
ds_read_b64_tr_b16 a[66:67], v14 offset:31232
v_mfma_f32_16x16x32_bf16 v[88:91], a[8:11], a[40:43], v[88:91]
ds_read_b64_tr_b16 a[68:69], v15 offset:30720
v_mfma_f32_16x16x32_bf16 v[112:115], a[12:15], a[40:43], v[112:115]
ds_read_b64_tr_b16 a[70:71], v15 offset:31232
v_mfma_f32_16x16x32_bf16 v[44:47], a[0:3], a[44:47], v[44:47]
ds_read_b64_tr_b16 a[72:73], v14 offset:32768
v_mfma_f32_16x16x32_bf16 v[68:71], a[4:7], a[44:47], v[68:71]
ds_read_b64_tr_b16 a[74:75], v14 offset:33280
v_mfma_f32_16x16x32_bf16 v[92:95], a[8:11], a[44:47], v[92:95]
ds_read_b64_tr_b16 a[76:77], v15 offset:32768
v_mfma_f32_16x16x32_bf16 v[116:119], a[12:15], a[44:47], v[116:119]
ds_read_b64_tr_b16 a[78:79], v15 offset:33280
v_mfma_f32_16x16x32_bf16 v[48:51], a[0:3], a[48:51], v[48:51]
v_mfma_f32_16x16x32_bf16 v[72:75], a[4:7], a[48:51], v[72:75]
v_mfma_f32_16x16x32_bf16 v[96:99], a[8:11], a[48:51], v[96:99]
v_mfma_f32_16x16x32_bf16 v[120:123], a[12:15], a[48:51], v[120:123]
v_mfma_f32_16x16x32_bf16 v[52:55], a[0:3], a[52:55], v[52:55]
v_mfma_f32_16x16x32_bf16 v[76:79], a[4:7], a[52:55], v[76:79]
v_mfma_f32_16x16x32_bf16 v[100:103], a[8:11], a[52:55], v[100:103]
v_mfma_f32_16x16x32_bf16 v[124:127], a[12:15], a[52:55], v[124:127]
s_waitcnt lgkmcnt(0)
v_mfma_f32_16x16x32_bf16 v[32:35], a[56:59], a[16:19], v[32:35]
s_barrier
ds_read_b128 a[0:3], v10 offset:0
v_mfma_f32_16x16x32_bf16 v[56:59], a[56:59], a[20:23], v[56:59]
ds_read_b64_tr_b16 a[32:33], v12 offset:40960
v_mfma_f32_16x16x32_bf16 v[80:83], a[56:59], a[24:27], v[80:83]
ds_read_b64_tr_b16 a[34:35], v12 offset:41472
v_mfma_f32_16x16x32_bf16 v[104:107], a[56:59], a[28:31], v[104:107]
ds_read_b128 a[4:7], v10 offset:2048
v_mfma_f32_16x16x32_bf16 v[36:39], a[60:63], a[16:19], v[36:39]
ds_read_b128 a[8:11], v10 offset:4096
v_mfma_f32_16x16x32_bf16 v[60:63], a[60:63], a[20:23], v[60:63]
ds_read_b128 a[12:15], v10 offset:6144
v_mfma_f32_16x16x32_bf16 v[84:87], a[60:63], a[24:27], v[84:87]
ds_read_b64_tr_b16 a[36:37], v13 offset:40960
v_mfma_f32_16x16x32_bf16 v[108:111], a[60:63], a[28:31], v[108:111]
ds_read_b64_tr_b16 a[38:39], v13 offset:41472
v_mfma_f32_16x16x32_bf16 v[40:43], a[16:19], a[64:67], v[40:43]
ds_read_b64_tr_b16 a[40:41], v12 offset:43008
v_mfma_f32_16x16x32_bf16 v[64:67], a[20:23], a[64:67], v[64:67]
ds_read_b64_tr_b16 a[42:43], v12 offset:43520
v_mfma_f32_16x16x32_bf16 v[88:91], a[24:27], a[64:67], v[88:91]
ds_read_b64_tr_b16 a[44:45], v13 offset:43008
v_mfma_f32_16x16x32_bf16 v[112:115], a[28:31], a[64:67], v[112:115]
ds_read_b64_tr_b16 a[46:47], v13 offset:43520
v_mfma_f32_16x16x32_bf16 v[44:47], a[16:19], a[68:71], v[44:47]
ds_read_b64_tr_b16 a[48:49], v12 offset:45056
v_mfma_f32_16x16x32_bf16 v[68:71], a[20:23], a[68:71], v[68:71]
ds_read_b64_tr_b16 a[50:51], v12 offset:45568
v_mfma_f32_16x16x32_bf16 v[92:95], a[24:27], a[68:71], v[92:95]
ds_read_b64_tr_b16 a[52:53], v13 offset:45056
v_mfma_f32_16x16x32_bf16 v[116:119], a[28:31], a[68:71], v[116:119]
ds_read_b64_tr_b16 a[54:55], v13 offset:45568
v_mfma_f32_16x16x32_bf16 v[48:51], a[16:19], a[72:75], v[48:51]
v_mfma_f32_16x16x32_bf16 v[72:75], a[20:23], a[72:75], v[72:75]
v_mfma_f32_16x16x32_bf16 v[96:99], a[24:27], a[72:75], v[96:99]
v_mfma_f32_16x16x32_bf16 v[120:123], a[28:31], a[72:75], v[120:123]
v_mfma_f32_16x16x32_bf16 v[52:55], a[16:19], a[76:79], v[52:55]
v_mfma_f32_16x16x32_bf16 v[76:79], a[20:23], a[76:79], v[76:79]
v_mfma_f32_16x16x32_bf16 v[100:103], a[24:27], a[76:79], v[100:103]
v_mfma_f32_16x16x32_bf16 v[124:127], a[28:31], a[76:79], v[124:127]
s_waitcnt lgkmcnt(0)
v_mfma_f32_16x16x32_bf16 v[32:35], a[32:35], a[0:3], v[32:35]
ds_read_b128 a[16:19], v11 offset:0
v_mfma_f32_16x16x32_bf16 v[56:59], a[32:35], a[4:7], v[56:59]
ds_read_b64_tr_b16 a[56:57], v12 offset:53248
v_mfma_f32_16x16x32_bf16 v[80:83], a[32:35], a[8:11], v[80:83]
ds_read_b64_tr_b16 a[58:59], v12 offset:53760
v_mfma_f32_16x16x32_bf16 v[104:107], a[32:35], a[12:15], v[104:107]
ds_read_b128 a[20:23], v11 offset:2048
v_mfma_f32_16x16x32_bf16 v[36:39], a[36:39], a[0:3], v[36:39]
ds_read_b128 a[24:27], v11 offset:4096
v_mfma_f32_16x16x32_bf16 v[60:63], a[36:39], a[4:7], v[60:63]
ds_read_b128 a[28:31], v11 offset:6144
v_mfma_f32_16x16x32_bf16 v[84:87], a[36:39], a[8:11], v[84:87]
ds_read_b64_tr_b16 a[60:61], v13 offset:53248
v_mfma_f32_16x16x32_bf16 v[108:111], a[36:39], a[12:15], v[108:111]
ds_read_b64_tr_b16 a[62:63], v13 offset:53760
v_mfma_f32_16x16x32_bf16 v[40:43], a[0:3], a[40:43], v[40:43]
ds_read_b64_tr_b16 a[64:65], v12 offset:55296
v_mfma_f32_16x16x32_bf16 v[64:67], a[4:7], a[40:43], v[64:67]
ds_read_b64_tr_b16 a[66:67], v12 offset:55808
v_mfma_f32_16x16x32_bf16 v[88:91], a[8:11], a[40:43], v[88:91]
ds_read_b64_tr_b16 a[68:69], v13 offset:55296
v_mfma_f32_16x16x32_bf16 v[112:115], a[12:15], a[40:43], v[112:115]
ds_read_b64_tr_b16 a[70:71], v13 offset:55808
v_mfma_f32_16x16x32_bf16 v[44:47], a[0:3], a[44:47], v[44:47]
ds_read_b64_tr_b16 a[72:73], v12 offset:57344
v_mfma_f32_16x16x32_bf16 v[68:71], a[4:7], a[44:47], v[68:71]
ds_read_b64_tr_b16 a[74:75], v12 offset:57856
v_mfma_f32_16x16x32_bf16 v[92:95], a[8:11], a[44:47], v[92:95]
ds_read_b64_tr_b16 a[76:77], v13 offset:57344
v_mfma_f32_16x16x32_bf16 v[116:119], a[12:15], a[44:47], v[116:119]
ds_read_b64_tr_b16 a[78:79], v13 offset:57856
v_mfma_f32_16x16x32_bf16 v[48:51], a[0:3], a[48:51], v[48:51]
v_lshrrev_b32 v2, 4, v1
v_lshlrev_b32 v2, 4, v2
s_lshl_b32 s70, s66, 8
s_add_u32 s70, s70, 159744
v_add_u32 v17, s70, v2
v_mfma_f32_16x16x32_bf16 v[72:75], a[4:7], a[48:51], v[72:75]
v_mfma_f32_16x16x32_bf16 v[96:99], a[8:11], a[48:51], v[96:99]
v_and_b32 v2, 15, v1
v_lshlrev_b32 v2, 2, v2
s_lshl_b32 s70, s67, 7
s_add_u32 s70, s70, 160768
v_add_u32 v18, s70, v2
v_mfma_f32_16x16x32_bf16 v[120:123], a[12:15], a[48:51], v[120:123]
v_mfma_f32_16x16x32_bf16 v[52:55], a[0:3], a[52:55], v[52:55]
v_mfma_f32_16x16x32_bf16 v[76:79], a[4:7], a[52:55], v[76:79]
v_mfma_f32_16x16x32_bf16 v[100:103], a[8:11], a[52:55], v[100:103]
v_mfma_f32_16x16x32_bf16 v[124:127], a[12:15], a[52:55], v[124:127]
s_waitcnt lgkmcnt(0)
v_mfma_f32_16x16x32_bf16 v[32:35], a[56:59], a[16:19], v[32:35]
s_barrier
ds_read_b128 a[0:3], v8 offset:24576
v_mfma_f32_16x16x32_bf16 v[56:59], a[56:59], a[20:23], v[56:59]
ds_read_b64_tr_b16 a[32:33], v12 offset:0
v_mfma_f32_16x16x32_bf16 v[80:83], a[56:59], a[24:27], v[80:83]
ds_read_b64_tr_b16 a[34:35], v12 offset:512
v_mfma_f32_16x16x32_bf16 v[104:107], a[56:59], a[28:31], v[104:107]
ds_read_b128 a[4:7], v8 offset:26624
v_mfma_f32_16x16x32_bf16 v[36:39], a[60:63], a[16:19], v[36:39]
ds_read_b128 a[8:11], v8 offset:28672
v_mfma_f32_16x16x32_bf16 v[60:63], a[60:63], a[20:23], v[60:63]
ds_read_b128 a[12:15], v8 offset:30720
v_mfma_f32_16x16x32_bf16 v[84:87], a[60:63], a[24:27], v[84:87]
ds_read_b64_tr_b16 a[36:37], v13 offset:0
v_mfma_f32_16x16x32_bf16 v[108:111], a[60:63], a[28:31], v[108:111]
ds_read_b64_tr_b16 a[38:39], v13 offset:512
v_mfma_f32_16x16x32_bf16 v[40:43], a[16:19], a[64:67], v[40:43]
ds_read_b64_tr_b16 a[40:41], v12 offset:2048
v_mfma_f32_16x16x32_bf16 v[64:67], a[20:23], a[64:67], v[64:67]
ds_read_b64_tr_b16 a[42:43], v12 offset:2560
v_mfma_f32_16x16x32_bf16 v[88:91], a[24:27], a[64:67], v[88:91]
ds_read_b64_tr_b16 a[44:45], v13 offset:2048
v_mfma_f32_16x16x32_bf16 v[112:115], a[28:31], a[64:67], v[112:115]
ds_read_b64_tr_b16 a[46:47], v13 offset:2560
v_mfma_f32_16x16x32_bf16 v[44:47], a[16:19], a[68:71], v[44:47]
ds_read_b64_tr_b16 a[48:49], v12 offset:4096
v_mfma_f32_16x16x32_bf16 v[68:71], a[20:23], a[68:71], v[68:71]
ds_read_b64_tr_b16 a[50:51], v12 offset:4608
v_mfma_f32_16x16x32_bf16 v[92:95], a[24:27], a[68:71], v[92:95]
ds_read_b64_tr_b16 a[52:53], v13 offset:4096
v_mfma_f32_16x16x32_bf16 v[116:119], a[28:31], a[68:71], v[116:119]
ds_read_b64_tr_b16 a[54:55], v13 offset:4608
v_mfma_f32_16x16x32_bf16 v[48:51], a[16:19], a[72:75], v[48:51]
v_mfma_f32_16x16x32_bf16 v[72:75], a[20:23], a[72:75], v[72:75]
v_mfma_f32_16x16x32_bf16 v[96:99], a[24:27], a[72:75], v[96:99]
v_mfma_f32_16x16x32_bf16 v[120:123], a[28:31], a[72:75], v[120:123]
v_mfma_f32_16x16x32_bf16 v[52:55], a[16:19], a[76:79], v[52:55]
v_mfma_f32_16x16x32_bf16 v[76:79], a[20:23], a[76:79], v[76:79]
v_mfma_f32_16x16x32_bf16 v[100:103], a[24:27], a[76:79], v[100:103]
v_mfma_f32_16x16x32_bf16 v[124:127], a[28:31], a[76:79], v[124:127]
s_waitcnt lgkmcnt(0)
v_mfma_f32_16x16x32_bf16 v[32:35], a[32:35], a[0:3], v[32:35]
ds_read_b128 a[16:19], v9 offset:24576
v_mfma_f32_16x16x32_bf16 v[56:59], a[32:35], a[4:7], v[56:59]
ds_read_b64_tr_b16 a[56:57], v12 offset:12288
v_mfma_f32_16x16x32_bf16 v[80:83], a[32:35], a[8:11], v[80:83]
ds_read_b64_tr_b16 a[58:59], v12 offset:12800
v_mfma_f32_16x16x32_bf16 v[104:107], a[32:35], a[12:15], v[104:107]
ds_read_b128 a[20:23], v9 offset:26624
v_mfma_f32_16x16x32_bf16 v[36:39], a[36:39], a[0:3], v[36:39]
ds_read_b128 a[24:27], v9 offset:28672
v_mfma_f32_16x16x32_bf16 v[60:63], a[36:39], a[4:7], v[60:63]
ds_read_b128 a[28:31], v9 offset:30720
v_mfma_f32_16x16x32_bf16 v[84:87], a[36:39], a[8:11], v[84:87]
ds_read_b64_tr_b16 a[60:61], v13 offset:12288
v_mfma_f32_16x16x32_bf16 v[108:111], a[36:39], a[12:15], v[108:111]
ds_read_b64_tr_b16 a[62:63], v13 offset:12800
v_mfma_f32_16x16x32_bf16 v[40:43], a[0:3], a[40:43], v[40:43]
ds_read_b64_tr_b16 a[64:65], v12 offset:14336
v_mfma_f32_16x16x32_bf16 v[64:67], a[4:7], a[40:43], v[64:67]
ds_read_b64_tr_b16 a[66:67], v12 offset:14848
v_mfma_f32_16x16x32_bf16 v[88:91], a[8:11], a[40:43], v[88:91]
ds_read_b64_tr_b16 a[68:69], v13 offset:14336
v_mfma_f32_16x16x32_bf16 v[112:115], a[12:15], a[40:43], v[112:115]
ds_read_b64_tr_b16 a[70:71], v13 offset:14848
v_mfma_f32_16x16x32_bf16 v[44:47], a[0:3], a[44:47], v[44:47]
ds_read_b64_tr_b16 a[72:73], v12 offset:16384
v_mfma_f32_16x16x32_bf16 v[68:71], a[4:7], a[44:47], v[68:71]
ds_read_b64_tr_b16 a[74:75], v12 offset:16896
v_mfma_f32_16x16x32_bf16 v[92:95], a[8:11], a[44:47], v[92:95]
ds_read_b64_tr_b16 a[76:77], v13 offset:16384
v_mfma_f32_16x16x32_bf16 v[116:119], a[12:15], a[44:47], v[116:119]
ds_read_b64_tr_b16 a[78:79], v13 offset:16896
v_mfma_f32_16x16x32_bf16 v[48:51], a[0:3], a[48:51], v[48:51]
v_mfma_f32_16x16x32_bf16 v[72:75], a[4:7], a[48:51], v[72:75]
v_mfma_f32_16x16x32_bf16 v[96:99], a[8:11], a[48:51], v[96:99]
v_mfma_f32_16x16x32_bf16 v[120:123], a[12:15], a[48:51], v[120:123]
v_mfma_f32_16x16x32_bf16 v[52:55], a[0:3], a[52:55], v[52:55]
v_mfma_f32_16x16x32_bf16 v[76:79], a[4:7], a[52:55], v[76:79]
v_mfma_f32_16x16x32_bf16 v[100:103], a[8:11], a[52:55], v[100:103]
v_mfma_f32_16x16x32_bf16 v[124:127], a[12:15], a[52:55], v[124:127]
s_waitcnt lgkmcnt(0)
v_mfma_f32_16x16x32_bf16 v[40:43], a[16:19], a[64:67], v[40:43]
s_barrier
ds_read_b128 v[20:23], v17 offset:0
v_mfma_f32_16x16x32_bf16 v[64:67], a[20:23], a[64:67], v[64:67]
ds_read_b128 v[24:27], v17 offset:512
v_mfma_f32_16x16x32_bf16 v[88:91], a[24:27], a[64:67], v[88:91]
ds_read_b32 v6, v18 offset:256
v_mfma_f32_16x16x32_bf16 v[112:115], a[28:31], a[64:67], v[112:115]
ds_read_b32 v8, v18 offset:320
v_mfma_f32_16x16x32_bf16 v[44:47], a[16:19], a[68:71], v[44:47]
ds_read_b32 v10, v18 offset:512
v_mfma_f32_16x16x32_bf16 v[68:71], a[20:23], a[68:71], v[68:71]
ds_read_b32 v18, v18 offset:576
v_mfma_f32_16x16x32_bf16 v[92:95], a[24:27], a[68:71], v[92:95]
v_mov_b32 v19, 161536
ds_read_b32 v19, v19
v_mfma_f32_16x16x32_bf16 v[116:119], a[28:31], a[68:71], v[116:119]
ds_read_b128 v[128:131], v17 offset:64
v_mfma_f32_16x16x32_bf16 v[48:51], a[16:19], a[72:75], v[48:51]
ds_read_b128 v[132:135], v17 offset:576
v_mfma_f32_16x16x32_bf16 v[72:75], a[20:23], a[72:75], v[72:75]
ds_read_b128 v[136:139], v17 offset:128
v_mfma_f32_16x16x32_bf16 v[96:99], a[24:27], a[72:75], v[96:99]
ds_read_b128 v[140:143], v17 offset:640
v_mfma_f32_16x16x32_bf16 v[120:123], a[28:31], a[72:75], v[120:123]
ds_read_b128 v[144:147], v17 offset:192
v_mfma_f32_16x16x32_bf16 v[52:55], a[16:19], a[76:79], v[52:55]
ds_read_b128 v[148:151], v17 offset:704
v_mfma_f32_16x16x32_bf16 v[76:79], a[20:23], a[76:79], v[76:79]
v_mfma_f32_16x16x32_bf16 v[100:103], a[24:27], a[76:79], v[100:103]
v_mfma_f32_16x16x32_bf16 v[124:127], a[28:31], a[76:79], v[124:127]
v_mfma_f32_16x16x32_bf16 v[32:35], a[56:59], a[16:19], v[32:35]
v_mfma_f32_16x16x32_bf16 v[56:59], a[56:59], a[20:23], v[56:59]
v_mfma_f32_16x16x32_bf16 v[80:83], a[56:59], a[24:27], v[80:83]
v_mfma_f32_16x16x32_bf16 v[104:107], a[56:59], a[28:31], v[104:107]
v_mfma_f32_16x16x32_bf16 v[36:39], a[60:63], a[16:19], v[36:39]
v_mfma_f32_16x16x32_bf16 v[60:63], a[60:63], a[20:23], v[60:63]
v_mfma_f32_16x16x32_bf16 v[84:87], a[60:63], a[24:27], v[84:87]
v_mfma_f32_16x16x32_bf16 v[108:111], a[60:63], a[28:31], v[108:111]
s_waitcnt lgkmcnt(0)
v_readfirstlane_b32 s69, v19
v_pk_mul_f32 v[28:29], v[24:25], s[90:91]
v_pk_mul_f32 v[30:31], v[26:27], s[90:91]
v_pk_fma_f32 v[40:41], v[20:21], v[6:7], v[40:41] op_sel:[0,0,0] op_sel_hi:[1,0,1]
v_pk_fma_f32 v[44:45], v[20:21], v[8:9], v[44:45] op_sel:[0,0,0] op_sel_hi:[1,0,1]
v_pk_fma_f32 v[42:43], v[22:23], v[6:7], v[42:43] op_sel:[0,0,0] op_sel_hi:[1,0,1]
v_pk_fma_f32 v[46:47], v[22:23], v[8:9], v[46:47] op_sel:[0,0,0] op_sel_hi:[1,0,1]
v_pk_mul_f32 v[2:3], v[40:41], v[28:29]
v_pk_mul_f32 v[12:13], v[44:45], v[28:29]
v_pk_mul_f32 v[4:5], v[42:43], v[30:31]
v_pk_mul_f32 v[14:15], v[46:47], v[30:31]
v_pk_fma_f32 v[40:41], v[40:41], v[24:25], s[82:83]
v_pk_fma_f32 v[44:45], v[44:45], v[24:25], s[82:83]
v_pk_fma_f32 v[42:43], v[42:43], v[26:27], s[82:83]
v_pk_fma_f32 v[46:47], v[46:47], v[26:27], s[82:83]
v_exp_f32_e64 v2, v2 clamp
v_exp_f32_e64 v12, v12 clamp
v_exp_f32_e64 v3, v3 clamp
v_exp_f32_e64 v13, v13 clamp
v_exp_f32_e64 v4, v4 clamp
v_exp_f32_e64 v14, v14 clamp
v_exp_f32_e64 v5, v5 clamp
v_exp_f32_e64 v15, v15 clamp
v_pk_add_f32 v[2:3], v[2:3], s[80:81]
v_pk_add_f32 v[12:13], v[12:13], s[80:81]
v_pk_add_f32 v[4:5], v[4:5], s[80:81]
v_pk_add_f32 v[14:15], v[14:15], s[80:81]
v_max_f32 v40, v40, v2
v_max_f32 v44, v44, v12
v_max_f32 v41, v41, v3
v_max_f32 v45, v45, v13
v_max_f32 v42, v42, v4
v_max_f32 v46, v46, v14
v_max_f32 v43, v43, v5
v_max_f32 v47, v47, v15
v_cvt_pk_bf16_f32 v40, v40, v41
v_cvt_pk_bf16_f32 v44, v44, v45
v_cvt_pk_bf16_f32 v41, v42, v43
v_cvt_pk_bf16_f32 v45, v46, v47
v_pk_fma_f32 v[48:49], v[20:21], v[10:11], v[48:49] op_sel:[0,0,0] op_sel_hi:[1,0,1]
v_pk_fma_f32 v[52:53], v[20:21], v[18:19], v[52:53] op_sel:[0,0,0] op_sel_hi:[1,0,1]
v_pk_fma_f32 v[50:51], v[22:23], v[10:11], v[50:51] op_sel:[0,0,0] op_sel_hi:[1,0,1]
v_pk_fma_f32 v[54:55], v[22:23], v[18:19], v[54:55] op_sel:[0,0,0] op_sel_hi:[1,0,1]
v_pk_mul_f32 v[48:49], v[48:49], v[24:25]
v_pk_mul_f32 v[52:53], v[52:53], v[24:25]
v_pk_mul_f32 v[50:51], v[50:51], v[26:27]
v_pk_mul_f32 v[54:55], v[54:55], v[26:27]
v_cvt_pk_bf16_f32 v48, v48, v49
v_cvt_pk_bf16_f32 v52, v52, v53
v_cvt_pk_bf16_f32 v49, v50, v51
v_cvt_pk_bf16_f32 v53, v54, v55
v_pk_mul_f32 v[28:29], v[132:133], s[90:91]
v_pk_mul_f32 v[30:31], v[134:135], s[90:91]
v_pk_fma_f32 v[64:65], v[128:129], v[6:7], v[64:65] op_sel:[0,0,0] op_sel_hi:[1,0,1]
v_pk_fma_f32 v[68:69], v[128:129], v[8:9], v[68:69] op_sel:[0,0,0] op_sel_hi:[1,0,1]
v_pk_fma_f32 v[66:67], v[130:131], v[6:7], v[66:67] op_sel:[0,0,0] op_sel_hi:[1,0,1]
v_pk_fma_f32 v[70:71], v[130:131], v[8:9], v[70:71] op_sel:[0,0,0] op_sel_hi:[1,0,1]
v_pk_mul_f32 v[2:3], v[64:65], v[28:29]
v_pk_mul_f32 v[12:13], v[68:69], v[28:29]
v_pk_mul_f32 v[4:5], v[66:67], v[30:31]
v_pk_mul_f32 v[14:15], v[70:71], v[30:31]
v_pk_fma_f32 v[64:65], v[64:65], v[132:133], s[82:83]
v_pk_fma_f32 v[68:69], v[68:69], v[132:133], s[82:83]
v_pk_fma_f32 v[66:67], v[66:67], v[134:135], s[82:83]
v_pk_fma_f32 v[70:71], v[70:71], v[134:135], s[82:83]
v_exp_f32_e64 v2, v2 clamp
v_exp_f32_e64 v12, v12 clamp
v_exp_f32_e64 v3, v3 clamp
v_exp_f32_e64 v13, v13 clamp
v_exp_f32_e64 v4, v4 clamp
v_exp_f32_e64 v14, v14 clamp
v_exp_f32_e64 v5, v5 clamp
v_exp_f32_e64 v15, v15 clamp
v_pk_add_f32 v[2:3], v[2:3], s[80:81]
v_pk_add_f32 v[12:13], v[12:13], s[80:81]
v_pk_add_f32 v[4:5], v[4:5], s[80:81]
s_branch L_over5
L_pad5:
s_branch L_ret9
L_over5:
v_pk_add_f32 v[14:15], v[14:15], s[80:81]
v_max_f32 v64, v64, v2
v_max_f32 v68, v68, v12
v_max_f32 v65, v65, v3
v_max_f32 v69, v69, v13
v_max_f32 v66, v66, v4
v_max_f32 v70, v70, v14
v_max_f32 v67, v67, v5
v_max_f32 v71, v71, v15
v_cvt_pk_bf16_f32 v42, v64, v65
v_cvt_pk_bf16_f32 v46, v68, v69
v_cvt_pk_bf16_f32 v43, v66, v67
v_cvt_pk_bf16_f32 v47, v70, v71
v_pk_fma_f32 v[72:73], v[128:129], v[10:11], v[72:73] op_sel:[0,0,0] op_sel_hi:[1,0,1]
v_pk_fma_f32 v[76:77], v[128:129], v[18:19], v[76:77] op_sel:[0,0,0] op_sel_hi:[1,0,1]
v_pk_fma_f32 v[74:75], v[130:131], v[10:11], v[74:75] op_sel:[0,0,0] op_sel_hi:[1,0,1]
v_pk_fma_f32 v[78:79], v[130:131], v[18:19], v[78:79] op_sel:[0,0,0] op_sel_hi:[1,0,1]
v_pk_mul_f32 v[72:73], v[72:73], v[132:133]
v_pk_mul_f32 v[76:77], v[76:77], v[132:133]
v_pk_mul_f32 v[74:75], v[74:75], v[134:135]
v_pk_mul_f32 v[78:79], v[78:79], v[134:135]
v_cvt_pk_bf16_f32 v50, v72, v73
v_cvt_pk_bf16_f32 v54, v76, v77
v_cvt_pk_bf16_f32 v51, v74, v75
v_cvt_pk_bf16_f32 v55, v78, v79
s_nop 0
v_mfma_f32_16x16x32_bf16 v[64:67], v[40:43], v[48:51], 0
v_mfma_f32_16x16x32_bf16 v[68:71], v[40:43], v[52:55], 0
v_mfma_f32_16x16x32_bf16 v[20:23], v[40:43], a[80:83], 0
v_mfma_f32_16x16x32_bf16 v[72:75], v[44:47], v[48:51], 0
v_mfma_f32_16x16x32_bf16 v[76:79], v[44:47], v[52:55], 0
v_mfma_f32_16x16x32_bf16 v[24:27], v[44:47], a[80:83], 0
v_pk_mul_f32 v[28:29], v[140:141], s[90:91]
v_pk_mul_f32 v[30:31], v[142:143], s[90:91]
v_pk_fma_f32 v[88:89], v[136:137], v[6:7], v[88:89] op_sel:[0,0,0] op_sel_hi:[1,0,1]
v_pk_fma_f32 v[92:93], v[136:137], v[8:9], v[92:93] op_sel:[0,0,0] op_sel_hi:[1,0,1]
v_pk_fma_f32 v[90:91], v[138:139], v[6:7], v[90:91] op_sel:[0,0,0] op_sel_hi:[1,0,1]
v_pk_fma_f32 v[94:95], v[138:139], v[8:9], v[94:95] op_sel:[0,0,0] op_sel_hi:[1,0,1]
v_pk_mul_f32 v[2:3], v[88:89], v[28:29]
v_pk_mul_f32 v[12:13], v[92:93], v[28:29]
v_pk_mul_f32 v[4:5], v[90:91], v[30:31]
v_pk_mul_f32 v[14:15], v[94:95], v[30:31]
v_pk_fma_f32 v[88:89], v[88:89], v[140:141], s[82:83]
v_pk_fma_f32 v[92:93], v[92:93], v[140:141], s[82:83]
v_pk_fma_f32 v[90:91], v[90:91], v[142:143], s[82:83]
v_pk_fma_f32 v[94:95], v[94:95], v[142:143], s[82:83]
v_exp_f32_e64 v2, v2 clamp
v_exp_f32_e64 v12, v12 clamp
v_exp_f32_e64 v3, v3 clamp
v_exp_f32_e64 v13, v13 clamp
v_exp_f32_e64 v4, v4 clamp
v_exp_f32_e64 v14, v14 clamp
v_exp_f32_e64 v5, v5 clamp
v_exp_f32_e64 v15, v15 clamp
v_pk_add_f32 v[2:3], v[2:3], s[80:81]
v_pk_add_f32 v[12:13], v[12:13], s[80:81]
v_pk_add_f32 v[4:5], v[4:5], s[80:81]
v_pk_add_f32 v[14:15], v[14:15], s[80:81]
v_max_f32 v88, v88, v2
v_max_f32 v92, v92, v12
v_max_f32 v89, v89, v3
v_max_f32 v93, v93, v13
v_max_f32 v90, v90, v4
v_max_f32 v94, v94, v14
v_max_f32 v91, v91, v5
v_max_f32 v95, v95, v15
v_cvt_pk_bf16_f32 v88, v88, v89
v_cvt_pk_bf16_f32 v92, v92, v93
v_cvt_pk_bf16_f32 v89, v90, v91
v_cvt_pk_bf16_f32 v93, v94, v95
v_pk_fma_f32 v[96:97], v[136:137], v[10:11], v[96:97] op_sel:[0,0,0] op_sel_hi:[1,0,1]
v_pk_fma_f32 v[100:101], v[136:137], v[18:19], v[100:101] op_sel:[0,0,0] op_sel_hi:[1,0,1]
v_pk_fma_f32 v[98:99], v[138:139], v[10:11], v[98:99] op_sel:[0,0,0] op_sel_hi:[1,0,1]
v_pk_fma_f32 v[102:103], v[138:139], v[18:19], v[102:103] op_sel:[0,0,0] op_sel_hi:[1,0,1]
v_pk_mul_f32 v[96:97], v[96:97], v[140:141]
v_pk_mul_f32 v[100:101], v[100:101], v[140:141]
v_pk_mul_f32 v[98:99], v[98:99], v[142:143]
v_pk_mul_f32 v[102:103], v[102:103], v[142:143]
v_cvt_pk_bf16_f32 v96, v96, v97
v_cvt_pk_bf16_f32 v100, v100, v101
v_cvt_pk_bf16_f32 v97, v98, v99
v_cvt_pk_bf16_f32 v101, v102, v103
v_pk_mul_f32 v[28:29], v[148:149], s[90:91]
v_pk_mul_f32 v[30:31], v[150:151], s[90:91]
v_pk_fma_f32 v[112:113], v[144:145], v[6:7], v[112:113] op_sel:[0,0,0] op_sel_hi:[1,0,1]
v_pk_fma_f32 v[116:117], v[144:145], v[8:9], v[116:117] op_sel:[0,0,0] op_sel_hi:[1,0,1]
v_pk_fma_f32 v[114:115], v[146:147], v[6:7], v[114:115] op_sel:[0,0,0] op_sel_hi:[1,0,1]
v_pk_fma_f32 v[118:119], v[146:147], v[8:9], v[118:119] op_sel:[0,0,0] op_sel_hi:[1,0,1]
v_pk_mul_f32 v[2:3], v[112:113], v[28:29]
v_pk_mul_f32 v[12:13], v[116:117], v[28:29]
v_pk_mul_f32 v[4:5], v[114:115], v[30:31]
v_pk_mul_f32 v[14:15], v[118:119], v[30:31]
v_pk_fma_f32 v[112:113], v[112:113], v[148:149], s[82:83]
v_pk_fma_f32 v[116:117], v[116:117], v[148:149], s[82:83]
v_pk_fma_f32 v[114:115], v[114:115], v[150:151], s[82:83]
v_pk_fma_f32 v[118:119], v[118:119], v[150:151], s[82:83]
v_exp_f32_e64 v2, v2 clamp
v_exp_f32_e64 v12, v12 clamp
v_exp_f32_e64 v3, v3 clamp
v_exp_f32_e64 v13, v13 clamp
v_exp_f32_e64 v4, v4 clamp
v_exp_f32_e64 v14, v14 clamp
v_exp_f32_e64 v5, v5 clamp
v_exp_f32_e64 v15, v15 clamp
v_pk_add_f32 v[2:3], v[2:3], s[80:81]
v_pk_add_f32 v[12:13], v[12:13], s[80:81]
v_pk_add_f32 v[4:5], v[4:5], s[80:81]
v_pk_add_f32 v[14:15], v[14:15], s[80:81]
v_max_f32 v112, v112, v2
v_max_f32 v116, v116, v12
v_max_f32 v113, v113, v3
v_max_f32 v117, v117, v13
v_max_f32 v114, v114, v4
v_max_f32 v118, v118, v14
v_max_f32 v115, v115, v5
v_max_f32 v119, v119, v15
v_cvt_pk_bf16_f32 v90, v112, v113
v_cvt_pk_bf16_f32 v94, v116, v117
v_cvt_pk_bf16_f32 v91, v114, v115
v_cvt_pk_bf16_f32 v95, v118, v119
v_pk_fma_f32 v[120:121], v[144:145], v[10:11], v[120:121] op_sel:[0,0,0] op_sel_hi:[1,0,1]
v_pk_fma_f32 v[124:125], v[144:145], v[18:19], v[124:125] op_sel:[0,0,0] op_sel_hi:[1,0,1]
v_pk_fma_f32 v[122:123], v[146:147], v[10:11], v[122:123] op_sel:[0,0,0] op_sel_hi:[1,0,1]
v_pk_fma_f32 v[126:127], v[146:147], v[18:19], v[126:127] op_sel:[0,0,0] op_sel_hi:[1,0,1]
v_pk_mul_f32 v[120:121], v[120:121], v[148:149]
v_pk_mul_f32 v[124:125], v[124:125], v[148:149]
v_pk_mul_f32 v[122:123], v[122:123], v[150:151]
v_pk_mul_f32 v[126:127], v[126:127], v[150:151]
v_cvt_pk_bf16_f32 v98, v120, v121
v_cvt_pk_bf16_f32 v102, v124, v125
v_cvt_pk_bf16_f32 v99, v122, v123
v_cvt_pk_bf16_f32 v103, v126, v127
s_nop 0
v_mfma_f32_16x16x32_bf16 v[64:67], v[88:91], v[96:99], v[64:67]
v_mfma_f32_16x16x32_bf16 v[68:71], v[88:91], v[100:103], v[68:71]
v_mfma_f32_16x16x32_bf16 v[20:23], v[88:91], a[80:83], v[20:23]
v_mfma_f32_16x16x32_bf16 v[72:75], v[92:95], v[96:99], v[72:75]
v_mfma_f32_16x16x32_bf16 v[76:79], v[92:95], v[100:103], v[76:79]
v_mfma_f32_16x16x32_bf16 v[24:27], v[92:95], a[80:83], v[24:27]
s_lshl_b32 s70, s60, 11
s_add_u32 s70, s70, 16384
v_add_u32 v2, s70, v16
v_xor_b32 v3, 4096, v2
v_lshrrev_b32 v4, 4, v1
v_lshlrev_b32 v5, 4, v4
v_lshlrev_b32 v4, 5, v4
s_lshl_b32 s70, s60, 6
s_add_u32 s70, s70, 163584
v_add_u32 v5, s70, v5
v_xor_b32 v6, 128, v5
s_lshl_b32 s72, s67, 1
s_add_u32 s72, s72, s66
s_lshl_b32 s72, s72, 10
s_add_u32 s72, s72, s87
s_lshl_b32 s73, s67, 7
s_lshl_b32 s70, s66, 4
s_add_u32 s73, s73, s70
s_add_u32 s73, s73, s87
s_add_u32 s73, s73, 4096
s_mov_b32 s92, 0x00010001
s_mov_b32 s93, 0x00010001
v_mov_b32 v15, s68
s_cmp_eq_u32 s66, 0
s_cbranch_scc0 L_ex1
ds_write_b128 v2, v[68:71]
ds_write_b128 v2, v[76:79] offset:1024
ds_write_b128 v5, v[24:27]
s_waitcnt lgkmcnt(0)
s_barrier
ds_read_b128 v[128:131], v3
ds_read_b128 v[132:135], v3 offset:1024
ds_read_b128 v[136:139], v6
s_waitcnt lgkmcnt(1)
v_pk_add_f32 v[128:129], v[128:129], v[64:65]
v_pk_add_f32 v[130:131], v[130:131], v[66:67]
v_pk_add_f32 v[132:133], v[132:133], v[72:73]
v_pk_add_f32 v[134:135], v[134:135], v[74:75]
s_waitcnt lgkmcnt(0)
v_pk_add_f32 v[136:137], v[136:137], v[20:21]
v_pk_add_f32 v[138:139], v[138:139], v[22:23]
s_branch L_ex_d
L_ex1:
ds_write_b128 v2, v[64:67]
ds_write_b128 v2, v[72:75] offset:1024
ds_write_b128 v5, v[20:23]
s_waitcnt lgkmcnt(0)
s_barrier
ds_read_b128 v[128:131], v3
ds_read_b128 v[132:135], v3 offset:1024
ds_read_b128 v[136:139], v6
s_waitcnt lgkmcnt(1)
v_pk_add_f32 v[128:129], v[128:129], v[68:69]
v_pk_add_f32 v[130:131], v[130:131], v[70:71]
v_pk_add_f32 v[132:133], v[132:133], v[76:77]
v_pk_add_f32 v[134:135], v[134:135], v[78:79]
s_waitcnt lgkmcnt(0)
v_pk_add_f32 v[136:137], v[136:137], v[24:25]
v_pk_add_f32 v[138:139], v[138:139], v[26:27]
L_ex_d:
v_cvt_pk_bf16_f32 v140, v128, v129
v_cvt_pk_bf16_f32 v141, v130, v131
v_cvt_pk_bf16_f32 v142, v132, v133
v_cvt_pk_bf16_f32 v143, v134, v135
v_bfi_b32 v136, s85, v15, v136
v_bfi_b32 v137, s85, v15, v137
v_bfi_b32 v138, s85, v15, v138
v_bfi_b32 v139, s85, v15, v139
s_cmp_eq_u32 s69, 0
s_cbranch_scc1 L_kvp_s
buffer_store_dwordx4 v[140:143], v16, s[12:15], s72 offen
s_mov_b64 exec, s[92:93]
buffer_store_dwordx4 v[136:139], v4, s[12:15], s73 offen
s_mov_b64 exec, -1
L_kvp_d:
s_barrier
v_and_b32 v2, 15, v1
v_lshlrev_b32 v2, 2, v2
s_lshl_b32 s70, s66, 8
s_add_u32 s70, s70, 159744
v_add_u32 v2, s70, v2
v_lshrrev_b32 v3, 4, v1
v_lshlrev_b32 v3, 4, v3
s_lshl_b32 s70, s67, 7
s_add_u32 s70, s70, 160768
v_add_u32 v5, s70, v3
ds_read_b32 v8, v2 offset:0
ds_read_b32 v128, v2 offset:512
ds_read_b32 v10, v2 offset:64
ds_read_b32 v130, v2 offset:576
ds_read_b32 v12, v2 offset:128
ds_read_b32 v132, v2 offset:640
ds_read_b32 v14, v2 offset:192
ds_read_b32 v134, v2 offset:704
ds_read_b128 v[144:147], v5 offset:0
ds_read_b128 v[148:151], v5 offset:64
s_lshl_b32 s70, s67, 11
s_add_u32 s70, s70, 24576
v_add_u32 v17, s70, v16
s_lshl_b32 s70, s67, 6
s_add_u32 s70, s70, 161600
v_add_u32 v18, s70, v3
s_waitcnt lgkmcnt(0)
v_mul_f32 v20, s90, v128
v_mul_f32 v22, s90, v130
v_mul_f32 v4, s90, v132
v_mul_f32 v6, s90, v134
v_pk_fma_f32 v[32:33], v[144:145], v[8:9], v[32:33] op_sel:[0,0,0] op_sel_hi:[1,0,1]
v_pk_fma_f32 v[36:37], v[148:149], v[8:9], v[36:37] op_sel:[0,0,0] op_sel_hi:[1,0,1]
v_pk_fma_f32 v[34:35], v[146:147], v[8:9], v[34:35] op_sel:[0,0,0] op_sel_hi:[1,0,1]
v_pk_fma_f32 v[38:39], v[150:151], v[8:9], v[38:39] op_sel:[0,0,0] op_sel_hi:[1,0,1]
v_pk_mul_f32 v[24:25], v[32:33], v[20:21] op_sel:[0,0] op_sel_hi:[1,0]
v_pk_mul_f32 v[28:29], v[36:37], v[20:21] op_sel:[0,0] op_sel_hi:[1,0]
v_pk_mul_f32 v[26:27], v[34:35], v[20:21] op_sel:[0,0] op_sel_hi:[1,0]
v_pk_mul_f32 v[30:31], v[38:39], v[20:21] op_sel:[0,0] op_sel_hi:[1,0]
v_pk_fma_f32 v[32:33], v[32:33], v[128:129], s[82:83] op_sel:[0,0,0] op_sel_hi:[1,0,1]
v_pk_fma_f32 v[36:37], v[36:37], v[128:129], s[82:83] op_sel:[0,0,0] op_sel_hi:[1,0,1]
v_pk_fma_f32 v[34:35], v[34:35], v[128:129], s[82:83] op_sel:[0,0,0] op_sel_hi:[1,0,1]
v_pk_fma_f32 v[38:39], v[38:39], v[128:129], s[82:83] op_sel:[0,0,0] op_sel_hi:[1,0,1]
v_exp_f32_e64 v24, v24 clamp
v_exp_f32_e64 v28, v28 clamp
v_exp_f32_e64 v25, v25 clamp
v_exp_f32_e64 v29, v29 clamp
v_exp_f32_e64 v26, v26 clamp
v_exp_f32_e64 v30, v30 clamp
v_exp_f32_e64 v27, v27 clamp
v_exp_f32_e64 v31, v31 clamp
v_pk_add_f32 v[24:25], v[24:25], s[80:81]
v_pk_add_f32 v[28:29], v[28:29], s[80:81]
v_pk_add_f32 v[26:27], v[26:27], s[80:81]
v_pk_add_f32 v[30:31], v[30:31], s[80:81]
v_max_f32 v32, v32, v24
v_max_f32 v36, v36, v28
v_max_f32 v33, v33, v25
v_max_f32 v37, v37, v29
v_max_f32 v34, v34, v26
v_max_f32 v38, v38, v30
v_max_f32 v35, v35, v27
v_max_f32 v39, v39, v31
v_cvt_pk_bf16_f32 v32, v32, v33
v_cvt_pk_bf16_f32 v33, v34, v35
v_cvt_pk_bf16_f32 v34, v36, v37
v_cvt_pk_bf16_f32 v35, v38, v39
v_pk_fma_f32 v[56:57], v[144:145], v[10:11], v[56:57] op_sel:[0,0,0] op_sel_hi:[1,0,1]
v_pk_fma_f32 v[60:61], v[148:149], v[10:11], v[60:61] op_sel:[0,0,0] op_sel_hi:[1,0,1]
v_pk_fma_f32 v[58:59], v[146:147], v[10:11], v[58:59] op_sel:[0,0,0] op_sel_hi:[1,0,1]
v_pk_fma_f32 v[62:63], v[150:151], v[10:11], v[62:63] op_sel:[0,0,0] op_sel_hi:[1,0,1]
v_pk_mul_f32 v[24:25], v[56:57], v[22:23] op_sel:[0,0] op_sel_hi:[1,0]
v_pk_mul_f32 v[28:29], v[60:61], v[22:23] op_sel:[0,0] op_sel_hi:[1,0]
v_pk_mul_f32 v[26:27], v[58:59], v[22:23] op_sel:[0,0] op_sel_hi:[1,0]
v_pk_mul_f32 v[30:31], v[62:63], v[22:23] op_sel:[0,0] op_sel_hi:[1,0]
v_pk_fma_f32 v[56:57], v[56:57], v[130:131], s[82:83] op_sel:[0,0,0] op_sel_hi:[1,0,1]
v_pk_fma_f32 v[60:61], v[60:61], v[130:131], s[82:83] op_sel:[0,0,0] op_sel_hi:[1,0,1]
v_pk_fma_f32 v[58:59], v[58:59], v[130:131], s[82:83] op_sel:[0,0,0] op_sel_hi:[1,0,1]
v_pk_fma_f32 v[62:63], v[62:63], v[130:131], s[82:83] op_sel:[0,0,0] op_sel_hi:[1,0,1]
v_exp_f32_e64 v24, v24 clamp
v_exp_f32_e64 v28, v28 clamp
v_exp_f32_e64 v25, v25 clamp
v_exp_f32_e64 v29, v29 clamp
v_exp_f32_e64 v26, v26 clamp
v_exp_f32_e64 v30, v30 clamp
v_exp_f32_e64 v27, v27 clamp
v_exp_f32_e64 v31, v31 clamp
v_pk_add_f32 v[24:25], v[24:25], s[80:81]
v_pk_add_f32 v[28:29], v[28:29], s[80:81]
v_pk_add_f32 v[26:27], v[26:27], s[80:81]
v_pk_add_f32 v[30:31], v[30:31], s[80:81]
v_max_f32 v56, v56, v24
v_max_f32 v60, v60, v28
v_max_f32 v57, v57, v25
v_max_f32 v61, v61, v29
v_max_f32 v58, v58, v26
v_max_f32 v62, v62, v30
v_max_f32 v59, v59, v27
v_max_f32 v63, v63, v31
v_cvt_pk_bf16_f32 v56, v56, v57
v_cvt_pk_bf16_f32 v57, v58, v59
v_cvt_pk_bf16_f32 v58, v60, v61
v_cvt_pk_bf16_f32 v59, v62, v63
v_pk_fma_f32 v[80:81], v[144:145], v[12:13], v[80:81] op_sel:[0,0,0] op_sel_hi:[1,0,1]
v_pk_fma_f32 v[84:85], v[148:149], v[12:13], v[84:85] op_sel:[0,0,0] op_sel_hi:[1,0,1]
v_pk_fma_f32 v[82:83], v[146:147], v[12:13], v[82:83] op_sel:[0,0,0] op_sel_hi:[1,0,1]
v_pk_fma_f32 v[86:87], v[150:151], v[12:13], v[86:87] op_sel:[0,0,0] op_sel_hi:[1,0,1]
v_pk_mul_f32 v[24:25], v[80:81], v[4:5] op_sel:[0,0] op_sel_hi:[1,0]
v_pk_mul_f32 v[28:29], v[84:85], v[4:5] op_sel:[0,0] op_sel_hi:[1,0]
v_pk_mul_f32 v[26:27], v[82:83], v[4:5] op_sel:[0,0] op_sel_hi:[1,0]
v_pk_mul_f32 v[30:31], v[86:87], v[4:5] op_sel:[0,0] op_sel_hi:[1,0]
v_pk_fma_f32 v[80:81], v[80:81], v[132:133], s[82:83] op_sel:[0,0,0] op_sel_hi:[1,0,1]
v_pk_fma_f32 v[84:85], v[84:85], v[132:133], s[82:83] op_sel:[0,0,0] op_sel_hi:[1,0,1]
v_pk_fma_f32 v[82:83], v[82:83], v[132:133], s[82:83] op_sel:[0,0,0] op_sel_hi:[1,0,1]
v_pk_fma_f32 v[86:87], v[86:87], v[132:133], s[82:83] op_sel:[0,0,0] op_sel_hi:[1,0,1]
v_exp_f32_e64 v24, v24 clamp
v_exp_f32_e64 v28, v28 clamp
v_exp_f32_e64 v25, v25 clamp
v_exp_f32_e64 v29, v29 clamp
v_exp_f32_e64 v26, v26 clamp
v_exp_f32_e64 v30, v30 clamp
v_exp_f32_e64 v27, v27 clamp
v_exp_f32_e64 v31, v31 clamp
v_pk_add_f32 v[24:25], v[24:25], s[80:81]
v_pk_add_f32 v[28:29], v[28:29], s[80:81]
v_pk_add_f32 v[26:27], v[26:27], s[80:81]
v_pk_add_f32 v[30:31], v[30:31], s[80:81]
v_max_f32 v80, v80, v24
v_max_f32 v84, v84, v28
v_max_f32 v81, v81, v25
v_max_f32 v85, v85, v29
v_max_f32 v82, v82, v26
v_max_f32 v86, v86, v30
v_max_f32 v83, v83, v27
v_max_f32 v87, v87, v31
v_cvt_pk_bf16_f32 v80, v80, v81
v_cvt_pk_bf16_f32 v81, v82, v83
v_cvt_pk_bf16_f32 v82, v84, v85
v_cvt_pk_bf16_f32 v83, v86, v87
v_pk_fma_f32 v[104:105], v[144:145], v[14:15], v[104:105] op_sel:[0,0,0] op_sel_hi:[1,0,1]
v_pk_fma_f32 v[108:109], v[148:149], v[14:15], v[108:109] op_sel:[0,0,0] op_sel_hi:[1,0,1]
v_pk_fma_f32 v[106:107], v[146:147], v[14:15], v[106:107] op_sel:[0,0,0] op_sel_hi:[1,0,1]
v_pk_fma_f32 v[110:111], v[150:151], v[14:15], v[110:111] op_sel:[0,0,0] op_sel_hi:[1,0,1]
v_pk_mul_f32 v[24:25], v[104:105], v[6:7] op_sel:[0,0] op_sel_hi:[1,0]
v_pk_mul_f32 v[28:29], v[108:109], v[6:7] op_sel:[0,0] op_sel_hi:[1,0]
v_pk_mul_f32 v[26:27], v[106:107], v[6:7] op_sel:[0,0] op_sel_hi:[1,0]
v_pk_mul_f32 v[30:31], v[110:111], v[6:7] op_sel:[0,0] op_sel_hi:[1,0]
v_pk_fma_f32 v[104:105], v[104:105], v[134:135], s[82:83] op_sel:[0,0,0] op_sel_hi:[1,0,1]
v_pk_fma_f32 v[108:109], v[108:109], v[134:135], s[82:83] op_sel:[0,0,0] op_sel_hi:[1,0,1]
v_pk_fma_f32 v[106:107], v[106:107], v[134:135], s[82:83] op_sel:[0,0,0] op_sel_hi:[1,0,1]
v_pk_fma_f32 v[110:111], v[110:111], v[134:135], s[82:83] op_sel:[0,0,0] op_sel_hi:[1,0,1]
v_exp_f32_e64 v24, v24 clamp
v_exp_f32_e64 v28, v28 clamp
v_exp_f32_e64 v25, v25 clamp
v_exp_f32_e64 v29, v29 clamp
v_exp_f32_e64 v26, v26 clamp
v_exp_f32_e64 v30, v30 clamp
v_exp_f32_e64 v27, v27 clamp
v_exp_f32_e64 v31, v31 clamp
v_pk_add_f32 v[24:25], v[24:25], s[80:81]
v_pk_add_f32 v[28:29], v[28:29], s[80:81]
v_pk_add_f32 v[26:27], v[26:27], s[80:81]
v_pk_add_f32 v[30:31], v[30:31], s[80:81]
v_max_f32 v104, v104, v24
v_max_f32 v108, v108, v28
v_max_f32 v105, v105, v25
v_max_f32 v109, v109, v29
v_max_f32 v106, v106, v26
v_max_f32 v110, v110, v30
v_max_f32 v107, v107, v27
v_max_f32 v111, v111, v31
v_cvt_pk_bf16_f32 v104, v104, v105
v_cvt_pk_bf16_f32 v105, v106, v107
v_cvt_pk_bf16_f32 v106, v108, v109
v_cvt_pk_bf16_f32 v107, v110, v111
v_lshrrev_b32 v2, 4, v1
v_bfe_u32 v3, v1, 2, 2
v_lshl_add_u32 v4, v2, 2, v3
v_lshlrev_b32 v5, 7, v4
v_bfe_u32 v4, v4, 1, 2
v_lshl_add_u32 v5, v4, 5, v5
v_and_b32 v4, 3, v1
v_lshl_add_u32 v5, v4, 3, v5
v_add_u32 v8, 28672, v5
v_xor_b32 v9, 32, v8
v_xor_b32 v10, 64, v8
v_xor_b32 v11, 96, v8
v_add_u32 v12, 65536, v8
v_add_u32 v13, 65536, v9
v_add_u32 v14, 65536, v10
v_add_u32 v15, 65536, v11
v_and_b32 v3, 15, v1
v_lshrrev_b32 v4, 1, v3
v_lshrrev_b32 v5, 1, v2
v_xor_b32 v4, v4, v5
v_lshlrev_b32 v4, 4, v4
v_lshl_add_u32 v4, v3, 7, v4
v_and_b32 v5, 1, v2
v_lshl_add_u32 v4, v5, 3, v4
s_lshl_b32 s70, s60, 12
v_add_u32 v20, s70, v4
v_xor_b32 v21, 32, v20
v_xor_b32 v22, 64, v20
v_xor_b32 v23, 96, v20
s_lshl_b32 s74, s64, 18
s_lshl_b32 s70, s60, 16
s_add_u32 s74, s74, s70
s_add_u32 s74, s74, 2097152
v_add_u32 v6, s74, v16
v_add_u32 v19, 32768, v6
s_lshl_b32 s74, s89, 11
s_barrier
ds_read_b128 a[0:3], v17
ds_read_b128 a[4:7], v17 offset:1024
ds_read_b128 a[8:11], v18
s_waitcnt lgkmcnt(0)
v_mfma_f32_16x16x32_bf16 v[48:51], a[8:11], v[32:35], 0
v_mfma_f32_16x16x32_bf16 v[40:43], a[0:3], v[32:35], 0
v_mfma_f32_16x16x32_bf16 v[44:47], a[4:7], v[32:35], 0
v_mfma_f32_16x16x32_bf16 v[72:75], a[8:11], v[56:59], 0
v_mfma_f32_16x16x32_bf16 v[64:67], a[0:3], v[56:59], 0
v_mfma_f32_16x16x32_bf16 v[68:71], a[4:7], v[56:59], 0
v_mfma_f32_16x16x32_bf16 v[96:99], a[8:11], v[80:83], 0
v_mfma_f32_16x16x32_bf16 v[88:91], a[0:3], v[80:83], 0
v_mfma_f32_16x16x32_bf16 v[92:95], a[4:7], v[80:83], 0
v_mfma_f32_16x16x32_bf16 v[120:123], a[8:11], v[104:107], 0
v_mfma_f32_16x16x32_bf16 v[112:115], a[0:3], v[104:107], 0
v_mfma_f32_16x16x32_bf16 v[116:119], a[4:7], v[104:107], 0
v_add_f32 v48, s80, v48
v_rcp_f32 v48, v48
s_nop 0
v_pk_mul_f32 v[40:41], v[40:41], v[48:49] op_sel_hi:[1,0]
v_pk_mul_f32 v[42:43], v[42:43], v[48:49] op_sel_hi:[1,0]
v_pk_mul_f32 v[44:45], v[44:45], v[48:49] op_sel_hi:[1,0]
v_pk_mul_f32 v[46:47], v[46:47], v[48:49] op_sel_hi:[1,0]
v_cvt_pk_bf16_f32 v52, v40, v41
v_cvt_pk_bf16_f32 v53, v42, v43
v_cvt_pk_bf16_f32 v54, v44, v45
v_cvt_pk_bf16_f32 v55, v46, v47
s_add_u32 s70, s88, 0
buffer_store_dwordx4 v[52:55], v16, s[12:15], s70 offen sc1
v_add_f32 v72, s80, v72
v_rcp_f32 v72, v72
s_nop 0
v_pk_mul_f32 v[64:65], v[64:65], v[72:73] op_sel_hi:[1,0]
v_pk_mul_f32 v[66:67], v[66:67], v[72:73] op_sel_hi:[1,0]
v_pk_mul_f32 v[68:69], v[68:69], v[72:73] op_sel_hi:[1,0]
v_pk_mul_f32 v[70:71], v[70:71], v[72:73] op_sel_hi:[1,0]
v_cvt_pk_bf16_f32 v76, v64, v65
v_cvt_pk_bf16_f32 v77, v66, v67
v_cvt_pk_bf16_f32 v78, v68, v69
v_cvt_pk_bf16_f32 v79, v70, v71
s_add_u32 s70, s88, 32768
buffer_store_dwordx4 v[76:79], v16, s[12:15], s70 offen sc1
v_add_f32 v96, s80, v96
v_rcp_f32 v96, v96
s_nop 0
v_pk_mul_f32 v[88:89], v[88:89], v[96:97] op_sel_hi:[1,0]
v_pk_mul_f32 v[90:91], v[90:91], v[96:97] op_sel_hi:[1,0]
v_pk_mul_f32 v[92:93], v[92:93], v[96:97] op_sel_hi:[1,0]
v_pk_mul_f32 v[94:95], v[94:95], v[96:97] op_sel_hi:[1,0]
v_cvt_pk_bf16_f32 v100, v88, v89
v_cvt_pk_bf16_f32 v101, v90, v91
v_cvt_pk_bf16_f32 v102, v92, v93
v_cvt_pk_bf16_f32 v103, v94, v95
s_add_u32 s70, s88, 65536
buffer_store_dwordx4 v[100:103], v16, s[12:15], s70 offen sc1
v_add_f32 v120, s80, v120
v_rcp_f32 v120, v120
s_nop 0
v_pk_mul_f32 v[112:113], v[112:113], v[120:121] op_sel_hi:[1,0]
v_pk_mul_f32 v[114:115], v[114:115], v[120:121] op_sel_hi:[1,0]
v_pk_mul_f32 v[116:117], v[116:117], v[120:121] op_sel_hi:[1,0]
v_pk_mul_f32 v[118:119], v[118:119], v[120:121] op_sel_hi:[1,0]
v_cvt_pk_bf16_f32 v124, v112, v113
v_cvt_pk_bf16_f32 v125, v114, v115
v_cvt_pk_bf16_f32 v126, v116, v117
v_cvt_pk_bf16_f32 v127, v118, v119
s_add_u32 s70, s88, 98304
buffer_store_dwordx4 v[124:127], v16, s[12:15], s70 offen sc1
v_xor_b32 v7, s76, v7
ds_read_b64 v[26:27], v20 offset:0
ds_read_b64 v[30:31], v21 offset:0
ds_read_b64 v[34:35], v22 offset:0
ds_read_b64 v[38:39], v23 offset:0
ds_read_b64 v[42:43], v20 offset:2048
ds_read_b64 v[46:47], v21 offset:2048
ds_read_b64 v[50:51], v22 offset:2048
ds_read_b64 v[54:55], v23 offset:2048
s_waitcnt lgkmcnt(0)
ds_read_b64_tr_b16 a[0:1], v8 offset:0
ds_read_b64_tr_b16 a[2:3], v8 offset:2048
ds_read_b64_tr_b16 a[4:5], v9 offset:0
ds_read_b64_tr_b16 a[6:7], v9 offset:2048
ds_read_b64_tr_b16 a[8:9], v10 offset:0
ds_read_b64_tr_b16 a[10:11], v10 offset:2048
ds_read_b64_tr_b16 a[12:13], v11 offset:0
ds_read_b64_tr_b16 a[14:15], v11 offset:2048
ds_read_b64_tr_b16 a[16:17], v8 offset:4096
ds_read_b64_tr_b16 a[18:19], v8 offset:6144
ds_read_b64_tr_b16 a[20:21], v9 offset:4096
ds_read_b64_tr_b16 a[22:23], v9 offset:6144
ds_read_b64_tr_b16 a[24:25], v10 offset:4096
ds_read_b64_tr_b16 a[26:27], v10 offset:6144
ds_read_b64_tr_b16 a[28:29], v11 offset:4096
ds_read_b64_tr_b16 a[30:31], v11 offset:6144
v_lshlrev_b32 v24, 16, v26
v_and_b32 v25, 0xffff0000, v26
v_lshlrev_b32 v26, 16, v27
v_and_b32 v27, 0xffff0000, v27
v_lshlrev_b32 v28, 16, v30
v_and_b32 v29, 0xffff0000, v30
v_lshlrev_b32 v30, 16, v31
v_and_b32 v31, 0xffff0000, v31
v_lshlrev_b32 v32, 16, v34
v_and_b32 v33, 0xffff0000, v34
v_lshlrev_b32 v34, 16, v35
v_and_b32 v35, 0xffff0000, v35
v_lshlrev_b32 v36, 16, v38
v_and_b32 v37, 0xffff0000, v38
v_lshlrev_b32 v38, 16, v39
v_and_b32 v39, 0xffff0000, v39
v_lshlrev_b32 v40, 16, v42
v_and_b32 v41, 0xffff0000, v42
v_lshlrev_b32 v42, 16, v43
v_and_b32 v43, 0xffff0000, v43
v_lshlrev_b32 v44, 16, v46
v_and_b32 v45, 0xffff0000, v46
v_lshlrev_b32 v46, 16, v47
v_and_b32 v47, 0xffff0000, v47
v_lshlrev_b32 v48, 16, v50
v_and_b32 v49, 0xffff0000, v50
v_lshlrev_b32 v50, 16, v51
v_and_b32 v51, 0xffff0000, v51
v_lshlrev_b32 v52, 16, v54
v_and_b32 v53, 0xffff0000, v54
v_lshlrev_b32 v54, 16, v55
v_and_b32 v55, 0xffff0000, v55
v_lshrrev_b32 v2, 4, v1
v_lshlrev_b32 v2, 3, v2
v_add_u32 v2, 162048, v2
v_mov_b32 v3, 162176
ds_read_b64 v[136:137], v2 offset:0
ds_read_b64 v[138:139], v2 offset:32
ds_read_b64 v[140:141], v2 offset:64
ds_read_b64 v[142:143], v2 offset:96
ds_read_b128 v[148:151], v3
s_waitcnt lgkmcnt(0)
v_add_f32 v148, v148, v149
v_add_f32 v150, v150, v151
v_add_f32 v148, v148, v150
s_nop 0
v_readfirstlane_b32 s84, v148
v_and_b32 v2, 3, v1
v_cmp_eq_u32 vcc, 0, v2
v_mov_b32 v3, 0x3f803f80
s_nop 0
v_cndmask_b32 v3, 0, v3, vcc
v_cmp_eq_u32 vcc, 2, v2
s_nop 1
v_cndmask_b32 v120, v3, v136, vcc
v_cndmask_b32 v121, v3, v137, vcc
v_cndmask_b32 v122, v3, v138, vcc
v_cndmask_b32 v123, v3, v139, vcc
v_cndmask_b32 v124, v3, v140, vcc
v_cndmask_b32 v125, v3, v141, vcc
v_cndmask_b32 v126, v3, v142, vcc
v_cndmask_b32 v127, v3, v143, vcc
v_and_b32 v2, 15, v1
v_lshrrev_b32 v3, 5, v1
v_lshlrev_b32 v4, 4, v2
v_mov_b32 v144, v4
s_lshl_b32 s75, s64, 15
s_lshl_b32 s70, s60, 9
s_add_u32 s75, s75, s70
s_add_u32 s75, s75, 6291456
s_lshl_b32 s70, s65, 11
s_add_u32 s72, s75, s70
s_mov_b32 s92, 0x00f0000f
s_mov_b32 s93, 0xf0000f00
s_mov_b32 s80, 0x22222222
s_mov_b32 s81, 0x22222222
s_mov_b32 s82, 0x44444444
s_mov_b32 s83, 0x44444444
s_mov_b32 s90, 0x88888888
s_mov_b32 s91, 0x88888888
v_and_b32 v2, 31, v1
v_lshlrev_b32 v5, 4, v2
v_lshl_add_u32 v145, v3, 11, v5
s_lshl_b32 s70, s64, 7
s_lshl_b32 s71, s60, 5
s_add_u32 s70, s70, s71
s_add_u32 s87, s70, 6815744
s_sub_u32 s70, 2047, s70
v_sub_u32 v146, s70, v2
s_lshl_b32 s70, s64, 2
s_add_u32 s70, s70, s60
s_lshl_b32 s70, s70, 12
s_lshl_b32 s71, s65, 7
s_add_u32 s70, s70, s71
s_branch L_over6
L_pad6:
s_branch L_pad11
L_over6:
s_add_u32 s88, s70, 7864320
v_lshrrev_b32 v2, 3, v1
v_and_b32 v3, 7, v1
v_lshlrev_b32 v147, 11, v2
v_lshl_add_u32 v147, v3, 4, v147
s_waitcnt vmcnt(0)
buffer_load_dwordx4 v[56:59], v6, s[12:15], s74 offen offset:0 sc1
buffer_load_dwordx4 v[60:63], v19, s[12:15], s74 offen offset:0 sc1
buffer_load_dwordx4 v[64:67], v6, s[12:15], s74 offen offset:1024 sc1
buffer_load_dwordx4 v[68:71], v19, s[12:15], s74 offen offset:1024 sc1
s_add_u32 s74, s74, 2048
s_and_b32 s74, s74, 0x7fff
buffer_load_dwordx4 v[72:75], v6, s[12:15], s74 offen offset:0 sc1
buffer_load_dwordx4 v[76:79], v19, s[12:15], s74 offen offset:0 sc1
buffer_load_dwordx4 v[80:83], v6, s[12:15], s74 offen offset:1024 sc1
buffer_load_dwordx4 v[84:87], v19, s[12:15], s74 offen offset:1024 sc1
s_add_u32 s74, s74, 2048
s_and_b32 s74, s74, 0x7fff
buffer_load_dwordx4 v[88:91], v6, s[12:15], s74 offen offset:0 sc1
buffer_load_dwordx4 v[92:95], v19, s[12:15], s74 offen offset:0 sc1
buffer_load_dwordx4 v[96:99], v6, s[12:15], s74 offen offset:1024 sc1
buffer_load_dwordx4 v[100:103], v19, s[12:15], s74 offen offset:1024 sc1
s_add_u32 s74, s74, 2048
s_and_b32 s74, s74, 0x7fff
s_waitcnt vmcnt(8)
L_o0_chk:
v_max3_u32 v2, v56, v60, v64
v_max_u32 v2, v2, v68
v_cmp_eq_u32 vcc, -1, v2
s_cbranch_vccnz L_o0_rt
L_o0_ok:
s_waitcnt lgkmcnt(8)
v_mfma_f32_16x16x32_bf16 v[24:27], a[0:3], v[56:59], v[24:27]
ds_read_b64_tr_b16 a[32:33], v8 offset:8192
buffer_load_dwordx4 v[104:107], v6, s[12:15], s74 offen offset:0 sc1
v_mfma_f32_16x16x32_bf16 v[40:43], a[0:3], v[60:63], v[40:43]
ds_read_b64_tr_b16 a[34:35], v8 offset:10240
buffer_load_dwordx4 v[108:111], v19, s[12:15], s74 offen offset:0 sc1
v_mfma_f32_16x16x32_bf16 v[28:31], a[4:7], v[56:59], v[28:31]
ds_read_b64_tr_b16 a[36:37], v9 offset:8192
v_mfma_f32_16x16x32_bf16 v[44:47], a[4:7], v[60:63], v[44:47]
ds_read_b64_tr_b16 a[38:39], v9 offset:10240
buffer_load_dwordx4 v[112:115], v6, s[12:15], s74 offen offset:1024 sc1
v_mfma_f32_16x16x32_bf16 v[32:35], a[8:11], v[56:59], v[32:35]
ds_read_b64_tr_b16 a[40:41], v10 offset:8192
buffer_load_dwordx4 v[116:119], v19, s[12:15], s74 offen offset:1024 sc1
v_mfma_f32_16x16x32_bf16 v[48:51], a[8:11], v[60:63], v[48:51]
ds_read_b64_tr_b16 a[42:43], v10 offset:10240
v_mfma_f32_16x16x32_bf16 v[36:39], a[12:15], v[56:59], v[36:39]
ds_read_b64_tr_b16 a[44:45], v11 offset:8192
s_add_u32 s74, s74, 2048
v_mfma_f32_16x16x32_bf16 v[52:55], a[12:15], v[60:63], v[52:55]
ds_read_b64_tr_b16 a[46:47], v11 offset:10240
s_waitcnt lgkmcnt(8)
v_mfma_f32_16x16x32_bf16 v[24:27], a[16:19], v[64:67], v[24:27]
ds_read_b64_tr_b16 a[0:1], v8 offset:12288
s_and_b32 s74, s74, 0x7fff
v_mfma_f32_16x16x32_bf16 v[40:43], a[16:19], v[68:71], v[40:43]
ds_read_b64_tr_b16 a[2:3], v8 offset:14336
s_waitcnt vmcnt(8)
v_mfma_f32_16x16x32_bf16 v[28:31], a[20:23], v[64:67], v[28:31]
ds_read_b64_tr_b16 a[4:5], v9 offset:12288
v_mfma_f32_16x16x32_bf16 v[44:47], a[20:23], v[68:71], v[44:47]
ds_read_b64_tr_b16 a[6:7], v9 offset:14336
v_max3_u32 v2, v72, v76, v80
v_mfma_f32_16x16x32_bf16 v[32:35], a[24:27], v[64:67], v[32:35]
ds_read_b64_tr_b16 a[8:9], v10 offset:12288
v_max_u32 v2, v2, v84
v_mfma_f32_16x16x32_bf16 v[48:51], a[24:27], v[68:71], v[48:51]
ds_read_b64_tr_b16 a[10:11], v10 offset:14336
v_mfma_f32_16x16x32_bf16 v[36:39], a[28:31], v[64:67], v[36:39]
ds_read_b64_tr_b16 a[12:13], v11 offset:12288
v_cmp_eq_u32 vcc, -1, v2
v_mfma_f32_16x16x32_bf16 v[52:55], a[28:31], v[68:71], v[52:55]
ds_read_b64_tr_b16 a[14:15], v11 offset:14336
s_cbranch_vccnz L_o1_rt
L_o1_ok:
s_waitcnt lgkmcnt(8)
v_mfma_f32_16x16x32_bf16 v[24:27], a[32:35], v[72:75], v[24:27]
ds_read_b64_tr_b16 a[16:17], v8 offset:16384
buffer_load_dwordx4 v[56:59], v6, s[12:15], s74 offen offset:0 sc1
v_mfma_f32_16x16x32_bf16 v[40:43], a[32:35], v[76:79], v[40:43]
ds_read_b64_tr_b16 a[18:19], v8 offset:18432
buffer_load_dwordx4 v[60:63], v19, s[12:15], s74 offen offset:0 sc1
v_mfma_f32_16x16x32_bf16 v[28:31], a[36:39], v[72:75], v[28:31]
ds_read_b64_tr_b16 a[20:21], v9 offset:16384
v_mfma_f32_16x16x32_bf16 v[44:47], a[36:39], v[76:79], v[44:47]
ds_read_b64_tr_b16 a[22:23], v9 offset:18432
buffer_load_dwordx4 v[64:67], v6, s[12:15], s74 offen offset:1024 sc1
v_mfma_f32_16x16x32_bf16 v[32:35], a[40:43], v[72:75], v[32:35]
ds_read_b64_tr_b16 a[24:25], v10 offset:16384
buffer_load_dwordx4 v[68:71], v19, s[12:15], s74 offen offset:1024 sc1
v_mfma_f32_16x16x32_bf16 v[48:51], a[40:43], v[76:79], v[48:51]
ds_read_b64_tr_b16 a[26:27], v10 offset:18432
v_mfma_f32_16x16x32_bf16 v[36:39], a[44:47], v[72:75], v[36:39]
ds_read_b64_tr_b16 a[28:29], v11 offset:16384
s_add_u32 s74, s74, 2048
v_mfma_f32_16x16x32_bf16 v[52:55], a[44:47], v[76:79], v[52:55]
ds_read_b64_tr_b16 a[30:31], v11 offset:18432
s_waitcnt lgkmcnt(8)
v_mfma_f32_16x16x32_bf16 v[24:27], a[0:3], v[80:83], v[24:27]
ds_read_b64_tr_b16 a[32:33], v8 offset:20480
s_and_b32 s74, s74, 0x7fff
v_mfma_f32_16x16x32_bf16 v[40:43], a[0:3], v[84:87], v[40:43]
ds_read_b64_tr_b16 a[34:35], v8 offset:22528
s_waitcnt vmcnt(8)
v_mfma_f32_16x16x32_bf16 v[28:31], a[4:7], v[80:83], v[28:31]
ds_read_b64_tr_b16 a[36:37], v9 offset:20480
v_mfma_f32_16x16x32_bf16 v[44:47], a[4:7], v[84:87], v[44:47]
ds_read_b64_tr_b16 a[38:39], v9 offset:22528
v_max3_u32 v2, v88, v92, v96
v_mfma_f32_16x16x32_bf16 v[32:35], a[8:11], v[80:83], v[32:35]
ds_read_b64_tr_b16 a[40:41], v10 offset:20480
v_max_u32 v2, v2, v100
v_mfma_f32_16x16x32_bf16 v[48:51], a[8:11], v[84:87], v[48:51]
ds_read_b64_tr_b16 a[42:43], v10 offset:22528
v_mfma_f32_16x16x32_bf16 v[36:39], a[12:15], v[80:83], v[36:39]
ds_read_b64_tr_b16 a[44:45], v11 offset:20480
v_cmp_eq_u32 vcc, -1, v2
v_mfma_f32_16x16x32_bf16 v[52:55], a[12:15], v[84:87], v[52:55]
ds_read_b64_tr_b16 a[46:47], v11 offset:22528
s_cbranch_vccnz L_o2_rt
L_o2_ok:
s_waitcnt lgkmcnt(8)
v_mfma_f32_16x16x32_bf16 v[24:27], a[16:19], v[88:91], v[24:27]
ds_read_b64_tr_b16 a[0:1], v8 offset:24576
buffer_load_dwordx4 v[72:75], v6, s[12:15], s74 offen offset:0 sc1
v_mfma_f32_16x16x32_bf16 v[40:43], a[16:19], v[92:95], v[40:43]
ds_read_b64_tr_b16 a[2:3], v8 offset:26624
buffer_load_dwordx4 v[76:79], v19, s[12:15], s74 offen offset:0 sc1
v_mfma_f32_16x16x32_bf16 v[28:31], a[20:23], v[88:91], v[28:31]
ds_read_b64_tr_b16 a[4:5], v9 offset:24576
v_mfma_f32_16x16x32_bf16 v[44:47], a[20:23], v[92:95], v[44:47]
ds_read_b64_tr_b16 a[6:7], v9 offset:26624
buffer_load_dwordx4 v[80:83], v6, s[12:15], s74 offen offset:1024 sc1
v_mfma_f32_16x16x32_bf16 v[32:35], a[24:27], v[88:91], v[32:35]
ds_read_b64_tr_b16 a[8:9], v10 offset:24576
buffer_load_dwordx4 v[84:87], v19, s[12:15], s74 offen offset:1024 sc1
v_mfma_f32_16x16x32_bf16 v[48:51], a[24:27], v[92:95], v[48:51]
ds_read_b64_tr_b16 a[10:11], v10 offset:26624
v_mfma_f32_16x16x32_bf16 v[36:39], a[28:31], v[88:91], v[36:39]
ds_read_b64_tr_b16 a[12:13], v11 offset:24576
s_add_u32 s74, s74, 2048
v_mfma_f32_16x16x32_bf16 v[52:55], a[28:31], v[92:95], v[52:55]
ds_read_b64_tr_b16 a[14:15], v11 offset:26624
s_waitcnt lgkmcnt(8)
v_mfma_f32_16x16x32_bf16 v[24:27], a[32:35], v[96:99], v[24:27]
ds_read_b64_tr_b16 a[16:17], v8 offset:28672
s_and_b32 s74, s74, 0x7fff
v_mfma_f32_16x16x32_bf16 v[40:43], a[32:35], v[100:103], v[40:43]
ds_read_b64_tr_b16 a[18:19], v8 offset:30720
s_waitcnt vmcnt(8)
v_mfma_f32_16x16x32_bf16 v[28:31], a[36:39], v[96:99], v[28:31]
ds_read_b64_tr_b16 a[20:21], v9 offset:28672
v_mfma_f32_16x16x32_bf16 v[44:47], a[36:39], v[100:103], v[44:47]
ds_read_b64_tr_b16 a[22:23], v9 offset:30720
v_max3_u32 v2, v104, v108, v112
v_mfma_f32_16x16x32_bf16 v[32:35], a[40:43], v[96:99], v[32:35]
ds_read_b64_tr_b16 a[24:25], v10 offset:28672
v_max_u32 v2, v2, v116
v_mfma_f32_16x16x32_bf16 v[48:51], a[40:43], v[100:103], v[48:51]
ds_read_b64_tr_b16 a[26:27], v10 offset:30720
v_mfma_f32_16x16x32_bf16 v[36:39], a[44:47], v[96:99], v[36:39]
ds_read_b64_tr_b16 a[28:29], v11 offset:28672
v_cmp_eq_u32 vcc, -1, v2
v_mfma_f32_16x16x32_bf16 v[52:55], a[44:47], v[100:103], v[52:55]
ds_read_b64_tr_b16 a[30:31], v11 offset:30720
s_cbranch_vccnz L_o3_rt
L_o3_ok:
s_waitcnt lgkmcnt(8)
v_mfma_f32_16x16x32_bf16 v[24:27], a[0:3], v[104:107], v[24:27]
ds_read_b64_tr_b16 a[32:33], v8 offset:32768
buffer_load_dwordx4 v[88:91], v6, s[12:15], s74 offen offset:0 sc1
v_mfma_f32_16x16x32_bf16 v[40:43], a[0:3], v[108:111], v[40:43]
ds_read_b64_tr_b16 a[34:35], v8 offset:34816
buffer_load_dwordx4 v[92:95], v19, s[12:15], s74 offen offset:0 sc1
v_mfma_f32_16x16x32_bf16 v[28:31], a[4:7], v[104:107], v[28:31]
ds_read_b64_tr_b16 a[36:37], v9 offset:32768
v_mfma_f32_16x16x32_bf16 v[44:47], a[4:7], v[108:111], v[44:47]
ds_read_b64_tr_b16 a[38:39], v9 offset:34816
buffer_load_dwordx4 v[96:99], v6, s[12:15], s74 offen offset:1024 sc1
v_mfma_f32_16x16x32_bf16 v[32:35], a[8:11], v[104:107], v[32:35]
ds_read_b64_tr_b16 a[40:41], v10 offset:32768
buffer_load_dwordx4 v[100:103], v19, s[12:15], s74 offen offset:1024 sc1
v_mfma_f32_16x16x32_bf16 v[48:51], a[8:11], v[108:111], v[48:51]
ds_read_b64_tr_b16 a[42:43], v10 offset:34816
v_mfma_f32_16x16x32_bf16 v[36:39], a[12:15], v[104:107], v[36:39]
ds_read_b64_tr_b16 a[44:45], v11 offset:32768
s_add_u32 s74, s74, 2048
v_mfma_f32_16x16x32_bf16 v[52:55], a[12:15], v[108:111], v[52:55]
ds_read_b64_tr_b16 a[46:47], v11 offset:34816
s_waitcnt lgkmcnt(8)
v_mfma_f32_16x16x32_bf16 v[24:27], a[16:19], v[112:115], v[24:27]
ds_read_b64_tr_b16 a[0:1], v8 offset:36864
s_and_b32 s74, s74, 0x7fff
v_mfma_f32_16x16x32_bf16 v[40:43], a[16:19], v[116:119], v[40:43]
ds_read_b64_tr_b16 a[2:3], v8 offset:38912
s_waitcnt vmcnt(8)
v_mfma_f32_16x16x32_bf16 v[28:31], a[20:23], v[112:115], v[28:31]
ds_read_b64_tr_b16 a[4:5], v9 offset:36864
v_mfma_f32_16x16x32_bf16 v[44:47], a[20:23], v[116:119], v[44:47]
ds_read_b64_tr_b16 a[6:7], v9 offset:38912
v_max3_u32 v2, v56, v60, v64
v_mfma_f32_16x16x32_bf16 v[32:35], a[24:27], v[112:115], v[32:35]
ds_read_b64_tr_b16 a[8:9], v10 offset:36864
v_max_u32 v2, v2, v68
v_mfma_f32_16x16x32_bf16 v[48:51], a[24:27], v[116:119], v[48:51]
ds_read_b64_tr_b16 a[10:11], v10 offset:38912
v_mfma_f32_16x16x32_bf16 v[36:39], a[28:31], v[112:115], v[36:39]
ds_read_b64_tr_b16 a[12:13], v11 offset:36864
v_cmp_eq_u32 vcc, -1, v2
v_mfma_f32_16x16x32_bf16 v[52:55], a[28:31], v[116:119], v[52:55]
ds_read_b64_tr_b16 a[14:15], v11 offset:38912
s_cbranch_vccnz L_o4_rt
L_o4_ok:
s_waitcnt lgkmcnt(8)
v_mfma_f32_16x16x32_bf16 v[24:27], a[32:35], v[56:59], v[24:27]
ds_read_b64_tr_b16 a[16:17], v8 offset:40960
buffer_load_dwordx4 v[104:107], v6, s[12:15], s74 offen offset:0 sc1
v_mfma_f32_16x16x32_bf16 v[40:43], a[32:35], v[60:63], v[40:43]
ds_read_b64_tr_b16 a[18:19], v8 offset:43008
buffer_load_dwordx4 v[108:111], v19, s[12:15], s74 offen offset:0 sc1
v_mfma_f32_16x16x32_bf16 v[28:31], a[36:39], v[56:59], v[28:31]
ds_read_b64_tr_b16 a[20:21], v9 offset:40960
v_mfma_f32_16x16x32_bf16 v[44:47], a[36:39], v[60:63], v[44:47]
ds_read_b64_tr_b16 a[22:23], v9 offset:43008
buffer_load_dwordx4 v[112:115], v6, s[12:15], s74 offen offset:1024 sc1
v_mfma_f32_16x16x32_bf16 v[32:35], a[40:43], v[56:59], v[32:35]
ds_read_b64_tr_b16 a[24:25], v10 offset:40960
buffer_load_dwordx4 v[116:119], v19, s[12:15], s74 offen offset:1024 sc1
v_mfma_f32_16x16x32_bf16 v[48:51], a[40:43], v[60:63], v[48:51]
ds_read_b64_tr_b16 a[26:27], v10 offset:43008
v_mfma_f32_16x16x32_bf16 v[36:39], a[44:47], v[56:59], v[36:39]
ds_read_b64_tr_b16 a[28:29], v11 offset:40960
s_add_u32 s74, s74, 2048
v_mfma_f32_16x16x32_bf16 v[52:55], a[44:47], v[60:63], v[52:55]
ds_read_b64_tr_b16 a[30:31], v11 offset:43008
s_waitcnt lgkmcnt(8)
v_mfma_f32_16x16x32_bf16 v[24:27], a[0:3], v[64:67], v[24:27]
ds_read_b64_tr_b16 a[32:33], v8 offset:45056
s_and_b32 s74, s74, 0x7fff
v_mfma_f32_16x16x32_bf16 v[40:43], a[0:3], v[68:71], v[40:43]
ds_read_b64_tr_b16 a[34:35], v8 offset:47104
s_waitcnt vmcnt(8)
v_mfma_f32_16x16x32_bf16 v[28:31], a[4:7], v[64:67], v[28:31]
ds_read_b64_tr_b16 a[36:37], v9 offset:45056
v_mfma_f32_16x16x32_bf16 v[44:47], a[4:7], v[68:71], v[44:47]
ds_read_b64_tr_b16 a[38:39], v9 offset:47104
v_max3_u32 v2, v72, v76, v80
v_mfma_f32_16x16x32_bf16 v[32:35], a[8:11], v[64:67], v[32:35]
ds_read_b64_tr_b16 a[40:41], v10 offset:45056
v_max_u32 v2, v2, v84
v_mfma_f32_16x16x32_bf16 v[48:51], a[8:11], v[68:71], v[48:51]
ds_read_b64_tr_b16 a[42:43], v10 offset:47104
v_mfma_f32_16x16x32_bf16 v[36:39], a[12:15], v[64:67], v[36:39]
ds_read_b64_tr_b16 a[44:45], v11 offset:45056
v_cmp_eq_u32 vcc, -1, v2
v_mfma_f32_16x16x32_bf16 v[52:55], a[12:15], v[68:71], v[52:55]
ds_read_b64_tr_b16 a[46:47], v11 offset:47104
s_cbranch_vccnz L_o5_rt
L_o5_ok:
s_waitcnt lgkmcnt(8)
v_mfma_f32_16x16x32_bf16 v[24:27], a[16:19], v[72:75], v[24:27]
ds_read_b64_tr_b16 a[0:1], v8 offset:49152
buffer_load_dwordx4 v[56:59], v6, s[12:15], s74 offen offset:0 sc1
v_mfma_f32_16x16x32_bf16 v[40:43], a[16:19], v[76:79], v[40:43]
ds_read_b64_tr_b16 a[2:3], v8 offset:51200
buffer_load_dwordx4 v[60:63], v19, s[12:15], s74 offen offset:0 sc1
v_mfma_f32_16x16x32_bf16 v[28:31], a[20:23], v[72:75], v[28:31]
ds_read_b64_tr_b16 a[4:5], v9 offset:49152
v_mfma_f32_16x16x32_bf16 v[44:47], a[20:23], v[76:79], v[44:47]
ds_read_b64_tr_b16 a[6:7], v9 offset:51200
buffer_load_dwordx4 v[64:67], v6, s[12:15], s74 offen offset:1024 sc1
v_mfma_f32_16x16x32_bf16 v[32:35], a[24:27], v[72:75], v[32:35]
ds_read_b64_tr_b16 a[8:9], v10 offset:49152
buffer_load_dwordx4 v[68:71], v19, s[12:15], s74 offen offset:1024 sc1
v_mfma_f32_16x16x32_bf16 v[48:51], a[24:27], v[76:79], v[48:51]
ds_read_b64_tr_b16 a[10:11], v10 offset:51200
v_mfma_f32_16x16x32_bf16 v[36:39], a[28:31], v[72:75], v[36:39]
ds_read_b64_tr_b16 a[12:13], v11 offset:49152
s_add_u32 s74, s74, 2048
v_mfma_f32_16x16x32_bf16 v[52:55], a[28:31], v[76:79], v[52:55]
ds_read_b64_tr_b16 a[14:15], v11 offset:51200
s_waitcnt lgkmcnt(8)
v_mfma_f32_16x16x32_bf16 v[24:27], a[32:35], v[80:83], v[24:27]
ds_read_b64_tr_b16 a[16:17], v8 offset:53248
s_and_b32 s74, s74, 0x7fff
v_mfma_f32_16x16x32_bf16 v[40:43], a[32:35], v[84:87], v[40:43]
ds_read_b64_tr_b16 a[18:19], v8 offset:55296
s_waitcnt vmcnt(8)
v_mfma_f32_16x16x32_bf16 v[28:31], a[36:39], v[80:83], v[28:31]
ds_read_b64_tr_b16 a[20:21], v9 offset:53248
v_mfma_f32_16x16x32_bf16 v[44:47], a[36:39], v[84:87], v[44:47]
ds_read_b64_tr_b16 a[22:23], v9 offset:55296
v_max3_u32 v2, v88, v92, v96
v_mfma_f32_16x16x32_bf16 v[32:35], a[40:43], v[80:83], v[32:35]
ds_read_b64_tr_b16 a[24:25], v10 offset:53248
v_max_u32 v2, v2, v100
v_mfma_f32_16x16x32_bf16 v[48:51], a[40:43], v[84:87], v[48:51]
ds_read_b64_tr_b16 a[26:27], v10 offset:55296
v_mfma_f32_16x16x32_bf16 v[36:39], a[44:47], v[80:83], v[36:39]
ds_read_b64_tr_b16 a[28:29], v11 offset:53248
v_cmp_eq_u32 vcc, -1, v2
v_mfma_f32_16x16x32_bf16 v[52:55], a[44:47], v[84:87], v[52:55]
ds_read_b64_tr_b16 a[30:31], v11 offset:55296
s_cbranch_vccnz L_o6_rt
L_o6_ok:
s_waitcnt lgkmcnt(8)
v_mfma_f32_16x16x32_bf16 v[24:27], a[0:3], v[88:91], v[24:27]
ds_read_b64_tr_b16 a[32:33], v8 offset:57344
buffer_load_dwordx4 v[72:75], v6, s[12:15], s74 offen offset:0 sc1
v_mfma_f32_16x16x32_bf16 v[40:43], a[0:3], v[92:95], v[40:43]
ds_read_b64_tr_b16 a[34:35], v8 offset:59392
buffer_load_dwordx4 v[76:79], v19, s[12:15], s74 offen offset:0 sc1
v_mfma_f32_16x16x32_bf16 v[28:31], a[4:7], v[88:91], v[28:31]
ds_read_b64_tr_b16 a[36:37], v9 offset:57344
v_mfma_f32_16x16x32_bf16 v[44:47], a[4:7], v[92:95], v[44:47]
ds_read_b64_tr_b16 a[38:39], v9 offset:59392
buffer_load_dwordx4 v[80:83], v6, s[12:15], s74 offen offset:1024 sc1
v_mfma_f32_16x16x32_bf16 v[32:35], a[8:11], v[88:91], v[32:35]
ds_read_b64_tr_b16 a[40:41], v10 offset:57344
buffer_load_dwordx4 v[84:87], v19, s[12:15], s74 offen offset:1024 sc1
v_mfma_f32_16x16x32_bf16 v[48:51], a[8:11], v[92:95], v[48:51]
ds_read_b64_tr_b16 a[42:43], v10 offset:59392
v_mfma_f32_16x16x32_bf16 v[36:39], a[12:15], v[88:91], v[36:39]
ds_read_b64_tr_b16 a[44:45], v11 offset:57344
s_add_u32 s74, s74, 2048
v_mfma_f32_16x16x32_bf16 v[52:55], a[12:15], v[92:95], v[52:55]
ds_read_b64_tr_b16 a[46:47], v11 offset:59392
s_waitcnt lgkmcnt(8)
v_mfma_f32_16x16x32_bf16 v[24:27], a[16:19], v[96:99], v[24:27]
ds_read_b64_tr_b16 a[0:1], v8 offset:61440
s_and_b32 s74, s74, 0x7fff
v_mfma_f32_16x16x32_bf16 v[40:43], a[16:19], v[100:103], v[40:43]
ds_read_b64_tr_b16 a[2:3], v8 offset:63488
s_waitcnt vmcnt(8)
v_mfma_f32_16x16x32_bf16 v[28:31], a[20:23], v[96:99], v[28:31]
ds_read_b64_tr_b16 a[4:5], v9 offset:61440
v_mfma_f32_16x16x32_bf16 v[44:47], a[20:23], v[100:103], v[44:47]
ds_read_b64_tr_b16 a[6:7], v9 offset:63488
v_max3_u32 v2, v104, v108, v112
v_mfma_f32_16x16x32_bf16 v[32:35], a[24:27], v[96:99], v[32:35]
ds_read_b64_tr_b16 a[8:9], v10 offset:61440
v_max_u32 v2, v2, v116
v_mfma_f32_16x16x32_bf16 v[48:51], a[24:27], v[100:103], v[48:51]
ds_read_b64_tr_b16 a[10:11], v10 offset:63488
v_mfma_f32_16x16x32_bf16 v[36:39], a[28:31], v[96:99], v[36:39]
ds_read_b64_tr_b16 a[12:13], v11 offset:61440
v_cmp_eq_u32 vcc, -1, v2
v_mfma_f32_16x16x32_bf16 v[52:55], a[28:31], v[100:103], v[52:55]
ds_read_b64_tr_b16 a[14:15], v11 offset:63488
s_cbranch_vccnz L_o7_rt
L_o7_ok:
s_waitcnt lgkmcnt(8)
v_mfma_f32_16x16x32_bf16 v[24:27], a[32:35], v[104:107], v[24:27]
ds_read_b64_tr_b16 a[16:17], v12 offset:0
buffer_load_dwordx4 v[88:91], v6, s[12:15], s74 offen offset:0 sc1
v_mfma_f32_16x16x32_bf16 v[40:43], a[32:35], v[108:111], v[40:43]
ds_read_b64_tr_b16 a[18:19], v12 offset:2048
buffer_load_dwordx4 v[92:95], v19, s[12:15], s74 offen offset:0 sc1
v_mfma_f32_16x16x32_bf16 v[28:31], a[36:39], v[104:107], v[28:31]
ds_read_b64_tr_b16 a[20:21], v13 offset:0
v_mfma_f32_16x16x32_bf16 v[44:47], a[36:39], v[108:111], v[44:47]
ds_read_b64_tr_b16 a[22:23], v13 offset:2048
buffer_load_dwordx4 v[96:99], v6, s[12:15], s74 offen offset:1024 sc1
v_mfma_f32_16x16x32_bf16 v[32:35], a[40:43], v[104:107], v[32:35]
ds_read_b64_tr_b16 a[24:25], v14 offset:0
buffer_load_dwordx4 v[100:103], v19, s[12:15], s74 offen offset:1024 sc1
v_mfma_f32_16x16x32_bf16 v[48:51], a[40:43], v[108:111], v[48:51]
ds_read_b64_tr_b16 a[26:27], v14 offset:2048
v_mfma_f32_16x16x32_bf16 v[36:39], a[44:47], v[104:107], v[36:39]
ds_read_b64_tr_b16 a[28:29], v15 offset:0
s_add_u32 s74, s74, 2048
v_mfma_f32_16x16x32_bf16 v[52:55], a[44:47], v[108:111], v[52:55]
ds_read_b64_tr_b16 a[30:31], v15 offset:2048
s_waitcnt lgkmcnt(8)
v_mfma_f32_16x16x32_bf16 v[24:27], a[0:3], v[112:115], v[24:27]
ds_read_b64_tr_b16 a[32:33], v12 offset:4096
s_and_b32 s74, s74, 0x7fff
v_mfma_f32_16x16x32_bf16 v[40:43], a[0:3], v[116:119], v[40:43]
ds_read_b64_tr_b16 a[34:35], v12 offset:6144
s_waitcnt vmcnt(8)
v_mfma_f32_16x16x32_bf16 v[28:31], a[4:7], v[112:115], v[28:31]
ds_read_b64_tr_b16 a[36:37], v13 offset:4096
v_mfma_f32_16x16x32_bf16 v[44:47], a[4:7], v[116:119], v[44:47]
ds_read_b64_tr_b16 a[38:39], v13 offset:6144
v_max3_u32 v2, v56, v60, v64
v_mfma_f32_16x16x32_bf16 v[32:35], a[8:11], v[112:115], v[32:35]
ds_read_b64_tr_b16 a[40:41], v14 offset:4096
v_max_u32 v2, v2, v68
v_mfma_f32_16x16x32_bf16 v[48:51], a[8:11], v[116:119], v[48:51]
ds_read_b64_tr_b16 a[42:43], v14 offset:6144
v_mfma_f32_16x16x32_bf16 v[36:39], a[12:15], v[112:115], v[36:39]
ds_read_b64_tr_b16 a[44:45], v15 offset:4096
v_cmp_eq_u32 vcc, -1, v2
v_mfma_f32_16x16x32_bf16 v[52:55], a[12:15], v[116:119], v[52:55]
ds_read_b64_tr_b16 a[46:47], v15 offset:6144
s_cbranch_vccnz L_o8_rt
L_o8_ok:
s_waitcnt lgkmcnt(8)
v_mfma_f32_16x16x32_bf16 v[24:27], a[16:19], v[56:59], v[24:27]
ds_read_b64_tr_b16 a[0:1], v12 offset:8192
buffer_load_dwordx4 v[104:107], v6, s[12:15], s74 offen offset:0 sc1
v_mfma_f32_16x16x32_bf16 v[40:43], a[16:19], v[60:63], v[40:43]
ds_read_b64_tr_b16 a[2:3], v12 offset:10240
buffer_load_dwordx4 v[108:111], v19, s[12:15], s74 offen offset:0 sc1
v_mfma_f32_16x16x32_bf16 v[28:31], a[20:23], v[56:59], v[28:31]
ds_read_b64_tr_b16 a[4:5], v13 offset:8192
v_mfma_f32_16x16x32_bf16 v[44:47], a[20:23], v[60:63], v[44:47]
ds_read_b64_tr_b16 a[6:7], v13 offset:10240
buffer_load_dwordx4 v[112:115], v6, s[12:15], s74 offen offset:1024 sc1
v_mfma_f32_16x16x32_bf16 v[32:35], a[24:27], v[56:59], v[32:35]
ds_read_b64_tr_b16 a[8:9], v14 offset:8192
buffer_load_dwordx4 v[116:119], v19, s[12:15], s74 offen offset:1024 sc1
v_mfma_f32_16x16x32_bf16 v[48:51], a[24:27], v[60:63], v[48:51]
ds_read_b64_tr_b16 a[10:11], v14 offset:10240
v_mfma_f32_16x16x32_bf16 v[36:39], a[28:31], v[56:59], v[36:39]
ds_read_b64_tr_b16 a[12:13], v15 offset:8192
s_add_u32 s74, s74, 2048
v_mfma_f32_16x16x32_bf16 v[52:55], a[28:31], v[60:63], v[52:55]
ds_read_b64_tr_b16 a[14:15], v15 offset:10240
s_waitcnt lgkmcnt(8)
v_mfma_f32_16x16x32_bf16 v[24:27], a[32:35], v[64:67], v[24:27]
ds_read_b64_tr_b16 a[16:17], v12 offset:12288
s_and_b32 s74, s74, 0x7fff
v_mfma_f32_16x16x32_bf16 v[40:43], a[32:35], v[68:71], v[40:43]
ds_read_b64_tr_b16 a[18:19], v12 offset:14336
s_waitcnt vmcnt(8)
v_mfma_f32_16x16x32_bf16 v[28:31], a[36:39], v[64:67], v[28:31]
ds_read_b64_tr_b16 a[20:21], v13 offset:12288
v_mfma_f32_16x16x32_bf16 v[44:47], a[36:39], v[68:71], v[44:47]
ds_read_b64_tr_b16 a[22:23], v13 offset:14336
v_max3_u32 v2, v72, v76, v80
v_mfma_f32_16x16x32_bf16 v[32:35], a[40:43], v[64:67], v[32:35]
ds_read_b64_tr_b16 a[24:25], v14 offset:12288
v_max_u32 v2, v2, v84
v_mfma_f32_16x16x32_bf16 v[48:51], a[40:43], v[68:71], v[48:51]
ds_read_b64_tr_b16 a[26:27], v14 offset:14336
v_mfma_f32_16x16x32_bf16 v[36:39], a[44:47], v[64:67], v[36:39]
ds_read_b64_tr_b16 a[28:29], v15 offset:12288
v_cmp_eq_u32 vcc, -1, v2
v_mfma_f32_16x16x32_bf16 v[52:55], a[44:47], v[68:71], v[52:55]
ds_read_b64_tr_b16 a[30:31], v15 offset:14336
s_cbranch_vccnz L_o9_rt
L_o9_ok:
s_waitcnt lgkmcnt(8)
v_mfma_f32_16x16x32_bf16 v[24:27], a[0:3], v[72:75], v[24:27]
ds_read_b64_tr_b16 a[32:33], v12 offset:16384
buffer_load_dwordx4 v[56:59], v6, s[12:15], s74 offen offset:0 sc1
v_mfma_f32_16x16x32_bf16 v[40:43], a[0:3], v[76:79], v[40:43]
ds_read_b64_tr_b16 a[34:35], v12 offset:18432
buffer_load_dwordx4 v[60:63], v19, s[12:15], s74 offen offset:0 sc1
v_mfma_f32_16x16x32_bf16 v[28:31], a[4:7], v[72:75], v[28:31]
ds_read_b64_tr_b16 a[36:37], v13 offset:16384
v_mfma_f32_16x16x32_bf16 v[44:47], a[4:7], v[76:79], v[44:47]
ds_read_b64_tr_b16 a[38:39], v13 offset:18432
buffer_load_dwordx4 v[64:67], v6, s[12:15], s74 offen offset:1024 sc1
v_mfma_f32_16x16x32_bf16 v[32:35], a[8:11], v[72:75], v[32:35]
ds_read_b64_tr_b16 a[40:41], v14 offset:16384
buffer_load_dwordx4 v[68:71], v19, s[12:15], s74 offen offset:1024 sc1
v_mfma_f32_16x16x32_bf16 v[48:51], a[8:11], v[76:79], v[48:51]
ds_read_b64_tr_b16 a[42:43], v14 offset:18432
v_mfma_f32_16x16x32_bf16 v[36:39], a[12:15], v[72:75], v[36:39]
ds_read_b64_tr_b16 a[44:45], v15 offset:16384
s_add_u32 s74, s74, 2048
v_mfma_f32_16x16x32_bf16 v[52:55], a[12:15], v[76:79], v[52:55]
ds_read_b64_tr_b16 a[46:47], v15 offset:18432
s_waitcnt lgkmcnt(8)
v_mfma_f32_16x16x32_bf16 v[24:27], a[16:19], v[80:83], v[24:27]
ds_read_b64_tr_b16 a[0:1], v12 offset:20480
s_and_b32 s74, s74, 0x7fff
v_mfma_f32_16x16x32_bf16 v[40:43], a[16:19], v[84:87], v[40:43]
ds_read_b64_tr_b16 a[2:3], v12 offset:22528
s_waitcnt vmcnt(8)
v_mfma_f32_16x16x32_bf16 v[28:31], a[20:23], v[80:83], v[28:31]
ds_read_b64_tr_b16 a[4:5], v13 offset:20480
v_mfma_f32_16x16x32_bf16 v[44:47], a[20:23], v[84:87], v[44:47]
ds_read_b64_tr_b16 a[6:7], v13 offset:22528
v_max3_u32 v2, v88, v92, v96
v_mfma_f32_16x16x32_bf16 v[32:35], a[24:27], v[80:83], v[32:35]
ds_read_b64_tr_b16 a[8:9], v14 offset:20480
v_max_u32 v2, v2, v100
v_mfma_f32_16x16x32_bf16 v[48:51], a[24:27], v[84:87], v[48:51]
ds_read_b64_tr_b16 a[10:11], v14 offset:22528
v_mfma_f32_16x16x32_bf16 v[36:39], a[28:31], v[80:83], v[36:39]
ds_read_b64_tr_b16 a[12:13], v15 offset:20480
v_cmp_eq_u32 vcc, -1, v2
v_mfma_f32_16x16x32_bf16 v[52:55], a[28:31], v[84:87], v[52:55]
ds_read_b64_tr_b16 a[14:15], v15 offset:22528
s_cbranch_vccnz L_o10_rt
L_o10_ok:
s_waitcnt lgkmcnt(8)
v_mfma_f32_16x16x32_bf16 v[24:27], a[32:35], v[88:91], v[24:27]
ds_read_b64_tr_b16 a[16:17], v12 offset:24576
buffer_load_dwordx4 v[72:75], v6, s[12:15], s74 offen offset:0 sc1
v_mfma_f32_16x16x32_bf16 v[40:43], a[32:35], v[92:95], v[40:43]
ds_read_b64_tr_b16 a[18:19], v12 offset:26624
buffer_load_dwordx4 v[76:79], v19, s[12:15], s74 offen offset:0 sc1
v_mfma_f32_16x16x32_bf16 v[28:31], a[36:39], v[88:91], v[28:31]
ds_read_b64_tr_b16 a[20:21], v13 offset:24576
v_mfma_f32_16x16x32_bf16 v[44:47], a[36:39], v[92:95], v[44:47]
ds_read_b64_tr_b16 a[22:23], v13 offset:26624
buffer_load_dwordx4 v[80:83], v6, s[12:15], s74 offen offset:1024 sc1
v_mfma_f32_16x16x32_bf16 v[32:35], a[40:43], v[88:91], v[32:35]
ds_read_b64_tr_b16 a[24:25], v14 offset:24576
buffer_load_dwordx4 v[84:87], v19, s[12:15], s74 offen offset:1024 sc1
v_mfma_f32_16x16x32_bf16 v[48:51], a[40:43], v[92:95], v[48:51]
ds_read_b64_tr_b16 a[26:27], v14 offset:26624
v_mfma_f32_16x16x32_bf16 v[36:39], a[44:47], v[88:91], v[36:39]
ds_read_b64_tr_b16 a[28:29], v15 offset:24576
s_add_u32 s74, s74, 2048
v_mfma_f32_16x16x32_bf16 v[52:55], a[44:47], v[92:95], v[52:55]
ds_read_b64_tr_b16 a[30:31], v15 offset:26624
s_waitcnt lgkmcnt(8)
v_mfma_f32_16x16x32_bf16 v[24:27], a[0:3], v[96:99], v[24:27]
ds_read_b64_tr_b16 a[32:33], v12 offset:28672
s_and_b32 s74, s74, 0x7fff
v_mfma_f32_16x16x32_bf16 v[40:43], a[0:3], v[100:103], v[40:43]
ds_read_b64_tr_b16 a[34:35], v12 offset:30720
s_waitcnt vmcnt(8)
v_mfma_f32_16x16x32_bf16 v[28:31], a[4:7], v[96:99], v[28:31]
ds_read_b64_tr_b16 a[36:37], v13 offset:28672
v_mfma_f32_16x16x32_bf16 v[44:47], a[4:7], v[100:103], v[44:47]
ds_read_b64_tr_b16 a[38:39], v13 offset:30720
v_max3_u32 v2, v104, v108, v112
v_mfma_f32_16x16x32_bf16 v[32:35], a[8:11], v[96:99], v[32:35]
ds_read_b64_tr_b16 a[40:41], v14 offset:28672
v_max_u32 v2, v2, v116
v_mfma_f32_16x16x32_bf16 v[48:51], a[8:11], v[100:103], v[48:51]
ds_read_b64_tr_b16 a[42:43], v14 offset:30720
v_mfma_f32_16x16x32_bf16 v[36:39], a[12:15], v[96:99], v[36:39]
ds_read_b64_tr_b16 a[44:45], v15 offset:28672
v_cmp_eq_u32 vcc, -1, v2
v_mfma_f32_16x16x32_bf16 v[52:55], a[12:15], v[100:103], v[52:55]
ds_read_b64_tr_b16 a[46:47], v15 offset:30720
s_cbranch_vccnz L_o11_rt
L_o11_ok:
s_waitcnt lgkmcnt(8)
v_mfma_f32_16x16x32_bf16 v[24:27], a[16:19], v[104:107], v[24:27]
ds_read_b64_tr_b16 a[0:1], v12 offset:32768
buffer_load_dwordx4 v[88:91], v6, s[12:15], s74 offen offset:0 sc1
v_mfma_f32_16x16x32_bf16 v[40:43], a[16:19], v[108:111], v[40:43]
ds_read_b64_tr_b16 a[2:3], v12 offset:34816
buffer_load_dwordx4 v[92:95], v19, s[12:15], s74 offen offset:0 sc1
v_mfma_f32_16x16x32_bf16 v[28:31], a[20:23], v[104:107], v[28:31]
ds_read_b64_tr_b16 a[4:5], v13 offset:32768
v_mfma_f32_16x16x32_bf16 v[44:47], a[20:23], v[108:111], v[44:47]
ds_read_b64_tr_b16 a[6:7], v13 offset:34816
buffer_load_dwordx4 v[96:99], v6, s[12:15], s74 offen offset:1024 sc1
v_mfma_f32_16x16x32_bf16 v[32:35], a[24:27], v[104:107], v[32:35]
ds_read_b64_tr_b16 a[8:9], v14 offset:32768
buffer_load_dwordx4 v[100:103], v19, s[12:15], s74 offen offset:1024 sc1
v_mfma_f32_16x16x32_bf16 v[48:51], a[24:27], v[108:111], v[48:51]
ds_read_b64_tr_b16 a[10:11], v14 offset:34816
v_mfma_f32_16x16x32_bf16 v[36:39], a[28:31], v[104:107], v[36:39]
ds_read_b64_tr_b16 a[12:13], v15 offset:32768
s_add_u32 s74, s74, 2048
v_mfma_f32_16x16x32_bf16 v[52:55], a[28:31], v[108:111], v[52:55]
ds_read_b64_tr_b16 a[14:15], v15 offset:34816
s_waitcnt lgkmcnt(8)
v_mfma_f32_16x16x32_bf16 v[24:27], a[32:35], v[112:115], v[24:27]
ds_read_b64_tr_b16 a[16:17], v12 offset:36864
s_branch L_over7
L_pad7:
s_branch L_pad12
L_over7:
s_and_b32 s74, s74, 0x7fff
v_mfma_f32_16x16x32_bf16 v[40:43], a[32:35], v[116:119], v[40:43]
ds_read_b64_tr_b16 a[18:19], v12 offset:38912
s_waitcnt vmcnt(8)
v_mfma_f32_16x16x32_bf16 v[28:31], a[36:39], v[112:115], v[28:31]
ds_read_b64_tr_b16 a[20:21], v13 offset:36864
v_mfma_f32_16x16x32_bf16 v[44:47], a[36:39], v[116:119], v[44:47]
ds_read_b64_tr_b16 a[22:23], v13 offset:38912
v_max3_u32 v2, v56, v60, v64
v_mfma_f32_16x16x32_bf16 v[32:35], a[40:43], v[112:115], v[32:35]
ds_read_b64_tr_b16 a[24:25], v14 offset:36864
v_max_u32 v2, v2, v68
v_mfma_f32_16x16x32_bf16 v[48:51], a[40:43], v[116:119], v[48:51]
ds_read_b64_tr_b16 a[26:27], v14 offset:38912
v_mfma_f32_16x16x32_bf16 v[36:39], a[44:47], v[112:115], v[36:39]
ds_read_b64_tr_b16 a[28:29], v15 offset:36864
v_cmp_eq_u32 vcc, -1, v2
v_mfma_f32_16x16x32_bf16 v[52:55], a[44:47], v[116:119], v[52:55]
ds_read_b64_tr_b16 a[30:31], v15 offset:38912
s_cbranch_vccnz L_o12_rt
L_o12_ok:
s_waitcnt lgkmcnt(8)
v_mfma_f32_16x16x32_bf16 v[24:27], a[0:3], v[56:59], v[24:27]
ds_read_b64_tr_b16 a[32:33], v12 offset:40960
buffer_load_dwordx4 v[104:107], v6, s[12:15], s74 offen offset:0 sc1
v_mfma_f32_16x16x32_bf16 v[40:43], a[0:3], v[60:63], v[40:43]
ds_read_b64_tr_b16 a[34:35], v12 offset:43008
v_mfma_f32_16x16x32_bf16 v[28:31], a[4:7], v[56:59], v[28:31]
ds_read_b64_tr_b16 a[36:37], v13 offset:40960
buffer_load_dwordx4 v[108:111], v19, s[12:15], s74 offen offset:0 sc1
v_mfma_f32_16x16x32_bf16 v[44:47], a[4:7], v[60:63], v[44:47]
ds_read_b64_tr_b16 a[38:39], v13 offset:43008
v_mfma_f32_16x16x32_bf16 v[32:35], a[8:11], v[56:59], v[32:35]
ds_read_b64_tr_b16 a[40:41], v14 offset:40960
buffer_load_dwordx4 v[112:115], v6, s[12:15], s74 offen offset:1024 sc1
v_mfma_f32_16x16x32_bf16 v[48:51], a[8:11], v[60:63], v[48:51]
ds_read_b64_tr_b16 a[42:43], v14 offset:43008
v_mfma_f32_16x16x32_bf16 v[36:39], a[12:15], v[56:59], v[36:39]
ds_read_b64_tr_b16 a[44:45], v15 offset:40960
buffer_load_dwordx4 v[116:119], v19, s[12:15], s74 offen offset:1024 sc1
v_mfma_f32_16x16x32_bf16 v[52:55], a[12:15], v[60:63], v[52:55]
ds_read_b64_tr_b16 a[46:47], v15 offset:43008
s_waitcnt lgkmcnt(8)
v_mfma_f32_16x16x32_bf16 v[24:27], a[16:19], v[64:67], v[24:27]
ds_read_b64_tr_b16 a[0:1], v12 offset:45056
s_waitcnt vmcnt(8)
v_mfma_f32_16x16x32_bf16 v[40:43], a[16:19], v[68:71], v[40:43]
ds_read_b64_tr_b16 a[2:3], v12 offset:47104
v_mfma_f32_16x16x32_bf16 v[28:31], a[20:23], v[64:67], v[28:31]
ds_read_b64_tr_b16 a[4:5], v13 offset:45056
v_max3_u32 v2, v72, v76, v80
v_mfma_f32_16x16x32_bf16 v[44:47], a[20:23], v[68:71], v[44:47]
ds_read_b64_tr_b16 a[6:7], v13 offset:47104
v_mfma_f32_16x16x32_bf16 v[32:35], a[24:27], v[64:67], v[32:35]
ds_read_b64_tr_b16 a[8:9], v14 offset:45056
v_max_u32 v2, v2, v84
v_mfma_f32_16x16x32_bf16 v[48:51], a[24:27], v[68:71], v[48:51]
ds_read_b64_tr_b16 a[10:11], v14 offset:47104
v_mfma_f32_16x16x32_bf16 v[36:39], a[28:31], v[64:67], v[36:39]
ds_read_b64_tr_b16 a[12:13], v15 offset:45056
v_cmp_eq_u32 vcc, -1, v2
v_mfma_f32_16x16x32_bf16 v[52:55], a[28:31], v[68:71], v[52:55]
ds_read_b64_tr_b16 a[14:15], v15 offset:47104
s_cbranch_vccnz L_o13_rt
L_o13_ok:
s_waitcnt lgkmcnt(8)
v_mfma_f32_16x16x32_bf16 v[24:27], a[32:35], v[72:75], v[24:27]
ds_read_b64_tr_b16 a[16:17], v12 offset:49152
s_waitcnt vmcnt(4)
v_mfma_f32_16x16x32_bf16 v[40:43], a[32:35], v[76:79], v[40:43]
ds_read_b64_tr_b16 a[18:19], v12 offset:51200
v_mfma_f32_16x16x32_bf16 v[28:31], a[36:39], v[72:75], v[28:31]
ds_read_b64_tr_b16 a[20:21], v13 offset:49152
v_mfma_f32_16x16x32_bf16 v[44:47], a[36:39], v[76:79], v[44:47]
ds_read_b64_tr_b16 a[22:23], v13 offset:51200
v_mfma_f32_16x16x32_bf16 v[32:35], a[40:43], v[72:75], v[32:35]
ds_read_b64_tr_b16 a[24:25], v14 offset:49152
v_max3_u32 v2, v88, v92, v96
v_mfma_f32_16x16x32_bf16 v[48:51], a[40:43], v[76:79], v[48:51]
ds_read_b64_tr_b16 a[26:27], v14 offset:51200
v_mfma_f32_16x16x32_bf16 v[36:39], a[44:47], v[72:75], v[36:39]
ds_read_b64_tr_b16 a[28:29], v15 offset:49152
v_mfma_f32_16x16x32_bf16 v[52:55], a[44:47], v[76:79], v[52:55]
ds_read_b64_tr_b16 a[30:31], v15 offset:51200
s_waitcnt lgkmcnt(8)
v_mfma_f32_16x16x32_bf16 v[24:27], a[0:3], v[80:83], v[24:27]
ds_read_b64_tr_b16 a[32:33], v12 offset:53248
v_max_u32 v2, v2, v100
v_mfma_f32_16x16x32_bf16 v[40:43], a[0:3], v[84:87], v[40:43]
ds_read_b64_tr_b16 a[34:35], v12 offset:55296
v_mfma_f32_16x16x32_bf16 v[28:31], a[4:7], v[80:83], v[28:31]
ds_read_b64_tr_b16 a[36:37], v13 offset:53248
v_mfma_f32_16x16x32_bf16 v[44:47], a[4:7], v[84:87], v[44:47]
ds_read_b64_tr_b16 a[38:39], v13 offset:55296
v_mfma_f32_16x16x32_bf16 v[32:35], a[8:11], v[80:83], v[32:35]
ds_read_b64_tr_b16 a[40:41], v14 offset:53248
v_cmp_eq_u32 vcc, -1, v2
v_mfma_f32_16x16x32_bf16 v[48:51], a[8:11], v[84:87], v[48:51]
ds_read_b64_tr_b16 a[42:43], v14 offset:55296
v_mfma_f32_16x16x32_bf16 v[36:39], a[12:15], v[80:83], v[36:39]
ds_read_b64_tr_b16 a[44:45], v15 offset:53248
v_mfma_f32_16x16x32_bf16 v[52:55], a[12:15], v[84:87], v[52:55]
ds_read_b64_tr_b16 a[46:47], v15 offset:55296
s_cbranch_vccnz L_o14_rt
L_o14_ok:
s_waitcnt lgkmcnt(8)
v_mfma_f32_16x16x32_bf16 v[24:27], a[16:19], v[88:91], v[24:27]
ds_read_b64_tr_b16 a[0:1], v12 offset:57344
s_waitcnt vmcnt(0)
v_mfma_f32_16x16x32_bf16 v[40:43], a[16:19], v[92:95], v[40:43]
ds_read_b64_tr_b16 a[2:3], v12 offset:59392
v_mfma_f32_16x16x32_bf16 v[28:31], a[20:23], v[88:91], v[28:31]
ds_read_b64_tr_b16 a[4:5], v13 offset:57344
v_mfma_f32_16x16x32_bf16 v[44:47], a[20:23], v[92:95], v[44:47]
ds_read_b64_tr_b16 a[6:7], v13 offset:59392
v_mfma_f32_16x16x32_bf16 v[32:35], a[24:27], v[88:91], v[32:35]
ds_read_b64_tr_b16 a[8:9], v14 offset:57344
v_max3_u32 v2, v104, v108, v112
v_mfma_f32_16x16x32_bf16 v[48:51], a[24:27], v[92:95], v[48:51]
ds_read_b64_tr_b16 a[10:11], v14 offset:59392
v_mfma_f32_16x16x32_bf16 v[36:39], a[28:31], v[88:91], v[36:39]
ds_read_b64_tr_b16 a[12:13], v15 offset:57344
v_mfma_f32_16x16x32_bf16 v[52:55], a[28:31], v[92:95], v[52:55]
ds_read_b64_tr_b16 a[14:15], v15 offset:59392
s_waitcnt lgkmcnt(8)
v_mfma_f32_16x16x32_bf16 v[24:27], a[32:35], v[96:99], v[24:27]
ds_read_b64_tr_b16 a[16:17], v12 offset:61440
v_max_u32 v2, v2, v116
v_mfma_f32_16x16x32_bf16 v[40:43], a[32:35], v[100:103], v[40:43]
ds_read_b64_tr_b16 a[18:19], v12 offset:63488
v_mfma_f32_16x16x32_bf16 v[28:31], a[36:39], v[96:99], v[28:31]
ds_read_b64_tr_b16 a[20:21], v13 offset:61440
v_mfma_f32_16x16x32_bf16 v[44:47], a[36:39], v[100:103], v[44:47]
ds_read_b64_tr_b16 a[22:23], v13 offset:63488
v_mfma_f32_16x16x32_bf16 v[32:35], a[40:43], v[96:99], v[32:35]
ds_read_b64_tr_b16 a[24:25], v14 offset:61440
v_cmp_eq_u32 vcc, -1, v2
v_mfma_f32_16x16x32_bf16 v[48:51], a[40:43], v[100:103], v[48:51]
ds_read_b64_tr_b16 a[26:27], v14 offset:63488
v_mfma_f32_16x16x32_bf16 v[36:39], a[44:47], v[96:99], v[36:39]
ds_read_b64_tr_b16 a[28:29], v15 offset:61440
v_mfma_f32_16x16x32_bf16 v[52:55], a[44:47], v[100:103], v[52:55]
ds_read_b64_tr_b16 a[30:31], v15 offset:63488
s_cbranch_vccnz L_o15_rt
L_o15_ok:
s_waitcnt lgkmcnt(8)
v_mfma_f32_16x16x32_bf16 v[24:27], a[0:3], v[104:107], v[24:27]
v_mfma_f32_16x16x32_bf16 v[40:43], a[0:3], v[108:111], v[40:43]
v_mfma_f32_16x16x32_bf16 v[28:31], a[4:7], v[104:107], v[28:31]
v_mfma_f32_16x16x32_bf16 v[44:47], a[4:7], v[108:111], v[44:47]
v_mfma_f32_16x16x32_bf16 v[32:35], a[8:11], v[104:107], v[32:35]
v_mfma_f32_16x16x32_bf16 v[48:51], a[8:11], v[108:111], v[48:51]
v_mfma_f32_16x16x32_bf16 v[36:39], a[12:15], v[104:107], v[36:39]
v_mfma_f32_16x16x32_bf16 v[52:55], a[12:15], v[108:111], v[52:55]
s_waitcnt lgkmcnt(0)
v_mfma_f32_16x16x32_bf16 v[24:27], a[16:19], v[112:115], v[24:27]
v_mfma_f32_16x16x32_bf16 v[40:43], a[16:19], v[116:119], v[40:43]
v_mfma_f32_16x16x32_bf16 v[28:31], a[20:23], v[112:115], v[28:31]
v_mfma_f32_16x16x32_bf16 v[44:47], a[20:23], v[116:119], v[44:47]
v_mfma_f32_16x16x32_bf16 v[32:35], a[24:27], v[112:115], v[32:35]
v_mfma_f32_16x16x32_bf16 v[48:51], a[24:27], v[116:119], v[48:51]
v_mfma_f32_16x16x32_bf16 v[36:39], a[28:31], v[112:115], v[36:39]
v_mfma_f32_16x16x32_bf16 v[52:55], a[28:31], v[116:119], v[52:55]
s_nop 0
v_cvt_pk_bf16_f32 v128, v24, v25
v_cvt_pk_bf16_f32 v129, v26, v27
v_cvt_pk_bf16_f32 v130, v28, v29
v_cvt_pk_bf16_f32 v131, v30, v31
v_cvt_pk_bf16_f32 v132, v32, v33
v_cvt_pk_bf16_f32 v133, v34, v35
v_cvt_pk_bf16_f32 v134, v36, v37
v_cvt_pk_bf16_f32 v135, v38, v39
v_cvt_pk_bf16_f32 v136, v40, v41
v_cvt_pk_bf16_f32 v137, v42, v43
v_cvt_pk_bf16_f32 v138, v44, v45
v_cvt_pk_bf16_f32 v139, v46, v47
v_cvt_pk_bf16_f32 v140, v48, v49
v_cvt_pk_bf16_f32 v141, v50, v51
v_cvt_pk_bf16_f32 v142, v52, v53
v_cvt_pk_bf16_f32 v143, v54, v55
v_mfma_f32_16x16x32_bf16 v[80:83], v[128:131], v[128:131], 0
v_mfma_f32_16x16x32_bf16 v[72:75], v[120:123], v[128:131], 0
v_mfma_f32_16x16x32_bf16 v[80:83], v[132:135], v[132:135], v[80:83]
v_mfma_f32_16x16x32_bf16 v[72:75], v[124:127], v[132:135], v[72:75]
v_mfma_f32_16x16x32_bf16 v[84:87], v[136:139], v[136:139], 0
v_mfma_f32_16x16x32_bf16 v[76:79], v[120:123], v[136:139], 0
v_mfma_f32_16x16x32_bf16 v[84:87], v[140:143], v[140:143], v[84:87]
v_mfma_f32_16x16x32_bf16 v[76:79], v[124:127], v[140:143], v[76:79]
s_nop 2
v_cndmask_b32_e64 v80, v80, v81, s[80:81]
v_cndmask_b32_e64 v82, v82, v83, s[90:91]
s_or_b64 vcc, s[82:83], s[90:91]
v_mov_b32 v75, s68
v_cndmask_b32 v73, v80, v82, vcc
v_cndmask_b32_e64 v84, v84, v85, s[80:81]
v_cndmask_b32_e64 v86, v86, v87, s[90:91]
s_or_b64 vcc, s[82:83], s[90:91]
v_mov_b32 v79, s68
v_cndmask_b32 v77, v84, v86, vcc
s_mov_b64 exec, s[92:93]
s_cmp_eq_u32 s69, 0
s_cbranch_scc1 L_stp_s
buffer_store_dwordx4 v[72:75], v144, s[12:15], s72 offen offset:0
buffer_store_dwordx4 v[76:79], v144, s[12:15], s72 offen offset:256
L_stp_d:
s_mov_b64 exec, -1
s_add_u32 s70, s75, 0
buffer_load_dwordx4 v[96:99], v145, s[12:15], s70 offen sc1
s_add_u32 s70, s75, 4096
buffer_load_dwordx4 v[100:103], v145, s[12:15], s70 offen sc1
s_add_u32 s70, s75, 8192
buffer_load_dwordx4 v[104:107], v145, s[12:15], s70 offen sc1
s_add_u32 s70, s75, 12288
buffer_load_dwordx4 v[108:111], v145, s[12:15], s70 offen sc1
s_add_u32 s70, s75, 16384
buffer_load_dwordx4 v[112:115], v145, s[12:15], s70 offen sc1
s_add_u32 s70, s75, 20480
buffer_load_dwordx4 v[116:119], v145, s[12:15], s70 offen sc1
s_add_u32 s70, s75, 24576
buffer_load_dwordx4 v[120:123], v145, s[12:15], s70 offen sc1
s_add_u32 s70, s75, 28672
buffer_load_dwordx4 v[124:127], v145, s[12:15], s70 offen sc1
s_barrier
ds_write_b64 v20, v[128:129] offset:0
ds_write_b64 v21, v[130:131] offset:0
ds_write_b64 v22, v[132:133] offset:0
ds_write_b64 v23, v[134:135] offset:0
ds_write_b64 v20, v[136:137] offset:2048
ds_write_b64 v21, v[138:139] offset:2048
ds_write_b64 v22, v[140:141] offset:2048
ds_write_b64 v23, v[142:143] offset:2048
v_lshrrev_b32 v2, 3, v1
v_lshrrev_b32 v3, 4, v1
v_and_b32 v13, 7, v1
v_xor_b32 v3, v3, v13
v_lshlrev_b32 v3, 4, v3
v_lshl_add_u32 v3, v2, 7, v3
s_lshl_b32 s70, s60, 12
v_add_u32 v9, s70, v3
v_xor_b32 v10, 64, v9
v_lshlrev_b32 v11, 11, v2
v_lshl_add_u32 v11, v13, 4, v11
s_lshl_b32 s70, s60, 5
v_add_u32 v12, s70, v2
s_lshl_b32 s74, s64, 18
s_lshl_b32 s70, s60, 16
s_add_u32 s74, s74, s70
s_lshl_b32 s70, s65, 7
s_add_u32 s74, s74, s70
s_mov_b32 s80, 0xff00ff00
s_mov_b32 s81, 0xff00ff00
s_lshl_b32 s70, s60, 5
s_add_u32 s70, s70, 161920
v_mov_b32 v14, s70
v_add_u32 v15, 16, v14
v_add_u32 v8, 161920, v16
v_lshlrev_b32 v8, 4, v13
v_add_u32 v8, 161920, v8
s_waitcnt vmcnt(0)
L_st_chk:
v_xor_b32 v88, s68, v99
v_xor_b32 v89, s68, v103
v_xor_b32 v90, s68, v107
v_xor_b32 v91, s68, v111
v_xor_b32 v92, s68, v115
v_xor_b32 v93, s68, v119
v_xor_b32 v94, s68, v123
v_xor_b32 v95, s68, v127
v_or3_b32 v88, v88, v89, v90
v_or3_b32 v91, v91, v92, v93
v_or3_b32 v88, v88, v94, v95
v_or_b32 v88, v88, v91
v_cmp_ne_u32 vcc, 0, v88
s_cbranch_vccnz L_st_rt
L_st_ok:
v_pk_add_f32 v[96:97], v[96:97], v[100:101]
v_add_f32 v98, v98, v102
v_pk_add_f32 v[104:105], v[104:105], v[108:109]
v_add_f32 v106, v106, v110
v_pk_add_f32 v[112:113], v[112:113], v[116:117]
v_add_f32 v114, v114, v118
v_pk_add_f32 v[120:121], v[120:121], v[124:125]
v_add_f32 v122, v122, v126
v_pk_add_f32 v[96:97], v[96:97], v[104:105]
v_add_f32 v98, v98, v106
v_pk_add_f32 v[112:113], v[112:113], v[120:121]
v_add_f32 v114, v114, v122
v_pk_add_f32 v[96:97], v[96:97], v[112:113]
v_add_f32 v98, v98, v114
v_mov_b32 v100, v96
v_mov_b32 v101, v97
v_mov_b32 v102, v98
v_permlane32_swap_b32 v96, v100
v_permlane32_swap_b32 v97, v101
v_permlane32_swap_b32 v98, v102
v_add_f32 v96, v96, v100
v_add_f32 v97, v97, v101
v_add_f32 v98, v98, v102
v_mul_f32 v73, 0x3a800000, v96
v_mul_f32 v97, 0x3a800000, v97
v_fma_f32 v97, -v73, v73, v97
v_fma_f32 v98, -v73, s84, v98
v_max_f32 v97, 0, v97
v_add_f32 v97, 0x3727c5ac, v97
v_rsq_f32 v74, v97
v_mov_b32 v75, s68
v_mul_f32 v98, v98, v74
v_ashrrev_i32 v99, 31, v98
v_or_b32 v99, 0x80000000, v99
v_xor_b32 v98, v98, v99
s_mov_b32 s70, 0xfffff800
v_and_or_b32 v72, v98, s70, v146
s_nop 1
v_mov_b32_dpp v78, v72 row_ror:1 row_mask:0xf bank_mask:0xf
v_max_u32 v76, v72, v78
v_min_u32 v77, v72, v78
s_nop 0
v_mov_b32_dpp v78, v76 row_ror:2 row_mask:0xf bank_mask:0xf
v_max_u32_dpp v79, v77, v77 row_ror:2 row_mask:0xf bank_mask:0xf
v_med3_u32 v77, v76, v78, v79
v_max_u32 v76, v76, v78
s_nop 1
v_mov_b32_dpp v78, v76 row_ror:4 row_mask:0xf bank_mask:0xf
v_max_u32_dpp v79, v77, v77 row_ror:4 row_mask:0xf bank_mask:0xf
v_med3_u32 v77, v76, v78, v79
v_max_u32 v76, v76, v78
s_nop 1
v_mov_b32_dpp v78, v76 row_ror:8 row_mask:0xf bank_mask:0xf
v_max_u32_dpp v79, v77, v77 row_ror:8 row_mask:0xf bank_mask:0xf
v_med3_u32 v77, v76, v78, v79
v_max_u32 v76, v76, v78
v_mov_b32 v78, v76
v_mov_b32 v79, v77
s_nop 0
v_permlane16_swap_b32 v76, v78
v_permlane16_swap_b32 v77, v79
v_max_u32 v79, v77, v79
v_med3_u32 v77, v76, v78, v79
v_max_u32 v76, v76, v78
v_cmp_eq_u32 vcc, v72, v77
v_cmp_eq_u32_e64 s[92:93], v72, v76
s_nop 0
v_cndmask_b32 v2, v14, v15, vcc
s_or_b64 exec, vcc, s[92:93]
ds_write_b128 v2, v[72:75]
s_mov_b64 exec, -1
v_cndmask_b32_e64 v5, v76, v77, s[80:81]
v_not_b32 v5, v5
v_bfe_u32 v6, v5, 1, 3
v_and_b32 v5, 127, v5
v_xor_b32 v6, v6, v13
v_lshlrev_b32 v6, 4, v6
v_lshl_add_u32 v6, v5, 7, v6
ds_read_b128 v[88:91], v6
v_readfirstlane_b32 s86, v77
v_readfirstlane_b32 s85, v76
v_add_f32 v80, 1.0, v74
v_mul_f32_e64 v56, -v73, v74
v_mov_b32 v82, v80
v_mov_b32 v58, v56
s_nop 0
v_permlane16_swap_b32 v80, v82
v_permlane16_swap_b32 v56, v58
s_waitcnt lgkmcnt(1)
s_barrier
s_sub_u32 s70, s64, s65
s_or_b32 s70, s70, s60
s_cbranch_scc1 L_norec
ds_read_b128 v[92:95], v8
s_waitcnt lgkmcnt(0)
buffer_store_dwordx4 v[92:95], v11, s[12:15], s87 offen sc1
L_norec:
s_mov_b64 exec, 0xffff
s_waitcnt lgkmcnt(0)
buffer_store_dwordx4 v[88:91], v147, s[12:15], s88 offen sc1
s_mov_b64 exec, -1
s_not_b32 s95, s86
s_and_b32 s95, s95, 127
s_not_b32 s94, s85
s_and_b32 s94, s94, 127
v_pk_fma_f32 v[24:25], v[24:25], v[80:81], v[56:57] op_sel_hi:[1,0,0]
v_pk_fma_f32 v[26:27], v[26:27], v[80:81], v[56:57] op_sel_hi:[1,0,0]
v_cvt_pk_bf16_f32 v128, v24, v25
v_cvt_pk_bf16_f32 v129, v26, v27
ds_write_b64 v20, v[128:129] offset:32768
v_pk_fma_f32 v[28:29], v[28:29], v[80:81], v[56:57] op_sel_hi:[1,0,0]
v_pk_fma_f32 v[30:31], v[30:31], v[80:81], v[56:57] op_sel_hi:[1,0,0]
v_cvt_pk_bf16_f32 v130, v28, v29
v_cvt_pk_bf16_f32 v131, v30, v31
ds_write_b64 v21, v[130:131] offset:32768
v_pk_fma_f32 v[32:33], v[32:33], v[80:81], v[56:57] op_sel_hi:[1,0,0]
v_pk_fma_f32 v[34:35], v[34:35], v[80:81], v[56:57] op_sel_hi:[1,0,0]
v_cvt_pk_bf16_f32 v132, v32, v33
v_cvt_pk_bf16_f32 v133, v34, v35
ds_write_b64 v22, v[132:133] offset:32768
v_pk_fma_f32 v[36:37], v[36:37], v[80:81], v[56:57] op_sel_hi:[1,0,0]
v_pk_fma_f32 v[38:39], v[38:39], v[80:81], v[56:57] op_sel_hi:[1,0,0]
v_cvt_pk_bf16_f32 v134, v36, v37
v_cvt_pk_bf16_f32 v135, v38, v39
ds_write_b64 v23, v[134:135] offset:32768
v_pk_fma_f32 v[40:41], v[40:41], v[82:83], v[58:59] op_sel_hi:[1,0,0]
v_pk_fma_f32 v[42:43], v[42:43], v[82:83], v[58:59] op_sel_hi:[1,0,0]
v_cvt_pk_bf16_f32 v136, v40, v41
v_cvt_pk_bf16_f32 v137, v42, v43
ds_write_b64 v20, v[136:137] offset:34816
v_pk_fma_f32 v[44:45], v[44:45], v[82:83], v[58:59] op_sel_hi:[1,0,0]
v_pk_fma_f32 v[46:47], v[46:47], v[82:83], v[58:59] op_sel_hi:[1,0,0]
v_cvt_pk_bf16_f32 v138, v44, v45
v_cvt_pk_bf16_f32 v139, v46, v47
ds_write_b64 v21, v[138:139] offset:34816
v_pk_fma_f32 v[48:49], v[48:49], v[82:83], v[58:59] op_sel_hi:[1,0,0]
v_pk_fma_f32 v[50:51], v[50:51], v[82:83], v[58:59] op_sel_hi:[1,0,0]
v_cvt_pk_bf16_f32 v140, v48, v49
v_cvt_pk_bf16_f32 v141, v50, v51
ds_write_b64 v22, v[140:141] offset:34816
v_pk_fma_f32 v[52:53], v[52:53], v[82:83], v[58:59] op_sel_hi:[1,0,0]
v_pk_fma_f32 v[54:55], v[54:55], v[82:83], v[58:59] op_sel_hi:[1,0,0]
v_cvt_pk_bf16_f32 v142, v52, v53
v_cvt_pk_bf16_f32 v143, v54, v55
ds_write_b64 v23, v[142:143] offset:34816
s_waitcnt lgkmcnt(0)
ds_read_b128 v[96:99], v9 offset:32768
ds_read_b128 v[100:103], v10 offset:33792
ds_read_b128 v[104:107], v9 offset:34816
ds_read_b128 v[108:111], v10 offset:35840
v_add_u32 v2, 0, v12
v_cmp_ne_u32 vcc, s94, v2
v_cmp_ne_u32_e64 s[92:93], s95, v2
s_add_u32 s70, s74, 0
s_waitcnt lgkmcnt(3)
s_and_b64 exec, vcc, s[92:93]
buffer_store_dwordx4 v[96:99], v11, s[20:23], s70 offen nt
s_mov_b64 exec, -1
v_add_u32 v2, 8, v12
v_cmp_ne_u32 vcc, s94, v2
v_cmp_ne_u32_e64 s[92:93], s95, v2
s_add_u32 s70, s74, 16384
s_waitcnt lgkmcnt(2)
s_and_b64 exec, vcc, s[92:93]
buffer_store_dwordx4 v[100:103], v11, s[20:23], s70 offen nt
s_mov_b64 exec, -1
v_add_u32 v2, 16, v12
v_cmp_ne_u32 vcc, s94, v2
v_cmp_ne_u32_e64 s[92:93], s95, v2
s_add_u32 s70, s74, 32768
s_waitcnt lgkmcnt(1)
s_and_b64 exec, vcc, s[92:93]
buffer_store_dwordx4 v[104:107], v11, s[20:23], s70 offen nt
s_mov_b64 exec, -1
v_add_u32 v2, 24, v12
v_cmp_ne_u32 vcc, s94, v2
v_cmp_ne_u32_e64 s[92:93], s95, v2
s_add_u32 s70, s74, 49152
s_waitcnt lgkmcnt(0)
s_and_b64 exec, vcc, s[92:93]
buffer_store_dwordx4 v[108:111], v11, s[20:23], s70 offen nt
s_mov_b64 exec, -1
v_mov_b32 v2, 161792
s_barrier
ds_read_b32 v3, v2
ds_read_b32 v4, v2 offset:16
s_waitcnt lgkmcnt(0)
v_readfirstlane_b32 s72, v3
v_readfirstlane_b32 s73, v4
s_cmp_eq_u32 s85, s72
s_cselect_b32 s94, 255, s94
s_cmp_eq_u32 s85, s73
s_cselect_b32 s94, 255, s94
s_cmp_eq_u32 s86, s72
s_cselect_b32 s95, 255, s95
s_cmp_eq_u32 s86, s73
s_cselect_b32 s95, 255, s95
v_add_u32 v2, 0, v12
v_cmp_eq_u32 vcc, s94, v2
v_cmp_eq_u32_e64 s[92:93], s95, v2
s_add_u32 s70, s74, 0
s_or_b64 exec, vcc, s[92:93]
s_cbranch_execz L_nodef0
buffer_store_dwordx4 v[96:99], v11, s[20:23], s70 offen nt
L_nodef0:
s_mov_b64 exec, -1
v_add_u32 v2, 8, v12
v_cmp_eq_u32 vcc, s94, v2
v_cmp_eq_u32_e64 s[92:93], s95, v2
s_add_u32 s70, s74, 16384
s_or_b64 exec, vcc, s[92:93]
s_cbranch_execz L_nodef1
buffer_store_dwordx4 v[100:103], v11, s[20:23], s70 offen nt
L_nodef1:
s_mov_b64 exec, -1
v_add_u32 v2, 16, v12
v_cmp_eq_u32 vcc, s94, v2
v_cmp_eq_u32_e64 s[92:93], s95, v2
s_add_u32 s70, s74, 32768
s_or_b64 exec, vcc, s[92:93]
s_cbranch_execz L_nodef2
buffer_store_dwordx4 v[104:107], v11, s[20:23], s70 offen nt
L_nodef2:
s_mov_b64 exec, -1
v_add_u32 v2, 24, v12
v_cmp_eq_u32 vcc, s94, v2
v_cmp_eq_u32_e64 s[92:93], s95, v2
s_add_u32 s70, s74, 49152
s_or_b64 exec, vcc, s[92:93]
s_cbranch_execz L_nodef3
buffer_store_dwordx4 v[108:111], v11, s[20:23], s70 offen nt
L_nodef3:
s_mov_b64 exec, -1
L_end:
s_endpgm
L_eg_rt:
s_add_u32 s78, s78, 1
s_cmp_gt_u32 s78, 65536
s_cbranch_scc1 L_eg_ok
s_add_u32 s70, s87, 0
buffer_load_dwordx4 v[20:23], v44, s[12:15], s70 offen sc1
buffer_load_dwordx4 v[36:39], v45, s[12:15], s88 offen sc1
buffer_load_dwordx4 v[40:43], v46, s[12:15], 0 offen offset:0 sc1
s_waitcnt vmcnt(0)
s_branch L_eg_chk
L_pad8:
s_branch L_retF
L_kvrt:
s_add_u32 s78, s78, 1
s_cmp_gt_u32 s78, 65536
s_cbranch_scc1 L_kvok
s_bitcmp1_b32 s73, 0
s_cbranch_scc0 L_kvn0
v_cmp_eq_u32 vcc, -1, v84
s_cbranch_vccz L_kv0_p0
s_add_u32 s70, s65, 1
s_and_b32 s70, s70, 15
s_mul_i32 s70, s70, 4352
s_add_u32 s70, s70, s87
buffer_load_dwordx4 v[84:87], v18, s[12:15], s70 offen sc1
L_kv0_p0:
v_cmp_eq_u32 vcc, -1, v88
s_cbranch_vccz L_kv0_p1
s_add_u32 s70, s65, 2
s_and_b32 s70, s70, 15
s_mul_i32 s70, s70, 4352
s_add_u32 s70, s70, s87
buffer_load_dwordx4 v[88:91], v18, s[12:15], s70 offen sc1
L_kv0_p1:
v_cmp_eq_u32 vcc, -1, v92
s_cbranch_vccz L_kv0_p2
s_add_u32 s70, s65, 3
s_and_b32 s70, s70, 15
s_mul_i32 s70, s70, 4352
s_add_u32 s70, s70, s87
buffer_load_dwordx4 v[92:95], v18, s[12:15], s70 offen sc1
L_kv0_p2:
v_cmp_eq_u32 vcc, -1, v96
s_cbranch_vccz L_kv0_p3
s_add_u32 s70, s65, 4
s_and_b32 s70, s70, 15
s_mul_i32 s70, s70, 4352
s_add_u32 s70, s70, s87
buffer_load_dwordx4 v[96:99], v18, s[12:15], s70 offen sc1
L_kv0_p3:
L_kvn0:
s_bitcmp1_b32 s73, 1
s_cbranch_scc0 L_kvn1
v_cmp_eq_u32 vcc, -1, v100
s_cbranch_vccz L_kv1_p0
s_add_u32 s70, s65, 5
s_and_b32 s70, s70, 15
s_mul_i32 s70, s70, 4352
s_add_u32 s70, s70, s87
buffer_load_dwordx4 v[100:103], v18, s[12:15], s70 offen sc1
L_kv1_p0:
v_cmp_eq_u32 vcc, -1, v104
s_cbranch_vccz L_kv1_p1
s_add_u32 s70, s65, 6
s_and_b32 s70, s70, 15
s_mul_i32 s70, s70, 4352
s_add_u32 s70, s70, s87
buffer_load_dwordx4 v[104:107], v18, s[12:15], s70 offen sc1
L_kv1_p1:
v_cmp_eq_u32 vcc, -1, v108
s_cbranch_vccz L_kv1_p2
s_add_u32 s70, s65, 7
s_and_b32 s70, s70, 15
s_mul_i32 s70, s70, 4352
s_add_u32 s70, s70, s87
buffer_load_dwordx4 v[108:111], v18, s[12:15], s70 offen sc1
L_kv1_p2:
v_cmp_eq_u32 vcc, -1, v112
s_cbranch_vccz L_kv1_p3
s_add_u32 s70, s65, 8
s_and_b32 s70, s70, 15
s_mul_i32 s70, s70, 4352
s_add_u32 s70, s70, s87
buffer_load_dwordx4 v[112:115], v18, s[12:15], s70 offen sc1
L_kv1_p3:
L_kvn1:
s_bitcmp1_b32 s73, 2
s_cbranch_scc0 L_kvn2
v_cmp_eq_u32 vcc, -1, v116
s_cbranch_vccz L_kv2_p0
s_add_u32 s70, s65, 9
s_and_b32 s70, s70, 15
s_mul_i32 s70, s70, 4352
s_add_u32 s70, s70, s87
buffer_load_dwordx4 v[116:119], v18, s[12:15], s70 offen sc1
L_kv2_p0:
v_cmp_eq_u32 vcc, -1, v120
s_cbranch_vccz L_kv2_p1
s_add_u32 s70, s65, 10
s_and_b32 s70, s70, 15
s_mul_i32 s70, s70, 4352
s_add_u32 s70, s70, s87
buffer_load_dwordx4 v[120:123], v18, s[12:15], s70 offen sc1
L_kv2_p1:
v_cmp_eq_u32 vcc, -1, v124
s_cbranch_vccz L_kv2_p2
s_add_u32 s70, s65, 11
s_and_b32 s70, s70, 15
s_mul_i32 s70, s70, 4352
s_add_u32 s70, s70, s87
buffer_load_dwordx4 v[124:127], v18, s[12:15], s70 offen sc1
L_kv2_p2:
v_cmp_eq_u32 vcc, -1, v128
s_cbranch_vccz L_kv2_p3
s_add_u32 s70, s65, 12
s_and_b32 s70, s70, 15
s_mul_i32 s70, s70, 4352
s_add_u32 s70, s70, s87
buffer_load_dwordx4 v[128:131], v18, s[12:15], s70 offen sc1
L_kv2_p3:
L_kvn2:
s_bitcmp1_b32 s73, 3
s_cbranch_scc0 L_kvn3
v_cmp_eq_u32 vcc, -1, v132
s_cbranch_vccz L_kv3_p0
s_add_u32 s70, s65, 13
s_and_b32 s70, s70, 15
s_mul_i32 s70, s70, 4352
s_add_u32 s70, s70, s87
buffer_load_dwordx4 v[132:135], v18, s[12:15], s70 offen sc1
L_kv3_p0:
v_cmp_eq_u32 vcc, -1, v136
s_cbranch_vccz L_kv3_p1
s_add_u32 s70, s65, 14
s_and_b32 s70, s70, 15
s_mul_i32 s70, s70, 4352
s_add_u32 s70, s70, s87
buffer_load_dwordx4 v[136:139], v18, s[12:15], s70 offen sc1
L_kv3_p1:
v_cmp_eq_u32 vcc, -1, v140
s_cbranch_vccz L_kv3_p2
s_add_u32 s70, s65, 15
s_and_b32 s70, s70, 15
s_mul_i32 s70, s70, 4352
s_add_u32 s70, s70, s87
buffer_load_dwordx4 v[140:143], v18, s[12:15], s70 offen sc1
L_kv3_p2:
v_cmp_eq_u32 vcc, -1, v144
s_cbranch_vccz L_kv3_p3
s_add_u32 s70, s65, 16
s_and_b32 s70, s70, 15
s_mul_i32 s70, s70, 4352
s_add_u32 s70, s70, s87
buffer_load_dwordx4 v[144:147], v18, s[12:15], s70 offen sc1
L_kv3_p3:
L_kvn3:
s_bitcmp1_b32 s73, 4
s_cbranch_scc0 L_kvn4
buffer_load_dwordx4 v[148:151], v55, s[12:15], s88 offen sc1
L_kvn4:
s_waitcnt vmcnt(0)
s_branch L_kvr
L_pad9:
s_branch L_pad13
L_pksame:
s_cmp_eq_u32 s73, 0
s_cbranch_scc1 L_pkf
s_add_u32 s78, s78, 1
s_cmp_le_u32 s78, 65536
s_cbranch_scc1 L_pk
s_branch L_pkf
L_pkx_rt:
s_add_u32 s78, s78, 1
s_cmp_gt_u32 s78, 65536
s_cbranch_scc1 L_pkx_ok
s_mov_b64 exec, s[92:93]
buffer_load_dwordx4 v[24:27], v58, s[12:15], 0 offen offset:0 sc1
buffer_load_dwordx4 v[28:31], v58, s[12:15], 0 offen offset:64 sc1
buffer_load_dwordx4 v[32:35], v58, s[12:15], 0 offen offset:128 sc1
buffer_load_dwordx4 v[36:39], v58, s[12:15], 0 offen offset:192 sc1
buffer_load_dwordx4 v[40:43], v58, s[12:15], 0 offen offset:256 sc1
buffer_load_dwordx4 v[44:47], v58, s[12:15], 0 offen offset:320 sc1
buffer_load_dwordx4 v[48:51], v58, s[12:15], 0 offen offset:384 sc1
buffer_load_dwordx4 v[52:55], v58, s[12:15], 0 offen offset:448 sc1
s_mov_b64 exec, -1
s_waitcnt vmcnt(0)
s_branch L_pkx_chk
L_pxp_s:
buffer_store_dwordx4 v[84:87], v60, s[12:15], s85 offen sc1
s_branch L_pxp_d
L_pad10:
s_branch L_pad14
L_px_rt:
s_add_u32 s78, s78, 1
s_cmp_gt_u32 s78, 65536
s_branch L_over11
L_pad11:
s_branch L_pad15
L_over11:
s_cbranch_scc1 L_px_ok
v_and_b32 v2, s91, v24
v_cmp_ne_u32 vcc, 0, v2
v_xor_b32 v24, s84, v24
s_cbranch_vccz L_px_p0
buffer_load_dwordx4 v[24:27], v61, s[12:15], s86 offen offset:0 sc1
L_px_p0:
v_and_b32 v2, s91, v28
v_cmp_ne_u32 vcc, 0, v2
v_xor_b32 v28, s84, v28
s_cbranch_vccz L_px_p1
buffer_load_dwordx4 v[28:31], v61, s[12:15], s86 offen offset:1024 sc1
L_px_p1:
v_and_b32 v2, s91, v32
v_cmp_ne_u32 vcc, 0, v2
v_xor_b32 v32, s84, v32
s_cbranch_vccz L_px_p2
buffer_load_dwordx4 v[32:35], v61, s[12:15], s86 offen offset:2048 sc1
L_px_p2:
v_and_b32 v2, s91, v36
v_cmp_ne_u32 vcc, 0, v2
v_xor_b32 v36, s84, v36
s_cbranch_vccz L_px_p3
buffer_load_dwordx4 v[36:39], v61, s[12:15], s86 offen offset:3072 sc1
L_px_p3:
s_waitcnt vmcnt(0)
s_branch L_px_chk
L_h_rt:
s_add_u32 s78, s78, 1
s_cmp_gt_u32 s78, 65536
s_cbranch_scc1 L_h_ok
buffer_load_dwordx2 v[84:85], v64, s[12:15], s72 offen sc1
s_waitcnt vmcnt(0)
s_branch L_h_chk
L_pad12:
s_branch L_retG
L_y_rt:
s_add_u32 s78, s78, 1
s_cmp_gt_u32 s78, 65536
s_cbranch_scc1 L_y_ok
v_mov_b32 v88, s84
v_and_b32 v2, s91, v120
v_cmp_ne_u32 vcc, 0, v2
v_xor_b32 v120, s84, v120
s_cbranch_vccz L_y_p0
buffer_load_dwordx4 v[120:123], v18, s[12:15], s88 offen offset:0 sc1
L_y_p0:
v_and_b32 v2, s91, v124
v_cmp_ne_u32 vcc, 0, v2
v_xor_b32 v124, s84, v124
s_cbranch_vccz L_y_p1
buffer_load_dwordx4 v[124:127], v18, s[12:15], s88 offen offset:1024 sc1
L_y_p1:
v_and_b32 v2, s91, v128
v_cmp_ne_u32 vcc, 0, v2
v_xor_b32 v128, s84, v128
s_cbranch_vccz L_y_p2
buffer_load_dwordx4 v[128:131], v18, s[12:15], s88 offen offset:2048 sc1
L_y_p2:
v_and_b32 v2, s91, v132
v_cmp_ne_u32 vcc, 0, v2
v_xor_b32 v132, s84, v132
s_cbranch_vccz L_y_p3
buffer_load_dwordx4 v[132:135], v18, s[12:15], s88 offen offset:3072 sc1
L_y_p3:
v_and_b32 v2, s91, v136
v_cmp_ne_u32 vcc, 0, v2
v_xor_b32 v136, s84, v136
s_cbranch_vccz L_y_p4
buffer_load_dwordx4 v[136:139], v18, s[12:15], s71 offen offset:0 sc1
L_y_p4:
v_and_b32 v2, s91, v140
v_cmp_ne_u32 vcc, 0, v2
v_xor_b32 v140, s84, v140
s_cbranch_vccz L_y_p5
buffer_load_dwordx4 v[140:143], v18, s[12:15], s71 offen offset:1024 sc1
L_y_p5:
v_and_b32 v2, s91, v144
v_cmp_ne_u32 vcc, 0, v2
v_xor_b32 v144, s84, v144
s_cbranch_vccz L_y_p6
buffer_load_dwordx4 v[144:147], v18, s[12:15], s71 offen offset:2048 sc1
L_y_p6:
s_waitcnt vmcnt(0)
s_branch L_y_chk
L_kvp_s:
buffer_store_dwordx4 v[140:143], v16, s[12:15], s72 offen sc1
s_mov_b64 exec, s[92:93]
buffer_store_dwordx4 v[136:139], v4, s[12:15], s73 offen sc1
s_mov_b64 exec, -1
s_branch L_kvp_d
L_pad13:
s_branch L_retG
L_o0_rt:
s_add_u32 s78, s78, 1
s_cmp_gt_u32 s78, 65536
s_cbranch_scc1 L_o0_ok
s_add_u32 s70, s89, 0
s_and_b32 s70, s70, 15
s_lshl_b32 s70, s70, 11
buffer_load_dwordx4 v[56:59], v6, s[12:15], s70 offen offset:0 sc1
buffer_load_dwordx4 v[60:63], v19, s[12:15], s70 offen offset:0 sc1
buffer_load_dwordx4 v[64:67], v6, s[12:15], s70 offen offset:1024 sc1
buffer_load_dwordx4 v[68:71], v19, s[12:15], s70 offen offset:1024 sc1
s_add_u32 s70, s89, 1
s_and_b32 s70, s70, 15
s_lshl_b32 s70, s70, 11
buffer_load_dwordx4 v[72:75], v6, s[12:15], s70 offen offset:0 sc1
buffer_load_dwordx4 v[76:79], v19, s[12:15], s70 offen offset:0 sc1
buffer_load_dwordx4 v[80:83], v6, s[12:15], s70 offen offset:1024 sc1
buffer_load_dwordx4 v[84:87], v19, s[12:15], s70 offen offset:1024 sc1
s_add_u32 s70, s89, 2
s_and_b32 s70, s70, 15
s_lshl_b32 s70, s70, 11
buffer_load_dwordx4 v[88:91], v6, s[12:15], s70 offen offset:0 sc1
buffer_load_dwordx4 v[92:95], v19, s[12:15], s70 offen offset:0 sc1
buffer_load_dwordx4 v[96:99], v6, s[12:15], s70 offen offset:1024 sc1
buffer_load_dwordx4 v[100:103], v19, s[12:15], s70 offen offset:1024 sc1
s_waitcnt vmcnt(0)
s_branch L_o0_chk
L_pad14:
s_branch L_retG
L_o1_rt:
s_add_u32 s78, s78, 1
s_cmp_gt_u32 s78, 65536
s_cbranch_scc1 L_o1_ok
s_add_u32 s70, s89, 1
s_and_b32 s70, s70, 15
s_lshl_b32 s70, s70, 11
buffer_load_dwordx4 v[72:75], v6, s[12:15], s70 offen offset:0 sc1
buffer_load_dwordx4 v[76:79], v19, s[12:15], s70 offen offset:0 sc1
buffer_load_dwordx4 v[80:83], v6, s[12:15], s70 offen offset:1024 sc1
buffer_load_dwordx4 v[84:87], v19, s[12:15], s70 offen offset:1024 sc1
s_add_u32 s70, s89, 2
s_and_b32 s70, s70, 15
s_lshl_b32 s70, s70, 11
buffer_load_dwordx4 v[88:91], v6, s[12:15], s70 offen offset:0 sc1
buffer_load_dwordx4 v[92:95], v19, s[12:15], s70 offen offset:0 sc1
buffer_load_dwordx4 v[96:99], v6, s[12:15], s70 offen offset:1024 sc1
buffer_load_dwordx4 v[100:103], v19, s[12:15], s70 offen offset:1024 sc1
s_waitcnt vmcnt(0)
v_max3_u32 v2, v72, v76, v80
v_max_u32 v2, v2, v84
v_cmp_eq_u32 vcc, -1, v2
s_cbranch_vccnz L_o1_rt
s_branch L_o1_ok
L_o2_rt:
s_add_u32 s78, s78, 1
s_cmp_gt_u32 s78, 65536
s_cbranch_scc1 L_o2_ok
s_add_u32 s70, s89, 2
s_and_b32 s70, s70, 15
s_lshl_b32 s70, s70, 11
buffer_load_dwordx4 v[88:91], v6, s[12:15], s70 offen offset:0 sc1
buffer_load_dwordx4 v[92:95], v19, s[12:15], s70 offen offset:0 sc1
buffer_load_dwordx4 v[96:99], v6, s[12:15], s70 offen offset:1024 sc1
buffer_load_dwordx4 v[100:103], v19, s[12:15], s70 offen offset:1024 sc1
s_add_u32 s70, s89, 3
s_and_b32 s70, s70, 15
s_lshl_b32 s70, s70, 11
buffer_load_dwordx4 v[104:107], v6, s[12:15], s70 offen offset:0 sc1
buffer_load_dwordx4 v[108:111], v19, s[12:15], s70 offen offset:0 sc1
buffer_load_dwordx4 v[112:115], v6, s[12:15], s70 offen offset:1024 sc1
buffer_load_dwordx4 v[116:119], v19, s[12:15], s70 offen offset:1024 sc1
s_waitcnt vmcnt(0)
v_max3_u32 v2, v88, v92, v96
v_max_u32 v2, v2, v100
v_cmp_eq_u32 vcc, -1, v2
s_cbranch_vccnz L_o2_rt
s_branch L_o2_ok
L_o3_rt:
s_add_u32 s78, s78, 1
s_cmp_gt_u32 s78, 65536
s_cbranch_scc1 L_o3_ok
s_add_u32 s70, s89, 3
s_and_b32 s70, s70, 15
s_lshl_b32 s70, s70, 11
buffer_load_dwordx4 v[104:107], v6, s[12:15], s70 offen offset:0 sc1
buffer_load_dwordx4 v[108:111], v19, s[12:15], s70 offen offset:0 sc1
buffer_load_dwordx4 v[112:115], v6, s[12:15], s70 offen offset:1024 sc1
buffer_load_dwordx4 v[116:119], v19, s[12:15], s70 offen offset:1024 sc1
s_add_u32 s70, s89, 4
s_and_b32 s70, s70, 15
s_lshl_b32 s70, s70, 11
buffer_load_dwordx4 v[56:59], v6, s[12:15], s70 offen offset:0 sc1
buffer_load_dwordx4 v[60:63], v19, s[12:15], s70 offen offset:0 sc1
buffer_load_dwordx4 v[64:67], v6, s[12:15], s70 offen offset:1024 sc1
buffer_load_dwordx4 v[68:71], v19, s[12:15], s70 offen offset:1024 sc1
s_waitcnt vmcnt(0)
v_max3_u32 v2, v104, v108, v112
v_max_u32 v2, v2, v116
v_cmp_eq_u32 vcc, -1, v2
s_cbranch_vccnz L_o3_rt
s_branch L_o3_ok
L_o4_rt:
s_add_u32 s78, s78, 1
s_cmp_gt_u32 s78, 65536
s_cbranch_scc1 L_o4_ok
s_add_u32 s70, s89, 4
s_and_b32 s70, s70, 15
s_lshl_b32 s70, s70, 11
buffer_load_dwordx4 v[56:59], v6, s[12:15], s70 offen offset:0 sc1
buffer_load_dwordx4 v[60:63], v19, s[12:15], s70 offen offset:0 sc1
buffer_load_dwordx4 v[64:67], v6, s[12:15], s70 offen offset:1024 sc1
buffer_load_dwordx4 v[68:71], v19, s[12:15], s70 offen offset:1024 sc1
s_add_u32 s70, s89, 5
s_and_b32 s70, s70, 15
s_lshl_b32 s70, s70, 11
buffer_load_dwordx4 v[72:75], v6, s[12:15], s70 offen offset:0 sc1
buffer_load_dwordx4 v[76:79], v19, s[12:15], s70 offen offset:0 sc1
buffer_load_dwordx4 v[80:83], v6, s[12:15], s70 offen offset:1024 sc1
buffer_load_dwordx4 v[84:87], v19, s[12:15], s70 offen offset:1024 sc1
s_waitcnt vmcnt(0)
v_max3_u32 v2, v56, v60, v64
v_max_u32 v2, v2, v68
v_cmp_eq_u32 vcc, -1, v2
s_cbranch_vccnz L_o4_rt
s_branch L_o4_ok
L_o5_rt:
s_add_u32 s78, s78, 1
s_cmp_gt_u32 s78, 65536
s_cbranch_scc1 L_o5_ok
s_add_u32 s70, s89, 5
s_and_b32 s70, s70, 15
s_lshl_b32 s70, s70, 11
buffer_load_dwordx4 v[72:75], v6, s[12:15], s70 offen offset:0 sc1
buffer_load_dwordx4 v[76:79], v19, s[12:15], s70 offen offset:0 sc1
buffer_load_dwordx4 v[80:83], v6, s[12:15], s70 offen offset:1024 sc1
buffer_load_dwordx4 v[84:87], v19, s[12:15], s70 offen offset:1024 sc1
s_add_u32 s70, s89, 6
s_and_b32 s70, s70, 15
s_lshl_b32 s70, s70, 11
buffer_load_dwordx4 v[88:91], v6, s[12:15], s70 offen offset:0 sc1
buffer_load_dwordx4 v[92:95], v19, s[12:15], s70 offen offset:0 sc1
buffer_load_dwordx4 v[96:99], v6, s[12:15], s70 offen offset:1024 sc1
buffer_load_dwordx4 v[100:103], v19, s[12:15], s70 offen offset:1024 sc1
s_waitcnt vmcnt(0)
v_max3_u32 v2, v72, v76, v80
v_max_u32 v2, v2, v84
v_cmp_eq_u32 vcc, -1, v2
s_cbranch_vccnz L_o5_rt
s_branch L_o5_ok
L_o6_rt:
s_add_u32 s78, s78, 1
s_cmp_gt_u32 s78, 65536
s_cbranch_scc1 L_o6_ok
s_add_u32 s70, s89, 6
s_and_b32 s70, s70, 15
s_lshl_b32 s70, s70, 11
buffer_load_dwordx4 v[88:91], v6, s[12:15], s70 offen offset:0 sc1
buffer_load_dwordx4 v[92:95], v19, s[12:15], s70 offen offset:0 sc1
buffer_load_dwordx4 v[96:99], v6, s[12:15], s70 offen offset:1024 sc1
buffer_load_dwordx4 v[100:103], v19, s[12:15], s70 offen offset:1024 sc1
s_add_u32 s70, s89, 7
s_and_b32 s70, s70, 15
s_lshl_b32 s70, s70, 11
buffer_load_dwordx4 v[104:107], v6, s[12:15], s70 offen offset:0 sc1
buffer_load_dwordx4 v[108:111], v19, s[12:15], s70 offen offset:0 sc1
buffer_load_dwordx4 v[112:115], v6, s[12:15], s70 offen offset:1024 sc1
buffer_load_dwordx4 v[116:119], v19, s[12:15], s70 offen offset:1024 sc1
s_waitcnt vmcnt(0)
v_max3_u32 v2, v88, v92, v96
v_max_u32 v2, v2, v100
v_cmp_eq_u32 vcc, -1, v2
s_cbranch_vccnz L_o6_rt
s_branch L_o6_ok
L_o7_rt:
s_add_u32 s78, s78, 1
s_cmp_gt_u32 s78, 65536
s_cbranch_scc1 L_o7_ok
s_add_u32 s70, s89, 7
s_and_b32 s70, s70, 15
s_lshl_b32 s70, s70, 11
buffer_load_dwordx4 v[104:107], v6, s[12:15], s70 offen offset:0 sc1
buffer_load_dwordx4 v[108:111], v19, s[12:15], s70 offen offset:0 sc1
buffer_load_dwordx4 v[112:115], v6, s[12:15], s70 offen offset:1024 sc1
buffer_load_dwordx4 v[116:119], v19, s[12:15], s70 offen offset:1024 sc1
s_add_u32 s70, s89, 8
s_and_b32 s70, s70, 15
s_lshl_b32 s70, s70, 11
buffer_load_dwordx4 v[56:59], v6, s[12:15], s70 offen offset:0 sc1
buffer_load_dwordx4 v[60:63], v19, s[12:15], s70 offen offset:0 sc1
buffer_load_dwordx4 v[64:67], v6, s[12:15], s70 offen offset:1024 sc1
buffer_load_dwordx4 v[68:71], v19, s[12:15], s70 offen offset:1024 sc1
s_waitcnt vmcnt(0)
v_max3_u32 v2, v104, v108, v112
v_max_u32 v2, v2, v116
v_cmp_eq_u32 vcc, -1, v2
s_cbranch_vccnz L_o7_rt
s_branch L_o7_ok
L_o8_rt:
s_add_u32 s78, s78, 1
s_cmp_gt_u32 s78, 65536
s_cbranch_scc1 L_o8_ok
s_add_u32 s70, s89, 8
s_and_b32 s70, s70, 15
s_lshl_b32 s70, s70, 11
buffer_load_dwordx4 v[56:59], v6, s[12:15], s70 offen offset:0 sc1
buffer_load_dwordx4 v[60:63], v19, s[12:15], s70 offen offset:0 sc1
buffer_load_dwordx4 v[64:67], v6, s[12:15], s70 offen offset:1024 sc1
buffer_load_dwordx4 v[68:71], v19, s[12:15], s70 offen offset:1024 sc1
s_add_u32 s70, s89, 9
s_and_b32 s70, s70, 15
s_lshl_b32 s70, s70, 11
buffer_load_dwordx4 v[72:75], v6, s[12:15], s70 offen offset:0 sc1
buffer_load_dwordx4 v[76:79], v19, s[12:15], s70 offen offset:0 sc1
buffer_load_dwordx4 v[80:83], v6, s[12:15], s70 offen offset:1024 sc1
buffer_load_dwordx4 v[84:87], v19, s[12:15], s70 offen offset:1024 sc1
s_waitcnt vmcnt(0)
v_max3_u32 v2, v56, v60, v64
v_max_u32 v2, v2, v68
v_cmp_eq_u32 vcc, -1, v2
s_cbranch_vccnz L_o8_rt
s_branch L_o8_ok
L_o9_rt:
s_add_u32 s78, s78, 1
s_cmp_gt_u32 s78, 65536
s_cbranch_scc1 L_o9_ok
s_add_u32 s70, s89, 9
s_and_b32 s70, s70, 15
s_lshl_b32 s70, s70, 11
buffer_load_dwordx4 v[72:75], v6, s[12:15], s70 offen offset:0 sc1
buffer_load_dwordx4 v[76:79], v19, s[12:15], s70 offen offset:0 sc1
buffer_load_dwordx4 v[80:83], v6, s[12:15], s70 offen offset:1024 sc1
buffer_load_dwordx4 v[84:87], v19, s[12:15], s70 offen offset:1024 sc1
s_add_u32 s70, s89, 10
s_and_b32 s70, s70, 15
s_lshl_b32 s70, s70, 11
buffer_load_dwordx4 v[88:91], v6, s[12:15], s70 offen offset:0 sc1
buffer_load_dwordx4 v[92:95], v19, s[12:15], s70 offen offset:0 sc1
buffer_load_dwordx4 v[96:99], v6, s[12:15], s70 offen offset:1024 sc1
buffer_load_dwordx4 v[100:103], v19, s[12:15], s70 offen offset:1024 sc1
s_waitcnt vmcnt(0)
v_max3_u32 v2, v72, v76, v80
v_max_u32 v2, v2, v84
v_cmp_eq_u32 vcc, -1, v2
s_cbranch_vccnz L_o9_rt
s_branch L_o9_ok
L_o10_rt:
s_add_u32 s78, s78, 1
s_cmp_gt_u32 s78, 65536
s_cbranch_scc1 L_o10_ok
s_add_u32 s70, s89, 10
s_and_b32 s70, s70, 15
s_lshl_b32 s70, s70, 11
buffer_load_dwordx4 v[88:91], v6, s[12:15], s70 offen offset:0 sc1
buffer_load_dwordx4 v[92:95], v19, s[12:15], s70 offen offset:0 sc1
buffer_load_dwordx4 v[96:99], v6, s[12:15], s70 offen offset:1024 sc1
buffer_load_dwordx4 v[100:103], v19, s[12:15], s70 offen offset:1024 sc1
s_add_u32 s70, s89, 11
s_and_b32 s70, s70, 15
s_lshl_b32 s70, s70, 11
buffer_load_dwordx4 v[104:107], v6, s[12:15], s70 offen offset:0 sc1
buffer_load_dwordx4 v[108:111], v19, s[12:15], s70 offen offset:0 sc1
buffer_load_dwordx4 v[112:115], v6, s[12:15], s70 offen offset:1024 sc1
buffer_load_dwordx4 v[116:119], v19, s[12:15], s70 offen offset:1024 sc1
s_waitcnt vmcnt(0)
v_max3_u32 v2, v88, v92, v96
v_max_u32 v2, v2, v100
v_cmp_eq_u32 vcc, -1, v2
s_cbranch_vccnz L_o10_rt
s_branch L_o10_ok
L_o11_rt:
s_add_u32 s78, s78, 1
s_cmp_gt_u32 s78, 65536
s_cbranch_scc1 L_o11_ok
s_add_u32 s70, s89, 11
s_and_b32 s70, s70, 15
s_lshl_b32 s70, s70, 11
buffer_load_dwordx4 v[104:107], v6, s[12:15], s70 offen offset:0 sc1
buffer_load_dwordx4 v[108:111], v19, s[12:15], s70 offen offset:0 sc1
buffer_load_dwordx4 v[112:115], v6, s[12:15], s70 offen offset:1024 sc1
buffer_load_dwordx4 v[116:119], v19, s[12:15], s70 offen offset:1024 sc1
s_add_u32 s70, s89, 12
s_and_b32 s70, s70, 15
s_lshl_b32 s70, s70, 11
buffer_load_dwordx4 v[56:59], v6, s[12:15], s70 offen offset:0 sc1
buffer_load_dwordx4 v[60:63], v19, s[12:15], s70 offen offset:0 sc1
buffer_load_dwordx4 v[64:67], v6, s[12:15], s70 offen offset:1024 sc1
buffer_load_dwordx4 v[68:71], v19, s[12:15], s70 offen offset:1024 sc1
s_waitcnt vmcnt(0)
v_max3_u32 v2, v104, v108, v112
v_max_u32 v2, v2, v116
v_cmp_eq_u32 vcc, -1, v2
s_cbranch_vccnz L_o11_rt
s_branch L_o11_ok
L_o12_rt:
s_add_u32 s78, s78, 1
s_cmp_gt_u32 s78, 65536
s_cbranch_scc1 L_o12_ok
s_add_u32 s70, s89, 12
s_and_b32 s70, s70, 15
s_lshl_b32 s70, s70, 11
buffer_load_dwordx4 v[56:59], v6, s[12:15], s70 offen offset:0 sc1
buffer_load_dwordx4 v[60:63], v19, s[12:15], s70 offen offset:0 sc1
buffer_load_dwordx4 v[64:67], v6, s[12:15], s70 offen offset:1024 sc1
buffer_load_dwordx4 v[68:71], v19, s[12:15], s70 offen offset:1024 sc1
s_add_u32 s70, s89, 13
s_and_b32 s70, s70, 15
s_lshl_b32 s70, s70, 11
buffer_load_dwordx4 v[72:75], v6, s[12:15], s70 offen offset:0 sc1
buffer_load_dwordx4 v[76:79], v19, s[12:15], s70 offen offset:0 sc1
buffer_load_dwordx4 v[80:83], v6, s[12:15], s70 offen offset:1024 sc1
buffer_load_dwordx4 v[84:87], v19, s[12:15], s70 offen offset:1024 sc1
s_waitcnt vmcnt(0)
v_max3_u32 v2, v56, v60, v64
v_max_u32 v2, v2, v68
v_cmp_eq_u32 vcc, -1, v2
s_cbranch_vccnz L_o12_rt
s_branch L_o12_ok
L_o13_rt:
s_add_u32 s78, s78, 1
s_cmp_gt_u32 s78, 65536
s_cbranch_scc1 L_o13_ok
s_add_u32 s70, s89, 13
s_and_b32 s70, s70, 15
s_lshl_b32 s70, s70, 11
buffer_load_dwordx4 v[72:75], v6, s[12:15], s70 offen offset:0 sc1
buffer_load_dwordx4 v[76:79], v19, s[12:15], s70 offen offset:0 sc1
buffer_load_dwordx4 v[80:83], v6, s[12:15], s70 offen offset:1024 sc1
buffer_load_dwordx4 v[84:87], v19, s[12:15], s70 offen offset:1024 sc1
s_add_u32 s70, s89, 14
s_and_b32 s70, s70, 15
s_lshl_b32 s70, s70, 11
buffer_load_dwordx4 v[88:91], v6, s[12:15], s70 offen offset:0 sc1
buffer_load_dwordx4 v[92:95], v19, s[12:15], s70 offen offset:0 sc1
buffer_load_dwordx4 v[96:99], v6, s[12:15], s70 offen offset:1024 sc1
buffer_load_dwordx4 v[100:103], v19, s[12:15], s70 offen offset:1024 sc1
s_waitcnt vmcnt(0)
v_max3_u32 v2, v72, v76, v80
v_max_u32 v2, v2, v84
v_cmp_eq_u32 vcc, -1, v2
s_cbranch_vccnz L_o13_rt
s_branch L_o13_ok
L_o14_rt:
s_add_u32 s78, s78, 1
s_cmp_gt_u32 s78, 65536
s_cbranch_scc1 L_o14_ok
s_add_u32 s70, s89, 14
s_and_b32 s70, s70, 15
s_lshl_b32 s70, s70, 11
buffer_load_dwordx4 v[88:91], v6, s[12:15], s70 offen offset:0 sc1
buffer_load_dwordx4 v[92:95], v19, s[12:15], s70 offen offset:0 sc1
buffer_load_dwordx4 v[96:99], v6, s[12:15], s70 offen offset:1024 sc1
buffer_load_dwordx4 v[100:103], v19, s[12:15], s70 offen offset:1024 sc1
s_add_u32 s70, s89, 15
s_and_b32 s70, s70, 15
s_lshl_b32 s70, s70, 11
buffer_load_dwordx4 v[104:107], v6, s[12:15], s70 offen offset:0 sc1
buffer_load_dwordx4 v[108:111], v19, s[12:15], s70 offen offset:0 sc1
buffer_load_dwordx4 v[112:115], v6, s[12:15], s70 offen offset:1024 sc1
buffer_load_dwordx4 v[116:119], v19, s[12:15], s70 offen offset:1024 sc1
s_waitcnt vmcnt(0)
v_max3_u32 v2, v88, v92, v96
v_max_u32 v2, v2, v100
v_cmp_eq_u32 vcc, -1, v2
s_cbranch_vccnz L_o14_rt
s_branch L_o14_ok
L_o15_rt:
s_add_u32 s78, s78, 1
s_cmp_gt_u32 s78, 65536
s_cbranch_scc1 L_o15_ok
s_add_u32 s70, s89, 15
s_and_b32 s70, s70, 15
s_lshl_b32 s70, s70, 11
buffer_load_dwordx4 v[104:107], v6, s[12:15], s70 offen offset:0 sc1
buffer_load_dwordx4 v[108:111], v19, s[12:15], s70 offen offset:0 sc1
buffer_load_dwordx4 v[112:115], v6, s[12:15], s70 offen offset:1024 sc1
buffer_load_dwordx4 v[116:119], v19, s[12:15], s70 offen offset:1024 sc1
s_waitcnt vmcnt(0)
v_max3_u32 v2, v104, v108, v112
v_max_u32 v2, v2, v116
v_cmp_eq_u32 vcc, -1, v2
s_cbranch_vccnz L_o15_rt
s_branch L_o15_ok
L_stp_s:
buffer_store_dwordx4 v[72:75], v144, s[12:15], s72 offen offset:0 sc1
buffer_store_dwordx4 v[76:79], v144, s[12:15], s72 offen offset:256 sc1
s_branch L_stp_d
L_pad15:
s_branch L_retG
L_st_rt:
s_add_u32 s78, s78, 1
s_cmp_gt_u32 s78, 65536
s_cbranch_scc1 L_st_ok
v_cmp_ne_u32 vcc, s68, v99
s_cbranch_vccz L_st_p0
s_add_u32 s70, s75, 0
buffer_load_dwordx4 v[96:99], v145, s[12:15], s70 offen sc1
L_st_p0:
v_cmp_ne_u32 vcc, s68, v103
s_cbranch_vccz L_st_p1
s_add_u32 s70, s75, 4096
buffer_load_dwordx4 v[100:103], v145, s[12:15], s70 offen sc1
L_st_p1:
v_cmp_ne_u32 vcc, s68, v107
s_cbranch_vccz L_st_p2
s_add_u32 s70, s75, 8192
buffer_load_dwordx4 v[104:107], v145, s[12:15], s70 offen sc1
L_st_p2:
v_cmp_ne_u32 vcc, s68, v111
s_cbranch_vccz L_st_p3
s_add_u32 s70, s75, 12288
buffer_load_dwordx4 v[108:111], v145, s[12:15], s70 offen sc1
L_st_p3:
v_cmp_ne_u32 vcc, s68, v115
s_cbranch_vccz L_st_p4
s_add_u32 s70, s75, 16384
buffer_load_dwordx4 v[112:115], v145, s[12:15], s70 offen sc1
L_st_p4:
v_cmp_ne_u32 vcc, s68, v119
s_cbranch_vccz L_st_p5
s_add_u32 s70, s75, 20480
buffer_load_dwordx4 v[116:119], v145, s[12:15], s70 offen sc1
L_st_p5:
v_cmp_ne_u32 vcc, s68, v123
s_cbranch_vccz L_st_p6
s_add_u32 s70, s75, 24576
buffer_load_dwordx4 v[120:123], v145, s[12:15], s70 offen sc1
L_st_p6:
v_cmp_ne_u32 vcc, s68, v127
s_cbranch_vccz L_st_p7
s_add_u32 s70, s75, 28672
buffer_load_dwordx4 v[124:127], v145, s[12:15], s70 offen sc1
L_st_p7:
s_waitcnt vmcnt(0)
s_branch L_st_chk
L_fin:
.section .rodata,"a"
.p2align 6
.amdhsa_kernel sequential_preLN__linear_attn_block__moe_arch_mod__prompt_kernel
  .amdhsa_next_free_vgpr 256
  .amdhsa_next_free_sgpr 102
  .amdhsa_accum_offset 152
  .amdhsa_group_segment_fixed_size 0
  .amdhsa_kernarg_size 88
  .amdhsa_user_sgpr_count 2
  .amdhsa_user_sgpr_kernarg_segment_ptr 1
  .amdhsa_system_sgpr_workgroup_id_x 1
  .amdhsa_float_denorm_mode_32 3
.end_amdhsa_kernel
```

```asm
; @launch grid=(256,1,1) block=(512,1,1) lds=163840
.amdgcn_target "amdgcn-amd-amdhsa--gfx950"
.text
.p2alignl 12, 0xbf810000
.fill 832, 4, 0xbf810000
.globl sequential_preLN__linear_attn_block__moe_arch_mod__prompt_kernel
.p2align 8
.type sequential_preLN__linear_attn_block__moe_arch_mod__prompt_kernel,@function
sequential_preLN__linear_attn_block__moe_arch_mod__prompt_kernel:
s_cmp_ge_u32 s2, 256
s_cbranch_scc1 L_end
s_load_dwordx16 s[40:55], s[0:1], 0
s_load_dwordx2 s[56:57], s[0:1], 64
s_load_dwordx2 s[58:59], s[0:1], 80
s_getpc_b64 s[20:21]
L_pc:
s_sub_u32 s20, s20, L_pc-sequential_preLN__linear_attn_block__moe_arch_mod__prompt_kernel
s_subb_u32 s21, s21, 0
s_and_b32 s21, s21, 0xffff
s_mov_b32 s22, L_fin-sequential_preLN__linear_attn_block__moe_arch_mod__prompt_kernel
s_mov_b32 s23, 0x20000
s_lshr_b32 s70, s2, 3
s_mul_i32 s70, s70, 1536
v_lshlrev_b32 v81, 7, v0
v_cmp_gt_u32 vcc, 12, v0
s_nop 0
s_mov_b64 exec, vcc
buffer_load_dword v81, v81, s[20:23], s70 offen
s_mov_b64 exec, -1
v_lshrrev_b32 v2, 6, v0
v_and_b32 v1, 63, v0
v_readfirstlane_b32 s60, v2
s_and_b32 s62, s2, 7
s_lshr_b32 s63, s2, 3
s_lshl_b32 s64, s62, 1
s_and_b32 s70, s63, 1
s_add_u32 s64, s64, s70
s_lshr_b32 s65, s63, 1
s_lshl_b32 s79, s64, 4
s_add_u32 s79, s79, s65
s_mov_b32 s78, 0
s_mov_b32 s89, s65
s_lshr_b32 s61, s60, 2
s_and_b32 s60, s60, 3
s_lshr_b32 s66, s60, 1
s_and_b32 s67, s60, 1
v_lshlrev_b32 v16, 4, v1
s_cmp_eq_u32 s61, 0
s_cbranch_scc1 L_compute
s_setprio 1
v_mov_b32 v18, v16
s_lshl_b32 s70, s65, 2
s_add_u32 s70, s70, s60
s_lshl_b32 s70, s70, 16
v_lshrrev_b32 v2, 3, v1
v_lshlrev_b32 v5, 11, v2
v_add_u32 v5, s70, v5
v_lshrrev_b32 v3, 4, v1
v_and_b32 v4, 7, v1
v_xor_b32 v3, v3, v4
v_xor_b32 v6, 0, v3
v_lshl_add_u32 v6, v6, 4, v5
v_add_u32 v8, 0, v6
v_xor_b32 v6, 4, v3
v_lshl_add_u32 v6, v6, 4, v5
v_add_u32 v9, 15360, v6
v_xor_b32 v6, 0, v3
v_lshl_add_u32 v6, v6, 4, v5
v_add_u32 v10, 30720, v6
v_xor_b32 v6, 4, v3
v_lshl_add_u32 v6, v6, 4, v5
v_add_u32 v11, 46080, v6
s_lshl_b32 s70, s60, 4
v_add_u32 v5, s70, v2
v_mul_u32_u24 v5, 6144, v5
s_lshl_b32 s70, s64, 7
v_add_u32 v5, s70, v5
v_bfe_u32 v3, v1, 4, 1
v_lshlrev_b32 v3, 1, v3
v_xor_b32 v3, v3, v4
v_xor_b32 v6, 0, v3
v_lshl_add_u32 v6, v6, 4, v5
v_add_u32 v12, 0, v6
v_xor_b32 v6, 4, v3
v_lshl_add_u32 v6, v6, 4, v5
v_add_u32 v13, 48128, v6
v_xor_b32 v6, 0, v3
v_lshl_add_u32 v6, v6, 4, v5
v_add_u32 v14, 0, v6
v_xor_b32 v6, 4, v3
v_lshl_add_u32 v6, v6, 4, v5
v_add_u32 v15, 48128, v6
v_xor_b32 v6, 0, v3
v_lshl_add_u32 v6, v6, 4, v5
v_add_u32 v16, 4096, v6
v_xor_b32 v6, 4, v3
v_lshl_add_u32 v6, v6, 4, v5
v_add_u32 v17, 52224, v6
s_lshl_b32 s76, s60, 12
s_mul_i32 s77, s60, 6144
s_and_b32 s70, s64, 1
s_lshl_b32 s70, s70, 3
s_mov_b32 s70, 0
s_andn2_b32 s71, s65, 1
s_add_u32 s70, s70, s71
s_and_b32 s70, s70, 15
s_mul_i32 s75, s70, 393216
s_lshl_b32 s74, s70, 7
s_waitcnt lgkmcnt(0)
s_load_dword s68, s[58:59], 0
s_mov_b32 s4, s40
s_and_b32 s5, s41, 0xffff
s_mov_b32 s6, 4194304
s_mov_b32 s7, 0x20000
s_mov_b32 s8, s42
s_and_b32 s9, s43, 0xffff
s_mov_b32 s10, 6291456
s_mov_b32 s11, 0x20000
s_add_u32 m0, s76, 122880
s_nop 0
buffer_load_dwordx4 v8, s[4:7], s74 offen offset:0 lds
buffer_load_dwordx4 v9, s[4:7], s74 offen offset:1024 lds
buffer_load_dwordx4 v10, s[4:7], s74 offen offset:2048 lds
buffer_load_dwordx4 v11, s[4:7], s74 offen offset:3072 lds
s_add_u32 s74, s74, 128
s_and_b32 s74, s74, 2047
s_add_u32 m0, s77, 0
s_nop 0
buffer_load_dwordx4 v12, s[8:11], s75 offen offset:0 lds
buffer_load_dwordx4 v13, s[8:11], s75 offen offset:1024 lds
buffer_load_dwordx4 v14, s[8:11], s75 offen offset:2048 lds
buffer_load_dwordx4 v15, s[8:11], s75 offen offset:3072 lds
s_add_u32 m0, s77, 4096
s_nop 0
buffer_load_dwordx4 v16, s[8:11], s75 offen offset:0 lds
buffer_load_dwordx4 v17, s[8:11], s75 offen offset:1024 lds
s_add_u32 s75, s75, 393216
s_cmp_eq_u32 s75, 6291456
s_cselect_b32 s75, 0, s75
s_mov_b32 s12, s58
s_and_b32 s13, s59, 0xffff
s_mov_b32 s14, 268435456
s_mov_b32 s15, 0x20000
s_mov_b32 s16, s44
s_and_b32 s17, s45, 0xffff
s_mov_b32 s18, 2097152
s_mov_b32 s19, 0x20000
s_mov_b32 s20, s56
s_and_b32 s21, s57, 0xffff
s_mov_b32 s22, 4194304
s_mov_b32 s23, 0x20000
s_mov_b32 s24, s50
s_and_b32 s25, s51, 0xffff
s_mov_b32 s26, 7340032
s_mov_b32 s27, 0x20000
s_mov_b32 s28, s52
s_and_b32 s29, s53, 0xffff
s_mov_b32 s30, 7340032
s_mov_b32 s31, 0x20000
s_mov_b32 s32, s54
s_and_b32 s33, s55, 0xffff
s_mov_b32 s34, 7340032
s_mov_b32 s35, 0x20000
s_mov_b32 s36, s48
s_and_b32 s37, s49, 0xffff
s_mov_b32 s38, 2048
s_mov_b32 s39, 0x20000
s_lshl_b32 s70, s65, 7
s_lshl_b32 s71, s64, 3
s_add_u32 s70, s70, s71
s_lshl_b32 s71, s60, 1
s_add_u32 s87, s70, s71
v_lshrrev_b32 v2, 3, v1
v_lshlrev_b32 v3, 11, v2
v_bfe_u32 v5, v1, 4, 2
v_lshlrev_b32 v5, 1, v5
v_and_b32 v4, 7, v1
v_xor_b32 v5, v5, v4
v_lshl_add_u32 v3, v5, 4, v3
s_lshl_b32 s70, s65, 7
v_add_u32 v80, s70, v3
v_mov_b32 v72, -1
v_mov_b32 v73, -1
v_mov_b32 v74, -1
v_mov_b32 v75, -1
s_mul_i32 s80, s79, 4352
s_add_u32 s80, s80, 524288
s_lshl_b32 s81, s65, 18
s_lshl_b32 s70, s66, 17
s_add_u32 s81, s81, s70
s_lshl_b32 s70, s64, 11
s_add_u32 s81, s81, s70
s_lshl_b32 s70, s67, 10
s_add_u32 s81, s81, s70
s_add_u32 s81, s81, 2097152
s_mov_b32 s72, 0x6543e210
s_mov_b32 s73, 0xdcbaf987
s_lshl_b32 s70, s64, 2
s_lshr_b64 s[72:73], s[72:73], s70
s_and_b32 s3, s72, 15
v_mul_u32_u24 v76, 7168, v2
v_lshl_add_u32 v76, v4, 4, v76
v_lshlrev_b32 v77, 11, v2
v_lshl_add_u32 v77, v4, 4, v77
s_and_b32 s70, s65, 3
s_lshl_b32 s70, s70, 2
s_add_u32 s70, s70, s60
s_mul_i32 s85, s70, 458752
s_lshl_b32 s70, s3, 9
s_add_u32 s85, s85, s70
s_lshr_b32 s70, s65, 2
s_lshl_b32 s70, s70, 7
s_xor_b32 s71, s70, 128
v_add_u32 v78, s71, v76
v_add_u32 v76, s70, v76
s_and_b32 s70, s65, 3
s_lshl2_add_u32 s70, s3, s70
s_and_b32 s71, s65, 12
s_add_u32 s71, s71, s60
s_lshl_b32 s86, s70, 17
s_lshl_b32 s70, s71, 7
s_add_u32 s86, s86, s70
s_cmp_lt_u32 s3, 14
s_cselect_b32 s26, s26, 0
s_cselect_b32 s30, s30, 0
s_cselect_b32 s34, s34, 0
s_mov_b32 s90, 0x10001
s_movk_i32 s91, 0xff
v_mov_b32 v79, 0
s_lshl_b32 s70, s87, 4
s_add_u32 s70, s70, 8192
v_writelane_b32 v79, s70, 0
s_lshl_b32 s70, s79, 4
s_add_u32 s70, s70, 4096
v_writelane_b32 v79, s70, 1
s_lshl_b32 s70, s64, 7
s_add_u32 s70, s70, 6815744
v_writelane_b32 v79, s70, 2
s_lshl_b32 s70, s79, 10
s_add_u32 s70, s70, 65536
v_writelane_b32 v79, s70, 3
s_lshl_b32 s70, s60, 10
s_add_u32 s70, s70, s80
v_writelane_b32 v79, s70, 4
s_lshl_b32 s70, s67, 7
s_add_u32 s70, s70, s80
s_add_u32 s70, s70, 4096
v_writelane_b32 v79, s70, 5
s_and_b32 s71, s65, 3
s_lshl2_add_u32 s71, s3, s71
s_and_b32 s70, s65, 12
s_add_u32 s70, s70, s60
s_lshl_b32 s71, s71, 7
s_lshl_b32 s70, s70, 15
s_add_u32 s70, s70, s71
s_add_u32 s70, s70, 7340032
v_writelane_b32 v79, s70, 6
s_lshl_b32 s71, s79, 2
s_add_u32 s71, s71, s60
s_lshl_b32 s70, s71, 9
s_add_u32 s70, s70, 6291456
v_writelane_b32 v79, s70, 7
s_lshl_b32 s71, s79, 2
s_add_u32 s71, s71, s60
s_lshl_b32 s70, s71, 8
s_add_u32 s70, s70, 6946816
v_writelane_b32 v79, s70, 8
s_add_u32 s70, s81, 0
v_writelane_b32 v79, s70, 9
s_add_u32 s70, s81, 32768
v_writelane_b32 v79, s70, 10
s_add_u32 s70, s81, 65536
v_writelane_b32 v79, s70, 11
s_add_u32 s70, s81, 98304
v_writelane_b32 v79, s70, 12
s_and_b32 s70, s65, 7
s_min_u32 s71, s60, 0
s_lshl_b32 s71, s71, 3
s_add_u32 s70, s70, s71
s_lshl_b32 s70, s70, 4
s_add_u32 s70, s70, s64
s_lshl_b32 s70, s70, 7
s_add_u32 s70, s70, 6815744
v_writelane_b32 v79, s70, 2
v_and_b32 v2, 7, v1
v_lshlrev_b32 v2, 7, v2
v_lshrrev_b32 v3, 3, v1
v_lshl_add_u32 v83, v3, 15, v2
v_add_u32 v83, s81, v83
s_mov_b32 exec_lo, 0
s_and_b32 s71, s65, 3
s_lshl2_add_u32 s71, s3, s71
s_and_b32 s70, s65, 12
s_add_u32 s70, s70, s60
s_lshl_b32 s71, s71, 7
s_lshl_b32 s70, s70, 15
s_add_u32 s70, s70, s71
s_add_u32 s70, s70, 7340032
s_mov_b32 exec_hi, 0xff
v_and_b32 v2, 3, v1
v_lshl_add_u32 v83, v2, 13, s70
s_lshl_b32 s70, s60, 10
s_add_u32 s70, s70, s80
s_mov_b32 exec_hi, 0xff0000
v_and_b32 v2, 7, v1
v_lshl_add_u32 v83, v2, 7, s70
s_lshl_b32 s71, s79, 2
s_add_u32 s71, s71, s60
s_lshl_b32 s70, s71, 9
s_add_u32 s70, s70, 6291456
s_mov_b32 exec_hi, 0xf000000
v_and_b32 v2, 3, v1
v_lshl_add_u32 v83, v2, 7, s70
s_lshl_b32 s71, s79, 2
s_add_u32 s71, s71, s60
s_lshl_b32 s70, s71, 8
s_add_u32 s70, s70, 6946816
s_mov_b32 exec_hi, 0x30000000
v_and_b32 v2, 1, v1
v_lshl_add_u32 v83, v2, 7, s70
s_lshl_b32 s70, s67, 7
s_add_u32 s70, s70, s80
s_add_u32 s70, s70, 4096
s_mov_b32 exec_hi, 0xc0000000
v_and_b32 v2, 0, v1
v_lshl_add_u32 v83, v2, 7, s70
s_mov_b64 exec, -1
s_add_u32 m0, s76, 106496
s_nop 0
buffer_load_dwordx4 v8, s[4:7], s74 offen offset:0 lds
buffer_load_dwordx4 v9, s[4:7], s74 offen offset:1024 lds
buffer_load_dwordx4 v10, s[4:7], s74 offen offset:2048 lds
buffer_load_dwordx4 v11, s[4:7], s74 offen offset:3072 lds
s_add_u32 s74, s74, 128
s_and_b32 s74, s74, 2047
s_add_u32 m0, s77, 81920
s_nop 0
buffer_load_dwordx4 v12, s[8:11], s75 offen offset:0 lds
buffer_load_dwordx4 v13, s[8:11], s75 offen offset:1024 lds
buffer_load_dwordx4 v14, s[8:11], s75 offen offset:2048 lds
buffer_load_dwordx4 v15, s[8:11], s75 offen offset:3072 lds
s_add_u32 m0, s77, 86016
s_nop 0
buffer_load_dwordx4 v16, s[8:11], s75 offen offset:0 lds
buffer_load_dwordx4 v17, s[8:11], s75 offen offset:1024 lds
s_add_u32 s75, s75, 393216
s_cmp_eq_u32 s75, 6291456
s_cselect_b32 s75, 0, s75
s_waitcnt vmcnt(10)
s_barrier
s_add_u32 m0, s76, 65536
s_nop 0
buffer_load_dwordx4 v8, s[4:7], s74 offen offset:0 lds
buffer_load_dwordx4 v9, s[4:7], s74 offen offset:1024 lds
buffer_load_dwordx4 v10, s[4:7], s74 offen offset:2048 lds
buffer_load_dwordx4 v11, s[4:7], s74 offen offset:3072 lds
s_add_u32 s74, s74, 128
s_and_b32 s74, s74, 2047
s_add_u32 m0, s77, 40960
s_nop 0
buffer_load_dwordx4 v12, s[8:11], s75 offen offset:0 lds
buffer_load_dwordx4 v13, s[8:11], s75 offen offset:1024 lds
buffer_load_dwordx4 v14, s[8:11], s75 offen offset:2048 lds
buffer_load_dwordx4 v15, s[8:11], s75 offen offset:3072 lds
s_add_u32 m0, s77, 45056
s_nop 0
buffer_load_dwordx4 v16, s[8:11], s75 offen offset:0 lds
buffer_load_dwordx4 v17, s[8:11], s75 offen offset:1024 lds
s_add_u32 s75, s75, 393216
s_cmp_eq_u32 s75, 6291456
s_cselect_b32 s75, 0, s75
s_waitcnt vmcnt(10)
s_barrier
s_add_u32 m0, s76, 24576
s_nop 0
buffer_load_dwordx4 v8, s[4:7], s74 offen offset:0 lds
buffer_load_dwordx4 v9, s[4:7], s74 offen offset:1024 lds
buffer_load_dwordx4 v10, s[4:7], s74 offen offset:2048 lds
buffer_load_dwordx4 v11, s[4:7], s74 offen offset:3072 lds
s_add_u32 s74, s74, 128
s_and_b32 s74, s74, 2047
s_add_u32 m0, s77, 0
s_nop 0
buffer_load_dwordx4 v12, s[8:11], s75 offen offset:0 lds
buffer_load_dwordx4 v13, s[8:11], s75 offen offset:1024 lds
buffer_load_dwordx4 v14, s[8:11], s75 offen offset:2048 lds
buffer_load_dwordx4 v15, s[8:11], s75 offen offset:3072 lds
s_add_u32 m0, s77, 4096
s_nop 0
buffer_load_dwordx4 v16, s[8:11], s75 offen offset:0 lds
buffer_load_dwordx4 v17, s[8:11], s75 offen offset:1024 lds
s_add_u32 s75, s75, 393216
s_cmp_eq_u32 s75, 6291456
s_cselect_b32 s75, 0, s75
s_add_u32 m0, s76, 122880
s_nop 0
buffer_load_dwordx4 v8, s[4:7], s74 offen offset:0 lds
buffer_load_dwordx4 v9, s[4:7], s74 offen offset:1024 lds
buffer_load_dwordx4 v10, s[4:7], s74 offen offset:2048 lds
buffer_load_dwordx4 v11, s[4:7], s74 offen offset:3072 lds
s_add_u32 s74, s74, 128
s_and_b32 s74, s74, 2047
v_lshlrev_b32 v2, 3, v1
s_lshl_b32 s70, s60, 9
buffer_load_dwordx2 v[88:89], v2, s[36:39], s70 offen
s_lshl_b32 s70, s87, 11
buffer_load_dwordx4 v[20:23], v18, s[4:7], s70 offen offset:0
s_lshl_b32 s70, s87, 11
buffer_load_dwordx4 v[24:27], v18, s[4:7], s70 offen offset:1024
s_lshl_b32 s70, s87, 11
buffer_load_dwordx4 v[28:31], v18, s[4:7], s70 offen offset:2048
s_lshl_b32 s70, s87, 11
buffer_load_dwordx4 v[32:35], v18, s[4:7], s70 offen offset:3072
s_mov_b64 exec, 0x1ef
buffer_load_dword v81, v79, s[12:15], 0 offen
s_mov_b64 exec, -1
s_lshl_b32 s70, s64, 2
s_add_u32 s70, s70, s60
s_lshl_b32 s70, s70, 12
s_lshl_b32 s71, s65, 7
s_add_u32 s70, s70, s71
s_add_u32 s70, s70, 7864320
s_mov_b64 exec, 0xffff
buffer_store_dwordx4 v[72:75], v77, s[12:15], s70 offen sc1
s_mov_b64 exec, -1
s_waitcnt vmcnt(21)
s_barrier
s_add_u32 m0, s77, 81920
s_nop 0
buffer_load_dwordx4 v12, s[8:11], s75 offen offset:0 lds
buffer_load_dwordx4 v13, s[8:11], s75 offen offset:1024 lds
buffer_load_dwordx4 v14, s[8:11], s75 offen offset:2048 lds
buffer_load_dwordx4 v15, s[8:11], s75 offen offset:3072 lds
s_add_u32 m0, s77, 86016
s_nop 0
buffer_load_dwordx4 v16, s[8:11], s75 offen offset:0 lds
buffer_load_dwordx4 v17, s[8:11], s75 offen offset:1024 lds
s_add_u32 s75, s75, 393216
s_cmp_eq_u32 s75, 6291456
s_cselect_b32 s75, 0, s75
s_add_u32 m0, s76, 106496
s_nop 0
buffer_load_dwordx4 v8, s[4:7], s74 offen offset:0 lds
buffer_load_dwordx4 v9, s[4:7], s74 offen offset:1024 lds
buffer_load_dwordx4 v10, s[4:7], s74 offen offset:2048 lds
buffer_load_dwordx4 v11, s[4:7], s74 offen offset:3072 lds
s_add_u32 s74, s74, 128
s_and_b32 s74, s74, 2047
s_waitcnt vmcnt(21)
s_barrier
s_add_u32 m0, s77, 40960
s_nop 0
buffer_load_dwordx4 v12, s[8:11], s75 offen offset:0 lds
s_waitcnt vmcnt(13)
s_waitcnt lgkmcnt(0)
s_add_u32 s68, s68, 1
s_and_b32 s84, s68, 0xff
s_not_b32 s70, s68
v_and_b32 v82, 3, v1
v_lshrrev_b32_e64 v82, v82, s70
v_and_b32 v82, 1, v82
v_mul_u32_u24 v82, 0x10001, v82
buffer_load_dwordx4 v13, s[8:11], s75 offen offset:1024 lds
v_lshlrev_b32 v36, 16, v20
v_and_b32 v37, 0xffff0000, v20
v_lshlrev_b32 v38, 16, v21
v_and_b32 v39, 0xffff0000, v21
v_lshlrev_b32 v40, 16, v22
buffer_load_dwordx4 v14, s[8:11], s75 offen offset:2048 lds
v_and_b32 v41, 0xffff0000, v22
v_lshlrev_b32 v42, 16, v23
v_and_b32 v43, 0xffff0000, v23
v_lshlrev_b32 v44, 16, v24
v_and_b32 v45, 0xffff0000, v24
buffer_load_dwordx4 v15, s[8:11], s75 offen offset:3072 lds
v_lshlrev_b32 v46, 16, v25
v_and_b32 v47, 0xffff0000, v25
v_lshlrev_b32 v48, 16, v26
v_and_b32 v49, 0xffff0000, v26
v_lshlrev_b32 v50, 16, v27
s_add_u32 m0, s77, 45056
s_nop 0
buffer_load_dwordx4 v16, s[8:11], s75 offen offset:0 lds
v_and_b32 v51, 0xffff0000, v27
v_lshlrev_b32 v52, 16, v28
v_and_b32 v53, 0xffff0000, v28
v_lshlrev_b32 v54, 16, v29
v_and_b32 v55, 0xffff0000, v29
buffer_load_dwordx4 v17, s[8:11], s75 offen offset:1024 lds
s_add_u32 s75, s75, 393216
s_cmp_eq_u32 s75, 6291456
s_cselect_b32 s75, 0, s75
v_lshlrev_b32 v56, 16, v30
v_and_b32 v57, 0xffff0000, v30
v_lshlrev_b32 v58, 16, v31
v_and_b32 v59, 0xffff0000, v31
v_lshlrev_b32 v60, 16, v32
s_add_u32 m0, s76, 65536
s_nop 0
buffer_load_dwordx4 v8, s[4:7], s74 offen offset:0 lds
v_and_b32 v61, 0xffff0000, v32
v_lshlrev_b32 v62, 16, v33
v_and_b32 v63, 0xffff0000, v33
v_lshlrev_b32 v64, 16, v34
v_and_b32 v65, 0xffff0000, v34
buffer_load_dwordx4 v9, s[4:7], s74 offen offset:1024 lds
v_lshlrev_b32 v66, 16, v35
v_and_b32 v67, 0xffff0000, v35
v_add_f32 v20, v36, v40
v_add_f32 v28, v52, v56
v_add_f32 v21, v37, v41
buffer_load_dwordx4 v10, s[4:7], s74 offen offset:2048 lds
v_add_f32 v29, v53, v57
v_add_f32 v22, v38, v42
v_add_f32 v30, v54, v58
v_add_f32 v23, v39, v43
v_add_f32 v31, v55, v59
buffer_load_dwordx4 v11, s[4:7], s74 offen offset:3072 lds
s_add_u32 s74, s74, 128
s_and_b32 s74, s74, 2047
v_add_f32 v20, v20, v44
v_add_f32 v28, v28, v60
s_waitcnt vmcnt(14)
s_barrier
s_add_u32 m0, s77, 0
s_nop 0
buffer_load_dwordx4 v12, s[8:11], s75 offen offset:0 lds
v_add_f32 v21, v21, v45
v_add_f32 v29, v29, v61
v_add_f32 v22, v22, v46
v_add_f32 v30, v30, v62
v_add_f32 v23, v23, v47
buffer_load_dwordx4 v13, s[8:11], s75 offen offset:1024 lds
v_add_f32 v31, v31, v63
v_add_f32 v20, v20, v48
v_add_f32 v28, v28, v64
v_add_f32 v21, v21, v49
v_add_f32 v29, v29, v65
buffer_load_dwordx4 v14, s[8:11], s75 offen offset:2048 lds
v_add_f32 v22, v22, v50
v_add_f32 v30, v30, v66
v_add_f32 v23, v23, v51
v_add_f32 v31, v31, v67
v_add_f32 v20, v20, v21
buffer_load_dwordx4 v15, s[8:11], s75 offen offset:3072 lds
v_add_f32 v22, v22, v23
v_add_f32 v28, v28, v29
v_add_f32 v30, v30, v31
v_add_f32 v2, v20, v22
v_add_f32 v4, v28, v30
s_add_u32 m0, s77, 4096
s_nop 0
buffer_load_dwordx4 v16, s[8:11], s75 offen offset:0 lds
v_add_f32_dpp v2, v2, v2 row_ror:1 row_mask:0xf bank_mask:0xf
v_add_f32_dpp v4, v4, v4 row_ror:1 row_mask:0xf bank_mask:0xf
s_nop 0
v_add_f32_dpp v2, v2, v2 row_ror:2 row_mask:0xf bank_mask:0xf
v_add_f32_dpp v4, v4, v4 row_ror:2 row_mask:0xf bank_mask:0xf
s_nop 0
v_add_f32_dpp v2, v2, v2 row_ror:4 row_mask:0xf bank_mask:0xf
buffer_load_dwordx4 v17, s[8:11], s75 offen offset:1024 lds
s_add_u32 s75, s75, 393216
s_cmp_eq_u32 s75, 6291456
s_cselect_b32 s75, 0, s75
v_add_f32_dpp v4, v4, v4 row_ror:4 row_mask:0xf bank_mask:0xf
v_add_f32_dpp v2, v2, v2 row_ror:8 row_mask:0xf bank_mask:0xf
s_nop 0
v_add_f32_dpp v4, v4, v4 row_ror:8 row_mask:0xf bank_mask:0xf
v_mov_b32 v6, v2
v_mov_b32 v7, v4
s_add_u32 m0, s76, 24576
s_nop 0
buffer_load_dwordx4 v8, s[4:7], s74 offen offset:0 lds
v_permlane16_swap_b32 v2, v6
v_permlane16_swap_b32 v4, v7
v_add_f32 v2, v2, v6
v_add_f32 v4, v4, v7
v_mov_b32 v6, v2
buffer_load_dwordx4 v9, s[4:7], s74 offen offset:1024 lds
v_mov_b32 v7, v4
v_permlane32_swap_b32 v2, v6
s_nop 0
v_permlane32_swap_b32 v4, v7
v_add_f32 v2, v2, v6
v_add_f32 v4, v4, v7
buffer_load_dwordx4 v10, s[4:7], s74 offen offset:2048 lds
v_mul_f32 v2, 0xba800000, v2
v_mul_f32 v4, 0xba800000, v4
v_add_f32 v36, v36, v2
v_add_f32 v52, v52, v4
v_add_f32 v37, v37, v2
buffer_load_dwordx4 v11, s[4:7], s74 offen offset:3072 lds
s_add_u32 s74, s74, 128
s_and_b32 s74, s74, 2047
v_add_f32 v53, v53, v4
v_add_f32 v38, v38, v2
s_cmp_eq_u32 s60, 0
s_cbranch_scc1 L_pad0
s_cmp_eq_u32 s60, 1
s_cbranch_scc1 L_pad3
s_cmp_eq_u32 s60, 2
s_cbranch_scc1 L_pad4
s_branch L_ret4
L_ret4:
s_waitcnt vmcnt(14)
s_barrier
s_add_u32 m0, s77, 81920
s_nop 0
buffer_load_dwordx4 v12, s[8:11], s75 offen offset:0 lds
v_add_f32 v54, v54, v4
v_add_f32 v39, v39, v2
v_add_f32 v55, v55, v4
v_add_f32 v40, v40, v2
v_add_f32 v56, v56, v4
buffer_load_dwordx4 v13, s[8:11], s75 offen offset:1024 lds
v_add_f32 v41, v41, v2
v_add_f32 v57, v57, v4
v_add_f32 v42, v42, v2
v_add_f32 v58, v58, v4
v_add_f32 v43, v43, v2
buffer_load_dwordx4 v14, s[8:11], s75 offen offset:2048 lds
v_add_f32 v59, v59, v4
v_add_f32 v44, v44, v2
v_add_f32 v60, v60, v4
v_add_f32 v45, v45, v2
v_add_f32 v61, v61, v4
buffer_load_dwordx4 v15, s[8:11], s75 offen offset:3072 lds
v_add_f32 v46, v46, v2
v_add_f32 v62, v62, v4
v_add_f32 v47, v47, v2
v_add_f32 v63, v63, v4
v_add_f32 v48, v48, v2
s_add_u32 m0, s77, 86016
s_nop 0
buffer_load_dwordx4 v16, s[8:11], s75 offen offset:0 lds
v_add_f32 v64, v64, v4
v_add_f32 v49, v49, v2
v_add_f32 v65, v65, v4
v_add_f32 v50, v50, v2
v_add_f32 v66, v66, v4
buffer_load_dwordx4 v17, s[8:11], s75 offen offset:1024 lds
s_add_u32 s75, s75, 393216
s_cmp_eq_u32 s75, 6291456
s_cselect_b32 s75, 0, s75
v_add_f32 v51, v51, v2
v_add_f32 v67, v67, v4
v_mul_f32 v20, v36, v36
v_mul_f32 v28, v52, v52
v_mul_f32 v21, v37, v37
s_add_u32 m0, s76, 122880
s_nop 0
buffer_load_dwordx4 v8, s[4:7], s74 offen offset:0 lds
v_mul_f32 v29, v53, v53
v_fmac_f32 v20, v38, v38
v_fmac_f32 v28, v54, v54
v_fmac_f32 v21, v39, v39
v_fmac_f32 v29, v55, v55
buffer_load_dwordx4 v9, s[4:7], s74 offen offset:1024 lds
v_fmac_f32 v20, v40, v40
v_fmac_f32 v28, v56, v56
v_fmac_f32 v21, v41, v41
v_fmac_f32 v29, v57, v57
v_fmac_f32 v20, v42, v42
buffer_load_dwordx4 v10, s[4:7], s74 offen offset:2048 lds
v_fmac_f32 v28, v58, v58
v_fmac_f32 v21, v43, v43
v_fmac_f32 v29, v59, v59
v_fmac_f32 v20, v44, v44
v_fmac_f32 v28, v60, v60
buffer_load_dwordx4 v11, s[4:7], s74 offen offset:3072 lds
s_add_u32 s74, s74, 128
s_and_b32 s74, s74, 2047
v_fmac_f32 v21, v45, v45
v_fmac_f32 v29, v61, v61
s_waitcnt vmcnt(14)
s_barrier
s_add_u32 m0, s77, 40960
s_nop 0
buffer_load_dwordx4 v12, s[8:11], s75 offen offset:0 lds
v_fmac_f32 v20, v46, v46
v_fmac_f32 v28, v62, v62
v_fmac_f32 v21, v47, v47
v_fmac_f32 v29, v63, v63
v_fmac_f32 v20, v48, v48
buffer_load_dwordx4 v13, s[8:11], s75 offen offset:1024 lds
v_fmac_f32 v28, v64, v64
v_fmac_f32 v21, v49, v49
v_fmac_f32 v29, v65, v65
v_fmac_f32 v20, v50, v50
v_fmac_f32 v28, v66, v66
buffer_load_dwordx4 v14, s[8:11], s75 offen offset:2048 lds
v_fmac_f32 v21, v51, v51
v_fmac_f32 v29, v67, v67
v_add_f32 v3, v20, v21
v_add_f32 v5, v28, v29
s_nop 0
v_add_f32_dpp v3, v3, v3 row_ror:1 row_mask:0xf bank_mask:0xf
buffer_load_dwordx4 v15, s[8:11], s75 offen offset:3072 lds
v_add_f32_dpp v5, v5, v5 row_ror:1 row_mask:0xf bank_mask:0xf
v_add_f32_dpp v3, v3, v3 row_ror:2 row_mask:0xf bank_mask:0xf
s_nop 0
v_add_f32_dpp v5, v5, v5 row_ror:2 row_mask:0xf bank_mask:0xf
v_add_f32_dpp v3, v3, v3 row_ror:4 row_mask:0xf bank_mask:0xf
s_nop 0
v_add_f32_dpp v5, v5, v5 row_ror:4 row_mask:0xf bank_mask:0xf
s_add_u32 m0, s77, 45056
s_nop 0
buffer_load_dwordx4 v16, s[8:11], s75 offen offset:0 lds
v_add_f32_dpp v3, v3, v3 row_ror:8 row_mask:0xf bank_mask:0xf
v_add_f32_dpp v5, v5, v5 row_ror:8 row_mask:0xf bank_mask:0xf
v_mov_b32 v6, v3
v_mov_b32 v7, v5
s_nop 0
v_permlane16_swap_b32 v3, v6
buffer_load_dwordx4 v17, s[8:11], s75 offen offset:1024 lds
s_add_u32 s75, s75, 393216
s_cmp_eq_u32 s75, 6291456
s_cselect_b32 s75, 0, s75
v_permlane16_swap_b32 v5, v7
v_add_f32 v3, v3, v6
v_add_f32 v5, v5, v7
v_mov_b32 v6, v3
v_mov_b32 v7, v5
s_add_u32 m0, s76, 106496
s_branch L_over0
L_pad0:
s_branch L_ret4
L_over0:
s_nop 0
buffer_load_dwordx4 v8, s[4:7], s74 offen offset:0 lds
v_permlane32_swap_b32 v3, v6
v_permlane32_swap_b32 v5, v7
v_add_f32 v3, v3, v6
v_add_f32 v5, v5, v7
v_mov_b32 v6, 0x3727c5ac
buffer_load_dwordx4 v9, s[4:7], s74 offen offset:1024 lds
v_fmac_f32 v6, 0x3a800000, v3
v_rsq_f32 v3, v6
v_mov_b32 v6, 0x3727c5ac
v_fmac_f32 v6, 0x3a800000, v5
v_rsq_f32 v5, v6
buffer_load_dwordx4 v10, s[4:7], s74 offen offset:2048 lds
v_cmp_eq_u32 vcc, 1, v1
s_nop 1
v_cndmask_b32 v20, v2, v4, vcc
v_cndmask_b32 v21, v3, v5, vcc
v_mov_b32 v22, 0
v_mov_b32 v23, s68
buffer_load_dwordx4 v11, s[4:7], s74 offen offset:3072 lds
s_add_u32 s74, s74, 128
s_and_b32 s74, s74, 2047
buffer_load_dwordx4 a[0:3], v76, s[24:27], s85 offen nt
buffer_load_dwordx4 a[32:35], v78, s[28:31], s85 offen nt
s_add_u32 s85, s85, 57344
buffer_load_dwordx4 a[4:7], v76, s[24:27], s85 offen nt
buffer_load_dwordx4 a[36:39], v78, s[28:31], s85 offen nt
s_add_u32 s85, s85, 57344
buffer_load_dwordx4 a[8:11], v76, s[24:27], s85 offen nt
buffer_load_dwordx4 a[40:43], v78, s[28:31], s85 offen nt
s_add_u32 s85, s85, 57344
s_lshl_b32 s70, s87, 4
s_add_u32 s70, s70, 8192
s_mov_b64 exec, 3
buffer_store_dwordx4 v[20:23], v18, s[12:15], s70 offen sc1
s_mov_b64 exec, -1
s_waitcnt vmcnt(21)
s_barrier
s_add_u32 m0, s77, 0
s_nop 0
buffer_load_dwordx4 v12, s[8:11], s75 offen offset:0 lds
v_lshlrev_b32 v2, 16, v88
v_and_b32 v3, 0xffff0000, v88
v_lshlrev_b32 v4, 16, v89
buffer_load_dwordx4 v13, s[8:11], s75 offen offset:1024 lds
v_and_b32 v5, 0xffff0000, v89
v_add_f32 v2, v2, v3
v_add_f32 v4, v4, v5
buffer_load_dwordx4 v14, s[8:11], s75 offen offset:2048 lds
v_add_f32 v2, v2, v4
s_nop 1
v_add_f32_dpp v2, v2, v2 row_ror:1 row_mask:0xf bank_mask:0xf
s_nop 1
v_add_f32_dpp v2, v2, v2 row_ror:2 row_mask:0xf bank_mask:0xf
buffer_load_dwordx4 v15, s[8:11], s75 offen offset:3072 lds
s_nop 0
v_add_f32_dpp v2, v2, v2 row_ror:4 row_mask:0xf bank_mask:0xf
s_nop 1
v_add_f32_dpp v2, v2, v2 row_ror:8 row_mask:0xf bank_mask:0xf
v_mov_b32 v3, v2
s_add_u32 m0, s77, 4096
s_nop 0
buffer_load_dwordx4 v16, s[8:11], s75 offen offset:0 lds
v_permlane16_swap_b32 v2, v3
v_add_f32 v2, v2, v3
v_mov_b32 v3, v2
buffer_load_dwordx4 v17, s[8:11], s75 offen offset:1024 lds
s_add_u32 s75, s75, 393216
s_cmp_eq_u32 s75, 6291456
s_cselect_b32 s75, 0, s75
v_permlane32_swap_b32 v2, v3
v_add_f32 v2, v2, v3
s_lshl_b32 s70, s60, 2
s_add_u32 s70, s70, 162176
v_mov_b32 v3, s70
s_add_u32 m0, s76, 65536
s_nop 0
buffer_load_dwordx4 v8, s[4:7], s74 offen offset:0 lds
ds_write_b32 v3, v2
s_lshl_b32 s70, s60, 2
s_sub_u32 s70, s70, s65
s_lshl_b32 s70, s70, 4
v_add_u32 v4, s70, v1
v_min_u32 v4, 18, v4
buffer_load_dwordx4 v9, s[4:7], s74 offen offset:1024 lds
v_cmp_gt_u32 vcc, 16, v4
s_nop 1
v_cndmask_b32 v4, 18, v4, vcc
v_lshlrev_b32 v4, 3, v4
buffer_load_dwordx4 v10, s[4:7], s74 offen offset:2048 lds
v_add_u32 v4, 162048, v4
ds_write_b64 v4, v[88:89]
buffer_load_dwordx4 v11, s[4:7], s74 offen offset:3072 lds
s_add_u32 s74, s74, 128
s_and_b32 s74, s74, 2047
s_waitcnt vmcnt(21)
s_barrier
s_add_u32 m0, s77, 81920
s_nop 0
buffer_load_dwordx4 v12, s[8:11], s75 offen offset:0 lds
s_getreg_b32 s71, hwreg(HW_REG_XCC_ID, 0, 4)
v_mov_b32 v84, s71
buffer_load_dwordx4 v13, s[8:11], s75 offen offset:1024 lds
v_mov_b32 v85, 0
buffer_load_dwordx4 v14, s[8:11], s75 offen offset:2048 lds
v_mov_b32 v86, 0
buffer_load_dwordx4 v15, s[8:11], s75 offen offset:3072 lds
v_mov_b32 v87, s68
s_add_u32 m0, s77, 86016
s_nop 0
buffer_load_dwordx4 v16, s[8:11], s75 offen offset:0 lds
s_lshl_b32 s70, s79, 4
s_add_u32 s70, s70, 4096
v_mov_b32 v19, s70
buffer_load_dwordx4 v17, s[8:11], s75 offen offset:1024 lds
s_add_u32 s75, s75, 393216
s_cmp_eq_u32 s75, 6291456
s_cselect_b32 s75, 0, s75
s_lshl_b32 s70, s65, 4
s_add_u32 s70, s70, s64
s_lshl_b32 s70, s70, 4
s_add_u32 s70, s70, 40960
v_writelane_b32 v19, s70, 1
s_add_u32 m0, s76, 24576
s_nop 0
buffer_load_dwordx4 v8, s[4:7], s74 offen offset:0 lds
buffer_load_dwordx4 v9, s[4:7], s74 offen offset:1024 lds
buffer_load_dwordx4 v10, s[4:7], s74 offen offset:2048 lds
buffer_load_dwordx4 v11, s[4:7], s74 offen offset:3072 lds
s_add_u32 s74, s74, 128
s_and_b32 s74, s74, 2047
buffer_load_dwordx4 a[12:15], v76, s[24:27], s85 offen nt
buffer_load_dwordx4 a[44:47], v78, s[28:31], s85 offen nt
s_add_u32 s85, s85, 57344
buffer_load_dwordx4 a[16:19], v76, s[24:27], s85 offen nt
buffer_load_dwordx4 a[48:51], v78, s[28:31], s85 offen nt
s_add_u32 s85, s85, 57344
buffer_load_dwordx4 a[20:23], v76, s[24:27], s85 offen nt
buffer_load_dwordx4 a[52:55], v78, s[28:31], s85 offen nt
s_add_u32 s85, s85, 57344
s_mov_b64 exec, 3
buffer_store_dwordx4 v[84:87], v19, s[12:15], 0 offen sc1
s_mov_b64 exec, -1
s_waitcnt vmcnt(21)
s_barrier
s_add_u32 m0, s77, 40960
s_nop 0
buffer_load_dwordx4 v12, s[8:11], s75 offen offset:0 lds
buffer_load_dwordx4 v13, s[8:11], s75 offen offset:1024 lds
buffer_load_dwordx4 v14, s[8:11], s75 offen offset:2048 lds
buffer_load_dwordx4 v15, s[8:11], s75 offen offset:3072 lds
s_add_u32 m0, s77, 45056
s_nop 0
buffer_load_dwordx4 v16, s[8:11], s75 offen offset:0 lds
buffer_load_dwordx4 v17, s[8:11], s75 offen offset:1024 lds
s_add_u32 s75, s75, 393216
s_cmp_eq_u32 s75, 6291456
s_cselect_b32 s75, 0, s75
s_add_u32 m0, s76, 122880
s_nop 0
buffer_load_dwordx4 v8, s[4:7], s74 offen offset:0 lds
buffer_load_dwordx4 v9, s[4:7], s74 offen offset:1024 lds
buffer_load_dwordx4 v10, s[4:7], s74 offen offset:2048 lds
buffer_load_dwordx4 v11, s[4:7], s74 offen offset:3072 lds
s_add_u32 s74, s74, 128
s_and_b32 s74, s74, 2047
s_cmp_eq_u32 s60, 0
s_cbranch_scc1 L_pad5
s_cmp_eq_u32 s60, 1
s_cbranch_scc1 L_ret9
s_cmp_eq_u32 s60, 2
s_cbranch_scc1 L_ret9
s_branch L_ret9
L_ret9:
s_waitcnt vmcnt(21)
s_barrier
s_add_u32 m0, s77, 0
s_nop 0
buffer_load_dwordx4 v12, s[8:11], s75 offen offset:0 lds
buffer_load_dwordx4 v13, s[8:11], s75 offen offset:1024 lds
buffer_load_dwordx4 v14, s[8:11], s75 offen offset:2048 lds
buffer_load_dwordx4 v15, s[8:11], s75 offen offset:3072 lds
s_add_u32 m0, s77, 4096
s_nop 0
buffer_load_dwordx4 v16, s[8:11], s75 offen offset:0 lds
buffer_load_dwordx4 v17, s[8:11], s75 offen offset:1024 lds
s_add_u32 s75, s75, 393216
s_cmp_eq_u32 s75, 6291456
s_cselect_b32 s75, 0, s75
s_add_u32 m0, s76, 106496
s_nop 0
buffer_load_dwordx4 v8, s[4:7], s74 offen offset:0 lds
buffer_load_dwordx4 v9, s[4:7], s74 offen offset:1024 lds
buffer_load_dwordx4 v10, s[4:7], s74 offen offset:2048 lds
buffer_load_dwordx4 v11, s[4:7], s74 offen offset:3072 lds
s_add_u32 s74, s74, 128
s_and_b32 s74, s74, 2047
buffer_load_dwordx4 a[24:27], v76, s[24:27], s85 offen nt
buffer_load_dwordx4 a[56:59], v78, s[28:31], s85 offen nt
s_add_u32 s85, s85, 57344
buffer_load_dwordx4 a[28:31], v76, s[24:27], s85 offen nt
buffer_load_dwordx4 a[60:63], v78, s[28:31], s85 offen nt
s_add_u32 s85, s85, 57344
buffer_load_dwordx4 a[64:67], v77, s[32:35], s86 offen nt
s_add_u32 s86, s86, 16384
buffer_load_dwordx4 a[68:71], v77, s[32:35], s86 offen nt
s_add_u32 s86, s86, 16384
s_waitcnt vmcnt(20)
s_barrier
s_add_u32 m0, s77, 81920
s_nop 0
buffer_load_dwordx4 v12, s[8:11], s75 offen offset:0 lds
v_lshrrev_b32 v2, 4, v1
v_and_b32 v3, 15, v1
buffer_load_dwordx4 v13, s[8:11], s75 offen offset:1024 lds
v_lshlrev_b32 v44, 10, v2
v_lshl_add_u32 v44, v3, 4, v44
buffer_load_dwordx4 v14, s[8:11], s75 offen offset:2048 lds
s_lshl_b32 s70, s60, 8
v_add_u32 v44, s70, v44
s_lshl_b32 s87, s64, 14
s_add_u32 s87, s87, 65536
buffer_load_dwordx4 v15, s[8:11], s75 offen offset:3072 lds
v_and_b32 v45, 31, v1
v_lshlrev_b32 v45, 4, v45
s_add_u32 m0, s77, 86016
s_nop 0
buffer_load_dwordx4 v16, s[8:11], s75 offen offset:0 lds
s_lshl_b32 s88, s65, 11
s_lshl_b32 s70, s60, 9
s_add_u32 s88, s88, s70
s_add_u32 s88, s88, 8192
s_lshl_b32 s70, s64, 8
s_add_u32 s70, s70, 4096
v_lshlrev_b32 v4, 4, v3
v_add_u32 v4, s70, v4
buffer_load_dwordx4 v17, s[8:11], s75 offen offset:1024 lds
s_add_u32 s75, s75, 393216
s_cmp_eq_u32 s75, 6291456
s_cselect_b32 s75, 0, s75
v_add_u32 v5, 36864, v4
v_and_b32 v6, 1, v2
s_add_u32 m0, s76, 65536
s_nop 0
buffer_load_dwordx4 v8, s[4:7], s74 offen offset:0 lds
v_cmp_eq_u32 vcc, 1, v6
s_nop 1
v_cndmask_b32 v46, v4, v5, vcc
buffer_load_dwordx4 v9, s[4:7], s74 offen offset:1024 lds
buffer_load_dwordx4 v10, s[4:7], s74 offen offset:2048 lds
buffer_load_dwordx4 v11, s[4:7], s74 offen offset:3072 lds
s_add_u32 s74, s74, 128
s_and_b32 s74, s74, 2047
s_add_u32 s70, s87, 0
buffer_load_dwordx4 v[20:23], v44, s[12:15], s70 offen sc1
buffer_load_dwordx4 v[36:39], v45, s[12:15], s88 offen sc1
buffer_load_dwordx4 v[40:43], v46, s[12:15], 0 offen offset:0 sc1
s_waitcnt vmcnt(23)
s_barrier
s_add_u32 m0, s77, 40960
s_nop 0
buffer_load_dwordx4 v12, s[8:11], s75 offen offset:0 lds
buffer_load_dwordx4 v13, s[8:11], s75 offen offset:1024 lds
buffer_load_dwordx4 v14, s[8:11], s75 offen offset:2048 lds
buffer_load_dwordx4 v15, s[8:11], s75 offen offset:3072 lds
s_add_u32 m0, s77, 45056
s_nop 0
buffer_load_dwordx4 v16, s[8:11], s75 offen offset:0 lds
buffer_load_dwordx4 v17, s[8:11], s75 offen offset:1024 lds
s_add_u32 s75, s75, 393216
s_cmp_eq_u32 s75, 6291456
s_cselect_b32 s75, 0, s75
s_add_u32 m0, s76, 24576
s_nop 0
buffer_load_dwordx4 v8, s[4:7], s74 offen offset:0 lds
buffer_load_dwordx4 v9, s[4:7], s74 offen offset:1024 lds
buffer_load_dwordx4 v10, s[4:7], s74 offen offset:2048 lds
buffer_load_dwordx4 v11, s[4:7], s74 offen offset:3072 lds
s_add_u32 s74, s74, 128
s_and_b32 s74, s74, 2047
buffer_load_dwordx4 a[72:75], v77, s[32:35], s86 offen nt
s_add_u32 s86, s86, 16384
buffer_load_dwordx4 a[76:79], v77, s[32:35], s86 offen nt
s_add_u32 s86, s86, 16384
buffer_load_dwordx4 a[80:83], v77, s[32:35], s86 offen nt
s_add_u32 s86, s86, 16384
s_waitcnt vmcnt(20)
s_barrier
s_add_u32 m0, s77, 0
s_nop 0
buffer_load_dwordx4 v12, s[8:11], s75 offen offset:0 lds
s_waitcnt vmcnt(14)
L_eg_chk:
v_xor_b32 v2, s68, v23
v_xor_b32 v3, s68, v39
v_xor_b32 v4, s68, v43
v_or3_b32 v2, v2, v3, v4
v_cmp_ne_u32 vcc, 0, v2
s_cbranch_vccnz L_eg_rt
L_eg_ok:
v_mov_b32 v24, v20
v_mov_b32 v25, v21
buffer_load_dwordx4 v13, s[8:11], s75 offen offset:1024 lds
v_mov_b32 v26, v22
v_permlane16_swap_b32 v20, v24
v_permlane16_swap_b32 v21, v25
buffer_load_dwordx4 v14, s[8:11], s75 offen offset:2048 lds
v_permlane16_swap_b32 v22, v26
v_add_f32 v20, v20, v24
v_add_f32 v21, v21, v25
buffer_load_dwordx4 v15, s[8:11], s75 offen offset:3072 lds
v_add_f32 v22, v22, v26
v_mov_b32 v24, v20
v_mov_b32 v25, v21
s_add_u32 m0, s77, 4096
s_nop 0
buffer_load_dwordx4 v16, s[8:11], s75 offen offset:0 lds
v_mov_b32 v26, v22
v_permlane32_swap_b32 v20, v24
v_permlane32_swap_b32 v21, v25
buffer_load_dwordx4 v17, s[8:11], s75 offen offset:1024 lds
s_add_u32 s75, s75, 393216
s_cmp_eq_u32 s75, 6291456
s_cselect_b32 s75, 0, s75
v_permlane32_swap_b32 v22, v26
v_add_f32 v20, v20, v24
s_lshl_b32 s70, s63, 2
s_add_u32 s70, s70, s60
s_lshl_b32 s70, s70, 14
v_lshlrev_b32 v81, 10, v1
s_mov_b64 exec, 0xffff
buffer_load_dword v81, v81, s[16:19], s70 offen offset:384
s_mov_b64 exec, -1
buffer_load_dwordx4 a[84:87], v77, s[32:35], s86 offen nt
s_add_u32 s86, s86, 16384
buffer_load_dwordx4 a[88:91], v77, s[32:35], s86 offen nt
s_add_u32 s86, s86, 16384
buffer_load_dwordx4 a[92:95], v77, s[32:35], s86 offen nt
s_add_u32 s86, s86, 16384
s_waitcnt vmcnt(17)
s_barrier
s_mul_i32 s70, s60, 2
s_add_u32 s70, s70, 120
s_lshl_b32 s82, s89, 3
s_add_u32 s82, s82, s70
s_lshl_b32 s70, s70, 10
s_add_u32 m0, s70, 28672
s_and_b32 s82, s82, 127
s_lshl_b32 s82, s82, 14
buffer_load_dwordx4 v80, s[16:19], s82 offen lds
v_add_f32 v21, v21, v25
v_add_f32 v22, v22, v26
v_and_b32 v3, 15, v1
v_lshlrev_b32 v3, 2, v3
s_lshl_b32 s70, s60, 6
s_add_u32 s70, s70, 160768
v_add_u32 v3, s70, v3
ds_write_b32 v3, v20 offset:0
ds_write_b32 v3, v21 offset:256
ds_write_b32 v3, v22 offset:512
s_add_u32 m0, m0, 1024
s_add_u32 s82, s82, 16384
s_and_b32 s82, s82, 0x1fffff
buffer_load_dwordx4 v80, s[16:19], s82 offen lds
v_lshrrev_b32 v4, 2, v45
s_lshl_b32 s70, s60, 7
s_add_u32 s70, s70, 159744
v_add_u32 v4, s70, v4
ds_write_b32 v4, v36
ds_write_b32 v4, v37 offset:512
s_getreg_b32 s71, hwreg(HW_REG_XCC_ID, 0, 4)
v_cmp_ne_u32 vcc, s71, v40
s_nop 0
s_and_b32 s70, vcc_lo, 0xffff
s_cselect_b32 s69, 0, 1
v_mov_b32 v5, s69
v_mov_b32 v6, 161536
ds_write_b32 v6, v5
s_waitcnt vmcnt(6)
s_barrier
s_mul_i32 s70, s60, 10
s_add_u32 s70, s70, 80
s_lshl_b32 s82, s89, 3
s_add_u32 s82, s82, s70
s_lshl_b32 s70, s70, 10
s_add_u32 m0, s70, 28672
s_and_b32 s82, s82, 127
s_lshl_b32 s82, s82, 14
buffer_load_dwordx4 v80, s[16:19], s82 offen lds
s_add_u32 m0, m0, 1024
s_add_u32 s82, s82, 16384
s_and_b32 s82, s82, 0x1fffff
buffer_load_dwordx4 v80, s[16:19], s82 offen lds
s_add_u32 m0, m0, 1024
s_add_u32 s82, s82, 16384
s_and_b32 s82, s82, 0x1fffff
buffer_load_dwordx4 v80, s[16:19], s82 offen lds
s_add_u32 m0, m0, 1024
s_add_u32 s82, s82, 16384
s_and_b32 s82, s82, 0x1fffff
buffer_load_dwordx4 v80, s[16:19], s82 offen lds
s_add_u32 m0, m0, 1024
s_add_u32 s82, s82, 16384
s_and_b32 s82, s82, 0x1fffff
buffer_load_dwordx4 v80, s[16:19], s82 offen lds
s_add_u32 m0, m0, 1024
s_add_u32 s82, s82, 16384
s_and_b32 s82, s82, 0x1fffff
buffer_load_dwordx4 v80, s[16:19], s82 offen lds
s_add_u32 m0, m0, 1024
s_add_u32 s82, s82, 16384
s_and_b32 s82, s82, 0x1fffff
buffer_load_dwordx4 v80, s[16:19], s82 offen lds
s_add_u32 m0, m0, 1024
s_add_u32 s82, s82, 16384
s_and_b32 s82, s82, 0x1fffff
buffer_load_dwordx4 v80, s[16:19], s82 offen lds
s_add_u32 m0, m0, 1024
s_add_u32 s82, s82, 16384
s_and_b32 s82, s82, 0x1fffff
buffer_load_dwordx4 v80, s[16:19], s82 offen lds
s_add_u32 m0, m0, 1024
s_add_u32 s82, s82, 16384
s_and_b32 s82, s82, 0x1fffff
buffer_load_dwordx4 v80, s[16:19], s82 offen lds
s_setprio 0
s_waitcnt lgkmcnt(0)
s_barrier
s_mov_b32 exec_lo, 0x0
s_mov_b32 exec_hi, 0xf
buffer_load_dword v81, v83, s[12:15], 0 offen
s_mov_b64 exec, -1
s_mul_i32 s70, s60, 14
s_add_u32 s70, s70, 24
s_lshl_b32 s82, s89, 3
s_add_u32 s82, s82, s70
s_lshl_b32 s70, s70, 10
s_add_u32 m0, s70, 28672
s_and_b32 s82, s82, 127
s_lshl_b32 s82, s82, 14
buffer_load_dwordx4 v80, s[16:19], s82 offen lds
s_add_u32 m0, m0, 1024
s_add_u32 s82, s82, 16384
s_and_b32 s82, s82, 0x1fffff
buffer_load_dwordx4 v80, s[16:19], s82 offen lds
s_add_u32 m0, m0, 1024
s_add_u32 s82, s82, 16384
s_and_b32 s82, s82, 0x1fffff
buffer_load_dwordx4 v80, s[16:19], s82 offen lds
s_add_u32 m0, m0, 1024
s_add_u32 s82, s82, 16384
s_and_b32 s82, s82, 0x1fffff
buffer_load_dwordx4 v80, s[16:19], s82 offen lds
s_add_u32 m0, m0, 1024
s_add_u32 s82, s82, 16384
s_and_b32 s82, s82, 0x1fffff
buffer_load_dwordx4 v80, s[16:19], s82 offen lds
s_add_u32 m0, m0, 1024
s_add_u32 s82, s82, 16384
s_and_b32 s82, s82, 0x1fffff
buffer_load_dwordx4 v80, s[16:19], s82 offen lds
s_add_u32 m0, m0, 1024
s_add_u32 s82, s82, 16384
s_and_b32 s82, s82, 0x1fffff
buffer_load_dwordx4 v80, s[16:19], s82 offen lds
s_add_u32 m0, m0, 1024
s_add_u32 s82, s82, 16384
s_and_b32 s82, s82, 0x1fffff
buffer_load_dwordx4 v80, s[16:19], s82 offen lds
s_add_u32 m0, m0, 1024
s_add_u32 s82, s82, 16384
s_and_b32 s82, s82, 0x1fffff
buffer_load_dwordx4 v80, s[16:19], s82 offen lds
s_add_u32 m0, m0, 1024
s_add_u32 s82, s82, 16384
s_and_b32 s82, s82, 0x1fffff
buffer_load_dwordx4 v80, s[16:19], s82 offen lds
s_add_u32 m0, m0, 1024
s_add_u32 s82, s82, 16384
s_and_b32 s82, s82, 0x1fffff
buffer_load_dwordx4 v80, s[16:19], s82 offen lds
s_add_u32 m0, m0, 1024
s_add_u32 s82, s82, 16384
s_and_b32 s82, s82, 0x1fffff
buffer_load_dwordx4 v80, s[16:19], s82 offen lds
s_add_u32 m0, m0, 1024
s_add_u32 s82, s82, 16384
s_and_b32 s82, s82, 0x1fffff
buffer_load_dwordx4 v80, s[16:19], s82 offen lds
s_add_u32 m0, m0, 1024
s_add_u32 s82, s82, 16384
s_and_b32 s82, s82, 0x1fffff
buffer_load_dwordx4 v80, s[16:19], s82 offen lds
s_sub_i32 s70, s64, s65
s_lshl_b32 s70, s70, 18
v_add_u32 v8, s70, v8
v_add_u32 v9, s70, v9
v_add_u32 v10, s70, v10
v_add_u32 v11, s70, v11
v_lshrrev_b32 v2, 4, v1
v_bfe_u32 v3, v1, 2, 2
v_and_b32 v4, 1, v1
v_lshlrev_b32 v4, 4, v4
v_mov_b32 v5, 0x3f80
v_lshlrev_b32 v4, v4, v5
v_cmp_eq_u32 vcc, v2, v3
s_nop 1
v_cndmask_b32 v4, 0, v4, vcc
v_and_b32 v5, 2, v1
v_cmp_eq_u32 vcc, 0, v5
s_nop 1
v_cndmask_b32 v58, 0, v4, vcc
v_cndmask_b32_e64 v59, v4, 0, vcc
v_mov_b32 v56, 0
v_mov_b32 v57, 0
v_mov_b32 v60, 0
v_mov_b32 v61, 0
v_and_b32 v3, 15, v1
v_mul_u32_u24 v55, 4352, v3
v_lshrrev_b32 v2, 4, v1
v_lshl_add_u32 v55, v2, 5, v55
s_mul_i32 s87, s64, 69632
s_add_u32 s87, s87, 524288
s_lshl_b32 s70, s66, 7
s_lshl_b32 s71, s67, 4
s_add_u32 s88, s70, s71
s_add_u32 s88, s88, s87
s_add_u32 s88, s88, 4096
s_lshl_b32 s70, s60, 10
s_add_u32 s87, s87, s70
s_cmp_eq_u32 s60, 0
s_cbranch_scc1 L_pad1
s_cmp_eq_u32 s60, 1
s_cbranch_scc1 L_pad8
s_cmp_eq_u32 s60, 2
s_cbranch_scc1 L_retF
s_branch L_retF
L_retF:
s_barrier
s_barrier
s_mul_i32 s70, s60, 6
s_add_u32 s70, s70, 0
s_lshl_b32 s82, s89, 3
s_add_u32 s82, s82, s70
s_lshl_b32 s70, s70, 10
s_add_u32 m0, s70, 28672
s_and_b32 s82, s82, 127
s_lshl_b32 s82, s82, 14
buffer_load_dwordx4 v80, s[16:19], s82 offen lds
s_add_u32 m0, m0, 1024
s_add_u32 s82, s82, 16384
s_and_b32 s82, s82, 0x1fffff
buffer_load_dwordx4 v80, s[16:19], s82 offen lds
s_add_u32 m0, m0, 1024
s_add_u32 s82, s82, 16384
s_and_b32 s82, s82, 0x1fffff
buffer_load_dwordx4 v80, s[16:19], s82 offen lds
s_add_u32 m0, m0, 1024
s_add_u32 s82, s82, 16384
s_and_b32 s82, s82, 0x1fffff
buffer_load_dwordx4 v80, s[16:19], s82 offen lds
s_add_u32 m0, m0, 1024
s_add_u32 s82, s82, 16384
s_and_b32 s82, s82, 0x1fffff
buffer_load_dwordx4 v80, s[16:19], s82 offen lds
s_add_u32 m0, m0, 1024
s_add_u32 s82, s82, 16384
s_and_b32 s82, s82, 0x1fffff
buffer_load_dwordx4 v80, s[16:19], s82 offen lds
s_lshl_b32 s70, s65, 7
s_mov_b32 m0, s76
s_nop 0
buffer_load_dwordx4 v8, s[4:7], s70 offen offset:0 lds
buffer_load_dwordx4 v9, s[4:7], s70 offen offset:1024 lds
buffer_load_dwordx4 v10, s[4:7], s70 offen offset:2048 lds
buffer_load_dwordx4 v11, s[4:7], s70 offen offset:3072 lds
s_add_u32 s70, s65, 1
s_and_b32 s70, s70, 15
s_mul_i32 s70, s70, 4352
s_add_u32 s70, s70, s87
buffer_load_dwordx4 v[84:87], v18, s[12:15], s70 offen sc1
s_add_u32 s70, s65, 2
s_and_b32 s70, s70, 15
s_mul_i32 s70, s70, 4352
s_add_u32 s70, s70, s87
buffer_load_dwordx4 v[88:91], v18, s[12:15], s70 offen sc1
s_add_u32 s70, s65, 3
s_and_b32 s70, s70, 15
s_mul_i32 s70, s70, 4352
s_add_u32 s70, s70, s87
buffer_load_dwordx4 v[92:95], v18, s[12:15], s70 offen sc1
s_add_u32 s70, s65, 4
s_and_b32 s70, s70, 15
s_mul_i32 s70, s70, 4352
s_add_u32 s70, s70, s87
buffer_load_dwordx4 v[96:99], v18, s[12:15], s70 offen sc1
s_add_u32 s70, s65, 5
s_and_b32 s70, s70, 15
s_mul_i32 s70, s70, 4352
s_add_u32 s70, s70, s87
buffer_load_dwordx4 v[100:103], v18, s[12:15], s70 offen sc1
s_add_u32 s70, s65, 6
s_and_b32 s70, s70, 15
s_mul_i32 s70, s70, 4352
s_add_u32 s70, s70, s87
buffer_load_dwordx4 v[104:107], v18, s[12:15], s70 offen sc1
s_add_u32 s70, s65, 7
s_and_b32 s70, s70, 15
s_mul_i32 s70, s70, 4352
s_add_u32 s70, s70, s87
buffer_load_dwordx4 v[108:111], v18, s[12:15], s70 offen sc1
s_add_u32 s70, s65, 8
s_and_b32 s70, s70, 15
s_mul_i32 s70, s70, 4352
s_add_u32 s70, s70, s87
buffer_load_dwordx4 v[112:115], v18, s[12:15], s70 offen sc1
s_add_u32 s70, s65, 9
s_and_b32 s70, s70, 15
s_mul_i32 s70, s70, 4352
s_add_u32 s70, s70, s87
buffer_load_dwordx4 v[116:119], v18, s[12:15], s70 offen sc1
s_add_u32 s70, s65, 10
s_and_b32 s70, s70, 15
s_mul_i32 s70, s70, 4352
s_add_u32 s70, s70, s87
buffer_load_dwordx4 v[120:123], v18, s[12:15], s70 offen sc1
s_add_u32 s70, s65, 11
s_and_b32 s70, s70, 15
s_mul_i32 s70, s70, 4352
s_add_u32 s70, s70, s87
buffer_load_dwordx4 v[124:127], v18, s[12:15], s70 offen sc1
s_add_u32 s70, s65, 12
s_and_b32 s70, s70, 15
s_mul_i32 s70, s70, 4352
s_add_u32 s70, s70, s87
buffer_load_dwordx4 v[128:131], v18, s[12:15], s70 offen sc1
s_add_u32 s70, s65, 13
s_and_b32 s70, s70, 15
s_mul_i32 s70, s70, 4352
s_add_u32 s70, s70, s87
buffer_load_dwordx4 v[132:135], v18, s[12:15], s70 offen sc1
s_add_u32 s70, s65, 14
s_and_b32 s70, s70, 15
s_mul_i32 s70, s70, 4352
s_add_u32 s70, s70, s87
buffer_load_dwordx4 v[136:139], v18, s[12:15], s70 offen sc1
s_add_u32 s70, s65, 15
s_and_b32 s70, s70, 15
s_mul_i32 s70, s70, 4352
s_add_u32 s70, s70, s87
buffer_load_dwordx4 v[140:143], v18, s[12:15], s70 offen sc1
s_add_u32 s70, s65, 16
s_and_b32 s70, s70, 15
s_mul_i32 s70, s70, 4352
s_add_u32 s70, s70, s87
buffer_load_dwordx4 v[144:147], v18, s[12:15], s70 offen sc1
buffer_load_dwordx4 v[148:151], v55, s[12:15], s88 offen sc1
s_branch L_over1
L_pad1:
s_branch L_retF
L_over1:
s_lshl_b32 s70, s66, 6
s_lshl_b32 s71, s67, 3
s_add_u32 s70, s70, s71
s_add_u32 s70, s70, 161600
v_lshrrev_b32 v4, 4, v1
v_lshlrev_b32 v4, 4, v4
v_add_u32 v4, s70, v4
s_lshl_b32 s70, s60, 10
s_add_u32 s70, s70, 24576
v_add_u32 v3, s70, v18
s_mov_b32 s73, 31
L_kvr:
s_bitcmp1_b32 s73, 0
s_cbranch_scc0 L_kvs0
s_waitcnt vmcnt(13)
v_max3_u32 v2, v84, v88, v92
v_max_u32 v2, v2, v96
v_cmp_eq_u32 vcc, -1, v2
s_cbranch_vccnz L_kvs0
s_bitset0_b32 s73, 0
v_mfma_f32_16x16x32_bf16 v[20:23], v[58:61], v[84:87], 0
v_mfma_f32_16x16x32_bf16 v[24:27], v[56:59], v[84:87], 0
v_mfma_f32_16x16x32_bf16 v[20:23], v[58:61], v[88:91], v[20:23]
v_mfma_f32_16x16x32_bf16 v[24:27], v[56:59], v[88:91], v[24:27]
v_mfma_f32_16x16x32_bf16 v[20:23], v[58:61], v[92:95], v[20:23]
v_mfma_f32_16x16x32_bf16 v[24:27], v[56:59], v[92:95], v[24:27]
v_mfma_f32_16x16x32_bf16 v[20:23], v[58:61], v[96:99], v[20:23]
v_mfma_f32_16x16x32_bf16 v[24:27], v[56:59], v[96:99], v[24:27]
L_kvs0:
s_bitcmp1_b32 s73, 1
s_cbranch_scc0 L_kvs1
s_waitcnt vmcnt(9)
v_max3_u32 v2, v100, v104, v108
v_max_u32 v2, v2, v112
v_cmp_eq_u32 vcc, -1, v2
s_cbranch_vccnz L_kvs1
s_bitset0_b32 s73, 1
v_mfma_f32_16x16x32_bf16 v[28:31], v[58:61], v[100:103], 0
v_mfma_f32_16x16x32_bf16 v[32:35], v[56:59], v[100:103], 0
v_mfma_f32_16x16x32_bf16 v[28:31], v[58:61], v[104:107], v[28:31]
v_mfma_f32_16x16x32_bf16 v[32:35], v[56:59], v[104:107], v[32:35]
v_mfma_f32_16x16x32_bf16 v[28:31], v[58:61], v[108:111], v[28:31]
v_mfma_f32_16x16x32_bf16 v[32:35], v[56:59], v[108:111], v[32:35]
v_mfma_f32_16x16x32_bf16 v[28:31], v[58:61], v[112:115], v[28:31]
v_mfma_f32_16x16x32_bf16 v[32:35], v[56:59], v[112:115], v[32:35]
L_kvs1:
s_bitcmp1_b32 s73, 2
s_cbranch_scc0 L_kvs2
s_waitcnt vmcnt(5)
v_max3_u32 v2, v116, v120, v124
v_max_u32 v2, v2, v128
v_cmp_eq_u32 vcc, -1, v2
s_cbranch_vccnz L_kvs2
s_bitset0_b32 s73, 2
v_mfma_f32_16x16x32_bf16 v[36:39], v[58:61], v[116:119], 0
v_mfma_f32_16x16x32_bf16 v[40:43], v[56:59], v[116:119], 0
v_mfma_f32_16x16x32_bf16 v[36:39], v[58:61], v[120:123], v[36:39]
v_mfma_f32_16x16x32_bf16 v[40:43], v[56:59], v[120:123], v[40:43]
v_mfma_f32_16x16x32_bf16 v[36:39], v[58:61], v[124:127], v[36:39]
v_mfma_f32_16x16x32_bf16 v[40:43], v[56:59], v[124:127], v[40:43]
v_mfma_f32_16x16x32_bf16 v[36:39], v[58:61], v[128:131], v[36:39]
v_mfma_f32_16x16x32_bf16 v[40:43], v[56:59], v[128:131], v[40:43]
L_kvs2:
s_bitcmp1_b32 s73, 3
s_cbranch_scc0 L_kvs3
s_waitcnt vmcnt(1)
v_max3_u32 v2, v132, v136, v140
v_max_u32 v2, v2, v144
v_cmp_eq_u32 vcc, -1, v2
s_cbranch_vccnz L_kvs3
s_bitset0_b32 s73, 3
v_mfma_f32_16x16x32_bf16 v[44:47], v[58:61], v[132:135], 0
v_mfma_f32_16x16x32_bf16 v[48:51], v[56:59], v[132:135], 0
v_mfma_f32_16x16x32_bf16 v[44:47], v[58:61], v[136:139], v[44:47]
v_mfma_f32_16x16x32_bf16 v[48:51], v[56:59], v[136:139], v[48:51]
v_mfma_f32_16x16x32_bf16 v[44:47], v[58:61], v[140:143], v[44:47]
v_mfma_f32_16x16x32_bf16 v[48:51], v[56:59], v[140:143], v[48:51]
v_mfma_f32_16x16x32_bf16 v[44:47], v[58:61], v[144:147], v[44:47]
v_mfma_f32_16x16x32_bf16 v[48:51], v[56:59], v[144:147], v[48:51]
L_kvs3:
s_bitcmp1_b32 s73, 4
s_cbranch_scc0 L_kvs4
s_waitcnt vmcnt(0)
v_xor_b32 v148, s84, v148
v_xor_b32 v149, s84, v149
v_xor_b32 v150, s84, v150
v_xor_b32 v151, s84, v151
v_or3_b32 v2, v148, v149, v150
v_bitop3_b32 v2, v2, v151, s91 bitop3:0xa8
v_cmp_ne_u32 vcc, 0, v2
s_cbranch_vccnz L_kvs4
s_bitset0_b32 s73, 4
v_add_f32_dpp v148, v148, v148 row_ror:1 row_mask:0xf bank_mask:0xf
v_add_f32_dpp v149, v149, v149 row_ror:1 row_mask:0xf bank_mask:0xf
v_add_f32_dpp v150, v150, v150 row_ror:1 row_mask:0xf bank_mask:0xf
v_add_f32_dpp v151, v151, v151 row_ror:1 row_mask:0xf bank_mask:0xf
v_add_f32_dpp v148, v148, v148 row_ror:2 row_mask:0xf bank_mask:0xf
v_add_f32_dpp v149, v149, v149 row_ror:2 row_mask:0xf bank_mask:0xf
v_add_f32_dpp v150, v150, v150 row_ror:2 row_mask:0xf bank_mask:0xf
v_add_f32_dpp v151, v151, v151 row_ror:2 row_mask:0xf bank_mask:0xf
v_add_f32_dpp v148, v148, v148 row_ror:4 row_mask:0xf bank_mask:0xf
v_add_f32_dpp v149, v149, v149 row_ror:4 row_mask:0xf bank_mask:0xf
v_add_f32_dpp v150, v150, v150 row_ror:4 row_mask:0xf bank_mask:0xf
v_add_f32_dpp v151, v151, v151 row_ror:4 row_mask:0xf bank_mask:0xf
v_add_f32_dpp v148, v148, v148 row_ror:8 row_mask:0xf bank_mask:0xf
v_add_f32_dpp v149, v149, v149 row_ror:8 row_mask:0xf bank_mask:0xf
v_add_f32_dpp v150, v150, v150 row_ror:8 row_mask:0xf bank_mask:0xf
v_add_f32_dpp v151, v151, v151 row_ror:8 row_mask:0xf bank_mask:0xf
v_cvt_pk_bf16_f32 v148, v148, v149
v_cvt_pk_bf16_f32 v149, v150, v151
ds_write_b64 v4, v[148:149]
L_kvs4:
s_cmp_lg_u32 s73, 0
s_cbranch_scc1 L_kvrt
L_kvok:
s_nop 3
v_pk_add_f32 v[20:21], v[20:21], v[28:29]
v_pk_add_f32 v[22:23], v[22:23], v[30:31]
v_pk_add_f32 v[24:25], v[24:25], v[32:33]
v_pk_add_f32 v[26:27], v[26:27], v[34:35]
v_pk_add_f32 v[36:37], v[36:37], v[44:45]
v_pk_add_f32 v[38:39], v[38:39], v[46:47]
v_pk_add_f32 v[40:41], v[40:41], v[48:49]
v_pk_add_f32 v[42:43], v[42:43], v[50:51]
v_pk_add_f32 v[20:21], v[20:21], v[36:37]
v_pk_add_f32 v[22:23], v[22:23], v[38:39]
v_pk_add_f32 v[24:25], v[24:25], v[40:41]
v_pk_add_f32 v[26:27], v[26:27], v[42:43]
v_cvt_pk_bf16_f32 v20, v20, v21
v_cvt_pk_bf16_f32 v21, v22, v23
v_cvt_pk_bf16_f32 v22, v24, v25
v_cvt_pk_bf16_f32 v23, v26, v27
ds_write_b128 v3, v[20:23]
s_waitcnt lgkmcnt(0)
s_barrier
s_mov_b32 exec_lo, 0x0
s_mov_b32 exec_hi, 0x3f000000
buffer_load_dword v81, v83, s[12:15], 0 offen
s_mov_b64 exec, -1
s_cmp_eq_u32 s60, 0
s_cbranch_scc1 L_pad2
s_cmp_eq_u32 s60, 1
s_cbranch_scc1 L_pad6
s_cmp_eq_u32 s60, 2
s_cbranch_scc1 L_pad7
s_branch L_pad9
L_retG:
v_lshrrev_b32 v2, 5, v1
v_lshlrev_b32 v2, 11, v2
v_bfe_u32 v3, v1, 3, 2
v_lshl_add_u32 v2, v3, 7, v2
v_bfe_u32 v3, v1, 4, 1
v_bfe_u32 v4, v1, 1, 2
v_xor_b32 v3, v3, v4
v_lshl_add_u32 v2, v3, 5, v2
v_and_b32 v3, 1, v1
v_lshl_add_u32 v2, v3, 4, v2
s_lshl_b32 s70, s60, 13
s_add_u32 s71, s70, 65536
v_add_u32 v100, s71, v2
v_xor_b32 v101, 64, v100
v_lshrrev_b32 v2, 2, v1
v_bfe_u32 v5, v1, 3, 2
v_xor_b32 v6, s60, v5
v_lshlrev_b32 v6, 5, v6
v_lshl_add_u32 v6, v2, 7, v6
v_and_b32 v7, 3, v1
v_lshl_add_u32 v6, v7, 3, v6
v_add_u32 v102, 65536, v6
s_lshl_b32 s71, s66, 16
s_add_u32 s70, s70, s71
s_add_u32 s70, s70, 49152
v_lshlrev_b32 v6, 5, v5
v_lshl_add_u32 v6, v2, 7, v6
v_lshl_add_u32 v6, v7, 3, v6
v_add_u32 v104, s70, v6
v_xor_b32 v105, 32, v104
v_xor_b32 v106, 64, v104
v_xor_b32 v107, 96, v104
v_lshrrev_b32 v5, 4, v1
v_xor_b32 v4, v4, v5
v_lshlrev_b32 v4, 5, v4
v_lshrrev_b32 v6, 3, v1
v_lshl_add_u32 v4, v6, 7, v4
v_lshl_add_u32 v4, v3, 4, v4
v_add_u32 v103, s70, v4
s_lshl_b32 s70, s60, 5
s_add_u32 s70, s70, 161792
v_mov_b32 v63, s70
v_add_u32 v114, 16, v63
v_lshl_add_u32 v56, v3, 4, v63
s_and_b32 s70, s65, 3
s_lshl_b32 s70, s70, 9
s_add_u32 s70, s70, 7864320
v_lshl_add_u32 v57, v5, 4, s70
v_lshlrev_b32 v60, 5, v5
v_lshl_add_u32 v60, v3, 4, v60
v_bfe_u32 v7, v1, 1, 1
v_lshl_add_u32 v60, v7, 7, v60
v_and_b32 v2, 3, v2
v_lshl_add_u32 v61, v2, 8, v60
v_lshlrev_b32 v62, 4, v3
v_lshl_add_u32 v62, v5, 5, v62
v_mov_b32 v59, s68
s_lshl_b32 s71, s79, 2
s_add_u32 s71, s71, s60
s_lshl_b32 s70, s71, 8
s_add_u32 s70, s70, 6946816
s_mov_b32 s85, s70
s_and_b32 s71, s65, 3
s_lshl2_add_u32 s71, s3, s71
s_and_b32 s70, s65, 12
s_add_u32 s70, s70, s60
s_lshl_b32 s71, s71, 7
s_lshl_b32 s70, s70, 15
s_add_u32 s70, s70, s71
s_add_u32 s70, s70, 7340032
s_mov_b32 s88, s70
s_lshl_b32 s70, s64, 14
s_add_u32 s86, s70, 6946816
s_and_b32 s70, s65, 3
v_mul_u32_u24 v2, 1, v7
v_xor_b32 v2, s70, v2
v_lshl_add_u32 v61, v2, 12, v61
s_lshl_b32 s87, s62, 11
s_add_u32 s87, s87, 6815744
s_mov_b32 s94, 0
s_mov_b32 s95, 0
s_mov_b32 s92, 0x000f000f
s_mov_b32 s93, 0x000f000f
s_mov_b32 s38, 0
v_mov_b32 v64, 0x3f803f80
v_mov_b32 v65, 0x3f803f80
v_mov_b32 v66, 0x3f803f80
v_mov_b32 v67, 0x3f803f80
v_add_u32 v115, 64, v1
v_mov_b32 v2, 0
v_mov_b32 v95, 0
v_mov_b32 v99, 0
s_waitcnt vmcnt(0) lgkmcnt(0)
s_barrier
ds_write_b128 v100, a[0:3] offset:0
ds_write_b128 v101, a[4:7] offset:512
ds_write_b128 v100, a[8:11] offset:1024
ds_write_b128 v101, a[12:15] offset:1536
ds_write_b128 v100, a[16:19] offset:4096
ds_write_b128 v101, a[20:23] offset:4608
ds_write_b128 v100, a[24:27] offset:5120
ds_write_b128 v101, a[28:31] offset:5632
ds_write_b128 v100, a[32:35] offset:32768
ds_write_b128 v101, a[36:39] offset:33280
ds_write_b128 v100, a[40:43] offset:33792
ds_write_b128 v101, a[44:47] offset:34304
ds_write_b128 v100, a[48:51] offset:36864
ds_write_b128 v101, a[52:55] offset:37376
ds_write_b128 v100, a[56:59] offset:37888
ds_write_b128 v101, a[60:63] offset:38400
ds_write_b128 v103, a[64:67] offset:0
ds_write_b128 v103, a[68:71] offset:1024
ds_write_b128 v103, a[72:75] offset:2048
ds_write_b128 v103, a[76:79] offset:3072
ds_write_b128 v103, a[80:83] offset:4096
ds_write_b128 v103, a[84:87] offset:5120
ds_write_b128 v103, a[88:91] offset:6144
ds_write_b128 v103, a[92:95] offset:7168
s_waitcnt lgkmcnt(0)
ds_read_b64_tr_b16 a[64:65], v104 offset:0
ds_read_b64_tr_b16 a[66:67], v104 offset:2048
ds_read_b64_tr_b16 a[68:69], v104 offset:4096
ds_read_b64_tr_b16 a[70:71], v104 offset:6144
ds_read_b64_tr_b16 a[72:73], v105 offset:0
ds_read_b64_tr_b16 a[74:75], v105 offset:2048
ds_read_b64_tr_b16 a[76:77], v105 offset:4096
ds_read_b64_tr_b16 a[78:79], v105 offset:6144
ds_read_b64_tr_b16 a[80:81], v106 offset:0
ds_read_b64_tr_b16 a[82:83], v106 offset:2048
ds_read_b64_tr_b16 a[84:85], v106 offset:4096
ds_read_b64_tr_b16 a[86:87], v106 offset:6144
ds_read_b64_tr_b16 a[88:89], v107 offset:0
ds_read_b64_tr_b16 a[90:91], v107 offset:2048
ds_read_b64_tr_b16 a[92:93], v107 offset:4096
ds_read_b64_tr_b16 a[94:95], v107 offset:6144
s_barrier
ds_read_b64_tr_b16 a[0:1], v102 offset:0
ds_read_b64_tr_b16 a[2:3], v102 offset:2048
ds_read_b64_tr_b16 a[32:33], v102 offset:32768
ds_read_b64_tr_b16 a[34:35], v102 offset:34816
ds_read_b64_tr_b16 a[4:5], v102 offset:4096
ds_read_b64_tr_b16 a[6:7], v102 offset:6144
ds_read_b64_tr_b16 a[36:37], v102 offset:36864
ds_read_b64_tr_b16 a[38:39], v102 offset:38912
ds_read_b64_tr_b16 a[8:9], v102 offset:8192
ds_read_b64_tr_b16 a[10:11], v102 offset:10240
ds_read_b64_tr_b16 a[40:41], v102 offset:40960
ds_read_b64_tr_b16 a[42:43], v102 offset:43008
ds_read_b64_tr_b16 a[12:13], v102 offset:12288
ds_read_b64_tr_b16 a[14:15], v102 offset:14336
ds_read_b64_tr_b16 a[44:45], v102 offset:45056
ds_read_b64_tr_b16 a[46:47], v102 offset:47104
ds_read_b64_tr_b16 a[16:17], v102 offset:16384
ds_read_b64_tr_b16 a[18:19], v102 offset:18432
ds_read_b64_tr_b16 a[48:49], v102 offset:49152
ds_read_b64_tr_b16 a[50:51], v102 offset:51200
ds_read_b64_tr_b16 a[20:21], v102 offset:20480
ds_read_b64_tr_b16 a[22:23], v102 offset:22528
ds_read_b64_tr_b16 a[52:53], v102 offset:53248
ds_read_b64_tr_b16 a[54:55], v102 offset:55296
ds_read_b64_tr_b16 a[24:25], v102 offset:24576
ds_read_b64_tr_b16 a[26:27], v102 offset:26624
ds_read_b64_tr_b16 a[56:57], v102 offset:57344
ds_read_b64_tr_b16 a[58:59], v102 offset:59392
ds_read_b64_tr_b16 a[28:29], v102 offset:28672
ds_read_b64_tr_b16 a[30:31], v102 offset:30720
ds_read_b64_tr_b16 a[60:61], v102 offset:61440
ds_read_b64_tr_b16 a[62:63], v102 offset:63488
s_waitcnt lgkmcnt(0)
buffer_load_dwordx4 v[92:95], v18, s[12:15], s87 offen offset:0 sc1
buffer_load_dwordx4 v[96:99], v18, s[12:15], s87 offen offset:1024 sc1
v_mfma_f32_16x16x32_bf16 v[68:71], a[0:3], v[64:67], 0
v_mfma_f32_16x16x32_bf16 v[72:75], a[32:35], v[64:67], 0
v_mfma_f32_16x16x32_bf16 v[68:71], a[4:7], v[64:67], v[68:71]
v_mfma_f32_16x16x32_bf16 v[72:75], a[36:39], v[64:67], v[72:75]
v_mfma_f32_16x16x32_bf16 v[68:71], a[8:11], v[64:67], v[68:71]
v_mfma_f32_16x16x32_bf16 v[72:75], a[40:43], v[64:67], v[72:75]
v_mfma_f32_16x16x32_bf16 v[68:71], a[12:15], v[64:67], v[68:71]
v_mfma_f32_16x16x32_bf16 v[72:75], a[44:47], v[64:67], v[72:75]
v_mfma_f32_16x16x32_bf16 v[68:71], a[16:19], v[64:67], v[68:71]
v_mfma_f32_16x16x32_bf16 v[72:75], a[48:51], v[64:67], v[72:75]
v_mfma_f32_16x16x32_bf16 v[68:71], a[20:23], v[64:67], v[68:71]
v_mfma_f32_16x16x32_bf16 v[72:75], a[52:55], v[64:67], v[72:75]
v_mfma_f32_16x16x32_bf16 v[68:71], a[24:27], v[64:67], v[68:71]
v_mfma_f32_16x16x32_bf16 v[72:75], a[56:59], v[64:67], v[72:75]
v_mfma_f32_16x16x32_bf16 v[68:71], a[28:31], v[64:67], v[68:71]
v_mfma_f32_16x16x32_bf16 v[72:75], a[60:63], v[64:67], v[72:75]
L_pk:
s_waitcnt vmcnt(0)
L_pk2:
v_cmp_eq_u32_e64 s[80:81], s68, v95
v_cmp_eq_u32_e64 s[82:83], s68, v99
s_nop 0
v_cndmask_b32_e64 v108, 0, v92, s[80:81]
v_cndmask_b32_e64 v109, 0, v96, s[82:83]
s_and_b64 s[76:77], s[80:81], s[82:83]
v_max_u32 v110, v108, v109
v_min_u32 v111, v108, v109
s_cmp_eq_u64 s[76:77], -1
s_cselect_b32 s73, 0, 1
s_cbranch_scc1 L_pkc
s_not_b64 exec, s[80:81]
s_cselect_b64 exec, exec, 1
buffer_load_dwordx4 v[92:95], v18, s[12:15], s87 offen offset:0 sc1
s_not_b64 exec, s[82:83]
s_cselect_b64 exec, exec, 1
buffer_load_dwordx4 v[96:99], v18, s[12:15], s87 offen offset:1024 sc1
s_mov_b64 exec, -1
L_pkc:
v_cmp_le_u32 vcc, s95, v110
v_cmp_le_u32_e64 s[76:77], s95, v111
s_bcnt1_i32_b64 s70, vcc
s_bcnt1_i32_b64 s71, s[76:77]
s_add_u32 s70, s70, s71
s_cmp_eq_u32 s70, 2
s_cbranch_scc1 L_pksame
v_mov_b32_dpp v112, v110 row_ror:1 row_mask:0xf bank_mask:0xf
v_max_u32_dpp v113, v111, v111 row_ror:1 row_mask:0xf bank_mask:0xf
v_med3_u32 v111, v110, v112, v113
v_max_u32 v110, v110, v112
s_nop 1
v_mov_b32_dpp v112, v110 row_ror:2 row_mask:0xf bank_mask:0xf
v_max_u32_dpp v113, v111, v111 row_ror:2 row_mask:0xf bank_mask:0xf
v_med3_u32 v111, v110, v112, v113
v_max_u32 v110, v110, v112
s_nop 1
v_mov_b32_dpp v112, v110 row_ror:4 row_mask:0xf bank_mask:0xf
v_max_u32_dpp v113, v111, v111 row_ror:4 row_mask:0xf bank_mask:0xf
v_med3_u32 v111, v110, v112, v113
v_max_u32 v110, v110, v112
s_nop 1
v_mov_b32_dpp v112, v110 row_ror:8 row_mask:0xf bank_mask:0xf
v_max_u32_dpp v113, v111, v111 row_ror:8 row_mask:0xf bank_mask:0xf
v_med3_u32 v111, v110, v112, v113
v_max_u32 v110, v110, v112
v_mov_b32 v112, v110
v_mov_b32 v113, v111
s_nop 0
v_permlane16_swap_b32 v110, v112
v_permlane16_swap_b32 v111, v113
v_max_u32 v113, v111, v113
v_med3_u32 v111, v110, v112, v113
v_max_u32 v110, v110, v112
v_mov_b32 v112, v110
v_mov_b32 v113, v111
s_nop 0
v_permlane32_swap_b32 v110, v112
v_permlane32_swap_b32 v111, v113
v_max_u32 v113, v111, v113
v_med3_u32 v111, v110, v112, v113
v_max_u32 v110, v110, v112
v_readfirstlane_b32 s95, v111
s_nop 0
s_cmp_eq_u32 s95, 0
s_cbranch_scc1 L_pksame
v_cmp_eq_u32 vcc, v108, v111
v_cmp_eq_u32_e64 s[76:77], v108, v110
s_nop 0
v_cndmask_b32 v112, v63, v114, vcc
s_or_b64 exec, vcc, s[76:77]
ds_write_b96 v112, v[92:94]
ds_write_b32 v112, v1 offset:12
s_mov_b64 exec, -1
v_cmp_eq_u32 vcc, v109, v111
v_cmp_eq_u32_e64 s[76:77], v109, v110
s_nop 0
v_cndmask_b32 v113, v63, v114, vcc
s_or_b64 exec, vcc, s[76:77]
ds_write_b96 v113, v[96:98]
ds_write_b32 v113, v115 offset:12
s_mov_b64 exec, -1
ds_read_b128 v[20:23], v56
s_waitcnt lgkmcnt(0)
v_lshl_add_u32 v58, v23, 11, v57
s_mov_b64 exec, s[92:93]
buffer_load_dwordx4 v[24:27], v58, s[12:15], 0 offen offset:0 sc1
buffer_load_dwordx4 v[28:31], v58, s[12:15], 0 offen offset:64 sc1
buffer_load_dwordx4 v[32:35], v58, s[12:15], 0 offen offset:128 sc1
buffer_load_dwordx4 v[36:39], v58, s[12:15], 0 offen offset:192 sc1
buffer_load_dwordx4 v[40:43], v58, s[12:15], 0 offen offset:256 sc1
buffer_load_dwordx4 v[44:47], v58, s[12:15], 0 offen offset:320 sc1
buffer_load_dwordx4 v[48:51], v58, s[12:15], 0 offen offset:384 sc1
buffer_load_dwordx4 v[52:55], v58, s[12:15], 0 offen offset:448 sc1
s_mov_b64 exec, -1
v_mul_f32_e64 v84, v68, -v21
v_mul_f32_e64 v85, v69, -v21
v_mul_f32_e64 v86, v70, -v21
v_mul_f32_e64 v87, v71, -v21
v_mul_f32_e64 v88, v72, -v21
v_mul_f32_e64 v89, v73, -v21
v_mul_f32_e64 v90, v74, -v21
v_mul_f32_e64 v91, v75, -v21
s_cmp_eq_u32 s73, 0
s_cbranch_scc1 L_pkf
s_waitcnt vmcnt(8)
s_add_u32 s78, s78, 1
s_cmp_le_u32 s78, 65536
s_cbranch_scc1 L_pk2
L_pkf:
s_waitcnt vmcnt(0)
L_pkx_chk:
v_max3_u32 v2, v24, v28, v32
v_max3_u32 v3, v36, v40, v44
v_max3_u32 v2, v2, v48, v52
v_max_u32 v2, v2, v3
v_cmp_eq_u32 vcc, -1, v2
s_nop 0
s_and_b64 vcc, vcc, s[92:93]
s_cbranch_vccnz L_pkx_rt
L_pkx_ok:
v_mfma_f32_16x16x32_bf16 v[84:87], a[0:3], v[24:27], v[84:87]
v_mfma_f32_16x16x32_bf16 v[88:91], a[32:35], v[24:27], v[88:91]
v_mfma_f32_16x16x32_bf16 v[84:87], a[4:7], v[28:31], v[84:87]
v_mfma_f32_16x16x32_bf16 v[88:91], a[36:39], v[28:31], v[88:91]
v_mfma_f32_16x16x32_bf16 v[84:87], a[8:11], v[32:35], v[84:87]
v_mfma_f32_16x16x32_bf16 v[88:91], a[40:43], v[32:35], v[88:91]
v_mfma_f32_16x16x32_bf16 v[84:87], a[12:15], v[36:39], v[84:87]
v_mfma_f32_16x16x32_bf16 v[88:91], a[44:47], v[36:39], v[88:91]
v_mfma_f32_16x16x32_bf16 v[84:87], a[16:19], v[40:43], v[84:87]
v_mfma_f32_16x16x32_bf16 v[88:91], a[48:51], v[40:43], v[88:91]
v_mfma_f32_16x16x32_bf16 v[84:87], a[20:23], v[44:47], v[84:87]
v_mfma_f32_16x16x32_bf16 v[88:91], a[52:55], v[44:47], v[88:91]
v_mfma_f32_16x16x32_bf16 v[84:87], a[24:27], v[48:51], v[84:87]
v_mfma_f32_16x16x32_bf16 v[88:91], a[56:59], v[48:51], v[88:91]
v_mfma_f32_16x16x32_bf16 v[84:87], a[28:31], v[52:55], v[84:87]
v_mfma_f32_16x16x32_bf16 v[88:91], a[60:63], v[52:55], v[88:91]
s_mov_b32 s76, 0xcccccccc
s_mov_b32 s77, 0xcccccccc
s_nop 5
v_cndmask_b32_e64 v84, v84, v88, s[76:77]
v_cndmask_b32_e64 v85, v85, v89, s[76:77]
v_cndmask_b32_e64 v86, v86, v90, s[76:77]
v_cndmask_b32_e64 v87, v87, v91, s[76:77]
v_bfi_b32 v84, s91, v59, v84
s_mov_b64 exec, s[92:93]
s_cmp_eq_u32 s69, 0
s_cbranch_scc1 L_pxp_s
buffer_store_dwordx4 v[84:87], v60, s[12:15], s85 offen
L_pxp_d:
s_mov_b64 exec, -1
buffer_load_dwordx4 v[24:27], v61, s[12:15], s86 offen offset:0 sc1
buffer_load_dwordx4 v[28:31], v61, s[12:15], s86 offen offset:1024 sc1
buffer_load_dwordx4 v[32:35], v61, s[12:15], s86 offen offset:2048 sc1
buffer_load_dwordx4 v[36:39], v61, s[12:15], s86 offen offset:3072 sc1
s_barrier
s_mov_b32 s92, 0x00030003
s_mov_b32 s93, 0x00030003
s_waitcnt vmcnt(0)
L_px_chk:
v_xor_b32 v24, s84, v24
v_xor_b32 v28, s84, v28
v_xor_b32 v32, s84, v32
v_xor_b32 v36, s84, v36
v_or3_b32 v2, v24, v28, v32
v_bitop3_b32 v2, v2, v36, s91 bitop3:0xa8
v_cmp_ne_u32 vcc, 0, v2
s_cbranch_vccnz L_px_rt
L_px_ok:
v_pk_add_f32 v[24:25], v[24:25], v[28:29]
v_pk_add_f32 v[32:33], v[32:33], v[36:37]
v_pk_add_f32 v[26:27], v[26:27], v[30:31]
v_pk_add_f32 v[34:35], v[34:35], v[38:39]
v_pk_add_f32 v[24:25], v[24:25], v[32:33]
v_pk_add_f32 v[26:27], v[26:27], v[34:35]
v_pk_mul_f32 v[24:25], v[24:25], v[22:23] op_sel_hi:[1,0]
v_pk_mul_f32 v[26:27], v[26:27], v[22:23] op_sel_hi:[1,0]
v_mul_f32 v28, 0xbfb8aa3b, v24
v_mul_f32 v29, 0xbfb8aa3b, v25
v_mul_f32 v30, 0xbfb8aa3b, v26
v_mul_f32 v31, 0xbfb8aa3b, v27
v_exp_f32 v28, v28
v_exp_f32 v29, v29
v_exp_f32 v30, v30
v_exp_f32 v31, v31
v_mul_f32_dpp v32, v24, v24 quad_perm:[2,3,0,1] row_mask:0xf bank_mask:0xf
v_mul_f32_dpp v33, v25, v25 quad_perm:[2,3,0,1] row_mask:0xf bank_mask:0xf
v_mul_f32_dpp v34, v26, v26 quad_perm:[2,3,0,1] row_mask:0xf bank_mask:0xf
v_mul_f32_dpp v35, v27, v27 quad_perm:[2,3,0,1] row_mask:0xf bank_mask:0xf
v_add_f32 v28, 1.0, v28
v_add_f32 v29, 1.0, v29
v_add_f32 v30, 1.0, v30
v_add_f32 v31, 1.0, v31
v_rcp_f32 v28, v28
v_rcp_f32 v29, v29
v_rcp_f32 v30, v30
v_rcp_f32 v31, v31
v_mul_f32 v24, v32, v28
v_mul_f32 v25, v33, v29
v_mul_f32 v26, v34, v30
v_mul_f32 v27, v35, v31
v_cvt_pk_bf16_f32 v28, v24, v25
v_cvt_pk_bf16_f32 v29, v26, v27
s_nop 0
v_mov_b32_dpp v30, v28 row_shl:4 row_mask:0xf bank_mask:0xf
v_mov_b32_dpp v31, v29 row_shl:4 row_mask:0xf bank_mask:0xf
v_mov_b32_dpp v32, v28 row_shl:8 row_mask:0xf bank_mask:0xf
v_mov_b32_dpp v33, v29 row_shl:8 row_mask:0xf bank_mask:0xf
v_mov_b32_dpp v34, v28 row_shl:12 row_mask:0xf bank_mask:0xf
v_mov_b32_dpp v35, v29 row_shl:12 row_mask:0xf bank_mask:0xf
v_mfma_f32_16x16x32_bf16 v[40:43], a[64:67], v[28:31], 0
v_mfma_f32_16x16x32_bf16 v[44:47], a[72:75], v[28:31], 0
v_mfma_f32_16x16x32_bf16 v[48:51], a[80:83], v[28:31], 0
v_mfma_f32_16x16x32_bf16 v[52:55], a[88:91], v[28:31], 0
v_mfma_f32_16x16x32_bf16 v[40:43], a[68:71], v[32:35], v[40:43]
v_mfma_f32_16x16x32_bf16 v[44:47], a[76:79], v[32:35], v[44:47]
v_mfma_f32_16x16x32_bf16 v[48:51], a[84:87], v[32:35], v[48:51]
v_mfma_f32_16x16x32_bf16 v[52:55], a[92:95], v[32:35], v[52:55]
s_cmp_ge_u32 s3, 14
s_cbranch_scc1 L_noy
s_mov_b64 exec, s[92:93]
s_nop 1
v_bfi_b32 v40, s91, v59, v40
buffer_store_dwordx4 v[40:43], v62, s[12:15], s88 offen sc1
s_add_u32 s88, s88, 8192
v_bfi_b32 v44, s91, v59, v44
buffer_store_dwordx4 v[44:47], v62, s[12:15], s88 offen sc1
s_add_u32 s88, s88, 8192
v_bfi_b32 v48, s91, v59, v48
buffer_store_dwordx4 v[48:51], v62, s[12:15], s88 offen sc1
s_add_u32 s88, s88, 8192
v_bfi_b32 v52, s91, v59, v52
buffer_store_dwordx4 v[52:55], v62, s[12:15], s88 offen sc1
s_mov_b64 exec, -1
L_noy:
s_or_b32 s70, s2, s60
s_cbranch_scc1 L_noep
v_mov_b32 v3, 0
s_mov_b64 exec, 1
buffer_store_dword v59, v3, s[12:15], 0 offen sc1
s_mov_b64 exec, -1
L_noep:
s_cmp_lt_u32 s63, 24
s_cbranch_scc1 L_ldone
s_cmp_lg_u32 s60, 1
s_cbranch_scc1 L_ldone
s_lshl_b32 s87, s62, 3
s_add_u32 s87, s87, s63
s_sub_u32 s87, s87, 24
s_lshl_b32 s88, s87, 13
s_add_u32 s88, s88, 7340032
s_add_u32 s71, s88, 4096
s_lshl_b32 s70, s87, 5
v_bfe_u32 v3, v1, 1, 2
v_lshl_add_u32 v7, v3, 3, s70
s_mov_b32 s72, 7864320
v_lshl_add_u32 v64, v23, 11, v7
buffer_load_dwordx2 v[84:85], v64, s[12:15], s72 offen sc1
buffer_load_dwordx4 v[120:123], v18, s[12:15], s88 offen offset:0 sc1
buffer_load_dwordx4 v[124:127], v18, s[12:15], s88 offen offset:1024 sc1
buffer_load_dwordx4 v[128:131], v18, s[12:15], s88 offen offset:2048 sc1
buffer_load_dwordx4 v[132:135], v18, s[12:15], s88 offen offset:3072 sc1
buffer_load_dwordx4 v[136:139], v18, s[12:15], s71 offen offset:0 sc1
buffer_load_dwordx4 v[140:143], v18, s[12:15], s71 offen offset:1024 sc1
buffer_load_dwordx4 v[144:147], v18, s[12:15], s71 offen offset:2048 sc1
v_mov_b32 v88, s84
v_and_b32 v65, 0xfffff800, v20
v_not_b32 v4, v65
v_ashrrev_i32 v4, 31, v4
v_or_b32 v4, 0x80000000, v4
v_xor_b32 v65, v65, v4
v_mul_f32 v65, 0xbfb8aa3b, v65
v_exp_f32 v65, v65
s_nop 0
v_add_f32 v65, 1.0, v65
v_rcp_f32 v65, v65
v_and_b32 v66, 0x7ff, v20
v_sub_u32 v66, 2047, v66
v_lshl_add_u32 v66, v66, 11, v7
v_add_f32 v67, 1.0, v22
v_mul_f32_e64 v21, -v21, v22
s_waitcnt vmcnt(7)
L_h_chk:
v_cmp_eq_u32 vcc, -1, v84
s_cbranch_vccnz L_h_rt
L_h_ok:
v_lshlrev_b32 v86, 16, v85
v_and_b32 v87, 0xffff0000, v85
v_and_b32 v85, 0xffff0000, v84
v_lshlrev_b32 v84, 16, v84
v_fma_f32 v84, v84, v67, v21
v_fma_f32 v85, v85, v67, v21
v_fma_f32 v86, v86, v67, v21
v_fma_f32 v87, v87, v67, v21
s_waitcnt vmcnt(0)
L_y_chk:
v_xor_b32 v120, s84, v120
v_xor_b32 v124, s84, v124
v_xor_b32 v128, s84, v128
v_xor_b32 v132, s84, v132
v_or3_b32 v2, v120, v124, v128
v_xor_b32 v136, s84, v136
v_xor_b32 v140, s84, v140
v_or3_b32 v2, v2, v132, v136
v_xor_b32 v144, s84, v144
v_xor_b32 v88, s84, v88
v_or3_b32 v2, v2, v140, v144
v_bitop3_b32 v2, v2, v88, s91 bitop3:0xa8
v_cmp_ne_u32 vcc, 0, v2
s_cbranch_vccnz L_y_rt
L_y_ok:
v_pk_add_f32 v[120:121], v[120:121], v[124:125]
v_pk_add_f32 v[122:123], v[122:123], v[126:127]
v_pk_add_f32 v[128:129], v[128:129], v[132:133]
v_pk_add_f32 v[130:131], v[130:131], v[134:135]
v_pk_add_f32 v[136:137], v[136:137], v[140:141]
v_pk_add_f32 v[138:139], v[138:139], v[142:143]
v_pk_add_f32 v[120:121], v[120:121], v[128:129]
v_pk_add_f32 v[122:123], v[122:123], v[130:131]
v_pk_add_f32 v[136:137], v[136:137], v[144:145]
v_pk_add_f32 v[138:139], v[138:139], v[146:147]
v_pk_add_f32 v[120:121], v[120:121], v[136:137]
v_pk_add_f32 v[122:123], v[122:123], v[138:139]
s_nop 0
v_add_f32_dpp v120, v120, v120 row_ror:8 row_mask:0xf bank_mask:0xf
v_add_f32_dpp v121, v121, v121 row_ror:8 row_mask:0xf bank_mask:0xf
v_add_f32_dpp v122, v122, v122 row_ror:8 row_mask:0xf bank_mask:0xf
v_add_f32_dpp v123, v123, v123 row_ror:8 row_mask:0xf bank_mask:0xf
v_mov_b32 v124, v120
v_mov_b32 v125, v121
v_mov_b32 v126, v122
v_mov_b32 v127, v123
v_permlane16_swap_b32 v120, v124
s_branch L_over2
L_pad2:
s_branch L_pad10
L_over2:
v_permlane16_swap_b32 v121, v125
v_permlane16_swap_b32 v122, v126
v_permlane16_swap_b32 v123, v127
v_add_f32 v120, v120, v124
v_add_f32 v121, v121, v125
v_add_f32 v122, v122, v126
v_add_f32 v123, v123, v127
v_mov_b32 v124, v120
v_mov_b32 v125, v121
v_mov_b32 v126, v122
v_mov_b32 v127, v123
v_permlane32_swap_b32 v120, v124
v_permlane32_swap_b32 v121, v125
v_permlane32_swap_b32 v122, v126
v_permlane32_swap_b32 v123, v127
v_add_f32 v120, v120, v124
v_add_f32 v121, v121, v125
v_add_f32 v122, v122, v126
v_add_f32 v123, v123, v127
v_fmac_f32 v84, v120, v65
v_fmac_f32 v85, v121, v65
v_fmac_f32 v86, v122, v65
v_fmac_f32 v87, v123, v65
v_cvt_pk_bf16_f32 v84, v84, v85
v_cvt_pk_bf16_f32 v85, v86, v87
s_mov_b64 exec, 0xff
buffer_store_dwordx2 v[84:85], v66, s[20:23], 0 offen sc1
L_ldone:
s_endpgm
.p2alignl 12, 0xbf810000
.fill 0, 4, 0xbf810000
L_compute:
v_and_b32 v2, 15, v1
v_lshrrev_b32 v4, 4, v1
v_lshrrev_b32 v3, 1, v2
v_xor_b32 v3, v3, v4
v_lshlrev_b32 v2, 7, v2
s_lshl_b32 s70, s66, 13
v_add_u32 v2, s70, v2
v_xor_b32 v5, 0, v3
v_lshl_add_u32 v8, v5, 4, v2
v_add_u32 v10, 65536, v8
v_xor_b32 v5, 4, v3
v_lshl_add_u32 v9, v5, 4, v2
v_add_u32 v11, 65536, v9
v_lshrrev_b32 v2, 5, v1
v_mul_u32_u24 v2, 6144, v2
v_bfe_u32 v3, v1, 4, 1
v_lshl_add_u32 v2, v3, 10, v2
v_bfe_u32 v4, v1, 2, 2
v_lshl_add_u32 v2, v4, 7, v2
v_lshlrev_b32 v3, 1, v3
v_bfe_u32 v4, v1, 3, 1
v_or_b32 v3, v3, v4
s_lshl_b32 s70, s67, 1
v_xor_b32 v3, s70, v3
v_and_b32 v4, 3, v1
v_lshl_add_u32 v2, v4, 3, v2
v_xor_b32 v4, 0, v3
v_lshl_add_u32 v12, v4, 5, v2
v_add_u32 v14, 65536, v12
v_xor_b32 v4, 1, v3
v_lshl_add_u32 v13, v4, 5, v2
v_add_u32 v15, 65536, v13
s_waitcnt lgkmcnt(0)
s_mov_b32 s12, s58
s_and_b32 s13, s59, 0xffff
s_mov_b32 s14, 268435456
s_mov_b32 s15, 0x20000
s_load_dword s68, s[58:59], 0
s_mov_b32 s20, s56
s_and_b32 s21, s57, 0xffff
s_mov_b32 s22, 4194304
s_mov_b32 s23, 0x20000
s_lshl_b32 s87, s64, 4
s_add_u32 s87, s87, s65
s_mul_i32 s87, s87, 4352
s_add_u32 s87, s87, 524288
s_lshl_b32 s88, s65, 18
s_lshl_b32 s70, s66, 17
s_add_u32 s88, s88, s70
s_lshl_b32 s70, s64, 11
s_add_u32 s88, s88, s70
s_lshl_b32 s70, s67, 10
s_add_u32 s88, s88, s70
s_add_u32 s88, s88, 2097152
s_mov_b32 s70, 0x3f803f80
v_accvgpr_write_b32 a80, s70
v_accvgpr_write_b32 a81, s70
v_accvgpr_write_b32 a82, s70
v_accvgpr_write_b32 a83, s70
s_mov_b32 s80, 0x358637bd
s_mov_b32 s81, 0x358637bd
s_mov_b32 s82, 0x3f800008
s_mov_b32 s83, 0x3f800008
s_mov_b32 s90, 0x3fb8aa3b
s_mov_b32 s91, 0x3fb8aa3b
s_waitcnt lgkmcnt(0)
s_add_u32 s68, s68, 1
v_and_b32 v7, 3, v1
v_lshrrev_b32_e64 v7, v7, s68
v_and_b32 v7, 1, v7
v_mul_u32_u24 v7, 0x10001, v7
s_mov_b32 s76, 0x10001
s_mov_b32 s77, 0x07060302
s_movk_i32 s85, 0xff
v_mov_b32 v28, -1
v_mov_b32 v29, -1
v_mov_b32 v30, -1
v_mov_b32 v31, -1
s_and_b32 s94, s65, 3
s_or_b32 s94, s94, s66
s_barrier
ds_read_b128 a[0:3], v10 offset:57344
ds_read_b64_tr_b16 a[32:33], v12 offset:0
ds_read_b64_tr_b16 a[34:35], v12 offset:512
ds_read_b128 a[4:7], v10 offset:59392
ds_read_b128 a[8:11], v10 offset:61440
ds_read_b128 a[12:15], v10 offset:63488
ds_read_b64_tr_b16 a[36:37], v13 offset:0
ds_read_b64_tr_b16 a[38:39], v13 offset:512
ds_read_b64_tr_b16 a[40:41], v12 offset:2048
ds_read_b64_tr_b16 a[42:43], v12 offset:2560
ds_read_b64_tr_b16 a[44:45], v13 offset:2048
ds_read_b64_tr_b16 a[46:47], v13 offset:2560
ds_read_b64_tr_b16 a[48:49], v12 offset:4096
ds_read_b64_tr_b16 a[50:51], v12 offset:4608
ds_read_b64_tr_b16 a[52:53], v13 offset:4096
ds_read_b64_tr_b16 a[54:55], v13 offset:4608
s_waitcnt lgkmcnt(0)
s_cmp_lg_u32 s94, 0
s_cbranch_scc1 L_nocs0_0
v_mfma_f32_16x16x32_bf16 v[128:131], a[80:83], a[32:35], 0
v_mfma_f32_16x16x32_bf16 v[132:135], a[80:83], a[36:39], 0
v_mfma_f32_16x16x32_bf16 v[136:139], a[80:83], a[40:43], 0
v_mfma_f32_16x16x32_bf16 v[140:143], a[80:83], a[44:47], 0
v_mfma_f32_16x16x32_bf16 v[144:147], a[80:83], a[48:51], 0
v_mfma_f32_16x16x32_bf16 v[148:151], a[80:83], a[52:55], 0
L_nocs0_0:
v_mfma_f32_16x16x32_bf16 v[32:35], a[32:35], a[0:3], 0
ds_read_b128 a[16:19], v11 offset:57344
v_mfma_f32_16x16x32_bf16 v[56:59], a[32:35], a[4:7], 0
ds_read_b64_tr_b16 a[56:57], v12 offset:12288
v_mfma_f32_16x16x32_bf16 v[80:83], a[32:35], a[8:11], 0
ds_read_b64_tr_b16 a[58:59], v12 offset:12800
v_mfma_f32_16x16x32_bf16 v[104:107], a[32:35], a[12:15], 0
ds_read_b128 a[20:23], v11 offset:59392
v_mfma_f32_16x16x32_bf16 v[36:39], a[36:39], a[0:3], 0
ds_read_b128 a[24:27], v11 offset:61440
v_mfma_f32_16x16x32_bf16 v[60:63], a[36:39], a[4:7], 0
ds_read_b128 a[28:31], v11 offset:63488
v_mfma_f32_16x16x32_bf16 v[84:87], a[36:39], a[8:11], 0
ds_read_b64_tr_b16 a[60:61], v13 offset:12288
v_mfma_f32_16x16x32_bf16 v[108:111], a[36:39], a[12:15], 0
ds_read_b64_tr_b16 a[62:63], v13 offset:12800
v_mfma_f32_16x16x32_bf16 v[40:43], a[0:3], a[40:43], 0
ds_read_b64_tr_b16 a[64:65], v12 offset:14336
v_mfma_f32_16x16x32_bf16 v[64:67], a[4:7], a[40:43], 0
ds_read_b64_tr_b16 a[66:67], v12 offset:14848
v_mfma_f32_16x16x32_bf16 v[88:91], a[8:11], a[40:43], 0
ds_read_b64_tr_b16 a[68:69], v13 offset:14336
v_mfma_f32_16x16x32_bf16 v[112:115], a[12:15], a[40:43], 0
ds_read_b64_tr_b16 a[70:71], v13 offset:14848
v_mfma_f32_16x16x32_bf16 v[44:47], a[0:3], a[44:47], 0
ds_read_b64_tr_b16 a[72:73], v12 offset:16384
v_mfma_f32_16x16x32_bf16 v[68:71], a[4:7], a[44:47], 0
ds_read_b64_tr_b16 a[74:75], v12 offset:16896
v_mfma_f32_16x16x32_bf16 v[92:95], a[8:11], a[44:47], 0
ds_read_b64_tr_b16 a[76:77], v13 offset:16384
v_mfma_f32_16x16x32_bf16 v[116:119], a[12:15], a[44:47], 0
ds_read_b64_tr_b16 a[78:79], v13 offset:16896
v_mfma_f32_16x16x32_bf16 v[48:51], a[0:3], a[48:51], 0
v_mfma_f32_16x16x32_bf16 v[72:75], a[4:7], a[48:51], 0
v_mfma_f32_16x16x32_bf16 v[96:99], a[8:11], a[48:51], 0
v_mfma_f32_16x16x32_bf16 v[120:123], a[12:15], a[48:51], 0
v_mfma_f32_16x16x32_bf16 v[52:55], a[0:3], a[52:55], 0
v_mfma_f32_16x16x32_bf16 v[76:79], a[4:7], a[52:55], 0
v_mfma_f32_16x16x32_bf16 v[100:103], a[8:11], a[52:55], 0
v_mfma_f32_16x16x32_bf16 v[124:127], a[12:15], a[52:55], 0
s_waitcnt lgkmcnt(0)
s_cmp_lg_u32 s94, 0
s_cbranch_scc1 L_nocs0_1
v_mfma_f32_16x16x32_bf16 v[128:131], a[80:83], a[56:59], v[128:131]
v_mfma_f32_16x16x32_bf16 v[132:135], a[80:83], a[60:63], v[132:135]
v_mfma_f32_16x16x32_bf16 v[136:139], a[80:83], a[64:67], v[136:139]
v_mfma_f32_16x16x32_bf16 v[140:143], a[80:83], a[68:71], v[140:143]
v_mfma_f32_16x16x32_bf16 v[144:147], a[80:83], a[72:75], v[144:147]
v_mfma_f32_16x16x32_bf16 v[148:151], a[80:83], a[76:79], v[148:151]
L_nocs0_1:
v_mfma_f32_16x16x32_bf16 v[32:35], a[56:59], a[16:19], v[32:35]
s_barrier
ds_read_b128 a[0:3], v10 offset:40960
v_mfma_f32_16x16x32_bf16 v[56:59], a[56:59], a[20:23], v[56:59]
ds_read_b64_tr_b16 a[32:33], v14 offset:16384
v_mfma_f32_16x16x32_bf16 v[80:83], a[56:59], a[24:27], v[80:83]
ds_read_b64_tr_b16 a[34:35], v14 offset:16896
v_mfma_f32_16x16x32_bf16 v[104:107], a[56:59], a[28:31], v[104:107]
ds_read_b128 a[4:7], v10 offset:43008
v_mfma_f32_16x16x32_bf16 v[36:39], a[60:63], a[16:19], v[36:39]
ds_read_b128 a[8:11], v10 offset:45056
v_mfma_f32_16x16x32_bf16 v[60:63], a[60:63], a[20:23], v[60:63]
ds_read_b128 a[12:15], v10 offset:47104
v_mfma_f32_16x16x32_bf16 v[84:87], a[60:63], a[24:27], v[84:87]
ds_read_b64_tr_b16 a[36:37], v15 offset:16384
v_mfma_f32_16x16x32_bf16 v[108:111], a[60:63], a[28:31], v[108:111]
ds_read_b64_tr_b16 a[38:39], v15 offset:16896
v_mfma_f32_16x16x32_bf16 v[40:43], a[16:19], a[64:67], v[40:43]
ds_read_b64_tr_b16 a[40:41], v14 offset:18432
v_mfma_f32_16x16x32_bf16 v[64:67], a[20:23], a[64:67], v[64:67]
ds_read_b64_tr_b16 a[42:43], v14 offset:18944
v_mfma_f32_16x16x32_bf16 v[88:91], a[24:27], a[64:67], v[88:91]
ds_read_b64_tr_b16 a[44:45], v15 offset:18432
v_mfma_f32_16x16x32_bf16 v[112:115], a[28:31], a[64:67], v[112:115]
ds_read_b64_tr_b16 a[46:47], v15 offset:18944
v_mfma_f32_16x16x32_bf16 v[44:47], a[16:19], a[68:71], v[44:47]
ds_read_b64_tr_b16 a[48:49], v14 offset:20480
v_mfma_f32_16x16x32_bf16 v[68:71], a[20:23], a[68:71], v[68:71]
ds_read_b64_tr_b16 a[50:51], v14 offset:20992
v_mfma_f32_16x16x32_bf16 v[92:95], a[24:27], a[68:71], v[92:95]
ds_read_b64_tr_b16 a[52:53], v15 offset:20480
v_mfma_f32_16x16x32_bf16 v[116:119], a[28:31], a[68:71], v[116:119]
ds_read_b64_tr_b16 a[54:55], v15 offset:20992
v_mfma_f32_16x16x32_bf16 v[48:51], a[16:19], a[72:75], v[48:51]
v_mfma_f32_16x16x32_bf16 v[72:75], a[20:23], a[72:75], v[72:75]
v_mfma_f32_16x16x32_bf16 v[96:99], a[24:27], a[72:75], v[96:99]
v_mfma_f32_16x16x32_bf16 v[120:123], a[28:31], a[72:75], v[120:123]
v_mfma_f32_16x16x32_bf16 v[52:55], a[16:19], a[76:79], v[52:55]
v_mfma_f32_16x16x32_bf16 v[76:79], a[20:23], a[76:79], v[76:79]
v_mfma_f32_16x16x32_bf16 v[100:103], a[24:27], a[76:79], v[100:103]
v_mfma_f32_16x16x32_bf16 v[124:127], a[28:31], a[76:79], v[124:127]
s_waitcnt lgkmcnt(0)
s_cmp_lg_u32 s94, 0
s_cbranch_scc1 L_nocs1_0
v_mfma_f32_16x16x32_bf16 v[128:131], a[80:83], a[32:35], v[128:131]
v_mfma_f32_16x16x32_bf16 v[132:135], a[80:83], a[36:39], v[132:135]
v_mfma_f32_16x16x32_bf16 v[136:139], a[80:83], a[40:43], v[136:139]
v_mfma_f32_16x16x32_bf16 v[140:143], a[80:83], a[44:47], v[140:143]
v_mfma_f32_16x16x32_bf16 v[144:147], a[80:83], a[48:51], v[144:147]
v_mfma_f32_16x16x32_bf16 v[148:151], a[80:83], a[52:55], v[148:151]
L_nocs1_0:
v_mfma_f32_16x16x32_bf16 v[32:35], a[32:35], a[0:3], v[32:35]
ds_read_b128 a[16:19], v11 offset:40960
v_mfma_f32_16x16x32_bf16 v[56:59], a[32:35], a[4:7], v[56:59]
ds_read_b64_tr_b16 a[56:57], v14 offset:28672
v_mfma_f32_16x16x32_bf16 v[80:83], a[32:35], a[8:11], v[80:83]
ds_read_b64_tr_b16 a[58:59], v14 offset:29184
v_mfma_f32_16x16x32_bf16 v[104:107], a[32:35], a[12:15], v[104:107]
ds_read_b128 a[20:23], v11 offset:43008
v_mfma_f32_16x16x32_bf16 v[36:39], a[36:39], a[0:3], v[36:39]
ds_read_b128 a[24:27], v11 offset:45056
v_mfma_f32_16x16x32_bf16 v[60:63], a[36:39], a[4:7], v[60:63]
ds_read_b128 a[28:31], v11 offset:47104
v_mfma_f32_16x16x32_bf16 v[84:87], a[36:39], a[8:11], v[84:87]
ds_read_b64_tr_b16 a[60:61], v15 offset:28672
v_mfma_f32_16x16x32_bf16 v[108:111], a[36:39], a[12:15], v[108:111]
ds_read_b64_tr_b16 a[62:63], v15 offset:29184
v_mfma_f32_16x16x32_bf16 v[40:43], a[0:3], a[40:43], v[40:43]
ds_read_b64_tr_b16 a[64:65], v14 offset:30720
v_mfma_f32_16x16x32_bf16 v[64:67], a[4:7], a[40:43], v[64:67]
ds_read_b64_tr_b16 a[66:67], v14 offset:31232
v_mfma_f32_16x16x32_bf16 v[88:91], a[8:11], a[40:43], v[88:91]
ds_read_b64_tr_b16 a[68:69], v15 offset:30720
v_mfma_f32_16x16x32_bf16 v[112:115], a[12:15], a[40:43], v[112:115]
ds_read_b64_tr_b16 a[70:71], v15 offset:31232
v_mfma_f32_16x16x32_bf16 v[44:47], a[0:3], a[44:47], v[44:47]
ds_read_b64_tr_b16 a[72:73], v14 offset:32768
v_mfma_f32_16x16x32_bf16 v[68:71], a[4:7], a[44:47], v[68:71]
ds_read_b64_tr_b16 a[74:75], v14 offset:33280
v_mfma_f32_16x16x32_bf16 v[92:95], a[8:11], a[44:47], v[92:95]
ds_read_b64_tr_b16 a[76:77], v15 offset:32768
v_mfma_f32_16x16x32_bf16 v[116:119], a[12:15], a[44:47], v[116:119]
ds_read_b64_tr_b16 a[78:79], v15 offset:33280
v_mfma_f32_16x16x32_bf16 v[48:51], a[0:3], a[48:51], v[48:51]
v_mfma_f32_16x16x32_bf16 v[72:75], a[4:7], a[48:51], v[72:75]
v_mfma_f32_16x16x32_bf16 v[96:99], a[8:11], a[48:51], v[96:99]
v_mfma_f32_16x16x32_bf16 v[120:123], a[12:15], a[48:51], v[120:123]
v_mfma_f32_16x16x32_bf16 v[52:55], a[0:3], a[52:55], v[52:55]
v_mfma_f32_16x16x32_bf16 v[76:79], a[4:7], a[52:55], v[76:79]
v_mfma_f32_16x16x32_bf16 v[100:103], a[8:11], a[52:55], v[100:103]
v_mfma_f32_16x16x32_bf16 v[124:127], a[12:15], a[52:55], v[124:127]
s_waitcnt lgkmcnt(0)
s_cmp_lg_u32 s94, 0
s_cbranch_scc1 L_nocs1_1
v_mfma_f32_16x16x32_bf16 v[128:131], a[80:83], a[56:59], v[128:131]
v_mfma_f32_16x16x32_bf16 v[132:135], a[80:83], a[60:63], v[132:135]
v_mfma_f32_16x16x32_bf16 v[136:139], a[80:83], a[64:67], v[136:139]
v_mfma_f32_16x16x32_bf16 v[140:143], a[80:83], a[68:71], v[140:143]
v_mfma_f32_16x16x32_bf16 v[144:147], a[80:83], a[72:75], v[144:147]
v_mfma_f32_16x16x32_bf16 v[148:151], a[80:83], a[76:79], v[148:151]
L_nocs1_1:
v_mfma_f32_16x16x32_bf16 v[32:35], a[56:59], a[16:19], v[32:35]
s_barrier
ds_read_b128 a[0:3], v10 offset:0
v_mfma_f32_16x16x32_bf16 v[56:59], a[56:59], a[20:23], v[56:59]
ds_read_b64_tr_b16 a[32:33], v12 offset:40960
v_mfma_f32_16x16x32_bf16 v[80:83], a[56:59], a[24:27], v[80:83]
ds_read_b64_tr_b16 a[34:35], v12 offset:41472
v_mfma_f32_16x16x32_bf16 v[104:107], a[56:59], a[28:31], v[104:107]
ds_read_b128 a[4:7], v10 offset:2048
v_mfma_f32_16x16x32_bf16 v[36:39], a[60:63], a[16:19], v[36:39]
ds_read_b128 a[8:11], v10 offset:4096
v_mfma_f32_16x16x32_bf16 v[60:63], a[60:63], a[20:23], v[60:63]
ds_read_b128 a[12:15], v10 offset:6144
v_mfma_f32_16x16x32_bf16 v[84:87], a[60:63], a[24:27], v[84:87]
ds_read_b64_tr_b16 a[36:37], v13 offset:40960
v_mfma_f32_16x16x32_bf16 v[108:111], a[60:63], a[28:31], v[108:111]
ds_read_b64_tr_b16 a[38:39], v13 offset:41472
v_mfma_f32_16x16x32_bf16 v[40:43], a[16:19], a[64:67], v[40:43]
ds_read_b64_tr_b16 a[40:41], v12 offset:43008
v_mfma_f32_16x16x32_bf16 v[64:67], a[20:23], a[64:67], v[64:67]
ds_read_b64_tr_b16 a[42:43], v12 offset:43520
v_mfma_f32_16x16x32_bf16 v[88:91], a[24:27], a[64:67], v[88:91]
ds_read_b64_tr_b16 a[44:45], v13 offset:43008
v_mfma_f32_16x16x32_bf16 v[112:115], a[28:31], a[64:67], v[112:115]
ds_read_b64_tr_b16 a[46:47], v13 offset:43520
v_mfma_f32_16x16x32_bf16 v[44:47], a[16:19], a[68:71], v[44:47]
ds_read_b64_tr_b16 a[48:49], v12 offset:45056
v_mfma_f32_16x16x32_bf16 v[68:71], a[20:23], a[68:71], v[68:71]
ds_read_b64_tr_b16 a[50:51], v12 offset:45568
v_mfma_f32_16x16x32_bf16 v[92:95], a[24:27], a[68:71], v[92:95]
ds_read_b64_tr_b16 a[52:53], v13 offset:45056
v_mfma_f32_16x16x32_bf16 v[116:119], a[28:31], a[68:71], v[116:119]
ds_read_b64_tr_b16 a[54:55], v13 offset:45568
v_mfma_f32_16x16x32_bf16 v[48:51], a[16:19], a[72:75], v[48:51]
v_mfma_f32_16x16x32_bf16 v[72:75], a[20:23], a[72:75], v[72:75]
v_mfma_f32_16x16x32_bf16 v[96:99], a[24:27], a[72:75], v[96:99]
v_mfma_f32_16x16x32_bf16 v[120:123], a[28:31], a[72:75], v[120:123]
v_mfma_f32_16x16x32_bf16 v[52:55], a[16:19], a[76:79], v[52:55]
v_mfma_f32_16x16x32_bf16 v[76:79], a[20:23], a[76:79], v[76:79]
v_mfma_f32_16x16x32_bf16 v[100:103], a[24:27], a[76:79], v[100:103]
v_mfma_f32_16x16x32_bf16 v[124:127], a[28:31], a[76:79], v[124:127]
s_waitcnt lgkmcnt(0)
s_cmp_lg_u32 s94, 0
s_cbranch_scc1 L_nocs2_0
v_mfma_f32_16x16x32_bf16 v[128:131], a[80:83], a[32:35], v[128:131]
v_mfma_f32_16x16x32_bf16 v[132:135], a[80:83], a[36:39], v[132:135]
v_mfma_f32_16x16x32_bf16 v[136:139], a[80:83], a[40:43], v[136:139]
v_mfma_f32_16x16x32_bf16 v[140:143], a[80:83], a[44:47], v[140:143]
v_mfma_f32_16x16x32_bf16 v[144:147], a[80:83], a[48:51], v[144:147]
v_mfma_f32_16x16x32_bf16 v[148:151], a[80:83], a[52:55], v[148:151]
L_nocs2_0:
v_mfma_f32_16x16x32_bf16 v[32:35], a[32:35], a[0:3], v[32:35]
ds_read_b128 a[16:19], v11 offset:0
v_mfma_f32_16x16x32_bf16 v[56:59], a[32:35], a[4:7], v[56:59]
ds_read_b64_tr_b16 a[56:57], v12 offset:53248
v_mfma_f32_16x16x32_bf16 v[80:83], a[32:35], a[8:11], v[80:83]
ds_read_b64_tr_b16 a[58:59], v12 offset:53760
v_mfma_f32_16x16x32_bf16 v[104:107], a[32:35], a[12:15], v[104:107]
ds_read_b128 a[20:23], v11 offset:2048
v_mfma_f32_16x16x32_bf16 v[36:39], a[36:39], a[0:3], v[36:39]
ds_read_b128 a[24:27], v11 offset:4096
v_mfma_f32_16x16x32_bf16 v[60:63], a[36:39], a[4:7], v[60:63]
ds_read_b128 a[28:31], v11 offset:6144
v_mfma_f32_16x16x32_bf16 v[84:87], a[36:39], a[8:11], v[84:87]
ds_read_b64_tr_b16 a[60:61], v13 offset:53248
v_mfma_f32_16x16x32_bf16 v[108:111], a[36:39], a[12:15], v[108:111]
ds_read_b64_tr_b16 a[62:63], v13 offset:53760
v_mfma_f32_16x16x32_bf16 v[40:43], a[0:3], a[40:43], v[40:43]
ds_read_b64_tr_b16 a[64:65], v12 offset:55296
v_mfma_f32_16x16x32_bf16 v[64:67], a[4:7], a[40:43], v[64:67]
ds_read_b64_tr_b16 a[66:67], v12 offset:55808
v_mfma_f32_16x16x32_bf16 v[88:91], a[8:11], a[40:43], v[88:91]
ds_read_b64_tr_b16 a[68:69], v13 offset:55296
v_mfma_f32_16x16x32_bf16 v[112:115], a[12:15], a[40:43], v[112:115]
ds_read_b64_tr_b16 a[70:71], v13 offset:55808
v_mfma_f32_16x16x32_bf16 v[44:47], a[0:3], a[44:47], v[44:47]
ds_read_b64_tr_b16 a[72:73], v12 offset:57344
v_mfma_f32_16x16x32_bf16 v[68:71], a[4:7], a[44:47], v[68:71]
ds_read_b64_tr_b16 a[74:75], v12 offset:57856
v_mfma_f32_16x16x32_bf16 v[92:95], a[8:11], a[44:47], v[92:95]
ds_read_b64_tr_b16 a[76:77], v13 offset:57344
v_mfma_f32_16x16x32_bf16 v[116:119], a[12:15], a[44:47], v[116:119]
ds_read_b64_tr_b16 a[78:79], v13 offset:57856
v_mfma_f32_16x16x32_bf16 v[48:51], a[0:3], a[48:51], v[48:51]
s_lshl_b32 s70, s60, 10
s_add_u32 s70, s70, s87
buffer_store_dwordx4 v[28:31], v16, s[12:15], s70 offen sc1
v_mfma_f32_16x16x32_bf16 v[72:75], a[4:7], a[48:51], v[72:75]
v_mfma_f32_16x16x32_bf16 v[96:99], a[8:11], a[48:51], v[96:99]
v_mfma_f32_16x16x32_bf16 v[120:123], a[12:15], a[48:51], v[120:123]
v_mfma_f32_16x16x32_bf16 v[52:55], a[0:3], a[52:55], v[52:55]
v_mfma_f32_16x16x32_bf16 v[76:79], a[4:7], a[52:55], v[76:79]
v_mfma_f32_16x16x32_bf16 v[100:103], a[8:11], a[52:55], v[100:103]
v_mfma_f32_16x16x32_bf16 v[124:127], a[12:15], a[52:55], v[124:127]
s_waitcnt lgkmcnt(0)
s_cmp_lg_u32 s94, 0
s_cbranch_scc1 L_nocs2_1
v_mfma_f32_16x16x32_bf16 v[128:131], a[80:83], a[56:59], v[128:131]
v_mfma_f32_16x16x32_bf16 v[132:135], a[80:83], a[60:63], v[132:135]
v_mfma_f32_16x16x32_bf16 v[136:139], a[80:83], a[64:67], v[136:139]
v_mfma_f32_16x16x32_bf16 v[140:143], a[80:83], a[68:71], v[140:143]
v_mfma_f32_16x16x32_bf16 v[144:147], a[80:83], a[72:75], v[144:147]
v_mfma_f32_16x16x32_bf16 v[148:151], a[80:83], a[76:79], v[148:151]
L_nocs2_1:
v_mfma_f32_16x16x32_bf16 v[32:35], a[56:59], a[16:19], v[32:35]
s_barrier
ds_read_b128 a[0:3], v8 offset:24576
v_mfma_f32_16x16x32_bf16 v[56:59], a[56:59], a[20:23], v[56:59]
ds_read_b64_tr_b16 a[32:33], v12 offset:0
v_mfma_f32_16x16x32_bf16 v[80:83], a[56:59], a[24:27], v[80:83]
ds_read_b64_tr_b16 a[34:35], v12 offset:512
v_mfma_f32_16x16x32_bf16 v[104:107], a[56:59], a[28:31], v[104:107]
ds_read_b128 a[4:7], v8 offset:26624
v_mfma_f32_16x16x32_bf16 v[36:39], a[60:63], a[16:19], v[36:39]
ds_read_b128 a[8:11], v8 offset:28672
v_mfma_f32_16x16x32_bf16 v[60:63], a[60:63], a[20:23], v[60:63]
ds_read_b128 a[12:15], v8 offset:30720
v_mfma_f32_16x16x32_bf16 v[84:87], a[60:63], a[24:27], v[84:87]
ds_read_b64_tr_b16 a[36:37], v13 offset:0
v_mfma_f32_16x16x32_bf16 v[108:111], a[60:63], a[28:31], v[108:111]
ds_read_b64_tr_b16 a[38:39], v13 offset:512
v_mfma_f32_16x16x32_bf16 v[40:43], a[16:19], a[64:67], v[40:43]
ds_read_b64_tr_b16 a[40:41], v12 offset:2048
v_mfma_f32_16x16x32_bf16 v[64:67], a[20:23], a[64:67], v[64:67]
ds_read_b64_tr_b16 a[42:43], v12 offset:2560
v_mfma_f32_16x16x32_bf16 v[88:91], a[24:27], a[64:67], v[88:91]
ds_read_b64_tr_b16 a[44:45], v13 offset:2048
v_mfma_f32_16x16x32_bf16 v[112:115], a[28:31], a[64:67], v[112:115]
ds_read_b64_tr_b16 a[46:47], v13 offset:2560
v_mfma_f32_16x16x32_bf16 v[44:47], a[16:19], a[68:71], v[44:47]
ds_read_b64_tr_b16 a[48:49], v12 offset:4096
v_mfma_f32_16x16x32_bf16 v[68:71], a[20:23], a[68:71], v[68:71]
ds_read_b64_tr_b16 a[50:51], v12 offset:4608
v_mfma_f32_16x16x32_bf16 v[92:95], a[24:27], a[68:71], v[92:95]
ds_read_b64_tr_b16 a[52:53], v13 offset:4096
v_mfma_f32_16x16x32_bf16 v[116:119], a[28:31], a[68:71], v[116:119]
ds_read_b64_tr_b16 a[54:55], v13 offset:4608
v_mfma_f32_16x16x32_bf16 v[48:51], a[16:19], a[72:75], v[48:51]
v_mfma_f32_16x16x32_bf16 v[72:75], a[20:23], a[72:75], v[72:75]
v_mfma_f32_16x16x32_bf16 v[96:99], a[24:27], a[72:75], v[96:99]
v_mfma_f32_16x16x32_bf16 v[120:123], a[28:31], a[72:75], v[120:123]
v_mfma_f32_16x16x32_bf16 v[52:55], a[16:19], a[76:79], v[52:55]
v_mfma_f32_16x16x32_bf16 v[76:79], a[20:23], a[76:79], v[76:79]
v_mfma_f32_16x16x32_bf16 v[100:103], a[24:27], a[76:79], v[100:103]
v_mfma_f32_16x16x32_bf16 v[124:127], a[28:31], a[76:79], v[124:127]
s_waitcnt lgkmcnt(0)
s_cmp_lg_u32 s94, 0
s_cbranch_scc1 L_nocs3_0
v_mfma_f32_16x16x32_bf16 v[128:131], a[80:83], a[32:35], v[128:131]
v_mfma_f32_16x16x32_bf16 v[132:135], a[80:83], a[36:39], v[132:135]
v_mfma_f32_16x16x32_bf16 v[136:139], a[80:83], a[40:43], v[136:139]
v_mfma_f32_16x16x32_bf16 v[140:143], a[80:83], a[44:47], v[140:143]
v_mfma_f32_16x16x32_bf16 v[144:147], a[80:83], a[48:51], v[144:147]
v_mfma_f32_16x16x32_bf16 v[148:151], a[80:83], a[52:55], v[148:151]
L_nocs3_0:
v_mfma_f32_16x16x32_bf16 v[32:35], a[32:35], a[0:3], v[32:35]
ds_read_b128 a[16:19], v9 offset:24576
v_mfma_f32_16x16x32_bf16 v[56:59], a[32:35], a[4:7], v[56:59]
ds_read_b64_tr_b16 a[56:57], v12 offset:12288
v_mfma_f32_16x16x32_bf16 v[80:83], a[32:35], a[8:11], v[80:83]
ds_read_b64_tr_b16 a[58:59], v12 offset:12800
v_mfma_f32_16x16x32_bf16 v[104:107], a[32:35], a[12:15], v[104:107]
ds_read_b128 a[20:23], v9 offset:26624
v_mfma_f32_16x16x32_bf16 v[36:39], a[36:39], a[0:3], v[36:39]
ds_read_b128 a[24:27], v9 offset:28672
v_mfma_f32_16x16x32_bf16 v[60:63], a[36:39], a[4:7], v[60:63]
ds_read_b128 a[28:31], v9 offset:30720
v_mfma_f32_16x16x32_bf16 v[84:87], a[36:39], a[8:11], v[84:87]
ds_read_b64_tr_b16 a[60:61], v13 offset:12288
v_mfma_f32_16x16x32_bf16 v[108:111], a[36:39], a[12:15], v[108:111]
ds_read_b64_tr_b16 a[62:63], v13 offset:12800
v_mfma_f32_16x16x32_bf16 v[40:43], a[0:3], a[40:43], v[40:43]
ds_read_b64_tr_b16 a[64:65], v12 offset:14336
v_mfma_f32_16x16x32_bf16 v[64:67], a[4:7], a[40:43], v[64:67]
ds_read_b64_tr_b16 a[66:67], v12 offset:14848
v_mfma_f32_16x16x32_bf16 v[88:91], a[8:11], a[40:43], v[88:91]
ds_read_b64_tr_b16 a[68:69], v13 offset:14336
v_mfma_f32_16x16x32_bf16 v[112:115], a[12:15], a[40:43], v[112:115]
ds_read_b64_tr_b16 a[70:71], v13 offset:14848
v_mfma_f32_16x16x32_bf16 v[44:47], a[0:3], a[44:47], v[44:47]
ds_read_b64_tr_b16 a[72:73], v12 offset:16384
v_mfma_f32_16x16x32_bf16 v[68:71], a[4:7], a[44:47], v[68:71]
ds_read_b64_tr_b16 a[74:75], v12 offset:16896
v_mfma_f32_16x16x32_bf16 v[92:95], a[8:11], a[44:47], v[92:95]
ds_read_b64_tr_b16 a[76:77], v13 offset:16384
v_mfma_f32_16x16x32_bf16 v[116:119], a[12:15], a[44:47], v[116:119]
ds_read_b64_tr_b16 a[78:79], v13 offset:16896
v_mfma_f32_16x16x32_bf16 v[48:51], a[0:3], a[48:51], v[48:51]
v_mfma_f32_16x16x32_bf16 v[72:75], a[4:7], a[48:51], v[72:75]
v_mfma_f32_16x16x32_bf16 v[96:99], a[8:11], a[48:51], v[96:99]
v_mfma_f32_16x16x32_bf16 v[120:123], a[12:15], a[48:51], v[120:123]
v_mfma_f32_16x16x32_bf16 v[52:55], a[0:3], a[52:55], v[52:55]
v_mfma_f32_16x16x32_bf16 v[76:79], a[4:7], a[52:55], v[76:79]
v_mfma_f32_16x16x32_bf16 v[100:103], a[8:11], a[52:55], v[100:103]
v_mfma_f32_16x16x32_bf16 v[124:127], a[12:15], a[52:55], v[124:127]
s_waitcnt lgkmcnt(0)
s_cmp_lg_u32 s94, 0
s_cbranch_scc1 L_nocs3_1
v_mfma_f32_16x16x32_bf16 v[128:131], a[80:83], a[56:59], v[128:131]
v_mfma_f32_16x16x32_bf16 v[132:135], a[80:83], a[60:63], v[132:135]
v_mfma_f32_16x16x32_bf16 v[136:139], a[80:83], a[64:67], v[136:139]
v_mfma_f32_16x16x32_bf16 v[140:143], a[80:83], a[68:71], v[140:143]
v_mfma_f32_16x16x32_bf16 v[144:147], a[80:83], a[72:75], v[144:147]
v_mfma_f32_16x16x32_bf16 v[148:151], a[80:83], a[76:79], v[148:151]
L_nocs3_1:
v_mfma_f32_16x16x32_bf16 v[32:35], a[56:59], a[16:19], v[32:35]
s_barrier
ds_read_b128 a[0:3], v10 offset:57344
v_mfma_f32_16x16x32_bf16 v[56:59], a[56:59], a[20:23], v[56:59]
ds_read_b64_tr_b16 a[32:33], v14 offset:16384
v_mfma_f32_16x16x32_bf16 v[80:83], a[56:59], a[24:27], v[80:83]
ds_read_b64_tr_b16 a[34:35], v14 offset:16896
v_mfma_f32_16x16x32_bf16 v[104:107], a[56:59], a[28:31], v[104:107]
ds_read_b128 a[4:7], v10 offset:59392
v_mfma_f32_16x16x32_bf16 v[36:39], a[60:63], a[16:19], v[36:39]
ds_read_b128 a[8:11], v10 offset:61440
v_mfma_f32_16x16x32_bf16 v[60:63], a[60:63], a[20:23], v[60:63]
ds_read_b128 a[12:15], v10 offset:63488
v_mfma_f32_16x16x32_bf16 v[84:87], a[60:63], a[24:27], v[84:87]
ds_read_b64_tr_b16 a[36:37], v15 offset:16384
v_mfma_f32_16x16x32_bf16 v[108:111], a[60:63], a[28:31], v[108:111]
ds_read_b64_tr_b16 a[38:39], v15 offset:16896
v_mfma_f32_16x16x32_bf16 v[40:43], a[16:19], a[64:67], v[40:43]
ds_read_b64_tr_b16 a[40:41], v14 offset:18432
v_mfma_f32_16x16x32_bf16 v[64:67], a[20:23], a[64:67], v[64:67]
ds_read_b64_tr_b16 a[42:43], v14 offset:18944
v_mfma_f32_16x16x32_bf16 v[88:91], a[24:27], a[64:67], v[88:91]
ds_read_b64_tr_b16 a[44:45], v15 offset:18432
v_mfma_f32_16x16x32_bf16 v[112:115], a[28:31], a[64:67], v[112:115]
ds_read_b64_tr_b16 a[46:47], v15 offset:18944
v_mfma_f32_16x16x32_bf16 v[44:47], a[16:19], a[68:71], v[44:47]
ds_read_b64_tr_b16 a[48:49], v14 offset:20480
v_mfma_f32_16x16x32_bf16 v[68:71], a[20:23], a[68:71], v[68:71]
ds_read_b64_tr_b16 a[50:51], v14 offset:20992
v_mfma_f32_16x16x32_bf16 v[92:95], a[24:27], a[68:71], v[92:95]
ds_read_b64_tr_b16 a[52:53], v15 offset:20480
v_mfma_f32_16x16x32_bf16 v[116:119], a[28:31], a[68:71], v[116:119]
ds_read_b64_tr_b16 a[54:55], v15 offset:20992
v_mfma_f32_16x16x32_bf16 v[48:51], a[16:19], a[72:75], v[48:51]
v_mfma_f32_16x16x32_bf16 v[72:75], a[20:23], a[72:75], v[72:75]
v_mfma_f32_16x16x32_bf16 v[96:99], a[24:27], a[72:75], v[96:99]
v_mfma_f32_16x16x32_bf16 v[120:123], a[28:31], a[72:75], v[120:123]
v_mfma_f32_16x16x32_bf16 v[52:55], a[16:19], a[76:79], v[52:55]
v_mfma_f32_16x16x32_bf16 v[76:79], a[20:23], a[76:79], v[76:79]
v_mfma_f32_16x16x32_bf16 v[100:103], a[24:27], a[76:79], v[100:103]
v_mfma_f32_16x16x32_bf16 v[124:127], a[28:31], a[76:79], v[124:127]
s_waitcnt lgkmcnt(0)
v_mfma_f32_16x16x32_bf16 v[32:35], a[32:35], a[0:3], v[32:35]
ds_read_b128 a[16:19], v11 offset:57344
v_mfma_f32_16x16x32_bf16 v[56:59], a[32:35], a[4:7], v[56:59]
ds_read_b64_tr_b16 a[56:57], v14 offset:28672
v_mfma_f32_16x16x32_bf16 v[80:83], a[32:35], a[8:11], v[80:83]
ds_read_b64_tr_b16 a[58:59], v14 offset:29184
v_mfma_f32_16x16x32_bf16 v[104:107], a[32:35], a[12:15], v[104:107]
ds_read_b128 a[20:23], v11 offset:59392
v_mfma_f32_16x16x32_bf16 v[36:39], a[36:39], a[0:3], v[36:39]
ds_read_b128 a[24:27], v11 offset:61440
v_mfma_f32_16x16x32_bf16 v[60:63], a[36:39], a[4:7], v[60:63]
ds_read_b128 a[28:31], v11 offset:63488
v_mfma_f32_16x16x32_bf16 v[84:87], a[36:39], a[8:11], v[84:87]
ds_read_b64_tr_b16 a[60:61], v15 offset:28672
v_mfma_f32_16x16x32_bf16 v[108:111], a[36:39], a[12:15], v[108:111]
ds_read_b64_tr_b16 a[62:63], v15 offset:29184
v_mfma_f32_16x16x32_bf16 v[40:43], a[0:3], a[40:43], v[40:43]
ds_read_b64_tr_b16 a[64:65], v14 offset:30720
v_mfma_f32_16x16x32_bf16 v[64:67], a[4:7], a[40:43], v[64:67]
ds_read_b64_tr_b16 a[66:67], v14 offset:31232
v_mfma_f32_16x16x32_bf16 v[88:91], a[8:11], a[40:43], v[88:91]
ds_read_b64_tr_b16 a[68:69], v15 offset:30720
v_mfma_f32_16x16x32_bf16 v[112:115], a[12:15], a[40:43], v[112:115]
ds_read_b64_tr_b16 a[70:71], v15 offset:31232
v_mfma_f32_16x16x32_bf16 v[44:47], a[0:3], a[44:47], v[44:47]
ds_read_b64_tr_b16 a[72:73], v14 offset:32768
v_mfma_f32_16x16x32_bf16 v[68:71], a[4:7], a[44:47], v[68:71]
ds_read_b64_tr_b16 a[74:75], v14 offset:33280
v_mfma_f32_16x16x32_bf16 v[92:95], a[8:11], a[44:47], v[92:95]
ds_read_b64_tr_b16 a[76:77], v15 offset:32768
v_mfma_f32_16x16x32_bf16 v[116:119], a[12:15], a[44:47], v[116:119]
ds_read_b64_tr_b16 a[78:79], v15 offset:33280
v_mfma_f32_16x16x32_bf16 v[48:51], a[0:3], a[48:51], v[48:51]
s_add_u32 s70, s88, 0
buffer_store_dwordx4 v[28:31], v16, s[12:15], s70 offen sc1
v_mfma_f32_16x16x32_bf16 v[72:75], a[4:7], a[48:51], v[72:75]
v_mfma_f32_16x16x32_bf16 v[96:99], a[8:11], a[48:51], v[96:99]
s_add_u32 s70, s88, 32768
buffer_store_dwordx4 v[28:31], v16, s[12:15], s70 offen sc1
v_mfma_f32_16x16x32_bf16 v[120:123], a[12:15], a[48:51], v[120:123]
v_mfma_f32_16x16x32_bf16 v[52:55], a[0:3], a[52:55], v[52:55]
v_mfma_f32_16x16x32_bf16 v[76:79], a[4:7], a[52:55], v[76:79]
v_mfma_f32_16x16x32_bf16 v[100:103], a[8:11], a[52:55], v[100:103]
v_mfma_f32_16x16x32_bf16 v[124:127], a[12:15], a[52:55], v[124:127]
s_waitcnt lgkmcnt(0)
v_mfma_f32_16x16x32_bf16 v[32:35], a[56:59], a[16:19], v[32:35]
s_barrier
ds_read_b128 a[0:3], v10 offset:40960
v_mfma_f32_16x16x32_bf16 v[56:59], a[56:59], a[20:23], v[56:59]
ds_read_b64_tr_b16 a[32:33], v12 offset:40960
v_mfma_f32_16x16x32_bf16 v[80:83], a[56:59], a[24:27], v[80:83]
ds_read_b64_tr_b16 a[34:35], v12 offset:41472
s_branch L_over3
L_pad3:
s_branch L_ret4
L_over3:
v_mfma_f32_16x16x32_bf16 v[104:107], a[56:59], a[28:31], v[104:107]
ds_read_b128 a[4:7], v10 offset:43008
v_mfma_f32_16x16x32_bf16 v[36:39], a[60:63], a[16:19], v[36:39]
ds_read_b128 a[8:11], v10 offset:45056
v_mfma_f32_16x16x32_bf16 v[60:63], a[60:63], a[20:23], v[60:63]
ds_read_b128 a[12:15], v10 offset:47104
v_mfma_f32_16x16x32_bf16 v[84:87], a[60:63], a[24:27], v[84:87]
ds_read_b64_tr_b16 a[36:37], v13 offset:40960
v_mfma_f32_16x16x32_bf16 v[108:111], a[60:63], a[28:31], v[108:111]
ds_read_b64_tr_b16 a[38:39], v13 offset:41472
v_mfma_f32_16x16x32_bf16 v[40:43], a[16:19], a[64:67], v[40:43]
ds_read_b64_tr_b16 a[40:41], v12 offset:43008
v_mfma_f32_16x16x32_bf16 v[64:67], a[20:23], a[64:67], v[64:67]
ds_read_b64_tr_b16 a[42:43], v12 offset:43520
v_mfma_f32_16x16x32_bf16 v[88:91], a[24:27], a[64:67], v[88:91]
ds_read_b64_tr_b16 a[44:45], v13 offset:43008
v_mfma_f32_16x16x32_bf16 v[112:115], a[28:31], a[64:67], v[112:115]
ds_read_b64_tr_b16 a[46:47], v13 offset:43520
v_mfma_f32_16x16x32_bf16 v[44:47], a[16:19], a[68:71], v[44:47]
ds_read_b64_tr_b16 a[48:49], v12 offset:45056
v_mfma_f32_16x16x32_bf16 v[68:71], a[20:23], a[68:71], v[68:71]
ds_read_b64_tr_b16 a[50:51], v12 offset:45568
v_mfma_f32_16x16x32_bf16 v[92:95], a[24:27], a[68:71], v[92:95]
ds_read_b64_tr_b16 a[52:53], v13 offset:45056
v_mfma_f32_16x16x32_bf16 v[116:119], a[28:31], a[68:71], v[116:119]
ds_read_b64_tr_b16 a[54:55], v13 offset:45568
v_mfma_f32_16x16x32_bf16 v[48:51], a[16:19], a[72:75], v[48:51]
v_mfma_f32_16x16x32_bf16 v[72:75], a[20:23], a[72:75], v[72:75]
v_mfma_f32_16x16x32_bf16 v[96:99], a[24:27], a[72:75], v[96:99]
v_mfma_f32_16x16x32_bf16 v[120:123], a[28:31], a[72:75], v[120:123]
v_mfma_f32_16x16x32_bf16 v[52:55], a[16:19], a[76:79], v[52:55]
v_mfma_f32_16x16x32_bf16 v[76:79], a[20:23], a[76:79], v[76:79]
v_mfma_f32_16x16x32_bf16 v[100:103], a[24:27], a[76:79], v[100:103]
v_mfma_f32_16x16x32_bf16 v[124:127], a[28:31], a[76:79], v[124:127]
s_waitcnt lgkmcnt(0)
v_mfma_f32_16x16x32_bf16 v[32:35], a[32:35], a[0:3], v[32:35]
ds_read_b128 a[16:19], v11 offset:40960
v_mfma_f32_16x16x32_bf16 v[56:59], a[32:35], a[4:7], v[56:59]
ds_read_b64_tr_b16 a[56:57], v12 offset:53248
v_mfma_f32_16x16x32_bf16 v[80:83], a[32:35], a[8:11], v[80:83]
ds_read_b64_tr_b16 a[58:59], v12 offset:53760
v_mfma_f32_16x16x32_bf16 v[104:107], a[32:35], a[12:15], v[104:107]
ds_read_b128 a[20:23], v11 offset:43008
v_mfma_f32_16x16x32_bf16 v[36:39], a[36:39], a[0:3], v[36:39]
ds_read_b128 a[24:27], v11 offset:45056
v_mfma_f32_16x16x32_bf16 v[60:63], a[36:39], a[4:7], v[60:63]
ds_read_b128 a[28:31], v11 offset:47104
v_mfma_f32_16x16x32_bf16 v[84:87], a[36:39], a[8:11], v[84:87]
ds_read_b64_tr_b16 a[60:61], v13 offset:53248
v_mfma_f32_16x16x32_bf16 v[108:111], a[36:39], a[12:15], v[108:111]
ds_read_b64_tr_b16 a[62:63], v13 offset:53760
v_mfma_f32_16x16x32_bf16 v[40:43], a[0:3], a[40:43], v[40:43]
ds_read_b64_tr_b16 a[64:65], v12 offset:55296
v_mfma_f32_16x16x32_bf16 v[64:67], a[4:7], a[40:43], v[64:67]
ds_read_b64_tr_b16 a[66:67], v12 offset:55808
v_mfma_f32_16x16x32_bf16 v[88:91], a[8:11], a[40:43], v[88:91]
ds_read_b64_tr_b16 a[68:69], v13 offset:55296
v_mfma_f32_16x16x32_bf16 v[112:115], a[12:15], a[40:43], v[112:115]
ds_read_b64_tr_b16 a[70:71], v13 offset:55808
v_mfma_f32_16x16x32_bf16 v[44:47], a[0:3], a[44:47], v[44:47]
ds_read_b64_tr_b16 a[72:73], v12 offset:57344
v_mfma_f32_16x16x32_bf16 v[68:71], a[4:7], a[44:47], v[68:71]
ds_read_b64_tr_b16 a[74:75], v12 offset:57856
v_mfma_f32_16x16x32_bf16 v[92:95], a[8:11], a[44:47], v[92:95]
ds_read_b64_tr_b16 a[76:77], v13 offset:57344
v_mfma_f32_16x16x32_bf16 v[116:119], a[12:15], a[44:47], v[116:119]
ds_read_b64_tr_b16 a[78:79], v13 offset:57856
v_mfma_f32_16x16x32_bf16 v[48:51], a[0:3], a[48:51], v[48:51]
s_cmp_lg_u32 s94, 0
s_cbranch_scc1 L_nocsp
v_and_b32 v2, 16, v1
v_cmp_ne_u32 vcc, 0, v2
s_nop 1
v_cndmask_b32 v24, v128, v132, vcc
v_cndmask_b32 v25, v136, v140, vcc
v_cndmask_b32 v26, v144, v148, vcc
v_mov_b32 v27, s68
s_lshl_b32 s70, s64, 4
s_lshr_b32 s71, s65, 2
s_add_u32 s70, s70, s71
s_lshl_b32 s70, s70, 10
s_lshl_b32 s71, s67, 9
s_add_u32 s70, s70, s71
s_add_u32 s70, s70, 65536
s_mov_b64 exec, 0xffffffff
buffer_store_dwordx4 v[24:27], v16, s[12:15], s70 offen sc1
s_mov_b64 exec, -1
L_nocsp:
v_mfma_f32_16x16x32_bf16 v[72:75], a[4:7], a[48:51], v[72:75]
v_mfma_f32_16x16x32_bf16 v[96:99], a[8:11], a[48:51], v[96:99]
s_add_u32 s70, s88, 65536
buffer_store_dwordx4 v[28:31], v16, s[12:15], s70 offen sc1
v_mfma_f32_16x16x32_bf16 v[120:123], a[12:15], a[48:51], v[120:123]
v_mfma_f32_16x16x32_bf16 v[52:55], a[0:3], a[52:55], v[52:55]
s_add_u32 s70, s88, 98304
buffer_store_dwordx4 v[28:31], v16, s[12:15], s70 offen sc1
v_mfma_f32_16x16x32_bf16 v[76:79], a[4:7], a[52:55], v[76:79]
v_mfma_f32_16x16x32_bf16 v[100:103], a[8:11], a[52:55], v[100:103]
v_mfma_f32_16x16x32_bf16 v[124:127], a[12:15], a[52:55], v[124:127]
s_waitcnt lgkmcnt(0)
v_mfma_f32_16x16x32_bf16 v[32:35], a[56:59], a[16:19], v[32:35]
s_barrier
ds_read_b128 a[0:3], v10 offset:0
v_mfma_f32_16x16x32_bf16 v[56:59], a[56:59], a[20:23], v[56:59]
ds_read_b64_tr_b16 a[32:33], v12 offset:0
v_mfma_f32_16x16x32_bf16 v[80:83], a[56:59], a[24:27], v[80:83]
ds_read_b64_tr_b16 a[34:35], v12 offset:512
v_mfma_f32_16x16x32_bf16 v[104:107], a[56:59], a[28:31], v[104:107]
ds_read_b128 a[4:7], v10 offset:2048
v_mfma_f32_16x16x32_bf16 v[36:39], a[60:63], a[16:19], v[36:39]
ds_read_b128 a[8:11], v10 offset:4096
v_mfma_f32_16x16x32_bf16 v[60:63], a[60:63], a[20:23], v[60:63]
ds_read_b128 a[12:15], v10 offset:6144
v_mfma_f32_16x16x32_bf16 v[84:87], a[60:63], a[24:27], v[84:87]
ds_read_b64_tr_b16 a[36:37], v13 offset:0
v_mfma_f32_16x16x32_bf16 v[108:111], a[60:63], a[28:31], v[108:111]
ds_read_b64_tr_b16 a[38:39], v13 offset:512
v_mfma_f32_16x16x32_bf16 v[40:43], a[16:19], a[64:67], v[40:43]
ds_read_b64_tr_b16 a[40:41], v12 offset:2048
v_mfma_f32_16x16x32_bf16 v[64:67], a[20:23], a[64:67], v[64:67]
ds_read_b64_tr_b16 a[42:43], v12 offset:2560
v_mfma_f32_16x16x32_bf16 v[88:91], a[24:27], a[64:67], v[88:91]
ds_read_b64_tr_b16 a[44:45], v13 offset:2048
v_mfma_f32_16x16x32_bf16 v[112:115], a[28:31], a[64:67], v[112:115]
ds_read_b64_tr_b16 a[46:47], v13 offset:2560
v_mfma_f32_16x16x32_bf16 v[44:47], a[16:19], a[68:71], v[44:47]
ds_read_b64_tr_b16 a[48:49], v12 offset:4096
v_mfma_f32_16x16x32_bf16 v[68:71], a[20:23], a[68:71], v[68:71]
ds_read_b64_tr_b16 a[50:51], v12 offset:4608
v_mfma_f32_16x16x32_bf16 v[92:95], a[24:27], a[68:71], v[92:95]
ds_read_b64_tr_b16 a[52:53], v13 offset:4096
v_mfma_f32_16x16x32_bf16 v[116:119], a[28:31], a[68:71], v[116:119]
ds_read_b64_tr_b16 a[54:55], v13 offset:4608
v_mfma_f32_16x16x32_bf16 v[48:51], a[16:19], a[72:75], v[48:51]
v_mfma_f32_16x16x32_bf16 v[72:75], a[20:23], a[72:75], v[72:75]
v_mfma_f32_16x16x32_bf16 v[96:99], a[24:27], a[72:75], v[96:99]
v_mfma_f32_16x16x32_bf16 v[120:123], a[28:31], a[72:75], v[120:123]
v_mfma_f32_16x16x32_bf16 v[52:55], a[16:19], a[76:79], v[52:55]
v_mfma_f32_16x16x32_bf16 v[76:79], a[20:23], a[76:79], v[76:79]
v_mfma_f32_16x16x32_bf16 v[100:103], a[24:27], a[76:79], v[100:103]
v_mfma_f32_16x16x32_bf16 v[124:127], a[28:31], a[76:79], v[124:127]
s_waitcnt lgkmcnt(0)
v_mfma_f32_16x16x32_bf16 v[32:35], a[32:35], a[0:3], v[32:35]
ds_read_b128 a[16:19], v11 offset:0
v_mfma_f32_16x16x32_bf16 v[56:59], a[32:35], a[4:7], v[56:59]
ds_read_b64_tr_b16 a[56:57], v12 offset:12288
v_mfma_f32_16x16x32_bf16 v[80:83], a[32:35], a[8:11], v[80:83]
ds_read_b64_tr_b16 a[58:59], v12 offset:12800
v_mfma_f32_16x16x32_bf16 v[104:107], a[32:35], a[12:15], v[104:107]
ds_read_b128 a[20:23], v11 offset:2048
v_mfma_f32_16x16x32_bf16 v[36:39], a[36:39], a[0:3], v[36:39]
ds_read_b128 a[24:27], v11 offset:4096
v_mfma_f32_16x16x32_bf16 v[60:63], a[36:39], a[4:7], v[60:63]
ds_read_b128 a[28:31], v11 offset:6144
v_mfma_f32_16x16x32_bf16 v[84:87], a[36:39], a[8:11], v[84:87]
ds_read_b64_tr_b16 a[60:61], v13 offset:12288
v_mfma_f32_16x16x32_bf16 v[108:111], a[36:39], a[12:15], v[108:111]
ds_read_b64_tr_b16 a[62:63], v13 offset:12800
v_mfma_f32_16x16x32_bf16 v[40:43], a[0:3], a[40:43], v[40:43]
ds_read_b64_tr_b16 a[64:65], v12 offset:14336
v_mfma_f32_16x16x32_bf16 v[64:67], a[4:7], a[40:43], v[64:67]
ds_read_b64_tr_b16 a[66:67], v12 offset:14848
v_mfma_f32_16x16x32_bf16 v[88:91], a[8:11], a[40:43], v[88:91]
ds_read_b64_tr_b16 a[68:69], v13 offset:14336
v_mfma_f32_16x16x32_bf16 v[112:115], a[12:15], a[40:43], v[112:115]
ds_read_b64_tr_b16 a[70:71], v13 offset:14848
v_mfma_f32_16x16x32_bf16 v[44:47], a[0:3], a[44:47], v[44:47]
ds_read_b64_tr_b16 a[72:73], v12 offset:16384
v_mfma_f32_16x16x32_bf16 v[68:71], a[4:7], a[44:47], v[68:71]
ds_read_b64_tr_b16 a[74:75], v12 offset:16896
v_mfma_f32_16x16x32_bf16 v[92:95], a[8:11], a[44:47], v[92:95]
ds_read_b64_tr_b16 a[76:77], v13 offset:16384
v_mfma_f32_16x16x32_bf16 v[116:119], a[12:15], a[44:47], v[116:119]
ds_read_b64_tr_b16 a[78:79], v13 offset:16896
v_mfma_f32_16x16x32_bf16 v[48:51], a[0:3], a[48:51], v[48:51]
v_mfma_f32_16x16x32_bf16 v[72:75], a[4:7], a[48:51], v[72:75]
v_mfma_f32_16x16x32_bf16 v[96:99], a[8:11], a[48:51], v[96:99]
v_mfma_f32_16x16x32_bf16 v[120:123], a[12:15], a[48:51], v[120:123]
v_mfma_f32_16x16x32_bf16 v[52:55], a[0:3], a[52:55], v[52:55]
v_mfma_f32_16x16x32_bf16 v[76:79], a[4:7], a[52:55], v[76:79]
v_mfma_f32_16x16x32_bf16 v[100:103], a[8:11], a[52:55], v[100:103]
v_mfma_f32_16x16x32_bf16 v[124:127], a[12:15], a[52:55], v[124:127]
s_waitcnt lgkmcnt(0)
v_mfma_f32_16x16x32_bf16 v[32:35], a[56:59], a[16:19], v[32:35]
s_barrier
ds_read_b128 a[0:3], v8 offset:24576
v_mfma_f32_16x16x32_bf16 v[56:59], a[56:59], a[20:23], v[56:59]
ds_read_b64_tr_b16 a[32:33], v14 offset:16384
v_mfma_f32_16x16x32_bf16 v[80:83], a[56:59], a[24:27], v[80:83]
ds_read_b64_tr_b16 a[34:35], v14 offset:16896
v_mfma_f32_16x16x32_bf16 v[104:107], a[56:59], a[28:31], v[104:107]
ds_read_b128 a[4:7], v8 offset:26624
v_mfma_f32_16x16x32_bf16 v[36:39], a[60:63], a[16:19], v[36:39]
ds_read_b128 a[8:11], v8 offset:28672
v_mfma_f32_16x16x32_bf16 v[60:63], a[60:63], a[20:23], v[60:63]
ds_read_b128 a[12:15], v8 offset:30720
v_mfma_f32_16x16x32_bf16 v[84:87], a[60:63], a[24:27], v[84:87]
ds_read_b64_tr_b16 a[36:37], v15 offset:16384
v_mfma_f32_16x16x32_bf16 v[108:111], a[60:63], a[28:31], v[108:111]
ds_read_b64_tr_b16 a[38:39], v15 offset:16896
v_mfma_f32_16x16x32_bf16 v[40:43], a[16:19], a[64:67], v[40:43]
ds_read_b64_tr_b16 a[40:41], v14 offset:18432
v_mfma_f32_16x16x32_bf16 v[64:67], a[20:23], a[64:67], v[64:67]
ds_read_b64_tr_b16 a[42:43], v14 offset:18944
v_mfma_f32_16x16x32_bf16 v[88:91], a[24:27], a[64:67], v[88:91]
ds_read_b64_tr_b16 a[44:45], v15 offset:18432
v_mfma_f32_16x16x32_bf16 v[112:115], a[28:31], a[64:67], v[112:115]
ds_read_b64_tr_b16 a[46:47], v15 offset:18944
v_mfma_f32_16x16x32_bf16 v[44:47], a[16:19], a[68:71], v[44:47]
ds_read_b64_tr_b16 a[48:49], v14 offset:20480
v_mfma_f32_16x16x32_bf16 v[68:71], a[20:23], a[68:71], v[68:71]
ds_read_b64_tr_b16 a[50:51], v14 offset:20992
v_mfma_f32_16x16x32_bf16 v[92:95], a[24:27], a[68:71], v[92:95]
ds_read_b64_tr_b16 a[52:53], v15 offset:20480
v_mfma_f32_16x16x32_bf16 v[116:119], a[28:31], a[68:71], v[116:119]
ds_read_b64_tr_b16 a[54:55], v15 offset:20992
v_mfma_f32_16x16x32_bf16 v[48:51], a[16:19], a[72:75], v[48:51]
v_mfma_f32_16x16x32_bf16 v[72:75], a[20:23], a[72:75], v[72:75]
v_mfma_f32_16x16x32_bf16 v[96:99], a[24:27], a[72:75], v[96:99]
v_mfma_f32_16x16x32_bf16 v[120:123], a[28:31], a[72:75], v[120:123]
v_mfma_f32_16x16x32_bf16 v[52:55], a[16:19], a[76:79], v[52:55]
v_mfma_f32_16x16x32_bf16 v[76:79], a[20:23], a[76:79], v[76:79]
v_mfma_f32_16x16x32_bf16 v[100:103], a[24:27], a[76:79], v[100:103]
v_mfma_f32_16x16x32_bf16 v[124:127], a[28:31], a[76:79], v[124:127]
s_waitcnt lgkmcnt(0)
v_mfma_f32_16x16x32_bf16 v[32:35], a[32:35], a[0:3], v[32:35]
ds_read_b128 a[16:19], v9 offset:24576
v_mfma_f32_16x16x32_bf16 v[56:59], a[32:35], a[4:7], v[56:59]
ds_read_b64_tr_b16 a[56:57], v14 offset:28672
v_mfma_f32_16x16x32_bf16 v[80:83], a[32:35], a[8:11], v[80:83]
ds_read_b64_tr_b16 a[58:59], v14 offset:29184
v_mfma_f32_16x16x32_bf16 v[104:107], a[32:35], a[12:15], v[104:107]
ds_read_b128 a[20:23], v9 offset:26624
v_mfma_f32_16x16x32_bf16 v[36:39], a[36:39], a[0:3], v[36:39]
ds_read_b128 a[24:27], v9 offset:28672
v_mfma_f32_16x16x32_bf16 v[60:63], a[36:39], a[4:7], v[60:63]
ds_read_b128 a[28:31], v9 offset:30720
v_mfma_f32_16x16x32_bf16 v[84:87], a[36:39], a[8:11], v[84:87]
ds_read_b64_tr_b16 a[60:61], v15 offset:28672
v_mfma_f32_16x16x32_bf16 v[108:111], a[36:39], a[12:15], v[108:111]
ds_read_b64_tr_b16 a[62:63], v15 offset:29184
v_mfma_f32_16x16x32_bf16 v[40:43], a[0:3], a[40:43], v[40:43]
ds_read_b64_tr_b16 a[64:65], v14 offset:30720
v_mfma_f32_16x16x32_bf16 v[64:67], a[4:7], a[40:43], v[64:67]
ds_read_b64_tr_b16 a[66:67], v14 offset:31232
v_mfma_f32_16x16x32_bf16 v[88:91], a[8:11], a[40:43], v[88:91]
ds_read_b64_tr_b16 a[68:69], v15 offset:30720
v_mfma_f32_16x16x32_bf16 v[112:115], a[12:15], a[40:43], v[112:115]
ds_read_b64_tr_b16 a[70:71], v15 offset:31232
v_mfma_f32_16x16x32_bf16 v[44:47], a[0:3], a[44:47], v[44:47]
ds_read_b64_tr_b16 a[72:73], v14 offset:32768
v_mfma_f32_16x16x32_bf16 v[68:71], a[4:7], a[44:47], v[68:71]
ds_read_b64_tr_b16 a[74:75], v14 offset:33280
v_mfma_f32_16x16x32_bf16 v[92:95], a[8:11], a[44:47], v[92:95]
ds_read_b64_tr_b16 a[76:77], v15 offset:32768
v_mfma_f32_16x16x32_bf16 v[116:119], a[12:15], a[44:47], v[116:119]
ds_read_b64_tr_b16 a[78:79], v15 offset:33280
v_mfma_f32_16x16x32_bf16 v[48:51], a[0:3], a[48:51], v[48:51]
s_waitcnt vmcnt(0)
v_mfma_f32_16x16x32_bf16 v[72:75], a[4:7], a[48:51], v[72:75]
v_mfma_f32_16x16x32_bf16 v[96:99], a[8:11], a[48:51], v[96:99]
v_mfma_f32_16x16x32_bf16 v[120:123], a[12:15], a[48:51], v[120:123]
v_mfma_f32_16x16x32_bf16 v[52:55], a[0:3], a[52:55], v[52:55]
v_mfma_f32_16x16x32_bf16 v[76:79], a[4:7], a[52:55], v[76:79]
v_mfma_f32_16x16x32_bf16 v[100:103], a[8:11], a[52:55], v[100:103]
v_mfma_f32_16x16x32_bf16 v[124:127], a[12:15], a[52:55], v[124:127]
s_waitcnt lgkmcnt(0)
v_mfma_f32_16x16x32_bf16 v[32:35], a[56:59], a[16:19], v[32:35]
s_barrier
ds_read_b128 a[0:3], v10 offset:57344
v_mfma_f32_16x16x32_bf16 v[56:59], a[56:59], a[20:23], v[56:59]
ds_read_b64_tr_b16 a[32:33], v12 offset:40960
v_mfma_f32_16x16x32_bf16 v[80:83], a[56:59], a[24:27], v[80:83]
ds_read_b64_tr_b16 a[34:35], v12 offset:41472
v_mfma_f32_16x16x32_bf16 v[104:107], a[56:59], a[28:31], v[104:107]
ds_read_b128 a[4:7], v10 offset:59392
v_mfma_f32_16x16x32_bf16 v[36:39], a[60:63], a[16:19], v[36:39]
ds_read_b128 a[8:11], v10 offset:61440
v_mfma_f32_16x16x32_bf16 v[60:63], a[60:63], a[20:23], v[60:63]
ds_read_b128 a[12:15], v10 offset:63488
v_mfma_f32_16x16x32_bf16 v[84:87], a[60:63], a[24:27], v[84:87]
ds_read_b64_tr_b16 a[36:37], v13 offset:40960
v_mfma_f32_16x16x32_bf16 v[108:111], a[60:63], a[28:31], v[108:111]
ds_read_b64_tr_b16 a[38:39], v13 offset:41472
v_mfma_f32_16x16x32_bf16 v[40:43], a[16:19], a[64:67], v[40:43]
ds_read_b64_tr_b16 a[40:41], v12 offset:43008
v_mfma_f32_16x16x32_bf16 v[64:67], a[20:23], a[64:67], v[64:67]
ds_read_b64_tr_b16 a[42:43], v12 offset:43520
v_mfma_f32_16x16x32_bf16 v[88:91], a[24:27], a[64:67], v[88:91]
ds_read_b64_tr_b16 a[44:45], v13 offset:43008
v_mfma_f32_16x16x32_bf16 v[112:115], a[28:31], a[64:67], v[112:115]
ds_read_b64_tr_b16 a[46:47], v13 offset:43520
v_mfma_f32_16x16x32_bf16 v[44:47], a[16:19], a[68:71], v[44:47]
ds_read_b64_tr_b16 a[48:49], v12 offset:45056
v_mfma_f32_16x16x32_bf16 v[68:71], a[20:23], a[68:71], v[68:71]
ds_read_b64_tr_b16 a[50:51], v12 offset:45568
v_mfma_f32_16x16x32_bf16 v[92:95], a[24:27], a[68:71], v[92:95]
ds_read_b64_tr_b16 a[52:53], v13 offset:45056
v_mfma_f32_16x16x32_bf16 v[116:119], a[28:31], a[68:71], v[116:119]
ds_read_b64_tr_b16 a[54:55], v13 offset:45568
v_mfma_f32_16x16x32_bf16 v[48:51], a[16:19], a[72:75], v[48:51]
v_mfma_f32_16x16x32_bf16 v[72:75], a[20:23], a[72:75], v[72:75]
v_mfma_f32_16x16x32_bf16 v[96:99], a[24:27], a[72:75], v[96:99]
v_mfma_f32_16x16x32_bf16 v[120:123], a[28:31], a[72:75], v[120:123]
v_mfma_f32_16x16x32_bf16 v[52:55], a[16:19], a[76:79], v[52:55]
v_mfma_f32_16x16x32_bf16 v[76:79], a[20:23], a[76:79], v[76:79]
v_mfma_f32_16x16x32_bf16 v[100:103], a[24:27], a[76:79], v[100:103]
v_mfma_f32_16x16x32_bf16 v[124:127], a[28:31], a[76:79], v[124:127]
s_waitcnt lgkmcnt(0)
v_mfma_f32_16x16x32_bf16 v[32:35], a[32:35], a[0:3], v[32:35]
ds_read_b128 a[16:19], v11 offset:57344
v_mfma_f32_16x16x32_bf16 v[56:59], a[32:35], a[4:7], v[56:59]
ds_read_b64_tr_b16 a[56:57], v12 offset:53248
v_mfma_f32_16x16x32_bf16 v[80:83], a[32:35], a[8:11], v[80:83]
ds_read_b64_tr_b16 a[58:59], v12 offset:53760
v_mfma_f32_16x16x32_bf16 v[104:107], a[32:35], a[12:15], v[104:107]
ds_read_b128 a[20:23], v11 offset:59392
v_mfma_f32_16x16x32_bf16 v[36:39], a[36:39], a[0:3], v[36:39]
ds_read_b128 a[24:27], v11 offset:61440
v_mfma_f32_16x16x32_bf16 v[60:63], a[36:39], a[4:7], v[60:63]
ds_read_b128 a[28:31], v11 offset:63488
v_mfma_f32_16x16x32_bf16 v[84:87], a[36:39], a[8:11], v[84:87]
ds_read_b64_tr_b16 a[60:61], v13 offset:53248
v_mfma_f32_16x16x32_bf16 v[108:111], a[36:39], a[12:15], v[108:111]
ds_read_b64_tr_b16 a[62:63], v13 offset:53760
v_mfma_f32_16x16x32_bf16 v[40:43], a[0:3], a[40:43], v[40:43]
ds_read_b64_tr_b16 a[64:65], v12 offset:55296
v_mfma_f32_16x16x32_bf16 v[64:67], a[4:7], a[40:43], v[64:67]
ds_read_b64_tr_b16 a[66:67], v12 offset:55808
v_mfma_f32_16x16x32_bf16 v[88:91], a[8:11], a[40:43], v[88:91]
ds_read_b64_tr_b16 a[68:69], v13 offset:55296
v_mfma_f32_16x16x32_bf16 v[112:115], a[12:15], a[40:43], v[112:115]
ds_read_b64_tr_b16 a[70:71], v13 offset:55808
v_mfma_f32_16x16x32_bf16 v[44:47], a[0:3], a[44:47], v[44:47]
ds_read_b64_tr_b16 a[72:73], v12 offset:57344
v_mfma_f32_16x16x32_bf16 v[68:71], a[4:7], a[44:47], v[68:71]
ds_read_b64_tr_b16 a[74:75], v12 offset:57856
v_mfma_f32_16x16x32_bf16 v[92:95], a[8:11], a[44:47], v[92:95]
ds_read_b64_tr_b16 a[76:77], v13 offset:57344
v_mfma_f32_16x16x32_bf16 v[116:119], a[12:15], a[44:47], v[116:119]
ds_read_b64_tr_b16 a[78:79], v13 offset:57856
v_mfma_f32_16x16x32_bf16 v[48:51], a[0:3], a[48:51], v[48:51]
v_mfma_f32_16x16x32_bf16 v[72:75], a[4:7], a[48:51], v[72:75]
v_mfma_f32_16x16x32_bf16 v[96:99], a[8:11], a[48:51], v[96:99]
v_mfma_f32_16x16x32_bf16 v[120:123], a[12:15], a[48:51], v[120:123]
v_mfma_f32_16x16x32_bf16 v[52:55], a[0:3], a[52:55], v[52:55]
v_mfma_f32_16x16x32_bf16 v[76:79], a[4:7], a[52:55], v[76:79]
v_mfma_f32_16x16x32_bf16 v[100:103], a[8:11], a[52:55], v[100:103]
v_mfma_f32_16x16x32_bf16 v[124:127], a[12:15], a[52:55], v[124:127]
s_waitcnt lgkmcnt(0)
v_mfma_f32_16x16x32_bf16 v[32:35], a[56:59], a[16:19], v[32:35]
s_barrier
ds_read_b128 a[0:3], v10 offset:40960
v_mfma_f32_16x16x32_bf16 v[56:59], a[56:59], a[20:23], v[56:59]
ds_read_b64_tr_b16 a[32:33], v12 offset:0
v_mfma_f32_16x16x32_bf16 v[80:83], a[56:59], a[24:27], v[80:83]
ds_read_b64_tr_b16 a[34:35], v12 offset:512
v_mfma_f32_16x16x32_bf16 v[104:107], a[56:59], a[28:31], v[104:107]
ds_read_b128 a[4:7], v10 offset:43008
v_mfma_f32_16x16x32_bf16 v[36:39], a[60:63], a[16:19], v[36:39]
ds_read_b128 a[8:11], v10 offset:45056
v_mfma_f32_16x16x32_bf16 v[60:63], a[60:63], a[20:23], v[60:63]
ds_read_b128 a[12:15], v10 offset:47104
v_mfma_f32_16x16x32_bf16 v[84:87], a[60:63], a[24:27], v[84:87]
ds_read_b64_tr_b16 a[36:37], v13 offset:0
v_mfma_f32_16x16x32_bf16 v[108:111], a[60:63], a[28:31], v[108:111]
ds_read_b64_tr_b16 a[38:39], v13 offset:512
v_mfma_f32_16x16x32_bf16 v[40:43], a[16:19], a[64:67], v[40:43]
ds_read_b64_tr_b16 a[40:41], v12 offset:2048
v_mfma_f32_16x16x32_bf16 v[64:67], a[20:23], a[64:67], v[64:67]
ds_read_b64_tr_b16 a[42:43], v12 offset:2560
v_mfma_f32_16x16x32_bf16 v[88:91], a[24:27], a[64:67], v[88:91]
ds_read_b64_tr_b16 a[44:45], v13 offset:2048
v_mfma_f32_16x16x32_bf16 v[112:115], a[28:31], a[64:67], v[112:115]
ds_read_b64_tr_b16 a[46:47], v13 offset:2560
v_mfma_f32_16x16x32_bf16 v[44:47], a[16:19], a[68:71], v[44:47]
ds_read_b64_tr_b16 a[48:49], v12 offset:4096
v_mfma_f32_16x16x32_bf16 v[68:71], a[20:23], a[68:71], v[68:71]
ds_read_b64_tr_b16 a[50:51], v12 offset:4608
v_mfma_f32_16x16x32_bf16 v[92:95], a[24:27], a[68:71], v[92:95]
ds_read_b64_tr_b16 a[52:53], v13 offset:4096
v_mfma_f32_16x16x32_bf16 v[116:119], a[28:31], a[68:71], v[116:119]
ds_read_b64_tr_b16 a[54:55], v13 offset:4608
v_mfma_f32_16x16x32_bf16 v[48:51], a[16:19], a[72:75], v[48:51]
v_mfma_f32_16x16x32_bf16 v[72:75], a[20:23], a[72:75], v[72:75]
v_mfma_f32_16x16x32_bf16 v[96:99], a[24:27], a[72:75], v[96:99]
v_mfma_f32_16x16x32_bf16 v[120:123], a[28:31], a[72:75], v[120:123]
v_mfma_f32_16x16x32_bf16 v[52:55], a[16:19], a[76:79], v[52:55]
v_mfma_f32_16x16x32_bf16 v[76:79], a[20:23], a[76:79], v[76:79]
v_mfma_f32_16x16x32_bf16 v[100:103], a[24:27], a[76:79], v[100:103]
v_mfma_f32_16x16x32_bf16 v[124:127], a[28:31], a[76:79], v[124:127]
s_waitcnt lgkmcnt(0)
v_mfma_f32_16x16x32_bf16 v[32:35], a[32:35], a[0:3], v[32:35]
ds_read_b128 a[16:19], v11 offset:40960
v_mfma_f32_16x16x32_bf16 v[56:59], a[32:35], a[4:7], v[56:59]
ds_read_b64_tr_b16 a[56:57], v12 offset:12288
v_mfma_f32_16x16x32_bf16 v[80:83], a[32:35], a[8:11], v[80:83]
ds_read_b64_tr_b16 a[58:59], v12 offset:12800
v_mfma_f32_16x16x32_bf16 v[104:107], a[32:35], a[12:15], v[104:107]
ds_read_b128 a[20:23], v11 offset:43008
v_mfma_f32_16x16x32_bf16 v[36:39], a[36:39], a[0:3], v[36:39]
ds_read_b128 a[24:27], v11 offset:45056
v_mfma_f32_16x16x32_bf16 v[60:63], a[36:39], a[4:7], v[60:63]
ds_read_b128 a[28:31], v11 offset:47104
v_mfma_f32_16x16x32_bf16 v[84:87], a[36:39], a[8:11], v[84:87]
ds_read_b64_tr_b16 a[60:61], v13 offset:12288
v_mfma_f32_16x16x32_bf16 v[108:111], a[36:39], a[12:15], v[108:111]
ds_read_b64_tr_b16 a[62:63], v13 offset:12800
v_mfma_f32_16x16x32_bf16 v[40:43], a[0:3], a[40:43], v[40:43]
ds_read_b64_tr_b16 a[64:65], v12 offset:14336
v_mfma_f32_16x16x32_bf16 v[64:67], a[4:7], a[40:43], v[64:67]
ds_read_b64_tr_b16 a[66:67], v12 offset:14848
v_mfma_f32_16x16x32_bf16 v[88:91], a[8:11], a[40:43], v[88:91]
ds_read_b64_tr_b16 a[68:69], v13 offset:14336
v_mfma_f32_16x16x32_bf16 v[112:115], a[12:15], a[40:43], v[112:115]
ds_read_b64_tr_b16 a[70:71], v13 offset:14848
v_mfma_f32_16x16x32_bf16 v[44:47], a[0:3], a[44:47], v[44:47]
ds_read_b64_tr_b16 a[72:73], v12 offset:16384
v_mfma_f32_16x16x32_bf16 v[68:71], a[4:7], a[44:47], v[68:71]
ds_read_b64_tr_b16 a[74:75], v12 offset:16896
v_mfma_f32_16x16x32_bf16 v[92:95], a[8:11], a[44:47], v[92:95]
ds_read_b64_tr_b16 a[76:77], v13 offset:16384
v_mfma_f32_16x16x32_bf16 v[116:119], a[12:15], a[44:47], v[116:119]
ds_read_b64_tr_b16 a[78:79], v13 offset:16896
v_mfma_f32_16x16x32_bf16 v[48:51], a[0:3], a[48:51], v[48:51]
v_mfma_f32_16x16x32_bf16 v[72:75], a[4:7], a[48:51], v[72:75]
v_mfma_f32_16x16x32_bf16 v[96:99], a[8:11], a[48:51], v[96:99]
v_mfma_f32_16x16x32_bf16 v[120:123], a[12:15], a[48:51], v[120:123]
v_mfma_f32_16x16x32_bf16 v[52:55], a[0:3], a[52:55], v[52:55]
v_mfma_f32_16x16x32_bf16 v[76:79], a[4:7], a[52:55], v[76:79]
v_mfma_f32_16x16x32_bf16 v[100:103], a[8:11], a[52:55], v[100:103]
v_mfma_f32_16x16x32_bf16 v[124:127], a[12:15], a[52:55], v[124:127]
s_waitcnt lgkmcnt(0)
v_mfma_f32_16x16x32_bf16 v[32:35], a[56:59], a[16:19], v[32:35]
s_barrier
ds_read_b128 a[0:3], v10 offset:0
v_mfma_f32_16x16x32_bf16 v[56:59], a[56:59], a[20:23], v[56:59]
ds_read_b64_tr_b16 a[32:33], v14 offset:16384
v_mfma_f32_16x16x32_bf16 v[80:83], a[56:59], a[24:27], v[80:83]
ds_read_b64_tr_b16 a[34:35], v14 offset:16896
v_mfma_f32_16x16x32_bf16 v[104:107], a[56:59], a[28:31], v[104:107]
ds_read_b128 a[4:7], v10 offset:2048
v_mfma_f32_16x16x32_bf16 v[36:39], a[60:63], a[16:19], v[36:39]
ds_read_b128 a[8:11], v10 offset:4096
v_mfma_f32_16x16x32_bf16 v[60:63], a[60:63], a[20:23], v[60:63]
ds_read_b128 a[12:15], v10 offset:6144
v_mfma_f32_16x16x32_bf16 v[84:87], a[60:63], a[24:27], v[84:87]
ds_read_b64_tr_b16 a[36:37], v15 offset:16384
v_mfma_f32_16x16x32_bf16 v[108:111], a[60:63], a[28:31], v[108:111]
ds_read_b64_tr_b16 a[38:39], v15 offset:16896
v_mfma_f32_16x16x32_bf16 v[40:43], a[16:19], a[64:67], v[40:43]
ds_read_b64_tr_b16 a[40:41], v14 offset:18432
v_mfma_f32_16x16x32_bf16 v[64:67], a[20:23], a[64:67], v[64:67]
ds_read_b64_tr_b16 a[42:43], v14 offset:18944
v_mfma_f32_16x16x32_bf16 v[88:91], a[24:27], a[64:67], v[88:91]
ds_read_b64_tr_b16 a[44:45], v15 offset:18432
v_mfma_f32_16x16x32_bf16 v[112:115], a[28:31], a[64:67], v[112:115]
ds_read_b64_tr_b16 a[46:47], v15 offset:18944
v_mfma_f32_16x16x32_bf16 v[44:47], a[16:19], a[68:71], v[44:47]
ds_read_b64_tr_b16 a[48:49], v14 offset:20480
v_mfma_f32_16x16x32_bf16 v[68:71], a[20:23], a[68:71], v[68:71]
ds_read_b64_tr_b16 a[50:51], v14 offset:20992
v_mfma_f32_16x16x32_bf16 v[92:95], a[24:27], a[68:71], v[92:95]
ds_read_b64_tr_b16 a[52:53], v15 offset:20480
v_mfma_f32_16x16x32_bf16 v[116:119], a[28:31], a[68:71], v[116:119]
ds_read_b64_tr_b16 a[54:55], v15 offset:20992
v_mfma_f32_16x16x32_bf16 v[48:51], a[16:19], a[72:75], v[48:51]
v_mfma_f32_16x16x32_bf16 v[72:75], a[20:23], a[72:75], v[72:75]
v_mfma_f32_16x16x32_bf16 v[96:99], a[24:27], a[72:75], v[96:99]
v_mfma_f32_16x16x32_bf16 v[120:123], a[28:31], a[72:75], v[120:123]
v_mfma_f32_16x16x32_bf16 v[52:55], a[16:19], a[76:79], v[52:55]
v_mfma_f32_16x16x32_bf16 v[76:79], a[20:23], a[76:79], v[76:79]
v_mfma_f32_16x16x32_bf16 v[100:103], a[24:27], a[76:79], v[100:103]
v_mfma_f32_16x16x32_bf16 v[124:127], a[28:31], a[76:79], v[124:127]
s_waitcnt lgkmcnt(0)
v_mfma_f32_16x16x32_bf16 v[32:35], a[32:35], a[0:3], v[32:35]
ds_read_b128 a[16:19], v11 offset:0
v_mfma_f32_16x16x32_bf16 v[56:59], a[32:35], a[4:7], v[56:59]
ds_read_b64_tr_b16 a[56:57], v14 offset:28672
v_mfma_f32_16x16x32_bf16 v[80:83], a[32:35], a[8:11], v[80:83]
ds_read_b64_tr_b16 a[58:59], v14 offset:29184
v_mfma_f32_16x16x32_bf16 v[104:107], a[32:35], a[12:15], v[104:107]
ds_read_b128 a[20:23], v11 offset:2048
v_mfma_f32_16x16x32_bf16 v[36:39], a[36:39], a[0:3], v[36:39]
ds_read_b128 a[24:27], v11 offset:4096
v_mfma_f32_16x16x32_bf16 v[60:63], a[36:39], a[4:7], v[60:63]
ds_read_b128 a[28:31], v11 offset:6144
v_mfma_f32_16x16x32_bf16 v[84:87], a[36:39], a[8:11], v[84:87]
ds_read_b64_tr_b16 a[60:61], v15 offset:28672
v_mfma_f32_16x16x32_bf16 v[108:111], a[36:39], a[12:15], v[108:111]
ds_read_b64_tr_b16 a[62:63], v15 offset:29184
v_mfma_f32_16x16x32_bf16 v[40:43], a[0:3], a[40:43], v[40:43]
ds_read_b64_tr_b16 a[64:65], v14 offset:30720
v_mfma_f32_16x16x32_bf16 v[64:67], a[4:7], a[40:43], v[64:67]
ds_read_b64_tr_b16 a[66:67], v14 offset:31232
v_mfma_f32_16x16x32_bf16 v[88:91], a[8:11], a[40:43], v[88:91]
ds_read_b64_tr_b16 a[68:69], v15 offset:30720
v_mfma_f32_16x16x32_bf16 v[112:115], a[12:15], a[40:43], v[112:115]
ds_read_b64_tr_b16 a[70:71], v15 offset:31232
v_mfma_f32_16x16x32_bf16 v[44:47], a[0:3], a[44:47], v[44:47]
ds_read_b64_tr_b16 a[72:73], v14 offset:32768
v_mfma_f32_16x16x32_bf16 v[68:71], a[4:7], a[44:47], v[68:71]
ds_read_b64_tr_b16 a[74:75], v14 offset:33280
v_mfma_f32_16x16x32_bf16 v[92:95], a[8:11], a[44:47], v[92:95]
ds_read_b64_tr_b16 a[76:77], v15 offset:32768
v_mfma_f32_16x16x32_bf16 v[116:119], a[12:15], a[44:47], v[116:119]
ds_read_b64_tr_b16 a[78:79], v15 offset:33280
v_mfma_f32_16x16x32_bf16 v[48:51], a[0:3], a[48:51], v[48:51]
v_mfma_f32_16x16x32_bf16 v[72:75], a[4:7], a[48:51], v[72:75]
v_mfma_f32_16x16x32_bf16 v[96:99], a[8:11], a[48:51], v[96:99]
v_mfma_f32_16x16x32_bf16 v[120:123], a[12:15], a[48:51], v[120:123]
v_mfma_f32_16x16x32_bf16 v[52:55], a[0:3], a[52:55], v[52:55]
v_mfma_f32_16x16x32_bf16 v[76:79], a[4:7], a[52:55], v[76:79]
v_mfma_f32_16x16x32_bf16 v[100:103], a[8:11], a[52:55], v[100:103]
v_mfma_f32_16x16x32_bf16 v[124:127], a[12:15], a[52:55], v[124:127]
s_waitcnt lgkmcnt(0)
v_mfma_f32_16x16x32_bf16 v[32:35], a[56:59], a[16:19], v[32:35]
s_barrier
ds_read_b128 a[0:3], v8 offset:24576
v_mfma_f32_16x16x32_bf16 v[56:59], a[56:59], a[20:23], v[56:59]
ds_read_b64_tr_b16 a[32:33], v12 offset:40960
v_mfma_f32_16x16x32_bf16 v[80:83], a[56:59], a[24:27], v[80:83]
ds_read_b64_tr_b16 a[34:35], v12 offset:41472
v_mfma_f32_16x16x32_bf16 v[104:107], a[56:59], a[28:31], v[104:107]
ds_read_b128 a[4:7], v8 offset:26624
v_mfma_f32_16x16x32_bf16 v[36:39], a[60:63], a[16:19], v[36:39]
ds_read_b128 a[8:11], v8 offset:28672
v_mfma_f32_16x16x32_bf16 v[60:63], a[60:63], a[20:23], v[60:63]
ds_read_b128 a[12:15], v8 offset:30720
v_mfma_f32_16x16x32_bf16 v[84:87], a[60:63], a[24:27], v[84:87]
s_branch L_over4
L_pad4:
s_branch L_ret4
L_over4:
ds_read_b64_tr_b16 a[36:37], v13 offset:40960
v_mfma_f32_16x16x32_bf16 v[108:111], a[60:63], a[28:31], v[108:111]
ds_read_b64_tr_b16 a[38:39], v13 offset:41472
v_mfma_f32_16x16x32_bf16 v[40:43], a[16:19], a[64:67], v[40:43]
ds_read_b64_tr_b16 a[40:41], v12 offset:43008
v_mfma_f32_16x16x32_bf16 v[64:67], a[20:23], a[64:67], v[64:67]
ds_read_b64_tr_b16 a[42:43], v12 offset:43520
v_mfma_f32_16x16x32_bf16 v[88:91], a[24:27], a[64:67], v[88:91]
ds_read_b64_tr_b16 a[44:45], v13 offset:43008
v_mfma_f32_16x16x32_bf16 v[112:115], a[28:31], a[64:67], v[112:115]
ds_read_b64_tr_b16 a[46:47], v13 offset:43520
v_mfma_f32_16x16x32_bf16 v[44:47], a[16:19], a[68:71], v[44:47]
ds_read_b64_tr_b16 a[48:49], v12 offset:45056
v_mfma_f32_16x16x32_bf16 v[68:71], a[20:23], a[68:71], v[68:71]
ds_read_b64_tr_b16 a[50:51], v12 offset:45568
v_mfma_f32_16x16x32_bf16 v[92:95], a[24:27], a[68:71], v[92:95]
ds_read_b64_tr_b16 a[52:53], v13 offset:45056
v_mfma_f32_16x16x32_bf16 v[116:119], a[28:31], a[68:71], v[116:119]
ds_read_b64_tr_b16 a[54:55], v13 offset:45568
v_mfma_f32_16x16x32_bf16 v[48:51], a[16:19], a[72:75], v[48:51]
v_mfma_f32_16x16x32_bf16 v[72:75], a[20:23], a[72:75], v[72:75]
v_mfma_f32_16x16x32_bf16 v[96:99], a[24:27], a[72:75], v[96:99]
v_mfma_f32_16x16x32_bf16 v[120:123], a[28:31], a[72:75], v[120:123]
v_mfma_f32_16x16x32_bf16 v[52:55], a[16:19], a[76:79], v[52:55]
v_mfma_f32_16x16x32_bf16 v[76:79], a[20:23], a[76:79], v[76:79]
v_mfma_f32_16x16x32_bf16 v[100:103], a[24:27], a[76:79], v[100:103]
v_mfma_f32_16x16x32_bf16 v[124:127], a[28:31], a[76:79], v[124:127]
s_waitcnt lgkmcnt(0)
v_mfma_f32_16x16x32_bf16 v[32:35], a[32:35], a[0:3], v[32:35]
ds_read_b128 a[16:19], v9 offset:24576
v_mfma_f32_16x16x32_bf16 v[56:59], a[32:35], a[4:7], v[56:59]
ds_read_b64_tr_b16 a[56:57], v12 offset:53248
v_mfma_f32_16x16x32_bf16 v[80:83], a[32:35], a[8:11], v[80:83]
ds_read_b64_tr_b16 a[58:59], v12 offset:53760
v_mfma_f32_16x16x32_bf16 v[104:107], a[32:35], a[12:15], v[104:107]
ds_read_b128 a[20:23], v9 offset:26624
v_mfma_f32_16x16x32_bf16 v[36:39], a[36:39], a[0:3], v[36:39]
ds_read_b128 a[24:27], v9 offset:28672
v_mfma_f32_16x16x32_bf16 v[60:63], a[36:39], a[4:7], v[60:63]
ds_read_b128 a[28:31], v9 offset:30720
v_mfma_f32_16x16x32_bf16 v[84:87], a[36:39], a[8:11], v[84:87]
ds_read_b64_tr_b16 a[60:61], v13 offset:53248
v_mfma_f32_16x16x32_bf16 v[108:111], a[36:39], a[12:15], v[108:111]
ds_read_b64_tr_b16 a[62:63], v13 offset:53760
v_mfma_f32_16x16x32_bf16 v[40:43], a[0:3], a[40:43], v[40:43]
ds_read_b64_tr_b16 a[64:65], v12 offset:55296
v_mfma_f32_16x16x32_bf16 v[64:67], a[4:7], a[40:43], v[64:67]
ds_read_b64_tr_b16 a[66:67], v12 offset:55808
v_mfma_f32_16x16x32_bf16 v[88:91], a[8:11], a[40:43], v[88:91]
ds_read_b64_tr_b16 a[68:69], v13 offset:55296
v_mfma_f32_16x16x32_bf16 v[112:115], a[12:15], a[40:43], v[112:115]
ds_read_b64_tr_b16 a[70:71], v13 offset:55808
v_mfma_f32_16x16x32_bf16 v[44:47], a[0:3], a[44:47], v[44:47]
ds_read_b64_tr_b16 a[72:73], v12 offset:57344
v_mfma_f32_16x16x32_bf16 v[68:71], a[4:7], a[44:47], v[68:71]
ds_read_b64_tr_b16 a[74:75], v12 offset:57856
v_mfma_f32_16x16x32_bf16 v[92:95], a[8:11], a[44:47], v[92:95]
ds_read_b64_tr_b16 a[76:77], v13 offset:57344
v_mfma_f32_16x16x32_bf16 v[116:119], a[12:15], a[44:47], v[116:119]
ds_read_b64_tr_b16 a[78:79], v13 offset:57856
v_mfma_f32_16x16x32_bf16 v[48:51], a[0:3], a[48:51], v[48:51]
v_mfma_f32_16x16x32_bf16 v[72:75], a[4:7], a[48:51], v[72:75]
v_mfma_f32_16x16x32_bf16 v[96:99], a[8:11], a[48:51], v[96:99]
v_mfma_f32_16x16x32_bf16 v[120:123], a[12:15], a[48:51], v[120:123]
v_mfma_f32_16x16x32_bf16 v[52:55], a[0:3], a[52:55], v[52:55]
v_mfma_f32_16x16x32_bf16 v[76:79], a[4:7], a[52:55], v[76:79]
v_mfma_f32_16x16x32_bf16 v[100:103], a[8:11], a[52:55], v[100:103]
v_mfma_f32_16x16x32_bf16 v[124:127], a[12:15], a[52:55], v[124:127]
s_waitcnt lgkmcnt(0)
v_mfma_f32_16x16x32_bf16 v[32:35], a[56:59], a[16:19], v[32:35]
s_barrier
ds_read_b128 a[0:3], v10 offset:57344
v_mfma_f32_16x16x32_bf16 v[56:59], a[56:59], a[20:23], v[56:59]
ds_read_b64_tr_b16 a[32:33], v12 offset:0
v_mfma_f32_16x16x32_bf16 v[80:83], a[56:59], a[24:27], v[80:83]
ds_read_b64_tr_b16 a[34:35], v12 offset:512
v_mfma_f32_16x16x32_bf16 v[104:107], a[56:59], a[28:31], v[104:107]
ds_read_b128 a[4:7], v10 offset:59392
v_mfma_f32_16x16x32_bf16 v[36:39], a[60:63], a[16:19], v[36:39]
ds_read_b128 a[8:11], v10 offset:61440
v_mfma_f32_16x16x32_bf16 v[60:63], a[60:63], a[20:23], v[60:63]
ds_read_b128 a[12:15], v10 offset:63488
v_mfma_f32_16x16x32_bf16 v[84:87], a[60:63], a[24:27], v[84:87]
ds_read_b64_tr_b16 a[36:37], v13 offset:0
v_mfma_f32_16x16x32_bf16 v[108:111], a[60:63], a[28:31], v[108:111]
ds_read_b64_tr_b16 a[38:39], v13 offset:512
v_mfma_f32_16x16x32_bf16 v[40:43], a[16:19], a[64:67], v[40:43]
ds_read_b64_tr_b16 a[40:41], v12 offset:2048
v_mfma_f32_16x16x32_bf16 v[64:67], a[20:23], a[64:67], v[64:67]
ds_read_b64_tr_b16 a[42:43], v12 offset:2560
v_mfma_f32_16x16x32_bf16 v[88:91], a[24:27], a[64:67], v[88:91]
ds_read_b64_tr_b16 a[44:45], v13 offset:2048
v_mfma_f32_16x16x32_bf16 v[112:115], a[28:31], a[64:67], v[112:115]
ds_read_b64_tr_b16 a[46:47], v13 offset:2560
v_mfma_f32_16x16x32_bf16 v[44:47], a[16:19], a[68:71], v[44:47]
ds_read_b64_tr_b16 a[48:49], v12 offset:4096
v_mfma_f32_16x16x32_bf16 v[68:71], a[20:23], a[68:71], v[68:71]
ds_read_b64_tr_b16 a[50:51], v12 offset:4608
v_mfma_f32_16x16x32_bf16 v[92:95], a[24:27], a[68:71], v[92:95]
ds_read_b64_tr_b16 a[52:53], v13 offset:4096
v_mfma_f32_16x16x32_bf16 v[116:119], a[28:31], a[68:71], v[116:119]
ds_read_b64_tr_b16 a[54:55], v13 offset:4608
v_mfma_f32_16x16x32_bf16 v[48:51], a[16:19], a[72:75], v[48:51]
v_mfma_f32_16x16x32_bf16 v[72:75], a[20:23], a[72:75], v[72:75]
v_mfma_f32_16x16x32_bf16 v[96:99], a[24:27], a[72:75], v[96:99]
v_mfma_f32_16x16x32_bf16 v[120:123], a[28:31], a[72:75], v[120:123]
v_mfma_f32_16x16x32_bf16 v[52:55], a[16:19], a[76:79], v[52:55]
v_mfma_f32_16x16x32_bf16 v[76:79], a[20:23], a[76:79], v[76:79]
v_mfma_f32_16x16x32_bf16 v[100:103], a[24:27], a[76:79], v[100:103]
v_mfma_f32_16x16x32_bf16 v[124:127], a[28:31], a[76:79], v[124:127]
s_waitcnt lgkmcnt(0)
v_mfma_f32_16x16x32_bf16 v[32:35], a[32:35], a[0:3], v[32:35]
ds_read_b128 a[16:19], v11 offset:57344
v_mfma_f32_16x16x32_bf16 v[56:59], a[32:35], a[4:7], v[56:59]
ds_read_b64_tr_b16 a[56:57], v12 offset:12288
v_mfma_f32_16x16x32_bf16 v[80:83], a[32:35], a[8:11], v[80:83]
ds_read_b64_tr_b16 a[58:59], v12 offset:12800
v_mfma_f32_16x16x32_bf16 v[104:107], a[32:35], a[12:15], v[104:107]
ds_read_b128 a[20:23], v11 offset:59392
v_mfma_f32_16x16x32_bf16 v[36:39], a[36:39], a[0:3], v[36:39]
ds_read_b128 a[24:27], v11 offset:61440
v_mfma_f32_16x16x32_bf16 v[60:63], a[36:39], a[4:7], v[60:63]
ds_read_b128 a[28:31], v11 offset:63488
v_mfma_f32_16x16x32_bf16 v[84:87], a[36:39], a[8:11], v[84:87]
ds_read_b64_tr_b16 a[60:61], v13 offset:12288
v_mfma_f32_16x16x32_bf16 v[108:111], a[36:39], a[12:15], v[108:111]
ds_read_b64_tr_b16 a[62:63], v13 offset:12800
v_mfma_f32_16x16x32_bf16 v[40:43], a[0:3], a[40:43], v[40:43]
ds_read_b64_tr_b16 a[64:65], v12 offset:14336
v_mfma_f32_16x16x32_bf16 v[64:67], a[4:7], a[40:43], v[64:67]
ds_read_b64_tr_b16 a[66:67], v12 offset:14848
v_mfma_f32_16x16x32_bf16 v[88:91], a[8:11], a[40:43], v[88:91]
ds_read_b64_tr_b16 a[68:69], v13 offset:14336
v_mfma_f32_16x16x32_bf16 v[112:115], a[12:15], a[40:43], v[112:115]
ds_read_b64_tr_b16 a[70:71], v13 offset:14848
v_mfma_f32_16x16x32_bf16 v[44:47], a[0:3], a[44:47], v[44:47]
ds_read_b64_tr_b16 a[72:73], v12 offset:16384
v_mfma_f32_16x16x32_bf16 v[68:71], a[4:7], a[44:47], v[68:71]
ds_read_b64_tr_b16 a[74:75], v12 offset:16896
v_mfma_f32_16x16x32_bf16 v[92:95], a[8:11], a[44:47], v[92:95]
ds_read_b64_tr_b16 a[76:77], v13 offset:16384
v_mfma_f32_16x16x32_bf16 v[116:119], a[12:15], a[44:47], v[116:119]
ds_read_b64_tr_b16 a[78:79], v13 offset:16896
v_mfma_f32_16x16x32_bf16 v[48:51], a[0:3], a[48:51], v[48:51]
v_mfma_f32_16x16x32_bf16 v[72:75], a[4:7], a[48:51], v[72:75]
v_mfma_f32_16x16x32_bf16 v[96:99], a[8:11], a[48:51], v[96:99]
v_mfma_f32_16x16x32_bf16 v[120:123], a[12:15], a[48:51], v[120:123]
v_mfma_f32_16x16x32_bf16 v[52:55], a[0:3], a[52:55], v[52:55]
v_mfma_f32_16x16x32_bf16 v[76:79], a[4:7], a[52:55], v[76:79]
v_mfma_f32_16x16x32_bf16 v[100:103], a[8:11], a[52:55], v[100:103]
v_mfma_f32_16x16x32_bf16 v[124:127], a[12:15], a[52:55], v[124:127]
s_waitcnt lgkmcnt(0)
v_mfma_f32_16x16x32_bf16 v[32:35], a[56:59], a[16:19], v[32:35]
s_barrier
ds_read_b128 a[0:3], v10 offset:40960
v_mfma_f32_16x16x32_bf16 v[56:59], a[56:59], a[20:23], v[56:59]
ds_read_b64_tr_b16 a[32:33], v14 offset:16384
v_mfma_f32_16x16x32_bf16 v[80:83], a[56:59], a[24:27], v[80:83]
ds_read_b64_tr_b16 a[34:35], v14 offset:16896
v_mfma_f32_16x16x32_bf16 v[104:107], a[56:59], a[28:31], v[104:107]
ds_read_b128 a[4:7], v10 offset:43008
v_mfma_f32_16x16x32_bf16 v[36:39], a[60:63], a[16:19], v[36:39]
ds_read_b128 a[8:11], v10 offset:45056
v_mfma_f32_16x16x32_bf16 v[60:63], a[60:63], a[20:23], v[60:63]
ds_read_b128 a[12:15], v10 offset:47104
v_mfma_f32_16x16x32_bf16 v[84:87], a[60:63], a[24:27], v[84:87]
ds_read_b64_tr_b16 a[36:37], v15 offset:16384
v_mfma_f32_16x16x32_bf16 v[108:111], a[60:63], a[28:31], v[108:111]
ds_read_b64_tr_b16 a[38:39], v15 offset:16896
v_mfma_f32_16x16x32_bf16 v[40:43], a[16:19], a[64:67], v[40:43]
ds_read_b64_tr_b16 a[40:41], v14 offset:18432
v_mfma_f32_16x16x32_bf16 v[64:67], a[20:23], a[64:67], v[64:67]
ds_read_b64_tr_b16 a[42:43], v14 offset:18944
v_mfma_f32_16x16x32_bf16 v[88:91], a[24:27], a[64:67], v[88:91]
ds_read_b64_tr_b16 a[44:45], v15 offset:18432
v_mfma_f32_16x16x32_bf16 v[112:115], a[28:31], a[64:67], v[112:115]
ds_read_b64_tr_b16 a[46:47], v15 offset:18944
v_mfma_f32_16x16x32_bf16 v[44:47], a[16:19], a[68:71], v[44:47]
ds_read_b64_tr_b16 a[48:49], v14 offset:20480
v_mfma_f32_16x16x32_bf16 v[68:71], a[20:23], a[68:71], v[68:71]
ds_read_b64_tr_b16 a[50:51], v14 offset:20992
v_mfma_f32_16x16x32_bf16 v[92:95], a[24:27], a[68:71], v[92:95]
ds_read_b64_tr_b16 a[52:53], v15 offset:20480
v_mfma_f32_16x16x32_bf16 v[116:119], a[28:31], a[68:71], v[116:119]
ds_read_b64_tr_b16 a[54:55], v15 offset:20992
v_mfma_f32_16x16x32_bf16 v[48:51], a[16:19], a[72:75], v[48:51]
v_mfma_f32_16x16x32_bf16 v[72:75], a[20:23], a[72:75], v[72:75]
v_mfma_f32_16x16x32_bf16 v[96:99], a[24:27], a[72:75], v[96:99]
v_mfma_f32_16x16x32_bf16 v[120:123], a[28:31], a[72:75], v[120:123]
v_mfma_f32_16x16x32_bf16 v[52:55], a[16:19], a[76:79], v[52:55]
v_mfma_f32_16x16x32_bf16 v[76:79], a[20:23], a[76:79], v[76:79]
v_mfma_f32_16x16x32_bf16 v[100:103], a[24:27], a[76:79], v[100:103]
v_mfma_f32_16x16x32_bf16 v[124:127], a[28:31], a[76:79], v[124:127]
s_waitcnt lgkmcnt(0)
v_mfma_f32_16x16x32_bf16 v[32:35], a[32:35], a[0:3], v[32:35]
ds_read_b128 a[16:19], v11 offset:40960
v_mfma_f32_16x16x32_bf16 v[56:59], a[32:35], a[4:7], v[56:59]
ds_read_b64_tr_b16 a[56:57], v14 offset:28672
v_mfma_f32_16x16x32_bf16 v[80:83], a[32:35], a[8:11], v[80:83]
ds_read_b64_tr_b16 a[58:59], v14 offset:29184
v_mfma_f32_16x16x32_bf16 v[104:107], a[32:35], a[12:15], v[104:107]
ds_read_b128 a[20:23], v11 offset:43008
v_mfma_f32_16x16x32_bf16 v[36:39], a[36:39], a[0:3], v[36:39]
ds_read_b128 a[24:27], v11 offset:45056
v_mfma_f32_16x16x32_bf16 v[60:63], a[36:39], a[4:7], v[60:63]
ds_read_b128 a[28:31], v11 offset:47104
v_mfma_f32_16x16x32_bf16 v[84:87], a[36:39], a[8:11], v[84:87]
ds_read_b64_tr_b16 a[60:61], v15 offset:28672
v_mfma_f32_16x16x32_bf16 v[108:111], a[36:39], a[12:15], v[108:111]
ds_read_b64_tr_b16 a[62:63], v15 offset:29184
v_mfma_f32_16x16x32_bf16 v[40:43], a[0:3], a[40:43], v[40:43]
ds_read_b64_tr_b16 a[64:65], v14 offset:30720
v_mfma_f32_16x16x32_bf16 v[64:67], a[4:7], a[40:43], v[64:67]
ds_read_b64_tr_b16 a[66:67], v14 offset:31232
v_mfma_f32_16x16x32_bf16 v[88:91], a[8:11], a[40:43], v[88:91]
ds_read_b64_tr_b16 a[68:69], v15 offset:30720
v_mfma_f32_16x16x32_bf16 v[112:115], a[12:15], a[40:43], v[112:115]
ds_read_b64_tr_b16 a[70:71], v15 offset:31232
v_mfma_f32_16x16x32_bf16 v[44:47], a[0:3], a[44:47], v[44:47]
ds_read_b64_tr_b16 a[72:73], v14 offset:32768
v_mfma_f32_16x16x32_bf16 v[68:71], a[4:7], a[44:47], v[68:71]
ds_read_b64_tr_b16 a[74:75], v14 offset:33280
v_mfma_f32_16x16x32_bf16 v[92:95], a[8:11], a[44:47], v[92:95]
ds_read_b64_tr_b16 a[76:77], v15 offset:32768
v_mfma_f32_16x16x32_bf16 v[116:119], a[12:15], a[44:47], v[116:119]
ds_read_b64_tr_b16 a[78:79], v15 offset:33280
v_mfma_f32_16x16x32_bf16 v[48:51], a[0:3], a[48:51], v[48:51]
v_mfma_f32_16x16x32_bf16 v[72:75], a[4:7], a[48:51], v[72:75]
v_mfma_f32_16x16x32_bf16 v[96:99], a[8:11], a[48:51], v[96:99]
v_mfma_f32_16x16x32_bf16 v[120:123], a[12:15], a[48:51], v[120:123]
v_mfma_f32_16x16x32_bf16 v[52:55], a[0:3], a[52:55], v[52:55]
v_mfma_f32_16x16x32_bf16 v[76:79], a[4:7], a[52:55], v[76:79]
v_mfma_f32_16x16x32_bf16 v[100:103], a[8:11], a[52:55], v[100:103]
v_mfma_f32_16x16x32_bf16 v[124:127], a[12:15], a[52:55], v[124:127]
s_waitcnt lgkmcnt(0)
v_mfma_f32_16x16x32_bf16 v[32:35], a[56:59], a[16:19], v[32:35]
s_barrier
ds_read_b128 a[0:3], v10 offset:0
v_mfma_f32_16x16x32_bf16 v[56:59], a[56:59], a[20:23], v[56:59]
ds_read_b64_tr_b16 a[32:33], v12 offset:40960
v_mfma_f32_16x16x32_bf16 v[80:83], a[56:59], a[24:27], v[80:83]
ds_read_b64_tr_b16 a[34:35], v12 offset:41472
v_mfma_f32_16x16x32_bf16 v[104:107], a[56:59], a[28:31], v[104:107]
ds_read_b128 a[4:7], v10 offset:2048
v_mfma_f32_16x16x32_bf16 v[36:39], a[60:63], a[16:19], v[36:39]
ds_read_b128 a[8:11], v10 offset:4096
v_mfma_f32_16x16x32_bf16 v[60:63], a[60:63], a[20:23], v[60:63]
ds_read_b128 a[12:15], v10 offset:6144
v_mfma_f32_16x16x32_bf16 v[84:87], a[60:63], a[24:27], v[84:87]
ds_read_b64_tr_b16 a[36:37], v13 offset:40960
v_mfma_f32_16x16x32_bf16 v[108:111], a[60:63], a[28:31], v[108:111]
ds_read_b64_tr_b16 a[38:39], v13 offset:41472
v_mfma_f32_16x16x32_bf16 v[40:43], a[16:19], a[64:67], v[40:43]
ds_read_b64_tr_b16 a[40:41], v12 offset:43008
v_mfma_f32_16x16x32_bf16 v[64:67], a[20:23], a[64:67], v[64:67]
ds_read_b64_tr_b16 a[42:43], v12 offset:43520
v_mfma_f32_16x16x32_bf16 v[88:91], a[24:27], a[64:67], v[88:91]
ds_read_b64_tr_b16 a[44:45], v13 offset:43008
v_mfma_f32_16x16x32_bf16 v[112:115], a[28:31], a[64:67], v[112:115]
ds_read_b64_tr_b16 a[46:47], v13 offset:43520
v_mfma_f32_16x16x32_bf16 v[44:47], a[16:19], a[68:71], v[44:47]
ds_read_b64_tr_b16 a[48:49], v12 offset:45056
v_mfma_f32_16x16x32_bf16 v[68:71], a[20:23], a[68:71], v[68:71]
ds_read_b64_tr_b16 a[50:51], v12 offset:45568
v_mfma_f32_16x16x32_bf16 v[92:95], a[24:27], a[68:71], v[92:95]
ds_read_b64_tr_b16 a[52:53], v13 offset:45056
v_mfma_f32_16x16x32_bf16 v[116:119], a[28:31], a[68:71], v[116:119]
ds_read_b64_tr_b16 a[54:55], v13 offset:45568
v_mfma_f32_16x16x32_bf16 v[48:51], a[16:19], a[72:75], v[48:51]
v_mfma_f32_16x16x32_bf16 v[72:75], a[20:23], a[72:75], v[72:75]
v_mfma_f32_16x16x32_bf16 v[96:99], a[24:27], a[72:75], v[96:99]
v_mfma_f32_16x16x32_bf16 v[120:123], a[28:31], a[72:75], v[120:123]
v_mfma_f32_16x16x32_bf16 v[52:55], a[16:19], a[76:79], v[52:55]
v_mfma_f32_16x16x32_bf16 v[76:79], a[20:23], a[76:79], v[76:79]
v_mfma_f32_16x16x32_bf16 v[100:103], a[24:27], a[76:79], v[100:103]
v_mfma_f32_16x16x32_bf16 v[124:127], a[28:31], a[76:79], v[124:127]
s_waitcnt lgkmcnt(0)
v_mfma_f32_16x16x32_bf16 v[32:35], a[32:35], a[0:3], v[32:35]
ds_read_b128 a[16:19], v11 offset:0
v_mfma_f32_16x16x32_bf16 v[56:59], a[32:35], a[4:7], v[56:59]
ds_read_b64_tr_b16 a[56:57], v12 offset:53248
v_mfma_f32_16x16x32_bf16 v[80:83], a[32:35], a[8:11], v[80:83]
ds_read_b64_tr_b16 a[58:59], v12 offset:53760
v_mfma_f32_16x16x32_bf16 v[104:107], a[32:35], a[12:15], v[104:107]
ds_read_b128 a[20:23], v11 offset:2048
v_mfma_f32_16x16x32_bf16 v[36:39], a[36:39], a[0:3], v[36:39]
ds_read_b128 a[24:27], v11 offset:4096
v_mfma_f32_16x16x32_bf16 v[60:63], a[36:39], a[4:7], v[60:63]
ds_read_b128 a[28:31], v11 offset:6144
v_mfma_f32_16x16x32_bf16 v[84:87], a[36:39], a[8:11], v[84:87]
ds_read_b64_tr_b16 a[60:61], v13 offset:53248
v_mfma_f32_16x16x32_bf16 v[108:111], a[36:39], a[12:15], v[108:111]
ds_read_b64_tr_b16 a[62:63], v13 offset:53760
v_mfma_f32_16x16x32_bf16 v[40:43], a[0:3], a[40:43], v[40:43]
ds_read_b64_tr_b16 a[64:65], v12 offset:55296
v_mfma_f32_16x16x32_bf16 v[64:67], a[4:7], a[40:43], v[64:67]
ds_read_b64_tr_b16 a[66:67], v12 offset:55808
v_mfma_f32_16x16x32_bf16 v[88:91], a[8:11], a[40:43], v[88:91]
ds_read_b64_tr_b16 a[68:69], v13 offset:55296
v_mfma_f32_16x16x32_bf16 v[112:115], a[12:15], a[40:43], v[112:115]
ds_read_b64_tr_b16 a[70:71], v13 offset:55808
v_mfma_f32_16x16x32_bf16 v[44:47], a[0:3], a[44:47], v[44:47]
ds_read_b64_tr_b16 a[72:73], v12 offset:57344
v_mfma_f32_16x16x32_bf16 v[68:71], a[4:7], a[44:47], v[68:71]
ds_read_b64_tr_b16 a[74:75], v12 offset:57856
v_mfma_f32_16x16x32_bf16 v[92:95], a[8:11], a[44:47], v[92:95]
ds_read_b64_tr_b16 a[76:77], v13 offset:57344
v_mfma_f32_16x16x32_bf16 v[116:119], a[12:15], a[44:47], v[116:119]
ds_read_b64_tr_b16 a[78:79], v13 offset:57856
v_mfma_f32_16x16x32_bf16 v[48:51], a[0:3], a[48:51], v[48:51]
v_lshrrev_b32 v2, 4, v1
v_lshlrev_b32 v2, 4, v2
s_lshl_b32 s70, s66, 8
s_add_u32 s70, s70, 159744
v_add_u32 v17, s70, v2
v_mfma_f32_16x16x32_bf16 v[72:75], a[4:7], a[48:51], v[72:75]
v_mfma_f32_16x16x32_bf16 v[96:99], a[8:11], a[48:51], v[96:99]
v_and_b32 v2, 15, v1
v_lshlrev_b32 v2, 2, v2
s_lshl_b32 s70, s67, 7
s_add_u32 s70, s70, 160768
v_add_u32 v18, s70, v2
v_mfma_f32_16x16x32_bf16 v[120:123], a[12:15], a[48:51], v[120:123]
v_mfma_f32_16x16x32_bf16 v[52:55], a[0:3], a[52:55], v[52:55]
v_mfma_f32_16x16x32_bf16 v[76:79], a[4:7], a[52:55], v[76:79]
v_mfma_f32_16x16x32_bf16 v[100:103], a[8:11], a[52:55], v[100:103]
v_mfma_f32_16x16x32_bf16 v[124:127], a[12:15], a[52:55], v[124:127]
s_waitcnt lgkmcnt(0)
v_mfma_f32_16x16x32_bf16 v[32:35], a[56:59], a[16:19], v[32:35]
s_barrier
ds_read_b128 a[0:3], v8 offset:24576
v_mfma_f32_16x16x32_bf16 v[56:59], a[56:59], a[20:23], v[56:59]
ds_read_b64_tr_b16 a[32:33], v12 offset:0
v_mfma_f32_16x16x32_bf16 v[80:83], a[56:59], a[24:27], v[80:83]
ds_read_b64_tr_b16 a[34:35], v12 offset:512
v_mfma_f32_16x16x32_bf16 v[104:107], a[56:59], a[28:31], v[104:107]
ds_read_b128 a[4:7], v8 offset:26624
v_mfma_f32_16x16x32_bf16 v[36:39], a[60:63], a[16:19], v[36:39]
ds_read_b128 a[8:11], v8 offset:28672
v_mfma_f32_16x16x32_bf16 v[60:63], a[60:63], a[20:23], v[60:63]
ds_read_b128 a[12:15], v8 offset:30720
v_mfma_f32_16x16x32_bf16 v[84:87], a[60:63], a[24:27], v[84:87]
ds_read_b64_tr_b16 a[36:37], v13 offset:0
v_mfma_f32_16x16x32_bf16 v[108:111], a[60:63], a[28:31], v[108:111]
ds_read_b64_tr_b16 a[38:39], v13 offset:512
v_mfma_f32_16x16x32_bf16 v[40:43], a[16:19], a[64:67], v[40:43]
ds_read_b64_tr_b16 a[40:41], v12 offset:2048
v_mfma_f32_16x16x32_bf16 v[64:67], a[20:23], a[64:67], v[64:67]
ds_read_b64_tr_b16 a[42:43], v12 offset:2560
v_mfma_f32_16x16x32_bf16 v[88:91], a[24:27], a[64:67], v[88:91]
ds_read_b64_tr_b16 a[44:45], v13 offset:2048
v_mfma_f32_16x16x32_bf16 v[112:115], a[28:31], a[64:67], v[112:115]
ds_read_b64_tr_b16 a[46:47], v13 offset:2560
v_mfma_f32_16x16x32_bf16 v[44:47], a[16:19], a[68:71], v[44:47]
ds_read_b64_tr_b16 a[48:49], v12 offset:4096
v_mfma_f32_16x16x32_bf16 v[68:71], a[20:23], a[68:71], v[68:71]
ds_read_b64_tr_b16 a[50:51], v12 offset:4608
v_mfma_f32_16x16x32_bf16 v[92:95], a[24:27], a[68:71], v[92:95]
ds_read_b64_tr_b16 a[52:53], v13 offset:4096
v_mfma_f32_16x16x32_bf16 v[116:119], a[28:31], a[68:71], v[116:119]
ds_read_b64_tr_b16 a[54:55], v13 offset:4608
v_mfma_f32_16x16x32_bf16 v[48:51], a[16:19], a[72:75], v[48:51]
v_mfma_f32_16x16x32_bf16 v[72:75], a[20:23], a[72:75], v[72:75]
v_mfma_f32_16x16x32_bf16 v[96:99], a[24:27], a[72:75], v[96:99]
v_mfma_f32_16x16x32_bf16 v[120:123], a[28:31], a[72:75], v[120:123]
v_mfma_f32_16x16x32_bf16 v[52:55], a[16:19], a[76:79], v[52:55]
v_mfma_f32_16x16x32_bf16 v[76:79], a[20:23], a[76:79], v[76:79]
v_mfma_f32_16x16x32_bf16 v[100:103], a[24:27], a[76:79], v[100:103]
v_mfma_f32_16x16x32_bf16 v[124:127], a[28:31], a[76:79], v[124:127]
s_waitcnt lgkmcnt(0)
v_mfma_f32_16x16x32_bf16 v[32:35], a[32:35], a[0:3], v[32:35]
ds_read_b128 a[16:19], v9 offset:24576
v_mfma_f32_16x16x32_bf16 v[56:59], a[32:35], a[4:7], v[56:59]
ds_read_b64_tr_b16 a[56:57], v12 offset:12288
v_mfma_f32_16x16x32_bf16 v[80:83], a[32:35], a[8:11], v[80:83]
ds_read_b64_tr_b16 a[58:59], v12 offset:12800
v_mfma_f32_16x16x32_bf16 v[104:107], a[32:35], a[12:15], v[104:107]
ds_read_b128 a[20:23], v9 offset:26624
v_mfma_f32_16x16x32_bf16 v[36:39], a[36:39], a[0:3], v[36:39]
ds_read_b128 a[24:27], v9 offset:28672
v_mfma_f32_16x16x32_bf16 v[60:63], a[36:39], a[4:7], v[60:63]
ds_read_b128 a[28:31], v9 offset:30720
v_mfma_f32_16x16x32_bf16 v[84:87], a[36:39], a[8:11], v[84:87]
ds_read_b64_tr_b16 a[60:61], v13 offset:12288
v_mfma_f32_16x16x32_bf16 v[108:111], a[36:39], a[12:15], v[108:111]
ds_read_b64_tr_b16 a[62:63], v13 offset:12800
v_mfma_f32_16x16x32_bf16 v[40:43], a[0:3], a[40:43], v[40:43]
ds_read_b64_tr_b16 a[64:65], v12 offset:14336
v_mfma_f32_16x16x32_bf16 v[64:67], a[4:7], a[40:43], v[64:67]
ds_read_b64_tr_b16 a[66:67], v12 offset:14848
v_mfma_f32_16x16x32_bf16 v[88:91], a[8:11], a[40:43], v[88:91]
ds_read_b64_tr_b16 a[68:69], v13 offset:14336
v_mfma_f32_16x16x32_bf16 v[112:115], a[12:15], a[40:43], v[112:115]
ds_read_b64_tr_b16 a[70:71], v13 offset:14848
v_mfma_f32_16x16x32_bf16 v[44:47], a[0:3], a[44:47], v[44:47]
ds_read_b64_tr_b16 a[72:73], v12 offset:16384
v_mfma_f32_16x16x32_bf16 v[68:71], a[4:7], a[44:47], v[68:71]
ds_read_b64_tr_b16 a[74:75], v12 offset:16896
v_mfma_f32_16x16x32_bf16 v[92:95], a[8:11], a[44:47], v[92:95]
ds_read_b64_tr_b16 a[76:77], v13 offset:16384
v_mfma_f32_16x16x32_bf16 v[116:119], a[12:15], a[44:47], v[116:119]
ds_read_b64_tr_b16 a[78:79], v13 offset:16896
v_mfma_f32_16x16x32_bf16 v[48:51], a[0:3], a[48:51], v[48:51]
v_mfma_f32_16x16x32_bf16 v[72:75], a[4:7], a[48:51], v[72:75]
v_mfma_f32_16x16x32_bf16 v[96:99], a[8:11], a[48:51], v[96:99]
v_mfma_f32_16x16x32_bf16 v[120:123], a[12:15], a[48:51], v[120:123]
v_mfma_f32_16x16x32_bf16 v[52:55], a[0:3], a[52:55], v[52:55]
v_mfma_f32_16x16x32_bf16 v[76:79], a[4:7], a[52:55], v[76:79]
v_mfma_f32_16x16x32_bf16 v[100:103], a[8:11], a[52:55], v[100:103]
v_mfma_f32_16x16x32_bf16 v[124:127], a[12:15], a[52:55], v[124:127]
s_waitcnt lgkmcnt(0)
v_mfma_f32_16x16x32_bf16 v[40:43], a[16:19], a[64:67], v[40:43]
s_barrier
ds_read_b128 v[20:23], v17 offset:0
v_mfma_f32_16x16x32_bf16 v[64:67], a[20:23], a[64:67], v[64:67]
ds_read_b128 v[24:27], v17 offset:512
v_mfma_f32_16x16x32_bf16 v[88:91], a[24:27], a[64:67], v[88:91]
ds_read_b32 v6, v18 offset:256
v_mfma_f32_16x16x32_bf16 v[112:115], a[28:31], a[64:67], v[112:115]
ds_read_b32 v8, v18 offset:320
v_mfma_f32_16x16x32_bf16 v[44:47], a[16:19], a[68:71], v[44:47]
ds_read_b32 v10, v18 offset:512
v_mfma_f32_16x16x32_bf16 v[68:71], a[20:23], a[68:71], v[68:71]
ds_read_b32 v18, v18 offset:576
v_mfma_f32_16x16x32_bf16 v[92:95], a[24:27], a[68:71], v[92:95]
v_mov_b32 v19, 161536
ds_read_b32 v19, v19
v_mfma_f32_16x16x32_bf16 v[116:119], a[28:31], a[68:71], v[116:119]
ds_read_b128 v[128:131], v17 offset:64
v_mfma_f32_16x16x32_bf16 v[48:51], a[16:19], a[72:75], v[48:51]
ds_read_b128 v[132:135], v17 offset:576
v_mfma_f32_16x16x32_bf16 v[72:75], a[20:23], a[72:75], v[72:75]
ds_read_b128 v[136:139], v17 offset:128
v_mfma_f32_16x16x32_bf16 v[96:99], a[24:27], a[72:75], v[96:99]
ds_read_b128 v[140:143], v17 offset:640
v_mfma_f32_16x16x32_bf16 v[120:123], a[28:31], a[72:75], v[120:123]
ds_read_b128 v[144:147], v17 offset:192
v_mfma_f32_16x16x32_bf16 v[52:55], a[16:19], a[76:79], v[52:55]
ds_read_b128 v[148:151], v17 offset:704
v_mfma_f32_16x16x32_bf16 v[76:79], a[20:23], a[76:79], v[76:79]
v_mfma_f32_16x16x32_bf16 v[100:103], a[24:27], a[76:79], v[100:103]
v_mfma_f32_16x16x32_bf16 v[124:127], a[28:31], a[76:79], v[124:127]
v_mfma_f32_16x16x32_bf16 v[32:35], a[56:59], a[16:19], v[32:35]
v_mfma_f32_16x16x32_bf16 v[56:59], a[56:59], a[20:23], v[56:59]
v_mfma_f32_16x16x32_bf16 v[80:83], a[56:59], a[24:27], v[80:83]
v_mfma_f32_16x16x32_bf16 v[104:107], a[56:59], a[28:31], v[104:107]
v_mfma_f32_16x16x32_bf16 v[36:39], a[60:63], a[16:19], v[36:39]
v_mfma_f32_16x16x32_bf16 v[60:63], a[60:63], a[20:23], v[60:63]
v_mfma_f32_16x16x32_bf16 v[84:87], a[60:63], a[24:27], v[84:87]
v_mfma_f32_16x16x32_bf16 v[108:111], a[60:63], a[28:31], v[108:111]
s_waitcnt lgkmcnt(0)
v_readfirstlane_b32 s69, v19
v_pk_mul_f32 v[28:29], v[24:25], s[90:91]
v_pk_mul_f32 v[30:31], v[26:27], s[90:91]
v_pk_fma_f32 v[40:41], v[20:21], v[6:7], v[40:41] op_sel:[0,0,0] op_sel_hi:[1,0,1]
v_pk_fma_f32 v[44:45], v[20:21], v[8:9], v[44:45] op_sel:[0,0,0] op_sel_hi:[1,0,1]
v_pk_fma_f32 v[42:43], v[22:23], v[6:7], v[42:43] op_sel:[0,0,0] op_sel_hi:[1,0,1]
v_pk_fma_f32 v[46:47], v[22:23], v[8:9], v[46:47] op_sel:[0,0,0] op_sel_hi:[1,0,1]
v_pk_mul_f32 v[2:3], v[40:41], v[28:29]
v_pk_mul_f32 v[12:13], v[44:45], v[28:29]
v_pk_mul_f32 v[4:5], v[42:43], v[30:31]
v_pk_mul_f32 v[14:15], v[46:47], v[30:31]
v_pk_fma_f32 v[40:41], v[40:41], v[24:25], s[82:83]
v_pk_fma_f32 v[44:45], v[44:45], v[24:25], s[82:83]
v_pk_fma_f32 v[42:43], v[42:43], v[26:27], s[82:83]
v_pk_fma_f32 v[46:47], v[46:47], v[26:27], s[82:83]
v_exp_f32_e64 v2, v2 clamp
v_exp_f32_e64 v12, v12 clamp
v_exp_f32_e64 v3, v3 clamp
v_exp_f32_e64 v13, v13 clamp
v_exp_f32_e64 v4, v4 clamp
v_exp_f32_e64 v14, v14 clamp
v_exp_f32_e64 v5, v5 clamp
v_exp_f32_e64 v15, v15 clamp
v_pk_add_f32 v[2:3], v[2:3], s[80:81]
v_pk_add_f32 v[12:13], v[12:13], s[80:81]
v_pk_add_f32 v[4:5], v[4:5], s[80:81]
v_pk_add_f32 v[14:15], v[14:15], s[80:81]
v_max_f32 v40, v40, v2
v_max_f32 v44, v44, v12
v_max_f32 v41, v41, v3
v_max_f32 v45, v45, v13
v_max_f32 v42, v42, v4
v_max_f32 v46, v46, v14
v_max_f32 v43, v43, v5
v_max_f32 v47, v47, v15
v_cvt_pk_bf16_f32 v40, v40, v41
v_cvt_pk_bf16_f32 v44, v44, v45
v_cvt_pk_bf16_f32 v41, v42, v43
v_cvt_pk_bf16_f32 v45, v46, v47
v_pk_fma_f32 v[48:49], v[20:21], v[10:11], v[48:49] op_sel:[0,0,0] op_sel_hi:[1,0,1]
v_pk_fma_f32 v[52:53], v[20:21], v[18:19], v[52:53] op_sel:[0,0,0] op_sel_hi:[1,0,1]
v_pk_fma_f32 v[50:51], v[22:23], v[10:11], v[50:51] op_sel:[0,0,0] op_sel_hi:[1,0,1]
v_pk_fma_f32 v[54:55], v[22:23], v[18:19], v[54:55] op_sel:[0,0,0] op_sel_hi:[1,0,1]
v_pk_mul_f32 v[48:49], v[48:49], v[24:25]
v_pk_mul_f32 v[52:53], v[52:53], v[24:25]
v_pk_mul_f32 v[50:51], v[50:51], v[26:27]
v_pk_mul_f32 v[54:55], v[54:55], v[26:27]
v_cvt_pk_bf16_f32 v48, v48, v49
v_cvt_pk_bf16_f32 v52, v52, v53
v_cvt_pk_bf16_f32 v49, v50, v51
v_cvt_pk_bf16_f32 v53, v54, v55
v_pk_mul_f32 v[28:29], v[132:133], s[90:91]
v_pk_mul_f32 v[30:31], v[134:135], s[90:91]
v_pk_fma_f32 v[64:65], v[128:129], v[6:7], v[64:65] op_sel:[0,0,0] op_sel_hi:[1,0,1]
v_pk_fma_f32 v[68:69], v[128:129], v[8:9], v[68:69] op_sel:[0,0,0] op_sel_hi:[1,0,1]
v_pk_fma_f32 v[66:67], v[130:131], v[6:7], v[66:67] op_sel:[0,0,0] op_sel_hi:[1,0,1]
v_pk_fma_f32 v[70:71], v[130:131], v[8:9], v[70:71] op_sel:[0,0,0] op_sel_hi:[1,0,1]
v_pk_mul_f32 v[2:3], v[64:65], v[28:29]
v_pk_mul_f32 v[12:13], v[68:69], v[28:29]
v_pk_mul_f32 v[4:5], v[66:67], v[30:31]
v_pk_mul_f32 v[14:15], v[70:71], v[30:31]
v_pk_fma_f32 v[64:65], v[64:65], v[132:133], s[82:83]
v_pk_fma_f32 v[68:69], v[68:69], v[132:133], s[82:83]
v_pk_fma_f32 v[66:67], v[66:67], v[134:135], s[82:83]
v_pk_fma_f32 v[70:71], v[70:71], v[134:135], s[82:83]
v_exp_f32_e64 v2, v2 clamp
v_exp_f32_e64 v12, v12 clamp
v_exp_f32_e64 v3, v3 clamp
v_exp_f32_e64 v13, v13 clamp
v_exp_f32_e64 v4, v4 clamp
v_exp_f32_e64 v14, v14 clamp
v_exp_f32_e64 v5, v5 clamp
v_exp_f32_e64 v15, v15 clamp
v_pk_add_f32 v[2:3], v[2:3], s[80:81]
v_pk_add_f32 v[12:13], v[12:13], s[80:81]
v_pk_add_f32 v[4:5], v[4:5], s[80:81]
s_branch L_over5
L_pad5:
s_branch L_ret9
L_over5:
v_pk_add_f32 v[14:15], v[14:15], s[80:81]
v_max_f32 v64, v64, v2
v_max_f32 v68, v68, v12
v_max_f32 v65, v65, v3
v_max_f32 v69, v69, v13
v_max_f32 v66, v66, v4
v_max_f32 v70, v70, v14
v_max_f32 v67, v67, v5
v_max_f32 v71, v71, v15
v_cvt_pk_bf16_f32 v42, v64, v65
v_cvt_pk_bf16_f32 v46, v68, v69
v_cvt_pk_bf16_f32 v43, v66, v67
v_cvt_pk_bf16_f32 v47, v70, v71
v_pk_fma_f32 v[72:73], v[128:129], v[10:11], v[72:73] op_sel:[0,0,0] op_sel_hi:[1,0,1]
v_pk_fma_f32 v[76:77], v[128:129], v[18:19], v[76:77] op_sel:[0,0,0] op_sel_hi:[1,0,1]
v_pk_fma_f32 v[74:75], v[130:131], v[10:11], v[74:75] op_sel:[0,0,0] op_sel_hi:[1,0,1]
v_pk_fma_f32 v[78:79], v[130:131], v[18:19], v[78:79] op_sel:[0,0,0] op_sel_hi:[1,0,1]
v_pk_mul_f32 v[72:73], v[72:73], v[132:133]
v_pk_mul_f32 v[76:77], v[76:77], v[132:133]
v_pk_mul_f32 v[74:75], v[74:75], v[134:135]
v_pk_mul_f32 v[78:79], v[78:79], v[134:135]
v_cvt_pk_bf16_f32 v50, v72, v73
v_cvt_pk_bf16_f32 v54, v76, v77
v_cvt_pk_bf16_f32 v51, v74, v75
v_cvt_pk_bf16_f32 v55, v78, v79
s_nop 0
v_mfma_f32_16x16x32_bf16 v[64:67], v[40:43], v[48:51], 0
v_mfma_f32_16x16x32_bf16 v[68:71], v[40:43], v[52:55], 0
v_mfma_f32_16x16x32_bf16 v[20:23], v[40:43], a[80:83], 0
v_mfma_f32_16x16x32_bf16 v[72:75], v[44:47], v[48:51], 0
v_mfma_f32_16x16x32_bf16 v[76:79], v[44:47], v[52:55], 0
v_mfma_f32_16x16x32_bf16 v[24:27], v[44:47], a[80:83], 0
v_pk_mul_f32 v[28:29], v[140:141], s[90:91]
v_pk_mul_f32 v[30:31], v[142:143], s[90:91]
v_pk_fma_f32 v[88:89], v[136:137], v[6:7], v[88:89] op_sel:[0,0,0] op_sel_hi:[1,0,1]
v_pk_fma_f32 v[92:93], v[136:137], v[8:9], v[92:93] op_sel:[0,0,0] op_sel_hi:[1,0,1]
v_pk_fma_f32 v[90:91], v[138:139], v[6:7], v[90:91] op_sel:[0,0,0] op_sel_hi:[1,0,1]
v_pk_fma_f32 v[94:95], v[138:139], v[8:9], v[94:95] op_sel:[0,0,0] op_sel_hi:[1,0,1]
v_pk_mul_f32 v[2:3], v[88:89], v[28:29]
v_pk_mul_f32 v[12:13], v[92:93], v[28:29]
v_pk_mul_f32 v[4:5], v[90:91], v[30:31]
v_pk_mul_f32 v[14:15], v[94:95], v[30:31]
v_pk_fma_f32 v[88:89], v[88:89], v[140:141], s[82:83]
v_pk_fma_f32 v[92:93], v[92:93], v[140:141], s[82:83]
v_pk_fma_f32 v[90:91], v[90:91], v[142:143], s[82:83]
v_pk_fma_f32 v[94:95], v[94:95], v[142:143], s[82:83]
v_exp_f32_e64 v2, v2 clamp
v_exp_f32_e64 v12, v12 clamp
v_exp_f32_e64 v3, v3 clamp
v_exp_f32_e64 v13, v13 clamp
v_exp_f32_e64 v4, v4 clamp
v_exp_f32_e64 v14, v14 clamp
v_exp_f32_e64 v5, v5 clamp
v_exp_f32_e64 v15, v15 clamp
v_pk_add_f32 v[2:3], v[2:3], s[80:81]
v_pk_add_f32 v[12:13], v[12:13], s[80:81]
v_pk_add_f32 v[4:5], v[4:5], s[80:81]
v_pk_add_f32 v[14:15], v[14:15], s[80:81]
v_max_f32 v88, v88, v2
v_max_f32 v92, v92, v12
v_max_f32 v89, v89, v3
v_max_f32 v93, v93, v13
v_max_f32 v90, v90, v4
v_max_f32 v94, v94, v14
v_max_f32 v91, v91, v5
v_max_f32 v95, v95, v15
v_cvt_pk_bf16_f32 v88, v88, v89
v_cvt_pk_bf16_f32 v92, v92, v93
v_cvt_pk_bf16_f32 v89, v90, v91
v_cvt_pk_bf16_f32 v93, v94, v95
v_pk_fma_f32 v[96:97], v[136:137], v[10:11], v[96:97] op_sel:[0,0,0] op_sel_hi:[1,0,1]
v_pk_fma_f32 v[100:101], v[136:137], v[18:19], v[100:101] op_sel:[0,0,0] op_sel_hi:[1,0,1]
v_pk_fma_f32 v[98:99], v[138:139], v[10:11], v[98:99] op_sel:[0,0,0] op_sel_hi:[1,0,1]
v_pk_fma_f32 v[102:103], v[138:139], v[18:19], v[102:103] op_sel:[0,0,0] op_sel_hi:[1,0,1]
v_pk_mul_f32 v[96:97], v[96:97], v[140:141]
v_pk_mul_f32 v[100:101], v[100:101], v[140:141]
v_pk_mul_f32 v[98:99], v[98:99], v[142:143]
v_pk_mul_f32 v[102:103], v[102:103], v[142:143]
v_cvt_pk_bf16_f32 v96, v96, v97
v_cvt_pk_bf16_f32 v100, v100, v101
v_cvt_pk_bf16_f32 v97, v98, v99
v_cvt_pk_bf16_f32 v101, v102, v103
v_pk_mul_f32 v[28:29], v[148:149], s[90:91]
v_pk_mul_f32 v[30:31], v[150:151], s[90:91]
v_pk_fma_f32 v[112:113], v[144:145], v[6:7], v[112:113] op_sel:[0,0,0] op_sel_hi:[1,0,1]
v_pk_fma_f32 v[116:117], v[144:145], v[8:9], v[116:117] op_sel:[0,0,0] op_sel_hi:[1,0,1]
v_pk_fma_f32 v[114:115], v[146:147], v[6:7], v[114:115] op_sel:[0,0,0] op_sel_hi:[1,0,1]
v_pk_fma_f32 v[118:119], v[146:147], v[8:9], v[118:119] op_sel:[0,0,0] op_sel_hi:[1,0,1]
v_pk_mul_f32 v[2:3], v[112:113], v[28:29]
v_pk_mul_f32 v[12:13], v[116:117], v[28:29]
v_pk_mul_f32 v[4:5], v[114:115], v[30:31]
v_pk_mul_f32 v[14:15], v[118:119], v[30:31]
v_pk_fma_f32 v[112:113], v[112:113], v[148:149], s[82:83]
v_pk_fma_f32 v[116:117], v[116:117], v[148:149], s[82:83]
v_pk_fma_f32 v[114:115], v[114:115], v[150:151], s[82:83]
v_pk_fma_f32 v[118:119], v[118:119], v[150:151], s[82:83]
v_exp_f32_e64 v2, v2 clamp
v_exp_f32_e64 v12, v12 clamp
v_exp_f32_e64 v3, v3 clamp
v_exp_f32_e64 v13, v13 clamp
v_exp_f32_e64 v4, v4 clamp
v_exp_f32_e64 v14, v14 clamp
v_exp_f32_e64 v5, v5 clamp
v_exp_f32_e64 v15, v15 clamp
v_pk_add_f32 v[2:3], v[2:3], s[80:81]
v_pk_add_f32 v[12:13], v[12:13], s[80:81]
v_pk_add_f32 v[4:5], v[4:5], s[80:81]
v_pk_add_f32 v[14:15], v[14:15], s[80:81]
v_max_f32 v112, v112, v2
v_max_f32 v116, v116, v12
v_max_f32 v113, v113, v3
v_max_f32 v117, v117, v13
v_max_f32 v114, v114, v4
v_max_f32 v118, v118, v14
v_max_f32 v115, v115, v5
v_max_f32 v119, v119, v15
v_cvt_pk_bf16_f32 v90, v112, v113
v_cvt_pk_bf16_f32 v94, v116, v117
v_cvt_pk_bf16_f32 v91, v114, v115
v_cvt_pk_bf16_f32 v95, v118, v119
v_pk_fma_f32 v[120:121], v[144:145], v[10:11], v[120:121] op_sel:[0,0,0] op_sel_hi:[1,0,1]
v_pk_fma_f32 v[124:125], v[144:145], v[18:19], v[124:125] op_sel:[0,0,0] op_sel_hi:[1,0,1]
v_pk_fma_f32 v[122:123], v[146:147], v[10:11], v[122:123] op_sel:[0,0,0] op_sel_hi:[1,0,1]
v_pk_fma_f32 v[126:127], v[146:147], v[18:19], v[126:127] op_sel:[0,0,0] op_sel_hi:[1,0,1]
v_pk_mul_f32 v[120:121], v[120:121], v[148:149]
v_pk_mul_f32 v[124:125], v[124:125], v[148:149]
v_pk_mul_f32 v[122:123], v[122:123], v[150:151]
v_pk_mul_f32 v[126:127], v[126:127], v[150:151]
v_cvt_pk_bf16_f32 v98, v120, v121
v_cvt_pk_bf16_f32 v102, v124, v125
v_cvt_pk_bf16_f32 v99, v122, v123
v_cvt_pk_bf16_f32 v103, v126, v127
s_nop 0
v_mfma_f32_16x16x32_bf16 v[64:67], v[88:91], v[96:99], v[64:67]
v_mfma_f32_16x16x32_bf16 v[68:71], v[88:91], v[100:103], v[68:71]
v_mfma_f32_16x16x32_bf16 v[20:23], v[88:91], a[80:83], v[20:23]
v_mfma_f32_16x16x32_bf16 v[72:75], v[92:95], v[96:99], v[72:75]
v_mfma_f32_16x16x32_bf16 v[76:79], v[92:95], v[100:103], v[76:79]
v_mfma_f32_16x16x32_bf16 v[24:27], v[92:95], a[80:83], v[24:27]
s_lshl_b32 s70, s60, 11
s_add_u32 s70, s70, 16384
v_add_u32 v2, s70, v16
v_xor_b32 v3, 4096, v2
v_lshrrev_b32 v4, 4, v1
v_lshlrev_b32 v5, 4, v4
v_lshlrev_b32 v4, 5, v4
s_lshl_b32 s70, s60, 6
s_add_u32 s70, s70, 163584
v_add_u32 v5, s70, v5
v_xor_b32 v6, 128, v5
s_lshl_b32 s72, s67, 1
s_add_u32 s72, s72, s66
s_lshl_b32 s72, s72, 10
s_add_u32 s72, s72, s87
s_lshl_b32 s73, s67, 7
s_lshl_b32 s70, s66, 4
s_add_u32 s73, s73, s70
s_add_u32 s73, s73, s87
s_add_u32 s73, s73, 4096
s_mov_b32 s92, 0x00010001
s_mov_b32 s93, 0x00010001
v_mov_b32 v15, s68
s_cmp_eq_u32 s66, 0
s_cbranch_scc0 L_ex1
ds_write_b128 v2, v[68:71]
ds_write_b128 v2, v[76:79] offset:1024
ds_write_b128 v5, v[24:27]
s_waitcnt lgkmcnt(0)
s_barrier
ds_read_b128 v[128:131], v3
ds_read_b128 v[132:135], v3 offset:1024
ds_read_b128 v[136:139], v6
s_waitcnt lgkmcnt(1)
v_pk_add_f32 v[128:129], v[128:129], v[64:65]
v_pk_add_f32 v[130:131], v[130:131], v[66:67]
v_pk_add_f32 v[132:133], v[132:133], v[72:73]
v_pk_add_f32 v[134:135], v[134:135], v[74:75]
s_waitcnt lgkmcnt(0)
v_pk_add_f32 v[136:137], v[136:137], v[20:21]
v_pk_add_f32 v[138:139], v[138:139], v[22:23]
s_branch L_ex_d
L_ex1:
ds_write_b128 v2, v[64:67]
ds_write_b128 v2, v[72:75] offset:1024
ds_write_b128 v5, v[20:23]
s_waitcnt lgkmcnt(0)
s_barrier
ds_read_b128 v[128:131], v3
ds_read_b128 v[132:135], v3 offset:1024
ds_read_b128 v[136:139], v6
s_waitcnt lgkmcnt(1)
v_pk_add_f32 v[128:129], v[128:129], v[68:69]
v_pk_add_f32 v[130:131], v[130:131], v[70:71]
v_pk_add_f32 v[132:133], v[132:133], v[76:77]
v_pk_add_f32 v[134:135], v[134:135], v[78:79]
s_waitcnt lgkmcnt(0)
v_pk_add_f32 v[136:137], v[136:137], v[24:25]
v_pk_add_f32 v[138:139], v[138:139], v[26:27]
L_ex_d:
v_cvt_pk_bf16_f32 v140, v128, v129
v_cvt_pk_bf16_f32 v141, v130, v131
v_cvt_pk_bf16_f32 v142, v132, v133
v_cvt_pk_bf16_f32 v143, v134, v135
v_bfi_b32 v136, s85, v15, v136
v_bfi_b32 v137, s85, v15, v137
v_bfi_b32 v138, s85, v15, v138
v_bfi_b32 v139, s85, v15, v139
s_cmp_eq_u32 s69, 0
s_cbranch_scc1 L_kvp_s
buffer_store_dwordx4 v[140:143], v16, s[12:15], s72 offen
s_mov_b64 exec, s[92:93]
buffer_store_dwordx4 v[136:139], v4, s[12:15], s73 offen
s_mov_b64 exec, -1
L_kvp_d:
s_barrier
v_and_b32 v2, 15, v1
v_lshlrev_b32 v2, 2, v2
s_lshl_b32 s70, s66, 8
s_add_u32 s70, s70, 159744
v_add_u32 v2, s70, v2
v_lshrrev_b32 v3, 4, v1
v_lshlrev_b32 v3, 4, v3
s_lshl_b32 s70, s67, 7
s_add_u32 s70, s70, 160768
v_add_u32 v5, s70, v3
ds_read_b32 v8, v2 offset:0
ds_read_b32 v128, v2 offset:512
ds_read_b32 v10, v2 offset:64
ds_read_b32 v130, v2 offset:576
ds_read_b32 v12, v2 offset:128
ds_read_b32 v132, v2 offset:640
ds_read_b32 v14, v2 offset:192
ds_read_b32 v134, v2 offset:704
ds_read_b128 v[144:147], v5 offset:0
ds_read_b128 v[148:151], v5 offset:64
s_lshl_b32 s70, s67, 11
s_add_u32 s70, s70, 24576
v_add_u32 v17, s70, v16
s_lshl_b32 s70, s67, 6
s_add_u32 s70, s70, 161600
v_add_u32 v18, s70, v3
s_waitcnt lgkmcnt(0)
v_mul_f32 v20, s90, v128
v_mul_f32 v22, s90, v130
v_mul_f32 v4, s90, v132
v_mul_f32 v6, s90, v134
v_pk_fma_f32 v[32:33], v[144:145], v[8:9], v[32:33] op_sel:[0,0,0] op_sel_hi:[1,0,1]
v_pk_fma_f32 v[36:37], v[148:149], v[8:9], v[36:37] op_sel:[0,0,0] op_sel_hi:[1,0,1]
v_pk_fma_f32 v[34:35], v[146:147], v[8:9], v[34:35] op_sel:[0,0,0] op_sel_hi:[1,0,1]
v_pk_fma_f32 v[38:39], v[150:151], v[8:9], v[38:39] op_sel:[0,0,0] op_sel_hi:[1,0,1]
v_pk_mul_f32 v[24:25], v[32:33], v[20:21] op_sel:[0,0] op_sel_hi:[1,0]
v_pk_mul_f32 v[28:29], v[36:37], v[20:21] op_sel:[0,0] op_sel_hi:[1,0]
v_pk_mul_f32 v[26:27], v[34:35], v[20:21] op_sel:[0,0] op_sel_hi:[1,0]
v_pk_mul_f32 v[30:31], v[38:39], v[20:21] op_sel:[0,0] op_sel_hi:[1,0]
v_pk_fma_f32 v[32:33], v[32:33], v[128:129], s[82:83] op_sel:[0,0,0] op_sel_hi:[1,0,1]
v_pk_fma_f32 v[36:37], v[36:37], v[128:129], s[82:83] op_sel:[0,0,0] op_sel_hi:[1,0,1]
v_pk_fma_f32 v[34:35], v[34:35], v[128:129], s[82:83] op_sel:[0,0,0] op_sel_hi:[1,0,1]
v_pk_fma_f32 v[38:39], v[38:39], v[128:129], s[82:83] op_sel:[0,0,0] op_sel_hi:[1,0,1]
v_exp_f32_e64 v24, v24 clamp
v_exp_f32_e64 v28, v28 clamp
v_exp_f32_e64 v25, v25 clamp
v_exp_f32_e64 v29, v29 clamp
v_exp_f32_e64 v26, v26 clamp
v_exp_f32_e64 v30, v30 clamp
v_exp_f32_e64 v27, v27 clamp
v_exp_f32_e64 v31, v31 clamp
v_pk_add_f32 v[24:25], v[24:25], s[80:81]
v_pk_add_f32 v[28:29], v[28:29], s[80:81]
v_pk_add_f32 v[26:27], v[26:27], s[80:81]
v_pk_add_f32 v[30:31], v[30:31], s[80:81]
v_max_f32 v32, v32, v24
v_max_f32 v36, v36, v28
v_max_f32 v33, v33, v25
v_max_f32 v37, v37, v29
v_max_f32 v34, v34, v26
v_max_f32 v38, v38, v30
v_max_f32 v35, v35, v27
v_max_f32 v39, v39, v31
v_cvt_pk_bf16_f32 v32, v32, v33
v_cvt_pk_bf16_f32 v33, v34, v35
v_cvt_pk_bf16_f32 v34, v36, v37
v_cvt_pk_bf16_f32 v35, v38, v39
v_pk_fma_f32 v[56:57], v[144:145], v[10:11], v[56:57] op_sel:[0,0,0] op_sel_hi:[1,0,1]
v_pk_fma_f32 v[60:61], v[148:149], v[10:11], v[60:61] op_sel:[0,0,0] op_sel_hi:[1,0,1]
v_pk_fma_f32 v[58:59], v[146:147], v[10:11], v[58:59] op_sel:[0,0,0] op_sel_hi:[1,0,1]
v_pk_fma_f32 v[62:63], v[150:151], v[10:11], v[62:63] op_sel:[0,0,0] op_sel_hi:[1,0,1]
v_pk_mul_f32 v[24:25], v[56:57], v[22:23] op_sel:[0,0] op_sel_hi:[1,0]
v_pk_mul_f32 v[28:29], v[60:61], v[22:23] op_sel:[0,0] op_sel_hi:[1,0]
v_pk_mul_f32 v[26:27], v[58:59], v[22:23] op_sel:[0,0] op_sel_hi:[1,0]
v_pk_mul_f32 v[30:31], v[62:63], v[22:23] op_sel:[0,0] op_sel_hi:[1,0]
v_pk_fma_f32 v[56:57], v[56:57], v[130:131], s[82:83] op_sel:[0,0,0] op_sel_hi:[1,0,1]
v_pk_fma_f32 v[60:61], v[60:61], v[130:131], s[82:83] op_sel:[0,0,0] op_sel_hi:[1,0,1]
v_pk_fma_f32 v[58:59], v[58:59], v[130:131], s[82:83] op_sel:[0,0,0] op_sel_hi:[1,0,1]
v_pk_fma_f32 v[62:63], v[62:63], v[130:131], s[82:83] op_sel:[0,0,0] op_sel_hi:[1,0,1]
v_exp_f32_e64 v24, v24 clamp
v_exp_f32_e64 v28, v28 clamp
v_exp_f32_e64 v25, v25 clamp
v_exp_f32_e64 v29, v29 clamp
v_exp_f32_e64 v26, v26 clamp
v_exp_f32_e64 v30, v30 clamp
v_exp_f32_e64 v27, v27 clamp
v_exp_f32_e64 v31, v31 clamp
v_pk_add_f32 v[24:25], v[24:25], s[80:81]
v_pk_add_f32 v[28:29], v[28:29], s[80:81]
v_pk_add_f32 v[26:27], v[26:27], s[80:81]
v_pk_add_f32 v[30:31], v[30:31], s[80:81]
v_max_f32 v56, v56, v24
v_max_f32 v60, v60, v28
v_max_f32 v57, v57, v25
v_max_f32 v61, v61, v29
v_max_f32 v58, v58, v26
v_max_f32 v62, v62, v30
v_max_f32 v59, v59, v27
v_max_f32 v63, v63, v31
v_cvt_pk_bf16_f32 v56, v56, v57
v_cvt_pk_bf16_f32 v57, v58, v59
v_cvt_pk_bf16_f32 v58, v60, v61
v_cvt_pk_bf16_f32 v59, v62, v63
v_pk_fma_f32 v[80:81], v[144:145], v[12:13], v[80:81] op_sel:[0,0,0] op_sel_hi:[1,0,1]
v_pk_fma_f32 v[84:85], v[148:149], v[12:13], v[84:85] op_sel:[0,0,0] op_sel_hi:[1,0,1]
v_pk_fma_f32 v[82:83], v[146:147], v[12:13], v[82:83] op_sel:[0,0,0] op_sel_hi:[1,0,1]
v_pk_fma_f32 v[86:87], v[150:151], v[12:13], v[86:87] op_sel:[0,0,0] op_sel_hi:[1,0,1]
v_pk_mul_f32 v[24:25], v[80:81], v[4:5] op_sel:[0,0] op_sel_hi:[1,0]
v_pk_mul_f32 v[28:29], v[84:85], v[4:5] op_sel:[0,0] op_sel_hi:[1,0]
v_pk_mul_f32 v[26:27], v[82:83], v[4:5] op_sel:[0,0] op_sel_hi:[1,0]
v_pk_mul_f32 v[30:31], v[86:87], v[4:5] op_sel:[0,0] op_sel_hi:[1,0]
v_pk_fma_f32 v[80:81], v[80:81], v[132:133], s[82:83] op_sel:[0,0,0] op_sel_hi:[1,0,1]
v_pk_fma_f32 v[84:85], v[84:85], v[132:133], s[82:83] op_sel:[0,0,0] op_sel_hi:[1,0,1]
v_pk_fma_f32 v[82:83], v[82:83], v[132:133], s[82:83] op_sel:[0,0,0] op_sel_hi:[1,0,1]
v_pk_fma_f32 v[86:87], v[86:87], v[132:133], s[82:83] op_sel:[0,0,0] op_sel_hi:[1,0,1]
v_exp_f32_e64 v24, v24 clamp
v_exp_f32_e64 v28, v28 clamp
v_exp_f32_e64 v25, v25 clamp
v_exp_f32_e64 v29, v29 clamp
v_exp_f32_e64 v26, v26 clamp
v_exp_f32_e64 v30, v30 clamp
v_exp_f32_e64 v27, v27 clamp
v_exp_f32_e64 v31, v31 clamp
v_pk_add_f32 v[24:25], v[24:25], s[80:81]
v_pk_add_f32 v[28:29], v[28:29], s[80:81]
v_pk_add_f32 v[26:27], v[26:27], s[80:81]
v_pk_add_f32 v[30:31], v[30:31], s[80:81]
v_max_f32 v80, v80, v24
v_max_f32 v84, v84, v28
v_max_f32 v81, v81, v25
v_max_f32 v85, v85, v29
v_max_f32 v82, v82, v26
v_max_f32 v86, v86, v30
v_max_f32 v83, v83, v27
v_max_f32 v87, v87, v31
v_cvt_pk_bf16_f32 v80, v80, v81
v_cvt_pk_bf16_f32 v81, v82, v83
v_cvt_pk_bf16_f32 v82, v84, v85
v_cvt_pk_bf16_f32 v83, v86, v87
v_pk_fma_f32 v[104:105], v[144:145], v[14:15], v[104:105] op_sel:[0,0,0] op_sel_hi:[1,0,1]
v_pk_fma_f32 v[108:109], v[148:149], v[14:15], v[108:109] op_sel:[0,0,0] op_sel_hi:[1,0,1]
v_pk_fma_f32 v[106:107], v[146:147], v[14:15], v[106:107] op_sel:[0,0,0] op_sel_hi:[1,0,1]
v_pk_fma_f32 v[110:111], v[150:151], v[14:15], v[110:111] op_sel:[0,0,0] op_sel_hi:[1,0,1]
v_pk_mul_f32 v[24:25], v[104:105], v[6:7] op_sel:[0,0] op_sel_hi:[1,0]
v_pk_mul_f32 v[28:29], v[108:109], v[6:7] op_sel:[0,0] op_sel_hi:[1,0]
v_pk_mul_f32 v[26:27], v[106:107], v[6:7] op_sel:[0,0] op_sel_hi:[1,0]
v_pk_mul_f32 v[30:31], v[110:111], v[6:7] op_sel:[0,0] op_sel_hi:[1,0]
v_pk_fma_f32 v[104:105], v[104:105], v[134:135], s[82:83] op_sel:[0,0,0] op_sel_hi:[1,0,1]
v_pk_fma_f32 v[108:109], v[108:109], v[134:135], s[82:83] op_sel:[0,0,0] op_sel_hi:[1,0,1]
v_pk_fma_f32 v[106:107], v[106:107], v[134:135], s[82:83] op_sel:[0,0,0] op_sel_hi:[1,0,1]
v_pk_fma_f32 v[110:111], v[110:111], v[134:135], s[82:83] op_sel:[0,0,0] op_sel_hi:[1,0,1]
v_exp_f32_e64 v24, v24 clamp
v_exp_f32_e64 v28, v28 clamp
v_exp_f32_e64 v25, v25 clamp
v_exp_f32_e64 v29, v29 clamp
v_exp_f32_e64 v26, v26 clamp
v_exp_f32_e64 v30, v30 clamp
v_exp_f32_e64 v27, v27 clamp
v_exp_f32_e64 v31, v31 clamp
v_pk_add_f32 v[24:25], v[24:25], s[80:81]
v_pk_add_f32 v[28:29], v[28:29], s[80:81]
v_pk_add_f32 v[26:27], v[26:27], s[80:81]
v_pk_add_f32 v[30:31], v[30:31], s[80:81]
v_max_f32 v104, v104, v24
v_max_f32 v108, v108, v28
v_max_f32 v105, v105, v25
v_max_f32 v109, v109, v29
v_max_f32 v106, v106, v26
v_max_f32 v110, v110, v30
v_max_f32 v107, v107, v27
v_max_f32 v111, v111, v31
v_cvt_pk_bf16_f32 v104, v104, v105
v_cvt_pk_bf16_f32 v105, v106, v107
v_cvt_pk_bf16_f32 v106, v108, v109
v_cvt_pk_bf16_f32 v107, v110, v111
v_lshrrev_b32 v2, 4, v1
v_bfe_u32 v3, v1, 2, 2
v_lshl_add_u32 v4, v2, 2, v3
v_lshlrev_b32 v5, 7, v4
v_bfe_u32 v4, v4, 1, 2
v_lshl_add_u32 v5, v4, 5, v5
v_and_b32 v4, 3, v1
v_lshl_add_u32 v5, v4, 3, v5
v_add_u32 v8, 28672, v5
v_xor_b32 v9, 32, v8
v_xor_b32 v10, 64, v8
v_xor_b32 v11, 96, v8
v_add_u32 v12, 65536, v8
v_add_u32 v13, 65536, v9
v_add_u32 v14, 65536, v10
v_add_u32 v15, 65536, v11
v_and_b32 v3, 15, v1
v_lshrrev_b32 v4, 1, v3
v_lshrrev_b32 v5, 1, v2
v_xor_b32 v4, v4, v5
v_lshlrev_b32 v4, 4, v4
v_lshl_add_u32 v4, v3, 7, v4
v_and_b32 v5, 1, v2
v_lshl_add_u32 v4, v5, 3, v4
s_lshl_b32 s70, s60, 12
v_add_u32 v20, s70, v4
v_xor_b32 v21, 32, v20
v_xor_b32 v22, 64, v20
v_xor_b32 v23, 96, v20
s_lshl_b32 s74, s64, 18
s_lshl_b32 s70, s60, 16
s_add_u32 s74, s74, s70
s_add_u32 s74, s74, 2097152
v_add_u32 v6, s74, v16
v_add_u32 v19, 32768, v6
s_lshl_b32 s74, s89, 11
s_mov_b32 s24, s74
s_add_u32 s25, s24, 2048
s_and_b32 s25, s25, 0x7fff
s_add_u32 s26, s25, 2048
s_and_b32 s26, s26, 0x7fff
s_add_u32 s27, s26, 2048
s_and_b32 s27, s27, 0x7fff
s_add_u32 s28, s27, 2048
s_and_b32 s28, s28, 0x7fff
s_add_u32 s29, s28, 2048
s_and_b32 s29, s29, 0x7fff
s_add_u32 s30, s29, 2048
s_and_b32 s30, s30, 0x7fff
s_add_u32 s31, s30, 2048
s_and_b32 s31, s31, 0x7fff
s_add_u32 s32, s31, 2048
s_and_b32 s32, s32, 0x7fff
s_add_u32 s33, s32, 2048
s_and_b32 s33, s33, 0x7fff
s_add_u32 s34, s33, 2048
s_and_b32 s34, s34, 0x7fff
s_add_u32 s35, s34, 2048
s_and_b32 s35, s35, 0x7fff
s_add_u32 s36, s35, 2048
s_and_b32 s36, s36, 0x7fff
s_add_u32 s37, s36, 2048
s_and_b32 s37, s37, 0x7fff
s_add_u32 s38, s37, 2048
s_and_b32 s38, s38, 0x7fff
s_add_u32 s39, s38, 2048
s_and_b32 s39, s39, 0x7fff
s_barrier
ds_read_b128 a[0:3], v17
ds_read_b128 a[4:7], v17 offset:1024
ds_read_b128 a[8:11], v18
s_waitcnt lgkmcnt(0)
v_mfma_f32_16x16x32_bf16 v[48:51], a[8:11], v[32:35], 0
v_mfma_f32_16x16x32_bf16 v[40:43], a[0:3], v[32:35], 0
v_mfma_f32_16x16x32_bf16 v[44:47], a[4:7], v[32:35], 0
v_mfma_f32_16x16x32_bf16 v[72:75], a[8:11], v[56:59], 0
v_mfma_f32_16x16x32_bf16 v[64:67], a[0:3], v[56:59], 0
v_mfma_f32_16x16x32_bf16 v[68:71], a[4:7], v[56:59], 0
v_mfma_f32_16x16x32_bf16 v[96:99], a[8:11], v[80:83], 0
v_mfma_f32_16x16x32_bf16 v[88:91], a[0:3], v[80:83], 0
v_mfma_f32_16x16x32_bf16 v[92:95], a[4:7], v[80:83], 0
v_mfma_f32_16x16x32_bf16 v[120:123], a[8:11], v[104:107], 0
v_mfma_f32_16x16x32_bf16 v[112:115], a[0:3], v[104:107], 0
v_mfma_f32_16x16x32_bf16 v[116:119], a[4:7], v[104:107], 0
v_add_f32 v48, s80, v48
v_rcp_f32 v48, v48
s_nop 0
v_pk_mul_f32 v[40:41], v[40:41], v[48:49] op_sel_hi:[1,0]
v_pk_mul_f32 v[42:43], v[42:43], v[48:49] op_sel_hi:[1,0]
v_pk_mul_f32 v[44:45], v[44:45], v[48:49] op_sel_hi:[1,0]
v_pk_mul_f32 v[46:47], v[46:47], v[48:49] op_sel_hi:[1,0]
v_cvt_pk_bf16_f32 v52, v40, v41
v_cvt_pk_bf16_f32 v53, v42, v43
v_cvt_pk_bf16_f32 v54, v44, v45
v_cvt_pk_bf16_f32 v55, v46, v47
s_add_u32 s70, s88, 0
buffer_store_dwordx4 v[52:55], v16, s[12:15], s70 offen sc1
v_add_f32 v72, s80, v72
v_rcp_f32 v72, v72
s_nop 0
v_pk_mul_f32 v[64:65], v[64:65], v[72:73] op_sel_hi:[1,0]
v_pk_mul_f32 v[66:67], v[66:67], v[72:73] op_sel_hi:[1,0]
v_pk_mul_f32 v[68:69], v[68:69], v[72:73] op_sel_hi:[1,0]
v_pk_mul_f32 v[70:71], v[70:71], v[72:73] op_sel_hi:[1,0]
v_cvt_pk_bf16_f32 v76, v64, v65
v_cvt_pk_bf16_f32 v77, v66, v67
v_cvt_pk_bf16_f32 v78, v68, v69
v_cvt_pk_bf16_f32 v79, v70, v71
s_add_u32 s70, s88, 32768
buffer_store_dwordx4 v[76:79], v16, s[12:15], s70 offen sc1
v_add_f32 v96, s80, v96
v_rcp_f32 v96, v96
s_nop 0
v_pk_mul_f32 v[88:89], v[88:89], v[96:97] op_sel_hi:[1,0]
v_pk_mul_f32 v[90:91], v[90:91], v[96:97] op_sel_hi:[1,0]
v_pk_mul_f32 v[92:93], v[92:93], v[96:97] op_sel_hi:[1,0]
v_pk_mul_f32 v[94:95], v[94:95], v[96:97] op_sel_hi:[1,0]
v_cvt_pk_bf16_f32 v100, v88, v89
v_cvt_pk_bf16_f32 v101, v90, v91
v_cvt_pk_bf16_f32 v102, v92, v93
v_cvt_pk_bf16_f32 v103, v94, v95
s_add_u32 s70, s88, 65536
buffer_store_dwordx4 v[100:103], v16, s[12:15], s70 offen sc1
v_add_f32 v120, s80, v120
v_rcp_f32 v120, v120
s_nop 0
v_pk_mul_f32 v[112:113], v[112:113], v[120:121] op_sel_hi:[1,0]
v_pk_mul_f32 v[114:115], v[114:115], v[120:121] op_sel_hi:[1,0]
v_pk_mul_f32 v[116:117], v[116:117], v[120:121] op_sel_hi:[1,0]
v_pk_mul_f32 v[118:119], v[118:119], v[120:121] op_sel_hi:[1,0]
v_cvt_pk_bf16_f32 v124, v112, v113
v_cvt_pk_bf16_f32 v125, v114, v115
v_cvt_pk_bf16_f32 v126, v116, v117
v_cvt_pk_bf16_f32 v127, v118, v119
s_add_u32 s70, s88, 98304
buffer_store_dwordx4 v[124:127], v16, s[12:15], s70 offen sc1
v_xor_b32 v7, s76, v7
ds_read_b64 v[26:27], v20 offset:0
ds_read_b64 v[30:31], v21 offset:0
ds_read_b64 v[34:35], v22 offset:0
ds_read_b64 v[38:39], v23 offset:0
ds_read_b64 v[42:43], v20 offset:2048
ds_read_b64 v[46:47], v21 offset:2048
ds_read_b64 v[50:51], v22 offset:2048
ds_read_b64 v[54:55], v23 offset:2048
s_waitcnt lgkmcnt(0)
ds_read_b64_tr_b16 a[0:1], v8 offset:0
ds_read_b64_tr_b16 a[2:3], v8 offset:2048
ds_read_b64_tr_b16 a[4:5], v9 offset:0
ds_read_b64_tr_b16 a[6:7], v9 offset:2048
ds_read_b64_tr_b16 a[8:9], v10 offset:0
ds_read_b64_tr_b16 a[10:11], v10 offset:2048
ds_read_b64_tr_b16 a[12:13], v11 offset:0
ds_read_b64_tr_b16 a[14:15], v11 offset:2048
ds_read_b64_tr_b16 a[16:17], v8 offset:4096
ds_read_b64_tr_b16 a[18:19], v8 offset:6144
ds_read_b64_tr_b16 a[20:21], v9 offset:4096
ds_read_b64_tr_b16 a[22:23], v9 offset:6144
ds_read_b64_tr_b16 a[24:25], v10 offset:4096
ds_read_b64_tr_b16 a[26:27], v10 offset:6144
ds_read_b64_tr_b16 a[28:29], v11 offset:4096
ds_read_b64_tr_b16 a[30:31], v11 offset:6144
v_lshlrev_b32 v24, 16, v26
v_and_b32 v25, 0xffff0000, v26
v_lshlrev_b32 v26, 16, v27
v_and_b32 v27, 0xffff0000, v27
v_lshlrev_b32 v28, 16, v30
v_and_b32 v29, 0xffff0000, v30
v_lshlrev_b32 v30, 16, v31
v_and_b32 v31, 0xffff0000, v31
v_lshlrev_b32 v32, 16, v34
v_and_b32 v33, 0xffff0000, v34
v_lshlrev_b32 v34, 16, v35
v_and_b32 v35, 0xffff0000, v35
v_lshlrev_b32 v36, 16, v38
v_and_b32 v37, 0xffff0000, v38
v_lshlrev_b32 v38, 16, v39
v_and_b32 v39, 0xffff0000, v39
v_lshlrev_b32 v40, 16, v42
v_and_b32 v41, 0xffff0000, v42
v_lshlrev_b32 v42, 16, v43
v_and_b32 v43, 0xffff0000, v43
v_lshlrev_b32 v44, 16, v46
v_and_b32 v45, 0xffff0000, v46
v_lshlrev_b32 v46, 16, v47
v_and_b32 v47, 0xffff0000, v47
v_lshlrev_b32 v48, 16, v50
v_and_b32 v49, 0xffff0000, v50
v_lshlrev_b32 v50, 16, v51
v_and_b32 v51, 0xffff0000, v51
v_lshlrev_b32 v52, 16, v54
v_and_b32 v53, 0xffff0000, v54
v_lshlrev_b32 v54, 16, v55
v_and_b32 v55, 0xffff0000, v55
v_lshrrev_b32 v2, 4, v1
v_lshlrev_b32 v2, 3, v2
v_add_u32 v2, 162048, v2
v_mov_b32 v3, 162176
ds_read_b64 v[136:137], v2 offset:0
ds_read_b64 v[138:139], v2 offset:32
ds_read_b64 v[140:141], v2 offset:64
ds_read_b64 v[142:143], v2 offset:96
ds_read_b128 v[148:151], v3
s_waitcnt lgkmcnt(0)
v_add_f32 v148, v148, v149
v_add_f32 v150, v150, v151
v_add_f32 v148, v148, v150
s_nop 0
s_branch L_over6
L_pad6:
s_branch L_pad11
L_over6:
v_readfirstlane_b32 s84, v148
v_and_b32 v2, 3, v1
v_cmp_eq_u32 vcc, 0, v2
v_mov_b32 v3, 0x3f803f80
s_nop 0
v_cndmask_b32 v3, 0, v3, vcc
v_cmp_eq_u32 vcc, 2, v2
s_nop 1
v_cndmask_b32 v120, v3, v136, vcc
v_cndmask_b32 v121, v3, v137, vcc
v_cndmask_b32 v122, v3, v138, vcc
v_cndmask_b32 v123, v3, v139, vcc
v_cndmask_b32 v124, v3, v140, vcc
v_cndmask_b32 v125, v3, v141, vcc
v_cndmask_b32 v126, v3, v142, vcc
v_cndmask_b32 v127, v3, v143, vcc
v_and_b32 v2, 15, v1
v_lshrrev_b32 v3, 5, v1
v_lshlrev_b32 v4, 4, v2
v_mov_b32 v144, v4
s_lshl_b32 s75, s64, 15
s_lshl_b32 s70, s60, 9
s_add_u32 s75, s75, s70
s_add_u32 s75, s75, 6291456
s_lshl_b32 s70, s65, 11
s_add_u32 s72, s75, s70
s_mov_b32 s92, 0x00f0000f
s_mov_b32 s93, 0xf0000f00
s_mov_b32 s80, 0x22222222
s_mov_b32 s81, 0x22222222
s_mov_b32 s82, 0x44444444
s_mov_b32 s83, 0x44444444
s_mov_b32 s90, 0x88888888
s_mov_b32 s91, 0x88888888
v_and_b32 v2, 31, v1
v_lshlrev_b32 v5, 4, v2
v_lshl_add_u32 v145, v3, 11, v5
s_lshl_b32 s70, s64, 7
s_lshl_b32 s71, s60, 5
s_add_u32 s70, s70, s71
s_add_u32 s87, s70, 6815744
s_sub_u32 s70, 2047, s70
v_sub_u32 v146, s70, v2
s_lshl_b32 s70, s64, 2
s_add_u32 s70, s70, s60
s_lshl_b32 s70, s70, 12
s_lshl_b32 s71, s65, 7
s_add_u32 s70, s70, s71
s_add_u32 s88, s70, 7864320
v_lshrrev_b32 v2, 3, v1
v_and_b32 v3, 7, v1
v_lshlrev_b32 v147, 11, v2
v_lshl_add_u32 v147, v3, 4, v147
buffer_load_dwordx4 v[56:59], v6, s[12:15], s24 offen offset:0 sc1
buffer_load_dwordx4 v[60:63], v19, s[12:15], s24 offen offset:0 sc1
buffer_load_dwordx4 v[64:67], v6, s[12:15], s24 offen offset:1024 sc1
buffer_load_dwordx4 v[68:71], v19, s[12:15], s24 offen offset:1024 sc1
buffer_load_dwordx4 v[72:75], v6, s[12:15], s25 offen offset:0 sc1
buffer_load_dwordx4 v[76:79], v19, s[12:15], s25 offen offset:0 sc1
buffer_load_dwordx4 v[80:83], v6, s[12:15], s25 offen offset:1024 sc1
buffer_load_dwordx4 v[84:87], v19, s[12:15], s25 offen offset:1024 sc1
buffer_load_dwordx4 v[88:91], v6, s[12:15], s26 offen offset:0 sc1
buffer_load_dwordx4 v[92:95], v19, s[12:15], s26 offen offset:0 sc1
buffer_load_dwordx4 v[96:99], v6, s[12:15], s26 offen offset:1024 sc1
buffer_load_dwordx4 v[100:103], v19, s[12:15], s26 offen offset:1024 sc1
s_waitcnt vmcnt(8)
v_max3_u32 v2, v56, v60, v64
v_max_u32 v2, v2, v68
v_cmp_eq_u32 vcc, -1, v2
s_cbranch_vccnz L_o0_rt
L_o0_ok:
s_waitcnt lgkmcnt(8)
v_mfma_f32_16x16x32_bf16 v[24:27], a[0:3], v[56:59], v[24:27]
ds_read_b64_tr_b16 a[32:33], v8 offset:8192
ds_read_b64_tr_b16 a[34:35], v8 offset:10240
v_mfma_f32_16x16x32_bf16 v[40:43], a[0:3], v[60:63], v[40:43]
buffer_load_dwordx4 v[104:107], v6, s[12:15], s27 offen offset:0 sc1
v_mfma_f32_16x16x32_bf16 v[28:31], a[4:7], v[56:59], v[28:31]
ds_read_b64_tr_b16 a[36:37], v9 offset:8192
ds_read_b64_tr_b16 a[38:39], v9 offset:10240
v_mfma_f32_16x16x32_bf16 v[44:47], a[4:7], v[60:63], v[44:47]
buffer_load_dwordx4 v[108:111], v19, s[12:15], s27 offen offset:0 sc1
v_mfma_f32_16x16x32_bf16 v[32:35], a[8:11], v[56:59], v[32:35]
ds_read_b64_tr_b16 a[40:41], v10 offset:8192
ds_read_b64_tr_b16 a[42:43], v10 offset:10240
v_mfma_f32_16x16x32_bf16 v[48:51], a[8:11], v[60:63], v[48:51]
buffer_load_dwordx4 v[112:115], v6, s[12:15], s27 offen offset:1024 sc1
v_mfma_f32_16x16x32_bf16 v[36:39], a[12:15], v[56:59], v[36:39]
ds_read_b64_tr_b16 a[44:45], v11 offset:8192
ds_read_b64_tr_b16 a[46:47], v11 offset:10240
v_mfma_f32_16x16x32_bf16 v[52:55], a[12:15], v[60:63], v[52:55]
buffer_load_dwordx4 v[116:119], v19, s[12:15], s27 offen offset:1024 sc1
s_waitcnt lgkmcnt(8)
v_mfma_f32_16x16x32_bf16 v[24:27], a[16:19], v[64:67], v[24:27]
ds_read_b64_tr_b16 a[0:1], v8 offset:12288
s_waitcnt vmcnt(8)
v_mfma_f32_16x16x32_bf16 v[40:43], a[16:19], v[68:71], v[40:43]
ds_read_b64_tr_b16 a[2:3], v8 offset:14336
v_max3_u32 v2, v72, v76, v80
v_mfma_f32_16x16x32_bf16 v[28:31], a[20:23], v[64:67], v[28:31]
ds_read_b64_tr_b16 a[4:5], v9 offset:12288
v_max_u32 v2, v2, v84
v_mfma_f32_16x16x32_bf16 v[44:47], a[20:23], v[68:71], v[44:47]
ds_read_b64_tr_b16 a[6:7], v9 offset:14336
v_cmp_eq_u32 vcc, -1, v2
v_mfma_f32_16x16x32_bf16 v[32:35], a[24:27], v[64:67], v[32:35]
ds_read_b64_tr_b16 a[8:9], v10 offset:12288
v_mfma_f32_16x16x32_bf16 v[48:51], a[24:27], v[68:71], v[48:51]
ds_read_b64_tr_b16 a[10:11], v10 offset:14336
v_mfma_f32_16x16x32_bf16 v[36:39], a[28:31], v[64:67], v[36:39]
ds_read_b64_tr_b16 a[12:13], v11 offset:12288
ds_read_b64_tr_b16 a[14:15], v11 offset:14336
v_mfma_f32_16x16x32_bf16 v[52:55], a[28:31], v[68:71], v[52:55]
s_cbranch_vccnz L_o1_rt
L_o1_ok:
s_waitcnt lgkmcnt(8)
v_mfma_f32_16x16x32_bf16 v[24:27], a[32:35], v[72:75], v[24:27]
ds_read_b64_tr_b16 a[16:17], v8 offset:16384
ds_read_b64_tr_b16 a[18:19], v8 offset:18432
v_mfma_f32_16x16x32_bf16 v[40:43], a[32:35], v[76:79], v[40:43]
buffer_load_dwordx4 v[56:59], v6, s[12:15], s28 offen offset:0 sc1
v_mfma_f32_16x16x32_bf16 v[28:31], a[36:39], v[72:75], v[28:31]
ds_read_b64_tr_b16 a[20:21], v9 offset:16384
ds_read_b64_tr_b16 a[22:23], v9 offset:18432
v_mfma_f32_16x16x32_bf16 v[44:47], a[36:39], v[76:79], v[44:47]
buffer_load_dwordx4 v[60:63], v19, s[12:15], s28 offen offset:0 sc1
v_mfma_f32_16x16x32_bf16 v[32:35], a[40:43], v[72:75], v[32:35]
ds_read_b64_tr_b16 a[24:25], v10 offset:16384
ds_read_b64_tr_b16 a[26:27], v10 offset:18432
v_mfma_f32_16x16x32_bf16 v[48:51], a[40:43], v[76:79], v[48:51]
buffer_load_dwordx4 v[64:67], v6, s[12:15], s28 offen offset:1024 sc1
v_mfma_f32_16x16x32_bf16 v[36:39], a[44:47], v[72:75], v[36:39]
ds_read_b64_tr_b16 a[28:29], v11 offset:16384
ds_read_b64_tr_b16 a[30:31], v11 offset:18432
v_mfma_f32_16x16x32_bf16 v[52:55], a[44:47], v[76:79], v[52:55]
buffer_load_dwordx4 v[68:71], v19, s[12:15], s28 offen offset:1024 sc1
s_waitcnt lgkmcnt(8)
v_mfma_f32_16x16x32_bf16 v[24:27], a[0:3], v[80:83], v[24:27]
ds_read_b64_tr_b16 a[32:33], v8 offset:20480
s_waitcnt vmcnt(8)
v_mfma_f32_16x16x32_bf16 v[40:43], a[0:3], v[84:87], v[40:43]
ds_read_b64_tr_b16 a[34:35], v8 offset:22528
v_max3_u32 v2, v88, v92, v96
v_mfma_f32_16x16x32_bf16 v[28:31], a[4:7], v[80:83], v[28:31]
ds_read_b64_tr_b16 a[36:37], v9 offset:20480
v_max_u32 v2, v2, v100
v_mfma_f32_16x16x32_bf16 v[44:47], a[4:7], v[84:87], v[44:47]
ds_read_b64_tr_b16 a[38:39], v9 offset:22528
v_cmp_eq_u32 vcc, -1, v2
v_mfma_f32_16x16x32_bf16 v[32:35], a[8:11], v[80:83], v[32:35]
ds_read_b64_tr_b16 a[40:41], v10 offset:20480
v_mfma_f32_16x16x32_bf16 v[48:51], a[8:11], v[84:87], v[48:51]
ds_read_b64_tr_b16 a[42:43], v10 offset:22528
v_mfma_f32_16x16x32_bf16 v[36:39], a[12:15], v[80:83], v[36:39]
ds_read_b64_tr_b16 a[44:45], v11 offset:20480
ds_read_b64_tr_b16 a[46:47], v11 offset:22528
v_mfma_f32_16x16x32_bf16 v[52:55], a[12:15], v[84:87], v[52:55]
s_cbranch_vccnz L_o2_rt
L_o2_ok:
s_waitcnt lgkmcnt(8)
v_mfma_f32_16x16x32_bf16 v[24:27], a[16:19], v[88:91], v[24:27]
ds_read_b64_tr_b16 a[0:1], v8 offset:24576
ds_read_b64_tr_b16 a[2:3], v8 offset:26624
v_mfma_f32_16x16x32_bf16 v[40:43], a[16:19], v[92:95], v[40:43]
buffer_load_dwordx4 v[72:75], v6, s[12:15], s29 offen offset:0 sc1
v_mfma_f32_16x16x32_bf16 v[28:31], a[20:23], v[88:91], v[28:31]
ds_read_b64_tr_b16 a[4:5], v9 offset:24576
ds_read_b64_tr_b16 a[6:7], v9 offset:26624
v_mfma_f32_16x16x32_bf16 v[44:47], a[20:23], v[92:95], v[44:47]
buffer_load_dwordx4 v[76:79], v19, s[12:15], s29 offen offset:0 sc1
v_mfma_f32_16x16x32_bf16 v[32:35], a[24:27], v[88:91], v[32:35]
ds_read_b64_tr_b16 a[8:9], v10 offset:24576
ds_read_b64_tr_b16 a[10:11], v10 offset:26624
v_mfma_f32_16x16x32_bf16 v[48:51], a[24:27], v[92:95], v[48:51]
buffer_load_dwordx4 v[80:83], v6, s[12:15], s29 offen offset:1024 sc1
v_mfma_f32_16x16x32_bf16 v[36:39], a[28:31], v[88:91], v[36:39]
ds_read_b64_tr_b16 a[12:13], v11 offset:24576
ds_read_b64_tr_b16 a[14:15], v11 offset:26624
v_mfma_f32_16x16x32_bf16 v[52:55], a[28:31], v[92:95], v[52:55]
buffer_load_dwordx4 v[84:87], v19, s[12:15], s29 offen offset:1024 sc1
s_waitcnt lgkmcnt(8)
v_mfma_f32_16x16x32_bf16 v[24:27], a[32:35], v[96:99], v[24:27]
ds_read_b64_tr_b16 a[16:17], v8 offset:28672
s_waitcnt vmcnt(8)
v_mfma_f32_16x16x32_bf16 v[40:43], a[32:35], v[100:103], v[40:43]
ds_read_b64_tr_b16 a[18:19], v8 offset:30720
v_max3_u32 v2, v104, v108, v112
v_mfma_f32_16x16x32_bf16 v[28:31], a[36:39], v[96:99], v[28:31]
ds_read_b64_tr_b16 a[20:21], v9 offset:28672
v_max_u32 v2, v2, v116
v_mfma_f32_16x16x32_bf16 v[44:47], a[36:39], v[100:103], v[44:47]
ds_read_b64_tr_b16 a[22:23], v9 offset:30720
v_cmp_eq_u32 vcc, -1, v2
v_mfma_f32_16x16x32_bf16 v[32:35], a[40:43], v[96:99], v[32:35]
ds_read_b64_tr_b16 a[24:25], v10 offset:28672
v_mfma_f32_16x16x32_bf16 v[48:51], a[40:43], v[100:103], v[48:51]
ds_read_b64_tr_b16 a[26:27], v10 offset:30720
v_mfma_f32_16x16x32_bf16 v[36:39], a[44:47], v[96:99], v[36:39]
ds_read_b64_tr_b16 a[28:29], v11 offset:28672
ds_read_b64_tr_b16 a[30:31], v11 offset:30720
v_mfma_f32_16x16x32_bf16 v[52:55], a[44:47], v[100:103], v[52:55]
s_cbranch_vccnz L_o3_rt
L_o3_ok:
s_waitcnt lgkmcnt(8)
v_mfma_f32_16x16x32_bf16 v[24:27], a[0:3], v[104:107], v[24:27]
ds_read_b64_tr_b16 a[32:33], v8 offset:32768
ds_read_b64_tr_b16 a[34:35], v8 offset:34816
v_mfma_f32_16x16x32_bf16 v[40:43], a[0:3], v[108:111], v[40:43]
buffer_load_dwordx4 v[88:91], v6, s[12:15], s30 offen offset:0 sc1
v_mfma_f32_16x16x32_bf16 v[28:31], a[4:7], v[104:107], v[28:31]
ds_read_b64_tr_b16 a[36:37], v9 offset:32768
ds_read_b64_tr_b16 a[38:39], v9 offset:34816
v_mfma_f32_16x16x32_bf16 v[44:47], a[4:7], v[108:111], v[44:47]
buffer_load_dwordx4 v[92:95], v19, s[12:15], s30 offen offset:0 sc1
v_mfma_f32_16x16x32_bf16 v[32:35], a[8:11], v[104:107], v[32:35]
ds_read_b64_tr_b16 a[40:41], v10 offset:32768
ds_read_b64_tr_b16 a[42:43], v10 offset:34816
v_mfma_f32_16x16x32_bf16 v[48:51], a[8:11], v[108:111], v[48:51]
buffer_load_dwordx4 v[96:99], v6, s[12:15], s30 offen offset:1024 sc1
v_mfma_f32_16x16x32_bf16 v[36:39], a[12:15], v[104:107], v[36:39]
ds_read_b64_tr_b16 a[44:45], v11 offset:32768
ds_read_b64_tr_b16 a[46:47], v11 offset:34816
v_mfma_f32_16x16x32_bf16 v[52:55], a[12:15], v[108:111], v[52:55]
buffer_load_dwordx4 v[100:103], v19, s[12:15], s30 offen offset:1024 sc1
s_waitcnt lgkmcnt(8)
v_mfma_f32_16x16x32_bf16 v[24:27], a[16:19], v[112:115], v[24:27]
ds_read_b64_tr_b16 a[0:1], v8 offset:36864
s_waitcnt vmcnt(8)
v_mfma_f32_16x16x32_bf16 v[40:43], a[16:19], v[116:119], v[40:43]
ds_read_b64_tr_b16 a[2:3], v8 offset:38912
v_max3_u32 v2, v56, v60, v64
v_mfma_f32_16x16x32_bf16 v[28:31], a[20:23], v[112:115], v[28:31]
ds_read_b64_tr_b16 a[4:5], v9 offset:36864
v_max_u32 v2, v2, v68
v_mfma_f32_16x16x32_bf16 v[44:47], a[20:23], v[116:119], v[44:47]
ds_read_b64_tr_b16 a[6:7], v9 offset:38912
v_cmp_eq_u32 vcc, -1, v2
v_mfma_f32_16x16x32_bf16 v[32:35], a[24:27], v[112:115], v[32:35]
ds_read_b64_tr_b16 a[8:9], v10 offset:36864
v_mfma_f32_16x16x32_bf16 v[48:51], a[24:27], v[116:119], v[48:51]
ds_read_b64_tr_b16 a[10:11], v10 offset:38912
v_mfma_f32_16x16x32_bf16 v[36:39], a[28:31], v[112:115], v[36:39]
ds_read_b64_tr_b16 a[12:13], v11 offset:36864
ds_read_b64_tr_b16 a[14:15], v11 offset:38912
v_mfma_f32_16x16x32_bf16 v[52:55], a[28:31], v[116:119], v[52:55]
s_cbranch_vccnz L_o4_rt
L_o4_ok:
s_waitcnt lgkmcnt(8)
v_mfma_f32_16x16x32_bf16 v[24:27], a[32:35], v[56:59], v[24:27]
ds_read_b64_tr_b16 a[16:17], v8 offset:40960
ds_read_b64_tr_b16 a[18:19], v8 offset:43008
v_mfma_f32_16x16x32_bf16 v[40:43], a[32:35], v[60:63], v[40:43]
buffer_load_dwordx4 v[104:107], v6, s[12:15], s31 offen offset:0 sc1
v_mfma_f32_16x16x32_bf16 v[28:31], a[36:39], v[56:59], v[28:31]
ds_read_b64_tr_b16 a[20:21], v9 offset:40960
ds_read_b64_tr_b16 a[22:23], v9 offset:43008
v_mfma_f32_16x16x32_bf16 v[44:47], a[36:39], v[60:63], v[44:47]
buffer_load_dwordx4 v[108:111], v19, s[12:15], s31 offen offset:0 sc1
v_mfma_f32_16x16x32_bf16 v[32:35], a[40:43], v[56:59], v[32:35]
ds_read_b64_tr_b16 a[24:25], v10 offset:40960
ds_read_b64_tr_b16 a[26:27], v10 offset:43008
v_mfma_f32_16x16x32_bf16 v[48:51], a[40:43], v[60:63], v[48:51]
buffer_load_dwordx4 v[112:115], v6, s[12:15], s31 offen offset:1024 sc1
v_mfma_f32_16x16x32_bf16 v[36:39], a[44:47], v[56:59], v[36:39]
ds_read_b64_tr_b16 a[28:29], v11 offset:40960
ds_read_b64_tr_b16 a[30:31], v11 offset:43008
v_mfma_f32_16x16x32_bf16 v[52:55], a[44:47], v[60:63], v[52:55]
buffer_load_dwordx4 v[116:119], v19, s[12:15], s31 offen offset:1024 sc1
s_waitcnt lgkmcnt(8)
v_mfma_f32_16x16x32_bf16 v[24:27], a[0:3], v[64:67], v[24:27]
ds_read_b64_tr_b16 a[32:33], v8 offset:45056
s_waitcnt vmcnt(8)
v_mfma_f32_16x16x32_bf16 v[40:43], a[0:3], v[68:71], v[40:43]
ds_read_b64_tr_b16 a[34:35], v8 offset:47104
v_max3_u32 v2, v72, v76, v80
v_mfma_f32_16x16x32_bf16 v[28:31], a[4:7], v[64:67], v[28:31]
ds_read_b64_tr_b16 a[36:37], v9 offset:45056
v_max_u32 v2, v2, v84
v_mfma_f32_16x16x32_bf16 v[44:47], a[4:7], v[68:71], v[44:47]
ds_read_b64_tr_b16 a[38:39], v9 offset:47104
v_cmp_eq_u32 vcc, -1, v2
v_mfma_f32_16x16x32_bf16 v[32:35], a[8:11], v[64:67], v[32:35]
ds_read_b64_tr_b16 a[40:41], v10 offset:45056
v_mfma_f32_16x16x32_bf16 v[48:51], a[8:11], v[68:71], v[48:51]
ds_read_b64_tr_b16 a[42:43], v10 offset:47104
v_mfma_f32_16x16x32_bf16 v[36:39], a[12:15], v[64:67], v[36:39]
ds_read_b64_tr_b16 a[44:45], v11 offset:45056
ds_read_b64_tr_b16 a[46:47], v11 offset:47104
v_mfma_f32_16x16x32_bf16 v[52:55], a[12:15], v[68:71], v[52:55]
s_cbranch_vccnz L_o5_rt
L_o5_ok:
s_waitcnt lgkmcnt(8)
v_mfma_f32_16x16x32_bf16 v[24:27], a[16:19], v[72:75], v[24:27]
ds_read_b64_tr_b16 a[0:1], v8 offset:49152
ds_read_b64_tr_b16 a[2:3], v8 offset:51200
v_mfma_f32_16x16x32_bf16 v[40:43], a[16:19], v[76:79], v[40:43]
buffer_load_dwordx4 v[56:59], v6, s[12:15], s32 offen offset:0 sc1
v_mfma_f32_16x16x32_bf16 v[28:31], a[20:23], v[72:75], v[28:31]
ds_read_b64_tr_b16 a[4:5], v9 offset:49152
ds_read_b64_tr_b16 a[6:7], v9 offset:51200
v_mfma_f32_16x16x32_bf16 v[44:47], a[20:23], v[76:79], v[44:47]
buffer_load_dwordx4 v[60:63], v19, s[12:15], s32 offen offset:0 sc1
v_mfma_f32_16x16x32_bf16 v[32:35], a[24:27], v[72:75], v[32:35]
ds_read_b64_tr_b16 a[8:9], v10 offset:49152
ds_read_b64_tr_b16 a[10:11], v10 offset:51200
v_mfma_f32_16x16x32_bf16 v[48:51], a[24:27], v[76:79], v[48:51]
buffer_load_dwordx4 v[64:67], v6, s[12:15], s32 offen offset:1024 sc1
v_mfma_f32_16x16x32_bf16 v[36:39], a[28:31], v[72:75], v[36:39]
ds_read_b64_tr_b16 a[12:13], v11 offset:49152
ds_read_b64_tr_b16 a[14:15], v11 offset:51200
v_mfma_f32_16x16x32_bf16 v[52:55], a[28:31], v[76:79], v[52:55]
buffer_load_dwordx4 v[68:71], v19, s[12:15], s32 offen offset:1024 sc1
s_waitcnt lgkmcnt(8)
v_mfma_f32_16x16x32_bf16 v[24:27], a[32:35], v[80:83], v[24:27]
ds_read_b64_tr_b16 a[16:17], v8 offset:53248
s_waitcnt vmcnt(8)
v_mfma_f32_16x16x32_bf16 v[40:43], a[32:35], v[84:87], v[40:43]
ds_read_b64_tr_b16 a[18:19], v8 offset:55296
v_max3_u32 v2, v88, v92, v96
v_mfma_f32_16x16x32_bf16 v[28:31], a[36:39], v[80:83], v[28:31]
ds_read_b64_tr_b16 a[20:21], v9 offset:53248
v_max_u32 v2, v2, v100
v_mfma_f32_16x16x32_bf16 v[44:47], a[36:39], v[84:87], v[44:47]
ds_read_b64_tr_b16 a[22:23], v9 offset:55296
v_cmp_eq_u32 vcc, -1, v2
v_mfma_f32_16x16x32_bf16 v[32:35], a[40:43], v[80:83], v[32:35]
ds_read_b64_tr_b16 a[24:25], v10 offset:53248
v_mfma_f32_16x16x32_bf16 v[48:51], a[40:43], v[84:87], v[48:51]
ds_read_b64_tr_b16 a[26:27], v10 offset:55296
v_mfma_f32_16x16x32_bf16 v[36:39], a[44:47], v[80:83], v[36:39]
ds_read_b64_tr_b16 a[28:29], v11 offset:53248
ds_read_b64_tr_b16 a[30:31], v11 offset:55296
v_mfma_f32_16x16x32_bf16 v[52:55], a[44:47], v[84:87], v[52:55]
s_cbranch_vccnz L_o6_rt
L_o6_ok:
s_waitcnt lgkmcnt(8)
v_mfma_f32_16x16x32_bf16 v[24:27], a[0:3], v[88:91], v[24:27]
ds_read_b64_tr_b16 a[32:33], v8 offset:57344
ds_read_b64_tr_b16 a[34:35], v8 offset:59392
v_mfma_f32_16x16x32_bf16 v[40:43], a[0:3], v[92:95], v[40:43]
buffer_load_dwordx4 v[72:75], v6, s[12:15], s33 offen offset:0 sc1
v_mfma_f32_16x16x32_bf16 v[28:31], a[4:7], v[88:91], v[28:31]
ds_read_b64_tr_b16 a[36:37], v9 offset:57344
ds_read_b64_tr_b16 a[38:39], v9 offset:59392
v_mfma_f32_16x16x32_bf16 v[44:47], a[4:7], v[92:95], v[44:47]
buffer_load_dwordx4 v[76:79], v19, s[12:15], s33 offen offset:0 sc1
v_mfma_f32_16x16x32_bf16 v[32:35], a[8:11], v[88:91], v[32:35]
ds_read_b64_tr_b16 a[40:41], v10 offset:57344
ds_read_b64_tr_b16 a[42:43], v10 offset:59392
v_mfma_f32_16x16x32_bf16 v[48:51], a[8:11], v[92:95], v[48:51]
buffer_load_dwordx4 v[80:83], v6, s[12:15], s33 offen offset:1024 sc1
v_mfma_f32_16x16x32_bf16 v[36:39], a[12:15], v[88:91], v[36:39]
ds_read_b64_tr_b16 a[44:45], v11 offset:57344
ds_read_b64_tr_b16 a[46:47], v11 offset:59392
v_mfma_f32_16x16x32_bf16 v[52:55], a[12:15], v[92:95], v[52:55]
buffer_load_dwordx4 v[84:87], v19, s[12:15], s33 offen offset:1024 sc1
s_waitcnt lgkmcnt(8)
v_mfma_f32_16x16x32_bf16 v[24:27], a[16:19], v[96:99], v[24:27]
ds_read_b64_tr_b16 a[0:1], v8 offset:61440
s_waitcnt vmcnt(8)
v_mfma_f32_16x16x32_bf16 v[40:43], a[16:19], v[100:103], v[40:43]
ds_read_b64_tr_b16 a[2:3], v8 offset:63488
v_max3_u32 v2, v104, v108, v112
v_mfma_f32_16x16x32_bf16 v[28:31], a[20:23], v[96:99], v[28:31]
ds_read_b64_tr_b16 a[4:5], v9 offset:61440
v_max_u32 v2, v2, v116
v_mfma_f32_16x16x32_bf16 v[44:47], a[20:23], v[100:103], v[44:47]
ds_read_b64_tr_b16 a[6:7], v9 offset:63488
v_cmp_eq_u32 vcc, -1, v2
v_mfma_f32_16x16x32_bf16 v[32:35], a[24:27], v[96:99], v[32:35]
ds_read_b64_tr_b16 a[8:9], v10 offset:61440
v_mfma_f32_16x16x32_bf16 v[48:51], a[24:27], v[100:103], v[48:51]
ds_read_b64_tr_b16 a[10:11], v10 offset:63488
v_mfma_f32_16x16x32_bf16 v[36:39], a[28:31], v[96:99], v[36:39]
ds_read_b64_tr_b16 a[12:13], v11 offset:61440
ds_read_b64_tr_b16 a[14:15], v11 offset:63488
v_mfma_f32_16x16x32_bf16 v[52:55], a[28:31], v[100:103], v[52:55]
s_cbranch_vccnz L_o7_rt
L_o7_ok:
s_waitcnt lgkmcnt(8)
v_mfma_f32_16x16x32_bf16 v[24:27], a[32:35], v[104:107], v[24:27]
ds_read_b64_tr_b16 a[16:17], v12 offset:0
ds_read_b64_tr_b16 a[18:19], v12 offset:2048
v_mfma_f32_16x16x32_bf16 v[40:43], a[32:35], v[108:111], v[40:43]
buffer_load_dwordx4 v[88:91], v6, s[12:15], s34 offen offset:0 sc1
v_mfma_f32_16x16x32_bf16 v[28:31], a[36:39], v[104:107], v[28:31]
ds_read_b64_tr_b16 a[20:21], v13 offset:0
ds_read_b64_tr_b16 a[22:23], v13 offset:2048
v_mfma_f32_16x16x32_bf16 v[44:47], a[36:39], v[108:111], v[44:47]
buffer_load_dwordx4 v[92:95], v19, s[12:15], s34 offen offset:0 sc1
v_mfma_f32_16x16x32_bf16 v[32:35], a[40:43], v[104:107], v[32:35]
ds_read_b64_tr_b16 a[24:25], v14 offset:0
ds_read_b64_tr_b16 a[26:27], v14 offset:2048
v_mfma_f32_16x16x32_bf16 v[48:51], a[40:43], v[108:111], v[48:51]
buffer_load_dwordx4 v[96:99], v6, s[12:15], s34 offen offset:1024 sc1
v_mfma_f32_16x16x32_bf16 v[36:39], a[44:47], v[104:107], v[36:39]
ds_read_b64_tr_b16 a[28:29], v15 offset:0
ds_read_b64_tr_b16 a[30:31], v15 offset:2048
v_mfma_f32_16x16x32_bf16 v[52:55], a[44:47], v[108:111], v[52:55]
buffer_load_dwordx4 v[100:103], v19, s[12:15], s34 offen offset:1024 sc1
s_waitcnt lgkmcnt(8)
v_mfma_f32_16x16x32_bf16 v[24:27], a[0:3], v[112:115], v[24:27]
ds_read_b64_tr_b16 a[32:33], v12 offset:4096
s_waitcnt vmcnt(8)
v_mfma_f32_16x16x32_bf16 v[40:43], a[0:3], v[116:119], v[40:43]
ds_read_b64_tr_b16 a[34:35], v12 offset:6144
v_max3_u32 v2, v56, v60, v64
v_mfma_f32_16x16x32_bf16 v[28:31], a[4:7], v[112:115], v[28:31]
ds_read_b64_tr_b16 a[36:37], v13 offset:4096
v_max_u32 v2, v2, v68
v_mfma_f32_16x16x32_bf16 v[44:47], a[4:7], v[116:119], v[44:47]
ds_read_b64_tr_b16 a[38:39], v13 offset:6144
v_cmp_eq_u32 vcc, -1, v2
v_mfma_f32_16x16x32_bf16 v[32:35], a[8:11], v[112:115], v[32:35]
ds_read_b64_tr_b16 a[40:41], v14 offset:4096
v_mfma_f32_16x16x32_bf16 v[48:51], a[8:11], v[116:119], v[48:51]
ds_read_b64_tr_b16 a[42:43], v14 offset:6144
v_mfma_f32_16x16x32_bf16 v[36:39], a[12:15], v[112:115], v[36:39]
ds_read_b64_tr_b16 a[44:45], v15 offset:4096
ds_read_b64_tr_b16 a[46:47], v15 offset:6144
v_mfma_f32_16x16x32_bf16 v[52:55], a[12:15], v[116:119], v[52:55]
s_cbranch_vccnz L_o8_rt
L_o8_ok:
s_waitcnt lgkmcnt(8)
v_mfma_f32_16x16x32_bf16 v[24:27], a[16:19], v[56:59], v[24:27]
ds_read_b64_tr_b16 a[0:1], v12 offset:8192
ds_read_b64_tr_b16 a[2:3], v12 offset:10240
v_mfma_f32_16x16x32_bf16 v[40:43], a[16:19], v[60:63], v[40:43]
buffer_load_dwordx4 v[104:107], v6, s[12:15], s35 offen offset:0 sc1
v_mfma_f32_16x16x32_bf16 v[28:31], a[20:23], v[56:59], v[28:31]
ds_read_b64_tr_b16 a[4:5], v13 offset:8192
ds_read_b64_tr_b16 a[6:7], v13 offset:10240
v_mfma_f32_16x16x32_bf16 v[44:47], a[20:23], v[60:63], v[44:47]
buffer_load_dwordx4 v[108:111], v19, s[12:15], s35 offen offset:0 sc1
v_mfma_f32_16x16x32_bf16 v[32:35], a[24:27], v[56:59], v[32:35]
ds_read_b64_tr_b16 a[8:9], v14 offset:8192
ds_read_b64_tr_b16 a[10:11], v14 offset:10240
v_mfma_f32_16x16x32_bf16 v[48:51], a[24:27], v[60:63], v[48:51]
buffer_load_dwordx4 v[112:115], v6, s[12:15], s35 offen offset:1024 sc1
v_mfma_f32_16x16x32_bf16 v[36:39], a[28:31], v[56:59], v[36:39]
ds_read_b64_tr_b16 a[12:13], v15 offset:8192
ds_read_b64_tr_b16 a[14:15], v15 offset:10240
v_mfma_f32_16x16x32_bf16 v[52:55], a[28:31], v[60:63], v[52:55]
buffer_load_dwordx4 v[116:119], v19, s[12:15], s35 offen offset:1024 sc1
s_waitcnt lgkmcnt(8)
v_mfma_f32_16x16x32_bf16 v[24:27], a[32:35], v[64:67], v[24:27]
ds_read_b64_tr_b16 a[16:17], v12 offset:12288
s_waitcnt vmcnt(8)
v_mfma_f32_16x16x32_bf16 v[40:43], a[32:35], v[68:71], v[40:43]
ds_read_b64_tr_b16 a[18:19], v12 offset:14336
v_max3_u32 v2, v72, v76, v80
v_mfma_f32_16x16x32_bf16 v[28:31], a[36:39], v[64:67], v[28:31]
ds_read_b64_tr_b16 a[20:21], v13 offset:12288
v_max_u32 v2, v2, v84
v_mfma_f32_16x16x32_bf16 v[44:47], a[36:39], v[68:71], v[44:47]
ds_read_b64_tr_b16 a[22:23], v13 offset:14336
v_cmp_eq_u32 vcc, -1, v2
v_mfma_f32_16x16x32_bf16 v[32:35], a[40:43], v[64:67], v[32:35]
ds_read_b64_tr_b16 a[24:25], v14 offset:12288
v_mfma_f32_16x16x32_bf16 v[48:51], a[40:43], v[68:71], v[48:51]
ds_read_b64_tr_b16 a[26:27], v14 offset:14336
v_mfma_f32_16x16x32_bf16 v[36:39], a[44:47], v[64:67], v[36:39]
ds_read_b64_tr_b16 a[28:29], v15 offset:12288
ds_read_b64_tr_b16 a[30:31], v15 offset:14336
v_mfma_f32_16x16x32_bf16 v[52:55], a[44:47], v[68:71], v[52:55]
s_cbranch_vccnz L_o9_rt
L_o9_ok:
s_waitcnt lgkmcnt(8)
v_mfma_f32_16x16x32_bf16 v[24:27], a[0:3], v[72:75], v[24:27]
ds_read_b64_tr_b16 a[32:33], v12 offset:16384
ds_read_b64_tr_b16 a[34:35], v12 offset:18432
v_mfma_f32_16x16x32_bf16 v[40:43], a[0:3], v[76:79], v[40:43]
buffer_load_dwordx4 v[56:59], v6, s[12:15], s36 offen offset:0 sc1
v_mfma_f32_16x16x32_bf16 v[28:31], a[4:7], v[72:75], v[28:31]
ds_read_b64_tr_b16 a[36:37], v13 offset:16384
ds_read_b64_tr_b16 a[38:39], v13 offset:18432
v_mfma_f32_16x16x32_bf16 v[44:47], a[4:7], v[76:79], v[44:47]
buffer_load_dwordx4 v[60:63], v19, s[12:15], s36 offen offset:0 sc1
v_mfma_f32_16x16x32_bf16 v[32:35], a[8:11], v[72:75], v[32:35]
ds_read_b64_tr_b16 a[40:41], v14 offset:16384
ds_read_b64_tr_b16 a[42:43], v14 offset:18432
v_mfma_f32_16x16x32_bf16 v[48:51], a[8:11], v[76:79], v[48:51]
buffer_load_dwordx4 v[64:67], v6, s[12:15], s36 offen offset:1024 sc1
v_mfma_f32_16x16x32_bf16 v[36:39], a[12:15], v[72:75], v[36:39]
ds_read_b64_tr_b16 a[44:45], v15 offset:16384
ds_read_b64_tr_b16 a[46:47], v15 offset:18432
v_mfma_f32_16x16x32_bf16 v[52:55], a[12:15], v[76:79], v[52:55]
buffer_load_dwordx4 v[68:71], v19, s[12:15], s36 offen offset:1024 sc1
s_waitcnt lgkmcnt(8)
v_mfma_f32_16x16x32_bf16 v[24:27], a[16:19], v[80:83], v[24:27]
ds_read_b64_tr_b16 a[0:1], v12 offset:20480
s_waitcnt vmcnt(8)
v_mfma_f32_16x16x32_bf16 v[40:43], a[16:19], v[84:87], v[40:43]
ds_read_b64_tr_b16 a[2:3], v12 offset:22528
v_max3_u32 v2, v88, v92, v96
v_mfma_f32_16x16x32_bf16 v[28:31], a[20:23], v[80:83], v[28:31]
ds_read_b64_tr_b16 a[4:5], v13 offset:20480
v_max_u32 v2, v2, v100
v_mfma_f32_16x16x32_bf16 v[44:47], a[20:23], v[84:87], v[44:47]
ds_read_b64_tr_b16 a[6:7], v13 offset:22528
v_cmp_eq_u32 vcc, -1, v2
v_mfma_f32_16x16x32_bf16 v[32:35], a[24:27], v[80:83], v[32:35]
ds_read_b64_tr_b16 a[8:9], v14 offset:20480
v_mfma_f32_16x16x32_bf16 v[48:51], a[24:27], v[84:87], v[48:51]
ds_read_b64_tr_b16 a[10:11], v14 offset:22528
v_mfma_f32_16x16x32_bf16 v[36:39], a[28:31], v[80:83], v[36:39]
ds_read_b64_tr_b16 a[12:13], v15 offset:20480
ds_read_b64_tr_b16 a[14:15], v15 offset:22528
v_mfma_f32_16x16x32_bf16 v[52:55], a[28:31], v[84:87], v[52:55]
s_cbranch_vccnz L_o10_rt
L_o10_ok:
s_waitcnt lgkmcnt(8)
v_mfma_f32_16x16x32_bf16 v[24:27], a[32:35], v[88:91], v[24:27]
ds_read_b64_tr_b16 a[16:17], v12 offset:24576
ds_read_b64_tr_b16 a[18:19], v12 offset:26624
v_mfma_f32_16x16x32_bf16 v[40:43], a[32:35], v[92:95], v[40:43]
buffer_load_dwordx4 v[72:75], v6, s[12:15], s37 offen offset:0 sc1
v_mfma_f32_16x16x32_bf16 v[28:31], a[36:39], v[88:91], v[28:31]
ds_read_b64_tr_b16 a[20:21], v13 offset:24576
ds_read_b64_tr_b16 a[22:23], v13 offset:26624
v_mfma_f32_16x16x32_bf16 v[44:47], a[36:39], v[92:95], v[44:47]
buffer_load_dwordx4 v[76:79], v19, s[12:15], s37 offen offset:0 sc1
v_mfma_f32_16x16x32_bf16 v[32:35], a[40:43], v[88:91], v[32:35]
ds_read_b64_tr_b16 a[24:25], v14 offset:24576
ds_read_b64_tr_b16 a[26:27], v14 offset:26624
v_mfma_f32_16x16x32_bf16 v[48:51], a[40:43], v[92:95], v[48:51]
buffer_load_dwordx4 v[80:83], v6, s[12:15], s37 offen offset:1024 sc1
v_mfma_f32_16x16x32_bf16 v[36:39], a[44:47], v[88:91], v[36:39]
ds_read_b64_tr_b16 a[28:29], v15 offset:24576
ds_read_b64_tr_b16 a[30:31], v15 offset:26624
v_mfma_f32_16x16x32_bf16 v[52:55], a[44:47], v[92:95], v[52:55]
buffer_load_dwordx4 v[84:87], v19, s[12:15], s37 offen offset:1024 sc1
s_waitcnt lgkmcnt(8)
v_mfma_f32_16x16x32_bf16 v[24:27], a[0:3], v[96:99], v[24:27]
ds_read_b64_tr_b16 a[32:33], v12 offset:28672
s_waitcnt vmcnt(8)
v_mfma_f32_16x16x32_bf16 v[40:43], a[0:3], v[100:103], v[40:43]
ds_read_b64_tr_b16 a[34:35], v12 offset:30720
v_max3_u32 v2, v104, v108, v112
v_mfma_f32_16x16x32_bf16 v[28:31], a[4:7], v[96:99], v[28:31]
ds_read_b64_tr_b16 a[36:37], v13 offset:28672
v_max_u32 v2, v2, v116
v_mfma_f32_16x16x32_bf16 v[44:47], a[4:7], v[100:103], v[44:47]
ds_read_b64_tr_b16 a[38:39], v13 offset:30720
v_cmp_eq_u32 vcc, -1, v2
v_mfma_f32_16x16x32_bf16 v[32:35], a[8:11], v[96:99], v[32:35]
ds_read_b64_tr_b16 a[40:41], v14 offset:28672
v_mfma_f32_16x16x32_bf16 v[48:51], a[8:11], v[100:103], v[48:51]
ds_read_b64_tr_b16 a[42:43], v14 offset:30720
v_mfma_f32_16x16x32_bf16 v[36:39], a[12:15], v[96:99], v[36:39]
ds_read_b64_tr_b16 a[44:45], v15 offset:28672
ds_read_b64_tr_b16 a[46:47], v15 offset:30720
v_mfma_f32_16x16x32_bf16 v[52:55], a[12:15], v[100:103], v[52:55]
s_cbranch_vccnz L_o11_rt
L_o11_ok:
s_waitcnt lgkmcnt(8)
v_mfma_f32_16x16x32_bf16 v[24:27], a[16:19], v[104:107], v[24:27]
ds_read_b64_tr_b16 a[0:1], v12 offset:32768
ds_read_b64_tr_b16 a[2:3], v12 offset:34816
v_mfma_f32_16x16x32_bf16 v[40:43], a[16:19], v[108:111], v[40:43]
buffer_load_dwordx4 v[88:91], v6, s[12:15], s38 offen offset:0 sc1
v_mfma_f32_16x16x32_bf16 v[28:31], a[20:23], v[104:107], v[28:31]
ds_read_b64_tr_b16 a[4:5], v13 offset:32768
ds_read_b64_tr_b16 a[6:7], v13 offset:34816
v_mfma_f32_16x16x32_bf16 v[44:47], a[20:23], v[108:111], v[44:47]
buffer_load_dwordx4 v[92:95], v19, s[12:15], s38 offen offset:0 sc1
v_mfma_f32_16x16x32_bf16 v[32:35], a[24:27], v[104:107], v[32:35]
ds_read_b64_tr_b16 a[8:9], v14 offset:32768
ds_read_b64_tr_b16 a[10:11], v14 offset:34816
v_mfma_f32_16x16x32_bf16 v[48:51], a[24:27], v[108:111], v[48:51]
buffer_load_dwordx4 v[96:99], v6, s[12:15], s38 offen offset:1024 sc1
v_mfma_f32_16x16x32_bf16 v[36:39], a[28:31], v[104:107], v[36:39]
ds_read_b64_tr_b16 a[12:13], v15 offset:32768
ds_read_b64_tr_b16 a[14:15], v15 offset:34816
v_mfma_f32_16x16x32_bf16 v[52:55], a[28:31], v[108:111], v[52:55]
buffer_load_dwordx4 v[100:103], v19, s[12:15], s38 offen offset:1024 sc1
s_waitcnt lgkmcnt(8)
v_mfma_f32_16x16x32_bf16 v[24:27], a[32:35], v[112:115], v[24:27]
s_branch L_over7
L_pad7:
s_branch L_pad12
L_over7:
ds_read_b64_tr_b16 a[16:17], v12 offset:36864
s_waitcnt vmcnt(8)
v_mfma_f32_16x16x32_bf16 v[40:43], a[32:35], v[116:119], v[40:43]
ds_read_b64_tr_b16 a[18:19], v12 offset:38912
v_max3_u32 v2, v56, v60, v64
v_mfma_f32_16x16x32_bf16 v[28:31], a[36:39], v[112:115], v[28:31]
ds_read_b64_tr_b16 a[20:21], v13 offset:36864
v_max_u32 v2, v2, v68
v_mfma_f32_16x16x32_bf16 v[44:47], a[36:39], v[116:119], v[44:47]
ds_read_b64_tr_b16 a[22:23], v13 offset:38912
v_cmp_eq_u32 vcc, -1, v2
v_mfma_f32_16x16x32_bf16 v[32:35], a[40:43], v[112:115], v[32:35]
ds_read_b64_tr_b16 a[24:25], v14 offset:36864
v_mfma_f32_16x16x32_bf16 v[48:51], a[40:43], v[116:119], v[48:51]
ds_read_b64_tr_b16 a[26:27], v14 offset:38912
v_mfma_f32_16x16x32_bf16 v[36:39], a[44:47], v[112:115], v[36:39]
ds_read_b64_tr_b16 a[28:29], v15 offset:36864
ds_read_b64_tr_b16 a[30:31], v15 offset:38912
v_mfma_f32_16x16x32_bf16 v[52:55], a[44:47], v[116:119], v[52:55]
s_cbranch_vccnz L_o12_rt
L_o12_ok:
s_waitcnt lgkmcnt(8)
v_mfma_f32_16x16x32_bf16 v[24:27], a[0:3], v[56:59], v[24:27]
ds_read_b64_tr_b16 a[32:33], v12 offset:40960
ds_read_b64_tr_b16 a[34:35], v12 offset:43008
v_mfma_f32_16x16x32_bf16 v[40:43], a[0:3], v[60:63], v[40:43]
buffer_load_dwordx4 v[104:107], v6, s[12:15], s39 offen offset:0 sc1
v_mfma_f32_16x16x32_bf16 v[28:31], a[4:7], v[56:59], v[28:31]
ds_read_b64_tr_b16 a[36:37], v13 offset:40960
ds_read_b64_tr_b16 a[38:39], v13 offset:43008
v_mfma_f32_16x16x32_bf16 v[44:47], a[4:7], v[60:63], v[44:47]
buffer_load_dwordx4 v[108:111], v19, s[12:15], s39 offen offset:0 sc1
v_mfma_f32_16x16x32_bf16 v[32:35], a[8:11], v[56:59], v[32:35]
ds_read_b64_tr_b16 a[40:41], v14 offset:40960
ds_read_b64_tr_b16 a[42:43], v14 offset:43008
v_mfma_f32_16x16x32_bf16 v[48:51], a[8:11], v[60:63], v[48:51]
buffer_load_dwordx4 v[112:115], v6, s[12:15], s39 offen offset:1024 sc1
v_mfma_f32_16x16x32_bf16 v[36:39], a[12:15], v[56:59], v[36:39]
ds_read_b64_tr_b16 a[44:45], v15 offset:40960
ds_read_b64_tr_b16 a[46:47], v15 offset:43008
v_mfma_f32_16x16x32_bf16 v[52:55], a[12:15], v[60:63], v[52:55]
buffer_load_dwordx4 v[116:119], v19, s[12:15], s39 offen offset:1024 sc1
s_waitcnt lgkmcnt(8)
v_mfma_f32_16x16x32_bf16 v[24:27], a[16:19], v[64:67], v[24:27]
ds_read_b64_tr_b16 a[0:1], v12 offset:45056
s_waitcnt vmcnt(8)
v_mfma_f32_16x16x32_bf16 v[40:43], a[16:19], v[68:71], v[40:43]
ds_read_b64_tr_b16 a[2:3], v12 offset:47104
v_max3_u32 v2, v72, v76, v80
v_mfma_f32_16x16x32_bf16 v[28:31], a[20:23], v[64:67], v[28:31]
ds_read_b64_tr_b16 a[4:5], v13 offset:45056
v_max_u32 v2, v2, v84
v_mfma_f32_16x16x32_bf16 v[44:47], a[20:23], v[68:71], v[44:47]
ds_read_b64_tr_b16 a[6:7], v13 offset:47104
v_cmp_eq_u32 vcc, -1, v2
v_mfma_f32_16x16x32_bf16 v[32:35], a[24:27], v[64:67], v[32:35]
ds_read_b64_tr_b16 a[8:9], v14 offset:45056
v_mfma_f32_16x16x32_bf16 v[48:51], a[24:27], v[68:71], v[48:51]
ds_read_b64_tr_b16 a[10:11], v14 offset:47104
v_mfma_f32_16x16x32_bf16 v[36:39], a[28:31], v[64:67], v[36:39]
ds_read_b64_tr_b16 a[12:13], v15 offset:45056
ds_read_b64_tr_b16 a[14:15], v15 offset:47104
v_mfma_f32_16x16x32_bf16 v[52:55], a[28:31], v[68:71], v[52:55]
s_cbranch_vccnz L_o13_rt
L_o13_ok:
s_waitcnt lgkmcnt(8)
v_mfma_f32_16x16x32_bf16 v[24:27], a[32:35], v[72:75], v[24:27]
ds_read_b64_tr_b16 a[16:17], v12 offset:49152
ds_read_b64_tr_b16 a[18:19], v12 offset:51200
v_mfma_f32_16x16x32_bf16 v[40:43], a[32:35], v[76:79], v[40:43]
v_mfma_f32_16x16x32_bf16 v[28:31], a[36:39], v[72:75], v[28:31]
ds_read_b64_tr_b16 a[20:21], v13 offset:49152
ds_read_b64_tr_b16 a[22:23], v13 offset:51200
v_mfma_f32_16x16x32_bf16 v[44:47], a[36:39], v[76:79], v[44:47]
v_mfma_f32_16x16x32_bf16 v[32:35], a[40:43], v[72:75], v[32:35]
ds_read_b64_tr_b16 a[24:25], v14 offset:49152
ds_read_b64_tr_b16 a[26:27], v14 offset:51200
v_mfma_f32_16x16x32_bf16 v[48:51], a[40:43], v[76:79], v[48:51]
v_mfma_f32_16x16x32_bf16 v[36:39], a[44:47], v[72:75], v[36:39]
ds_read_b64_tr_b16 a[28:29], v15 offset:49152
ds_read_b64_tr_b16 a[30:31], v15 offset:51200
v_mfma_f32_16x16x32_bf16 v[52:55], a[44:47], v[76:79], v[52:55]
s_waitcnt lgkmcnt(8)
v_mfma_f32_16x16x32_bf16 v[24:27], a[0:3], v[80:83], v[24:27]
ds_read_b64_tr_b16 a[32:33], v12 offset:53248
s_waitcnt vmcnt(4)
v_mfma_f32_16x16x32_bf16 v[40:43], a[0:3], v[84:87], v[40:43]
ds_read_b64_tr_b16 a[34:35], v12 offset:55296
v_max3_u32 v2, v88, v92, v96
v_mfma_f32_16x16x32_bf16 v[28:31], a[4:7], v[80:83], v[28:31]
ds_read_b64_tr_b16 a[36:37], v13 offset:53248
v_max_u32 v2, v2, v100
v_mfma_f32_16x16x32_bf16 v[44:47], a[4:7], v[84:87], v[44:47]
ds_read_b64_tr_b16 a[38:39], v13 offset:55296
v_cmp_eq_u32 vcc, -1, v2
v_mfma_f32_16x16x32_bf16 v[32:35], a[8:11], v[80:83], v[32:35]
ds_read_b64_tr_b16 a[40:41], v14 offset:53248
v_mfma_f32_16x16x32_bf16 v[48:51], a[8:11], v[84:87], v[48:51]
ds_read_b64_tr_b16 a[42:43], v14 offset:55296
v_mfma_f32_16x16x32_bf16 v[36:39], a[12:15], v[80:83], v[36:39]
ds_read_b64_tr_b16 a[44:45], v15 offset:53248
ds_read_b64_tr_b16 a[46:47], v15 offset:55296
v_mfma_f32_16x16x32_bf16 v[52:55], a[12:15], v[84:87], v[52:55]
s_cbranch_vccnz L_o14_rt
L_o14_ok:
s_waitcnt lgkmcnt(8)
v_mfma_f32_16x16x32_bf16 v[24:27], a[16:19], v[88:91], v[24:27]
ds_read_b64_tr_b16 a[0:1], v12 offset:57344
ds_read_b64_tr_b16 a[2:3], v12 offset:59392
v_mfma_f32_16x16x32_bf16 v[40:43], a[16:19], v[92:95], v[40:43]
v_mfma_f32_16x16x32_bf16 v[28:31], a[20:23], v[88:91], v[28:31]
ds_read_b64_tr_b16 a[4:5], v13 offset:57344
ds_read_b64_tr_b16 a[6:7], v13 offset:59392
v_mfma_f32_16x16x32_bf16 v[44:47], a[20:23], v[92:95], v[44:47]
v_mfma_f32_16x16x32_bf16 v[32:35], a[24:27], v[88:91], v[32:35]
ds_read_b64_tr_b16 a[8:9], v14 offset:57344
ds_read_b64_tr_b16 a[10:11], v14 offset:59392
v_mfma_f32_16x16x32_bf16 v[48:51], a[24:27], v[92:95], v[48:51]
v_mfma_f32_16x16x32_bf16 v[36:39], a[28:31], v[88:91], v[36:39]
ds_read_b64_tr_b16 a[12:13], v15 offset:57344
ds_read_b64_tr_b16 a[14:15], v15 offset:59392
v_mfma_f32_16x16x32_bf16 v[52:55], a[28:31], v[92:95], v[52:55]
s_waitcnt lgkmcnt(8)
v_mfma_f32_16x16x32_bf16 v[24:27], a[32:35], v[96:99], v[24:27]
ds_read_b64_tr_b16 a[16:17], v12 offset:61440
s_waitcnt vmcnt(0)
v_mfma_f32_16x16x32_bf16 v[40:43], a[32:35], v[100:103], v[40:43]
ds_read_b64_tr_b16 a[18:19], v12 offset:63488
v_max3_u32 v2, v104, v108, v112
v_mfma_f32_16x16x32_bf16 v[28:31], a[36:39], v[96:99], v[28:31]
ds_read_b64_tr_b16 a[20:21], v13 offset:61440
v_max_u32 v2, v2, v116
v_mfma_f32_16x16x32_bf16 v[44:47], a[36:39], v[100:103], v[44:47]
ds_read_b64_tr_b16 a[22:23], v13 offset:63488
v_cmp_eq_u32 vcc, -1, v2
v_mfma_f32_16x16x32_bf16 v[32:35], a[40:43], v[96:99], v[32:35]
ds_read_b64_tr_b16 a[24:25], v14 offset:61440
v_mfma_f32_16x16x32_bf16 v[48:51], a[40:43], v[100:103], v[48:51]
ds_read_b64_tr_b16 a[26:27], v14 offset:63488
v_mfma_f32_16x16x32_bf16 v[36:39], a[44:47], v[96:99], v[36:39]
ds_read_b64_tr_b16 a[28:29], v15 offset:61440
ds_read_b64_tr_b16 a[30:31], v15 offset:63488
v_mfma_f32_16x16x32_bf16 v[52:55], a[44:47], v[100:103], v[52:55]
s_cbranch_vccnz L_o15_rt
L_o15_ok:
s_waitcnt lgkmcnt(8)
v_mfma_f32_16x16x32_bf16 v[24:27], a[0:3], v[104:107], v[24:27]
v_mfma_f32_16x16x32_bf16 v[40:43], a[0:3], v[108:111], v[40:43]
v_mfma_f32_16x16x32_bf16 v[28:31], a[4:7], v[104:107], v[28:31]
v_mfma_f32_16x16x32_bf16 v[44:47], a[4:7], v[108:111], v[44:47]
v_mfma_f32_16x16x32_bf16 v[32:35], a[8:11], v[104:107], v[32:35]
v_mfma_f32_16x16x32_bf16 v[48:51], a[8:11], v[108:111], v[48:51]
v_mfma_f32_16x16x32_bf16 v[36:39], a[12:15], v[104:107], v[36:39]
v_mfma_f32_16x16x32_bf16 v[52:55], a[12:15], v[108:111], v[52:55]
s_waitcnt lgkmcnt(0)
v_mfma_f32_16x16x32_bf16 v[24:27], a[16:19], v[112:115], v[24:27]
v_mfma_f32_16x16x32_bf16 v[40:43], a[16:19], v[116:119], v[40:43]
v_mfma_f32_16x16x32_bf16 v[28:31], a[20:23], v[112:115], v[28:31]
v_mfma_f32_16x16x32_bf16 v[44:47], a[20:23], v[116:119], v[44:47]
v_mfma_f32_16x16x32_bf16 v[32:35], a[24:27], v[112:115], v[32:35]
v_mfma_f32_16x16x32_bf16 v[48:51], a[24:27], v[116:119], v[48:51]
v_mfma_f32_16x16x32_bf16 v[36:39], a[28:31], v[112:115], v[36:39]
v_mfma_f32_16x16x32_bf16 v[52:55], a[28:31], v[116:119], v[52:55]
s_nop 0
v_cvt_pk_bf16_f32 v128, v24, v25
v_cvt_pk_bf16_f32 v129, v26, v27
v_cvt_pk_bf16_f32 v130, v28, v29
v_cvt_pk_bf16_f32 v131, v30, v31
v_cvt_pk_bf16_f32 v132, v32, v33
v_cvt_pk_bf16_f32 v133, v34, v35
v_cvt_pk_bf16_f32 v134, v36, v37
v_cvt_pk_bf16_f32 v135, v38, v39
v_cvt_pk_bf16_f32 v136, v40, v41
v_cvt_pk_bf16_f32 v137, v42, v43
v_cvt_pk_bf16_f32 v138, v44, v45
v_cvt_pk_bf16_f32 v139, v46, v47
v_cvt_pk_bf16_f32 v140, v48, v49
v_cvt_pk_bf16_f32 v141, v50, v51
v_cvt_pk_bf16_f32 v142, v52, v53
v_cvt_pk_bf16_f32 v143, v54, v55
v_mfma_f32_16x16x32_bf16 v[80:83], v[128:131], v[128:131], 0
v_mfma_f32_16x16x32_bf16 v[72:75], v[120:123], v[128:131], 0
v_mfma_f32_16x16x32_bf16 v[80:83], v[132:135], v[132:135], v[80:83]
v_mfma_f32_16x16x32_bf16 v[72:75], v[124:127], v[132:135], v[72:75]
v_mfma_f32_16x16x32_bf16 v[84:87], v[136:139], v[136:139], 0
v_mfma_f32_16x16x32_bf16 v[76:79], v[120:123], v[136:139], 0
v_mfma_f32_16x16x32_bf16 v[84:87], v[140:143], v[140:143], v[84:87]
v_mfma_f32_16x16x32_bf16 v[76:79], v[124:127], v[140:143], v[76:79]
s_nop 2
v_cndmask_b32_e64 v80, v80, v81, s[80:81]
v_cndmask_b32_e64 v82, v82, v83, s[90:91]
s_or_b64 vcc, s[82:83], s[90:91]
v_mov_b32 v75, s68
v_cndmask_b32 v73, v80, v82, vcc
v_cndmask_b32_e64 v84, v84, v85, s[80:81]
v_cndmask_b32_e64 v86, v86, v87, s[90:91]
s_or_b64 vcc, s[82:83], s[90:91]
v_mov_b32 v79, s68
v_cndmask_b32 v77, v84, v86, vcc
s_mov_b64 exec, s[92:93]
s_cmp_eq_u32 s69, 0
s_cbranch_scc1 L_stp_s
buffer_store_dwordx4 v[72:75], v144, s[12:15], s72 offen offset:0
buffer_store_dwordx4 v[76:79], v144, s[12:15], s72 offen offset:256
L_stp_d:
s_mov_b64 exec, -1
s_add_u32 s70, s75, 0
buffer_load_dwordx4 v[96:99], v145, s[12:15], s70 offen sc1
s_add_u32 s70, s75, 4096
buffer_load_dwordx4 v[100:103], v145, s[12:15], s70 offen sc1
s_add_u32 s70, s75, 8192
buffer_load_dwordx4 v[104:107], v145, s[12:15], s70 offen sc1
s_add_u32 s70, s75, 12288
buffer_load_dwordx4 v[108:111], v145, s[12:15], s70 offen sc1
s_add_u32 s70, s75, 16384
buffer_load_dwordx4 v[112:115], v145, s[12:15], s70 offen sc1
s_add_u32 s70, s75, 20480
buffer_load_dwordx4 v[116:119], v145, s[12:15], s70 offen sc1
s_add_u32 s70, s75, 24576
buffer_load_dwordx4 v[120:123], v145, s[12:15], s70 offen sc1
s_add_u32 s70, s75, 28672
buffer_load_dwordx4 v[124:127], v145, s[12:15], s70 offen sc1
s_barrier
ds_write_b64 v20, v[128:129] offset:0
ds_write_b64 v21, v[130:131] offset:0
ds_write_b64 v22, v[132:133] offset:0
ds_write_b64 v23, v[134:135] offset:0
ds_write_b64 v20, v[136:137] offset:2048
ds_write_b64 v21, v[138:139] offset:2048
ds_write_b64 v22, v[140:141] offset:2048
ds_write_b64 v23, v[142:143] offset:2048
v_lshrrev_b32 v2, 3, v1
v_lshrrev_b32 v3, 4, v1
v_and_b32 v13, 7, v1
v_xor_b32 v3, v3, v13
v_lshlrev_b32 v3, 4, v3
v_lshl_add_u32 v3, v2, 7, v3
s_lshl_b32 s70, s60, 12
v_add_u32 v9, s70, v3
v_xor_b32 v10, 64, v9
v_lshlrev_b32 v11, 11, v2
v_lshl_add_u32 v11, v13, 4, v11
s_lshl_b32 s70, s60, 5
v_add_u32 v12, s70, v2
s_lshl_b32 s74, s64, 18
s_lshl_b32 s70, s60, 16
s_add_u32 s74, s74, s70
s_lshl_b32 s70, s65, 7
s_add_u32 s74, s74, s70
s_mov_b32 s80, 0xff00ff00
s_mov_b32 s81, 0xff00ff00
s_lshl_b32 s70, s60, 5
s_add_u32 s70, s70, 161920
v_mov_b32 v14, s70
v_add_u32 v15, 16, v14
v_add_u32 v8, 161920, v16
v_lshlrev_b32 v8, 4, v13
v_add_u32 v8, 161920, v8
s_waitcnt vmcnt(0)
L_st_chk:
v_xor_b32 v88, s68, v99
v_xor_b32 v89, s68, v103
v_xor_b32 v90, s68, v107
v_xor_b32 v91, s68, v111
v_xor_b32 v92, s68, v115
v_xor_b32 v93, s68, v119
v_xor_b32 v94, s68, v123
v_xor_b32 v95, s68, v127
v_or3_b32 v88, v88, v89, v90
v_or3_b32 v91, v91, v92, v93
v_or3_b32 v88, v88, v94, v95
v_or_b32 v88, v88, v91
v_cmp_ne_u32 vcc, 0, v88
s_cbranch_vccnz L_st_rt
L_st_ok:
v_pk_add_f32 v[96:97], v[96:97], v[100:101]
v_add_f32 v98, v98, v102
v_pk_add_f32 v[104:105], v[104:105], v[108:109]
v_add_f32 v106, v106, v110
v_pk_add_f32 v[112:113], v[112:113], v[116:117]
v_add_f32 v114, v114, v118
v_pk_add_f32 v[120:121], v[120:121], v[124:125]
v_add_f32 v122, v122, v126
v_pk_add_f32 v[96:97], v[96:97], v[104:105]
v_add_f32 v98, v98, v106
v_pk_add_f32 v[112:113], v[112:113], v[120:121]
v_add_f32 v114, v114, v122
v_pk_add_f32 v[96:97], v[96:97], v[112:113]
v_add_f32 v98, v98, v114
v_mov_b32 v100, v96
v_mov_b32 v101, v97
v_mov_b32 v102, v98
v_permlane32_swap_b32 v96, v100
v_permlane32_swap_b32 v97, v101
v_permlane32_swap_b32 v98, v102
v_add_f32 v96, v96, v100
v_add_f32 v97, v97, v101
v_add_f32 v98, v98, v102
v_mul_f32 v73, 0x3a800000, v96
v_mul_f32 v97, 0x3a800000, v97
v_fma_f32 v97, -v73, v73, v97
v_fma_f32 v98, -v73, s84, v98
v_max_f32 v97, 0, v97
v_add_f32 v97, 0x3727c5ac, v97
v_rsq_f32 v74, v97
v_mov_b32 v75, s68
v_mul_f32 v98, v98, v74
v_ashrrev_i32 v99, 31, v98
v_or_b32 v99, 0x80000000, v99
v_xor_b32 v98, v98, v99
s_mov_b32 s70, 0xfffff800
v_and_or_b32 v72, v98, s70, v146
s_nop 1
v_mov_b32_dpp v78, v72 row_ror:1 row_mask:0xf bank_mask:0xf
v_max_u32 v76, v72, v78
v_min_u32 v77, v72, v78
s_nop 0
v_mov_b32_dpp v78, v76 row_ror:2 row_mask:0xf bank_mask:0xf
v_max_u32_dpp v79, v77, v77 row_ror:2 row_mask:0xf bank_mask:0xf
v_med3_u32 v77, v76, v78, v79
v_max_u32 v76, v76, v78
s_nop 1
v_mov_b32_dpp v78, v76 row_ror:4 row_mask:0xf bank_mask:0xf
v_max_u32_dpp v79, v77, v77 row_ror:4 row_mask:0xf bank_mask:0xf
v_med3_u32 v77, v76, v78, v79
v_max_u32 v76, v76, v78
s_nop 1
v_mov_b32_dpp v78, v76 row_ror:8 row_mask:0xf bank_mask:0xf
v_max_u32_dpp v79, v77, v77 row_ror:8 row_mask:0xf bank_mask:0xf
v_med3_u32 v77, v76, v78, v79
v_max_u32 v76, v76, v78
v_mov_b32 v78, v76
v_mov_b32 v79, v77
s_nop 0
v_permlane16_swap_b32 v76, v78
v_permlane16_swap_b32 v77, v79
v_max_u32 v79, v77, v79
v_med3_u32 v77, v76, v78, v79
v_max_u32 v76, v76, v78
v_cmp_eq_u32 vcc, v72, v77
v_cmp_eq_u32_e64 s[92:93], v72, v76
s_nop 0
v_cndmask_b32 v2, v14, v15, vcc
s_or_b64 exec, vcc, s[92:93]
ds_write_b128 v2, v[72:75]
s_mov_b64 exec, -1
v_cndmask_b32_e64 v5, v76, v77, s[80:81]
v_not_b32 v5, v5
v_bfe_u32 v6, v5, 1, 3
v_and_b32 v5, 127, v5
v_xor_b32 v6, v6, v13
v_lshlrev_b32 v6, 4, v6
v_lshl_add_u32 v6, v5, 7, v6
ds_read_b128 v[88:91], v6
v_readfirstlane_b32 s86, v77
v_readfirstlane_b32 s85, v76
v_add_f32 v80, 1.0, v74
v_mul_f32_e64 v56, -v73, v74
v_mov_b32 v82, v80
v_mov_b32 v58, v56
s_nop 0
v_permlane16_swap_b32 v80, v82
v_permlane16_swap_b32 v56, v58
s_waitcnt lgkmcnt(1)
s_barrier
s_sub_u32 s70, s64, s65
s_or_b32 s70, s70, s60
s_cbranch_scc1 L_norec
ds_read_b128 v[92:95], v8
s_waitcnt lgkmcnt(0)
buffer_store_dwordx4 v[92:95], v11, s[12:15], s87 offen sc1
L_norec:
s_mov_b64 exec, 0xffff
s_waitcnt lgkmcnt(0)
buffer_store_dwordx4 v[88:91], v147, s[12:15], s88 offen sc1
s_mov_b64 exec, -1
s_not_b32 s95, s86
s_and_b32 s95, s95, 127
s_not_b32 s94, s85
s_and_b32 s94, s94, 127
v_pk_fma_f32 v[24:25], v[24:25], v[80:81], v[56:57] op_sel_hi:[1,0,0]
v_pk_fma_f32 v[26:27], v[26:27], v[80:81], v[56:57] op_sel_hi:[1,0,0]
v_cvt_pk_bf16_f32 v128, v24, v25
v_cvt_pk_bf16_f32 v129, v26, v27
ds_write_b64 v20, v[128:129] offset:32768
v_pk_fma_f32 v[28:29], v[28:29], v[80:81], v[56:57] op_sel_hi:[1,0,0]
v_pk_fma_f32 v[30:31], v[30:31], v[80:81], v[56:57] op_sel_hi:[1,0,0]
v_cvt_pk_bf16_f32 v130, v28, v29
v_cvt_pk_bf16_f32 v131, v30, v31
ds_write_b64 v21, v[130:131] offset:32768
v_pk_fma_f32 v[32:33], v[32:33], v[80:81], v[56:57] op_sel_hi:[1,0,0]
v_pk_fma_f32 v[34:35], v[34:35], v[80:81], v[56:57] op_sel_hi:[1,0,0]
v_cvt_pk_bf16_f32 v132, v32, v33
v_cvt_pk_bf16_f32 v133, v34, v35
ds_write_b64 v22, v[132:133] offset:32768
v_pk_fma_f32 v[36:37], v[36:37], v[80:81], v[56:57] op_sel_hi:[1,0,0]
v_pk_fma_f32 v[38:39], v[38:39], v[80:81], v[56:57] op_sel_hi:[1,0,0]
v_cvt_pk_bf16_f32 v134, v36, v37
v_cvt_pk_bf16_f32 v135, v38, v39
ds_write_b64 v23, v[134:135] offset:32768
v_pk_fma_f32 v[40:41], v[40:41], v[82:83], v[58:59] op_sel_hi:[1,0,0]
v_pk_fma_f32 v[42:43], v[42:43], v[82:83], v[58:59] op_sel_hi:[1,0,0]
v_cvt_pk_bf16_f32 v136, v40, v41
v_cvt_pk_bf16_f32 v137, v42, v43
ds_write_b64 v20, v[136:137] offset:34816
v_pk_fma_f32 v[44:45], v[44:45], v[82:83], v[58:59] op_sel_hi:[1,0,0]
v_pk_fma_f32 v[46:47], v[46:47], v[82:83], v[58:59] op_sel_hi:[1,0,0]
v_cvt_pk_bf16_f32 v138, v44, v45
v_cvt_pk_bf16_f32 v139, v46, v47
ds_write_b64 v21, v[138:139] offset:34816
v_pk_fma_f32 v[48:49], v[48:49], v[82:83], v[58:59] op_sel_hi:[1,0,0]
v_pk_fma_f32 v[50:51], v[50:51], v[82:83], v[58:59] op_sel_hi:[1,0,0]
v_cvt_pk_bf16_f32 v140, v48, v49
v_cvt_pk_bf16_f32 v141, v50, v51
ds_write_b64 v22, v[140:141] offset:34816
v_pk_fma_f32 v[52:53], v[52:53], v[82:83], v[58:59] op_sel_hi:[1,0,0]
v_pk_fma_f32 v[54:55], v[54:55], v[82:83], v[58:59] op_sel_hi:[1,0,0]
v_cvt_pk_bf16_f32 v142, v52, v53
v_cvt_pk_bf16_f32 v143, v54, v55
ds_write_b64 v23, v[142:143] offset:34816
s_waitcnt lgkmcnt(0)
ds_read_b128 v[96:99], v9 offset:32768
ds_read_b128 v[100:103], v10 offset:33792
ds_read_b128 v[104:107], v9 offset:34816
ds_read_b128 v[108:111], v10 offset:35840
v_add_u32 v2, 0, v12
v_cmp_ne_u32 vcc, s94, v2
v_cmp_ne_u32_e64 s[92:93], s95, v2
s_add_u32 s70, s74, 0
s_waitcnt lgkmcnt(3)
s_and_b64 exec, vcc, s[92:93]
buffer_store_dwordx4 v[96:99], v11, s[20:23], s70 offen nt
s_mov_b64 exec, -1
v_add_u32 v2, 8, v12
v_cmp_ne_u32 vcc, s94, v2
v_cmp_ne_u32_e64 s[92:93], s95, v2
s_add_u32 s70, s74, 16384
s_waitcnt lgkmcnt(2)
s_and_b64 exec, vcc, s[92:93]
buffer_store_dwordx4 v[100:103], v11, s[20:23], s70 offen nt
s_mov_b64 exec, -1
v_add_u32 v2, 16, v12
v_cmp_ne_u32 vcc, s94, v2
v_cmp_ne_u32_e64 s[92:93], s95, v2
s_add_u32 s70, s74, 32768
s_waitcnt lgkmcnt(1)
s_and_b64 exec, vcc, s[92:93]
buffer_store_dwordx4 v[104:107], v11, s[20:23], s70 offen nt
s_mov_b64 exec, -1
v_add_u32 v2, 24, v12
v_cmp_ne_u32 vcc, s94, v2
v_cmp_ne_u32_e64 s[92:93], s95, v2
s_add_u32 s70, s74, 49152
s_waitcnt lgkmcnt(0)
s_and_b64 exec, vcc, s[92:93]
buffer_store_dwordx4 v[108:111], v11, s[20:23], s70 offen nt
s_mov_b64 exec, -1
v_mov_b32 v2, 161792
s_barrier
ds_read_b32 v3, v2
ds_read_b32 v4, v2 offset:16
s_waitcnt lgkmcnt(0)
v_readfirstlane_b32 s72, v3
v_readfirstlane_b32 s73, v4
s_cmp_eq_u32 s85, s72
s_cselect_b32 s94, 255, s94
s_cmp_eq_u32 s85, s73
s_cselect_b32 s94, 255, s94
s_cmp_eq_u32 s86, s72
s_cselect_b32 s95, 255, s95
s_cmp_eq_u32 s86, s73
s_cselect_b32 s95, 255, s95
v_add_u32 v2, 0, v12
v_cmp_eq_u32 vcc, s94, v2
v_cmp_eq_u32_e64 s[92:93], s95, v2
s_add_u32 s70, s74, 0
s_or_b64 exec, vcc, s[92:93]
s_cbranch_execz L_nodef0
buffer_store_dwordx4 v[96:99], v11, s[20:23], s70 offen nt
L_nodef0:
s_mov_b64 exec, -1
v_add_u32 v2, 8, v12
v_cmp_eq_u32 vcc, s94, v2
v_cmp_eq_u32_e64 s[92:93], s95, v2
s_add_u32 s70, s74, 16384
s_or_b64 exec, vcc, s[92:93]
s_cbranch_execz L_nodef1
buffer_store_dwordx4 v[100:103], v11, s[20:23], s70 offen nt
L_nodef1:
s_mov_b64 exec, -1
v_add_u32 v2, 16, v12
v_cmp_eq_u32 vcc, s94, v2
v_cmp_eq_u32_e64 s[92:93], s95, v2
s_add_u32 s70, s74, 32768
s_or_b64 exec, vcc, s[92:93]
s_cbranch_execz L_nodef2
buffer_store_dwordx4 v[104:107], v11, s[20:23], s70 offen nt
L_nodef2:
s_mov_b64 exec, -1
v_add_u32 v2, 24, v12
v_cmp_eq_u32 vcc, s94, v2
v_cmp_eq_u32_e64 s[92:93], s95, v2
s_add_u32 s70, s74, 49152
s_or_b64 exec, vcc, s[92:93]
s_cbranch_execz L_nodef3
buffer_store_dwordx4 v[108:111], v11, s[20:23], s70 offen nt
L_nodef3:
s_mov_b64 exec, -1
L_end:
s_endpgm
L_eg_rt:
s_add_u32 s78, s78, 1
s_cmp_gt_u32 s78, 65536
s_cbranch_scc1 L_eg_ok
s_add_u32 s70, s87, 0
buffer_load_dwordx4 v[20:23], v44, s[12:15], s70 offen sc1
buffer_load_dwordx4 v[36:39], v45, s[12:15], s88 offen sc1
buffer_load_dwordx4 v[40:43], v46, s[12:15], 0 offen offset:0 sc1
s_waitcnt vmcnt(0)
s_branch L_eg_chk
L_pad8:
s_branch L_retF
L_kvrt:
s_add_u32 s78, s78, 1
s_cmp_gt_u32 s78, 65536
s_cbranch_scc1 L_kvok
s_bitcmp1_b32 s73, 0
s_cbranch_scc0 L_kvn0
v_cmp_eq_u32 vcc, -1, v84
s_cbranch_vccz L_kv0_p0
s_add_u32 s70, s65, 1
s_and_b32 s70, s70, 15
s_mul_i32 s70, s70, 4352
s_add_u32 s70, s70, s87
buffer_load_dwordx4 v[84:87], v18, s[12:15], s70 offen sc1
L_kv0_p0:
v_cmp_eq_u32 vcc, -1, v88
s_cbranch_vccz L_kv0_p1
s_add_u32 s70, s65, 2
s_and_b32 s70, s70, 15
s_mul_i32 s70, s70, 4352
s_add_u32 s70, s70, s87
buffer_load_dwordx4 v[88:91], v18, s[12:15], s70 offen sc1
L_kv0_p1:
v_cmp_eq_u32 vcc, -1, v92
s_cbranch_vccz L_kv0_p2
s_add_u32 s70, s65, 3
s_and_b32 s70, s70, 15
s_mul_i32 s70, s70, 4352
s_add_u32 s70, s70, s87
buffer_load_dwordx4 v[92:95], v18, s[12:15], s70 offen sc1
L_kv0_p2:
v_cmp_eq_u32 vcc, -1, v96
s_cbranch_vccz L_kv0_p3
s_add_u32 s70, s65, 4
s_and_b32 s70, s70, 15
s_mul_i32 s70, s70, 4352
s_add_u32 s70, s70, s87
buffer_load_dwordx4 v[96:99], v18, s[12:15], s70 offen sc1
L_kv0_p3:
L_kvn0:
s_bitcmp1_b32 s73, 1
s_cbranch_scc0 L_kvn1
v_cmp_eq_u32 vcc, -1, v100
s_cbranch_vccz L_kv1_p0
s_add_u32 s70, s65, 5
s_and_b32 s70, s70, 15
s_mul_i32 s70, s70, 4352
s_add_u32 s70, s70, s87
buffer_load_dwordx4 v[100:103], v18, s[12:15], s70 offen sc1
L_kv1_p0:
v_cmp_eq_u32 vcc, -1, v104
s_cbranch_vccz L_kv1_p1
s_add_u32 s70, s65, 6
s_and_b32 s70, s70, 15
s_mul_i32 s70, s70, 4352
s_add_u32 s70, s70, s87
buffer_load_dwordx4 v[104:107], v18, s[12:15], s70 offen sc1
L_kv1_p1:
v_cmp_eq_u32 vcc, -1, v108
s_cbranch_vccz L_kv1_p2
s_add_u32 s70, s65, 7
s_and_b32 s70, s70, 15
s_mul_i32 s70, s70, 4352
s_add_u32 s70, s70, s87
buffer_load_dwordx4 v[108:111], v18, s[12:15], s70 offen sc1
L_kv1_p2:
v_cmp_eq_u32 vcc, -1, v112
s_cbranch_vccz L_kv1_p3
s_add_u32 s70, s65, 8
s_and_b32 s70, s70, 15
s_mul_i32 s70, s70, 4352
s_add_u32 s70, s70, s87
buffer_load_dwordx4 v[112:115], v18, s[12:15], s70 offen sc1
L_kv1_p3:
L_kvn1:
s_bitcmp1_b32 s73, 2
s_cbranch_scc0 L_kvn2
v_cmp_eq_u32 vcc, -1, v116
s_cbranch_vccz L_kv2_p0
s_add_u32 s70, s65, 9
s_and_b32 s70, s70, 15
s_mul_i32 s70, s70, 4352
s_add_u32 s70, s70, s87
buffer_load_dwordx4 v[116:119], v18, s[12:15], s70 offen sc1
L_kv2_p0:
v_cmp_eq_u32 vcc, -1, v120
s_cbranch_vccz L_kv2_p1
s_add_u32 s70, s65, 10
s_and_b32 s70, s70, 15
s_mul_i32 s70, s70, 4352
s_add_u32 s70, s70, s87
buffer_load_dwordx4 v[120:123], v18, s[12:15], s70 offen sc1
L_kv2_p1:
v_cmp_eq_u32 vcc, -1, v124
s_cbranch_vccz L_kv2_p2
s_add_u32 s70, s65, 11
s_and_b32 s70, s70, 15
s_mul_i32 s70, s70, 4352
s_add_u32 s70, s70, s87
buffer_load_dwordx4 v[124:127], v18, s[12:15], s70 offen sc1
L_kv2_p2:
v_cmp_eq_u32 vcc, -1, v128
s_cbranch_vccz L_kv2_p3
s_add_u32 s70, s65, 12
s_and_b32 s70, s70, 15
s_mul_i32 s70, s70, 4352
s_add_u32 s70, s70, s87
buffer_load_dwordx4 v[128:131], v18, s[12:15], s70 offen sc1
L_kv2_p3:
L_kvn2:
s_bitcmp1_b32 s73, 3
s_cbranch_scc0 L_kvn3
v_cmp_eq_u32 vcc, -1, v132
s_cbranch_vccz L_kv3_p0
s_add_u32 s70, s65, 13
s_and_b32 s70, s70, 15
s_mul_i32 s70, s70, 4352
s_add_u32 s70, s70, s87
buffer_load_dwordx4 v[132:135], v18, s[12:15], s70 offen sc1
L_kv3_p0:
v_cmp_eq_u32 vcc, -1, v136
s_cbranch_vccz L_kv3_p1
s_add_u32 s70, s65, 14
s_and_b32 s70, s70, 15
s_mul_i32 s70, s70, 4352
s_add_u32 s70, s70, s87
buffer_load_dwordx4 v[136:139], v18, s[12:15], s70 offen sc1
L_kv3_p1:
v_cmp_eq_u32 vcc, -1, v140
s_cbranch_vccz L_kv3_p2
s_add_u32 s70, s65, 15
s_and_b32 s70, s70, 15
s_mul_i32 s70, s70, 4352
s_add_u32 s70, s70, s87
buffer_load_dwordx4 v[140:143], v18, s[12:15], s70 offen sc1
L_kv3_p2:
v_cmp_eq_u32 vcc, -1, v144
s_cbranch_vccz L_kv3_p3
s_add_u32 s70, s65, 16
s_and_b32 s70, s70, 15
s_mul_i32 s70, s70, 4352
s_add_u32 s70, s70, s87
buffer_load_dwordx4 v[144:147], v18, s[12:15], s70 offen sc1
L_kv3_p3:
L_kvn3:
s_bitcmp1_b32 s73, 4
s_cbranch_scc0 L_kvn4
buffer_load_dwordx4 v[148:151], v55, s[12:15], s88 offen sc1
L_kvn4:
s_waitcnt vmcnt(0)
s_branch L_kvr
L_pad9:
s_branch L_pad13
L_pksame:
s_cmp_eq_u32 s73, 0
s_cbranch_scc1 L_pkf
s_add_u32 s78, s78, 1
s_cmp_le_u32 s78, 65536
s_cbranch_scc1 L_pk
s_branch L_pkf
L_pkx_rt:
s_add_u32 s78, s78, 1
s_cmp_gt_u32 s78, 65536
s_cbranch_scc1 L_pkx_ok
s_mov_b64 exec, s[92:93]
buffer_load_dwordx4 v[24:27], v58, s[12:15], 0 offen offset:0 sc1
buffer_load_dwordx4 v[28:31], v58, s[12:15], 0 offen offset:64 sc1
buffer_load_dwordx4 v[32:35], v58, s[12:15], 0 offen offset:128 sc1
buffer_load_dwordx4 v[36:39], v58, s[12:15], 0 offen offset:192 sc1
buffer_load_dwordx4 v[40:43], v58, s[12:15], 0 offen offset:256 sc1
buffer_load_dwordx4 v[44:47], v58, s[12:15], 0 offen offset:320 sc1
buffer_load_dwordx4 v[48:51], v58, s[12:15], 0 offen offset:384 sc1
buffer_load_dwordx4 v[52:55], v58, s[12:15], 0 offen offset:448 sc1
s_mov_b64 exec, -1
s_waitcnt vmcnt(0)
s_branch L_pkx_chk
L_pxp_s:
buffer_store_dwordx4 v[84:87], v60, s[12:15], s85 offen sc1
s_branch L_pxp_d
L_pad10:
s_branch L_pad14
L_px_rt:
s_add_u32 s78, s78, 1
s_cmp_gt_u32 s78, 65536
s_branch L_over11
L_pad11:
s_branch L_pad15
L_over11:
s_cbranch_scc1 L_px_ok
v_and_b32 v2, s91, v24
v_cmp_ne_u32 vcc, 0, v2
v_xor_b32 v24, s84, v24
s_cbranch_vccz L_px_p0
buffer_load_dwordx4 v[24:27], v61, s[12:15], s86 offen offset:0 sc1
L_px_p0:
v_and_b32 v2, s91, v28
v_cmp_ne_u32 vcc, 0, v2
v_xor_b32 v28, s84, v28
s_cbranch_vccz L_px_p1
buffer_load_dwordx4 v[28:31], v61, s[12:15], s86 offen offset:1024 sc1
L_px_p1:
v_and_b32 v2, s91, v32
v_cmp_ne_u32 vcc, 0, v2
v_xor_b32 v32, s84, v32
s_cbranch_vccz L_px_p2
buffer_load_dwordx4 v[32:35], v61, s[12:15], s86 offen offset:2048 sc1
L_px_p2:
v_and_b32 v2, s91, v36
v_cmp_ne_u32 vcc, 0, v2
v_xor_b32 v36, s84, v36
s_cbranch_vccz L_px_p3
buffer_load_dwordx4 v[36:39], v61, s[12:15], s86 offen offset:3072 sc1
L_px_p3:
s_waitcnt vmcnt(0)
s_branch L_px_chk
L_h_rt:
s_add_u32 s78, s78, 1
s_cmp_gt_u32 s78, 65536
s_cbranch_scc1 L_h_ok
buffer_load_dwordx2 v[84:85], v64, s[12:15], s72 offen sc1
s_waitcnt vmcnt(0)
s_branch L_h_chk
L_pad12:
s_branch L_retG
L_y_rt:
s_add_u32 s78, s78, 1
s_cmp_gt_u32 s78, 65536
s_cbranch_scc1 L_y_ok
v_mov_b32 v88, s84
v_and_b32 v2, s91, v120
v_cmp_ne_u32 vcc, 0, v2
v_xor_b32 v120, s84, v120
s_cbranch_vccz L_y_p0
buffer_load_dwordx4 v[120:123], v18, s[12:15], s88 offen offset:0 sc1
L_y_p0:
v_and_b32 v2, s91, v124
v_cmp_ne_u32 vcc, 0, v2
v_xor_b32 v124, s84, v124
s_cbranch_vccz L_y_p1
buffer_load_dwordx4 v[124:127], v18, s[12:15], s88 offen offset:1024 sc1
L_y_p1:
v_and_b32 v2, s91, v128
v_cmp_ne_u32 vcc, 0, v2
v_xor_b32 v128, s84, v128
s_cbranch_vccz L_y_p2
buffer_load_dwordx4 v[128:131], v18, s[12:15], s88 offen offset:2048 sc1
L_y_p2:
v_and_b32 v2, s91, v132
v_cmp_ne_u32 vcc, 0, v2
v_xor_b32 v132, s84, v132
s_cbranch_vccz L_y_p3
buffer_load_dwordx4 v[132:135], v18, s[12:15], s88 offen offset:3072 sc1
L_y_p3:
v_and_b32 v2, s91, v136
v_cmp_ne_u32 vcc, 0, v2
v_xor_b32 v136, s84, v136
s_cbranch_vccz L_y_p4
buffer_load_dwordx4 v[136:139], v18, s[12:15], s71 offen offset:0 sc1
L_y_p4:
v_and_b32 v2, s91, v140
v_cmp_ne_u32 vcc, 0, v2
v_xor_b32 v140, s84, v140
s_cbranch_vccz L_y_p5
buffer_load_dwordx4 v[140:143], v18, s[12:15], s71 offen offset:1024 sc1
L_y_p5:
v_and_b32 v2, s91, v144
v_cmp_ne_u32 vcc, 0, v2
v_xor_b32 v144, s84, v144
s_cbranch_vccz L_y_p6
buffer_load_dwordx4 v[144:147], v18, s[12:15], s71 offen offset:2048 sc1
L_y_p6:
s_waitcnt vmcnt(0)
s_branch L_y_chk
L_kvp_s:
buffer_store_dwordx4 v[140:143], v16, s[12:15], s72 offen sc1
s_mov_b64 exec, s[92:93]
buffer_store_dwordx4 v[136:139], v4, s[12:15], s73 offen sc1
s_mov_b64 exec, -1
s_branch L_kvp_d
L_pad13:
s_branch L_retG
L_o0_rt:
s_add_u32 s78, s78, 1
s_cmp_gt_u32 s78, 65536
s_cbranch_scc1 L_o0_ok
buffer_load_dwordx4 v[56:59], v6, s[12:15], s24 offen offset:0 sc1
buffer_load_dwordx4 v[60:63], v19, s[12:15], s24 offen offset:0 sc1
buffer_load_dwordx4 v[64:67], v6, s[12:15], s24 offen offset:1024 sc1
buffer_load_dwordx4 v[68:71], v19, s[12:15], s24 offen offset:1024 sc1
s_waitcnt vmcnt(4)
v_max3_u32 v2, v72, v76, v80
v_max3_u32 v2, v2, v84, v88
v_max3_u32 v2, v2, v92, v96
v_max3_u32 v2, v2, v100, v100
v_cmp_eq_u32 vcc, -1, v2
s_cbranch_vccz L_o0_a
buffer_load_dwordx4 v[72:75], v6, s[12:15], s25 offen offset:0 sc1
buffer_load_dwordx4 v[76:79], v19, s[12:15], s25 offen offset:0 sc1
buffer_load_dwordx4 v[80:83], v6, s[12:15], s25 offen offset:1024 sc1
buffer_load_dwordx4 v[84:87], v19, s[12:15], s25 offen offset:1024 sc1
buffer_load_dwordx4 v[88:91], v6, s[12:15], s26 offen offset:0 sc1
buffer_load_dwordx4 v[92:95], v19, s[12:15], s26 offen offset:0 sc1
buffer_load_dwordx4 v[96:99], v6, s[12:15], s26 offen offset:1024 sc1
buffer_load_dwordx4 v[100:103], v19, s[12:15], s26 offen offset:1024 sc1
s_waitcnt vmcnt(8)
s_branch L_o0_b
L_o0_a:
s_waitcnt vmcnt(0)
L_o0_b:
v_max3_u32 v2, v56, v60, v64
v_max_u32 v2, v2, v68
v_cmp_eq_u32 vcc, -1, v2
s_cbranch_vccnz L_o0_rt
s_branch L_o0_ok
s_endpgm
L_pad14:
s_branch L_retG
L_o1_rt:
s_add_u32 s78, s78, 1
s_cmp_gt_u32 s78, 65536
s_cbranch_scc1 L_o1_ok
buffer_load_dwordx4 v[72:75], v6, s[12:15], s25 offen offset:0 sc1
buffer_load_dwordx4 v[76:79], v19, s[12:15], s25 offen offset:0 sc1
buffer_load_dwordx4 v[80:83], v6, s[12:15], s25 offen offset:1024 sc1
buffer_load_dwordx4 v[84:87], v19, s[12:15], s25 offen offset:1024 sc1
s_waitcnt vmcnt(4)
v_max3_u32 v2, v88, v92, v96
v_max3_u32 v2, v2, v100, v104
v_max3_u32 v2, v2, v108, v112
v_max3_u32 v2, v2, v116, v116
v_cmp_eq_u32 vcc, -1, v2
s_cbranch_vccz L_o1_a
buffer_load_dwordx4 v[88:91], v6, s[12:15], s26 offen offset:0 sc1
buffer_load_dwordx4 v[92:95], v19, s[12:15], s26 offen offset:0 sc1
buffer_load_dwordx4 v[96:99], v6, s[12:15], s26 offen offset:1024 sc1
buffer_load_dwordx4 v[100:103], v19, s[12:15], s26 offen offset:1024 sc1
buffer_load_dwordx4 v[104:107], v6, s[12:15], s27 offen offset:0 sc1
buffer_load_dwordx4 v[108:111], v19, s[12:15], s27 offen offset:0 sc1
buffer_load_dwordx4 v[112:115], v6, s[12:15], s27 offen offset:1024 sc1
buffer_load_dwordx4 v[116:119], v19, s[12:15], s27 offen offset:1024 sc1
s_waitcnt vmcnt(8)
s_branch L_o1_b
L_o1_a:
s_waitcnt vmcnt(0)
L_o1_b:
v_max3_u32 v2, v72, v76, v80
v_max_u32 v2, v2, v84
v_cmp_eq_u32 vcc, -1, v2
s_cbranch_vccnz L_o1_rt
s_branch L_o1_ok
L_o2_rt:
s_add_u32 s78, s78, 1
s_cmp_gt_u32 s78, 65536
s_cbranch_scc1 L_o2_ok
buffer_load_dwordx4 v[88:91], v6, s[12:15], s26 offen offset:0 sc1
buffer_load_dwordx4 v[92:95], v19, s[12:15], s26 offen offset:0 sc1
buffer_load_dwordx4 v[96:99], v6, s[12:15], s26 offen offset:1024 sc1
buffer_load_dwordx4 v[100:103], v19, s[12:15], s26 offen offset:1024 sc1
s_waitcnt vmcnt(4)
v_max3_u32 v2, v104, v108, v112
v_max3_u32 v2, v2, v116, v56
v_max3_u32 v2, v2, v60, v64
v_max3_u32 v2, v2, v68, v68
v_cmp_eq_u32 vcc, -1, v2
s_cbranch_vccz L_o2_a
buffer_load_dwordx4 v[104:107], v6, s[12:15], s27 offen offset:0 sc1
buffer_load_dwordx4 v[108:111], v19, s[12:15], s27 offen offset:0 sc1
buffer_load_dwordx4 v[112:115], v6, s[12:15], s27 offen offset:1024 sc1
buffer_load_dwordx4 v[116:119], v19, s[12:15], s27 offen offset:1024 sc1
buffer_load_dwordx4 v[56:59], v6, s[12:15], s28 offen offset:0 sc1
buffer_load_dwordx4 v[60:63], v19, s[12:15], s28 offen offset:0 sc1
buffer_load_dwordx4 v[64:67], v6, s[12:15], s28 offen offset:1024 sc1
buffer_load_dwordx4 v[68:71], v19, s[12:15], s28 offen offset:1024 sc1
s_waitcnt vmcnt(8)
s_branch L_o2_b
L_o2_a:
s_waitcnt vmcnt(0)
L_o2_b:
v_max3_u32 v2, v88, v92, v96
v_max_u32 v2, v2, v100
v_cmp_eq_u32 vcc, -1, v2
s_cbranch_vccnz L_o2_rt
s_branch L_o2_ok
L_o3_rt:
s_add_u32 s78, s78, 1
s_cmp_gt_u32 s78, 65536
s_cbranch_scc1 L_o3_ok
buffer_load_dwordx4 v[104:107], v6, s[12:15], s27 offen offset:0 sc1
buffer_load_dwordx4 v[108:111], v19, s[12:15], s27 offen offset:0 sc1
buffer_load_dwordx4 v[112:115], v6, s[12:15], s27 offen offset:1024 sc1
buffer_load_dwordx4 v[116:119], v19, s[12:15], s27 offen offset:1024 sc1
s_waitcnt vmcnt(4)
v_max3_u32 v2, v56, v60, v64
v_max3_u32 v2, v2, v68, v72
v_max3_u32 v2, v2, v76, v80
v_max3_u32 v2, v2, v84, v84
v_cmp_eq_u32 vcc, -1, v2
s_cbranch_vccz L_o3_a
buffer_load_dwordx4 v[56:59], v6, s[12:15], s28 offen offset:0 sc1
buffer_load_dwordx4 v[60:63], v19, s[12:15], s28 offen offset:0 sc1
buffer_load_dwordx4 v[64:67], v6, s[12:15], s28 offen offset:1024 sc1
buffer_load_dwordx4 v[68:71], v19, s[12:15], s28 offen offset:1024 sc1
buffer_load_dwordx4 v[72:75], v6, s[12:15], s29 offen offset:0 sc1
buffer_load_dwordx4 v[76:79], v19, s[12:15], s29 offen offset:0 sc1
buffer_load_dwordx4 v[80:83], v6, s[12:15], s29 offen offset:1024 sc1
buffer_load_dwordx4 v[84:87], v19, s[12:15], s29 offen offset:1024 sc1
s_waitcnt vmcnt(8)
s_branch L_o3_b
L_o3_a:
s_waitcnt vmcnt(0)
L_o3_b:
v_max3_u32 v2, v104, v108, v112
v_max_u32 v2, v2, v116
v_cmp_eq_u32 vcc, -1, v2
s_cbranch_vccnz L_o3_rt
s_branch L_o3_ok
L_o4_rt:
s_add_u32 s78, s78, 1
s_cmp_gt_u32 s78, 65536
s_cbranch_scc1 L_o4_ok
buffer_load_dwordx4 v[56:59], v6, s[12:15], s28 offen offset:0 sc1
buffer_load_dwordx4 v[60:63], v19, s[12:15], s28 offen offset:0 sc1
buffer_load_dwordx4 v[64:67], v6, s[12:15], s28 offen offset:1024 sc1
buffer_load_dwordx4 v[68:71], v19, s[12:15], s28 offen offset:1024 sc1
s_waitcnt vmcnt(4)
v_max3_u32 v2, v72, v76, v80
v_max3_u32 v2, v2, v84, v88
v_max3_u32 v2, v2, v92, v96
v_max3_u32 v2, v2, v100, v100
v_cmp_eq_u32 vcc, -1, v2
s_cbranch_vccz L_o4_a
buffer_load_dwordx4 v[72:75], v6, s[12:15], s29 offen offset:0 sc1
buffer_load_dwordx4 v[76:79], v19, s[12:15], s29 offen offset:0 sc1
buffer_load_dwordx4 v[80:83], v6, s[12:15], s29 offen offset:1024 sc1
buffer_load_dwordx4 v[84:87], v19, s[12:15], s29 offen offset:1024 sc1
buffer_load_dwordx4 v[88:91], v6, s[12:15], s30 offen offset:0 sc1
buffer_load_dwordx4 v[92:95], v19, s[12:15], s30 offen offset:0 sc1
buffer_load_dwordx4 v[96:99], v6, s[12:15], s30 offen offset:1024 sc1
buffer_load_dwordx4 v[100:103], v19, s[12:15], s30 offen offset:1024 sc1
s_waitcnt vmcnt(8)
s_branch L_o4_b
L_o4_a:
s_waitcnt vmcnt(0)
L_o4_b:
v_max3_u32 v2, v56, v60, v64
v_max_u32 v2, v2, v68
v_cmp_eq_u32 vcc, -1, v2
s_cbranch_vccnz L_o4_rt
s_branch L_o4_ok
L_o5_rt:
s_add_u32 s78, s78, 1
s_cmp_gt_u32 s78, 65536
s_cbranch_scc1 L_o5_ok
buffer_load_dwordx4 v[72:75], v6, s[12:15], s29 offen offset:0 sc1
buffer_load_dwordx4 v[76:79], v19, s[12:15], s29 offen offset:0 sc1
buffer_load_dwordx4 v[80:83], v6, s[12:15], s29 offen offset:1024 sc1
buffer_load_dwordx4 v[84:87], v19, s[12:15], s29 offen offset:1024 sc1
s_waitcnt vmcnt(4)
v_max3_u32 v2, v88, v92, v96
v_max3_u32 v2, v2, v100, v104
v_max3_u32 v2, v2, v108, v112
v_max3_u32 v2, v2, v116, v116
v_cmp_eq_u32 vcc, -1, v2
s_cbranch_vccz L_o5_a
buffer_load_dwordx4 v[88:91], v6, s[12:15], s30 offen offset:0 sc1
buffer_load_dwordx4 v[92:95], v19, s[12:15], s30 offen offset:0 sc1
buffer_load_dwordx4 v[96:99], v6, s[12:15], s30 offen offset:1024 sc1
buffer_load_dwordx4 v[100:103], v19, s[12:15], s30 offen offset:1024 sc1
buffer_load_dwordx4 v[104:107], v6, s[12:15], s31 offen offset:0 sc1
buffer_load_dwordx4 v[108:111], v19, s[12:15], s31 offen offset:0 sc1
buffer_load_dwordx4 v[112:115], v6, s[12:15], s31 offen offset:1024 sc1
buffer_load_dwordx4 v[116:119], v19, s[12:15], s31 offen offset:1024 sc1
s_waitcnt vmcnt(8)
s_branch L_o5_b
L_o5_a:
s_waitcnt vmcnt(0)
L_o5_b:
v_max3_u32 v2, v72, v76, v80
v_max_u32 v2, v2, v84
v_cmp_eq_u32 vcc, -1, v2
s_cbranch_vccnz L_o5_rt
s_branch L_o5_ok
L_o6_rt:
s_add_u32 s78, s78, 1
s_cmp_gt_u32 s78, 65536
s_cbranch_scc1 L_o6_ok
buffer_load_dwordx4 v[88:91], v6, s[12:15], s30 offen offset:0 sc1
buffer_load_dwordx4 v[92:95], v19, s[12:15], s30 offen offset:0 sc1
buffer_load_dwordx4 v[96:99], v6, s[12:15], s30 offen offset:1024 sc1
buffer_load_dwordx4 v[100:103], v19, s[12:15], s30 offen offset:1024 sc1
s_waitcnt vmcnt(4)
v_max3_u32 v2, v104, v108, v112
v_max3_u32 v2, v2, v116, v56
v_max3_u32 v2, v2, v60, v64
v_max3_u32 v2, v2, v68, v68
v_cmp_eq_u32 vcc, -1, v2
s_cbranch_vccz L_o6_a
buffer_load_dwordx4 v[104:107], v6, s[12:15], s31 offen offset:0 sc1
buffer_load_dwordx4 v[108:111], v19, s[12:15], s31 offen offset:0 sc1
buffer_load_dwordx4 v[112:115], v6, s[12:15], s31 offen offset:1024 sc1
buffer_load_dwordx4 v[116:119], v19, s[12:15], s31 offen offset:1024 sc1
buffer_load_dwordx4 v[56:59], v6, s[12:15], s32 offen offset:0 sc1
buffer_load_dwordx4 v[60:63], v19, s[12:15], s32 offen offset:0 sc1
buffer_load_dwordx4 v[64:67], v6, s[12:15], s32 offen offset:1024 sc1
buffer_load_dwordx4 v[68:71], v19, s[12:15], s32 offen offset:1024 sc1
s_waitcnt vmcnt(8)
s_branch L_o6_b
L_o6_a:
s_waitcnt vmcnt(0)
L_o6_b:
v_max3_u32 v2, v88, v92, v96
v_max_u32 v2, v2, v100
v_cmp_eq_u32 vcc, -1, v2
s_cbranch_vccnz L_o6_rt
s_branch L_o6_ok
L_o7_rt:
s_add_u32 s78, s78, 1
s_cmp_gt_u32 s78, 65536
s_cbranch_scc1 L_o7_ok
buffer_load_dwordx4 v[104:107], v6, s[12:15], s31 offen offset:0 sc1
buffer_load_dwordx4 v[108:111], v19, s[12:15], s31 offen offset:0 sc1
buffer_load_dwordx4 v[112:115], v6, s[12:15], s31 offen offset:1024 sc1
buffer_load_dwordx4 v[116:119], v19, s[12:15], s31 offen offset:1024 sc1
s_waitcnt vmcnt(4)
v_max3_u32 v2, v56, v60, v64
v_max3_u32 v2, v2, v68, v72
v_max3_u32 v2, v2, v76, v80
v_max3_u32 v2, v2, v84, v84
v_cmp_eq_u32 vcc, -1, v2
s_cbranch_vccz L_o7_a
buffer_load_dwordx4 v[56:59], v6, s[12:15], s32 offen offset:0 sc1
buffer_load_dwordx4 v[60:63], v19, s[12:15], s32 offen offset:0 sc1
buffer_load_dwordx4 v[64:67], v6, s[12:15], s32 offen offset:1024 sc1
buffer_load_dwordx4 v[68:71], v19, s[12:15], s32 offen offset:1024 sc1
buffer_load_dwordx4 v[72:75], v6, s[12:15], s33 offen offset:0 sc1
buffer_load_dwordx4 v[76:79], v19, s[12:15], s33 offen offset:0 sc1
buffer_load_dwordx4 v[80:83], v6, s[12:15], s33 offen offset:1024 sc1
buffer_load_dwordx4 v[84:87], v19, s[12:15], s33 offen offset:1024 sc1
s_waitcnt vmcnt(8)
s_branch L_o7_b
L_o7_a:
s_waitcnt vmcnt(0)
L_o7_b:
v_max3_u32 v2, v104, v108, v112
v_max_u32 v2, v2, v116
v_cmp_eq_u32 vcc, -1, v2
s_cbranch_vccnz L_o7_rt
s_branch L_o7_ok
L_o8_rt:
s_add_u32 s78, s78, 1
s_cmp_gt_u32 s78, 65536
s_cbranch_scc1 L_o8_ok
buffer_load_dwordx4 v[56:59], v6, s[12:15], s32 offen offset:0 sc1
buffer_load_dwordx4 v[60:63], v19, s[12:15], s32 offen offset:0 sc1
buffer_load_dwordx4 v[64:67], v6, s[12:15], s32 offen offset:1024 sc1
buffer_load_dwordx4 v[68:71], v19, s[12:15], s32 offen offset:1024 sc1
s_waitcnt vmcnt(4)
v_max3_u32 v2, v72, v76, v80
v_max3_u32 v2, v2, v84, v88
v_max3_u32 v2, v2, v92, v96
v_max3_u32 v2, v2, v100, v100
v_cmp_eq_u32 vcc, -1, v2
s_cbranch_vccz L_o8_a
buffer_load_dwordx4 v[72:75], v6, s[12:15], s33 offen offset:0 sc1
buffer_load_dwordx4 v[76:79], v19, s[12:15], s33 offen offset:0 sc1
buffer_load_dwordx4 v[80:83], v6, s[12:15], s33 offen offset:1024 sc1
buffer_load_dwordx4 v[84:87], v19, s[12:15], s33 offen offset:1024 sc1
buffer_load_dwordx4 v[88:91], v6, s[12:15], s34 offen offset:0 sc1
buffer_load_dwordx4 v[92:95], v19, s[12:15], s34 offen offset:0 sc1
buffer_load_dwordx4 v[96:99], v6, s[12:15], s34 offen offset:1024 sc1
buffer_load_dwordx4 v[100:103], v19, s[12:15], s34 offen offset:1024 sc1
s_waitcnt vmcnt(8)
s_branch L_o8_b
L_o8_a:
s_waitcnt vmcnt(0)
L_o8_b:
v_max3_u32 v2, v56, v60, v64
v_max_u32 v2, v2, v68
v_cmp_eq_u32 vcc, -1, v2
s_cbranch_vccnz L_o8_rt
s_branch L_o8_ok
L_o9_rt:
s_add_u32 s78, s78, 1
s_cmp_gt_u32 s78, 65536
s_cbranch_scc1 L_o9_ok
buffer_load_dwordx4 v[72:75], v6, s[12:15], s33 offen offset:0 sc1
buffer_load_dwordx4 v[76:79], v19, s[12:15], s33 offen offset:0 sc1
buffer_load_dwordx4 v[80:83], v6, s[12:15], s33 offen offset:1024 sc1
buffer_load_dwordx4 v[84:87], v19, s[12:15], s33 offen offset:1024 sc1
s_waitcnt vmcnt(4)
v_max3_u32 v2, v88, v92, v96
v_max3_u32 v2, v2, v100, v104
v_max3_u32 v2, v2, v108, v112
v_max3_u32 v2, v2, v116, v116
v_cmp_eq_u32 vcc, -1, v2
s_cbranch_vccz L_o9_a
buffer_load_dwordx4 v[88:91], v6, s[12:15], s34 offen offset:0 sc1
buffer_load_dwordx4 v[92:95], v19, s[12:15], s34 offen offset:0 sc1
buffer_load_dwordx4 v[96:99], v6, s[12:15], s34 offen offset:1024 sc1
buffer_load_dwordx4 v[100:103], v19, s[12:15], s34 offen offset:1024 sc1
buffer_load_dwordx4 v[104:107], v6, s[12:15], s35 offen offset:0 sc1
buffer_load_dwordx4 v[108:111], v19, s[12:15], s35 offen offset:0 sc1
buffer_load_dwordx4 v[112:115], v6, s[12:15], s35 offen offset:1024 sc1
buffer_load_dwordx4 v[116:119], v19, s[12:15], s35 offen offset:1024 sc1
s_waitcnt vmcnt(8)
s_branch L_o9_b
L_o9_a:
s_waitcnt vmcnt(0)
L_o9_b:
v_max3_u32 v2, v72, v76, v80
v_max_u32 v2, v2, v84
v_cmp_eq_u32 vcc, -1, v2
s_cbranch_vccnz L_o9_rt
s_branch L_o9_ok
L_o10_rt:
s_add_u32 s78, s78, 1
s_cmp_gt_u32 s78, 65536
s_cbranch_scc1 L_o10_ok
buffer_load_dwordx4 v[88:91], v6, s[12:15], s34 offen offset:0 sc1
buffer_load_dwordx4 v[92:95], v19, s[12:15], s34 offen offset:0 sc1
buffer_load_dwordx4 v[96:99], v6, s[12:15], s34 offen offset:1024 sc1
buffer_load_dwordx4 v[100:103], v19, s[12:15], s34 offen offset:1024 sc1
s_waitcnt vmcnt(4)
v_max3_u32 v2, v104, v108, v112
v_max3_u32 v2, v2, v116, v56
v_max3_u32 v2, v2, v60, v64
v_max3_u32 v2, v2, v68, v68
v_cmp_eq_u32 vcc, -1, v2
s_cbranch_vccz L_o10_a
buffer_load_dwordx4 v[104:107], v6, s[12:15], s35 offen offset:0 sc1
buffer_load_dwordx4 v[108:111], v19, s[12:15], s35 offen offset:0 sc1
buffer_load_dwordx4 v[112:115], v6, s[12:15], s35 offen offset:1024 sc1
buffer_load_dwordx4 v[116:119], v19, s[12:15], s35 offen offset:1024 sc1
buffer_load_dwordx4 v[56:59], v6, s[12:15], s36 offen offset:0 sc1
buffer_load_dwordx4 v[60:63], v19, s[12:15], s36 offen offset:0 sc1
buffer_load_dwordx4 v[64:67], v6, s[12:15], s36 offen offset:1024 sc1
buffer_load_dwordx4 v[68:71], v19, s[12:15], s36 offen offset:1024 sc1
s_waitcnt vmcnt(8)
s_branch L_o10_b
L_o10_a:
s_waitcnt vmcnt(0)
L_o10_b:
v_max3_u32 v2, v88, v92, v96
v_max_u32 v2, v2, v100
v_cmp_eq_u32 vcc, -1, v2
s_cbranch_vccnz L_o10_rt
s_branch L_o10_ok
L_o11_rt:
s_add_u32 s78, s78, 1
s_cmp_gt_u32 s78, 65536
s_cbranch_scc1 L_o11_ok
buffer_load_dwordx4 v[104:107], v6, s[12:15], s35 offen offset:0 sc1
buffer_load_dwordx4 v[108:111], v19, s[12:15], s35 offen offset:0 sc1
buffer_load_dwordx4 v[112:115], v6, s[12:15], s35 offen offset:1024 sc1
buffer_load_dwordx4 v[116:119], v19, s[12:15], s35 offen offset:1024 sc1
s_waitcnt vmcnt(4)
v_max3_u32 v2, v56, v60, v64
v_max3_u32 v2, v2, v68, v72
v_max3_u32 v2, v2, v76, v80
v_max3_u32 v2, v2, v84, v84
v_cmp_eq_u32 vcc, -1, v2
s_cbranch_vccz L_o11_a
buffer_load_dwordx4 v[56:59], v6, s[12:15], s36 offen offset:0 sc1
buffer_load_dwordx4 v[60:63], v19, s[12:15], s36 offen offset:0 sc1
buffer_load_dwordx4 v[64:67], v6, s[12:15], s36 offen offset:1024 sc1
buffer_load_dwordx4 v[68:71], v19, s[12:15], s36 offen offset:1024 sc1
buffer_load_dwordx4 v[72:75], v6, s[12:15], s37 offen offset:0 sc1
buffer_load_dwordx4 v[76:79], v19, s[12:15], s37 offen offset:0 sc1
buffer_load_dwordx4 v[80:83], v6, s[12:15], s37 offen offset:1024 sc1
buffer_load_dwordx4 v[84:87], v19, s[12:15], s37 offen offset:1024 sc1
s_waitcnt vmcnt(8)
s_branch L_o11_b
L_o11_a:
s_waitcnt vmcnt(0)
L_o11_b:
v_max3_u32 v2, v104, v108, v112
v_max_u32 v2, v2, v116
v_cmp_eq_u32 vcc, -1, v2
s_cbranch_vccnz L_o11_rt
s_branch L_o11_ok
L_o12_rt:
s_add_u32 s78, s78, 1
s_cmp_gt_u32 s78, 65536
s_cbranch_scc1 L_o12_ok
buffer_load_dwordx4 v[56:59], v6, s[12:15], s36 offen offset:0 sc1
buffer_load_dwordx4 v[60:63], v19, s[12:15], s36 offen offset:0 sc1
buffer_load_dwordx4 v[64:67], v6, s[12:15], s36 offen offset:1024 sc1
buffer_load_dwordx4 v[68:71], v19, s[12:15], s36 offen offset:1024 sc1
s_waitcnt vmcnt(4)
v_max3_u32 v2, v72, v76, v80
v_max3_u32 v2, v2, v84, v88
v_max3_u32 v2, v2, v92, v96
v_max3_u32 v2, v2, v100, v100
v_cmp_eq_u32 vcc, -1, v2
s_cbranch_vccz L_o12_a
buffer_load_dwordx4 v[72:75], v6, s[12:15], s37 offen offset:0 sc1
buffer_load_dwordx4 v[76:79], v19, s[12:15], s37 offen offset:0 sc1
buffer_load_dwordx4 v[80:83], v6, s[12:15], s37 offen offset:1024 sc1
buffer_load_dwordx4 v[84:87], v19, s[12:15], s37 offen offset:1024 sc1
buffer_load_dwordx4 v[88:91], v6, s[12:15], s38 offen offset:0 sc1
buffer_load_dwordx4 v[92:95], v19, s[12:15], s38 offen offset:0 sc1
buffer_load_dwordx4 v[96:99], v6, s[12:15], s38 offen offset:1024 sc1
buffer_load_dwordx4 v[100:103], v19, s[12:15], s38 offen offset:1024 sc1
s_waitcnt vmcnt(8)
s_branch L_o12_b
L_o12_a:
s_waitcnt vmcnt(0)
L_o12_b:
v_max3_u32 v2, v56, v60, v64
v_max_u32 v2, v2, v68
v_cmp_eq_u32 vcc, -1, v2
s_cbranch_vccnz L_o12_rt
s_branch L_o12_ok
L_o13_rt:
s_add_u32 s78, s78, 1
s_cmp_gt_u32 s78, 65536
s_cbranch_scc1 L_o13_ok
buffer_load_dwordx4 v[72:75], v6, s[12:15], s37 offen offset:0 sc1
buffer_load_dwordx4 v[76:79], v19, s[12:15], s37 offen offset:0 sc1
buffer_load_dwordx4 v[80:83], v6, s[12:15], s37 offen offset:1024 sc1
buffer_load_dwordx4 v[84:87], v19, s[12:15], s37 offen offset:1024 sc1
s_waitcnt vmcnt(4)
v_max3_u32 v2, v88, v92, v96
v_max3_u32 v2, v2, v100, v104
v_max3_u32 v2, v2, v108, v112
v_max3_u32 v2, v2, v116, v116
v_cmp_eq_u32 vcc, -1, v2
s_cbranch_vccz L_o13_a
buffer_load_dwordx4 v[88:91], v6, s[12:15], s38 offen offset:0 sc1
buffer_load_dwordx4 v[92:95], v19, s[12:15], s38 offen offset:0 sc1
buffer_load_dwordx4 v[96:99], v6, s[12:15], s38 offen offset:1024 sc1
buffer_load_dwordx4 v[100:103], v19, s[12:15], s38 offen offset:1024 sc1
buffer_load_dwordx4 v[104:107], v6, s[12:15], s39 offen offset:0 sc1
buffer_load_dwordx4 v[108:111], v19, s[12:15], s39 offen offset:0 sc1
buffer_load_dwordx4 v[112:115], v6, s[12:15], s39 offen offset:1024 sc1
buffer_load_dwordx4 v[116:119], v19, s[12:15], s39 offen offset:1024 sc1
s_waitcnt vmcnt(8)
s_branch L_o13_b
L_o13_a:
s_waitcnt vmcnt(0)
L_o13_b:
v_max3_u32 v2, v72, v76, v80
v_max_u32 v2, v2, v84
v_cmp_eq_u32 vcc, -1, v2
s_cbranch_vccnz L_o13_rt
s_branch L_o13_ok
L_o14_rt:
s_add_u32 s78, s78, 1
s_cmp_gt_u32 s78, 65536
s_cbranch_scc1 L_o14_ok
buffer_load_dwordx4 v[88:91], v6, s[12:15], s38 offen offset:0 sc1
buffer_load_dwordx4 v[92:95], v19, s[12:15], s38 offen offset:0 sc1
buffer_load_dwordx4 v[96:99], v6, s[12:15], s38 offen offset:1024 sc1
buffer_load_dwordx4 v[100:103], v19, s[12:15], s38 offen offset:1024 sc1
s_waitcnt vmcnt(4)
v_max3_u32 v2, v104, v108, v112
v_max3_u32 v2, v2, v116, v116
v_cmp_eq_u32 vcc, -1, v2
s_cbranch_vccz L_o14_a
buffer_load_dwordx4 v[104:107], v6, s[12:15], s39 offen offset:0 sc1
buffer_load_dwordx4 v[108:111], v19, s[12:15], s39 offen offset:0 sc1
buffer_load_dwordx4 v[112:115], v6, s[12:15], s39 offen offset:1024 sc1
buffer_load_dwordx4 v[116:119], v19, s[12:15], s39 offen offset:1024 sc1
s_waitcnt vmcnt(4)
s_branch L_o14_b
L_o14_a:
s_waitcnt vmcnt(0)
L_o14_b:
v_max3_u32 v2, v88, v92, v96
v_max_u32 v2, v2, v100
v_cmp_eq_u32 vcc, -1, v2
s_cbranch_vccnz L_o14_rt
s_branch L_o14_ok
L_o15_rt:
s_add_u32 s78, s78, 1
s_cmp_gt_u32 s78, 65536
s_cbranch_scc1 L_o15_ok
buffer_load_dwordx4 v[104:107], v6, s[12:15], s39 offen offset:0 sc1
buffer_load_dwordx4 v[108:111], v19, s[12:15], s39 offen offset:0 sc1
buffer_load_dwordx4 v[112:115], v6, s[12:15], s39 offen offset:1024 sc1
buffer_load_dwordx4 v[116:119], v19, s[12:15], s39 offen offset:1024 sc1
s_waitcnt vmcnt(0)
L_o15_b:
v_max3_u32 v2, v104, v108, v112
v_max_u32 v2, v2, v116
v_cmp_eq_u32 vcc, -1, v2
s_cbranch_vccnz L_o15_rt
s_branch L_o15_ok
L_stp_s:
buffer_store_dwordx4 v[72:75], v144, s[12:15], s72 offen offset:0 sc1
buffer_store_dwordx4 v[76:79], v144, s[12:15], s72 offen offset:256 sc1
s_branch L_stp_d
L_pad15:
s_branch L_retG
L_st_rt:
s_add_u32 s78, s78, 1
s_cmp_gt_u32 s78, 65536
s_cbranch_scc1 L_st_ok
v_cmp_ne_u32 vcc, s68, v99
s_cbranch_vccz L_st_p0
s_add_u32 s70, s75, 0
buffer_load_dwordx4 v[96:99], v145, s[12:15], s70 offen sc1
L_st_p0:
v_cmp_ne_u32 vcc, s68, v103
s_cbranch_vccz L_st_p1
s_add_u32 s70, s75, 4096
buffer_load_dwordx4 v[100:103], v145, s[12:15], s70 offen sc1
L_st_p1:
v_cmp_ne_u32 vcc, s68, v107
s_cbranch_vccz L_st_p2
s_add_u32 s70, s75, 8192
buffer_load_dwordx4 v[104:107], v145, s[12:15], s70 offen sc1
L_st_p2:
v_cmp_ne_u32 vcc, s68, v111
s_cbranch_vccz L_st_p3
s_add_u32 s70, s75, 12288
buffer_load_dwordx4 v[108:111], v145, s[12:15], s70 offen sc1
L_st_p3:
v_cmp_ne_u32 vcc, s68, v115
s_cbranch_vccz L_st_p4
s_add_u32 s70, s75, 16384
buffer_load_dwordx4 v[112:115], v145, s[12:15], s70 offen sc1
L_st_p4:
v_cmp_ne_u32 vcc, s68, v119
s_cbranch_vccz L_st_p5
s_add_u32 s70, s75, 20480
buffer_load_dwordx4 v[116:119], v145, s[12:15], s70 offen sc1
L_st_p5:
v_cmp_ne_u32 vcc, s68, v123
s_cbranch_vccz L_st_p6
s_add_u32 s70, s75, 24576
buffer_load_dwordx4 v[120:123], v145, s[12:15], s70 offen sc1
L_st_p6:
v_cmp_ne_u32 vcc, s68, v127
s_cbranch_vccz L_st_p7
s_add_u32 s70, s75, 28672
buffer_load_dwordx4 v[124:127], v145, s[12:15], s70 offen sc1
L_st_p7:
s_waitcnt vmcnt(0)
s_branch L_st_chk
L_fin:
.section .rodata,"a"
.p2align 6
.amdhsa_kernel sequential_preLN__linear_attn_block__moe_arch_mod__prompt_kernel
  .amdhsa_next_free_vgpr 256
  .amdhsa_next_free_sgpr 102
  .amdhsa_accum_offset 152
  .amdhsa_group_segment_fixed_size 0
  .amdhsa_kernarg_size 88
  .amdhsa_user_sgpr_count 2
  .amdhsa_user_sgpr_kernarg_segment_ptr 1
  .amdhsa_system_sgpr_workgroup_id_x 1
  .amdhsa_float_denorm_mode_32 3
.end_amdhsa_kernel
```

```asm
; @launch grid=(256,1,1) block=(512,1,1) lds=163840
.amdgcn_target "amdgcn-amd-amdhsa--gfx950"
.text
.p2alignl 12, 0xbf810000
.fill 832, 4, 0xbf810000
.globl sequential_preLN__linear_attn_block__moe_arch_mod__prompt_kernel
.p2align 8
.type sequential_preLN__linear_attn_block__moe_arch_mod__prompt_kernel,@function
sequential_preLN__linear_attn_block__moe_arch_mod__prompt_kernel:
s_cmp_ge_u32 s2, 256
s_cbranch_scc1 L_end
s_load_dwordx16 s[40:55], s[0:1], 0
s_load_dwordx2 s[56:57], s[0:1], 64
s_load_dwordx2 s[58:59], s[0:1], 80
s_getpc_b64 s[20:21]
L_pc:
s_sub_u32 s20, s20, L_pc-sequential_preLN__linear_attn_block__moe_arch_mod__prompt_kernel
s_subb_u32 s21, s21, 0
s_and_b32 s21, s21, 0xffff
s_mov_b32 s22, L_fin-sequential_preLN__linear_attn_block__moe_arch_mod__prompt_kernel
s_mov_b32 s23, 0x20000
s_lshr_b32 s70, s2, 3
s_mul_i32 s70, s70, 1536
v_lshlrev_b32 v81, 7, v0
v_cmp_gt_u32 vcc, 12, v0
s_nop 0
s_mov_b64 exec, vcc
buffer_load_dword v81, v81, s[20:23], s70 offen
s_mov_b64 exec, -1
v_lshrrev_b32 v2, 6, v0
v_and_b32 v1, 63, v0
v_readfirstlane_b32 s60, v2
s_and_b32 s62, s2, 7
s_lshr_b32 s63, s2, 3
s_lshl_b32 s64, s62, 1
s_and_b32 s70, s63, 1
s_add_u32 s64, s64, s70
s_lshr_b32 s65, s63, 1
s_lshl_b32 s79, s64, 4
s_add_u32 s79, s79, s65
s_mov_b32 s78, 0
s_mov_b32 s89, s65
s_lshr_b32 s61, s60, 2
s_and_b32 s60, s60, 3
s_lshr_b32 s66, s60, 1
s_and_b32 s67, s60, 1
v_lshlrev_b32 v16, 4, v1
s_cmp_eq_u32 s61, 0
s_cbranch_scc1 L_compute
s_setprio 1
v_mov_b32 v18, v16
s_lshl_b32 s70, s65, 2
s_add_u32 s70, s70, s60
s_lshl_b32 s70, s70, 16
v_lshrrev_b32 v2, 3, v1
v_lshlrev_b32 v5, 11, v2
v_add_u32 v5, s70, v5
v_lshrrev_b32 v3, 4, v1
v_and_b32 v4, 7, v1
v_xor_b32 v3, v3, v4
v_xor_b32 v6, 0, v3
v_lshl_add_u32 v6, v6, 4, v5
v_add_u32 v8, 0, v6
v_xor_b32 v6, 4, v3
v_lshl_add_u32 v6, v6, 4, v5
v_add_u32 v9, 15360, v6
v_xor_b32 v6, 0, v3
v_lshl_add_u32 v6, v6, 4, v5
v_add_u32 v10, 30720, v6
v_xor_b32 v6, 4, v3
v_lshl_add_u32 v6, v6, 4, v5
v_add_u32 v11, 46080, v6
s_lshl_b32 s70, s60, 4
v_add_u32 v5, s70, v2
v_mul_u32_u24 v5, 6144, v5
s_lshl_b32 s70, s64, 7
v_add_u32 v5, s70, v5
v_bfe_u32 v3, v1, 4, 1
v_lshlrev_b32 v3, 1, v3
v_xor_b32 v3, v3, v4
v_xor_b32 v6, 0, v3
v_lshl_add_u32 v6, v6, 4, v5
v_add_u32 v12, 0, v6
v_xor_b32 v6, 4, v3
v_lshl_add_u32 v6, v6, 4, v5
v_add_u32 v13, 48128, v6
v_xor_b32 v6, 0, v3
v_lshl_add_u32 v6, v6, 4, v5
v_add_u32 v14, 0, v6
v_xor_b32 v6, 4, v3
v_lshl_add_u32 v6, v6, 4, v5
v_add_u32 v15, 48128, v6
v_xor_b32 v6, 0, v3
v_lshl_add_u32 v6, v6, 4, v5
v_add_u32 v16, 4096, v6
v_xor_b32 v6, 4, v3
v_lshl_add_u32 v6, v6, 4, v5
v_add_u32 v17, 52224, v6
s_lshl_b32 s76, s60, 12
s_mul_i32 s77, s60, 6144
s_and_b32 s70, s64, 1
s_lshl_b32 s70, s70, 3
s_mov_b32 s70, 0
s_andn2_b32 s71, s65, 1
s_add_u32 s70, s70, s71
s_and_b32 s70, s70, 15
s_mul_i32 s75, s70, 393216
s_lshl_b32 s74, s70, 7
s_waitcnt lgkmcnt(0)
s_load_dword s68, s[58:59], 0
s_mov_b32 s4, s40
s_and_b32 s5, s41, 0xffff
s_mov_b32 s6, 4194304
s_mov_b32 s7, 0x20000
s_mov_b32 s8, s42
s_and_b32 s9, s43, 0xffff
s_mov_b32 s10, 6291456
s_mov_b32 s11, 0x20000
s_add_u32 m0, s76, 122880
s_nop 0
buffer_load_dwordx4 v8, s[4:7], s74 offen offset:0 lds
buffer_load_dwordx4 v9, s[4:7], s74 offen offset:1024 lds
buffer_load_dwordx4 v10, s[4:7], s74 offen offset:2048 lds
buffer_load_dwordx4 v11, s[4:7], s74 offen offset:3072 lds
s_add_u32 s74, s74, 128
s_and_b32 s74, s74, 2047
s_add_u32 m0, s77, 0
s_nop 0
buffer_load_dwordx4 v12, s[8:11], s75 offen offset:0 lds
buffer_load_dwordx4 v13, s[8:11], s75 offen offset:1024 lds
buffer_load_dwordx4 v14, s[8:11], s75 offen offset:2048 lds
buffer_load_dwordx4 v15, s[8:11], s75 offen offset:3072 lds
s_add_u32 m0, s77, 4096
s_nop 0
buffer_load_dwordx4 v16, s[8:11], s75 offen offset:0 lds
buffer_load_dwordx4 v17, s[8:11], s75 offen offset:1024 lds
s_add_u32 s75, s75, 393216
s_cmp_eq_u32 s75, 6291456
s_cselect_b32 s75, 0, s75
s_mov_b32 s12, s58
s_and_b32 s13, s59, 0xffff
s_mov_b32 s14, 268435456
s_mov_b32 s15, 0x20000
s_mov_b32 s16, s44
s_and_b32 s17, s45, 0xffff
s_mov_b32 s18, 2097152
s_mov_b32 s19, 0x20000
s_mov_b32 s20, s56
s_and_b32 s21, s57, 0xffff
s_mov_b32 s22, 4194304
s_mov_b32 s23, 0x20000
s_mov_b32 s24, s50
s_and_b32 s25, s51, 0xffff
s_mov_b32 s26, 7340032
s_mov_b32 s27, 0x20000
s_mov_b32 s28, s52
s_and_b32 s29, s53, 0xffff
s_mov_b32 s30, 7340032
s_mov_b32 s31, 0x20000
s_mov_b32 s32, s54
s_and_b32 s33, s55, 0xffff
s_mov_b32 s34, 7340032
s_mov_b32 s35, 0x20000
s_mov_b32 s36, s48
s_and_b32 s37, s49, 0xffff
s_mov_b32 s38, 2048
s_mov_b32 s39, 0x20000
s_lshl_b32 s70, s65, 7
s_lshl_b32 s71, s64, 3
s_add_u32 s70, s70, s71
s_lshl_b32 s71, s60, 1
s_add_u32 s87, s70, s71
v_lshrrev_b32 v2, 3, v1
v_lshlrev_b32 v3, 11, v2
v_bfe_u32 v5, v1, 4, 2
v_lshlrev_b32 v5, 1, v5
v_and_b32 v4, 7, v1
v_xor_b32 v5, v5, v4
v_lshl_add_u32 v3, v5, 4, v3
s_lshl_b32 s70, s65, 7
v_add_u32 v80, s70, v3
v_mov_b32 v72, -1
v_mov_b32 v73, -1
v_mov_b32 v74, -1
v_mov_b32 v75, -1
s_mul_i32 s80, s79, 4352
s_add_u32 s80, s80, 524288
s_lshl_b32 s81, s65, 18
s_lshl_b32 s70, s66, 17
s_add_u32 s81, s81, s70
s_lshl_b32 s70, s64, 11
s_add_u32 s81, s81, s70
s_lshl_b32 s70, s67, 10
s_add_u32 s81, s81, s70
s_add_u32 s81, s81, 2097152
s_mov_b32 s72, 0x6543e210
s_mov_b32 s73, 0xdcbaf987
s_lshl_b32 s70, s64, 2
s_lshr_b64 s[72:73], s[72:73], s70
s_and_b32 s3, s72, 15
v_mul_u32_u24 v76, 7168, v2
v_lshl_add_u32 v76, v4, 4, v76
v_lshlrev_b32 v77, 11, v2
v_lshl_add_u32 v77, v4, 4, v77
s_and_b32 s70, s65, 3
s_lshl_b32 s70, s70, 2
s_add_u32 s70, s70, s60
s_mul_i32 s85, s70, 458752
s_lshl_b32 s70, s3, 9
s_add_u32 s85, s85, s70
s_lshr_b32 s70, s65, 2
s_lshl_b32 s70, s70, 7
s_xor_b32 s71, s70, 128
v_add_u32 v78, s71, v76
v_add_u32 v76, s70, v76
s_and_b32 s70, s65, 3
s_lshl2_add_u32 s70, s3, s70
s_and_b32 s71, s65, 12
s_add_u32 s71, s71, s60
s_lshl_b32 s86, s70, 17
s_lshl_b32 s70, s71, 7
s_add_u32 s86, s86, s70
s_cmp_lt_u32 s3, 14
s_cselect_b32 s26, s26, 0
s_cselect_b32 s30, s30, 0
s_cselect_b32 s34, s34, 0
s_mov_b32 s90, 0x10001
s_movk_i32 s91, 0xff
v_mov_b32 v79, 0
s_lshl_b32 s70, s87, 4
s_add_u32 s70, s70, 8192
v_writelane_b32 v79, s70, 0
s_lshl_b32 s70, s79, 4
s_add_u32 s70, s70, 4096
v_writelane_b32 v79, s70, 1
s_lshl_b32 s70, s64, 7
s_add_u32 s70, s70, 6815744
v_writelane_b32 v79, s70, 2
s_lshl_b32 s70, s79, 10
s_add_u32 s70, s70, 65536
v_writelane_b32 v79, s70, 3
s_lshl_b32 s70, s60, 10
s_add_u32 s70, s70, s80
v_writelane_b32 v79, s70, 4
s_lshl_b32 s70, s67, 7
s_add_u32 s70, s70, s80
s_add_u32 s70, s70, 4096
v_writelane_b32 v79, s70, 5
s_and_b32 s71, s65, 3
s_lshl2_add_u32 s71, s3, s71
s_and_b32 s70, s65, 12
s_add_u32 s70, s70, s60
s_lshl_b32 s71, s71, 7
s_lshl_b32 s70, s70, 15
s_add_u32 s70, s70, s71
s_add_u32 s70, s70, 7340032
v_writelane_b32 v79, s70, 6
s_lshl_b32 s71, s79, 2
s_add_u32 s71, s71, s60
s_lshl_b32 s70, s71, 9
s_add_u32 s70, s70, 6291456
v_writelane_b32 v79, s70, 7
s_lshl_b32 s71, s79, 2
s_add_u32 s71, s71, s60
s_lshl_b32 s70, s71, 8
s_add_u32 s70, s70, 6946816
v_writelane_b32 v79, s70, 8
s_add_u32 s70, s81, 0
v_writelane_b32 v79, s70, 9
s_add_u32 s70, s81, 32768
v_writelane_b32 v79, s70, 10
s_add_u32 s70, s81, 65536
v_writelane_b32 v79, s70, 11
s_add_u32 s70, s81, 98304
v_writelane_b32 v79, s70, 12
s_and_b32 s70, s65, 7
s_min_u32 s71, s60, 0
s_lshl_b32 s71, s71, 3
s_add_u32 s70, s70, s71
s_lshl_b32 s70, s70, 4
s_add_u32 s70, s70, s64
s_lshl_b32 s70, s70, 7
s_add_u32 s70, s70, 6815744
v_writelane_b32 v79, s70, 2
v_and_b32 v2, 7, v1
v_lshlrev_b32 v2, 7, v2
v_lshrrev_b32 v3, 3, v1
v_lshl_add_u32 v83, v3, 15, v2
v_add_u32 v83, s81, v83
s_mov_b32 exec_lo, 0
s_and_b32 s71, s65, 3
s_lshl2_add_u32 s71, s3, s71
s_and_b32 s70, s65, 12
s_add_u32 s70, s70, s60
s_lshl_b32 s71, s71, 7
s_lshl_b32 s70, s70, 15
s_add_u32 s70, s70, s71
s_add_u32 s70, s70, 7340032
s_mov_b32 exec_hi, 0xff
v_and_b32 v2, 3, v1
v_lshl_add_u32 v83, v2, 13, s70
s_lshl_b32 s70, s60, 10
s_add_u32 s70, s70, s80
s_mov_b32 exec_hi, 0xff0000
v_and_b32 v2, 7, v1
v_lshl_add_u32 v83, v2, 7, s70
s_lshl_b32 s71, s79, 2
s_add_u32 s71, s71, s60
s_lshl_b32 s70, s71, 9
s_add_u32 s70, s70, 6291456
s_mov_b32 exec_hi, 0xf000000
v_and_b32 v2, 3, v1
v_lshl_add_u32 v83, v2, 7, s70
s_lshl_b32 s71, s79, 2
s_add_u32 s71, s71, s60
s_lshl_b32 s70, s71, 8
s_add_u32 s70, s70, 6946816
s_mov_b32 exec_hi, 0x30000000
v_and_b32 v2, 1, v1
v_lshl_add_u32 v83, v2, 7, s70
s_lshl_b32 s70, s67, 7
s_add_u32 s70, s70, s80
s_add_u32 s70, s70, 4096
s_mov_b32 exec_hi, 0xc0000000
v_and_b32 v2, 0, v1
v_lshl_add_u32 v83, v2, 7, s70
s_mov_b64 exec, -1
s_add_u32 m0, s76, 106496
s_nop 0
buffer_load_dwordx4 v8, s[4:7], s74 offen offset:0 lds
buffer_load_dwordx4 v9, s[4:7], s74 offen offset:1024 lds
buffer_load_dwordx4 v10, s[4:7], s74 offen offset:2048 lds
buffer_load_dwordx4 v11, s[4:7], s74 offen offset:3072 lds
s_add_u32 s74, s74, 128
s_and_b32 s74, s74, 2047
s_add_u32 m0, s77, 81920
s_nop 0
buffer_load_dwordx4 v12, s[8:11], s75 offen offset:0 lds
buffer_load_dwordx4 v13, s[8:11], s75 offen offset:1024 lds
buffer_load_dwordx4 v14, s[8:11], s75 offen offset:2048 lds
buffer_load_dwordx4 v15, s[8:11], s75 offen offset:3072 lds
s_add_u32 m0, s77, 86016
s_nop 0
buffer_load_dwordx4 v16, s[8:11], s75 offen offset:0 lds
buffer_load_dwordx4 v17, s[8:11], s75 offen offset:1024 lds
s_add_u32 s75, s75, 393216
s_cmp_eq_u32 s75, 6291456
s_cselect_b32 s75, 0, s75
s_waitcnt vmcnt(10)
s_barrier
s_add_u32 m0, s76, 65536
s_nop 0
buffer_load_dwordx4 v8, s[4:7], s74 offen offset:0 lds
buffer_load_dwordx4 v9, s[4:7], s74 offen offset:1024 lds
buffer_load_dwordx4 v10, s[4:7], s74 offen offset:2048 lds
buffer_load_dwordx4 v11, s[4:7], s74 offen offset:3072 lds
s_add_u32 s74, s74, 128
s_and_b32 s74, s74, 2047
s_add_u32 m0, s77, 40960
s_nop 0
buffer_load_dwordx4 v12, s[8:11], s75 offen offset:0 lds
buffer_load_dwordx4 v13, s[8:11], s75 offen offset:1024 lds
buffer_load_dwordx4 v14, s[8:11], s75 offen offset:2048 lds
buffer_load_dwordx4 v15, s[8:11], s75 offen offset:3072 lds
s_add_u32 m0, s77, 45056
s_nop 0
buffer_load_dwordx4 v16, s[8:11], s75 offen offset:0 lds
buffer_load_dwordx4 v17, s[8:11], s75 offen offset:1024 lds
s_add_u32 s75, s75, 393216
s_cmp_eq_u32 s75, 6291456
s_cselect_b32 s75, 0, s75
s_waitcnt vmcnt(10)
s_barrier
s_add_u32 m0, s76, 24576
s_nop 0
buffer_load_dwordx4 v8, s[4:7], s74 offen offset:0 lds
buffer_load_dwordx4 v9, s[4:7], s74 offen offset:1024 lds
buffer_load_dwordx4 v10, s[4:7], s74 offen offset:2048 lds
buffer_load_dwordx4 v11, s[4:7], s74 offen offset:3072 lds
s_add_u32 s74, s74, 128
s_and_b32 s74, s74, 2047
s_add_u32 m0, s77, 0
s_nop 0
buffer_load_dwordx4 v12, s[8:11], s75 offen offset:0 lds
buffer_load_dwordx4 v13, s[8:11], s75 offen offset:1024 lds
buffer_load_dwordx4 v14, s[8:11], s75 offen offset:2048 lds
buffer_load_dwordx4 v15, s[8:11], s75 offen offset:3072 lds
s_add_u32 m0, s77, 4096
s_nop 0
buffer_load_dwordx4 v16, s[8:11], s75 offen offset:0 lds
buffer_load_dwordx4 v17, s[8:11], s75 offen offset:1024 lds
s_add_u32 s75, s75, 393216
s_cmp_eq_u32 s75, 6291456
s_cselect_b32 s75, 0, s75
s_add_u32 m0, s76, 122880
s_nop 0
buffer_load_dwordx4 v8, s[4:7], s74 offen offset:0 lds
buffer_load_dwordx4 v9, s[4:7], s74 offen offset:1024 lds
buffer_load_dwordx4 v10, s[4:7], s74 offen offset:2048 lds
buffer_load_dwordx4 v11, s[4:7], s74 offen offset:3072 lds
s_add_u32 s74, s74, 128
s_and_b32 s74, s74, 2047
v_lshlrev_b32 v2, 3, v1
s_lshl_b32 s70, s60, 9
buffer_load_dwordx2 v[88:89], v2, s[36:39], s70 offen
s_lshl_b32 s70, s87, 11
buffer_load_dwordx4 v[20:23], v18, s[4:7], s70 offen offset:0
s_lshl_b32 s70, s87, 11
buffer_load_dwordx4 v[24:27], v18, s[4:7], s70 offen offset:1024
s_lshl_b32 s70, s87, 11
buffer_load_dwordx4 v[28:31], v18, s[4:7], s70 offen offset:2048
s_lshl_b32 s70, s87, 11
buffer_load_dwordx4 v[32:35], v18, s[4:7], s70 offen offset:3072
s_mov_b64 exec, 0x1ef
buffer_load_dword v81, v79, s[12:15], 0 offen
s_mov_b64 exec, -1
s_lshl_b32 s70, s64, 2
s_add_u32 s70, s70, s60
s_lshl_b32 s70, s70, 12
s_lshl_b32 s71, s65, 7
s_add_u32 s70, s70, s71
s_add_u32 s70, s70, 7864320
s_mov_b64 exec, 0xffff
buffer_store_dwordx4 v[72:75], v77, s[12:15], s70 offen sc1
s_mov_b64 exec, -1
s_waitcnt vmcnt(21)
s_barrier
s_add_u32 m0, s77, 81920
s_nop 0
buffer_load_dwordx4 v12, s[8:11], s75 offen offset:0 lds
buffer_load_dwordx4 v13, s[8:11], s75 offen offset:1024 lds
buffer_load_dwordx4 v14, s[8:11], s75 offen offset:2048 lds
buffer_load_dwordx4 v15, s[8:11], s75 offen offset:3072 lds
s_add_u32 m0, s77, 86016
s_nop 0
buffer_load_dwordx4 v16, s[8:11], s75 offen offset:0 lds
buffer_load_dwordx4 v17, s[8:11], s75 offen offset:1024 lds
s_add_u32 s75, s75, 393216
s_cmp_eq_u32 s75, 6291456
s_cselect_b32 s75, 0, s75
s_add_u32 m0, s76, 106496
s_nop 0
buffer_load_dwordx4 v8, s[4:7], s74 offen offset:0 lds
buffer_load_dwordx4 v9, s[4:7], s74 offen offset:1024 lds
buffer_load_dwordx4 v10, s[4:7], s74 offen offset:2048 lds
buffer_load_dwordx4 v11, s[4:7], s74 offen offset:3072 lds
s_add_u32 s74, s74, 128
s_and_b32 s74, s74, 2047
s_waitcnt vmcnt(21)
s_barrier
s_add_u32 m0, s77, 40960
s_nop 0
buffer_load_dwordx4 v12, s[8:11], s75 offen offset:0 lds
s_waitcnt vmcnt(13)
s_waitcnt lgkmcnt(0)
s_add_u32 s68, s68, 1
s_and_b32 s84, s68, 0xff
s_not_b32 s70, s68
v_and_b32 v82, 3, v1
v_lshrrev_b32_e64 v82, v82, s70
v_and_b32 v82, 1, v82
v_mul_u32_u24 v82, 0x10001, v82
buffer_load_dwordx4 v13, s[8:11], s75 offen offset:1024 lds
v_lshlrev_b32 v36, 16, v20
v_and_b32 v37, 0xffff0000, v20
v_lshlrev_b32 v38, 16, v21
v_and_b32 v39, 0xffff0000, v21
v_lshlrev_b32 v40, 16, v22
buffer_load_dwordx4 v14, s[8:11], s75 offen offset:2048 lds
v_and_b32 v41, 0xffff0000, v22
v_lshlrev_b32 v42, 16, v23
v_and_b32 v43, 0xffff0000, v23
v_lshlrev_b32 v44, 16, v24
v_and_b32 v45, 0xffff0000, v24
buffer_load_dwordx4 v15, s[8:11], s75 offen offset:3072 lds
v_lshlrev_b32 v46, 16, v25
v_and_b32 v47, 0xffff0000, v25
v_lshlrev_b32 v48, 16, v26
v_and_b32 v49, 0xffff0000, v26
v_lshlrev_b32 v50, 16, v27
s_add_u32 m0, s77, 45056
s_nop 0
buffer_load_dwordx4 v16, s[8:11], s75 offen offset:0 lds
v_and_b32 v51, 0xffff0000, v27
v_lshlrev_b32 v52, 16, v28
v_and_b32 v53, 0xffff0000, v28
v_lshlrev_b32 v54, 16, v29
v_and_b32 v55, 0xffff0000, v29
buffer_load_dwordx4 v17, s[8:11], s75 offen offset:1024 lds
s_add_u32 s75, s75, 393216
s_cmp_eq_u32 s75, 6291456
s_cselect_b32 s75, 0, s75
v_lshlrev_b32 v56, 16, v30
v_and_b32 v57, 0xffff0000, v30
v_lshlrev_b32 v58, 16, v31
v_and_b32 v59, 0xffff0000, v31
v_lshlrev_b32 v60, 16, v32
s_add_u32 m0, s76, 65536
s_nop 0
buffer_load_dwordx4 v8, s[4:7], s74 offen offset:0 lds
v_and_b32 v61, 0xffff0000, v32
v_lshlrev_b32 v62, 16, v33
v_and_b32 v63, 0xffff0000, v33
v_lshlrev_b32 v64, 16, v34
v_and_b32 v65, 0xffff0000, v34
buffer_load_dwordx4 v9, s[4:7], s74 offen offset:1024 lds
v_lshlrev_b32 v66, 16, v35
v_and_b32 v67, 0xffff0000, v35
v_add_f32 v20, v36, v40
v_add_f32 v28, v52, v56
v_add_f32 v21, v37, v41
buffer_load_dwordx4 v10, s[4:7], s74 offen offset:2048 lds
v_add_f32 v29, v53, v57
v_add_f32 v22, v38, v42
v_add_f32 v30, v54, v58
v_add_f32 v23, v39, v43
v_add_f32 v31, v55, v59
buffer_load_dwordx4 v11, s[4:7], s74 offen offset:3072 lds
s_add_u32 s74, s74, 128
s_and_b32 s74, s74, 2047
v_add_f32 v20, v20, v44
v_add_f32 v28, v28, v60
s_waitcnt vmcnt(14)
s_barrier
s_add_u32 m0, s77, 0
s_nop 0
buffer_load_dwordx4 v12, s[8:11], s75 offen offset:0 lds
v_add_f32 v21, v21, v45
v_add_f32 v29, v29, v61
v_add_f32 v22, v22, v46
v_add_f32 v30, v30, v62
v_add_f32 v23, v23, v47
buffer_load_dwordx4 v13, s[8:11], s75 offen offset:1024 lds
v_add_f32 v31, v31, v63
v_add_f32 v20, v20, v48
v_add_f32 v28, v28, v64
v_add_f32 v21, v21, v49
v_add_f32 v29, v29, v65
buffer_load_dwordx4 v14, s[8:11], s75 offen offset:2048 lds
v_add_f32 v22, v22, v50
v_add_f32 v30, v30, v66
v_add_f32 v23, v23, v51
v_add_f32 v31, v31, v67
v_add_f32 v20, v20, v21
buffer_load_dwordx4 v15, s[8:11], s75 offen offset:3072 lds
v_add_f32 v22, v22, v23
v_add_f32 v28, v28, v29
v_add_f32 v30, v30, v31
v_add_f32 v2, v20, v22
v_add_f32 v4, v28, v30
s_add_u32 m0, s77, 4096
s_nop 0
buffer_load_dwordx4 v16, s[8:11], s75 offen offset:0 lds
v_add_f32_dpp v2, v2, v2 row_ror:1 row_mask:0xf bank_mask:0xf
v_add_f32_dpp v4, v4, v4 row_ror:1 row_mask:0xf bank_mask:0xf
s_nop 0
v_add_f32_dpp v2, v2, v2 row_ror:2 row_mask:0xf bank_mask:0xf
v_add_f32_dpp v4, v4, v4 row_ror:2 row_mask:0xf bank_mask:0xf
s_nop 0
v_add_f32_dpp v2, v2, v2 row_ror:4 row_mask:0xf bank_mask:0xf
buffer_load_dwordx4 v17, s[8:11], s75 offen offset:1024 lds
s_add_u32 s75, s75, 393216
s_cmp_eq_u32 s75, 6291456
s_cselect_b32 s75, 0, s75
v_add_f32_dpp v4, v4, v4 row_ror:4 row_mask:0xf bank_mask:0xf
v_add_f32_dpp v2, v2, v2 row_ror:8 row_mask:0xf bank_mask:0xf
s_nop 0
v_add_f32_dpp v4, v4, v4 row_ror:8 row_mask:0xf bank_mask:0xf
v_mov_b32 v6, v2
v_mov_b32 v7, v4
s_add_u32 m0, s76, 24576
s_nop 0
buffer_load_dwordx4 v8, s[4:7], s74 offen offset:0 lds
v_permlane16_swap_b32 v2, v6
v_permlane16_swap_b32 v4, v7
v_add_f32 v2, v2, v6
v_add_f32 v4, v4, v7
v_mov_b32 v6, v2
buffer_load_dwordx4 v9, s[4:7], s74 offen offset:1024 lds
v_mov_b32 v7, v4
v_permlane32_swap_b32 v2, v6
s_nop 0
v_permlane32_swap_b32 v4, v7
v_add_f32 v2, v2, v6
v_add_f32 v4, v4, v7
buffer_load_dwordx4 v10, s[4:7], s74 offen offset:2048 lds
v_mul_f32 v2, 0xba800000, v2
v_mul_f32 v4, 0xba800000, v4
v_add_f32 v36, v36, v2
v_add_f32 v52, v52, v4
v_add_f32 v37, v37, v2
buffer_load_dwordx4 v11, s[4:7], s74 offen offset:3072 lds
s_add_u32 s74, s74, 128
s_and_b32 s74, s74, 2047
v_add_f32 v53, v53, v4
v_add_f32 v38, v38, v2
s_cmp_eq_u32 s60, 0
s_cbranch_scc1 L_pad0
s_cmp_eq_u32 s60, 1
s_cbranch_scc1 L_pad3
s_cmp_eq_u32 s60, 2
s_cbranch_scc1 L_pad4
s_branch L_ret4
L_ret4:
s_waitcnt vmcnt(14)
s_barrier
s_add_u32 m0, s77, 81920
s_nop 0
buffer_load_dwordx4 v12, s[8:11], s75 offen offset:0 lds
v_add_f32 v54, v54, v4
v_add_f32 v39, v39, v2
v_add_f32 v55, v55, v4
v_add_f32 v40, v40, v2
v_add_f32 v56, v56, v4
buffer_load_dwordx4 v13, s[8:11], s75 offen offset:1024 lds
v_add_f32 v41, v41, v2
v_add_f32 v57, v57, v4
v_add_f32 v42, v42, v2
v_add_f32 v58, v58, v4
v_add_f32 v43, v43, v2
buffer_load_dwordx4 v14, s[8:11], s75 offen offset:2048 lds
v_add_f32 v59, v59, v4
v_add_f32 v44, v44, v2
v_add_f32 v60, v60, v4
v_add_f32 v45, v45, v2
v_add_f32 v61, v61, v4
buffer_load_dwordx4 v15, s[8:11], s75 offen offset:3072 lds
v_add_f32 v46, v46, v2
v_add_f32 v62, v62, v4
v_add_f32 v47, v47, v2
v_add_f32 v63, v63, v4
v_add_f32 v48, v48, v2
s_add_u32 m0, s77, 86016
s_nop 0
buffer_load_dwordx4 v16, s[8:11], s75 offen offset:0 lds
v_add_f32 v64, v64, v4
v_add_f32 v49, v49, v2
v_add_f32 v65, v65, v4
v_add_f32 v50, v50, v2
v_add_f32 v66, v66, v4
buffer_load_dwordx4 v17, s[8:11], s75 offen offset:1024 lds
s_add_u32 s75, s75, 393216
s_cmp_eq_u32 s75, 6291456
s_cselect_b32 s75, 0, s75
v_add_f32 v51, v51, v2
v_add_f32 v67, v67, v4
v_mul_f32 v20, v36, v36
v_mul_f32 v28, v52, v52
v_mul_f32 v21, v37, v37
s_add_u32 m0, s76, 122880
s_nop 0
buffer_load_dwordx4 v8, s[4:7], s74 offen offset:0 lds
v_mul_f32 v29, v53, v53
v_fmac_f32 v20, v38, v38
v_fmac_f32 v28, v54, v54
v_fmac_f32 v21, v39, v39
v_fmac_f32 v29, v55, v55
buffer_load_dwordx4 v9, s[4:7], s74 offen offset:1024 lds
v_fmac_f32 v20, v40, v40
v_fmac_f32 v28, v56, v56
v_fmac_f32 v21, v41, v41
v_fmac_f32 v29, v57, v57
v_fmac_f32 v20, v42, v42
buffer_load_dwordx4 v10, s[4:7], s74 offen offset:2048 lds
v_fmac_f32 v28, v58, v58
v_fmac_f32 v21, v43, v43
v_fmac_f32 v29, v59, v59
v_fmac_f32 v20, v44, v44
v_fmac_f32 v28, v60, v60
buffer_load_dwordx4 v11, s[4:7], s74 offen offset:3072 lds
s_add_u32 s74, s74, 128
s_and_b32 s74, s74, 2047
v_fmac_f32 v21, v45, v45
v_fmac_f32 v29, v61, v61
s_waitcnt vmcnt(14)
s_barrier
s_add_u32 m0, s77, 40960
s_nop 0
buffer_load_dwordx4 v12, s[8:11], s75 offen offset:0 lds
v_fmac_f32 v20, v46, v46
v_fmac_f32 v28, v62, v62
v_fmac_f32 v21, v47, v47
v_fmac_f32 v29, v63, v63
v_fmac_f32 v20, v48, v48
buffer_load_dwordx4 v13, s[8:11], s75 offen offset:1024 lds
v_fmac_f32 v28, v64, v64
v_fmac_f32 v21, v49, v49
v_fmac_f32 v29, v65, v65
v_fmac_f32 v20, v50, v50
v_fmac_f32 v28, v66, v66
buffer_load_dwordx4 v14, s[8:11], s75 offen offset:2048 lds
v_fmac_f32 v21, v51, v51
v_fmac_f32 v29, v67, v67
v_add_f32 v3, v20, v21
v_add_f32 v5, v28, v29
s_nop 0
v_add_f32_dpp v3, v3, v3 row_ror:1 row_mask:0xf bank_mask:0xf
buffer_load_dwordx4 v15, s[8:11], s75 offen offset:3072 lds
v_add_f32_dpp v5, v5, v5 row_ror:1 row_mask:0xf bank_mask:0xf
v_add_f32_dpp v3, v3, v3 row_ror:2 row_mask:0xf bank_mask:0xf
s_nop 0
v_add_f32_dpp v5, v5, v5 row_ror:2 row_mask:0xf bank_mask:0xf
v_add_f32_dpp v3, v3, v3 row_ror:4 row_mask:0xf bank_mask:0xf
s_nop 0
v_add_f32_dpp v5, v5, v5 row_ror:4 row_mask:0xf bank_mask:0xf
s_add_u32 m0, s77, 45056
s_nop 0
buffer_load_dwordx4 v16, s[8:11], s75 offen offset:0 lds
v_add_f32_dpp v3, v3, v3 row_ror:8 row_mask:0xf bank_mask:0xf
v_add_f32_dpp v5, v5, v5 row_ror:8 row_mask:0xf bank_mask:0xf
v_mov_b32 v6, v3
v_mov_b32 v7, v5
s_nop 0
v_permlane16_swap_b32 v3, v6
buffer_load_dwordx4 v17, s[8:11], s75 offen offset:1024 lds
s_add_u32 s75, s75, 393216
s_cmp_eq_u32 s75, 6291456
s_cselect_b32 s75, 0, s75
v_permlane16_swap_b32 v5, v7
v_add_f32 v3, v3, v6
v_add_f32 v5, v5, v7
v_mov_b32 v6, v3
v_mov_b32 v7, v5
s_add_u32 m0, s76, 106496
s_branch L_over0
L_pad0:
s_branch L_ret4
L_over0:
s_nop 0
buffer_load_dwordx4 v8, s[4:7], s74 offen offset:0 lds
v_permlane32_swap_b32 v3, v6
v_permlane32_swap_b32 v5, v7
v_add_f32 v3, v3, v6
v_add_f32 v5, v5, v7
v_mov_b32 v6, 0x3727c5ac
buffer_load_dwordx4 v9, s[4:7], s74 offen offset:1024 lds
v_fmac_f32 v6, 0x3a800000, v3
v_rsq_f32 v3, v6
v_mov_b32 v6, 0x3727c5ac
v_fmac_f32 v6, 0x3a800000, v5
v_rsq_f32 v5, v6
buffer_load_dwordx4 v10, s[4:7], s74 offen offset:2048 lds
v_cmp_eq_u32 vcc, 1, v1
s_nop 1
v_cndmask_b32 v20, v2, v4, vcc
v_cndmask_b32 v21, v3, v5, vcc
v_mov_b32 v22, 0
v_mov_b32 v23, s68
buffer_load_dwordx4 v11, s[4:7], s74 offen offset:3072 lds
s_add_u32 s74, s74, 128
s_and_b32 s74, s74, 2047
buffer_load_dwordx4 a[0:3], v76, s[24:27], s85 offen nt
buffer_load_dwordx4 a[32:35], v78, s[28:31], s85 offen nt
s_add_u32 s85, s85, 57344
buffer_load_dwordx4 a[4:7], v76, s[24:27], s85 offen nt
buffer_load_dwordx4 a[36:39], v78, s[28:31], s85 offen nt
s_add_u32 s85, s85, 57344
buffer_load_dwordx4 a[8:11], v76, s[24:27], s85 offen nt
buffer_load_dwordx4 a[40:43], v78, s[28:31], s85 offen nt
s_add_u32 s85, s85, 57344
s_lshl_b32 s70, s87, 4
s_add_u32 s70, s70, 8192
s_mov_b64 exec, 3
buffer_store_dwordx4 v[20:23], v18, s[12:15], s70 offen sc1
s_mov_b64 exec, -1
s_waitcnt vmcnt(21)
s_barrier
s_add_u32 m0, s77, 0
s_nop 0
buffer_load_dwordx4 v12, s[8:11], s75 offen offset:0 lds
v_lshlrev_b32 v2, 16, v88
v_and_b32 v3, 0xffff0000, v88
v_lshlrev_b32 v4, 16, v89
buffer_load_dwordx4 v13, s[8:11], s75 offen offset:1024 lds
v_and_b32 v5, 0xffff0000, v89
v_add_f32 v2, v2, v3
v_add_f32 v4, v4, v5
buffer_load_dwordx4 v14, s[8:11], s75 offen offset:2048 lds
v_add_f32 v2, v2, v4
s_nop 1
v_add_f32_dpp v2, v2, v2 row_ror:1 row_mask:0xf bank_mask:0xf
s_nop 1
v_add_f32_dpp v2, v2, v2 row_ror:2 row_mask:0xf bank_mask:0xf
buffer_load_dwordx4 v15, s[8:11], s75 offen offset:3072 lds
s_nop 0
v_add_f32_dpp v2, v2, v2 row_ror:4 row_mask:0xf bank_mask:0xf
s_nop 1
v_add_f32_dpp v2, v2, v2 row_ror:8 row_mask:0xf bank_mask:0xf
v_mov_b32 v3, v2
s_add_u32 m0, s77, 4096
s_nop 0
buffer_load_dwordx4 v16, s[8:11], s75 offen offset:0 lds
v_permlane16_swap_b32 v2, v3
v_add_f32 v2, v2, v3
v_mov_b32 v3, v2
buffer_load_dwordx4 v17, s[8:11], s75 offen offset:1024 lds
s_add_u32 s75, s75, 393216
s_cmp_eq_u32 s75, 6291456
s_cselect_b32 s75, 0, s75
v_permlane32_swap_b32 v2, v3
v_add_f32 v2, v2, v3
s_lshl_b32 s70, s60, 2
s_add_u32 s70, s70, 162176
v_mov_b32 v3, s70
s_add_u32 m0, s76, 65536
s_nop 0
buffer_load_dwordx4 v8, s[4:7], s74 offen offset:0 lds
ds_write_b32 v3, v2
s_lshl_b32 s70, s60, 2
s_sub_u32 s70, s70, s65
s_lshl_b32 s70, s70, 4
v_add_u32 v4, s70, v1
v_min_u32 v4, 18, v4
buffer_load_dwordx4 v9, s[4:7], s74 offen offset:1024 lds
v_cmp_gt_u32 vcc, 16, v4
s_nop 1
v_cndmask_b32 v4, 18, v4, vcc
v_lshlrev_b32 v4, 3, v4
buffer_load_dwordx4 v10, s[4:7], s74 offen offset:2048 lds
v_add_u32 v4, 162048, v4
ds_write_b64 v4, v[88:89]
buffer_load_dwordx4 v11, s[4:7], s74 offen offset:3072 lds
s_add_u32 s74, s74, 128
s_and_b32 s74, s74, 2047
s_waitcnt vmcnt(21)
s_barrier
s_add_u32 m0, s77, 81920
s_nop 0
buffer_load_dwordx4 v12, s[8:11], s75 offen offset:0 lds
s_getreg_b32 s71, hwreg(HW_REG_XCC_ID, 0, 4)
v_mov_b32 v84, s71
buffer_load_dwordx4 v13, s[8:11], s75 offen offset:1024 lds
v_mov_b32 v85, 0
buffer_load_dwordx4 v14, s[8:11], s75 offen offset:2048 lds
v_mov_b32 v86, 0
buffer_load_dwordx4 v15, s[8:11], s75 offen offset:3072 lds
v_mov_b32 v87, s68
s_add_u32 m0, s77, 86016
s_nop 0
buffer_load_dwordx4 v16, s[8:11], s75 offen offset:0 lds
s_lshl_b32 s70, s79, 4
s_add_u32 s70, s70, 4096
v_mov_b32 v19, s70
buffer_load_dwordx4 v17, s[8:11], s75 offen offset:1024 lds
s_add_u32 s75, s75, 393216
s_cmp_eq_u32 s75, 6291456
s_cselect_b32 s75, 0, s75
s_lshl_b32 s70, s65, 4
s_add_u32 s70, s70, s64
s_lshl_b32 s70, s70, 4
s_add_u32 s70, s70, 40960
v_writelane_b32 v19, s70, 1
s_add_u32 m0, s76, 24576
s_nop 0
buffer_load_dwordx4 v8, s[4:7], s74 offen offset:0 lds
buffer_load_dwordx4 v9, s[4:7], s74 offen offset:1024 lds
buffer_load_dwordx4 v10, s[4:7], s74 offen offset:2048 lds
buffer_load_dwordx4 v11, s[4:7], s74 offen offset:3072 lds
s_add_u32 s74, s74, 128
s_and_b32 s74, s74, 2047
buffer_load_dwordx4 a[12:15], v76, s[24:27], s85 offen nt
buffer_load_dwordx4 a[44:47], v78, s[28:31], s85 offen nt
s_add_u32 s85, s85, 57344
buffer_load_dwordx4 a[16:19], v76, s[24:27], s85 offen nt
buffer_load_dwordx4 a[48:51], v78, s[28:31], s85 offen nt
s_add_u32 s85, s85, 57344
buffer_load_dwordx4 a[20:23], v76, s[24:27], s85 offen nt
buffer_load_dwordx4 a[52:55], v78, s[28:31], s85 offen nt
s_add_u32 s85, s85, 57344
s_mov_b64 exec, 3
buffer_store_dwordx4 v[84:87], v19, s[12:15], 0 offen sc1
s_mov_b64 exec, -1
s_waitcnt vmcnt(21)
s_barrier
s_add_u32 m0, s77, 40960
s_nop 0
buffer_load_dwordx4 v12, s[8:11], s75 offen offset:0 lds
buffer_load_dwordx4 v13, s[8:11], s75 offen offset:1024 lds
buffer_load_dwordx4 v14, s[8:11], s75 offen offset:2048 lds
buffer_load_dwordx4 v15, s[8:11], s75 offen offset:3072 lds
s_add_u32 m0, s77, 45056
s_nop 0
buffer_load_dwordx4 v16, s[8:11], s75 offen offset:0 lds
buffer_load_dwordx4 v17, s[8:11], s75 offen offset:1024 lds
s_add_u32 s75, s75, 393216
s_cmp_eq_u32 s75, 6291456
s_cselect_b32 s75, 0, s75
s_add_u32 m0, s76, 122880
s_nop 0
buffer_load_dwordx4 v8, s[4:7], s74 offen offset:0 lds
buffer_load_dwordx4 v9, s[4:7], s74 offen offset:1024 lds
buffer_load_dwordx4 v10, s[4:7], s74 offen offset:2048 lds
buffer_load_dwordx4 v11, s[4:7], s74 offen offset:3072 lds
s_add_u32 s74, s74, 128
s_and_b32 s74, s74, 2047
s_cmp_eq_u32 s60, 0
s_cbranch_scc1 L_pad5
s_cmp_eq_u32 s60, 1
s_cbranch_scc1 L_ret9
s_cmp_eq_u32 s60, 2
s_cbranch_scc1 L_ret9
s_branch L_ret9
L_ret9:
s_waitcnt vmcnt(21)
s_barrier
s_add_u32 m0, s77, 0
s_nop 0
buffer_load_dwordx4 v12, s[8:11], s75 offen offset:0 lds
buffer_load_dwordx4 v13, s[8:11], s75 offen offset:1024 lds
buffer_load_dwordx4 v14, s[8:11], s75 offen offset:2048 lds
buffer_load_dwordx4 v15, s[8:11], s75 offen offset:3072 lds
s_add_u32 m0, s77, 4096
s_nop 0
buffer_load_dwordx4 v16, s[8:11], s75 offen offset:0 lds
buffer_load_dwordx4 v17, s[8:11], s75 offen offset:1024 lds
s_add_u32 s75, s75, 393216
s_cmp_eq_u32 s75, 6291456
s_cselect_b32 s75, 0, s75
s_add_u32 m0, s76, 106496
s_nop 0
buffer_load_dwordx4 v8, s[4:7], s74 offen offset:0 lds
buffer_load_dwordx4 v9, s[4:7], s74 offen offset:1024 lds
buffer_load_dwordx4 v10, s[4:7], s74 offen offset:2048 lds
buffer_load_dwordx4 v11, s[4:7], s74 offen offset:3072 lds
s_add_u32 s74, s74, 128
s_and_b32 s74, s74, 2047
buffer_load_dwordx4 a[24:27], v76, s[24:27], s85 offen nt
buffer_load_dwordx4 a[56:59], v78, s[28:31], s85 offen nt
s_add_u32 s85, s85, 57344
buffer_load_dwordx4 a[28:31], v76, s[24:27], s85 offen nt
buffer_load_dwordx4 a[60:63], v78, s[28:31], s85 offen nt
s_add_u32 s85, s85, 57344
buffer_load_dwordx4 a[64:67], v77, s[32:35], s86 offen nt
s_add_u32 s86, s86, 16384
buffer_load_dwordx4 a[68:71], v77, s[32:35], s86 offen nt
s_add_u32 s86, s86, 16384
s_waitcnt vmcnt(20)
s_barrier
s_add_u32 m0, s77, 81920
s_nop 0
buffer_load_dwordx4 v12, s[8:11], s75 offen offset:0 lds
v_lshrrev_b32 v2, 4, v1
v_and_b32 v3, 15, v1
buffer_load_dwordx4 v13, s[8:11], s75 offen offset:1024 lds
v_lshlrev_b32 v44, 10, v2
v_lshl_add_u32 v44, v3, 4, v44
buffer_load_dwordx4 v14, s[8:11], s75 offen offset:2048 lds
s_lshl_b32 s70, s60, 8
v_add_u32 v44, s70, v44
s_lshl_b32 s87, s64, 14
s_add_u32 s87, s87, 65536
buffer_load_dwordx4 v15, s[8:11], s75 offen offset:3072 lds
v_and_b32 v45, 31, v1
v_lshlrev_b32 v45, 4, v45
s_add_u32 m0, s77, 86016
s_nop 0
buffer_load_dwordx4 v16, s[8:11], s75 offen offset:0 lds
s_lshl_b32 s88, s65, 11
s_lshl_b32 s70, s60, 9
s_add_u32 s88, s88, s70
s_add_u32 s88, s88, 8192
s_lshl_b32 s70, s64, 8
s_add_u32 s70, s70, 4096
v_lshlrev_b32 v4, 4, v3
v_add_u32 v4, s70, v4
buffer_load_dwordx4 v17, s[8:11], s75 offen offset:1024 lds
s_add_u32 s75, s75, 393216
s_cmp_eq_u32 s75, 6291456
s_cselect_b32 s75, 0, s75
v_add_u32 v5, 36864, v4
v_lshrrev_b32 v6, 5, v1
s_add_u32 m0, s76, 65536
s_nop 0
buffer_load_dwordx4 v8, s[4:7], s74 offen offset:0 lds
v_lshlrev_b32 v6, 8, v6
v_xor_b32 v4, v4, v6
buffer_load_dwordx4 v9, s[4:7], s74 offen offset:1024 lds
v_and_b32 v6, 1, v2
v_cmp_eq_u32 vcc, 1, v6
buffer_load_dwordx4 v10, s[4:7], s74 offen offset:2048 lds
s_nop 0
v_cndmask_b32 v46, v4, v5, vcc
buffer_load_dwordx4 v11, s[4:7], s74 offen offset:3072 lds
s_add_u32 s74, s74, 128
s_and_b32 s74, s74, 2047
s_add_u32 s70, s87, 0
buffer_load_dwordx4 v[20:23], v44, s[12:15], s70 offen sc1
buffer_load_dwordx4 v[36:39], v45, s[12:15], s88 offen sc1
buffer_load_dwordx4 v[40:43], v46, s[12:15], 0 offen offset:0 sc1
s_waitcnt vmcnt(23)
s_barrier
s_add_u32 m0, s77, 40960
s_nop 0
buffer_load_dwordx4 v12, s[8:11], s75 offen offset:0 lds
buffer_load_dwordx4 v13, s[8:11], s75 offen offset:1024 lds
buffer_load_dwordx4 v14, s[8:11], s75 offen offset:2048 lds
buffer_load_dwordx4 v15, s[8:11], s75 offen offset:3072 lds
s_add_u32 m0, s77, 45056
s_nop 0
buffer_load_dwordx4 v16, s[8:11], s75 offen offset:0 lds
buffer_load_dwordx4 v17, s[8:11], s75 offen offset:1024 lds
s_add_u32 s75, s75, 393216
s_cmp_eq_u32 s75, 6291456
s_cselect_b32 s75, 0, s75
s_add_u32 m0, s76, 24576
s_nop 0
buffer_load_dwordx4 v8, s[4:7], s74 offen offset:0 lds
buffer_load_dwordx4 v9, s[4:7], s74 offen offset:1024 lds
buffer_load_dwordx4 v10, s[4:7], s74 offen offset:2048 lds
buffer_load_dwordx4 v11, s[4:7], s74 offen offset:3072 lds
s_add_u32 s74, s74, 128
s_and_b32 s74, s74, 2047
buffer_load_dwordx4 a[72:75], v77, s[32:35], s86 offen nt
s_add_u32 s86, s86, 16384
buffer_load_dwordx4 a[76:79], v77, s[32:35], s86 offen nt
s_add_u32 s86, s86, 16384
buffer_load_dwordx4 a[80:83], v77, s[32:35], s86 offen nt
s_add_u32 s86, s86, 16384
s_waitcnt vmcnt(20)
s_barrier
s_add_u32 m0, s77, 0
s_nop 0
buffer_load_dwordx4 v12, s[8:11], s75 offen offset:0 lds
s_waitcnt vmcnt(14)
L_eg_chk:
v_xor_b32 v2, s68, v23
v_xor_b32 v3, s68, v39
v_xor_b32 v4, s68, v43
v_or3_b32 v2, v2, v3, v4
v_cmp_ne_u32 vcc, 0, v2
s_cbranch_vccnz L_eg_rt
L_eg_ok:
v_mov_b32 v24, v20
v_mov_b32 v25, v21
buffer_load_dwordx4 v13, s[8:11], s75 offen offset:1024 lds
v_mov_b32 v26, v22
v_permlane16_swap_b32 v20, v24
v_permlane16_swap_b32 v21, v25
buffer_load_dwordx4 v14, s[8:11], s75 offen offset:2048 lds
v_permlane16_swap_b32 v22, v26
v_add_f32 v20, v20, v24
v_add_f32 v21, v21, v25
buffer_load_dwordx4 v15, s[8:11], s75 offen offset:3072 lds
v_add_f32 v22, v22, v26
v_mov_b32 v24, v20
v_mov_b32 v25, v21
s_add_u32 m0, s77, 4096
s_nop 0
buffer_load_dwordx4 v16, s[8:11], s75 offen offset:0 lds
v_mov_b32 v26, v22
v_permlane32_swap_b32 v20, v24
v_permlane32_swap_b32 v21, v25
buffer_load_dwordx4 v17, s[8:11], s75 offen offset:1024 lds
s_add_u32 s75, s75, 393216
s_cmp_eq_u32 s75, 6291456
s_cselect_b32 s75, 0, s75
v_permlane32_swap_b32 v22, v26
v_add_f32 v20, v20, v24
s_lshl_b32 s70, s63, 2
s_add_u32 s70, s70, s60
s_lshl_b32 s70, s70, 14
v_lshlrev_b32 v81, 10, v1
s_mov_b64 exec, 0xffff
buffer_load_dword v81, v81, s[16:19], s70 offen offset:384
s_mov_b64 exec, -1
buffer_load_dwordx4 a[84:87], v77, s[32:35], s86 offen nt
s_add_u32 s86, s86, 16384
buffer_load_dwordx4 a[88:91], v77, s[32:35], s86 offen nt
s_add_u32 s86, s86, 16384
buffer_load_dwordx4 a[92:95], v77, s[32:35], s86 offen nt
s_add_u32 s86, s86, 16384
s_waitcnt vmcnt(17)
s_barrier
s_mul_i32 s70, s60, 2
s_add_u32 s70, s70, 120
s_lshl_b32 s82, s89, 3
s_add_u32 s82, s82, s70
s_lshl_b32 s70, s70, 10
s_add_u32 m0, s70, 28672
s_and_b32 s82, s82, 127
s_lshl_b32 s82, s82, 14
buffer_load_dwordx4 v80, s[16:19], s82 offen lds
v_add_f32 v21, v21, v25
v_add_f32 v22, v22, v26
v_and_b32 v3, 15, v1
v_lshlrev_b32 v3, 2, v3
s_lshl_b32 s70, s60, 6
s_add_u32 s70, s70, 160768
v_add_u32 v3, s70, v3
ds_write_b32 v3, v20 offset:0
ds_write_b32 v3, v21 offset:256
ds_write_b32 v3, v22 offset:512
s_add_u32 m0, m0, 1024
s_add_u32 s82, s82, 16384
s_and_b32 s82, s82, 0x1fffff
buffer_load_dwordx4 v80, s[16:19], s82 offen lds
v_lshrrev_b32 v4, 2, v45
s_lshl_b32 s70, s60, 7
s_add_u32 s70, s70, 159744
v_add_u32 v4, s70, v4
ds_write_b32 v4, v36
ds_write_b32 v4, v37 offset:512
s_getreg_b32 s71, hwreg(HW_REG_XCC_ID, 0, 4)
v_cmp_ne_u32 vcc, s71, v40
s_nop 0
s_or_b32 s70, vcc_lo, vcc_hi
s_and_b32 s70, s70, 0xffff
s_cselect_b32 s69, 0, 1
v_mov_b32 v5, s69
v_mov_b32 v6, 161536
ds_write_b32 v6, v5
s_waitcnt vmcnt(6)
s_barrier
s_mul_i32 s70, s60, 10
s_add_u32 s70, s70, 80
s_lshl_b32 s82, s89, 3
s_add_u32 s82, s82, s70
s_lshl_b32 s70, s70, 10
s_add_u32 m0, s70, 28672
s_and_b32 s82, s82, 127
s_lshl_b32 s82, s82, 14
buffer_load_dwordx4 v80, s[16:19], s82 offen lds
s_add_u32 m0, m0, 1024
s_add_u32 s82, s82, 16384
s_and_b32 s82, s82, 0x1fffff
buffer_load_dwordx4 v80, s[16:19], s82 offen lds
s_add_u32 m0, m0, 1024
s_add_u32 s82, s82, 16384
s_and_b32 s82, s82, 0x1fffff
buffer_load_dwordx4 v80, s[16:19], s82 offen lds
s_add_u32 m0, m0, 1024
s_add_u32 s82, s82, 16384
s_and_b32 s82, s82, 0x1fffff
buffer_load_dwordx4 v80, s[16:19], s82 offen lds
s_add_u32 m0, m0, 1024
s_add_u32 s82, s82, 16384
s_and_b32 s82, s82, 0x1fffff
buffer_load_dwordx4 v80, s[16:19], s82 offen lds
s_add_u32 m0, m0, 1024
s_add_u32 s82, s82, 16384
s_and_b32 s82, s82, 0x1fffff
buffer_load_dwordx4 v80, s[16:19], s82 offen lds
s_add_u32 m0, m0, 1024
s_add_u32 s82, s82, 16384
s_and_b32 s82, s82, 0x1fffff
buffer_load_dwordx4 v80, s[16:19], s82 offen lds
s_add_u32 m0, m0, 1024
s_add_u32 s82, s82, 16384
s_and_b32 s82, s82, 0x1fffff
buffer_load_dwordx4 v80, s[16:19], s82 offen lds
s_add_u32 m0, m0, 1024
s_add_u32 s82, s82, 16384
s_and_b32 s82, s82, 0x1fffff
buffer_load_dwordx4 v80, s[16:19], s82 offen lds
s_add_u32 m0, m0, 1024
s_add_u32 s82, s82, 16384
s_and_b32 s82, s82, 0x1fffff
buffer_load_dwordx4 v80, s[16:19], s82 offen lds
s_setprio 0
s_waitcnt lgkmcnt(0)
s_barrier
s_mov_b32 exec_lo, 0x0
s_mov_b32 exec_hi, 0xf
buffer_load_dword v81, v83, s[12:15], 0 offen
s_mov_b64 exec, -1
s_mul_i32 s70, s60, 14
s_add_u32 s70, s70, 24
s_lshl_b32 s82, s89, 3
s_add_u32 s82, s82, s70
s_lshl_b32 s70, s70, 10
s_add_u32 m0, s70, 28672
s_and_b32 s82, s82, 127
s_lshl_b32 s82, s82, 14
buffer_load_dwordx4 v80, s[16:19], s82 offen lds
s_add_u32 m0, m0, 1024
s_add_u32 s82, s82, 16384
s_and_b32 s82, s82, 0x1fffff
buffer_load_dwordx4 v80, s[16:19], s82 offen lds
s_add_u32 m0, m0, 1024
s_add_u32 s82, s82, 16384
s_and_b32 s82, s82, 0x1fffff
buffer_load_dwordx4 v80, s[16:19], s82 offen lds
s_add_u32 m0, m0, 1024
s_add_u32 s82, s82, 16384
s_and_b32 s82, s82, 0x1fffff
buffer_load_dwordx4 v80, s[16:19], s82 offen lds
s_add_u32 m0, m0, 1024
s_add_u32 s82, s82, 16384
s_and_b32 s82, s82, 0x1fffff
buffer_load_dwordx4 v80, s[16:19], s82 offen lds
s_add_u32 m0, m0, 1024
s_add_u32 s82, s82, 16384
s_and_b32 s82, s82, 0x1fffff
buffer_load_dwordx4 v80, s[16:19], s82 offen lds
s_add_u32 m0, m0, 1024
s_add_u32 s82, s82, 16384
s_and_b32 s82, s82, 0x1fffff
buffer_load_dwordx4 v80, s[16:19], s82 offen lds
s_add_u32 m0, m0, 1024
s_add_u32 s82, s82, 16384
s_and_b32 s82, s82, 0x1fffff
buffer_load_dwordx4 v80, s[16:19], s82 offen lds
s_add_u32 m0, m0, 1024
s_add_u32 s82, s82, 16384
s_and_b32 s82, s82, 0x1fffff
buffer_load_dwordx4 v80, s[16:19], s82 offen lds
s_add_u32 m0, m0, 1024
s_add_u32 s82, s82, 16384
s_and_b32 s82, s82, 0x1fffff
buffer_load_dwordx4 v80, s[16:19], s82 offen lds
s_add_u32 m0, m0, 1024
s_add_u32 s82, s82, 16384
s_and_b32 s82, s82, 0x1fffff
buffer_load_dwordx4 v80, s[16:19], s82 offen lds
s_add_u32 m0, m0, 1024
s_add_u32 s82, s82, 16384
s_and_b32 s82, s82, 0x1fffff
buffer_load_dwordx4 v80, s[16:19], s82 offen lds
s_add_u32 m0, m0, 1024
s_add_u32 s82, s82, 16384
s_and_b32 s82, s82, 0x1fffff
buffer_load_dwordx4 v80, s[16:19], s82 offen lds
s_add_u32 m0, m0, 1024
s_add_u32 s82, s82, 16384
s_and_b32 s82, s82, 0x1fffff
buffer_load_dwordx4 v80, s[16:19], s82 offen lds
s_sub_i32 s70, s64, s65
s_lshl_b32 s70, s70, 18
v_add_u32 v8, s70, v8
v_add_u32 v9, s70, v9
v_add_u32 v10, s70, v10
v_add_u32 v11, s70, v11
v_lshrrev_b32 v2, 4, v1
v_bfe_u32 v3, v1, 2, 2
v_and_b32 v4, 1, v1
v_lshlrev_b32 v4, 4, v4
v_mov_b32 v5, 0x3f80
v_lshlrev_b32 v4, v4, v5
v_cmp_eq_u32 vcc, v2, v3
s_nop 1
v_cndmask_b32 v4, 0, v4, vcc
v_and_b32 v5, 2, v1
v_cmp_eq_u32 vcc, 0, v5
s_nop 1
v_cndmask_b32 v58, 0, v4, vcc
v_cndmask_b32_e64 v59, v4, 0, vcc
v_mov_b32 v56, 0
v_mov_b32 v57, 0
v_mov_b32 v60, 0
v_mov_b32 v61, 0
v_and_b32 v3, 15, v1
v_mul_u32_u24 v55, 4352, v3
v_lshrrev_b32 v2, 4, v1
v_lshl_add_u32 v55, v2, 5, v55
s_mul_i32 s87, s64, 69632
s_add_u32 s87, s87, 524288
s_lshl_b32 s70, s66, 7
s_lshl_b32 s71, s67, 4
s_add_u32 s88, s70, s71
s_add_u32 s88, s88, s87
s_add_u32 s88, s88, 4096
s_lshl_b32 s70, s60, 10
s_add_u32 s87, s87, s70
s_cmp_eq_u32 s60, 0
s_cbranch_scc1 L_pad1
s_cmp_eq_u32 s60, 1
s_cbranch_scc1 L_pad8
s_cmp_eq_u32 s60, 2
s_cbranch_scc1 L_pad14
s_branch L_retF
L_retF:
s_barrier
s_barrier
s_mul_i32 s70, s60, 6
s_add_u32 s70, s70, 0
s_lshl_b32 s82, s89, 3
s_add_u32 s82, s82, s70
s_lshl_b32 s70, s70, 10
s_add_u32 m0, s70, 28672
s_and_b32 s82, s82, 127
s_lshl_b32 s82, s82, 14
buffer_load_dwordx4 v80, s[16:19], s82 offen lds
s_add_u32 m0, m0, 1024
s_add_u32 s82, s82, 16384
s_and_b32 s82, s82, 0x1fffff
buffer_load_dwordx4 v80, s[16:19], s82 offen lds
s_add_u32 m0, m0, 1024
s_add_u32 s82, s82, 16384
s_and_b32 s82, s82, 0x1fffff
buffer_load_dwordx4 v80, s[16:19], s82 offen lds
s_add_u32 m0, m0, 1024
s_add_u32 s82, s82, 16384
s_and_b32 s82, s82, 0x1fffff
buffer_load_dwordx4 v80, s[16:19], s82 offen lds
s_add_u32 m0, m0, 1024
s_add_u32 s82, s82, 16384
s_and_b32 s82, s82, 0x1fffff
buffer_load_dwordx4 v80, s[16:19], s82 offen lds
s_add_u32 m0, m0, 1024
s_add_u32 s82, s82, 16384
s_and_b32 s82, s82, 0x1fffff
buffer_load_dwordx4 v80, s[16:19], s82 offen lds
s_lshl_b32 s70, s65, 7
s_mov_b32 m0, s76
s_nop 0
buffer_load_dwordx4 v8, s[4:7], s70 offen offset:0 lds
buffer_load_dwordx4 v9, s[4:7], s70 offen offset:1024 lds
buffer_load_dwordx4 v10, s[4:7], s70 offen offset:2048 lds
buffer_load_dwordx4 v11, s[4:7], s70 offen offset:3072 lds
s_add_u32 s70, s65, 1
s_and_b32 s70, s70, 15
s_mul_i32 s70, s70, 4352
s_add_u32 s70, s70, s87
buffer_load_dwordx4 v[84:87], v18, s[12:15], s70 offen sc1
s_add_u32 s70, s65, 2
s_and_b32 s70, s70, 15
s_mul_i32 s70, s70, 4352
s_add_u32 s70, s70, s87
buffer_load_dwordx4 v[88:91], v18, s[12:15], s70 offen sc1
s_add_u32 s70, s65, 3
s_and_b32 s70, s70, 15
s_mul_i32 s70, s70, 4352
s_add_u32 s70, s70, s87
buffer_load_dwordx4 v[92:95], v18, s[12:15], s70 offen sc1
s_add_u32 s70, s65, 4
s_and_b32 s70, s70, 15
s_mul_i32 s70, s70, 4352
s_add_u32 s70, s70, s87
buffer_load_dwordx4 v[96:99], v18, s[12:15], s70 offen sc1
s_add_u32 s70, s65, 5
s_and_b32 s70, s70, 15
s_mul_i32 s70, s70, 4352
s_add_u32 s70, s70, s87
buffer_load_dwordx4 v[100:103], v18, s[12:15], s70 offen sc1
s_add_u32 s70, s65, 6
s_and_b32 s70, s70, 15
s_mul_i32 s70, s70, 4352
s_add_u32 s70, s70, s87
buffer_load_dwordx4 v[104:107], v18, s[12:15], s70 offen sc1
s_add_u32 s70, s65, 7
s_and_b32 s70, s70, 15
s_mul_i32 s70, s70, 4352
s_add_u32 s70, s70, s87
buffer_load_dwordx4 v[108:111], v18, s[12:15], s70 offen sc1
s_add_u32 s70, s65, 8
s_and_b32 s70, s70, 15
s_mul_i32 s70, s70, 4352
s_add_u32 s70, s70, s87
buffer_load_dwordx4 v[112:115], v18, s[12:15], s70 offen sc1
s_add_u32 s70, s65, 9
s_and_b32 s70, s70, 15
s_mul_i32 s70, s70, 4352
s_add_u32 s70, s70, s87
buffer_load_dwordx4 v[116:119], v18, s[12:15], s70 offen sc1
s_add_u32 s70, s65, 10
s_and_b32 s70, s70, 15
s_mul_i32 s70, s70, 4352
s_add_u32 s70, s70, s87
buffer_load_dwordx4 v[120:123], v18, s[12:15], s70 offen sc1
s_add_u32 s70, s65, 11
s_and_b32 s70, s70, 15
s_mul_i32 s70, s70, 4352
s_add_u32 s70, s70, s87
buffer_load_dwordx4 v[124:127], v18, s[12:15], s70 offen sc1
s_add_u32 s70, s65, 12
s_and_b32 s70, s70, 15
s_mul_i32 s70, s70, 4352
s_add_u32 s70, s70, s87
buffer_load_dwordx4 v[128:131], v18, s[12:15], s70 offen sc1
s_add_u32 s70, s65, 13
s_and_b32 s70, s70, 15
s_mul_i32 s70, s70, 4352
s_add_u32 s70, s70, s87
buffer_load_dwordx4 v[132:135], v18, s[12:15], s70 offen sc1
s_add_u32 s70, s65, 14
s_and_b32 s70, s70, 15
s_mul_i32 s70, s70, 4352
s_add_u32 s70, s70, s87
buffer_load_dwordx4 v[136:139], v18, s[12:15], s70 offen sc1
s_add_u32 s70, s65, 15
s_and_b32 s70, s70, 15
s_mul_i32 s70, s70, 4352
s_add_u32 s70, s70, s87
buffer_load_dwordx4 v[140:143], v18, s[12:15], s70 offen sc1
s_add_u32 s70, s65, 16
s_and_b32 s70, s70, 15
s_mul_i32 s70, s70, 4352
s_add_u32 s70, s70, s87
s_branch L_over1
L_pad1:
s_branch L_retF
L_over1:
buffer_load_dwordx4 v[144:147], v18, s[12:15], s70 offen sc1
buffer_load_dwordx4 v[148:151], v55, s[12:15], s88 offen sc1
s_lshl_b32 s70, s66, 6
s_lshl_b32 s71, s67, 3
s_add_u32 s70, s70, s71
s_add_u32 s70, s70, 161600
v_lshrrev_b32 v4, 4, v1
v_lshlrev_b32 v4, 4, v4
v_add_u32 v4, s70, v4
s_lshl_b32 s70, s60, 10
s_add_u32 s70, s70, 24576
v_add_u32 v3, s70, v18
s_mov_b32 s73, 31
L_kvr:
s_bitcmp1_b32 s73, 0
s_cbranch_scc0 L_kvs0
s_waitcnt vmcnt(13)
v_max3_u32 v2, v84, v88, v92
v_max_u32 v2, v2, v96
v_cmp_eq_u32 vcc, -1, v2
s_cbranch_vccnz L_kvs0
s_bitset0_b32 s73, 0
v_mfma_f32_16x16x32_bf16 v[20:23], v[58:61], v[84:87], 0
v_mfma_f32_16x16x32_bf16 v[24:27], v[56:59], v[84:87], 0
v_mfma_f32_16x16x32_bf16 v[20:23], v[58:61], v[88:91], v[20:23]
v_mfma_f32_16x16x32_bf16 v[24:27], v[56:59], v[88:91], v[24:27]
v_mfma_f32_16x16x32_bf16 v[20:23], v[58:61], v[92:95], v[20:23]
v_mfma_f32_16x16x32_bf16 v[24:27], v[56:59], v[92:95], v[24:27]
v_mfma_f32_16x16x32_bf16 v[20:23], v[58:61], v[96:99], v[20:23]
v_mfma_f32_16x16x32_bf16 v[24:27], v[56:59], v[96:99], v[24:27]
L_kvs0:
s_bitcmp1_b32 s73, 1
s_cbranch_scc0 L_kvs1
s_waitcnt vmcnt(9)
v_max3_u32 v2, v100, v104, v108
v_max_u32 v2, v2, v112
v_cmp_eq_u32 vcc, -1, v2
s_cbranch_vccnz L_kvs1
s_bitset0_b32 s73, 1
v_mfma_f32_16x16x32_bf16 v[28:31], v[58:61], v[100:103], 0
v_mfma_f32_16x16x32_bf16 v[32:35], v[56:59], v[100:103], 0
v_mfma_f32_16x16x32_bf16 v[28:31], v[58:61], v[104:107], v[28:31]
v_mfma_f32_16x16x32_bf16 v[32:35], v[56:59], v[104:107], v[32:35]
v_mfma_f32_16x16x32_bf16 v[28:31], v[58:61], v[108:111], v[28:31]
v_mfma_f32_16x16x32_bf16 v[32:35], v[56:59], v[108:111], v[32:35]
v_mfma_f32_16x16x32_bf16 v[28:31], v[58:61], v[112:115], v[28:31]
v_mfma_f32_16x16x32_bf16 v[32:35], v[56:59], v[112:115], v[32:35]
L_kvs1:
s_bitcmp1_b32 s73, 2
s_cbranch_scc0 L_kvs2
s_waitcnt vmcnt(5)
v_max3_u32 v2, v116, v120, v124
v_max_u32 v2, v2, v128
v_cmp_eq_u32 vcc, -1, v2
s_cbranch_vccnz L_kvs2
s_bitset0_b32 s73, 2
v_mfma_f32_16x16x32_bf16 v[36:39], v[58:61], v[116:119], 0
v_mfma_f32_16x16x32_bf16 v[40:43], v[56:59], v[116:119], 0
v_mfma_f32_16x16x32_bf16 v[36:39], v[58:61], v[120:123], v[36:39]
v_mfma_f32_16x16x32_bf16 v[40:43], v[56:59], v[120:123], v[40:43]
v_mfma_f32_16x16x32_bf16 v[36:39], v[58:61], v[124:127], v[36:39]
v_mfma_f32_16x16x32_bf16 v[40:43], v[56:59], v[124:127], v[40:43]
v_mfma_f32_16x16x32_bf16 v[36:39], v[58:61], v[128:131], v[36:39]
v_mfma_f32_16x16x32_bf16 v[40:43], v[56:59], v[128:131], v[40:43]
L_kvs2:
s_bitcmp1_b32 s73, 3
s_cbranch_scc0 L_kvs3
s_waitcnt vmcnt(1)
v_max3_u32 v2, v132, v136, v140
v_max_u32 v2, v2, v144
v_cmp_eq_u32 vcc, -1, v2
s_cbranch_vccnz L_kvs3
s_bitset0_b32 s73, 3
v_mfma_f32_16x16x32_bf16 v[44:47], v[58:61], v[132:135], 0
v_mfma_f32_16x16x32_bf16 v[48:51], v[56:59], v[132:135], 0
v_mfma_f32_16x16x32_bf16 v[44:47], v[58:61], v[136:139], v[44:47]
v_mfma_f32_16x16x32_bf16 v[48:51], v[56:59], v[136:139], v[48:51]
v_mfma_f32_16x16x32_bf16 v[44:47], v[58:61], v[140:143], v[44:47]
v_mfma_f32_16x16x32_bf16 v[48:51], v[56:59], v[140:143], v[48:51]
v_mfma_f32_16x16x32_bf16 v[44:47], v[58:61], v[144:147], v[44:47]
v_mfma_f32_16x16x32_bf16 v[48:51], v[56:59], v[144:147], v[48:51]
L_kvs3:
s_bitcmp1_b32 s73, 4
s_cbranch_scc0 L_kvs4
s_waitcnt vmcnt(0)
v_xor_b32 v148, s84, v148
v_xor_b32 v149, s84, v149
v_xor_b32 v150, s84, v150
v_xor_b32 v151, s84, v151
v_or3_b32 v2, v148, v149, v150
v_bitop3_b32 v2, v2, v151, s91 bitop3:0xa8
v_cmp_ne_u32 vcc, 0, v2
s_cbranch_vccnz L_kvs4
s_bitset0_b32 s73, 4
v_add_f32_dpp v148, v148, v148 row_ror:1 row_mask:0xf bank_mask:0xf
v_add_f32_dpp v149, v149, v149 row_ror:1 row_mask:0xf bank_mask:0xf
v_add_f32_dpp v150, v150, v150 row_ror:1 row_mask:0xf bank_mask:0xf
v_add_f32_dpp v151, v151, v151 row_ror:1 row_mask:0xf bank_mask:0xf
v_add_f32_dpp v148, v148, v148 row_ror:2 row_mask:0xf bank_mask:0xf
v_add_f32_dpp v149, v149, v149 row_ror:2 row_mask:0xf bank_mask:0xf
v_add_f32_dpp v150, v150, v150 row_ror:2 row_mask:0xf bank_mask:0xf
v_add_f32_dpp v151, v151, v151 row_ror:2 row_mask:0xf bank_mask:0xf
v_add_f32_dpp v148, v148, v148 row_ror:4 row_mask:0xf bank_mask:0xf
v_add_f32_dpp v149, v149, v149 row_ror:4 row_mask:0xf bank_mask:0xf
v_add_f32_dpp v150, v150, v150 row_ror:4 row_mask:0xf bank_mask:0xf
v_add_f32_dpp v151, v151, v151 row_ror:4 row_mask:0xf bank_mask:0xf
v_add_f32_dpp v148, v148, v148 row_ror:8 row_mask:0xf bank_mask:0xf
v_add_f32_dpp v149, v149, v149 row_ror:8 row_mask:0xf bank_mask:0xf
v_add_f32_dpp v150, v150, v150 row_ror:8 row_mask:0xf bank_mask:0xf
v_add_f32_dpp v151, v151, v151 row_ror:8 row_mask:0xf bank_mask:0xf
v_cvt_pk_bf16_f32 v148, v148, v149
v_cvt_pk_bf16_f32 v149, v150, v151
ds_write_b64 v4, v[148:149]
L_kvs4:
s_cmp_lg_u32 s73, 0
s_cbranch_scc1 L_kvrt
L_kvok:
s_nop 3
v_pk_add_f32 v[20:21], v[20:21], v[28:29]
v_pk_add_f32 v[22:23], v[22:23], v[30:31]
v_pk_add_f32 v[24:25], v[24:25], v[32:33]
v_pk_add_f32 v[26:27], v[26:27], v[34:35]
v_pk_add_f32 v[36:37], v[36:37], v[44:45]
v_pk_add_f32 v[38:39], v[38:39], v[46:47]
v_pk_add_f32 v[40:41], v[40:41], v[48:49]
v_pk_add_f32 v[42:43], v[42:43], v[50:51]
v_pk_add_f32 v[20:21], v[20:21], v[36:37]
v_pk_add_f32 v[22:23], v[22:23], v[38:39]
v_pk_add_f32 v[24:25], v[24:25], v[40:41]
v_pk_add_f32 v[26:27], v[26:27], v[42:43]
v_cvt_pk_bf16_f32 v20, v20, v21
v_cvt_pk_bf16_f32 v21, v22, v23
v_cvt_pk_bf16_f32 v22, v24, v25
v_cvt_pk_bf16_f32 v23, v26, v27
ds_write_b128 v3, v[20:23]
s_waitcnt lgkmcnt(0)
s_barrier
s_mov_b32 exec_lo, 0x0
s_mov_b32 exec_hi, 0x3f000000
buffer_load_dword v81, v83, s[12:15], 0 offen
s_mov_b64 exec, -1
s_not_b32 s70, s68
v_mov_b32 v81, -1
v_writelane_b32 v81, s70, 62
v_writelane_b32 v81, s70, 63
s_mov_b32 exec_lo, 0
s_cmp_eq_u32 s69, 0
s_cselect_b32 exec_hi, 0, 0x3f000000
buffer_store_dword v81, v83, s[12:15], 0 offen offset:4
s_mov_b64 exec, -1
s_cmp_eq_u32 s60, 0
s_cbranch_scc1 L_pad2
s_cmp_eq_u32 s60, 1
s_cbranch_scc1 L_pad6
s_cmp_eq_u32 s60, 2
s_cbranch_scc1 L_pad7
s_branch L_pad9
L_retG:
v_lshrrev_b32 v2, 5, v1
v_lshlrev_b32 v2, 11, v2
v_bfe_u32 v3, v1, 3, 2
v_lshl_add_u32 v2, v3, 7, v2
v_bfe_u32 v3, v1, 4, 1
v_bfe_u32 v4, v1, 1, 2
v_xor_b32 v3, v3, v4
v_lshl_add_u32 v2, v3, 5, v2
v_and_b32 v3, 1, v1
v_lshl_add_u32 v2, v3, 4, v2
s_lshl_b32 s70, s60, 13
s_add_u32 s71, s70, 65536
v_add_u32 v100, s71, v2
v_xor_b32 v101, 64, v100
v_lshrrev_b32 v2, 2, v1
v_bfe_u32 v5, v1, 3, 2
v_xor_b32 v6, s60, v5
v_lshlrev_b32 v6, 5, v6
v_lshl_add_u32 v6, v2, 7, v6
v_and_b32 v7, 3, v1
v_lshl_add_u32 v6, v7, 3, v6
v_add_u32 v102, 65536, v6
s_lshl_b32 s71, s66, 16
s_add_u32 s70, s70, s71
s_add_u32 s70, s70, 49152
v_lshlrev_b32 v6, 5, v5
v_lshl_add_u32 v6, v2, 7, v6
v_lshl_add_u32 v6, v7, 3, v6
v_add_u32 v104, s70, v6
v_xor_b32 v105, 32, v104
v_xor_b32 v106, 64, v104
v_xor_b32 v107, 96, v104
v_lshrrev_b32 v5, 4, v1
v_xor_b32 v4, v4, v5
v_lshlrev_b32 v4, 5, v4
v_lshrrev_b32 v6, 3, v1
v_lshl_add_u32 v4, v6, 7, v4
v_lshl_add_u32 v4, v3, 4, v4
v_add_u32 v103, s70, v4
s_lshl_b32 s70, s60, 5
s_add_u32 s70, s70, 161792
v_mov_b32 v63, s70
v_add_u32 v114, 16, v63
v_lshl_add_u32 v56, v3, 4, v63
s_and_b32 s70, s65, 3
s_lshl_b32 s70, s70, 9
s_add_u32 s70, s70, 7864320
v_lshl_add_u32 v57, v5, 4, s70
v_lshlrev_b32 v60, 5, v5
v_lshl_add_u32 v60, v3, 4, v60
v_bfe_u32 v7, v1, 1, 1
v_lshl_add_u32 v60, v7, 7, v60
v_and_b32 v2, 3, v2
v_lshl_add_u32 v61, v2, 8, v60
v_lshlrev_b32 v62, 4, v3
v_lshl_add_u32 v62, v5, 5, v62
v_mov_b32 v59, s68
s_lshl_b32 s71, s79, 2
s_add_u32 s71, s71, s60
s_lshl_b32 s70, s71, 8
s_add_u32 s70, s70, 6946816
s_mov_b32 s85, s70
s_and_b32 s71, s65, 3
s_lshl2_add_u32 s71, s3, s71
s_and_b32 s70, s65, 12
s_add_u32 s70, s70, s60
s_lshl_b32 s71, s71, 7
s_lshl_b32 s70, s70, 15
s_add_u32 s70, s70, s71
s_add_u32 s70, s70, 7340032
s_mov_b32 s88, s70
s_lshl_b32 s70, s64, 14
s_add_u32 s86, s70, 6946816
s_and_b32 s70, s65, 3
v_mul_u32_u24 v2, 1, v7
v_xor_b32 v2, s70, v2
v_lshl_add_u32 v61, v2, 12, v61
s_lshl_b32 s87, s62, 11
s_add_u32 s87, s87, 6815744
s_mov_b32 s94, 0
s_mov_b32 s95, 0
s_mov_b32 s92, 0x000f000f
s_mov_b32 s93, 0x000f000f
s_and_b32 s70, s65, 12
s_add_u32 s70, s70, s60
s_lshr_b32 s70, s70, 1
s_xor_b32 s24, s70, s62
s_xor_b32 s70, s69, 1
s_or_b32 s24, s24, s70
s_mov_b32 s38, 0
v_mov_b32 v64, 0x3f803f80
v_mov_b32 v65, 0x3f803f80
v_mov_b32 v66, 0x3f803f80
v_mov_b32 v67, 0x3f803f80
v_add_u32 v115, 64, v1
v_mov_b32 v2, 0
v_mov_b32 v95, 0
v_mov_b32 v99, 0
s_waitcnt vmcnt(0) lgkmcnt(0)
s_barrier
ds_write_b128 v100, a[0:3] offset:0
ds_write_b128 v101, a[4:7] offset:512
ds_write_b128 v100, a[8:11] offset:1024
ds_write_b128 v101, a[12:15] offset:1536
ds_write_b128 v100, a[16:19] offset:4096
ds_write_b128 v101, a[20:23] offset:4608
ds_write_b128 v100, a[24:27] offset:5120
ds_write_b128 v101, a[28:31] offset:5632
ds_write_b128 v100, a[32:35] offset:32768
ds_write_b128 v101, a[36:39] offset:33280
ds_write_b128 v100, a[40:43] offset:33792
ds_write_b128 v101, a[44:47] offset:34304
ds_write_b128 v100, a[48:51] offset:36864
ds_write_b128 v101, a[52:55] offset:37376
ds_write_b128 v100, a[56:59] offset:37888
ds_write_b128 v101, a[60:63] offset:38400
ds_write_b128 v103, a[64:67] offset:0
ds_write_b128 v103, a[68:71] offset:1024
ds_write_b128 v103, a[72:75] offset:2048
ds_write_b128 v103, a[76:79] offset:3072
ds_write_b128 v103, a[80:83] offset:4096
ds_write_b128 v103, a[84:87] offset:5120
ds_write_b128 v103, a[88:91] offset:6144
ds_write_b128 v103, a[92:95] offset:7168
s_waitcnt lgkmcnt(0)
ds_read_b64_tr_b16 a[64:65], v104 offset:0
ds_read_b64_tr_b16 a[66:67], v104 offset:2048
ds_read_b64_tr_b16 a[68:69], v104 offset:4096
ds_read_b64_tr_b16 a[70:71], v104 offset:6144
ds_read_b64_tr_b16 a[72:73], v105 offset:0
ds_read_b64_tr_b16 a[74:75], v105 offset:2048
ds_read_b64_tr_b16 a[76:77], v105 offset:4096
ds_read_b64_tr_b16 a[78:79], v105 offset:6144
ds_read_b64_tr_b16 a[80:81], v106 offset:0
ds_read_b64_tr_b16 a[82:83], v106 offset:2048
ds_read_b64_tr_b16 a[84:85], v106 offset:4096
ds_read_b64_tr_b16 a[86:87], v106 offset:6144
ds_read_b64_tr_b16 a[88:89], v107 offset:0
ds_read_b64_tr_b16 a[90:91], v107 offset:2048
ds_read_b64_tr_b16 a[92:93], v107 offset:4096
ds_read_b64_tr_b16 a[94:95], v107 offset:6144
s_barrier
ds_read_b64_tr_b16 a[0:1], v102 offset:0
ds_read_b64_tr_b16 a[2:3], v102 offset:2048
ds_read_b64_tr_b16 a[32:33], v102 offset:32768
ds_read_b64_tr_b16 a[34:35], v102 offset:34816
ds_read_b64_tr_b16 a[4:5], v102 offset:4096
ds_read_b64_tr_b16 a[6:7], v102 offset:6144
ds_read_b64_tr_b16 a[36:37], v102 offset:36864
ds_read_b64_tr_b16 a[38:39], v102 offset:38912
ds_read_b64_tr_b16 a[8:9], v102 offset:8192
ds_read_b64_tr_b16 a[10:11], v102 offset:10240
ds_read_b64_tr_b16 a[40:41], v102 offset:40960
ds_read_b64_tr_b16 a[42:43], v102 offset:43008
ds_read_b64_tr_b16 a[12:13], v102 offset:12288
ds_read_b64_tr_b16 a[14:15], v102 offset:14336
ds_read_b64_tr_b16 a[44:45], v102 offset:45056
ds_read_b64_tr_b16 a[46:47], v102 offset:47104
ds_read_b64_tr_b16 a[16:17], v102 offset:16384
ds_read_b64_tr_b16 a[18:19], v102 offset:18432
ds_read_b64_tr_b16 a[48:49], v102 offset:49152
ds_read_b64_tr_b16 a[50:51], v102 offset:51200
ds_read_b64_tr_b16 a[20:21], v102 offset:20480
ds_read_b64_tr_b16 a[22:23], v102 offset:22528
ds_read_b64_tr_b16 a[52:53], v102 offset:53248
ds_read_b64_tr_b16 a[54:55], v102 offset:55296
ds_read_b64_tr_b16 a[24:25], v102 offset:24576
ds_read_b64_tr_b16 a[26:27], v102 offset:26624
ds_read_b64_tr_b16 a[56:57], v102 offset:57344
ds_read_b64_tr_b16 a[58:59], v102 offset:59392
ds_read_b64_tr_b16 a[28:29], v102 offset:28672
ds_read_b64_tr_b16 a[30:31], v102 offset:30720
ds_read_b64_tr_b16 a[60:61], v102 offset:61440
ds_read_b64_tr_b16 a[62:63], v102 offset:63488
s_waitcnt lgkmcnt(0)
buffer_load_dwordx4 v[92:95], v18, s[12:15], s87 offen offset:0 sc1
buffer_load_dwordx4 v[96:99], v18, s[12:15], s87 offen offset:1024 sc1
v_mfma_f32_16x16x32_bf16 v[68:71], a[0:3], v[64:67], 0
v_mfma_f32_16x16x32_bf16 v[72:75], a[32:35], v[64:67], 0
v_mfma_f32_16x16x32_bf16 v[68:71], a[4:7], v[64:67], v[68:71]
v_mfma_f32_16x16x32_bf16 v[72:75], a[36:39], v[64:67], v[72:75]
v_mfma_f32_16x16x32_bf16 v[68:71], a[8:11], v[64:67], v[68:71]
v_mfma_f32_16x16x32_bf16 v[72:75], a[40:43], v[64:67], v[72:75]
v_mfma_f32_16x16x32_bf16 v[68:71], a[12:15], v[64:67], v[68:71]
v_mfma_f32_16x16x32_bf16 v[72:75], a[44:47], v[64:67], v[72:75]
v_mfma_f32_16x16x32_bf16 v[68:71], a[16:19], v[64:67], v[68:71]
v_mfma_f32_16x16x32_bf16 v[72:75], a[48:51], v[64:67], v[72:75]
v_mfma_f32_16x16x32_bf16 v[68:71], a[20:23], v[64:67], v[68:71]
v_mfma_f32_16x16x32_bf16 v[72:75], a[52:55], v[64:67], v[72:75]
v_mfma_f32_16x16x32_bf16 v[68:71], a[24:27], v[64:67], v[68:71]
v_mfma_f32_16x16x32_bf16 v[72:75], a[56:59], v[64:67], v[72:75]
v_mfma_f32_16x16x32_bf16 v[68:71], a[28:31], v[64:67], v[68:71]
v_mfma_f32_16x16x32_bf16 v[72:75], a[60:63], v[64:67], v[72:75]
L_pk:
s_waitcnt vmcnt(0)
L_pk2:
v_cmp_eq_u32_e64 s[80:81], s68, v95
v_cmp_eq_u32_e64 s[82:83], s68, v99
s_nop 0
v_cndmask_b32_e64 v108, 0, v92, s[80:81]
v_cndmask_b32_e64 v109, 0, v96, s[82:83]
s_and_b64 s[76:77], s[80:81], s[82:83]
v_max_u32 v110, v108, v109
v_min_u32 v111, v108, v109
s_cmp_eq_u64 s[76:77], -1
s_cselect_b32 s73, 0, 1
s_cbranch_scc1 L_pkc
s_not_b64 exec, s[80:81]
s_cselect_b64 exec, exec, 1
buffer_load_dwordx4 v[92:95], v18, s[12:15], s87 offen offset:0 sc1
s_not_b64 exec, s[82:83]
s_cselect_b64 exec, exec, 1
buffer_load_dwordx4 v[96:99], v18, s[12:15], s87 offen offset:1024 sc1
s_mov_b64 exec, -1
L_pkc:
v_cmp_le_u32 vcc, s95, v110
v_cmp_le_u32_e64 s[76:77], s95, v111
s_bcnt1_i32_b64 s70, vcc
s_bcnt1_i32_b64 s71, s[76:77]
s_add_u32 s70, s70, s71
s_cmp_eq_u32 s70, 2
s_cbranch_scc1 L_pksame
v_mov_b32_dpp v112, v110 row_ror:1 row_mask:0xf bank_mask:0xf
v_max_u32_dpp v113, v111, v111 row_ror:1 row_mask:0xf bank_mask:0xf
v_med3_u32 v111, v110, v112, v113
v_max_u32 v110, v110, v112
s_nop 1
v_mov_b32_dpp v112, v110 row_ror:2 row_mask:0xf bank_mask:0xf
v_max_u32_dpp v113, v111, v111 row_ror:2 row_mask:0xf bank_mask:0xf
v_med3_u32 v111, v110, v112, v113
v_max_u32 v110, v110, v112
s_nop 1
v_mov_b32_dpp v112, v110 row_ror:4 row_mask:0xf bank_mask:0xf
v_max_u32_dpp v113, v111, v111 row_ror:4 row_mask:0xf bank_mask:0xf
v_med3_u32 v111, v110, v112, v113
v_max_u32 v110, v110, v112
s_nop 1
v_mov_b32_dpp v112, v110 row_ror:8 row_mask:0xf bank_mask:0xf
v_max_u32_dpp v113, v111, v111 row_ror:8 row_mask:0xf bank_mask:0xf
v_med3_u32 v111, v110, v112, v113
v_max_u32 v110, v110, v112
v_mov_b32 v112, v110
v_mov_b32 v113, v111
s_nop 0
v_permlane16_swap_b32 v110, v112
v_permlane16_swap_b32 v111, v113
v_max_u32 v113, v111, v113
v_med3_u32 v111, v110, v112, v113
v_max_u32 v110, v110, v112
v_mov_b32 v112, v110
v_mov_b32 v113, v111
s_nop 0
v_permlane32_swap_b32 v110, v112
v_permlane32_swap_b32 v111, v113
v_max_u32 v113, v111, v113
v_med3_u32 v111, v110, v112, v113
v_max_u32 v110, v110, v112
v_readfirstlane_b32 s95, v111
s_nop 0
s_cmp_eq_u32 s95, 0
s_cbranch_scc1 L_pksame
v_cmp_eq_u32 vcc, v108, v111
v_cmp_eq_u32_e64 s[76:77], v108, v110
s_nop 0
v_cndmask_b32 v112, v63, v114, vcc
s_or_b64 exec, vcc, s[76:77]
ds_write_b96 v112, v[92:94]
ds_write_b32 v112, v1 offset:12
s_mov_b64 exec, -1
v_cmp_eq_u32 vcc, v109, v111
v_cmp_eq_u32_e64 s[76:77], v109, v110
s_nop 0
v_cndmask_b32 v113, v63, v114, vcc
s_or_b64 exec, vcc, s[76:77]
ds_write_b96 v113, v[96:98]
ds_write_b32 v113, v115 offset:12
s_mov_b64 exec, -1
ds_read_b128 v[20:23], v56
s_waitcnt lgkmcnt(0)
v_lshl_add_u32 v58, v23, 11, v57
s_mov_b64 exec, s[92:93]
buffer_load_dwordx4 v[24:27], v58, s[12:15], 0 offen offset:0 sc1
buffer_load_dwordx4 v[28:31], v58, s[12:15], 0 offen offset:64 sc1
buffer_load_dwordx4 v[32:35], v58, s[12:15], 0 offen offset:128 sc1
buffer_load_dwordx4 v[36:39], v58, s[12:15], 0 offen offset:192 sc1
buffer_load_dwordx4 v[40:43], v58, s[12:15], 0 offen offset:256 sc1
buffer_load_dwordx4 v[44:47], v58, s[12:15], 0 offen offset:320 sc1
buffer_load_dwordx4 v[48:51], v58, s[12:15], 0 offen offset:384 sc1
buffer_load_dwordx4 v[52:55], v58, s[12:15], 0 offen offset:448 sc1
s_mov_b64 exec, -1
v_mul_f32_e64 v84, v68, -v21
v_mul_f32_e64 v85, v69, -v21
v_mul_f32_e64 v86, v70, -v21
v_mul_f32_e64 v87, v71, -v21
v_mul_f32_e64 v88, v72, -v21
v_mul_f32_e64 v89, v73, -v21
v_mul_f32_e64 v90, v74, -v21
v_mul_f32_e64 v91, v75, -v21
s_cmp_eq_u32 s73, 0
s_cbranch_scc1 L_pkf
s_waitcnt vmcnt(8)
s_add_u32 s78, s78, 1
s_cmp_le_u32 s78, 65536
s_cbranch_scc1 L_pk2
L_pkf:
s_waitcnt vmcnt(0)
L_pkx_chk:
v_max3_u32 v2, v24, v28, v32
v_max3_u32 v3, v36, v40, v44
v_max3_u32 v2, v2, v48, v52
v_max_u32 v2, v2, v3
v_cmp_eq_u32 vcc, -1, v2
s_nop 0
s_and_b64 vcc, vcc, s[92:93]
s_cbranch_vccnz L_pkx_rt
L_pkx_ok:
v_mfma_f32_16x16x32_bf16 v[84:87], a[0:3], v[24:27], v[84:87]
v_mfma_f32_16x16x32_bf16 v[88:91], a[32:35], v[24:27], v[88:91]
v_mfma_f32_16x16x32_bf16 v[84:87], a[4:7], v[28:31], v[84:87]
v_mfma_f32_16x16x32_bf16 v[88:91], a[36:39], v[28:31], v[88:91]
v_mfma_f32_16x16x32_bf16 v[84:87], a[8:11], v[32:35], v[84:87]
v_mfma_f32_16x16x32_bf16 v[88:91], a[40:43], v[32:35], v[88:91]
v_mfma_f32_16x16x32_bf16 v[84:87], a[12:15], v[36:39], v[84:87]
v_mfma_f32_16x16x32_bf16 v[88:91], a[44:47], v[36:39], v[88:91]
v_mfma_f32_16x16x32_bf16 v[84:87], a[16:19], v[40:43], v[84:87]
v_mfma_f32_16x16x32_bf16 v[88:91], a[48:51], v[40:43], v[88:91]
v_mfma_f32_16x16x32_bf16 v[84:87], a[20:23], v[44:47], v[84:87]
v_mfma_f32_16x16x32_bf16 v[88:91], a[52:55], v[44:47], v[88:91]
v_mfma_f32_16x16x32_bf16 v[84:87], a[24:27], v[48:51], v[84:87]
v_mfma_f32_16x16x32_bf16 v[88:91], a[56:59], v[48:51], v[88:91]
v_mfma_f32_16x16x32_bf16 v[84:87], a[28:31], v[52:55], v[84:87]
v_mfma_f32_16x16x32_bf16 v[88:91], a[60:63], v[52:55], v[88:91]
s_mov_b32 s76, 0xcccccccc
s_mov_b32 s77, 0xcccccccc
s_nop 5
v_cndmask_b32_e64 v84, v84, v88, s[76:77]
v_cndmask_b32_e64 v85, v85, v89, s[76:77]
v_cndmask_b32_e64 v86, v86, v90, s[76:77]
v_cndmask_b32_e64 v87, v87, v91, s[76:77]
v_bfi_b32 v84, s91, v59, v84
s_mov_b64 exec, s[92:93]
s_cmp_eq_u32 s69, 0
s_cbranch_scc1 L_pxp_s
buffer_store_dwordx4 v[84:87], v60, s[12:15], s85 offen
L_pxp_d:
s_mov_b64 exec, -1
buffer_load_dwordx4 v[24:27], v61, s[12:15], s86 offen offset:0 sc1
buffer_load_dwordx4 v[28:31], v61, s[12:15], s86 offen offset:1024 sc1
buffer_load_dwordx4 v[32:35], v61, s[12:15], s86 offen offset:2048 sc1
buffer_load_dwordx4 v[36:39], v61, s[12:15], s86 offen offset:3072 sc1
s_barrier
s_mov_b32 s92, 0x00030003
s_mov_b32 s93, 0x00030003
s_waitcnt vmcnt(0)
L_px_chk:
v_xor_b32 v24, s84, v24
v_xor_b32 v28, s84, v28
v_xor_b32 v32, s84, v32
v_xor_b32 v36, s84, v36
v_or3_b32 v2, v24, v28, v32
v_bitop3_b32 v2, v2, v36, s91 bitop3:0xa8
v_cmp_ne_u32 vcc, 0, v2
s_cbranch_vccnz L_px_rt
L_px_ok:
v_pk_add_f32 v[24:25], v[24:25], v[28:29]
v_pk_add_f32 v[32:33], v[32:33], v[36:37]
v_pk_add_f32 v[26:27], v[26:27], v[30:31]
v_pk_add_f32 v[34:35], v[34:35], v[38:39]
v_pk_add_f32 v[24:25], v[24:25], v[32:33]
v_pk_add_f32 v[26:27], v[26:27], v[34:35]
v_pk_mul_f32 v[24:25], v[24:25], v[22:23] op_sel_hi:[1,0]
v_pk_mul_f32 v[26:27], v[26:27], v[22:23] op_sel_hi:[1,0]
v_mul_f32 v28, 0xbfb8aa3b, v24
v_mul_f32 v29, 0xbfb8aa3b, v25
v_mul_f32 v30, 0xbfb8aa3b, v26
v_mul_f32 v31, 0xbfb8aa3b, v27
v_exp_f32 v28, v28
v_exp_f32 v29, v29
v_exp_f32 v30, v30
v_exp_f32 v31, v31
v_mul_f32_dpp v32, v24, v24 quad_perm:[2,3,0,1] row_mask:0xf bank_mask:0xf
v_mul_f32_dpp v33, v25, v25 quad_perm:[2,3,0,1] row_mask:0xf bank_mask:0xf
v_mul_f32_dpp v34, v26, v26 quad_perm:[2,3,0,1] row_mask:0xf bank_mask:0xf
v_mul_f32_dpp v35, v27, v27 quad_perm:[2,3,0,1] row_mask:0xf bank_mask:0xf
v_add_f32 v28, 1.0, v28
v_add_f32 v29, 1.0, v29
v_add_f32 v30, 1.0, v30
v_add_f32 v31, 1.0, v31
v_rcp_f32 v28, v28
v_rcp_f32 v29, v29
v_rcp_f32 v30, v30
v_rcp_f32 v31, v31
v_mul_f32 v24, v32, v28
v_mul_f32 v25, v33, v29
v_mul_f32 v26, v34, v30
v_mul_f32 v27, v35, v31
v_cvt_pk_bf16_f32 v28, v24, v25
v_cvt_pk_bf16_f32 v29, v26, v27
s_nop 0
v_mov_b32_dpp v30, v28 row_shl:4 row_mask:0xf bank_mask:0xf
v_mov_b32_dpp v31, v29 row_shl:4 row_mask:0xf bank_mask:0xf
v_mov_b32_dpp v32, v28 row_shl:8 row_mask:0xf bank_mask:0xf
v_mov_b32_dpp v33, v29 row_shl:8 row_mask:0xf bank_mask:0xf
v_mov_b32_dpp v34, v28 row_shl:12 row_mask:0xf bank_mask:0xf
v_mov_b32_dpp v35, v29 row_shl:12 row_mask:0xf bank_mask:0xf
v_mfma_f32_16x16x32_bf16 v[40:43], a[64:67], v[28:31], 0
v_mfma_f32_16x16x32_bf16 v[44:47], a[72:75], v[28:31], 0
v_mfma_f32_16x16x32_bf16 v[48:51], a[80:83], v[28:31], 0
v_mfma_f32_16x16x32_bf16 v[52:55], a[88:91], v[28:31], 0
v_mfma_f32_16x16x32_bf16 v[40:43], a[68:71], v[32:35], v[40:43]
v_mfma_f32_16x16x32_bf16 v[44:47], a[76:79], v[32:35], v[44:47]
v_mfma_f32_16x16x32_bf16 v[48:51], a[84:87], v[32:35], v[48:51]
v_mfma_f32_16x16x32_bf16 v[52:55], a[92:95], v[32:35], v[52:55]
s_cmp_ge_u32 s3, 14
s_cbranch_scc1 L_noy
s_mov_b64 exec, s[92:93]
s_cmp_eq_u32 s24, 0
s_cbranch_scc1 L_yown
v_bfi_b32 v40, s91, v59, v40
buffer_store_dwordx4 v[40:43], v62, s[12:15], s88 offen sc1
s_add_u32 s88, s88, 8192
v_bfi_b32 v44, s91, v59, v44
buffer_store_dwordx4 v[44:47], v62, s[12:15], s88 offen sc1
s_add_u32 s88, s88, 8192
v_bfi_b32 v48, s91, v59, v48
buffer_store_dwordx4 v[48:51], v62, s[12:15], s88 offen sc1
s_add_u32 s88, s88, 8192
v_bfi_b32 v52, s91, v59, v52
buffer_store_dwordx4 v[52:55], v62, s[12:15], s88 offen sc1
L_yd:
s_mov_b64 exec, -1
L_noy:
s_or_b32 s70, s2, s60
s_cbranch_scc1 L_noep
v_mov_b32 v3, 0
s_mov_b64 exec, 1
buffer_store_dword v59, v3, s[12:15], 0 offen sc1
s_mov_b64 exec, -1
L_noep:
s_cmp_lt_u32 s63, 24
s_cbranch_scc1 L_ldone
s_cmp_lg_u32 s60, 1
s_cbranch_scc1 L_ldone
s_lshl_b32 s87, s62, 3
s_add_u32 s87, s87, s63
s_sub_u32 s87, s87, 24
s_lshl_b32 s88, s87, 13
s_add_u32 s88, s88, 7340032
s_add_u32 s71, s88, 4096
s_lshl_b32 s70, s87, 5
v_bfe_u32 v3, v1, 1, 2
v_lshl_add_u32 v7, v3, 3, s70
s_mov_b32 s72, 7864320
v_lshl_add_u32 v64, v23, 11, v7
buffer_load_dwordx2 v[84:85], v64, s[12:15], s72 offen sc1
buffer_load_dwordx4 v[120:123], v18, s[12:15], s88 offen offset:0 sc1
buffer_load_dwordx4 v[124:127], v18, s[12:15], s88 offen offset:1024 sc1
buffer_load_dwordx4 v[128:131], v18, s[12:15], s88 offen offset:2048 sc1
buffer_load_dwordx4 v[132:135], v18, s[12:15], s88 offen offset:3072 sc1
buffer_load_dwordx4 v[136:139], v18, s[12:15], s71 offen offset:0 sc1
buffer_load_dwordx4 v[140:143], v18, s[12:15], s71 offen offset:1024 sc1
buffer_load_dwordx4 v[144:147], v18, s[12:15], s71 offen offset:2048 sc1
v_mov_b32 v88, s84
v_and_b32 v65, 0xfffff800, v20
v_not_b32 v4, v65
v_ashrrev_i32 v4, 31, v4
v_or_b32 v4, 0x80000000, v4
v_xor_b32 v65, v65, v4
v_mul_f32 v65, 0xbfb8aa3b, v65
v_exp_f32 v65, v65
s_nop 0
v_add_f32 v65, 1.0, v65
v_rcp_f32 v65, v65
v_and_b32 v66, 0x7ff, v20
v_sub_u32 v66, 2047, v66
v_lshl_add_u32 v66, v66, 11, v7
v_add_f32 v67, 1.0, v22
v_mul_f32_e64 v21, -v21, v22
s_load_dword s94, s[12:13], 4096
s_waitcnt lgkmcnt(0)
buffer_load_dwordx4 v[24:27], v18, s[12:15], s88 offen offset:0 sc1
buffer_load_dwordx4 v[28:31], v18, s[12:15], s88 offen offset:1024 sc1
buffer_load_dwordx4 v[32:35], v18, s[12:15], s88 offen offset:2048 sc1
buffer_load_dwordx4 v[36:39], v18, s[12:15], s88 offen offset:3072 sc1
buffer_load_dwordx4 v[92:95], v18, s[12:15], s71 offen offset:0 sc1
buffer_load_dwordx4 v[96:99], v18, s[12:15], s71 offen offset:1024 sc1
buffer_load_dwordx4 v[100:103], v18, s[12:15], s71 offen offset:2048 sc1
s_load_dword s94, s[12:13], 4160
s_waitcnt lgkmcnt(0)
buffer_load_dwordx4 v[40:43], v18, s[12:15], s88 offen offset:0 sc1
buffer_load_dwordx4 v[44:47], v18, s[12:15], s88 offen offset:1024 sc1
buffer_load_dwordx4 v[48:51], v18, s[12:15], s88 offen offset:2048 sc1
buffer_load_dwordx4 v[52:55], v18, s[12:15], s88 offen offset:3072 sc1
buffer_load_dwordx4 v[104:107], v18, s[12:15], s71 offen offset:0 sc1
buffer_load_dwordx4 v[108:111], v18, s[12:15], s71 offen offset:1024 sc1
buffer_load_dwordx4 v[112:115], v18, s[12:15], s71 offen offset:2048 sc1
s_waitcnt vmcnt(21)
L_h_chk:
v_cmp_eq_u32 vcc, -1, v84
s_cbranch_vccnz L_h_rt
L_h_ok:
v_lshlrev_b32 v86, 16, v85
v_and_b32 v87, 0xffff0000, v85
v_and_b32 v85, 0xffff0000, v84
v_lshlrev_b32 v84, 16, v84
v_fma_f32 v84, v84, v67, v21
v_fma_f32 v85, v85, v67, v21
v_fma_f32 v86, v86, v67, v21
v_fma_f32 v87, v87, v67, v21
L_yr:
s_branch L_over2
L_pad2:
s_branch L_pad10
L_over2:
s_waitcnt vmcnt(14)
v_xor_b32 v120, s84, v120
v_xor_b32 v124, s84, v124
v_xor_b32 v128, s84, v128
v_xor_b32 v132, s84, v132
v_or3_b32 v2, v120, v124, v128
v_xor_b32 v136, s84, v136
v_xor_b32 v140, s84, v140
v_or3_b32 v2, v2, v132, v136
v_xor_b32 v144, s84, v144
v_xor_b32 v88, s84, v88
v_or3_b32 v2, v2, v140, v144
v_bitop3_b32 v2, v2, v88, s91 bitop3:0xa8
v_cmp_ne_u32 vcc, 0, v2
s_cbranch_vccnz L_y_rt
L_yf0:
v_pk_add_f32 v[120:121], v[120:121], v[124:125]
v_pk_add_f32 v[122:123], v[122:123], v[126:127]
v_pk_add_f32 v[128:129], v[128:129], v[132:133]
v_pk_add_f32 v[130:131], v[130:131], v[134:135]
v_pk_add_f32 v[136:137], v[136:137], v[140:141]
v_pk_add_f32 v[138:139], v[138:139], v[142:143]
v_pk_add_f32 v[120:121], v[120:121], v[128:129]
v_pk_add_f32 v[122:123], v[122:123], v[130:131]
v_pk_add_f32 v[136:137], v[136:137], v[144:145]
v_pk_add_f32 v[138:139], v[138:139], v[146:147]
v_pk_add_f32 v[120:121], v[120:121], v[136:137]
v_pk_add_f32 v[122:123], v[122:123], v[138:139]
s_nop 0
v_add_f32_dpp v68, v120, v120 row_ror:8 row_mask:0xf bank_mask:0xf
v_add_f32_dpp v69, v121, v121 row_ror:8 row_mask:0xf bank_mask:0xf
v_add_f32_dpp v70, v122, v122 row_ror:8 row_mask:0xf bank_mask:0xf
v_add_f32_dpp v71, v123, v123 row_ror:8 row_mask:0xf bank_mask:0xf
L_yf:
v_mov_b32 v72, v68
v_mov_b32 v73, v69
v_mov_b32 v74, v70
v_mov_b32 v75, v71
v_permlane16_swap_b32 v68, v72
v_permlane16_swap_b32 v69, v73
v_permlane16_swap_b32 v70, v74
v_permlane16_swap_b32 v71, v75
v_add_f32 v68, v68, v72
v_add_f32 v69, v69, v73
v_add_f32 v70, v70, v74
v_add_f32 v71, v71, v75
v_mov_b32 v72, v68
v_mov_b32 v73, v69
v_mov_b32 v74, v70
v_mov_b32 v75, v71
v_permlane32_swap_b32 v68, v72
v_permlane32_swap_b32 v69, v73
v_permlane32_swap_b32 v70, v74
v_permlane32_swap_b32 v71, v75
v_add_f32 v68, v68, v72
v_add_f32 v69, v69, v73
v_add_f32 v70, v70, v74
v_add_f32 v71, v71, v75
v_fmac_f32 v84, v68, v65
v_fmac_f32 v85, v69, v65
v_fmac_f32 v86, v70, v65
v_fmac_f32 v87, v71, v65
v_cvt_pk_bf16_f32 v84, v84, v85
v_cvt_pk_bf16_f32 v85, v86, v87
s_mov_b64 exec, 0xff
buffer_store_dwordx2 v[84:85], v66, s[20:23], 0 offen sc1
L_ldone:
s_endpgm
.p2alignl 12, 0xbf810000
.fill 0, 4, 0xbf810000
L_compute:
v_and_b32 v2, 15, v1
v_lshrrev_b32 v4, 4, v1
v_lshrrev_b32 v3, 1, v2
v_xor_b32 v3, v3, v4
v_lshlrev_b32 v2, 7, v2
s_lshl_b32 s70, s66, 13
v_add_u32 v2, s70, v2
v_xor_b32 v5, 0, v3
v_lshl_add_u32 v8, v5, 4, v2
v_add_u32 v10, 65536, v8
v_xor_b32 v5, 4, v3
v_lshl_add_u32 v9, v5, 4, v2
v_add_u32 v11, 65536, v9
v_lshrrev_b32 v2, 5, v1
v_mul_u32_u24 v2, 6144, v2
v_bfe_u32 v3, v1, 4, 1
v_lshl_add_u32 v2, v3, 10, v2
v_bfe_u32 v4, v1, 2, 2
v_lshl_add_u32 v2, v4, 7, v2
v_lshlrev_b32 v3, 1, v3
v_bfe_u32 v4, v1, 3, 1
v_or_b32 v3, v3, v4
s_lshl_b32 s70, s67, 1
v_xor_b32 v3, s70, v3
v_and_b32 v4, 3, v1
v_lshl_add_u32 v2, v4, 3, v2
v_xor_b32 v4, 0, v3
v_lshl_add_u32 v12, v4, 5, v2
v_add_u32 v14, 65536, v12
v_xor_b32 v4, 1, v3
v_lshl_add_u32 v13, v4, 5, v2
v_add_u32 v15, 65536, v13
s_waitcnt lgkmcnt(0)
s_mov_b32 s12, s58
s_and_b32 s13, s59, 0xffff
s_mov_b32 s14, 268435456
s_mov_b32 s15, 0x20000
s_load_dword s68, s[58:59], 0
s_mov_b32 s20, s56
s_and_b32 s21, s57, 0xffff
s_mov_b32 s22, 4194304
s_mov_b32 s23, 0x20000
s_lshl_b32 s87, s64, 4
s_add_u32 s87, s87, s65
s_mul_i32 s87, s87, 4352
s_add_u32 s87, s87, 524288
s_lshl_b32 s88, s65, 18
s_lshl_b32 s70, s66, 17
s_add_u32 s88, s88, s70
s_lshl_b32 s70, s64, 11
s_add_u32 s88, s88, s70
s_lshl_b32 s70, s67, 10
s_add_u32 s88, s88, s70
s_add_u32 s88, s88, 2097152
s_mov_b32 s70, 0x3f803f80
v_accvgpr_write_b32 a80, s70
v_accvgpr_write_b32 a81, s70
v_accvgpr_write_b32 a82, s70
v_accvgpr_write_b32 a83, s70
s_mov_b32 s80, 0x358637bd
s_mov_b32 s81, 0x358637bd
s_mov_b32 s82, 0x3f800008
s_mov_b32 s83, 0x3f800008
s_mov_b32 s90, 0x3fb8aa3b
s_mov_b32 s91, 0x3fb8aa3b
s_waitcnt lgkmcnt(0)
s_add_u32 s68, s68, 1
v_and_b32 v7, 3, v1
v_lshrrev_b32_e64 v7, v7, s68
v_and_b32 v7, 1, v7
v_mul_u32_u24 v7, 0x10001, v7
s_mov_b32 s76, 0x10001
s_mov_b32 s77, 0x07060302
s_movk_i32 s85, 0xff
v_mov_b32 v28, -1
v_mov_b32 v29, -1
v_mov_b32 v30, -1
v_mov_b32 v31, -1
s_and_b32 s94, s65, 3
s_or_b32 s94, s94, s66
s_barrier
ds_read_b128 a[0:3], v10 offset:57344
ds_read_b64_tr_b16 a[32:33], v12 offset:0
ds_read_b64_tr_b16 a[34:35], v12 offset:512
ds_read_b128 a[4:7], v10 offset:59392
ds_read_b128 a[8:11], v10 offset:61440
ds_read_b128 a[12:15], v10 offset:63488
ds_read_b64_tr_b16 a[36:37], v13 offset:0
ds_read_b64_tr_b16 a[38:39], v13 offset:512
ds_read_b64_tr_b16 a[40:41], v12 offset:2048
ds_read_b64_tr_b16 a[42:43], v12 offset:2560
ds_read_b64_tr_b16 a[44:45], v13 offset:2048
ds_read_b64_tr_b16 a[46:47], v13 offset:2560
ds_read_b64_tr_b16 a[48:49], v12 offset:4096
ds_read_b64_tr_b16 a[50:51], v12 offset:4608
ds_read_b64_tr_b16 a[52:53], v13 offset:4096
ds_read_b64_tr_b16 a[54:55], v13 offset:4608
s_waitcnt lgkmcnt(0)
s_cmp_lg_u32 s94, 0
s_cbranch_scc1 L_nocs0_0
v_mfma_f32_16x16x32_bf16 v[128:131], a[80:83], a[32:35], 0
v_mfma_f32_16x16x32_bf16 v[132:135], a[80:83], a[36:39], 0
v_mfma_f32_16x16x32_bf16 v[136:139], a[80:83], a[40:43], 0
v_mfma_f32_16x16x32_bf16 v[140:143], a[80:83], a[44:47], 0
v_mfma_f32_16x16x32_bf16 v[144:147], a[80:83], a[48:51], 0
v_mfma_f32_16x16x32_bf16 v[148:151], a[80:83], a[52:55], 0
L_nocs0_0:
v_mfma_f32_16x16x32_bf16 v[32:35], a[32:35], a[0:3], 0
ds_read_b128 a[16:19], v11 offset:57344
v_mfma_f32_16x16x32_bf16 v[56:59], a[32:35], a[4:7], 0
ds_read_b64_tr_b16 a[56:57], v12 offset:12288
v_mfma_f32_16x16x32_bf16 v[80:83], a[32:35], a[8:11], 0
ds_read_b64_tr_b16 a[58:59], v12 offset:12800
v_mfma_f32_16x16x32_bf16 v[104:107], a[32:35], a[12:15], 0
ds_read_b128 a[20:23], v11 offset:59392
v_mfma_f32_16x16x32_bf16 v[36:39], a[36:39], a[0:3], 0
ds_read_b128 a[24:27], v11 offset:61440
v_mfma_f32_16x16x32_bf16 v[60:63], a[36:39], a[4:7], 0
ds_read_b128 a[28:31], v11 offset:63488
v_mfma_f32_16x16x32_bf16 v[84:87], a[36:39], a[8:11], 0
ds_read_b64_tr_b16 a[60:61], v13 offset:12288
v_mfma_f32_16x16x32_bf16 v[108:111], a[36:39], a[12:15], 0
ds_read_b64_tr_b16 a[62:63], v13 offset:12800
v_mfma_f32_16x16x32_bf16 v[40:43], a[0:3], a[40:43], 0
ds_read_b64_tr_b16 a[64:65], v12 offset:14336
v_mfma_f32_16x16x32_bf16 v[64:67], a[4:7], a[40:43], 0
ds_read_b64_tr_b16 a[66:67], v12 offset:14848
v_mfma_f32_16x16x32_bf16 v[88:91], a[8:11], a[40:43], 0
ds_read_b64_tr_b16 a[68:69], v13 offset:14336
v_mfma_f32_16x16x32_bf16 v[112:115], a[12:15], a[40:43], 0
ds_read_b64_tr_b16 a[70:71], v13 offset:14848
v_mfma_f32_16x16x32_bf16 v[44:47], a[0:3], a[44:47], 0
ds_read_b64_tr_b16 a[72:73], v12 offset:16384
v_mfma_f32_16x16x32_bf16 v[68:71], a[4:7], a[44:47], 0
ds_read_b64_tr_b16 a[74:75], v12 offset:16896
v_mfma_f32_16x16x32_bf16 v[92:95], a[8:11], a[44:47], 0
ds_read_b64_tr_b16 a[76:77], v13 offset:16384
v_mfma_f32_16x16x32_bf16 v[116:119], a[12:15], a[44:47], 0
ds_read_b64_tr_b16 a[78:79], v13 offset:16896
v_mfma_f32_16x16x32_bf16 v[48:51], a[0:3], a[48:51], 0
v_mfma_f32_16x16x32_bf16 v[72:75], a[4:7], a[48:51], 0
v_mfma_f32_16x16x32_bf16 v[96:99], a[8:11], a[48:51], 0
v_mfma_f32_16x16x32_bf16 v[120:123], a[12:15], a[48:51], 0
v_mfma_f32_16x16x32_bf16 v[52:55], a[0:3], a[52:55], 0
v_mfma_f32_16x16x32_bf16 v[76:79], a[4:7], a[52:55], 0
v_mfma_f32_16x16x32_bf16 v[100:103], a[8:11], a[52:55], 0
v_mfma_f32_16x16x32_bf16 v[124:127], a[12:15], a[52:55], 0
s_waitcnt lgkmcnt(0)
s_cmp_lg_u32 s94, 0
s_cbranch_scc1 L_nocs0_1
v_mfma_f32_16x16x32_bf16 v[128:131], a[80:83], a[56:59], v[128:131]
v_mfma_f32_16x16x32_bf16 v[132:135], a[80:83], a[60:63], v[132:135]
v_mfma_f32_16x16x32_bf16 v[136:139], a[80:83], a[64:67], v[136:139]
v_mfma_f32_16x16x32_bf16 v[140:143], a[80:83], a[68:71], v[140:143]
v_mfma_f32_16x16x32_bf16 v[144:147], a[80:83], a[72:75], v[144:147]
v_mfma_f32_16x16x32_bf16 v[148:151], a[80:83], a[76:79], v[148:151]
L_nocs0_1:
v_mfma_f32_16x16x32_bf16 v[32:35], a[56:59], a[16:19], v[32:35]
s_barrier
ds_read_b128 a[0:3], v10 offset:40960
v_mfma_f32_16x16x32_bf16 v[56:59], a[56:59], a[20:23], v[56:59]
ds_read_b64_tr_b16 a[32:33], v14 offset:16384
v_mfma_f32_16x16x32_bf16 v[80:83], a[56:59], a[24:27], v[80:83]
ds_read_b64_tr_b16 a[34:35], v14 offset:16896
v_mfma_f32_16x16x32_bf16 v[104:107], a[56:59], a[28:31], v[104:107]
ds_read_b128 a[4:7], v10 offset:43008
v_mfma_f32_16x16x32_bf16 v[36:39], a[60:63], a[16:19], v[36:39]
ds_read_b128 a[8:11], v10 offset:45056
v_mfma_f32_16x16x32_bf16 v[60:63], a[60:63], a[20:23], v[60:63]
ds_read_b128 a[12:15], v10 offset:47104
v_mfma_f32_16x16x32_bf16 v[84:87], a[60:63], a[24:27], v[84:87]
ds_read_b64_tr_b16 a[36:37], v15 offset:16384
v_mfma_f32_16x16x32_bf16 v[108:111], a[60:63], a[28:31], v[108:111]
ds_read_b64_tr_b16 a[38:39], v15 offset:16896
v_mfma_f32_16x16x32_bf16 v[40:43], a[16:19], a[64:67], v[40:43]
ds_read_b64_tr_b16 a[40:41], v14 offset:18432
v_mfma_f32_16x16x32_bf16 v[64:67], a[20:23], a[64:67], v[64:67]
ds_read_b64_tr_b16 a[42:43], v14 offset:18944
v_mfma_f32_16x16x32_bf16 v[88:91], a[24:27], a[64:67], v[88:91]
ds_read_b64_tr_b16 a[44:45], v15 offset:18432
v_mfma_f32_16x16x32_bf16 v[112:115], a[28:31], a[64:67], v[112:115]
ds_read_b64_tr_b16 a[46:47], v15 offset:18944
v_mfma_f32_16x16x32_bf16 v[44:47], a[16:19], a[68:71], v[44:47]
ds_read_b64_tr_b16 a[48:49], v14 offset:20480
v_mfma_f32_16x16x32_bf16 v[68:71], a[20:23], a[68:71], v[68:71]
ds_read_b64_tr_b16 a[50:51], v14 offset:20992
v_mfma_f32_16x16x32_bf16 v[92:95], a[24:27], a[68:71], v[92:95]
ds_read_b64_tr_b16 a[52:53], v15 offset:20480
v_mfma_f32_16x16x32_bf16 v[116:119], a[28:31], a[68:71], v[116:119]
ds_read_b64_tr_b16 a[54:55], v15 offset:20992
v_mfma_f32_16x16x32_bf16 v[48:51], a[16:19], a[72:75], v[48:51]
v_mfma_f32_16x16x32_bf16 v[72:75], a[20:23], a[72:75], v[72:75]
v_mfma_f32_16x16x32_bf16 v[96:99], a[24:27], a[72:75], v[96:99]
v_mfma_f32_16x16x32_bf16 v[120:123], a[28:31], a[72:75], v[120:123]
v_mfma_f32_16x16x32_bf16 v[52:55], a[16:19], a[76:79], v[52:55]
v_mfma_f32_16x16x32_bf16 v[76:79], a[20:23], a[76:79], v[76:79]
v_mfma_f32_16x16x32_bf16 v[100:103], a[24:27], a[76:79], v[100:103]
v_mfma_f32_16x16x32_bf16 v[124:127], a[28:31], a[76:79], v[124:127]
s_waitcnt lgkmcnt(0)
s_cmp_lg_u32 s94, 0
s_cbranch_scc1 L_nocs1_0
v_mfma_f32_16x16x32_bf16 v[128:131], a[80:83], a[32:35], v[128:131]
v_mfma_f32_16x16x32_bf16 v[132:135], a[80:83], a[36:39], v[132:135]
v_mfma_f32_16x16x32_bf16 v[136:139], a[80:83], a[40:43], v[136:139]
v_mfma_f32_16x16x32_bf16 v[140:143], a[80:83], a[44:47], v[140:143]
v_mfma_f32_16x16x32_bf16 v[144:147], a[80:83], a[48:51], v[144:147]
v_mfma_f32_16x16x32_bf16 v[148:151], a[80:83], a[52:55], v[148:151]
L_nocs1_0:
v_mfma_f32_16x16x32_bf16 v[32:35], a[32:35], a[0:3], v[32:35]
ds_read_b128 a[16:19], v11 offset:40960
v_mfma_f32_16x16x32_bf16 v[56:59], a[32:35], a[4:7], v[56:59]
ds_read_b64_tr_b16 a[56:57], v14 offset:28672
v_mfma_f32_16x16x32_bf16 v[80:83], a[32:35], a[8:11], v[80:83]
ds_read_b64_tr_b16 a[58:59], v14 offset:29184
v_mfma_f32_16x16x32_bf16 v[104:107], a[32:35], a[12:15], v[104:107]
ds_read_b128 a[20:23], v11 offset:43008
v_mfma_f32_16x16x32_bf16 v[36:39], a[36:39], a[0:3], v[36:39]
ds_read_b128 a[24:27], v11 offset:45056
v_mfma_f32_16x16x32_bf16 v[60:63], a[36:39], a[4:7], v[60:63]
ds_read_b128 a[28:31], v11 offset:47104
v_mfma_f32_16x16x32_bf16 v[84:87], a[36:39], a[8:11], v[84:87]
ds_read_b64_tr_b16 a[60:61], v15 offset:28672
v_mfma_f32_16x16x32_bf16 v[108:111], a[36:39], a[12:15], v[108:111]
ds_read_b64_tr_b16 a[62:63], v15 offset:29184
v_mfma_f32_16x16x32_bf16 v[40:43], a[0:3], a[40:43], v[40:43]
ds_read_b64_tr_b16 a[64:65], v14 offset:30720
v_mfma_f32_16x16x32_bf16 v[64:67], a[4:7], a[40:43], v[64:67]
ds_read_b64_tr_b16 a[66:67], v14 offset:31232
v_mfma_f32_16x16x32_bf16 v[88:91], a[8:11], a[40:43], v[88:91]
ds_read_b64_tr_b16 a[68:69], v15 offset:30720
v_mfma_f32_16x16x32_bf16 v[112:115], a[12:15], a[40:43], v[112:115]
ds_read_b64_tr_b16 a[70:71], v15 offset:31232
v_mfma_f32_16x16x32_bf16 v[44:47], a[0:3], a[44:47], v[44:47]
ds_read_b64_tr_b16 a[72:73], v14 offset:32768
v_mfma_f32_16x16x32_bf16 v[68:71], a[4:7], a[44:47], v[68:71]
ds_read_b64_tr_b16 a[74:75], v14 offset:33280
v_mfma_f32_16x16x32_bf16 v[92:95], a[8:11], a[44:47], v[92:95]
ds_read_b64_tr_b16 a[76:77], v15 offset:32768
v_mfma_f32_16x16x32_bf16 v[116:119], a[12:15], a[44:47], v[116:119]
ds_read_b64_tr_b16 a[78:79], v15 offset:33280
v_mfma_f32_16x16x32_bf16 v[48:51], a[0:3], a[48:51], v[48:51]
v_mfma_f32_16x16x32_bf16 v[72:75], a[4:7], a[48:51], v[72:75]
v_mfma_f32_16x16x32_bf16 v[96:99], a[8:11], a[48:51], v[96:99]
v_mfma_f32_16x16x32_bf16 v[120:123], a[12:15], a[48:51], v[120:123]
v_mfma_f32_16x16x32_bf16 v[52:55], a[0:3], a[52:55], v[52:55]
v_mfma_f32_16x16x32_bf16 v[76:79], a[4:7], a[52:55], v[76:79]
v_mfma_f32_16x16x32_bf16 v[100:103], a[8:11], a[52:55], v[100:103]
v_mfma_f32_16x16x32_bf16 v[124:127], a[12:15], a[52:55], v[124:127]
s_waitcnt lgkmcnt(0)
s_cmp_lg_u32 s94, 0
s_cbranch_scc1 L_nocs1_1
v_mfma_f32_16x16x32_bf16 v[128:131], a[80:83], a[56:59], v[128:131]
v_mfma_f32_16x16x32_bf16 v[132:135], a[80:83], a[60:63], v[132:135]
v_mfma_f32_16x16x32_bf16 v[136:139], a[80:83], a[64:67], v[136:139]
v_mfma_f32_16x16x32_bf16 v[140:143], a[80:83], a[68:71], v[140:143]
v_mfma_f32_16x16x32_bf16 v[144:147], a[80:83], a[72:75], v[144:147]
v_mfma_f32_16x16x32_bf16 v[148:151], a[80:83], a[76:79], v[148:151]
L_nocs1_1:
v_mfma_f32_16x16x32_bf16 v[32:35], a[56:59], a[16:19], v[32:35]
s_barrier
ds_read_b128 a[0:3], v10 offset:0
v_mfma_f32_16x16x32_bf16 v[56:59], a[56:59], a[20:23], v[56:59]
ds_read_b64_tr_b16 a[32:33], v12 offset:40960
v_mfma_f32_16x16x32_bf16 v[80:83], a[56:59], a[24:27], v[80:83]
ds_read_b64_tr_b16 a[34:35], v12 offset:41472
v_mfma_f32_16x16x32_bf16 v[104:107], a[56:59], a[28:31], v[104:107]
ds_read_b128 a[4:7], v10 offset:2048
v_mfma_f32_16x16x32_bf16 v[36:39], a[60:63], a[16:19], v[36:39]
ds_read_b128 a[8:11], v10 offset:4096
v_mfma_f32_16x16x32_bf16 v[60:63], a[60:63], a[20:23], v[60:63]
ds_read_b128 a[12:15], v10 offset:6144
v_mfma_f32_16x16x32_bf16 v[84:87], a[60:63], a[24:27], v[84:87]
ds_read_b64_tr_b16 a[36:37], v13 offset:40960
v_mfma_f32_16x16x32_bf16 v[108:111], a[60:63], a[28:31], v[108:111]
ds_read_b64_tr_b16 a[38:39], v13 offset:41472
v_mfma_f32_16x16x32_bf16 v[40:43], a[16:19], a[64:67], v[40:43]
ds_read_b64_tr_b16 a[40:41], v12 offset:43008
v_mfma_f32_16x16x32_bf16 v[64:67], a[20:23], a[64:67], v[64:67]
ds_read_b64_tr_b16 a[42:43], v12 offset:43520
v_mfma_f32_16x16x32_bf16 v[88:91], a[24:27], a[64:67], v[88:91]
ds_read_b64_tr_b16 a[44:45], v13 offset:43008
v_mfma_f32_16x16x32_bf16 v[112:115], a[28:31], a[64:67], v[112:115]
ds_read_b64_tr_b16 a[46:47], v13 offset:43520
v_mfma_f32_16x16x32_bf16 v[44:47], a[16:19], a[68:71], v[44:47]
ds_read_b64_tr_b16 a[48:49], v12 offset:45056
v_mfma_f32_16x16x32_bf16 v[68:71], a[20:23], a[68:71], v[68:71]
ds_read_b64_tr_b16 a[50:51], v12 offset:45568
v_mfma_f32_16x16x32_bf16 v[92:95], a[24:27], a[68:71], v[92:95]
ds_read_b64_tr_b16 a[52:53], v13 offset:45056
v_mfma_f32_16x16x32_bf16 v[116:119], a[28:31], a[68:71], v[116:119]
ds_read_b64_tr_b16 a[54:55], v13 offset:45568
v_mfma_f32_16x16x32_bf16 v[48:51], a[16:19], a[72:75], v[48:51]
v_mfma_f32_16x16x32_bf16 v[72:75], a[20:23], a[72:75], v[72:75]
v_mfma_f32_16x16x32_bf16 v[96:99], a[24:27], a[72:75], v[96:99]
v_mfma_f32_16x16x32_bf16 v[120:123], a[28:31], a[72:75], v[120:123]
v_mfma_f32_16x16x32_bf16 v[52:55], a[16:19], a[76:79], v[52:55]
v_mfma_f32_16x16x32_bf16 v[76:79], a[20:23], a[76:79], v[76:79]
v_mfma_f32_16x16x32_bf16 v[100:103], a[24:27], a[76:79], v[100:103]
v_mfma_f32_16x16x32_bf16 v[124:127], a[28:31], a[76:79], v[124:127]
s_waitcnt lgkmcnt(0)
s_cmp_lg_u32 s94, 0
s_cbranch_scc1 L_nocs2_0
v_mfma_f32_16x16x32_bf16 v[128:131], a[80:83], a[32:35], v[128:131]
v_mfma_f32_16x16x32_bf16 v[132:135], a[80:83], a[36:39], v[132:135]
v_mfma_f32_16x16x32_bf16 v[136:139], a[80:83], a[40:43], v[136:139]
v_mfma_f32_16x16x32_bf16 v[140:143], a[80:83], a[44:47], v[140:143]
v_mfma_f32_16x16x32_bf16 v[144:147], a[80:83], a[48:51], v[144:147]
v_mfma_f32_16x16x32_bf16 v[148:151], a[80:83], a[52:55], v[148:151]
L_nocs2_0:
v_mfma_f32_16x16x32_bf16 v[32:35], a[32:35], a[0:3], v[32:35]
ds_read_b128 a[16:19], v11 offset:0
v_mfma_f32_16x16x32_bf16 v[56:59], a[32:35], a[4:7], v[56:59]
ds_read_b64_tr_b16 a[56:57], v12 offset:53248
v_mfma_f32_16x16x32_bf16 v[80:83], a[32:35], a[8:11], v[80:83]
ds_read_b64_tr_b16 a[58:59], v12 offset:53760
v_mfma_f32_16x16x32_bf16 v[104:107], a[32:35], a[12:15], v[104:107]
ds_read_b128 a[20:23], v11 offset:2048
v_mfma_f32_16x16x32_bf16 v[36:39], a[36:39], a[0:3], v[36:39]
ds_read_b128 a[24:27], v11 offset:4096
v_mfma_f32_16x16x32_bf16 v[60:63], a[36:39], a[4:7], v[60:63]
ds_read_b128 a[28:31], v11 offset:6144
v_mfma_f32_16x16x32_bf16 v[84:87], a[36:39], a[8:11], v[84:87]
ds_read_b64_tr_b16 a[60:61], v13 offset:53248
v_mfma_f32_16x16x32_bf16 v[108:111], a[36:39], a[12:15], v[108:111]
ds_read_b64_tr_b16 a[62:63], v13 offset:53760
v_mfma_f32_16x16x32_bf16 v[40:43], a[0:3], a[40:43], v[40:43]
ds_read_b64_tr_b16 a[64:65], v12 offset:55296
v_mfma_f32_16x16x32_bf16 v[64:67], a[4:7], a[40:43], v[64:67]
ds_read_b64_tr_b16 a[66:67], v12 offset:55808
v_mfma_f32_16x16x32_bf16 v[88:91], a[8:11], a[40:43], v[88:91]
ds_read_b64_tr_b16 a[68:69], v13 offset:55296
v_mfma_f32_16x16x32_bf16 v[112:115], a[12:15], a[40:43], v[112:115]
ds_read_b64_tr_b16 a[70:71], v13 offset:55808
v_mfma_f32_16x16x32_bf16 v[44:47], a[0:3], a[44:47], v[44:47]
ds_read_b64_tr_b16 a[72:73], v12 offset:57344
v_mfma_f32_16x16x32_bf16 v[68:71], a[4:7], a[44:47], v[68:71]
ds_read_b64_tr_b16 a[74:75], v12 offset:57856
v_mfma_f32_16x16x32_bf16 v[92:95], a[8:11], a[44:47], v[92:95]
ds_read_b64_tr_b16 a[76:77], v13 offset:57344
v_mfma_f32_16x16x32_bf16 v[116:119], a[12:15], a[44:47], v[116:119]
ds_read_b64_tr_b16 a[78:79], v13 offset:57856
v_mfma_f32_16x16x32_bf16 v[48:51], a[0:3], a[48:51], v[48:51]
s_lshl_b32 s70, s60, 10
s_add_u32 s70, s70, s87
buffer_store_dwordx4 v[28:31], v16, s[12:15], s70 offen sc1
v_mfma_f32_16x16x32_bf16 v[72:75], a[4:7], a[48:51], v[72:75]
v_mfma_f32_16x16x32_bf16 v[96:99], a[8:11], a[48:51], v[96:99]
v_mfma_f32_16x16x32_bf16 v[120:123], a[12:15], a[48:51], v[120:123]
v_mfma_f32_16x16x32_bf16 v[52:55], a[0:3], a[52:55], v[52:55]
v_mfma_f32_16x16x32_bf16 v[76:79], a[4:7], a[52:55], v[76:79]
v_mfma_f32_16x16x32_bf16 v[100:103], a[8:11], a[52:55], v[100:103]
v_mfma_f32_16x16x32_bf16 v[124:127], a[12:15], a[52:55], v[124:127]
s_waitcnt lgkmcnt(0)
s_cmp_lg_u32 s94, 0
s_cbranch_scc1 L_nocs2_1
v_mfma_f32_16x16x32_bf16 v[128:131], a[80:83], a[56:59], v[128:131]
v_mfma_f32_16x16x32_bf16 v[132:135], a[80:83], a[60:63], v[132:135]
v_mfma_f32_16x16x32_bf16 v[136:139], a[80:83], a[64:67], v[136:139]
v_mfma_f32_16x16x32_bf16 v[140:143], a[80:83], a[68:71], v[140:143]
v_mfma_f32_16x16x32_bf16 v[144:147], a[80:83], a[72:75], v[144:147]
v_mfma_f32_16x16x32_bf16 v[148:151], a[80:83], a[76:79], v[148:151]
L_nocs2_1:
v_mfma_f32_16x16x32_bf16 v[32:35], a[56:59], a[16:19], v[32:35]
s_barrier
ds_read_b128 a[0:3], v8 offset:24576
v_mfma_f32_16x16x32_bf16 v[56:59], a[56:59], a[20:23], v[56:59]
ds_read_b64_tr_b16 a[32:33], v12 offset:0
v_mfma_f32_16x16x32_bf16 v[80:83], a[56:59], a[24:27], v[80:83]
ds_read_b64_tr_b16 a[34:35], v12 offset:512
v_mfma_f32_16x16x32_bf16 v[104:107], a[56:59], a[28:31], v[104:107]
ds_read_b128 a[4:7], v8 offset:26624
v_mfma_f32_16x16x32_bf16 v[36:39], a[60:63], a[16:19], v[36:39]
ds_read_b128 a[8:11], v8 offset:28672
v_mfma_f32_16x16x32_bf16 v[60:63], a[60:63], a[20:23], v[60:63]
ds_read_b128 a[12:15], v8 offset:30720
v_mfma_f32_16x16x32_bf16 v[84:87], a[60:63], a[24:27], v[84:87]
ds_read_b64_tr_b16 a[36:37], v13 offset:0
v_mfma_f32_16x16x32_bf16 v[108:111], a[60:63], a[28:31], v[108:111]
ds_read_b64_tr_b16 a[38:39], v13 offset:512
v_mfma_f32_16x16x32_bf16 v[40:43], a[16:19], a[64:67], v[40:43]
ds_read_b64_tr_b16 a[40:41], v12 offset:2048
v_mfma_f32_16x16x32_bf16 v[64:67], a[20:23], a[64:67], v[64:67]
ds_read_b64_tr_b16 a[42:43], v12 offset:2560
v_mfma_f32_16x16x32_bf16 v[88:91], a[24:27], a[64:67], v[88:91]
ds_read_b64_tr_b16 a[44:45], v13 offset:2048
v_mfma_f32_16x16x32_bf16 v[112:115], a[28:31], a[64:67], v[112:115]
ds_read_b64_tr_b16 a[46:47], v13 offset:2560
v_mfma_f32_16x16x32_bf16 v[44:47], a[16:19], a[68:71], v[44:47]
ds_read_b64_tr_b16 a[48:49], v12 offset:4096
v_mfma_f32_16x16x32_bf16 v[68:71], a[20:23], a[68:71], v[68:71]
ds_read_b64_tr_b16 a[50:51], v12 offset:4608
v_mfma_f32_16x16x32_bf16 v[92:95], a[24:27], a[68:71], v[92:95]
ds_read_b64_tr_b16 a[52:53], v13 offset:4096
v_mfma_f32_16x16x32_bf16 v[116:119], a[28:31], a[68:71], v[116:119]
ds_read_b64_tr_b16 a[54:55], v13 offset:4608
v_mfma_f32_16x16x32_bf16 v[48:51], a[16:19], a[72:75], v[48:51]
v_mfma_f32_16x16x32_bf16 v[72:75], a[20:23], a[72:75], v[72:75]
v_mfma_f32_16x16x32_bf16 v[96:99], a[24:27], a[72:75], v[96:99]
v_mfma_f32_16x16x32_bf16 v[120:123], a[28:31], a[72:75], v[120:123]
v_mfma_f32_16x16x32_bf16 v[52:55], a[16:19], a[76:79], v[52:55]
v_mfma_f32_16x16x32_bf16 v[76:79], a[20:23], a[76:79], v[76:79]
v_mfma_f32_16x16x32_bf16 v[100:103], a[24:27], a[76:79], v[100:103]
v_mfma_f32_16x16x32_bf16 v[124:127], a[28:31], a[76:79], v[124:127]
s_waitcnt lgkmcnt(0)
s_cmp_lg_u32 s94, 0
s_cbranch_scc1 L_nocs3_0
v_mfma_f32_16x16x32_bf16 v[128:131], a[80:83], a[32:35], v[128:131]
v_mfma_f32_16x16x32_bf16 v[132:135], a[80:83], a[36:39], v[132:135]
v_mfma_f32_16x16x32_bf16 v[136:139], a[80:83], a[40:43], v[136:139]
v_mfma_f32_16x16x32_bf16 v[140:143], a[80:83], a[44:47], v[140:143]
v_mfma_f32_16x16x32_bf16 v[144:147], a[80:83], a[48:51], v[144:147]
v_mfma_f32_16x16x32_bf16 v[148:151], a[80:83], a[52:55], v[148:151]
L_nocs3_0:
v_mfma_f32_16x16x32_bf16 v[32:35], a[32:35], a[0:3], v[32:35]
ds_read_b128 a[16:19], v9 offset:24576
v_mfma_f32_16x16x32_bf16 v[56:59], a[32:35], a[4:7], v[56:59]
ds_read_b64_tr_b16 a[56:57], v12 offset:12288
v_mfma_f32_16x16x32_bf16 v[80:83], a[32:35], a[8:11], v[80:83]
ds_read_b64_tr_b16 a[58:59], v12 offset:12800
v_mfma_f32_16x16x32_bf16 v[104:107], a[32:35], a[12:15], v[104:107]
ds_read_b128 a[20:23], v9 offset:26624
v_mfma_f32_16x16x32_bf16 v[36:39], a[36:39], a[0:3], v[36:39]
ds_read_b128 a[24:27], v9 offset:28672
v_mfma_f32_16x16x32_bf16 v[60:63], a[36:39], a[4:7], v[60:63]
ds_read_b128 a[28:31], v9 offset:30720
v_mfma_f32_16x16x32_bf16 v[84:87], a[36:39], a[8:11], v[84:87]
ds_read_b64_tr_b16 a[60:61], v13 offset:12288
v_mfma_f32_16x16x32_bf16 v[108:111], a[36:39], a[12:15], v[108:111]
ds_read_b64_tr_b16 a[62:63], v13 offset:12800
v_mfma_f32_16x16x32_bf16 v[40:43], a[0:3], a[40:43], v[40:43]
ds_read_b64_tr_b16 a[64:65], v12 offset:14336
v_mfma_f32_16x16x32_bf16 v[64:67], a[4:7], a[40:43], v[64:67]
ds_read_b64_tr_b16 a[66:67], v12 offset:14848
v_mfma_f32_16x16x32_bf16 v[88:91], a[8:11], a[40:43], v[88:91]
ds_read_b64_tr_b16 a[68:69], v13 offset:14336
v_mfma_f32_16x16x32_bf16 v[112:115], a[12:15], a[40:43], v[112:115]
ds_read_b64_tr_b16 a[70:71], v13 offset:14848
v_mfma_f32_16x16x32_bf16 v[44:47], a[0:3], a[44:47], v[44:47]
ds_read_b64_tr_b16 a[72:73], v12 offset:16384
v_mfma_f32_16x16x32_bf16 v[68:71], a[4:7], a[44:47], v[68:71]
ds_read_b64_tr_b16 a[74:75], v12 offset:16896
v_mfma_f32_16x16x32_bf16 v[92:95], a[8:11], a[44:47], v[92:95]
ds_read_b64_tr_b16 a[76:77], v13 offset:16384
v_mfma_f32_16x16x32_bf16 v[116:119], a[12:15], a[44:47], v[116:119]
ds_read_b64_tr_b16 a[78:79], v13 offset:16896
v_mfma_f32_16x16x32_bf16 v[48:51], a[0:3], a[48:51], v[48:51]
v_mfma_f32_16x16x32_bf16 v[72:75], a[4:7], a[48:51], v[72:75]
v_mfma_f32_16x16x32_bf16 v[96:99], a[8:11], a[48:51], v[96:99]
v_mfma_f32_16x16x32_bf16 v[120:123], a[12:15], a[48:51], v[120:123]
v_mfma_f32_16x16x32_bf16 v[52:55], a[0:3], a[52:55], v[52:55]
v_mfma_f32_16x16x32_bf16 v[76:79], a[4:7], a[52:55], v[76:79]
v_mfma_f32_16x16x32_bf16 v[100:103], a[8:11], a[52:55], v[100:103]
v_mfma_f32_16x16x32_bf16 v[124:127], a[12:15], a[52:55], v[124:127]
s_waitcnt lgkmcnt(0)
s_cmp_lg_u32 s94, 0
s_cbranch_scc1 L_nocs3_1
v_mfma_f32_16x16x32_bf16 v[128:131], a[80:83], a[56:59], v[128:131]
v_mfma_f32_16x16x32_bf16 v[132:135], a[80:83], a[60:63], v[132:135]
v_mfma_f32_16x16x32_bf16 v[136:139], a[80:83], a[64:67], v[136:139]
v_mfma_f32_16x16x32_bf16 v[140:143], a[80:83], a[68:71], v[140:143]
v_mfma_f32_16x16x32_bf16 v[144:147], a[80:83], a[72:75], v[144:147]
v_mfma_f32_16x16x32_bf16 v[148:151], a[80:83], a[76:79], v[148:151]
L_nocs3_1:
v_mfma_f32_16x16x32_bf16 v[32:35], a[56:59], a[16:19], v[32:35]
s_barrier
ds_read_b128 a[0:3], v10 offset:57344
v_mfma_f32_16x16x32_bf16 v[56:59], a[56:59], a[20:23], v[56:59]
ds_read_b64_tr_b16 a[32:33], v14 offset:16384
v_mfma_f32_16x16x32_bf16 v[80:83], a[56:59], a[24:27], v[80:83]
ds_read_b64_tr_b16 a[34:35], v14 offset:16896
v_mfma_f32_16x16x32_bf16 v[104:107], a[56:59], a[28:31], v[104:107]
ds_read_b128 a[4:7], v10 offset:59392
v_mfma_f32_16x16x32_bf16 v[36:39], a[60:63], a[16:19], v[36:39]
ds_read_b128 a[8:11], v10 offset:61440
v_mfma_f32_16x16x32_bf16 v[60:63], a[60:63], a[20:23], v[60:63]
ds_read_b128 a[12:15], v10 offset:63488
v_mfma_f32_16x16x32_bf16 v[84:87], a[60:63], a[24:27], v[84:87]
ds_read_b64_tr_b16 a[36:37], v15 offset:16384
v_mfma_f32_16x16x32_bf16 v[108:111], a[60:63], a[28:31], v[108:111]
ds_read_b64_tr_b16 a[38:39], v15 offset:16896
v_mfma_f32_16x16x32_bf16 v[40:43], a[16:19], a[64:67], v[40:43]
ds_read_b64_tr_b16 a[40:41], v14 offset:18432
v_mfma_f32_16x16x32_bf16 v[64:67], a[20:23], a[64:67], v[64:67]
ds_read_b64_tr_b16 a[42:43], v14 offset:18944
v_mfma_f32_16x16x32_bf16 v[88:91], a[24:27], a[64:67], v[88:91]
ds_read_b64_tr_b16 a[44:45], v15 offset:18432
v_mfma_f32_16x16x32_bf16 v[112:115], a[28:31], a[64:67], v[112:115]
ds_read_b64_tr_b16 a[46:47], v15 offset:18944
v_mfma_f32_16x16x32_bf16 v[44:47], a[16:19], a[68:71], v[44:47]
ds_read_b64_tr_b16 a[48:49], v14 offset:20480
v_mfma_f32_16x16x32_bf16 v[68:71], a[20:23], a[68:71], v[68:71]
ds_read_b64_tr_b16 a[50:51], v14 offset:20992
v_mfma_f32_16x16x32_bf16 v[92:95], a[24:27], a[68:71], v[92:95]
ds_read_b64_tr_b16 a[52:53], v15 offset:20480
v_mfma_f32_16x16x32_bf16 v[116:119], a[28:31], a[68:71], v[116:119]
ds_read_b64_tr_b16 a[54:55], v15 offset:20992
v_mfma_f32_16x16x32_bf16 v[48:51], a[16:19], a[72:75], v[48:51]
v_mfma_f32_16x16x32_bf16 v[72:75], a[20:23], a[72:75], v[72:75]
v_mfma_f32_16x16x32_bf16 v[96:99], a[24:27], a[72:75], v[96:99]
v_mfma_f32_16x16x32_bf16 v[120:123], a[28:31], a[72:75], v[120:123]
v_mfma_f32_16x16x32_bf16 v[52:55], a[16:19], a[76:79], v[52:55]
v_mfma_f32_16x16x32_bf16 v[76:79], a[20:23], a[76:79], v[76:79]
v_mfma_f32_16x16x32_bf16 v[100:103], a[24:27], a[76:79], v[100:103]
v_mfma_f32_16x16x32_bf16 v[124:127], a[28:31], a[76:79], v[124:127]
s_waitcnt lgkmcnt(0)
v_mfma_f32_16x16x32_bf16 v[32:35], a[32:35], a[0:3], v[32:35]
ds_read_b128 a[16:19], v11 offset:57344
v_mfma_f32_16x16x32_bf16 v[56:59], a[32:35], a[4:7], v[56:59]
ds_read_b64_tr_b16 a[56:57], v14 offset:28672
v_mfma_f32_16x16x32_bf16 v[80:83], a[32:35], a[8:11], v[80:83]
ds_read_b64_tr_b16 a[58:59], v14 offset:29184
v_mfma_f32_16x16x32_bf16 v[104:107], a[32:35], a[12:15], v[104:107]
ds_read_b128 a[20:23], v11 offset:59392
v_mfma_f32_16x16x32_bf16 v[36:39], a[36:39], a[0:3], v[36:39]
ds_read_b128 a[24:27], v11 offset:61440
v_mfma_f32_16x16x32_bf16 v[60:63], a[36:39], a[4:7], v[60:63]
ds_read_b128 a[28:31], v11 offset:63488
v_mfma_f32_16x16x32_bf16 v[84:87], a[36:39], a[8:11], v[84:87]
ds_read_b64_tr_b16 a[60:61], v15 offset:28672
v_mfma_f32_16x16x32_bf16 v[108:111], a[36:39], a[12:15], v[108:111]
ds_read_b64_tr_b16 a[62:63], v15 offset:29184
v_mfma_f32_16x16x32_bf16 v[40:43], a[0:3], a[40:43], v[40:43]
ds_read_b64_tr_b16 a[64:65], v14 offset:30720
v_mfma_f32_16x16x32_bf16 v[64:67], a[4:7], a[40:43], v[64:67]
ds_read_b64_tr_b16 a[66:67], v14 offset:31232
v_mfma_f32_16x16x32_bf16 v[88:91], a[8:11], a[40:43], v[88:91]
ds_read_b64_tr_b16 a[68:69], v15 offset:30720
v_mfma_f32_16x16x32_bf16 v[112:115], a[12:15], a[40:43], v[112:115]
ds_read_b64_tr_b16 a[70:71], v15 offset:31232
v_mfma_f32_16x16x32_bf16 v[44:47], a[0:3], a[44:47], v[44:47]
ds_read_b64_tr_b16 a[72:73], v14 offset:32768
v_mfma_f32_16x16x32_bf16 v[68:71], a[4:7], a[44:47], v[68:71]
ds_read_b64_tr_b16 a[74:75], v14 offset:33280
v_mfma_f32_16x16x32_bf16 v[92:95], a[8:11], a[44:47], v[92:95]
ds_read_b64_tr_b16 a[76:77], v15 offset:32768
v_mfma_f32_16x16x32_bf16 v[116:119], a[12:15], a[44:47], v[116:119]
ds_read_b64_tr_b16 a[78:79], v15 offset:33280
v_mfma_f32_16x16x32_bf16 v[48:51], a[0:3], a[48:51], v[48:51]
s_add_u32 s70, s88, 0
buffer_store_dwordx4 v[28:31], v16, s[12:15], s70 offen sc1
v_mfma_f32_16x16x32_bf16 v[72:75], a[4:7], a[48:51], v[72:75]
v_mfma_f32_16x16x32_bf16 v[96:99], a[8:11], a[48:51], v[96:99]
s_add_u32 s70, s88, 32768
buffer_store_dwordx4 v[28:31], v16, s[12:15], s70 offen sc1
v_mfma_f32_16x16x32_bf16 v[120:123], a[12:15], a[48:51], v[120:123]
v_mfma_f32_16x16x32_bf16 v[52:55], a[0:3], a[52:55], v[52:55]
v_mfma_f32_16x16x32_bf16 v[76:79], a[4:7], a[52:55], v[76:79]
v_mfma_f32_16x16x32_bf16 v[100:103], a[8:11], a[52:55], v[100:103]
v_mfma_f32_16x16x32_bf16 v[124:127], a[12:15], a[52:55], v[124:127]
s_waitcnt lgkmcnt(0)
v_mfma_f32_16x16x32_bf16 v[32:35], a[56:59], a[16:19], v[32:35]
s_barrier
ds_read_b128 a[0:3], v10 offset:40960
v_mfma_f32_16x16x32_bf16 v[56:59], a[56:59], a[20:23], v[56:59]
ds_read_b64_tr_b16 a[32:33], v12 offset:40960
v_mfma_f32_16x16x32_bf16 v[80:83], a[56:59], a[24:27], v[80:83]
ds_read_b64_tr_b16 a[34:35], v12 offset:41472
s_branch L_over3
L_pad3:
s_branch L_ret4
L_over3:
v_mfma_f32_16x16x32_bf16 v[104:107], a[56:59], a[28:31], v[104:107]
ds_read_b128 a[4:7], v10 offset:43008
v_mfma_f32_16x16x32_bf16 v[36:39], a[60:63], a[16:19], v[36:39]
ds_read_b128 a[8:11], v10 offset:45056
v_mfma_f32_16x16x32_bf16 v[60:63], a[60:63], a[20:23], v[60:63]
ds_read_b128 a[12:15], v10 offset:47104
v_mfma_f32_16x16x32_bf16 v[84:87], a[60:63], a[24:27], v[84:87]
ds_read_b64_tr_b16 a[36:37], v13 offset:40960
v_mfma_f32_16x16x32_bf16 v[108:111], a[60:63], a[28:31], v[108:111]
ds_read_b64_tr_b16 a[38:39], v13 offset:41472
v_mfma_f32_16x16x32_bf16 v[40:43], a[16:19], a[64:67], v[40:43]
ds_read_b64_tr_b16 a[40:41], v12 offset:43008
v_mfma_f32_16x16x32_bf16 v[64:67], a[20:23], a[64:67], v[64:67]
ds_read_b64_tr_b16 a[42:43], v12 offset:43520
v_mfma_f32_16x16x32_bf16 v[88:91], a[24:27], a[64:67], v[88:91]
ds_read_b64_tr_b16 a[44:45], v13 offset:43008
v_mfma_f32_16x16x32_bf16 v[112:115], a[28:31], a[64:67], v[112:115]
ds_read_b64_tr_b16 a[46:47], v13 offset:43520
v_mfma_f32_16x16x32_bf16 v[44:47], a[16:19], a[68:71], v[44:47]
ds_read_b64_tr_b16 a[48:49], v12 offset:45056
v_mfma_f32_16x16x32_bf16 v[68:71], a[20:23], a[68:71], v[68:71]
ds_read_b64_tr_b16 a[50:51], v12 offset:45568
v_mfma_f32_16x16x32_bf16 v[92:95], a[24:27], a[68:71], v[92:95]
ds_read_b64_tr_b16 a[52:53], v13 offset:45056
v_mfma_f32_16x16x32_bf16 v[116:119], a[28:31], a[68:71], v[116:119]
ds_read_b64_tr_b16 a[54:55], v13 offset:45568
v_mfma_f32_16x16x32_bf16 v[48:51], a[16:19], a[72:75], v[48:51]
v_mfma_f32_16x16x32_bf16 v[72:75], a[20:23], a[72:75], v[72:75]
v_mfma_f32_16x16x32_bf16 v[96:99], a[24:27], a[72:75], v[96:99]
v_mfma_f32_16x16x32_bf16 v[120:123], a[28:31], a[72:75], v[120:123]
v_mfma_f32_16x16x32_bf16 v[52:55], a[16:19], a[76:79], v[52:55]
v_mfma_f32_16x16x32_bf16 v[76:79], a[20:23], a[76:79], v[76:79]
v_mfma_f32_16x16x32_bf16 v[100:103], a[24:27], a[76:79], v[100:103]
v_mfma_f32_16x16x32_bf16 v[124:127], a[28:31], a[76:79], v[124:127]
s_waitcnt lgkmcnt(0)
v_mfma_f32_16x16x32_bf16 v[32:35], a[32:35], a[0:3], v[32:35]
ds_read_b128 a[16:19], v11 offset:40960
v_mfma_f32_16x16x32_bf16 v[56:59], a[32:35], a[4:7], v[56:59]
ds_read_b64_tr_b16 a[56:57], v12 offset:53248
v_mfma_f32_16x16x32_bf16 v[80:83], a[32:35], a[8:11], v[80:83]
ds_read_b64_tr_b16 a[58:59], v12 offset:53760
v_mfma_f32_16x16x32_bf16 v[104:107], a[32:35], a[12:15], v[104:107]
ds_read_b128 a[20:23], v11 offset:43008
v_mfma_f32_16x16x32_bf16 v[36:39], a[36:39], a[0:3], v[36:39]
ds_read_b128 a[24:27], v11 offset:45056
v_mfma_f32_16x16x32_bf16 v[60:63], a[36:39], a[4:7], v[60:63]
ds_read_b128 a[28:31], v11 offset:47104
v_mfma_f32_16x16x32_bf16 v[84:87], a[36:39], a[8:11], v[84:87]
ds_read_b64_tr_b16 a[60:61], v13 offset:53248
v_mfma_f32_16x16x32_bf16 v[108:111], a[36:39], a[12:15], v[108:111]
ds_read_b64_tr_b16 a[62:63], v13 offset:53760
v_mfma_f32_16x16x32_bf16 v[40:43], a[0:3], a[40:43], v[40:43]
ds_read_b64_tr_b16 a[64:65], v12 offset:55296
v_mfma_f32_16x16x32_bf16 v[64:67], a[4:7], a[40:43], v[64:67]
ds_read_b64_tr_b16 a[66:67], v12 offset:55808
v_mfma_f32_16x16x32_bf16 v[88:91], a[8:11], a[40:43], v[88:91]
ds_read_b64_tr_b16 a[68:69], v13 offset:55296
v_mfma_f32_16x16x32_bf16 v[112:115], a[12:15], a[40:43], v[112:115]
ds_read_b64_tr_b16 a[70:71], v13 offset:55808
v_mfma_f32_16x16x32_bf16 v[44:47], a[0:3], a[44:47], v[44:47]
ds_read_b64_tr_b16 a[72:73], v12 offset:57344
v_mfma_f32_16x16x32_bf16 v[68:71], a[4:7], a[44:47], v[68:71]
ds_read_b64_tr_b16 a[74:75], v12 offset:57856
v_mfma_f32_16x16x32_bf16 v[92:95], a[8:11], a[44:47], v[92:95]
ds_read_b64_tr_b16 a[76:77], v13 offset:57344
v_mfma_f32_16x16x32_bf16 v[116:119], a[12:15], a[44:47], v[116:119]
ds_read_b64_tr_b16 a[78:79], v13 offset:57856
v_mfma_f32_16x16x32_bf16 v[48:51], a[0:3], a[48:51], v[48:51]
s_cmp_lg_u32 s94, 0
s_cbranch_scc1 L_nocsp
v_and_b32 v2, 16, v1
v_cmp_ne_u32 vcc, 0, v2
s_nop 1
v_cndmask_b32 v24, v128, v132, vcc
v_cndmask_b32 v25, v136, v140, vcc
v_cndmask_b32 v26, v144, v148, vcc
v_mov_b32 v27, s68
s_lshl_b32 s70, s64, 4
s_lshr_b32 s71, s65, 2
s_add_u32 s70, s70, s71
s_lshl_b32 s70, s70, 10
s_lshl_b32 s71, s67, 9
s_add_u32 s70, s70, s71
s_add_u32 s70, s70, 65536
s_mov_b64 exec, 0xffffffff
buffer_store_dwordx4 v[24:27], v16, s[12:15], s70 offen sc1
s_mov_b64 exec, -1
L_nocsp:
v_mfma_f32_16x16x32_bf16 v[72:75], a[4:7], a[48:51], v[72:75]
v_mfma_f32_16x16x32_bf16 v[96:99], a[8:11], a[48:51], v[96:99]
s_add_u32 s70, s88, 65536
buffer_store_dwordx4 v[28:31], v16, s[12:15], s70 offen sc1
v_mfma_f32_16x16x32_bf16 v[120:123], a[12:15], a[48:51], v[120:123]
v_mfma_f32_16x16x32_bf16 v[52:55], a[0:3], a[52:55], v[52:55]
s_add_u32 s70, s88, 98304
buffer_store_dwordx4 v[28:31], v16, s[12:15], s70 offen sc1
v_mfma_f32_16x16x32_bf16 v[76:79], a[4:7], a[52:55], v[76:79]
v_mfma_f32_16x16x32_bf16 v[100:103], a[8:11], a[52:55], v[100:103]
v_mfma_f32_16x16x32_bf16 v[124:127], a[12:15], a[52:55], v[124:127]
s_waitcnt lgkmcnt(0)
v_mfma_f32_16x16x32_bf16 v[32:35], a[56:59], a[16:19], v[32:35]
s_barrier
ds_read_b128 a[0:3], v10 offset:0
v_mfma_f32_16x16x32_bf16 v[56:59], a[56:59], a[20:23], v[56:59]
ds_read_b64_tr_b16 a[32:33], v12 offset:0
v_mfma_f32_16x16x32_bf16 v[80:83], a[56:59], a[24:27], v[80:83]
ds_read_b64_tr_b16 a[34:35], v12 offset:512
v_mfma_f32_16x16x32_bf16 v[104:107], a[56:59], a[28:31], v[104:107]
ds_read_b128 a[4:7], v10 offset:2048
v_mfma_f32_16x16x32_bf16 v[36:39], a[60:63], a[16:19], v[36:39]
ds_read_b128 a[8:11], v10 offset:4096
v_mfma_f32_16x16x32_bf16 v[60:63], a[60:63], a[20:23], v[60:63]
ds_read_b128 a[12:15], v10 offset:6144
v_mfma_f32_16x16x32_bf16 v[84:87], a[60:63], a[24:27], v[84:87]
ds_read_b64_tr_b16 a[36:37], v13 offset:0
v_mfma_f32_16x16x32_bf16 v[108:111], a[60:63], a[28:31], v[108:111]
ds_read_b64_tr_b16 a[38:39], v13 offset:512
v_mfma_f32_16x16x32_bf16 v[40:43], a[16:19], a[64:67], v[40:43]
ds_read_b64_tr_b16 a[40:41], v12 offset:2048
v_mfma_f32_16x16x32_bf16 v[64:67], a[20:23], a[64:67], v[64:67]
ds_read_b64_tr_b16 a[42:43], v12 offset:2560
v_mfma_f32_16x16x32_bf16 v[88:91], a[24:27], a[64:67], v[88:91]
ds_read_b64_tr_b16 a[44:45], v13 offset:2048
v_mfma_f32_16x16x32_bf16 v[112:115], a[28:31], a[64:67], v[112:115]
ds_read_b64_tr_b16 a[46:47], v13 offset:2560
v_mfma_f32_16x16x32_bf16 v[44:47], a[16:19], a[68:71], v[44:47]
ds_read_b64_tr_b16 a[48:49], v12 offset:4096
v_mfma_f32_16x16x32_bf16 v[68:71], a[20:23], a[68:71], v[68:71]
ds_read_b64_tr_b16 a[50:51], v12 offset:4608
v_mfma_f32_16x16x32_bf16 v[92:95], a[24:27], a[68:71], v[92:95]
ds_read_b64_tr_b16 a[52:53], v13 offset:4096
v_mfma_f32_16x16x32_bf16 v[116:119], a[28:31], a[68:71], v[116:119]
ds_read_b64_tr_b16 a[54:55], v13 offset:4608
v_mfma_f32_16x16x32_bf16 v[48:51], a[16:19], a[72:75], v[48:51]
v_mfma_f32_16x16x32_bf16 v[72:75], a[20:23], a[72:75], v[72:75]
v_mfma_f32_16x16x32_bf16 v[96:99], a[24:27], a[72:75], v[96:99]
v_mfma_f32_16x16x32_bf16 v[120:123], a[28:31], a[72:75], v[120:123]
v_mfma_f32_16x16x32_bf16 v[52:55], a[16:19], a[76:79], v[52:55]
v_mfma_f32_16x16x32_bf16 v[76:79], a[20:23], a[76:79], v[76:79]
v_mfma_f32_16x16x32_bf16 v[100:103], a[24:27], a[76:79], v[100:103]
v_mfma_f32_16x16x32_bf16 v[124:127], a[28:31], a[76:79], v[124:127]
s_waitcnt lgkmcnt(0)
v_mfma_f32_16x16x32_bf16 v[32:35], a[32:35], a[0:3], v[32:35]
ds_read_b128 a[16:19], v11 offset:0
v_mfma_f32_16x16x32_bf16 v[56:59], a[32:35], a[4:7], v[56:59]
ds_read_b64_tr_b16 a[56:57], v12 offset:12288
v_mfma_f32_16x16x32_bf16 v[80:83], a[32:35], a[8:11], v[80:83]
ds_read_b64_tr_b16 a[58:59], v12 offset:12800
v_mfma_f32_16x16x32_bf16 v[104:107], a[32:35], a[12:15], v[104:107]
ds_read_b128 a[20:23], v11 offset:2048
v_mfma_f32_16x16x32_bf16 v[36:39], a[36:39], a[0:3], v[36:39]
ds_read_b128 a[24:27], v11 offset:4096
v_mfma_f32_16x16x32_bf16 v[60:63], a[36:39], a[4:7], v[60:63]
ds_read_b128 a[28:31], v11 offset:6144
v_mfma_f32_16x16x32_bf16 v[84:87], a[36:39], a[8:11], v[84:87]
ds_read_b64_tr_b16 a[60:61], v13 offset:12288
v_mfma_f32_16x16x32_bf16 v[108:111], a[36:39], a[12:15], v[108:111]
ds_read_b64_tr_b16 a[62:63], v13 offset:12800
v_mfma_f32_16x16x32_bf16 v[40:43], a[0:3], a[40:43], v[40:43]
ds_read_b64_tr_b16 a[64:65], v12 offset:14336
v_mfma_f32_16x16x32_bf16 v[64:67], a[4:7], a[40:43], v[64:67]
ds_read_b64_tr_b16 a[66:67], v12 offset:14848
v_mfma_f32_16x16x32_bf16 v[88:91], a[8:11], a[40:43], v[88:91]
ds_read_b64_tr_b16 a[68:69], v13 offset:14336
v_mfma_f32_16x16x32_bf16 v[112:115], a[12:15], a[40:43], v[112:115]
ds_read_b64_tr_b16 a[70:71], v13 offset:14848
v_mfma_f32_16x16x32_bf16 v[44:47], a[0:3], a[44:47], v[44:47]
ds_read_b64_tr_b16 a[72:73], v12 offset:16384
v_mfma_f32_16x16x32_bf16 v[68:71], a[4:7], a[44:47], v[68:71]
ds_read_b64_tr_b16 a[74:75], v12 offset:16896
v_mfma_f32_16x16x32_bf16 v[92:95], a[8:11], a[44:47], v[92:95]
ds_read_b64_tr_b16 a[76:77], v13 offset:16384
v_mfma_f32_16x16x32_bf16 v[116:119], a[12:15], a[44:47], v[116:119]
ds_read_b64_tr_b16 a[78:79], v13 offset:16896
v_mfma_f32_16x16x32_bf16 v[48:51], a[0:3], a[48:51], v[48:51]
v_mfma_f32_16x16x32_bf16 v[72:75], a[4:7], a[48:51], v[72:75]
v_mfma_f32_16x16x32_bf16 v[96:99], a[8:11], a[48:51], v[96:99]
v_mfma_f32_16x16x32_bf16 v[120:123], a[12:15], a[48:51], v[120:123]
v_mfma_f32_16x16x32_bf16 v[52:55], a[0:3], a[52:55], v[52:55]
v_mfma_f32_16x16x32_bf16 v[76:79], a[4:7], a[52:55], v[76:79]
v_mfma_f32_16x16x32_bf16 v[100:103], a[8:11], a[52:55], v[100:103]
v_mfma_f32_16x16x32_bf16 v[124:127], a[12:15], a[52:55], v[124:127]
s_waitcnt lgkmcnt(0)
v_mfma_f32_16x16x32_bf16 v[32:35], a[56:59], a[16:19], v[32:35]
s_barrier
ds_read_b128 a[0:3], v8 offset:24576
v_mfma_f32_16x16x32_bf16 v[56:59], a[56:59], a[20:23], v[56:59]
ds_read_b64_tr_b16 a[32:33], v14 offset:16384
v_mfma_f32_16x16x32_bf16 v[80:83], a[56:59], a[24:27], v[80:83]
ds_read_b64_tr_b16 a[34:35], v14 offset:16896
v_mfma_f32_16x16x32_bf16 v[104:107], a[56:59], a[28:31], v[104:107]
ds_read_b128 a[4:7], v8 offset:26624
v_mfma_f32_16x16x32_bf16 v[36:39], a[60:63], a[16:19], v[36:39]
ds_read_b128 a[8:11], v8 offset:28672
v_mfma_f32_16x16x32_bf16 v[60:63], a[60:63], a[20:23], v[60:63]
ds_read_b128 a[12:15], v8 offset:30720
v_mfma_f32_16x16x32_bf16 v[84:87], a[60:63], a[24:27], v[84:87]
ds_read_b64_tr_b16 a[36:37], v15 offset:16384
v_mfma_f32_16x16x32_bf16 v[108:111], a[60:63], a[28:31], v[108:111]
ds_read_b64_tr_b16 a[38:39], v15 offset:16896
v_mfma_f32_16x16x32_bf16 v[40:43], a[16:19], a[64:67], v[40:43]
ds_read_b64_tr_b16 a[40:41], v14 offset:18432
v_mfma_f32_16x16x32_bf16 v[64:67], a[20:23], a[64:67], v[64:67]
ds_read_b64_tr_b16 a[42:43], v14 offset:18944
v_mfma_f32_16x16x32_bf16 v[88:91], a[24:27], a[64:67], v[88:91]
ds_read_b64_tr_b16 a[44:45], v15 offset:18432
v_mfma_f32_16x16x32_bf16 v[112:115], a[28:31], a[64:67], v[112:115]
ds_read_b64_tr_b16 a[46:47], v15 offset:18944
v_mfma_f32_16x16x32_bf16 v[44:47], a[16:19], a[68:71], v[44:47]
ds_read_b64_tr_b16 a[48:49], v14 offset:20480
v_mfma_f32_16x16x32_bf16 v[68:71], a[20:23], a[68:71], v[68:71]
ds_read_b64_tr_b16 a[50:51], v14 offset:20992
v_mfma_f32_16x16x32_bf16 v[92:95], a[24:27], a[68:71], v[92:95]
ds_read_b64_tr_b16 a[52:53], v15 offset:20480
v_mfma_f32_16x16x32_bf16 v[116:119], a[28:31], a[68:71], v[116:119]
ds_read_b64_tr_b16 a[54:55], v15 offset:20992
v_mfma_f32_16x16x32_bf16 v[48:51], a[16:19], a[72:75], v[48:51]
v_mfma_f32_16x16x32_bf16 v[72:75], a[20:23], a[72:75], v[72:75]
v_mfma_f32_16x16x32_bf16 v[96:99], a[24:27], a[72:75], v[96:99]
v_mfma_f32_16x16x32_bf16 v[120:123], a[28:31], a[72:75], v[120:123]
v_mfma_f32_16x16x32_bf16 v[52:55], a[16:19], a[76:79], v[52:55]
v_mfma_f32_16x16x32_bf16 v[76:79], a[20:23], a[76:79], v[76:79]
v_mfma_f32_16x16x32_bf16 v[100:103], a[24:27], a[76:79], v[100:103]
v_mfma_f32_16x16x32_bf16 v[124:127], a[28:31], a[76:79], v[124:127]
s_waitcnt lgkmcnt(0)
v_mfma_f32_16x16x32_bf16 v[32:35], a[32:35], a[0:3], v[32:35]
ds_read_b128 a[16:19], v9 offset:24576
v_mfma_f32_16x16x32_bf16 v[56:59], a[32:35], a[4:7], v[56:59]
ds_read_b64_tr_b16 a[56:57], v14 offset:28672
v_mfma_f32_16x16x32_bf16 v[80:83], a[32:35], a[8:11], v[80:83]
ds_read_b64_tr_b16 a[58:59], v14 offset:29184
v_mfma_f32_16x16x32_bf16 v[104:107], a[32:35], a[12:15], v[104:107]
ds_read_b128 a[20:23], v9 offset:26624
v_mfma_f32_16x16x32_bf16 v[36:39], a[36:39], a[0:3], v[36:39]
ds_read_b128 a[24:27], v9 offset:28672
v_mfma_f32_16x16x32_bf16 v[60:63], a[36:39], a[4:7], v[60:63]
ds_read_b128 a[28:31], v9 offset:30720
v_mfma_f32_16x16x32_bf16 v[84:87], a[36:39], a[8:11], v[84:87]
ds_read_b64_tr_b16 a[60:61], v15 offset:28672
v_mfma_f32_16x16x32_bf16 v[108:111], a[36:39], a[12:15], v[108:111]
ds_read_b64_tr_b16 a[62:63], v15 offset:29184
v_mfma_f32_16x16x32_bf16 v[40:43], a[0:3], a[40:43], v[40:43]
ds_read_b64_tr_b16 a[64:65], v14 offset:30720
v_mfma_f32_16x16x32_bf16 v[64:67], a[4:7], a[40:43], v[64:67]
ds_read_b64_tr_b16 a[66:67], v14 offset:31232
v_mfma_f32_16x16x32_bf16 v[88:91], a[8:11], a[40:43], v[88:91]
ds_read_b64_tr_b16 a[68:69], v15 offset:30720
v_mfma_f32_16x16x32_bf16 v[112:115], a[12:15], a[40:43], v[112:115]
ds_read_b64_tr_b16 a[70:71], v15 offset:31232
v_mfma_f32_16x16x32_bf16 v[44:47], a[0:3], a[44:47], v[44:47]
ds_read_b64_tr_b16 a[72:73], v14 offset:32768
v_mfma_f32_16x16x32_bf16 v[68:71], a[4:7], a[44:47], v[68:71]
ds_read_b64_tr_b16 a[74:75], v14 offset:33280
v_mfma_f32_16x16x32_bf16 v[92:95], a[8:11], a[44:47], v[92:95]
ds_read_b64_tr_b16 a[76:77], v15 offset:32768
v_mfma_f32_16x16x32_bf16 v[116:119], a[12:15], a[44:47], v[116:119]
ds_read_b64_tr_b16 a[78:79], v15 offset:33280
v_mfma_f32_16x16x32_bf16 v[48:51], a[0:3], a[48:51], v[48:51]
s_waitcnt vmcnt(0)
v_mfma_f32_16x16x32_bf16 v[72:75], a[4:7], a[48:51], v[72:75]
v_mfma_f32_16x16x32_bf16 v[96:99], a[8:11], a[48:51], v[96:99]
v_mfma_f32_16x16x32_bf16 v[120:123], a[12:15], a[48:51], v[120:123]
v_mfma_f32_16x16x32_bf16 v[52:55], a[0:3], a[52:55], v[52:55]
v_mfma_f32_16x16x32_bf16 v[76:79], a[4:7], a[52:55], v[76:79]
v_mfma_f32_16x16x32_bf16 v[100:103], a[8:11], a[52:55], v[100:103]
v_mfma_f32_16x16x32_bf16 v[124:127], a[12:15], a[52:55], v[124:127]
s_waitcnt lgkmcnt(0)
v_mfma_f32_16x16x32_bf16 v[32:35], a[56:59], a[16:19], v[32:35]
s_barrier
ds_read_b128 a[0:3], v10 offset:57344
v_mfma_f32_16x16x32_bf16 v[56:59], a[56:59], a[20:23], v[56:59]
ds_read_b64_tr_b16 a[32:33], v12 offset:40960
v_mfma_f32_16x16x32_bf16 v[80:83], a[56:59], a[24:27], v[80:83]
ds_read_b64_tr_b16 a[34:35], v12 offset:41472
v_mfma_f32_16x16x32_bf16 v[104:107], a[56:59], a[28:31], v[104:107]
ds_read_b128 a[4:7], v10 offset:59392
v_mfma_f32_16x16x32_bf16 v[36:39], a[60:63], a[16:19], v[36:39]
ds_read_b128 a[8:11], v10 offset:61440
v_mfma_f32_16x16x32_bf16 v[60:63], a[60:63], a[20:23], v[60:63]
ds_read_b128 a[12:15], v10 offset:63488
v_mfma_f32_16x16x32_bf16 v[84:87], a[60:63], a[24:27], v[84:87]
ds_read_b64_tr_b16 a[36:37], v13 offset:40960
v_mfma_f32_16x16x32_bf16 v[108:111], a[60:63], a[28:31], v[108:111]
ds_read_b64_tr_b16 a[38:39], v13 offset:41472
v_mfma_f32_16x16x32_bf16 v[40:43], a[16:19], a[64:67], v[40:43]
ds_read_b64_tr_b16 a[40:41], v12 offset:43008
v_mfma_f32_16x16x32_bf16 v[64:67], a[20:23], a[64:67], v[64:67]
ds_read_b64_tr_b16 a[42:43], v12 offset:43520
v_mfma_f32_16x16x32_bf16 v[88:91], a[24:27], a[64:67], v[88:91]
ds_read_b64_tr_b16 a[44:45], v13 offset:43008
v_mfma_f32_16x16x32_bf16 v[112:115], a[28:31], a[64:67], v[112:115]
ds_read_b64_tr_b16 a[46:47], v13 offset:43520
v_mfma_f32_16x16x32_bf16 v[44:47], a[16:19], a[68:71], v[44:47]
ds_read_b64_tr_b16 a[48:49], v12 offset:45056
v_mfma_f32_16x16x32_bf16 v[68:71], a[20:23], a[68:71], v[68:71]
ds_read_b64_tr_b16 a[50:51], v12 offset:45568
v_mfma_f32_16x16x32_bf16 v[92:95], a[24:27], a[68:71], v[92:95]
ds_read_b64_tr_b16 a[52:53], v13 offset:45056
v_mfma_f32_16x16x32_bf16 v[116:119], a[28:31], a[68:71], v[116:119]
ds_read_b64_tr_b16 a[54:55], v13 offset:45568
v_mfma_f32_16x16x32_bf16 v[48:51], a[16:19], a[72:75], v[48:51]
v_mfma_f32_16x16x32_bf16 v[72:75], a[20:23], a[72:75], v[72:75]
v_mfma_f32_16x16x32_bf16 v[96:99], a[24:27], a[72:75], v[96:99]
v_mfma_f32_16x16x32_bf16 v[120:123], a[28:31], a[72:75], v[120:123]
v_mfma_f32_16x16x32_bf16 v[52:55], a[16:19], a[76:79], v[52:55]
v_mfma_f32_16x16x32_bf16 v[76:79], a[20:23], a[76:79], v[76:79]
v_mfma_f32_16x16x32_bf16 v[100:103], a[24:27], a[76:79], v[100:103]
v_mfma_f32_16x16x32_bf16 v[124:127], a[28:31], a[76:79], v[124:127]
s_waitcnt lgkmcnt(0)
v_mfma_f32_16x16x32_bf16 v[32:35], a[32:35], a[0:3], v[32:35]
ds_read_b128 a[16:19], v11 offset:57344
v_mfma_f32_16x16x32_bf16 v[56:59], a[32:35], a[4:7], v[56:59]
ds_read_b64_tr_b16 a[56:57], v12 offset:53248
v_mfma_f32_16x16x32_bf16 v[80:83], a[32:35], a[8:11], v[80:83]
ds_read_b64_tr_b16 a[58:59], v12 offset:53760
v_mfma_f32_16x16x32_bf16 v[104:107], a[32:35], a[12:15], v[104:107]
ds_read_b128 a[20:23], v11 offset:59392
v_mfma_f32_16x16x32_bf16 v[36:39], a[36:39], a[0:3], v[36:39]
ds_read_b128 a[24:27], v11 offset:61440
v_mfma_f32_16x16x32_bf16 v[60:63], a[36:39], a[4:7], v[60:63]
ds_read_b128 a[28:31], v11 offset:63488
v_mfma_f32_16x16x32_bf16 v[84:87], a[36:39], a[8:11], v[84:87]
ds_read_b64_tr_b16 a[60:61], v13 offset:53248
v_mfma_f32_16x16x32_bf16 v[108:111], a[36:39], a[12:15], v[108:111]
ds_read_b64_tr_b16 a[62:63], v13 offset:53760
v_mfma_f32_16x16x32_bf16 v[40:43], a[0:3], a[40:43], v[40:43]
ds_read_b64_tr_b16 a[64:65], v12 offset:55296
v_mfma_f32_16x16x32_bf16 v[64:67], a[4:7], a[40:43], v[64:67]
ds_read_b64_tr_b16 a[66:67], v12 offset:55808
v_mfma_f32_16x16x32_bf16 v[88:91], a[8:11], a[40:43], v[88:91]
ds_read_b64_tr_b16 a[68:69], v13 offset:55296
v_mfma_f32_16x16x32_bf16 v[112:115], a[12:15], a[40:43], v[112:115]
ds_read_b64_tr_b16 a[70:71], v13 offset:55808
v_mfma_f32_16x16x32_bf16 v[44:47], a[0:3], a[44:47], v[44:47]
ds_read_b64_tr_b16 a[72:73], v12 offset:57344
v_mfma_f32_16x16x32_bf16 v[68:71], a[4:7], a[44:47], v[68:71]
ds_read_b64_tr_b16 a[74:75], v12 offset:57856
v_mfma_f32_16x16x32_bf16 v[92:95], a[8:11], a[44:47], v[92:95]
ds_read_b64_tr_b16 a[76:77], v13 offset:57344
v_mfma_f32_16x16x32_bf16 v[116:119], a[12:15], a[44:47], v[116:119]
ds_read_b64_tr_b16 a[78:79], v13 offset:57856
v_mfma_f32_16x16x32_bf16 v[48:51], a[0:3], a[48:51], v[48:51]
v_mfma_f32_16x16x32_bf16 v[72:75], a[4:7], a[48:51], v[72:75]
v_mfma_f32_16x16x32_bf16 v[96:99], a[8:11], a[48:51], v[96:99]
v_mfma_f32_16x16x32_bf16 v[120:123], a[12:15], a[48:51], v[120:123]
v_mfma_f32_16x16x32_bf16 v[52:55], a[0:3], a[52:55], v[52:55]
v_mfma_f32_16x16x32_bf16 v[76:79], a[4:7], a[52:55], v[76:79]
v_mfma_f32_16x16x32_bf16 v[100:103], a[8:11], a[52:55], v[100:103]
v_mfma_f32_16x16x32_bf16 v[124:127], a[12:15], a[52:55], v[124:127]
s_waitcnt lgkmcnt(0)
v_mfma_f32_16x16x32_bf16 v[32:35], a[56:59], a[16:19], v[32:35]
s_barrier
ds_read_b128 a[0:3], v10 offset:40960
v_mfma_f32_16x16x32_bf16 v[56:59], a[56:59], a[20:23], v[56:59]
ds_read_b64_tr_b16 a[32:33], v12 offset:0
v_mfma_f32_16x16x32_bf16 v[80:83], a[56:59], a[24:27], v[80:83]
ds_read_b64_tr_b16 a[34:35], v12 offset:512
v_mfma_f32_16x16x32_bf16 v[104:107], a[56:59], a[28:31], v[104:107]
ds_read_b128 a[4:7], v10 offset:43008
v_mfma_f32_16x16x32_bf16 v[36:39], a[60:63], a[16:19], v[36:39]
ds_read_b128 a[8:11], v10 offset:45056
v_mfma_f32_16x16x32_bf16 v[60:63], a[60:63], a[20:23], v[60:63]
ds_read_b128 a[12:15], v10 offset:47104
v_mfma_f32_16x16x32_bf16 v[84:87], a[60:63], a[24:27], v[84:87]
ds_read_b64_tr_b16 a[36:37], v13 offset:0
v_mfma_f32_16x16x32_bf16 v[108:111], a[60:63], a[28:31], v[108:111]
ds_read_b64_tr_b16 a[38:39], v13 offset:512
v_mfma_f32_16x16x32_bf16 v[40:43], a[16:19], a[64:67], v[40:43]
ds_read_b64_tr_b16 a[40:41], v12 offset:2048
v_mfma_f32_16x16x32_bf16 v[64:67], a[20:23], a[64:67], v[64:67]
ds_read_b64_tr_b16 a[42:43], v12 offset:2560
v_mfma_f32_16x16x32_bf16 v[88:91], a[24:27], a[64:67], v[88:91]
ds_read_b64_tr_b16 a[44:45], v13 offset:2048
v_mfma_f32_16x16x32_bf16 v[112:115], a[28:31], a[64:67], v[112:115]
ds_read_b64_tr_b16 a[46:47], v13 offset:2560
v_mfma_f32_16x16x32_bf16 v[44:47], a[16:19], a[68:71], v[44:47]
ds_read_b64_tr_b16 a[48:49], v12 offset:4096
v_mfma_f32_16x16x32_bf16 v[68:71], a[20:23], a[68:71], v[68:71]
ds_read_b64_tr_b16 a[50:51], v12 offset:4608
v_mfma_f32_16x16x32_bf16 v[92:95], a[24:27], a[68:71], v[92:95]
ds_read_b64_tr_b16 a[52:53], v13 offset:4096
v_mfma_f32_16x16x32_bf16 v[116:119], a[28:31], a[68:71], v[116:119]
ds_read_b64_tr_b16 a[54:55], v13 offset:4608
v_mfma_f32_16x16x32_bf16 v[48:51], a[16:19], a[72:75], v[48:51]
v_mfma_f32_16x16x32_bf16 v[72:75], a[20:23], a[72:75], v[72:75]
v_mfma_f32_16x16x32_bf16 v[96:99], a[24:27], a[72:75], v[96:99]
v_mfma_f32_16x16x32_bf16 v[120:123], a[28:31], a[72:75], v[120:123]
v_mfma_f32_16x16x32_bf16 v[52:55], a[16:19], a[76:79], v[52:55]
v_mfma_f32_16x16x32_bf16 v[76:79], a[20:23], a[76:79], v[76:79]
v_mfma_f32_16x16x32_bf16 v[100:103], a[24:27], a[76:79], v[100:103]
v_mfma_f32_16x16x32_bf16 v[124:127], a[28:31], a[76:79], v[124:127]
s_waitcnt lgkmcnt(0)
v_mfma_f32_16x16x32_bf16 v[32:35], a[32:35], a[0:3], v[32:35]
ds_read_b128 a[16:19], v11 offset:40960
v_mfma_f32_16x16x32_bf16 v[56:59], a[32:35], a[4:7], v[56:59]
ds_read_b64_tr_b16 a[56:57], v12 offset:12288
v_mfma_f32_16x16x32_bf16 v[80:83], a[32:35], a[8:11], v[80:83]
ds_read_b64_tr_b16 a[58:59], v12 offset:12800
v_mfma_f32_16x16x32_bf16 v[104:107], a[32:35], a[12:15], v[104:107]
ds_read_b128 a[20:23], v11 offset:43008
v_mfma_f32_16x16x32_bf16 v[36:39], a[36:39], a[0:3], v[36:39]
ds_read_b128 a[24:27], v11 offset:45056
v_mfma_f32_16x16x32_bf16 v[60:63], a[36:39], a[4:7], v[60:63]
ds_read_b128 a[28:31], v11 offset:47104
v_mfma_f32_16x16x32_bf16 v[84:87], a[36:39], a[8:11], v[84:87]
ds_read_b64_tr_b16 a[60:61], v13 offset:12288
v_mfma_f32_16x16x32_bf16 v[108:111], a[36:39], a[12:15], v[108:111]
ds_read_b64_tr_b16 a[62:63], v13 offset:12800
v_mfma_f32_16x16x32_bf16 v[40:43], a[0:3], a[40:43], v[40:43]
ds_read_b64_tr_b16 a[64:65], v12 offset:14336
v_mfma_f32_16x16x32_bf16 v[64:67], a[4:7], a[40:43], v[64:67]
ds_read_b64_tr_b16 a[66:67], v12 offset:14848
v_mfma_f32_16x16x32_bf16 v[88:91], a[8:11], a[40:43], v[88:91]
ds_read_b64_tr_b16 a[68:69], v13 offset:14336
v_mfma_f32_16x16x32_bf16 v[112:115], a[12:15], a[40:43], v[112:115]
ds_read_b64_tr_b16 a[70:71], v13 offset:14848
v_mfma_f32_16x16x32_bf16 v[44:47], a[0:3], a[44:47], v[44:47]
ds_read_b64_tr_b16 a[72:73], v12 offset:16384
v_mfma_f32_16x16x32_bf16 v[68:71], a[4:7], a[44:47], v[68:71]
ds_read_b64_tr_b16 a[74:75], v12 offset:16896
v_mfma_f32_16x16x32_bf16 v[92:95], a[8:11], a[44:47], v[92:95]
ds_read_b64_tr_b16 a[76:77], v13 offset:16384
v_mfma_f32_16x16x32_bf16 v[116:119], a[12:15], a[44:47], v[116:119]
ds_read_b64_tr_b16 a[78:79], v13 offset:16896
v_mfma_f32_16x16x32_bf16 v[48:51], a[0:3], a[48:51], v[48:51]
v_mfma_f32_16x16x32_bf16 v[72:75], a[4:7], a[48:51], v[72:75]
v_mfma_f32_16x16x32_bf16 v[96:99], a[8:11], a[48:51], v[96:99]
v_mfma_f32_16x16x32_bf16 v[120:123], a[12:15], a[48:51], v[120:123]
v_mfma_f32_16x16x32_bf16 v[52:55], a[0:3], a[52:55], v[52:55]
v_mfma_f32_16x16x32_bf16 v[76:79], a[4:7], a[52:55], v[76:79]
v_mfma_f32_16x16x32_bf16 v[100:103], a[8:11], a[52:55], v[100:103]
v_mfma_f32_16x16x32_bf16 v[124:127], a[12:15], a[52:55], v[124:127]
s_waitcnt lgkmcnt(0)
v_mfma_f32_16x16x32_bf16 v[32:35], a[56:59], a[16:19], v[32:35]
s_barrier
ds_read_b128 a[0:3], v10 offset:0
v_mfma_f32_16x16x32_bf16 v[56:59], a[56:59], a[20:23], v[56:59]
ds_read_b64_tr_b16 a[32:33], v14 offset:16384
v_mfma_f32_16x16x32_bf16 v[80:83], a[56:59], a[24:27], v[80:83]
ds_read_b64_tr_b16 a[34:35], v14 offset:16896
v_mfma_f32_16x16x32_bf16 v[104:107], a[56:59], a[28:31], v[104:107]
ds_read_b128 a[4:7], v10 offset:2048
v_mfma_f32_16x16x32_bf16 v[36:39], a[60:63], a[16:19], v[36:39]
ds_read_b128 a[8:11], v10 offset:4096
v_mfma_f32_16x16x32_bf16 v[60:63], a[60:63], a[20:23], v[60:63]
ds_read_b128 a[12:15], v10 offset:6144
v_mfma_f32_16x16x32_bf16 v[84:87], a[60:63], a[24:27], v[84:87]
ds_read_b64_tr_b16 a[36:37], v15 offset:16384
v_mfma_f32_16x16x32_bf16 v[108:111], a[60:63], a[28:31], v[108:111]
ds_read_b64_tr_b16 a[38:39], v15 offset:16896
v_mfma_f32_16x16x32_bf16 v[40:43], a[16:19], a[64:67], v[40:43]
ds_read_b64_tr_b16 a[40:41], v14 offset:18432
v_mfma_f32_16x16x32_bf16 v[64:67], a[20:23], a[64:67], v[64:67]
ds_read_b64_tr_b16 a[42:43], v14 offset:18944
v_mfma_f32_16x16x32_bf16 v[88:91], a[24:27], a[64:67], v[88:91]
ds_read_b64_tr_b16 a[44:45], v15 offset:18432
v_mfma_f32_16x16x32_bf16 v[112:115], a[28:31], a[64:67], v[112:115]
ds_read_b64_tr_b16 a[46:47], v15 offset:18944
v_mfma_f32_16x16x32_bf16 v[44:47], a[16:19], a[68:71], v[44:47]
ds_read_b64_tr_b16 a[48:49], v14 offset:20480
v_mfma_f32_16x16x32_bf16 v[68:71], a[20:23], a[68:71], v[68:71]
ds_read_b64_tr_b16 a[50:51], v14 offset:20992
v_mfma_f32_16x16x32_bf16 v[92:95], a[24:27], a[68:71], v[92:95]
ds_read_b64_tr_b16 a[52:53], v15 offset:20480
v_mfma_f32_16x16x32_bf16 v[116:119], a[28:31], a[68:71], v[116:119]
ds_read_b64_tr_b16 a[54:55], v15 offset:20992
v_mfma_f32_16x16x32_bf16 v[48:51], a[16:19], a[72:75], v[48:51]
v_mfma_f32_16x16x32_bf16 v[72:75], a[20:23], a[72:75], v[72:75]
v_mfma_f32_16x16x32_bf16 v[96:99], a[24:27], a[72:75], v[96:99]
v_mfma_f32_16x16x32_bf16 v[120:123], a[28:31], a[72:75], v[120:123]
v_mfma_f32_16x16x32_bf16 v[52:55], a[16:19], a[76:79], v[52:55]
v_mfma_f32_16x16x32_bf16 v[76:79], a[20:23], a[76:79], v[76:79]
v_mfma_f32_16x16x32_bf16 v[100:103], a[24:27], a[76:79], v[100:103]
v_mfma_f32_16x16x32_bf16 v[124:127], a[28:31], a[76:79], v[124:127]
s_waitcnt lgkmcnt(0)
v_mfma_f32_16x16x32_bf16 v[32:35], a[32:35], a[0:3], v[32:35]
ds_read_b128 a[16:19], v11 offset:0
v_mfma_f32_16x16x32_bf16 v[56:59], a[32:35], a[4:7], v[56:59]
ds_read_b64_tr_b16 a[56:57], v14 offset:28672
v_mfma_f32_16x16x32_bf16 v[80:83], a[32:35], a[8:11], v[80:83]
ds_read_b64_tr_b16 a[58:59], v14 offset:29184
v_mfma_f32_16x16x32_bf16 v[104:107], a[32:35], a[12:15], v[104:107]
ds_read_b128 a[20:23], v11 offset:2048
v_mfma_f32_16x16x32_bf16 v[36:39], a[36:39], a[0:3], v[36:39]
ds_read_b128 a[24:27], v11 offset:4096
v_mfma_f32_16x16x32_bf16 v[60:63], a[36:39], a[4:7], v[60:63]
ds_read_b128 a[28:31], v11 offset:6144
v_mfma_f32_16x16x32_bf16 v[84:87], a[36:39], a[8:11], v[84:87]
ds_read_b64_tr_b16 a[60:61], v15 offset:28672
v_mfma_f32_16x16x32_bf16 v[108:111], a[36:39], a[12:15], v[108:111]
ds_read_b64_tr_b16 a[62:63], v15 offset:29184
v_mfma_f32_16x16x32_bf16 v[40:43], a[0:3], a[40:43], v[40:43]
ds_read_b64_tr_b16 a[64:65], v14 offset:30720
v_mfma_f32_16x16x32_bf16 v[64:67], a[4:7], a[40:43], v[64:67]
ds_read_b64_tr_b16 a[66:67], v14 offset:31232
v_mfma_f32_16x16x32_bf16 v[88:91], a[8:11], a[40:43], v[88:91]
ds_read_b64_tr_b16 a[68:69], v15 offset:30720
v_mfma_f32_16x16x32_bf16 v[112:115], a[12:15], a[40:43], v[112:115]
ds_read_b64_tr_b16 a[70:71], v15 offset:31232
v_mfma_f32_16x16x32_bf16 v[44:47], a[0:3], a[44:47], v[44:47]
ds_read_b64_tr_b16 a[72:73], v14 offset:32768
v_mfma_f32_16x16x32_bf16 v[68:71], a[4:7], a[44:47], v[68:71]
ds_read_b64_tr_b16 a[74:75], v14 offset:33280
v_mfma_f32_16x16x32_bf16 v[92:95], a[8:11], a[44:47], v[92:95]
ds_read_b64_tr_b16 a[76:77], v15 offset:32768
v_mfma_f32_16x16x32_bf16 v[116:119], a[12:15], a[44:47], v[116:119]
ds_read_b64_tr_b16 a[78:79], v15 offset:33280
v_mfma_f32_16x16x32_bf16 v[48:51], a[0:3], a[48:51], v[48:51]
v_mfma_f32_16x16x32_bf16 v[72:75], a[4:7], a[48:51], v[72:75]
v_mfma_f32_16x16x32_bf16 v[96:99], a[8:11], a[48:51], v[96:99]
v_mfma_f32_16x16x32_bf16 v[120:123], a[12:15], a[48:51], v[120:123]
v_mfma_f32_16x16x32_bf16 v[52:55], a[0:3], a[52:55], v[52:55]
v_mfma_f32_16x16x32_bf16 v[76:79], a[4:7], a[52:55], v[76:79]
v_mfma_f32_16x16x32_bf16 v[100:103], a[8:11], a[52:55], v[100:103]
v_mfma_f32_16x16x32_bf16 v[124:127], a[12:15], a[52:55], v[124:127]
s_waitcnt lgkmcnt(0)
v_mfma_f32_16x16x32_bf16 v[32:35], a[56:59], a[16:19], v[32:35]
s_barrier
ds_read_b128 a[0:3], v8 offset:24576
v_mfma_f32_16x16x32_bf16 v[56:59], a[56:59], a[20:23], v[56:59]
ds_read_b64_tr_b16 a[32:33], v12 offset:40960
v_mfma_f32_16x16x32_bf16 v[80:83], a[56:59], a[24:27], v[80:83]
ds_read_b64_tr_b16 a[34:35], v12 offset:41472
v_mfma_f32_16x16x32_bf16 v[104:107], a[56:59], a[28:31], v[104:107]
ds_read_b128 a[4:7], v8 offset:26624
v_mfma_f32_16x16x32_bf16 v[36:39], a[60:63], a[16:19], v[36:39]
ds_read_b128 a[8:11], v8 offset:28672
v_mfma_f32_16x16x32_bf16 v[60:63], a[60:63], a[20:23], v[60:63]
ds_read_b128 a[12:15], v8 offset:30720
v_mfma_f32_16x16x32_bf16 v[84:87], a[60:63], a[24:27], v[84:87]
s_branch L_over4
L_pad4:
s_branch L_ret4
L_over4:
ds_read_b64_tr_b16 a[36:37], v13 offset:40960
v_mfma_f32_16x16x32_bf16 v[108:111], a[60:63], a[28:31], v[108:111]
ds_read_b64_tr_b16 a[38:39], v13 offset:41472
v_mfma_f32_16x16x32_bf16 v[40:43], a[16:19], a[64:67], v[40:43]
ds_read_b64_tr_b16 a[40:41], v12 offset:43008
v_mfma_f32_16x16x32_bf16 v[64:67], a[20:23], a[64:67], v[64:67]
ds_read_b64_tr_b16 a[42:43], v12 offset:43520
v_mfma_f32_16x16x32_bf16 v[88:91], a[24:27], a[64:67], v[88:91]
ds_read_b64_tr_b16 a[44:45], v13 offset:43008
v_mfma_f32_16x16x32_bf16 v[112:115], a[28:31], a[64:67], v[112:115]
ds_read_b64_tr_b16 a[46:47], v13 offset:43520
v_mfma_f32_16x16x32_bf16 v[44:47], a[16:19], a[68:71], v[44:47]
ds_read_b64_tr_b16 a[48:49], v12 offset:45056
v_mfma_f32_16x16x32_bf16 v[68:71], a[20:23], a[68:71], v[68:71]
ds_read_b64_tr_b16 a[50:51], v12 offset:45568
v_mfma_f32_16x16x32_bf16 v[92:95], a[24:27], a[68:71], v[92:95]
ds_read_b64_tr_b16 a[52:53], v13 offset:45056
v_mfma_f32_16x16x32_bf16 v[116:119], a[28:31], a[68:71], v[116:119]
ds_read_b64_tr_b16 a[54:55], v13 offset:45568
v_mfma_f32_16x16x32_bf16 v[48:51], a[16:19], a[72:75], v[48:51]
v_mfma_f32_16x16x32_bf16 v[72:75], a[20:23], a[72:75], v[72:75]
v_mfma_f32_16x16x32_bf16 v[96:99], a[24:27], a[72:75], v[96:99]
v_mfma_f32_16x16x32_bf16 v[120:123], a[28:31], a[72:75], v[120:123]
v_mfma_f32_16x16x32_bf16 v[52:55], a[16:19], a[76:79], v[52:55]
v_mfma_f32_16x16x32_bf16 v[76:79], a[20:23], a[76:79], v[76:79]
v_mfma_f32_16x16x32_bf16 v[100:103], a[24:27], a[76:79], v[100:103]
v_mfma_f32_16x16x32_bf16 v[124:127], a[28:31], a[76:79], v[124:127]
s_waitcnt lgkmcnt(0)
v_mfma_f32_16x16x32_bf16 v[32:35], a[32:35], a[0:3], v[32:35]
ds_read_b128 a[16:19], v9 offset:24576
v_mfma_f32_16x16x32_bf16 v[56:59], a[32:35], a[4:7], v[56:59]
ds_read_b64_tr_b16 a[56:57], v12 offset:53248
v_mfma_f32_16x16x32_bf16 v[80:83], a[32:35], a[8:11], v[80:83]
ds_read_b64_tr_b16 a[58:59], v12 offset:53760
v_mfma_f32_16x16x32_bf16 v[104:107], a[32:35], a[12:15], v[104:107]
ds_read_b128 a[20:23], v9 offset:26624
v_mfma_f32_16x16x32_bf16 v[36:39], a[36:39], a[0:3], v[36:39]
ds_read_b128 a[24:27], v9 offset:28672
v_mfma_f32_16x16x32_bf16 v[60:63], a[36:39], a[4:7], v[60:63]
ds_read_b128 a[28:31], v9 offset:30720
v_mfma_f32_16x16x32_bf16 v[84:87], a[36:39], a[8:11], v[84:87]
ds_read_b64_tr_b16 a[60:61], v13 offset:53248
v_mfma_f32_16x16x32_bf16 v[108:111], a[36:39], a[12:15], v[108:111]
ds_read_b64_tr_b16 a[62:63], v13 offset:53760
v_mfma_f32_16x16x32_bf16 v[40:43], a[0:3], a[40:43], v[40:43]
ds_read_b64_tr_b16 a[64:65], v12 offset:55296
v_mfma_f32_16x16x32_bf16 v[64:67], a[4:7], a[40:43], v[64:67]
ds_read_b64_tr_b16 a[66:67], v12 offset:55808
v_mfma_f32_16x16x32_bf16 v[88:91], a[8:11], a[40:43], v[88:91]
ds_read_b64_tr_b16 a[68:69], v13 offset:55296
v_mfma_f32_16x16x32_bf16 v[112:115], a[12:15], a[40:43], v[112:115]
ds_read_b64_tr_b16 a[70:71], v13 offset:55808
v_mfma_f32_16x16x32_bf16 v[44:47], a[0:3], a[44:47], v[44:47]
ds_read_b64_tr_b16 a[72:73], v12 offset:57344
v_mfma_f32_16x16x32_bf16 v[68:71], a[4:7], a[44:47], v[68:71]
ds_read_b64_tr_b16 a[74:75], v12 offset:57856
v_mfma_f32_16x16x32_bf16 v[92:95], a[8:11], a[44:47], v[92:95]
ds_read_b64_tr_b16 a[76:77], v13 offset:57344
v_mfma_f32_16x16x32_bf16 v[116:119], a[12:15], a[44:47], v[116:119]
ds_read_b64_tr_b16 a[78:79], v13 offset:57856
v_mfma_f32_16x16x32_bf16 v[48:51], a[0:3], a[48:51], v[48:51]
v_mfma_f32_16x16x32_bf16 v[72:75], a[4:7], a[48:51], v[72:75]
v_mfma_f32_16x16x32_bf16 v[96:99], a[8:11], a[48:51], v[96:99]
v_mfma_f32_16x16x32_bf16 v[120:123], a[12:15], a[48:51], v[120:123]
v_mfma_f32_16x16x32_bf16 v[52:55], a[0:3], a[52:55], v[52:55]
v_mfma_f32_16x16x32_bf16 v[76:79], a[4:7], a[52:55], v[76:79]
v_mfma_f32_16x16x32_bf16 v[100:103], a[8:11], a[52:55], v[100:103]
v_mfma_f32_16x16x32_bf16 v[124:127], a[12:15], a[52:55], v[124:127]
s_waitcnt lgkmcnt(0)
v_mfma_f32_16x16x32_bf16 v[32:35], a[56:59], a[16:19], v[32:35]
s_barrier
ds_read_b128 a[0:3], v10 offset:57344
v_mfma_f32_16x16x32_bf16 v[56:59], a[56:59], a[20:23], v[56:59]
ds_read_b64_tr_b16 a[32:33], v12 offset:0
v_mfma_f32_16x16x32_bf16 v[80:83], a[56:59], a[24:27], v[80:83]
ds_read_b64_tr_b16 a[34:35], v12 offset:512
v_mfma_f32_16x16x32_bf16 v[104:107], a[56:59], a[28:31], v[104:107]
ds_read_b128 a[4:7], v10 offset:59392
v_mfma_f32_16x16x32_bf16 v[36:39], a[60:63], a[16:19], v[36:39]
ds_read_b128 a[8:11], v10 offset:61440
v_mfma_f32_16x16x32_bf16 v[60:63], a[60:63], a[20:23], v[60:63]
ds_read_b128 a[12:15], v10 offset:63488
v_mfma_f32_16x16x32_bf16 v[84:87], a[60:63], a[24:27], v[84:87]
ds_read_b64_tr_b16 a[36:37], v13 offset:0
v_mfma_f32_16x16x32_bf16 v[108:111], a[60:63], a[28:31], v[108:111]
ds_read_b64_tr_b16 a[38:39], v13 offset:512
v_mfma_f32_16x16x32_bf16 v[40:43], a[16:19], a[64:67], v[40:43]
ds_read_b64_tr_b16 a[40:41], v12 offset:2048
v_mfma_f32_16x16x32_bf16 v[64:67], a[20:23], a[64:67], v[64:67]
ds_read_b64_tr_b16 a[42:43], v12 offset:2560
v_mfma_f32_16x16x32_bf16 v[88:91], a[24:27], a[64:67], v[88:91]
ds_read_b64_tr_b16 a[44:45], v13 offset:2048
v_mfma_f32_16x16x32_bf16 v[112:115], a[28:31], a[64:67], v[112:115]
ds_read_b64_tr_b16 a[46:47], v13 offset:2560
v_mfma_f32_16x16x32_bf16 v[44:47], a[16:19], a[68:71], v[44:47]
ds_read_b64_tr_b16 a[48:49], v12 offset:4096
v_mfma_f32_16x16x32_bf16 v[68:71], a[20:23], a[68:71], v[68:71]
ds_read_b64_tr_b16 a[50:51], v12 offset:4608
v_mfma_f32_16x16x32_bf16 v[92:95], a[24:27], a[68:71], v[92:95]
ds_read_b64_tr_b16 a[52:53], v13 offset:4096
v_mfma_f32_16x16x32_bf16 v[116:119], a[28:31], a[68:71], v[116:119]
ds_read_b64_tr_b16 a[54:55], v13 offset:4608
v_mfma_f32_16x16x32_bf16 v[48:51], a[16:19], a[72:75], v[48:51]
v_mfma_f32_16x16x32_bf16 v[72:75], a[20:23], a[72:75], v[72:75]
v_mfma_f32_16x16x32_bf16 v[96:99], a[24:27], a[72:75], v[96:99]
v_mfma_f32_16x16x32_bf16 v[120:123], a[28:31], a[72:75], v[120:123]
v_mfma_f32_16x16x32_bf16 v[52:55], a[16:19], a[76:79], v[52:55]
v_mfma_f32_16x16x32_bf16 v[76:79], a[20:23], a[76:79], v[76:79]
v_mfma_f32_16x16x32_bf16 v[100:103], a[24:27], a[76:79], v[100:103]
v_mfma_f32_16x16x32_bf16 v[124:127], a[28:31], a[76:79], v[124:127]
s_waitcnt lgkmcnt(0)
v_mfma_f32_16x16x32_bf16 v[32:35], a[32:35], a[0:3], v[32:35]
ds_read_b128 a[16:19], v11 offset:57344
v_mfma_f32_16x16x32_bf16 v[56:59], a[32:35], a[4:7], v[56:59]
ds_read_b64_tr_b16 a[56:57], v12 offset:12288
v_mfma_f32_16x16x32_bf16 v[80:83], a[32:35], a[8:11], v[80:83]
ds_read_b64_tr_b16 a[58:59], v12 offset:12800
v_mfma_f32_16x16x32_bf16 v[104:107], a[32:35], a[12:15], v[104:107]
ds_read_b128 a[20:23], v11 offset:59392
v_mfma_f32_16x16x32_bf16 v[36:39], a[36:39], a[0:3], v[36:39]
ds_read_b128 a[24:27], v11 offset:61440
v_mfma_f32_16x16x32_bf16 v[60:63], a[36:39], a[4:7], v[60:63]
ds_read_b128 a[28:31], v11 offset:63488
v_mfma_f32_16x16x32_bf16 v[84:87], a[36:39], a[8:11], v[84:87]
ds_read_b64_tr_b16 a[60:61], v13 offset:12288
v_mfma_f32_16x16x32_bf16 v[108:111], a[36:39], a[12:15], v[108:111]
ds_read_b64_tr_b16 a[62:63], v13 offset:12800
v_mfma_f32_16x16x32_bf16 v[40:43], a[0:3], a[40:43], v[40:43]
ds_read_b64_tr_b16 a[64:65], v12 offset:14336
v_mfma_f32_16x16x32_bf16 v[64:67], a[4:7], a[40:43], v[64:67]
ds_read_b64_tr_b16 a[66:67], v12 offset:14848
v_mfma_f32_16x16x32_bf16 v[88:91], a[8:11], a[40:43], v[88:91]
ds_read_b64_tr_b16 a[68:69], v13 offset:14336
v_mfma_f32_16x16x32_bf16 v[112:115], a[12:15], a[40:43], v[112:115]
ds_read_b64_tr_b16 a[70:71], v13 offset:14848
v_mfma_f32_16x16x32_bf16 v[44:47], a[0:3], a[44:47], v[44:47]
ds_read_b64_tr_b16 a[72:73], v12 offset:16384
v_mfma_f32_16x16x32_bf16 v[68:71], a[4:7], a[44:47], v[68:71]
ds_read_b64_tr_b16 a[74:75], v12 offset:16896
v_mfma_f32_16x16x32_bf16 v[92:95], a[8:11], a[44:47], v[92:95]
ds_read_b64_tr_b16 a[76:77], v13 offset:16384
v_mfma_f32_16x16x32_bf16 v[116:119], a[12:15], a[44:47], v[116:119]
ds_read_b64_tr_b16 a[78:79], v13 offset:16896
v_mfma_f32_16x16x32_bf16 v[48:51], a[0:3], a[48:51], v[48:51]
v_mfma_f32_16x16x32_bf16 v[72:75], a[4:7], a[48:51], v[72:75]
v_mfma_f32_16x16x32_bf16 v[96:99], a[8:11], a[48:51], v[96:99]
v_mfma_f32_16x16x32_bf16 v[120:123], a[12:15], a[48:51], v[120:123]
v_mfma_f32_16x16x32_bf16 v[52:55], a[0:3], a[52:55], v[52:55]
v_mfma_f32_16x16x32_bf16 v[76:79], a[4:7], a[52:55], v[76:79]
v_mfma_f32_16x16x32_bf16 v[100:103], a[8:11], a[52:55], v[100:103]
v_mfma_f32_16x16x32_bf16 v[124:127], a[12:15], a[52:55], v[124:127]
s_waitcnt lgkmcnt(0)
v_mfma_f32_16x16x32_bf16 v[32:35], a[56:59], a[16:19], v[32:35]
s_barrier
ds_read_b128 a[0:3], v10 offset:40960
v_mfma_f32_16x16x32_bf16 v[56:59], a[56:59], a[20:23], v[56:59]
ds_read_b64_tr_b16 a[32:33], v14 offset:16384
v_mfma_f32_16x16x32_bf16 v[80:83], a[56:59], a[24:27], v[80:83]
ds_read_b64_tr_b16 a[34:35], v14 offset:16896
v_mfma_f32_16x16x32_bf16 v[104:107], a[56:59], a[28:31], v[104:107]
ds_read_b128 a[4:7], v10 offset:43008
v_mfma_f32_16x16x32_bf16 v[36:39], a[60:63], a[16:19], v[36:39]
ds_read_b128 a[8:11], v10 offset:45056
v_mfma_f32_16x16x32_bf16 v[60:63], a[60:63], a[20:23], v[60:63]
ds_read_b128 a[12:15], v10 offset:47104
v_mfma_f32_16x16x32_bf16 v[84:87], a[60:63], a[24:27], v[84:87]
ds_read_b64_tr_b16 a[36:37], v15 offset:16384
v_mfma_f32_16x16x32_bf16 v[108:111], a[60:63], a[28:31], v[108:111]
ds_read_b64_tr_b16 a[38:39], v15 offset:16896
v_mfma_f32_16x16x32_bf16 v[40:43], a[16:19], a[64:67], v[40:43]
ds_read_b64_tr_b16 a[40:41], v14 offset:18432
v_mfma_f32_16x16x32_bf16 v[64:67], a[20:23], a[64:67], v[64:67]
ds_read_b64_tr_b16 a[42:43], v14 offset:18944
v_mfma_f32_16x16x32_bf16 v[88:91], a[24:27], a[64:67], v[88:91]
ds_read_b64_tr_b16 a[44:45], v15 offset:18432
v_mfma_f32_16x16x32_bf16 v[112:115], a[28:31], a[64:67], v[112:115]
ds_read_b64_tr_b16 a[46:47], v15 offset:18944
v_mfma_f32_16x16x32_bf16 v[44:47], a[16:19], a[68:71], v[44:47]
ds_read_b64_tr_b16 a[48:49], v14 offset:20480
v_mfma_f32_16x16x32_bf16 v[68:71], a[20:23], a[68:71], v[68:71]
ds_read_b64_tr_b16 a[50:51], v14 offset:20992
v_mfma_f32_16x16x32_bf16 v[92:95], a[24:27], a[68:71], v[92:95]
ds_read_b64_tr_b16 a[52:53], v15 offset:20480
v_mfma_f32_16x16x32_bf16 v[116:119], a[28:31], a[68:71], v[116:119]
ds_read_b64_tr_b16 a[54:55], v15 offset:20992
v_mfma_f32_16x16x32_bf16 v[48:51], a[16:19], a[72:75], v[48:51]
v_mfma_f32_16x16x32_bf16 v[72:75], a[20:23], a[72:75], v[72:75]
v_mfma_f32_16x16x32_bf16 v[96:99], a[24:27], a[72:75], v[96:99]
v_mfma_f32_16x16x32_bf16 v[120:123], a[28:31], a[72:75], v[120:123]
v_mfma_f32_16x16x32_bf16 v[52:55], a[16:19], a[76:79], v[52:55]
v_mfma_f32_16x16x32_bf16 v[76:79], a[20:23], a[76:79], v[76:79]
v_mfma_f32_16x16x32_bf16 v[100:103], a[24:27], a[76:79], v[100:103]
v_mfma_f32_16x16x32_bf16 v[124:127], a[28:31], a[76:79], v[124:127]
s_waitcnt lgkmcnt(0)
v_mfma_f32_16x16x32_bf16 v[32:35], a[32:35], a[0:3], v[32:35]
ds_read_b128 a[16:19], v11 offset:40960
v_mfma_f32_16x16x32_bf16 v[56:59], a[32:35], a[4:7], v[56:59]
ds_read_b64_tr_b16 a[56:57], v14 offset:28672
v_mfma_f32_16x16x32_bf16 v[80:83], a[32:35], a[8:11], v[80:83]
ds_read_b64_tr_b16 a[58:59], v14 offset:29184
v_mfma_f32_16x16x32_bf16 v[104:107], a[32:35], a[12:15], v[104:107]
ds_read_b128 a[20:23], v11 offset:43008
v_mfma_f32_16x16x32_bf16 v[36:39], a[36:39], a[0:3], v[36:39]
ds_read_b128 a[24:27], v11 offset:45056
v_mfma_f32_16x16x32_bf16 v[60:63], a[36:39], a[4:7], v[60:63]
ds_read_b128 a[28:31], v11 offset:47104
v_mfma_f32_16x16x32_bf16 v[84:87], a[36:39], a[8:11], v[84:87]
ds_read_b64_tr_b16 a[60:61], v15 offset:28672
v_mfma_f32_16x16x32_bf16 v[108:111], a[36:39], a[12:15], v[108:111]
ds_read_b64_tr_b16 a[62:63], v15 offset:29184
v_mfma_f32_16x16x32_bf16 v[40:43], a[0:3], a[40:43], v[40:43]
ds_read_b64_tr_b16 a[64:65], v14 offset:30720
v_mfma_f32_16x16x32_bf16 v[64:67], a[4:7], a[40:43], v[64:67]
ds_read_b64_tr_b16 a[66:67], v14 offset:31232
v_mfma_f32_16x16x32_bf16 v[88:91], a[8:11], a[40:43], v[88:91]
ds_read_b64_tr_b16 a[68:69], v15 offset:30720
v_mfma_f32_16x16x32_bf16 v[112:115], a[12:15], a[40:43], v[112:115]
ds_read_b64_tr_b16 a[70:71], v15 offset:31232
v_mfma_f32_16x16x32_bf16 v[44:47], a[0:3], a[44:47], v[44:47]
ds_read_b64_tr_b16 a[72:73], v14 offset:32768
v_mfma_f32_16x16x32_bf16 v[68:71], a[4:7], a[44:47], v[68:71]
ds_read_b64_tr_b16 a[74:75], v14 offset:33280
v_mfma_f32_16x16x32_bf16 v[92:95], a[8:11], a[44:47], v[92:95]
ds_read_b64_tr_b16 a[76:77], v15 offset:32768
v_mfma_f32_16x16x32_bf16 v[116:119], a[12:15], a[44:47], v[116:119]
ds_read_b64_tr_b16 a[78:79], v15 offset:33280
v_mfma_f32_16x16x32_bf16 v[48:51], a[0:3], a[48:51], v[48:51]
v_mfma_f32_16x16x32_bf16 v[72:75], a[4:7], a[48:51], v[72:75]
v_mfma_f32_16x16x32_bf16 v[96:99], a[8:11], a[48:51], v[96:99]
v_mfma_f32_16x16x32_bf16 v[120:123], a[12:15], a[48:51], v[120:123]
v_mfma_f32_16x16x32_bf16 v[52:55], a[0:3], a[52:55], v[52:55]
v_mfma_f32_16x16x32_bf16 v[76:79], a[4:7], a[52:55], v[76:79]
v_mfma_f32_16x16x32_bf16 v[100:103], a[8:11], a[52:55], v[100:103]
v_mfma_f32_16x16x32_bf16 v[124:127], a[12:15], a[52:55], v[124:127]
s_waitcnt lgkmcnt(0)
v_mfma_f32_16x16x32_bf16 v[32:35], a[56:59], a[16:19], v[32:35]
s_barrier
ds_read_b128 a[0:3], v10 offset:0
v_mfma_f32_16x16x32_bf16 v[56:59], a[56:59], a[20:23], v[56:59]
ds_read_b64_tr_b16 a[32:33], v12 offset:40960
v_mfma_f32_16x16x32_bf16 v[80:83], a[56:59], a[24:27], v[80:83]
ds_read_b64_tr_b16 a[34:35], v12 offset:41472
v_mfma_f32_16x16x32_bf16 v[104:107], a[56:59], a[28:31], v[104:107]
ds_read_b128 a[4:7], v10 offset:2048
v_mfma_f32_16x16x32_bf16 v[36:39], a[60:63], a[16:19], v[36:39]
ds_read_b128 a[8:11], v10 offset:4096
v_mfma_f32_16x16x32_bf16 v[60:63], a[60:63], a[20:23], v[60:63]
ds_read_b128 a[12:15], v10 offset:6144
v_mfma_f32_16x16x32_bf16 v[84:87], a[60:63], a[24:27], v[84:87]
ds_read_b64_tr_b16 a[36:37], v13 offset:40960
v_mfma_f32_16x16x32_bf16 v[108:111], a[60:63], a[28:31], v[108:111]
ds_read_b64_tr_b16 a[38:39], v13 offset:41472
v_mfma_f32_16x16x32_bf16 v[40:43], a[16:19], a[64:67], v[40:43]
ds_read_b64_tr_b16 a[40:41], v12 offset:43008
v_mfma_f32_16x16x32_bf16 v[64:67], a[20:23], a[64:67], v[64:67]
ds_read_b64_tr_b16 a[42:43], v12 offset:43520
v_mfma_f32_16x16x32_bf16 v[88:91], a[24:27], a[64:67], v[88:91]
ds_read_b64_tr_b16 a[44:45], v13 offset:43008
v_mfma_f32_16x16x32_bf16 v[112:115], a[28:31], a[64:67], v[112:115]
ds_read_b64_tr_b16 a[46:47], v13 offset:43520
v_mfma_f32_16x16x32_bf16 v[44:47], a[16:19], a[68:71], v[44:47]
ds_read_b64_tr_b16 a[48:49], v12 offset:45056
v_mfma_f32_16x16x32_bf16 v[68:71], a[20:23], a[68:71], v[68:71]
ds_read_b64_tr_b16 a[50:51], v12 offset:45568
v_mfma_f32_16x16x32_bf16 v[92:95], a[24:27], a[68:71], v[92:95]
ds_read_b64_tr_b16 a[52:53], v13 offset:45056
v_mfma_f32_16x16x32_bf16 v[116:119], a[28:31], a[68:71], v[116:119]
ds_read_b64_tr_b16 a[54:55], v13 offset:45568
v_mfma_f32_16x16x32_bf16 v[48:51], a[16:19], a[72:75], v[48:51]
v_mfma_f32_16x16x32_bf16 v[72:75], a[20:23], a[72:75], v[72:75]
v_mfma_f32_16x16x32_bf16 v[96:99], a[24:27], a[72:75], v[96:99]
v_mfma_f32_16x16x32_bf16 v[120:123], a[28:31], a[72:75], v[120:123]
v_mfma_f32_16x16x32_bf16 v[52:55], a[16:19], a[76:79], v[52:55]
v_mfma_f32_16x16x32_bf16 v[76:79], a[20:23], a[76:79], v[76:79]
v_mfma_f32_16x16x32_bf16 v[100:103], a[24:27], a[76:79], v[100:103]
v_mfma_f32_16x16x32_bf16 v[124:127], a[28:31], a[76:79], v[124:127]
s_waitcnt lgkmcnt(0)
v_mfma_f32_16x16x32_bf16 v[32:35], a[32:35], a[0:3], v[32:35]
ds_read_b128 a[16:19], v11 offset:0
v_mfma_f32_16x16x32_bf16 v[56:59], a[32:35], a[4:7], v[56:59]
ds_read_b64_tr_b16 a[56:57], v12 offset:53248
v_mfma_f32_16x16x32_bf16 v[80:83], a[32:35], a[8:11], v[80:83]
ds_read_b64_tr_b16 a[58:59], v12 offset:53760
v_mfma_f32_16x16x32_bf16 v[104:107], a[32:35], a[12:15], v[104:107]
ds_read_b128 a[20:23], v11 offset:2048
v_mfma_f32_16x16x32_bf16 v[36:39], a[36:39], a[0:3], v[36:39]
ds_read_b128 a[24:27], v11 offset:4096
v_mfma_f32_16x16x32_bf16 v[60:63], a[36:39], a[4:7], v[60:63]
ds_read_b128 a[28:31], v11 offset:6144
v_mfma_f32_16x16x32_bf16 v[84:87], a[36:39], a[8:11], v[84:87]
ds_read_b64_tr_b16 a[60:61], v13 offset:53248
v_mfma_f32_16x16x32_bf16 v[108:111], a[36:39], a[12:15], v[108:111]
ds_read_b64_tr_b16 a[62:63], v13 offset:53760
v_mfma_f32_16x16x32_bf16 v[40:43], a[0:3], a[40:43], v[40:43]
ds_read_b64_tr_b16 a[64:65], v12 offset:55296
v_mfma_f32_16x16x32_bf16 v[64:67], a[4:7], a[40:43], v[64:67]
ds_read_b64_tr_b16 a[66:67], v12 offset:55808
v_mfma_f32_16x16x32_bf16 v[88:91], a[8:11], a[40:43], v[88:91]
ds_read_b64_tr_b16 a[68:69], v13 offset:55296
v_mfma_f32_16x16x32_bf16 v[112:115], a[12:15], a[40:43], v[112:115]
ds_read_b64_tr_b16 a[70:71], v13 offset:55808
v_mfma_f32_16x16x32_bf16 v[44:47], a[0:3], a[44:47], v[44:47]
ds_read_b64_tr_b16 a[72:73], v12 offset:57344
v_mfma_f32_16x16x32_bf16 v[68:71], a[4:7], a[44:47], v[68:71]
ds_read_b64_tr_b16 a[74:75], v12 offset:57856
v_mfma_f32_16x16x32_bf16 v[92:95], a[8:11], a[44:47], v[92:95]
ds_read_b64_tr_b16 a[76:77], v13 offset:57344
v_mfma_f32_16x16x32_bf16 v[116:119], a[12:15], a[44:47], v[116:119]
ds_read_b64_tr_b16 a[78:79], v13 offset:57856
v_mfma_f32_16x16x32_bf16 v[48:51], a[0:3], a[48:51], v[48:51]
v_lshrrev_b32 v2, 4, v1
v_lshlrev_b32 v2, 4, v2
s_lshl_b32 s70, s66, 8
s_add_u32 s70, s70, 159744
v_add_u32 v17, s70, v2
v_mfma_f32_16x16x32_bf16 v[72:75], a[4:7], a[48:51], v[72:75]
v_mfma_f32_16x16x32_bf16 v[96:99], a[8:11], a[48:51], v[96:99]
v_and_b32 v2, 15, v1
v_lshlrev_b32 v2, 2, v2
s_lshl_b32 s70, s67, 7
s_add_u32 s70, s70, 160768
v_add_u32 v18, s70, v2
v_mfma_f32_16x16x32_bf16 v[120:123], a[12:15], a[48:51], v[120:123]
v_mfma_f32_16x16x32_bf16 v[52:55], a[0:3], a[52:55], v[52:55]
v_mfma_f32_16x16x32_bf16 v[76:79], a[4:7], a[52:55], v[76:79]
v_mfma_f32_16x16x32_bf16 v[100:103], a[8:11], a[52:55], v[100:103]
v_mfma_f32_16x16x32_bf16 v[124:127], a[12:15], a[52:55], v[124:127]
s_waitcnt lgkmcnt(0)
v_mfma_f32_16x16x32_bf16 v[32:35], a[56:59], a[16:19], v[32:35]
s_barrier
ds_read_b128 a[0:3], v8 offset:24576
v_mfma_f32_16x16x32_bf16 v[56:59], a[56:59], a[20:23], v[56:59]
ds_read_b64_tr_b16 a[32:33], v12 offset:0
v_mfma_f32_16x16x32_bf16 v[80:83], a[56:59], a[24:27], v[80:83]
ds_read_b64_tr_b16 a[34:35], v12 offset:512
v_mfma_f32_16x16x32_bf16 v[104:107], a[56:59], a[28:31], v[104:107]
ds_read_b128 a[4:7], v8 offset:26624
v_mfma_f32_16x16x32_bf16 v[36:39], a[60:63], a[16:19], v[36:39]
ds_read_b128 a[8:11], v8 offset:28672
v_mfma_f32_16x16x32_bf16 v[60:63], a[60:63], a[20:23], v[60:63]
ds_read_b128 a[12:15], v8 offset:30720
v_mfma_f32_16x16x32_bf16 v[84:87], a[60:63], a[24:27], v[84:87]
ds_read_b64_tr_b16 a[36:37], v13 offset:0
v_mfma_f32_16x16x32_bf16 v[108:111], a[60:63], a[28:31], v[108:111]
ds_read_b64_tr_b16 a[38:39], v13 offset:512
v_mfma_f32_16x16x32_bf16 v[40:43], a[16:19], a[64:67], v[40:43]
ds_read_b64_tr_b16 a[40:41], v12 offset:2048
v_mfma_f32_16x16x32_bf16 v[64:67], a[20:23], a[64:67], v[64:67]
ds_read_b64_tr_b16 a[42:43], v12 offset:2560
v_mfma_f32_16x16x32_bf16 v[88:91], a[24:27], a[64:67], v[88:91]
ds_read_b64_tr_b16 a[44:45], v13 offset:2048
v_mfma_f32_16x16x32_bf16 v[112:115], a[28:31], a[64:67], v[112:115]
ds_read_b64_tr_b16 a[46:47], v13 offset:2560
v_mfma_f32_16x16x32_bf16 v[44:47], a[16:19], a[68:71], v[44:47]
ds_read_b64_tr_b16 a[48:49], v12 offset:4096
v_mfma_f32_16x16x32_bf16 v[68:71], a[20:23], a[68:71], v[68:71]
ds_read_b64_tr_b16 a[50:51], v12 offset:4608
v_mfma_f32_16x16x32_bf16 v[92:95], a[24:27], a[68:71], v[92:95]
ds_read_b64_tr_b16 a[52:53], v13 offset:4096
v_mfma_f32_16x16x32_bf16 v[116:119], a[28:31], a[68:71], v[116:119]
ds_read_b64_tr_b16 a[54:55], v13 offset:4608
v_mfma_f32_16x16x32_bf16 v[48:51], a[16:19], a[72:75], v[48:51]
v_mfma_f32_16x16x32_bf16 v[72:75], a[20:23], a[72:75], v[72:75]
v_mfma_f32_16x16x32_bf16 v[96:99], a[24:27], a[72:75], v[96:99]
v_mfma_f32_16x16x32_bf16 v[120:123], a[28:31], a[72:75], v[120:123]
v_mfma_f32_16x16x32_bf16 v[52:55], a[16:19], a[76:79], v[52:55]
v_mfma_f32_16x16x32_bf16 v[76:79], a[20:23], a[76:79], v[76:79]
v_mfma_f32_16x16x32_bf16 v[100:103], a[24:27], a[76:79], v[100:103]
v_mfma_f32_16x16x32_bf16 v[124:127], a[28:31], a[76:79], v[124:127]
s_waitcnt lgkmcnt(0)
v_mfma_f32_16x16x32_bf16 v[32:35], a[32:35], a[0:3], v[32:35]
ds_read_b128 a[16:19], v9 offset:24576
v_mfma_f32_16x16x32_bf16 v[56:59], a[32:35], a[4:7], v[56:59]
ds_read_b64_tr_b16 a[56:57], v12 offset:12288
v_mfma_f32_16x16x32_bf16 v[80:83], a[32:35], a[8:11], v[80:83]
ds_read_b64_tr_b16 a[58:59], v12 offset:12800
v_mfma_f32_16x16x32_bf16 v[104:107], a[32:35], a[12:15], v[104:107]
ds_read_b128 a[20:23], v9 offset:26624
v_mfma_f32_16x16x32_bf16 v[36:39], a[36:39], a[0:3], v[36:39]
ds_read_b128 a[24:27], v9 offset:28672
v_mfma_f32_16x16x32_bf16 v[60:63], a[36:39], a[4:7], v[60:63]
ds_read_b128 a[28:31], v9 offset:30720
v_mfma_f32_16x16x32_bf16 v[84:87], a[36:39], a[8:11], v[84:87]
ds_read_b64_tr_b16 a[60:61], v13 offset:12288
v_mfma_f32_16x16x32_bf16 v[108:111], a[36:39], a[12:15], v[108:111]
ds_read_b64_tr_b16 a[62:63], v13 offset:12800
v_mfma_f32_16x16x32_bf16 v[40:43], a[0:3], a[40:43], v[40:43]
ds_read_b64_tr_b16 a[64:65], v12 offset:14336
v_mfma_f32_16x16x32_bf16 v[64:67], a[4:7], a[40:43], v[64:67]
ds_read_b64_tr_b16 a[66:67], v12 offset:14848
v_mfma_f32_16x16x32_bf16 v[88:91], a[8:11], a[40:43], v[88:91]
ds_read_b64_tr_b16 a[68:69], v13 offset:14336
v_mfma_f32_16x16x32_bf16 v[112:115], a[12:15], a[40:43], v[112:115]
ds_read_b64_tr_b16 a[70:71], v13 offset:14848
v_mfma_f32_16x16x32_bf16 v[44:47], a[0:3], a[44:47], v[44:47]
ds_read_b64_tr_b16 a[72:73], v12 offset:16384
v_mfma_f32_16x16x32_bf16 v[68:71], a[4:7], a[44:47], v[68:71]
ds_read_b64_tr_b16 a[74:75], v12 offset:16896
v_mfma_f32_16x16x32_bf16 v[92:95], a[8:11], a[44:47], v[92:95]
ds_read_b64_tr_b16 a[76:77], v13 offset:16384
v_mfma_f32_16x16x32_bf16 v[116:119], a[12:15], a[44:47], v[116:119]
ds_read_b64_tr_b16 a[78:79], v13 offset:16896
v_mfma_f32_16x16x32_bf16 v[48:51], a[0:3], a[48:51], v[48:51]
v_mfma_f32_16x16x32_bf16 v[72:75], a[4:7], a[48:51], v[72:75]
v_mfma_f32_16x16x32_bf16 v[96:99], a[8:11], a[48:51], v[96:99]
v_mfma_f32_16x16x32_bf16 v[120:123], a[12:15], a[48:51], v[120:123]
v_mfma_f32_16x16x32_bf16 v[52:55], a[0:3], a[52:55], v[52:55]
v_mfma_f32_16x16x32_bf16 v[76:79], a[4:7], a[52:55], v[76:79]
v_mfma_f32_16x16x32_bf16 v[100:103], a[8:11], a[52:55], v[100:103]
v_mfma_f32_16x16x32_bf16 v[124:127], a[12:15], a[52:55], v[124:127]
s_waitcnt lgkmcnt(0)
v_mfma_f32_16x16x32_bf16 v[40:43], a[16:19], a[64:67], v[40:43]
s_barrier
ds_read_b128 v[20:23], v17 offset:0
v_mfma_f32_16x16x32_bf16 v[64:67], a[20:23], a[64:67], v[64:67]
ds_read_b128 v[24:27], v17 offset:512
v_mfma_f32_16x16x32_bf16 v[88:91], a[24:27], a[64:67], v[88:91]
ds_read_b32 v6, v18 offset:256
v_mfma_f32_16x16x32_bf16 v[112:115], a[28:31], a[64:67], v[112:115]
ds_read_b32 v8, v18 offset:320
v_mfma_f32_16x16x32_bf16 v[44:47], a[16:19], a[68:71], v[44:47]
ds_read_b32 v10, v18 offset:512
v_mfma_f32_16x16x32_bf16 v[68:71], a[20:23], a[68:71], v[68:71]
ds_read_b32 v18, v18 offset:576
v_mfma_f32_16x16x32_bf16 v[92:95], a[24:27], a[68:71], v[92:95]
v_mov_b32 v19, 161536
ds_read_b32 v19, v19
v_mfma_f32_16x16x32_bf16 v[116:119], a[28:31], a[68:71], v[116:119]
ds_read_b128 v[128:131], v17 offset:64
v_mfma_f32_16x16x32_bf16 v[48:51], a[16:19], a[72:75], v[48:51]
ds_read_b128 v[132:135], v17 offset:576
v_mfma_f32_16x16x32_bf16 v[72:75], a[20:23], a[72:75], v[72:75]
ds_read_b128 v[136:139], v17 offset:128
v_mfma_f32_16x16x32_bf16 v[96:99], a[24:27], a[72:75], v[96:99]
ds_read_b128 v[140:143], v17 offset:640
v_mfma_f32_16x16x32_bf16 v[120:123], a[28:31], a[72:75], v[120:123]
ds_read_b128 v[144:147], v17 offset:192
v_mfma_f32_16x16x32_bf16 v[52:55], a[16:19], a[76:79], v[52:55]
ds_read_b128 v[148:151], v17 offset:704
v_mfma_f32_16x16x32_bf16 v[76:79], a[20:23], a[76:79], v[76:79]
v_mfma_f32_16x16x32_bf16 v[100:103], a[24:27], a[76:79], v[100:103]
v_mfma_f32_16x16x32_bf16 v[124:127], a[28:31], a[76:79], v[124:127]
v_mfma_f32_16x16x32_bf16 v[32:35], a[56:59], a[16:19], v[32:35]
v_mfma_f32_16x16x32_bf16 v[56:59], a[56:59], a[20:23], v[56:59]
v_mfma_f32_16x16x32_bf16 v[80:83], a[56:59], a[24:27], v[80:83]
v_mfma_f32_16x16x32_bf16 v[104:107], a[56:59], a[28:31], v[104:107]
v_mfma_f32_16x16x32_bf16 v[36:39], a[60:63], a[16:19], v[36:39]
v_mfma_f32_16x16x32_bf16 v[60:63], a[60:63], a[20:23], v[60:63]
v_mfma_f32_16x16x32_bf16 v[84:87], a[60:63], a[24:27], v[84:87]
v_mfma_f32_16x16x32_bf16 v[108:111], a[60:63], a[28:31], v[108:111]
s_waitcnt lgkmcnt(0)
v_readfirstlane_b32 s69, v19
v_pk_mul_f32 v[28:29], v[24:25], s[90:91]
v_pk_mul_f32 v[30:31], v[26:27], s[90:91]
v_pk_fma_f32 v[40:41], v[20:21], v[6:7], v[40:41] op_sel:[0,0,0] op_sel_hi:[1,0,1]
v_pk_fma_f32 v[44:45], v[20:21], v[8:9], v[44:45] op_sel:[0,0,0] op_sel_hi:[1,0,1]
v_pk_fma_f32 v[42:43], v[22:23], v[6:7], v[42:43] op_sel:[0,0,0] op_sel_hi:[1,0,1]
v_pk_fma_f32 v[46:47], v[22:23], v[8:9], v[46:47] op_sel:[0,0,0] op_sel_hi:[1,0,1]
v_pk_mul_f32 v[2:3], v[40:41], v[28:29]
v_pk_mul_f32 v[12:13], v[44:45], v[28:29]
v_pk_mul_f32 v[4:5], v[42:43], v[30:31]
v_pk_mul_f32 v[14:15], v[46:47], v[30:31]
v_pk_fma_f32 v[40:41], v[40:41], v[24:25], s[82:83]
v_pk_fma_f32 v[44:45], v[44:45], v[24:25], s[82:83]
v_pk_fma_f32 v[42:43], v[42:43], v[26:27], s[82:83]
v_pk_fma_f32 v[46:47], v[46:47], v[26:27], s[82:83]
v_exp_f32_e64 v2, v2 clamp
v_exp_f32_e64 v12, v12 clamp
v_exp_f32_e64 v3, v3 clamp
v_exp_f32_e64 v13, v13 clamp
v_exp_f32_e64 v4, v4 clamp
v_exp_f32_e64 v14, v14 clamp
v_exp_f32_e64 v5, v5 clamp
v_exp_f32_e64 v15, v15 clamp
v_pk_add_f32 v[2:3], v[2:3], s[80:81]
v_pk_add_f32 v[12:13], v[12:13], s[80:81]
v_pk_add_f32 v[4:5], v[4:5], s[80:81]
v_pk_add_f32 v[14:15], v[14:15], s[80:81]
v_max_f32 v40, v40, v2
v_max_f32 v44, v44, v12
v_max_f32 v41, v41, v3
v_max_f32 v45, v45, v13
v_max_f32 v42, v42, v4
v_max_f32 v46, v46, v14
v_max_f32 v43, v43, v5
v_max_f32 v47, v47, v15
v_cvt_pk_bf16_f32 v40, v40, v41
v_cvt_pk_bf16_f32 v44, v44, v45
v_cvt_pk_bf16_f32 v41, v42, v43
v_cvt_pk_bf16_f32 v45, v46, v47
v_pk_fma_f32 v[48:49], v[20:21], v[10:11], v[48:49] op_sel:[0,0,0] op_sel_hi:[1,0,1]
v_pk_fma_f32 v[52:53], v[20:21], v[18:19], v[52:53] op_sel:[0,0,0] op_sel_hi:[1,0,1]
v_pk_fma_f32 v[50:51], v[22:23], v[10:11], v[50:51] op_sel:[0,0,0] op_sel_hi:[1,0,1]
v_pk_fma_f32 v[54:55], v[22:23], v[18:19], v[54:55] op_sel:[0,0,0] op_sel_hi:[1,0,1]
v_pk_mul_f32 v[48:49], v[48:49], v[24:25]
v_pk_mul_f32 v[52:53], v[52:53], v[24:25]
v_pk_mul_f32 v[50:51], v[50:51], v[26:27]
v_pk_mul_f32 v[54:55], v[54:55], v[26:27]
v_cvt_pk_bf16_f32 v48, v48, v49
v_cvt_pk_bf16_f32 v52, v52, v53
v_cvt_pk_bf16_f32 v49, v50, v51
v_cvt_pk_bf16_f32 v53, v54, v55
v_pk_mul_f32 v[28:29], v[132:133], s[90:91]
v_pk_mul_f32 v[30:31], v[134:135], s[90:91]
v_pk_fma_f32 v[64:65], v[128:129], v[6:7], v[64:65] op_sel:[0,0,0] op_sel_hi:[1,0,1]
v_pk_fma_f32 v[68:69], v[128:129], v[8:9], v[68:69] op_sel:[0,0,0] op_sel_hi:[1,0,1]
v_pk_fma_f32 v[66:67], v[130:131], v[6:7], v[66:67] op_sel:[0,0,0] op_sel_hi:[1,0,1]
v_pk_fma_f32 v[70:71], v[130:131], v[8:9], v[70:71] op_sel:[0,0,0] op_sel_hi:[1,0,1]
v_pk_mul_f32 v[2:3], v[64:65], v[28:29]
v_pk_mul_f32 v[12:13], v[68:69], v[28:29]
v_pk_mul_f32 v[4:5], v[66:67], v[30:31]
v_pk_mul_f32 v[14:15], v[70:71], v[30:31]
v_pk_fma_f32 v[64:65], v[64:65], v[132:133], s[82:83]
v_pk_fma_f32 v[68:69], v[68:69], v[132:133], s[82:83]
v_pk_fma_f32 v[66:67], v[66:67], v[134:135], s[82:83]
v_pk_fma_f32 v[70:71], v[70:71], v[134:135], s[82:83]
v_exp_f32_e64 v2, v2 clamp
v_exp_f32_e64 v12, v12 clamp
v_exp_f32_e64 v3, v3 clamp
v_exp_f32_e64 v13, v13 clamp
v_exp_f32_e64 v4, v4 clamp
v_exp_f32_e64 v14, v14 clamp
v_exp_f32_e64 v5, v5 clamp
v_exp_f32_e64 v15, v15 clamp
v_pk_add_f32 v[2:3], v[2:3], s[80:81]
v_pk_add_f32 v[12:13], v[12:13], s[80:81]
v_pk_add_f32 v[4:5], v[4:5], s[80:81]
s_branch L_over5
L_pad5:
s_branch L_ret9
L_over5:
v_pk_add_f32 v[14:15], v[14:15], s[80:81]
v_max_f32 v64, v64, v2
v_max_f32 v68, v68, v12
v_max_f32 v65, v65, v3
v_max_f32 v69, v69, v13
v_max_f32 v66, v66, v4
v_max_f32 v70, v70, v14
v_max_f32 v67, v67, v5
v_max_f32 v71, v71, v15
v_cvt_pk_bf16_f32 v42, v64, v65
v_cvt_pk_bf16_f32 v46, v68, v69
v_cvt_pk_bf16_f32 v43, v66, v67
v_cvt_pk_bf16_f32 v47, v70, v71
v_pk_fma_f32 v[72:73], v[128:129], v[10:11], v[72:73] op_sel:[0,0,0] op_sel_hi:[1,0,1]
v_pk_fma_f32 v[76:77], v[128:129], v[18:19], v[76:77] op_sel:[0,0,0] op_sel_hi:[1,0,1]
v_pk_fma_f32 v[74:75], v[130:131], v[10:11], v[74:75] op_sel:[0,0,0] op_sel_hi:[1,0,1]
v_pk_fma_f32 v[78:79], v[130:131], v[18:19], v[78:79] op_sel:[0,0,0] op_sel_hi:[1,0,1]
v_pk_mul_f32 v[72:73], v[72:73], v[132:133]
v_pk_mul_f32 v[76:77], v[76:77], v[132:133]
v_pk_mul_f32 v[74:75], v[74:75], v[134:135]
v_pk_mul_f32 v[78:79], v[78:79], v[134:135]
v_cvt_pk_bf16_f32 v50, v72, v73
v_cvt_pk_bf16_f32 v54, v76, v77
v_cvt_pk_bf16_f32 v51, v74, v75
v_cvt_pk_bf16_f32 v55, v78, v79
s_nop 0
v_mfma_f32_16x16x32_bf16 v[64:67], v[40:43], v[48:51], 0
v_mfma_f32_16x16x32_bf16 v[68:71], v[40:43], v[52:55], 0
v_mfma_f32_16x16x32_bf16 v[20:23], v[40:43], a[80:83], 0
v_mfma_f32_16x16x32_bf16 v[72:75], v[44:47], v[48:51], 0
v_mfma_f32_16x16x32_bf16 v[76:79], v[44:47], v[52:55], 0
v_mfma_f32_16x16x32_bf16 v[24:27], v[44:47], a[80:83], 0
v_pk_mul_f32 v[28:29], v[140:141], s[90:91]
v_pk_mul_f32 v[30:31], v[142:143], s[90:91]
v_pk_fma_f32 v[88:89], v[136:137], v[6:7], v[88:89] op_sel:[0,0,0] op_sel_hi:[1,0,1]
v_pk_fma_f32 v[92:93], v[136:137], v[8:9], v[92:93] op_sel:[0,0,0] op_sel_hi:[1,0,1]
v_pk_fma_f32 v[90:91], v[138:139], v[6:7], v[90:91] op_sel:[0,0,0] op_sel_hi:[1,0,1]
v_pk_fma_f32 v[94:95], v[138:139], v[8:9], v[94:95] op_sel:[0,0,0] op_sel_hi:[1,0,1]
v_pk_mul_f32 v[2:3], v[88:89], v[28:29]
v_pk_mul_f32 v[12:13], v[92:93], v[28:29]
v_pk_mul_f32 v[4:5], v[90:91], v[30:31]
v_pk_mul_f32 v[14:15], v[94:95], v[30:31]
v_pk_fma_f32 v[88:89], v[88:89], v[140:141], s[82:83]
v_pk_fma_f32 v[92:93], v[92:93], v[140:141], s[82:83]
v_pk_fma_f32 v[90:91], v[90:91], v[142:143], s[82:83]
v_pk_fma_f32 v[94:95], v[94:95], v[142:143], s[82:83]
v_exp_f32_e64 v2, v2 clamp
v_exp_f32_e64 v12, v12 clamp
v_exp_f32_e64 v3, v3 clamp
v_exp_f32_e64 v13, v13 clamp
v_exp_f32_e64 v4, v4 clamp
v_exp_f32_e64 v14, v14 clamp
v_exp_f32_e64 v5, v5 clamp
v_exp_f32_e64 v15, v15 clamp
v_pk_add_f32 v[2:3], v[2:3], s[80:81]
v_pk_add_f32 v[12:13], v[12:13], s[80:81]
v_pk_add_f32 v[4:5], v[4:5], s[80:81]
v_pk_add_f32 v[14:15], v[14:15], s[80:81]
v_max_f32 v88, v88, v2
v_max_f32 v92, v92, v12
v_max_f32 v89, v89, v3
v_max_f32 v93, v93, v13
v_max_f32 v90, v90, v4
v_max_f32 v94, v94, v14
v_max_f32 v91, v91, v5
v_max_f32 v95, v95, v15
v_cvt_pk_bf16_f32 v88, v88, v89
v_cvt_pk_bf16_f32 v92, v92, v93
v_cvt_pk_bf16_f32 v89, v90, v91
v_cvt_pk_bf16_f32 v93, v94, v95
v_pk_fma_f32 v[96:97], v[136:137], v[10:11], v[96:97] op_sel:[0,0,0] op_sel_hi:[1,0,1]
v_pk_fma_f32 v[100:101], v[136:137], v[18:19], v[100:101] op_sel:[0,0,0] op_sel_hi:[1,0,1]
v_pk_fma_f32 v[98:99], v[138:139], v[10:11], v[98:99] op_sel:[0,0,0] op_sel_hi:[1,0,1]
v_pk_fma_f32 v[102:103], v[138:139], v[18:19], v[102:103] op_sel:[0,0,0] op_sel_hi:[1,0,1]
v_pk_mul_f32 v[96:97], v[96:97], v[140:141]
v_pk_mul_f32 v[100:101], v[100:101], v[140:141]
v_pk_mul_f32 v[98:99], v[98:99], v[142:143]
v_pk_mul_f32 v[102:103], v[102:103], v[142:143]
v_cvt_pk_bf16_f32 v96, v96, v97
v_cvt_pk_bf16_f32 v100, v100, v101
v_cvt_pk_bf16_f32 v97, v98, v99
v_cvt_pk_bf16_f32 v101, v102, v103
v_pk_mul_f32 v[28:29], v[148:149], s[90:91]
v_pk_mul_f32 v[30:31], v[150:151], s[90:91]
v_pk_fma_f32 v[112:113], v[144:145], v[6:7], v[112:113] op_sel:[0,0,0] op_sel_hi:[1,0,1]
v_pk_fma_f32 v[116:117], v[144:145], v[8:9], v[116:117] op_sel:[0,0,0] op_sel_hi:[1,0,1]
v_pk_fma_f32 v[114:115], v[146:147], v[6:7], v[114:115] op_sel:[0,0,0] op_sel_hi:[1,0,1]
v_pk_fma_f32 v[118:119], v[146:147], v[8:9], v[118:119] op_sel:[0,0,0] op_sel_hi:[1,0,1]
v_pk_mul_f32 v[2:3], v[112:113], v[28:29]
v_pk_mul_f32 v[12:13], v[116:117], v[28:29]
v_pk_mul_f32 v[4:5], v[114:115], v[30:31]
v_pk_mul_f32 v[14:15], v[118:119], v[30:31]
v_pk_fma_f32 v[112:113], v[112:113], v[148:149], s[82:83]
v_pk_fma_f32 v[116:117], v[116:117], v[148:149], s[82:83]
v_pk_fma_f32 v[114:115], v[114:115], v[150:151], s[82:83]
v_pk_fma_f32 v[118:119], v[118:119], v[150:151], s[82:83]
v_exp_f32_e64 v2, v2 clamp
v_exp_f32_e64 v12, v12 clamp
v_exp_f32_e64 v3, v3 clamp
v_exp_f32_e64 v13, v13 clamp
v_exp_f32_e64 v4, v4 clamp
v_exp_f32_e64 v14, v14 clamp
v_exp_f32_e64 v5, v5 clamp
v_exp_f32_e64 v15, v15 clamp
v_pk_add_f32 v[2:3], v[2:3], s[80:81]
v_pk_add_f32 v[12:13], v[12:13], s[80:81]
v_pk_add_f32 v[4:5], v[4:5], s[80:81]
v_pk_add_f32 v[14:15], v[14:15], s[80:81]
v_max_f32 v112, v112, v2
v_max_f32 v116, v116, v12
v_max_f32 v113, v113, v3
v_max_f32 v117, v117, v13
v_max_f32 v114, v114, v4
v_max_f32 v118, v118, v14
v_max_f32 v115, v115, v5
v_max_f32 v119, v119, v15
v_cvt_pk_bf16_f32 v90, v112, v113
v_cvt_pk_bf16_f32 v94, v116, v117
v_cvt_pk_bf16_f32 v91, v114, v115
v_cvt_pk_bf16_f32 v95, v118, v119
v_pk_fma_f32 v[120:121], v[144:145], v[10:11], v[120:121] op_sel:[0,0,0] op_sel_hi:[1,0,1]
v_pk_fma_f32 v[124:125], v[144:145], v[18:19], v[124:125] op_sel:[0,0,0] op_sel_hi:[1,0,1]
v_pk_fma_f32 v[122:123], v[146:147], v[10:11], v[122:123] op_sel:[0,0,0] op_sel_hi:[1,0,1]
v_pk_fma_f32 v[126:127], v[146:147], v[18:19], v[126:127] op_sel:[0,0,0] op_sel_hi:[1,0,1]
v_pk_mul_f32 v[120:121], v[120:121], v[148:149]
v_pk_mul_f32 v[124:125], v[124:125], v[148:149]
v_pk_mul_f32 v[122:123], v[122:123], v[150:151]
v_pk_mul_f32 v[126:127], v[126:127], v[150:151]
v_cvt_pk_bf16_f32 v98, v120, v121
v_cvt_pk_bf16_f32 v102, v124, v125
v_cvt_pk_bf16_f32 v99, v122, v123
v_cvt_pk_bf16_f32 v103, v126, v127
s_nop 0
v_mfma_f32_16x16x32_bf16 v[64:67], v[88:91], v[96:99], v[64:67]
v_mfma_f32_16x16x32_bf16 v[68:71], v[88:91], v[100:103], v[68:71]
v_mfma_f32_16x16x32_bf16 v[20:23], v[88:91], a[80:83], v[20:23]
v_mfma_f32_16x16x32_bf16 v[72:75], v[92:95], v[96:99], v[72:75]
v_mfma_f32_16x16x32_bf16 v[76:79], v[92:95], v[100:103], v[76:79]
v_mfma_f32_16x16x32_bf16 v[24:27], v[92:95], a[80:83], v[24:27]
s_lshl_b32 s70, s60, 11
s_add_u32 s70, s70, 16384
v_add_u32 v2, s70, v16
v_xor_b32 v3, 4096, v2
v_lshrrev_b32 v4, 4, v1
v_lshlrev_b32 v5, 4, v4
v_lshlrev_b32 v4, 5, v4
s_lshl_b32 s70, s60, 6
s_add_u32 s70, s70, 163584
v_add_u32 v5, s70, v5
v_xor_b32 v6, 128, v5
s_lshl_b32 s72, s67, 1
s_add_u32 s72, s72, s66
s_lshl_b32 s72, s72, 10
s_add_u32 s72, s72, s87
s_lshl_b32 s73, s67, 7
s_lshl_b32 s70, s66, 4
s_add_u32 s73, s73, s70
s_add_u32 s73, s73, s87
s_add_u32 s73, s73, 4096
s_mov_b32 s92, 0x00010001
s_mov_b32 s93, 0x00010001
v_mov_b32 v15, s68
s_cmp_eq_u32 s66, 0
s_cbranch_scc0 L_ex1
ds_write_b128 v2, v[68:71]
ds_write_b128 v2, v[76:79] offset:1024
ds_write_b128 v5, v[24:27]
s_waitcnt lgkmcnt(0)
s_barrier
ds_read_b128 v[128:131], v3
ds_read_b128 v[132:135], v3 offset:1024
ds_read_b128 v[136:139], v6
s_waitcnt lgkmcnt(1)
v_pk_add_f32 v[128:129], v[128:129], v[64:65]
v_pk_add_f32 v[130:131], v[130:131], v[66:67]
v_pk_add_f32 v[132:133], v[132:133], v[72:73]
v_pk_add_f32 v[134:135], v[134:135], v[74:75]
s_waitcnt lgkmcnt(0)
v_pk_add_f32 v[136:137], v[136:137], v[20:21]
v_pk_add_f32 v[138:139], v[138:139], v[22:23]
s_branch L_ex_d
L_ex1:
ds_write_b128 v2, v[64:67]
ds_write_b128 v2, v[72:75] offset:1024
ds_write_b128 v5, v[20:23]
s_waitcnt lgkmcnt(0)
s_barrier
ds_read_b128 v[128:131], v3
ds_read_b128 v[132:135], v3 offset:1024
ds_read_b128 v[136:139], v6
s_waitcnt lgkmcnt(1)
v_pk_add_f32 v[128:129], v[128:129], v[68:69]
v_pk_add_f32 v[130:131], v[130:131], v[70:71]
v_pk_add_f32 v[132:133], v[132:133], v[76:77]
v_pk_add_f32 v[134:135], v[134:135], v[78:79]
s_waitcnt lgkmcnt(0)
v_pk_add_f32 v[136:137], v[136:137], v[24:25]
v_pk_add_f32 v[138:139], v[138:139], v[26:27]
L_ex_d:
v_cvt_pk_bf16_f32 v140, v128, v129
v_cvt_pk_bf16_f32 v141, v130, v131
v_cvt_pk_bf16_f32 v142, v132, v133
v_cvt_pk_bf16_f32 v143, v134, v135
v_bfi_b32 v136, s85, v15, v136
v_bfi_b32 v137, s85, v15, v137
v_bfi_b32 v138, s85, v15, v138
v_bfi_b32 v139, s85, v15, v139
s_cmp_eq_u32 s69, 0
s_cbranch_scc1 L_kvp_s
buffer_store_dwordx4 v[140:143], v16, s[12:15], s72 offen
s_mov_b64 exec, s[92:93]
buffer_store_dwordx4 v[136:139], v4, s[12:15], s73 offen
s_mov_b64 exec, -1
L_kvp_d:
s_barrier
v_and_b32 v2, 15, v1
v_lshlrev_b32 v2, 2, v2
s_lshl_b32 s70, s66, 8
s_add_u32 s70, s70, 159744
v_add_u32 v2, s70, v2
v_lshrrev_b32 v3, 4, v1
v_lshlrev_b32 v3, 4, v3
s_lshl_b32 s70, s67, 7
s_add_u32 s70, s70, 160768
v_add_u32 v5, s70, v3
ds_read_b32 v8, v2 offset:0
ds_read_b32 v128, v2 offset:512
ds_read_b32 v10, v2 offset:64
ds_read_b32 v130, v2 offset:576
ds_read_b32 v12, v2 offset:128
ds_read_b32 v132, v2 offset:640
ds_read_b32 v14, v2 offset:192
ds_read_b32 v134, v2 offset:704
ds_read_b128 v[144:147], v5 offset:0
ds_read_b128 v[148:151], v5 offset:64
s_lshl_b32 s70, s67, 11
s_add_u32 s70, s70, 24576
v_add_u32 v17, s70, v16
s_lshl_b32 s70, s67, 6
s_add_u32 s70, s70, 161600
v_add_u32 v18, s70, v3
s_waitcnt lgkmcnt(0)
v_mul_f32 v20, s90, v128
v_mul_f32 v22, s90, v130
v_mul_f32 v4, s90, v132
v_mul_f32 v6, s90, v134
v_pk_fma_f32 v[32:33], v[144:145], v[8:9], v[32:33] op_sel:[0,0,0] op_sel_hi:[1,0,1]
v_pk_fma_f32 v[36:37], v[148:149], v[8:9], v[36:37] op_sel:[0,0,0] op_sel_hi:[1,0,1]
v_pk_fma_f32 v[34:35], v[146:147], v[8:9], v[34:35] op_sel:[0,0,0] op_sel_hi:[1,0,1]
v_pk_fma_f32 v[38:39], v[150:151], v[8:9], v[38:39] op_sel:[0,0,0] op_sel_hi:[1,0,1]
v_pk_mul_f32 v[24:25], v[32:33], v[20:21] op_sel:[0,0] op_sel_hi:[1,0]
v_pk_mul_f32 v[28:29], v[36:37], v[20:21] op_sel:[0,0] op_sel_hi:[1,0]
v_pk_mul_f32 v[26:27], v[34:35], v[20:21] op_sel:[0,0] op_sel_hi:[1,0]
v_pk_mul_f32 v[30:31], v[38:39], v[20:21] op_sel:[0,0] op_sel_hi:[1,0]
v_pk_fma_f32 v[32:33], v[32:33], v[128:129], s[82:83] op_sel:[0,0,0] op_sel_hi:[1,0,1]
v_pk_fma_f32 v[36:37], v[36:37], v[128:129], s[82:83] op_sel:[0,0,0] op_sel_hi:[1,0,1]
v_pk_fma_f32 v[34:35], v[34:35], v[128:129], s[82:83] op_sel:[0,0,0] op_sel_hi:[1,0,1]
v_pk_fma_f32 v[38:39], v[38:39], v[128:129], s[82:83] op_sel:[0,0,0] op_sel_hi:[1,0,1]
v_exp_f32_e64 v24, v24 clamp
v_exp_f32_e64 v28, v28 clamp
v_exp_f32_e64 v25, v25 clamp
v_exp_f32_e64 v29, v29 clamp
v_exp_f32_e64 v26, v26 clamp
v_exp_f32_e64 v30, v30 clamp
v_exp_f32_e64 v27, v27 clamp
v_exp_f32_e64 v31, v31 clamp
v_pk_add_f32 v[24:25], v[24:25], s[80:81]
v_pk_add_f32 v[28:29], v[28:29], s[80:81]
v_pk_add_f32 v[26:27], v[26:27], s[80:81]
v_pk_add_f32 v[30:31], v[30:31], s[80:81]
v_max_f32 v32, v32, v24
v_max_f32 v36, v36, v28
v_max_f32 v33, v33, v25
v_max_f32 v37, v37, v29
v_max_f32 v34, v34, v26
v_max_f32 v38, v38, v30
v_max_f32 v35, v35, v27
v_max_f32 v39, v39, v31
v_cvt_pk_bf16_f32 v32, v32, v33
v_cvt_pk_bf16_f32 v33, v34, v35
v_cvt_pk_bf16_f32 v34, v36, v37
v_cvt_pk_bf16_f32 v35, v38, v39
v_pk_fma_f32 v[56:57], v[144:145], v[10:11], v[56:57] op_sel:[0,0,0] op_sel_hi:[1,0,1]
v_pk_fma_f32 v[60:61], v[148:149], v[10:11], v[60:61] op_sel:[0,0,0] op_sel_hi:[1,0,1]
v_pk_fma_f32 v[58:59], v[146:147], v[10:11], v[58:59] op_sel:[0,0,0] op_sel_hi:[1,0,1]
v_pk_fma_f32 v[62:63], v[150:151], v[10:11], v[62:63] op_sel:[0,0,0] op_sel_hi:[1,0,1]
v_pk_mul_f32 v[24:25], v[56:57], v[22:23] op_sel:[0,0] op_sel_hi:[1,0]
v_pk_mul_f32 v[28:29], v[60:61], v[22:23] op_sel:[0,0] op_sel_hi:[1,0]
v_pk_mul_f32 v[26:27], v[58:59], v[22:23] op_sel:[0,0] op_sel_hi:[1,0]
v_pk_mul_f32 v[30:31], v[62:63], v[22:23] op_sel:[0,0] op_sel_hi:[1,0]
v_pk_fma_f32 v[56:57], v[56:57], v[130:131], s[82:83] op_sel:[0,0,0] op_sel_hi:[1,0,1]
v_pk_fma_f32 v[60:61], v[60:61], v[130:131], s[82:83] op_sel:[0,0,0] op_sel_hi:[1,0,1]
v_pk_fma_f32 v[58:59], v[58:59], v[130:131], s[82:83] op_sel:[0,0,0] op_sel_hi:[1,0,1]
v_pk_fma_f32 v[62:63], v[62:63], v[130:131], s[82:83] op_sel:[0,0,0] op_sel_hi:[1,0,1]
v_exp_f32_e64 v24, v24 clamp
v_exp_f32_e64 v28, v28 clamp
v_exp_f32_e64 v25, v25 clamp
v_exp_f32_e64 v29, v29 clamp
v_exp_f32_e64 v26, v26 clamp
v_exp_f32_e64 v30, v30 clamp
v_exp_f32_e64 v27, v27 clamp
v_exp_f32_e64 v31, v31 clamp
v_pk_add_f32 v[24:25], v[24:25], s[80:81]
v_pk_add_f32 v[28:29], v[28:29], s[80:81]
v_pk_add_f32 v[26:27], v[26:27], s[80:81]
v_pk_add_f32 v[30:31], v[30:31], s[80:81]
v_max_f32 v56, v56, v24
v_max_f32 v60, v60, v28
v_max_f32 v57, v57, v25
v_max_f32 v61, v61, v29
v_max_f32 v58, v58, v26
v_max_f32 v62, v62, v30
v_max_f32 v59, v59, v27
v_max_f32 v63, v63, v31
v_cvt_pk_bf16_f32 v56, v56, v57
v_cvt_pk_bf16_f32 v57, v58, v59
v_cvt_pk_bf16_f32 v58, v60, v61
v_cvt_pk_bf16_f32 v59, v62, v63
v_pk_fma_f32 v[80:81], v[144:145], v[12:13], v[80:81] op_sel:[0,0,0] op_sel_hi:[1,0,1]
v_pk_fma_f32 v[84:85], v[148:149], v[12:13], v[84:85] op_sel:[0,0,0] op_sel_hi:[1,0,1]
v_pk_fma_f32 v[82:83], v[146:147], v[12:13], v[82:83] op_sel:[0,0,0] op_sel_hi:[1,0,1]
v_pk_fma_f32 v[86:87], v[150:151], v[12:13], v[86:87] op_sel:[0,0,0] op_sel_hi:[1,0,1]
v_pk_mul_f32 v[24:25], v[80:81], v[4:5] op_sel:[0,0] op_sel_hi:[1,0]
v_pk_mul_f32 v[28:29], v[84:85], v[4:5] op_sel:[0,0] op_sel_hi:[1,0]
v_pk_mul_f32 v[26:27], v[82:83], v[4:5] op_sel:[0,0] op_sel_hi:[1,0]
v_pk_mul_f32 v[30:31], v[86:87], v[4:5] op_sel:[0,0] op_sel_hi:[1,0]
v_pk_fma_f32 v[80:81], v[80:81], v[132:133], s[82:83] op_sel:[0,0,0] op_sel_hi:[1,0,1]
v_pk_fma_f32 v[84:85], v[84:85], v[132:133], s[82:83] op_sel:[0,0,0] op_sel_hi:[1,0,1]
v_pk_fma_f32 v[82:83], v[82:83], v[132:133], s[82:83] op_sel:[0,0,0] op_sel_hi:[1,0,1]
v_pk_fma_f32 v[86:87], v[86:87], v[132:133], s[82:83] op_sel:[0,0,0] op_sel_hi:[1,0,1]
v_exp_f32_e64 v24, v24 clamp
v_exp_f32_e64 v28, v28 clamp
v_exp_f32_e64 v25, v25 clamp
v_exp_f32_e64 v29, v29 clamp
v_exp_f32_e64 v26, v26 clamp
v_exp_f32_e64 v30, v30 clamp
v_exp_f32_e64 v27, v27 clamp
v_exp_f32_e64 v31, v31 clamp
v_pk_add_f32 v[24:25], v[24:25], s[80:81]
v_pk_add_f32 v[28:29], v[28:29], s[80:81]
v_pk_add_f32 v[26:27], v[26:27], s[80:81]
v_pk_add_f32 v[30:31], v[30:31], s[80:81]
v_max_f32 v80, v80, v24
v_max_f32 v84, v84, v28
v_max_f32 v81, v81, v25
v_max_f32 v85, v85, v29
v_max_f32 v82, v82, v26
v_max_f32 v86, v86, v30
v_max_f32 v83, v83, v27
v_max_f32 v87, v87, v31
v_cvt_pk_bf16_f32 v80, v80, v81
v_cvt_pk_bf16_f32 v81, v82, v83
v_cvt_pk_bf16_f32 v82, v84, v85
v_cvt_pk_bf16_f32 v83, v86, v87
v_pk_fma_f32 v[104:105], v[144:145], v[14:15], v[104:105] op_sel:[0,0,0] op_sel_hi:[1,0,1]
v_pk_fma_f32 v[108:109], v[148:149], v[14:15], v[108:109] op_sel:[0,0,0] op_sel_hi:[1,0,1]
v_pk_fma_f32 v[106:107], v[146:147], v[14:15], v[106:107] op_sel:[0,0,0] op_sel_hi:[1,0,1]
v_pk_fma_f32 v[110:111], v[150:151], v[14:15], v[110:111] op_sel:[0,0,0] op_sel_hi:[1,0,1]
v_pk_mul_f32 v[24:25], v[104:105], v[6:7] op_sel:[0,0] op_sel_hi:[1,0]
v_pk_mul_f32 v[28:29], v[108:109], v[6:7] op_sel:[0,0] op_sel_hi:[1,0]
v_pk_mul_f32 v[26:27], v[106:107], v[6:7] op_sel:[0,0] op_sel_hi:[1,0]
v_pk_mul_f32 v[30:31], v[110:111], v[6:7] op_sel:[0,0] op_sel_hi:[1,0]
v_pk_fma_f32 v[104:105], v[104:105], v[134:135], s[82:83] op_sel:[0,0,0] op_sel_hi:[1,0,1]
v_pk_fma_f32 v[108:109], v[108:109], v[134:135], s[82:83] op_sel:[0,0,0] op_sel_hi:[1,0,1]
v_pk_fma_f32 v[106:107], v[106:107], v[134:135], s[82:83] op_sel:[0,0,0] op_sel_hi:[1,0,1]
v_pk_fma_f32 v[110:111], v[110:111], v[134:135], s[82:83] op_sel:[0,0,0] op_sel_hi:[1,0,1]
v_exp_f32_e64 v24, v24 clamp
v_exp_f32_e64 v28, v28 clamp
v_exp_f32_e64 v25, v25 clamp
v_exp_f32_e64 v29, v29 clamp
v_exp_f32_e64 v26, v26 clamp
v_exp_f32_e64 v30, v30 clamp
v_exp_f32_e64 v27, v27 clamp
v_exp_f32_e64 v31, v31 clamp
v_pk_add_f32 v[24:25], v[24:25], s[80:81]
v_pk_add_f32 v[28:29], v[28:29], s[80:81]
v_pk_add_f32 v[26:27], v[26:27], s[80:81]
v_pk_add_f32 v[30:31], v[30:31], s[80:81]
v_max_f32 v104, v104, v24
v_max_f32 v108, v108, v28
v_max_f32 v105, v105, v25
v_max_f32 v109, v109, v29
v_max_f32 v106, v106, v26
v_max_f32 v110, v110, v30
v_max_f32 v107, v107, v27
v_max_f32 v111, v111, v31
v_cvt_pk_bf16_f32 v104, v104, v105
v_cvt_pk_bf16_f32 v105, v106, v107
v_cvt_pk_bf16_f32 v106, v108, v109
v_cvt_pk_bf16_f32 v107, v110, v111
v_lshrrev_b32 v2, 4, v1
v_bfe_u32 v3, v1, 2, 2
v_lshl_add_u32 v4, v2, 2, v3
v_lshlrev_b32 v5, 7, v4
v_bfe_u32 v4, v4, 1, 2
v_lshl_add_u32 v5, v4, 5, v5
v_and_b32 v4, 3, v1
v_lshl_add_u32 v5, v4, 3, v5
v_add_u32 v8, 28672, v5
v_xor_b32 v9, 32, v8
v_xor_b32 v10, 64, v8
v_xor_b32 v11, 96, v8
v_add_u32 v12, 65536, v8
v_add_u32 v13, 65536, v9
v_add_u32 v14, 65536, v10
v_add_u32 v15, 65536, v11
v_and_b32 v3, 15, v1
v_lshrrev_b32 v4, 1, v3
v_lshrrev_b32 v5, 1, v2
v_xor_b32 v4, v4, v5
v_lshlrev_b32 v4, 4, v4
v_lshl_add_u32 v4, v3, 7, v4
v_and_b32 v5, 1, v2
v_lshl_add_u32 v4, v5, 3, v4
s_lshl_b32 s70, s60, 12
v_add_u32 v20, s70, v4
v_xor_b32 v21, 32, v20
v_xor_b32 v22, 64, v20
v_xor_b32 v23, 96, v20
s_lshl_b32 s74, s64, 18
s_lshl_b32 s70, s60, 16
s_add_u32 s74, s74, s70
s_add_u32 s74, s74, 2097152
v_add_u32 v6, s74, v16
v_add_u32 v19, 32768, v6
s_lshl_b32 s74, s89, 11
s_mov_b32 s24, s74
s_add_u32 s25, s24, 2048
s_and_b32 s25, s25, 0x7fff
s_add_u32 s26, s25, 2048
s_and_b32 s26, s26, 0x7fff
s_add_u32 s27, s26, 2048
s_and_b32 s27, s27, 0x7fff
s_add_u32 s28, s27, 2048
s_and_b32 s28, s28, 0x7fff
s_add_u32 s29, s28, 2048
s_and_b32 s29, s29, 0x7fff
s_add_u32 s30, s29, 2048
s_and_b32 s30, s30, 0x7fff
s_add_u32 s31, s30, 2048
s_and_b32 s31, s31, 0x7fff
s_add_u32 s32, s31, 2048
s_and_b32 s32, s32, 0x7fff
s_add_u32 s33, s32, 2048
s_and_b32 s33, s33, 0x7fff
s_add_u32 s34, s33, 2048
s_and_b32 s34, s34, 0x7fff
s_add_u32 s35, s34, 2048
s_and_b32 s35, s35, 0x7fff
s_add_u32 s36, s35, 2048
s_and_b32 s36, s36, 0x7fff
s_add_u32 s37, s36, 2048
s_and_b32 s37, s37, 0x7fff
s_add_u32 s38, s37, 2048
s_and_b32 s38, s38, 0x7fff
s_add_u32 s39, s38, 2048
s_and_b32 s39, s39, 0x7fff
s_barrier
ds_read_b128 a[0:3], v17
ds_read_b128 a[4:7], v17 offset:1024
ds_read_b128 a[8:11], v18
s_waitcnt lgkmcnt(0)
v_mfma_f32_16x16x32_bf16 v[48:51], a[8:11], v[32:35], 0
v_mfma_f32_16x16x32_bf16 v[40:43], a[0:3], v[32:35], 0
v_mfma_f32_16x16x32_bf16 v[44:47], a[4:7], v[32:35], 0
v_mfma_f32_16x16x32_bf16 v[72:75], a[8:11], v[56:59], 0
v_mfma_f32_16x16x32_bf16 v[64:67], a[0:3], v[56:59], 0
v_mfma_f32_16x16x32_bf16 v[68:71], a[4:7], v[56:59], 0
v_mfma_f32_16x16x32_bf16 v[96:99], a[8:11], v[80:83], 0
v_mfma_f32_16x16x32_bf16 v[88:91], a[0:3], v[80:83], 0
v_mfma_f32_16x16x32_bf16 v[92:95], a[4:7], v[80:83], 0
v_mfma_f32_16x16x32_bf16 v[120:123], a[8:11], v[104:107], 0
v_mfma_f32_16x16x32_bf16 v[112:115], a[0:3], v[104:107], 0
v_mfma_f32_16x16x32_bf16 v[116:119], a[4:7], v[104:107], 0
s_lshr_b32 s71, s65, 1
s_xor_b32 s71, s71, s62
s_xor_b32 s70, s69, 1
s_or_b32 s71, s71, s70
v_add_f32 v48, s80, v48
v_rcp_f32 v48, v48
s_nop 0
v_pk_mul_f32 v[40:41], v[40:41], v[48:49] op_sel_hi:[1,0]
v_pk_mul_f32 v[42:43], v[42:43], v[48:49] op_sel_hi:[1,0]
v_pk_mul_f32 v[44:45], v[44:45], v[48:49] op_sel_hi:[1,0]
v_pk_mul_f32 v[46:47], v[46:47], v[48:49] op_sel_hi:[1,0]
v_cvt_pk_bf16_f32 v52, v40, v41
v_cvt_pk_bf16_f32 v53, v42, v43
v_cvt_pk_bf16_f32 v54, v44, v45
v_cvt_pk_bf16_f32 v55, v46, v47
s_add_u32 s70, s88, 0
s_cmp_eq_u32 s71, 0
s_cbranch_scc1 L_oown0
buffer_store_dwordx4 v[52:55], v16, s[12:15], s70 offen sc1
L_ood0:
v_add_f32 v72, s80, v72
v_rcp_f32 v72, v72
s_nop 0
v_pk_mul_f32 v[64:65], v[64:65], v[72:73] op_sel_hi:[1,0]
v_pk_mul_f32 v[66:67], v[66:67], v[72:73] op_sel_hi:[1,0]
v_pk_mul_f32 v[68:69], v[68:69], v[72:73] op_sel_hi:[1,0]
v_pk_mul_f32 v[70:71], v[70:71], v[72:73] op_sel_hi:[1,0]
v_cvt_pk_bf16_f32 v76, v64, v65
v_cvt_pk_bf16_f32 v77, v66, v67
v_cvt_pk_bf16_f32 v78, v68, v69
v_cvt_pk_bf16_f32 v79, v70, v71
s_add_u32 s70, s88, 32768
s_cmp_eq_u32 s71, 0
s_cbranch_scc1 L_oown1
buffer_store_dwordx4 v[76:79], v16, s[12:15], s70 offen sc1
L_ood1:
v_add_f32 v96, s80, v96
v_rcp_f32 v96, v96
s_nop 0
v_pk_mul_f32 v[88:89], v[88:89], v[96:97] op_sel_hi:[1,0]
v_pk_mul_f32 v[90:91], v[90:91], v[96:97] op_sel_hi:[1,0]
v_pk_mul_f32 v[92:93], v[92:93], v[96:97] op_sel_hi:[1,0]
v_pk_mul_f32 v[94:95], v[94:95], v[96:97] op_sel_hi:[1,0]
v_cvt_pk_bf16_f32 v100, v88, v89
v_cvt_pk_bf16_f32 v101, v90, v91
v_cvt_pk_bf16_f32 v102, v92, v93
v_cvt_pk_bf16_f32 v103, v94, v95
s_add_u32 s70, s88, 65536
s_cmp_eq_u32 s71, 0
s_cbranch_scc1 L_oown2
buffer_store_dwordx4 v[100:103], v16, s[12:15], s70 offen sc1
L_ood2:
v_add_f32 v120, s80, v120
v_rcp_f32 v120, v120
s_nop 0
v_pk_mul_f32 v[112:113], v[112:113], v[120:121] op_sel_hi:[1,0]
v_pk_mul_f32 v[114:115], v[114:115], v[120:121] op_sel_hi:[1,0]
v_pk_mul_f32 v[116:117], v[116:117], v[120:121] op_sel_hi:[1,0]
v_pk_mul_f32 v[118:119], v[118:119], v[120:121] op_sel_hi:[1,0]
v_cvt_pk_bf16_f32 v124, v112, v113
v_cvt_pk_bf16_f32 v125, v114, v115
v_cvt_pk_bf16_f32 v126, v116, v117
v_cvt_pk_bf16_f32 v127, v118, v119
s_add_u32 s70, s88, 98304
s_cmp_eq_u32 s71, 0
s_cbranch_scc1 L_oown3
buffer_store_dwordx4 v[124:127], v16, s[12:15], s70 offen sc1
L_ood3:
v_xor_b32 v7, s76, v7
ds_read_b64 v[26:27], v20 offset:0
ds_read_b64 v[30:31], v21 offset:0
ds_read_b64 v[34:35], v22 offset:0
ds_read_b64 v[38:39], v23 offset:0
ds_read_b64 v[42:43], v20 offset:2048
ds_read_b64 v[46:47], v21 offset:2048
ds_read_b64 v[50:51], v22 offset:2048
ds_read_b64 v[54:55], v23 offset:2048
s_waitcnt lgkmcnt(0)
ds_read_b64_tr_b16 a[0:1], v8 offset:0
ds_read_b64_tr_b16 a[2:3], v8 offset:2048
ds_read_b64_tr_b16 a[4:5], v9 offset:0
ds_read_b64_tr_b16 a[6:7], v9 offset:2048
ds_read_b64_tr_b16 a[8:9], v10 offset:0
ds_read_b64_tr_b16 a[10:11], v10 offset:2048
ds_read_b64_tr_b16 a[12:13], v11 offset:0
ds_read_b64_tr_b16 a[14:15], v11 offset:2048
ds_read_b64_tr_b16 a[16:17], v8 offset:4096
ds_read_b64_tr_b16 a[18:19], v8 offset:6144
ds_read_b64_tr_b16 a[20:21], v9 offset:4096
ds_read_b64_tr_b16 a[22:23], v9 offset:6144
ds_read_b64_tr_b16 a[24:25], v10 offset:4096
ds_read_b64_tr_b16 a[26:27], v10 offset:6144
ds_read_b64_tr_b16 a[28:29], v11 offset:4096
ds_read_b64_tr_b16 a[30:31], v11 offset:6144
v_lshlrev_b32 v24, 16, v26
v_and_b32 v25, 0xffff0000, v26
v_lshlrev_b32 v26, 16, v27
v_and_b32 v27, 0xffff0000, v27
v_lshlrev_b32 v28, 16, v30
v_and_b32 v29, 0xffff0000, v30
v_lshlrev_b32 v30, 16, v31
v_and_b32 v31, 0xffff0000, v31
v_lshlrev_b32 v32, 16, v34
v_and_b32 v33, 0xffff0000, v34
v_lshlrev_b32 v34, 16, v35
v_and_b32 v35, 0xffff0000, v35
v_lshlrev_b32 v36, 16, v38
v_and_b32 v37, 0xffff0000, v38
v_lshlrev_b32 v38, 16, v39
v_and_b32 v39, 0xffff0000, v39
v_lshlrev_b32 v40, 16, v42
v_and_b32 v41, 0xffff0000, v42
v_lshlrev_b32 v42, 16, v43
v_and_b32 v43, 0xffff0000, v43
v_lshlrev_b32 v44, 16, v46
v_and_b32 v45, 0xffff0000, v46
v_lshlrev_b32 v46, 16, v47
v_and_b32 v47, 0xffff0000, v47
v_lshlrev_b32 v48, 16, v50
v_and_b32 v49, 0xffff0000, v50
v_lshlrev_b32 v50, 16, v51
v_and_b32 v51, 0xffff0000, v51
v_lshlrev_b32 v52, 16, v54
v_and_b32 v53, 0xffff0000, v54
v_lshlrev_b32 v54, 16, v55
v_and_b32 v55, 0xffff0000, v55
v_lshrrev_b32 v2, 4, v1
v_lshlrev_b32 v2, 3, v2
v_add_u32 v2, 162048, v2
v_mov_b32 v3, 162176
ds_read_b64 v[136:137], v2 offset:0
ds_read_b64 v[138:139], v2 offset:32
s_branch L_over6
L_pad6:
s_branch L_pad11
L_over6:
ds_read_b64 v[140:141], v2 offset:64
ds_read_b64 v[142:143], v2 offset:96
ds_read_b128 v[148:151], v3
s_waitcnt lgkmcnt(0)
v_add_f32 v148, v148, v149
v_add_f32 v150, v150, v151
v_add_f32 v148, v148, v150
s_nop 0
v_readfirstlane_b32 s84, v148
v_and_b32 v2, 3, v1
v_cmp_eq_u32 vcc, 0, v2
v_mov_b32 v3, 0x3f803f80
s_nop 0
v_cndmask_b32 v3, 0, v3, vcc
v_cmp_eq_u32 vcc, 2, v2
s_nop 1
v_cndmask_b32 v120, v3, v136, vcc
v_cndmask_b32 v121, v3, v137, vcc
v_cndmask_b32 v122, v3, v138, vcc
v_cndmask_b32 v123, v3, v139, vcc
v_cndmask_b32 v124, v3, v140, vcc
v_cndmask_b32 v125, v3, v141, vcc
v_cndmask_b32 v126, v3, v142, vcc
v_cndmask_b32 v127, v3, v143, vcc
v_and_b32 v2, 15, v1
v_lshrrev_b32 v3, 5, v1
v_lshlrev_b32 v4, 4, v2
v_mov_b32 v144, v4
s_lshl_b32 s75, s64, 15
s_lshl_b32 s70, s60, 9
s_add_u32 s75, s75, s70
s_add_u32 s75, s75, 6291456
s_lshl_b32 s70, s65, 11
s_add_u32 s72, s75, s70
s_mov_b32 s92, 0x00f0000f
s_mov_b32 s93, 0xf0000f00
s_mov_b32 s80, 0x22222222
s_mov_b32 s81, 0x22222222
s_mov_b32 s82, 0x44444444
s_mov_b32 s83, 0x44444444
s_mov_b32 s90, 0x88888888
s_mov_b32 s91, 0x88888888
v_and_b32 v2, 31, v1
v_lshlrev_b32 v5, 4, v2
v_lshl_add_u32 v145, v3, 11, v5
s_lshl_b32 s70, s64, 7
s_lshl_b32 s71, s60, 5
s_add_u32 s70, s70, s71
s_add_u32 s87, s70, 6815744
s_sub_u32 s70, 2047, s70
v_sub_u32 v146, s70, v2
s_lshl_b32 s70, s64, 2
s_add_u32 s70, s70, s60
s_lshl_b32 s70, s70, 12
s_lshl_b32 s71, s65, 7
s_add_u32 s70, s70, s71
s_add_u32 s88, s70, 7864320
v_lshrrev_b32 v2, 3, v1
v_and_b32 v3, 7, v1
v_lshlrev_b32 v147, 11, v2
v_lshl_add_u32 v147, v3, 4, v147
buffer_load_dwordx4 v[56:59], v6, s[12:15], s24 offen offset:0 sc1
buffer_load_dwordx4 v[60:63], v19, s[12:15], s24 offen offset:0 sc1
buffer_load_dwordx4 v[64:67], v6, s[12:15], s24 offen offset:1024 sc1
buffer_load_dwordx4 v[68:71], v19, s[12:15], s24 offen offset:1024 sc1
buffer_load_dwordx4 v[72:75], v6, s[12:15], s25 offen offset:0 sc1
buffer_load_dwordx4 v[76:79], v19, s[12:15], s25 offen offset:0 sc1
buffer_load_dwordx4 v[80:83], v6, s[12:15], s25 offen offset:1024 sc1
buffer_load_dwordx4 v[84:87], v19, s[12:15], s25 offen offset:1024 sc1
buffer_load_dwordx4 v[88:91], v6, s[12:15], s26 offen offset:0 sc1
buffer_load_dwordx4 v[92:95], v19, s[12:15], s26 offen offset:0 sc1
buffer_load_dwordx4 v[96:99], v6, s[12:15], s26 offen offset:1024 sc1
buffer_load_dwordx4 v[100:103], v19, s[12:15], s26 offen offset:1024 sc1
s_waitcnt vmcnt(8)
v_max3_u32 v2, v56, v60, v64
v_max_u32 v2, v2, v68
v_cmp_eq_u32 vcc, -1, v2
s_cbranch_vccnz L_o0_rt
L_o0_ok:
s_waitcnt lgkmcnt(8)
v_mfma_f32_16x16x32_bf16 v[24:27], a[0:3], v[56:59], v[24:27]
ds_read_b64_tr_b16 a[32:33], v8 offset:8192
ds_read_b64_tr_b16 a[34:35], v8 offset:10240
v_mfma_f32_16x16x32_bf16 v[40:43], a[0:3], v[60:63], v[40:43]
buffer_load_dwordx4 v[104:107], v6, s[12:15], s27 offen offset:0 sc1
v_mfma_f32_16x16x32_bf16 v[28:31], a[4:7], v[56:59], v[28:31]
ds_read_b64_tr_b16 a[36:37], v9 offset:8192
ds_read_b64_tr_b16 a[38:39], v9 offset:10240
v_mfma_f32_16x16x32_bf16 v[44:47], a[4:7], v[60:63], v[44:47]
buffer_load_dwordx4 v[108:111], v19, s[12:15], s27 offen offset:0 sc1
v_mfma_f32_16x16x32_bf16 v[32:35], a[8:11], v[56:59], v[32:35]
ds_read_b64_tr_b16 a[40:41], v10 offset:8192
ds_read_b64_tr_b16 a[42:43], v10 offset:10240
v_mfma_f32_16x16x32_bf16 v[48:51], a[8:11], v[60:63], v[48:51]
buffer_load_dwordx4 v[112:115], v6, s[12:15], s27 offen offset:1024 sc1
v_mfma_f32_16x16x32_bf16 v[36:39], a[12:15], v[56:59], v[36:39]
ds_read_b64_tr_b16 a[44:45], v11 offset:8192
ds_read_b64_tr_b16 a[46:47], v11 offset:10240
v_mfma_f32_16x16x32_bf16 v[52:55], a[12:15], v[60:63], v[52:55]
buffer_load_dwordx4 v[116:119], v19, s[12:15], s27 offen offset:1024 sc1
s_waitcnt lgkmcnt(8)
v_mfma_f32_16x16x32_bf16 v[24:27], a[16:19], v[64:67], v[24:27]
ds_read_b64_tr_b16 a[0:1], v8 offset:12288
s_waitcnt vmcnt(8)
v_mfma_f32_16x16x32_bf16 v[40:43], a[16:19], v[68:71], v[40:43]
ds_read_b64_tr_b16 a[2:3], v8 offset:14336
v_max3_u32 v2, v72, v76, v80
v_mfma_f32_16x16x32_bf16 v[28:31], a[20:23], v[64:67], v[28:31]
ds_read_b64_tr_b16 a[4:5], v9 offset:12288
v_max_u32 v2, v2, v84
v_mfma_f32_16x16x32_bf16 v[44:47], a[20:23], v[68:71], v[44:47]
ds_read_b64_tr_b16 a[6:7], v9 offset:14336
v_cmp_eq_u32 vcc, -1, v2
v_mfma_f32_16x16x32_bf16 v[32:35], a[24:27], v[64:67], v[32:35]
ds_read_b64_tr_b16 a[8:9], v10 offset:12288
v_mfma_f32_16x16x32_bf16 v[48:51], a[24:27], v[68:71], v[48:51]
ds_read_b64_tr_b16 a[10:11], v10 offset:14336
v_mfma_f32_16x16x32_bf16 v[36:39], a[28:31], v[64:67], v[36:39]
ds_read_b64_tr_b16 a[12:13], v11 offset:12288
ds_read_b64_tr_b16 a[14:15], v11 offset:14336
v_mfma_f32_16x16x32_bf16 v[52:55], a[28:31], v[68:71], v[52:55]
s_cbranch_vccnz L_o1_rt
L_o1_ok:
s_waitcnt lgkmcnt(8)
v_mfma_f32_16x16x32_bf16 v[24:27], a[32:35], v[72:75], v[24:27]
ds_read_b64_tr_b16 a[16:17], v8 offset:16384
ds_read_b64_tr_b16 a[18:19], v8 offset:18432
v_mfma_f32_16x16x32_bf16 v[40:43], a[32:35], v[76:79], v[40:43]
buffer_load_dwordx4 v[56:59], v6, s[12:15], s28 offen offset:0 sc1
v_mfma_f32_16x16x32_bf16 v[28:31], a[36:39], v[72:75], v[28:31]
ds_read_b64_tr_b16 a[20:21], v9 offset:16384
ds_read_b64_tr_b16 a[22:23], v9 offset:18432
v_mfma_f32_16x16x32_bf16 v[44:47], a[36:39], v[76:79], v[44:47]
buffer_load_dwordx4 v[60:63], v19, s[12:15], s28 offen offset:0 sc1
v_mfma_f32_16x16x32_bf16 v[32:35], a[40:43], v[72:75], v[32:35]
ds_read_b64_tr_b16 a[24:25], v10 offset:16384
ds_read_b64_tr_b16 a[26:27], v10 offset:18432
v_mfma_f32_16x16x32_bf16 v[48:51], a[40:43], v[76:79], v[48:51]
buffer_load_dwordx4 v[64:67], v6, s[12:15], s28 offen offset:1024 sc1
v_mfma_f32_16x16x32_bf16 v[36:39], a[44:47], v[72:75], v[36:39]
ds_read_b64_tr_b16 a[28:29], v11 offset:16384
ds_read_b64_tr_b16 a[30:31], v11 offset:18432
v_mfma_f32_16x16x32_bf16 v[52:55], a[44:47], v[76:79], v[52:55]
buffer_load_dwordx4 v[68:71], v19, s[12:15], s28 offen offset:1024 sc1
s_waitcnt lgkmcnt(8)
v_mfma_f32_16x16x32_bf16 v[24:27], a[0:3], v[80:83], v[24:27]
ds_read_b64_tr_b16 a[32:33], v8 offset:20480
s_waitcnt vmcnt(8)
v_mfma_f32_16x16x32_bf16 v[40:43], a[0:3], v[84:87], v[40:43]
ds_read_b64_tr_b16 a[34:35], v8 offset:22528
v_max3_u32 v2, v88, v92, v96
v_mfma_f32_16x16x32_bf16 v[28:31], a[4:7], v[80:83], v[28:31]
ds_read_b64_tr_b16 a[36:37], v9 offset:20480
v_max_u32 v2, v2, v100
v_mfma_f32_16x16x32_bf16 v[44:47], a[4:7], v[84:87], v[44:47]
ds_read_b64_tr_b16 a[38:39], v9 offset:22528
v_cmp_eq_u32 vcc, -1, v2
v_mfma_f32_16x16x32_bf16 v[32:35], a[8:11], v[80:83], v[32:35]
ds_read_b64_tr_b16 a[40:41], v10 offset:20480
v_mfma_f32_16x16x32_bf16 v[48:51], a[8:11], v[84:87], v[48:51]
ds_read_b64_tr_b16 a[42:43], v10 offset:22528
v_mfma_f32_16x16x32_bf16 v[36:39], a[12:15], v[80:83], v[36:39]
ds_read_b64_tr_b16 a[44:45], v11 offset:20480
ds_read_b64_tr_b16 a[46:47], v11 offset:22528
v_mfma_f32_16x16x32_bf16 v[52:55], a[12:15], v[84:87], v[52:55]
s_cbranch_vccnz L_o2_rt
L_o2_ok:
s_waitcnt lgkmcnt(8)
v_mfma_f32_16x16x32_bf16 v[24:27], a[16:19], v[88:91], v[24:27]
ds_read_b64_tr_b16 a[0:1], v8 offset:24576
ds_read_b64_tr_b16 a[2:3], v8 offset:26624
v_mfma_f32_16x16x32_bf16 v[40:43], a[16:19], v[92:95], v[40:43]
buffer_load_dwordx4 v[72:75], v6, s[12:15], s29 offen offset:0 sc1
v_mfma_f32_16x16x32_bf16 v[28:31], a[20:23], v[88:91], v[28:31]
ds_read_b64_tr_b16 a[4:5], v9 offset:24576
ds_read_b64_tr_b16 a[6:7], v9 offset:26624
v_mfma_f32_16x16x32_bf16 v[44:47], a[20:23], v[92:95], v[44:47]
buffer_load_dwordx4 v[76:79], v19, s[12:15], s29 offen offset:0 sc1
v_mfma_f32_16x16x32_bf16 v[32:35], a[24:27], v[88:91], v[32:35]
ds_read_b64_tr_b16 a[8:9], v10 offset:24576
ds_read_b64_tr_b16 a[10:11], v10 offset:26624
v_mfma_f32_16x16x32_bf16 v[48:51], a[24:27], v[92:95], v[48:51]
buffer_load_dwordx4 v[80:83], v6, s[12:15], s29 offen offset:1024 sc1
v_mfma_f32_16x16x32_bf16 v[36:39], a[28:31], v[88:91], v[36:39]
ds_read_b64_tr_b16 a[12:13], v11 offset:24576
ds_read_b64_tr_b16 a[14:15], v11 offset:26624
v_mfma_f32_16x16x32_bf16 v[52:55], a[28:31], v[92:95], v[52:55]
buffer_load_dwordx4 v[84:87], v19, s[12:15], s29 offen offset:1024 sc1
s_waitcnt lgkmcnt(8)
v_mfma_f32_16x16x32_bf16 v[24:27], a[32:35], v[96:99], v[24:27]
ds_read_b64_tr_b16 a[16:17], v8 offset:28672
s_waitcnt vmcnt(8)
v_mfma_f32_16x16x32_bf16 v[40:43], a[32:35], v[100:103], v[40:43]
ds_read_b64_tr_b16 a[18:19], v8 offset:30720
v_max3_u32 v2, v104, v108, v112
v_mfma_f32_16x16x32_bf16 v[28:31], a[36:39], v[96:99], v[28:31]
ds_read_b64_tr_b16 a[20:21], v9 offset:28672
v_max_u32 v2, v2, v116
v_mfma_f32_16x16x32_bf16 v[44:47], a[36:39], v[100:103], v[44:47]
ds_read_b64_tr_b16 a[22:23], v9 offset:30720
v_cmp_eq_u32 vcc, -1, v2
v_mfma_f32_16x16x32_bf16 v[32:35], a[40:43], v[96:99], v[32:35]
ds_read_b64_tr_b16 a[24:25], v10 offset:28672
v_mfma_f32_16x16x32_bf16 v[48:51], a[40:43], v[100:103], v[48:51]
ds_read_b64_tr_b16 a[26:27], v10 offset:30720
v_mfma_f32_16x16x32_bf16 v[36:39], a[44:47], v[96:99], v[36:39]
ds_read_b64_tr_b16 a[28:29], v11 offset:28672
ds_read_b64_tr_b16 a[30:31], v11 offset:30720
v_mfma_f32_16x16x32_bf16 v[52:55], a[44:47], v[100:103], v[52:55]
s_cbranch_vccnz L_o3_rt
L_o3_ok:
s_waitcnt lgkmcnt(8)
v_mfma_f32_16x16x32_bf16 v[24:27], a[0:3], v[104:107], v[24:27]
ds_read_b64_tr_b16 a[32:33], v8 offset:32768
ds_read_b64_tr_b16 a[34:35], v8 offset:34816
v_mfma_f32_16x16x32_bf16 v[40:43], a[0:3], v[108:111], v[40:43]
buffer_load_dwordx4 v[88:91], v6, s[12:15], s30 offen offset:0 sc1
v_mfma_f32_16x16x32_bf16 v[28:31], a[4:7], v[104:107], v[28:31]
ds_read_b64_tr_b16 a[36:37], v9 offset:32768
ds_read_b64_tr_b16 a[38:39], v9 offset:34816
v_mfma_f32_16x16x32_bf16 v[44:47], a[4:7], v[108:111], v[44:47]
buffer_load_dwordx4 v[92:95], v19, s[12:15], s30 offen offset:0 sc1
v_mfma_f32_16x16x32_bf16 v[32:35], a[8:11], v[104:107], v[32:35]
ds_read_b64_tr_b16 a[40:41], v10 offset:32768
ds_read_b64_tr_b16 a[42:43], v10 offset:34816
v_mfma_f32_16x16x32_bf16 v[48:51], a[8:11], v[108:111], v[48:51]
buffer_load_dwordx4 v[96:99], v6, s[12:15], s30 offen offset:1024 sc1
v_mfma_f32_16x16x32_bf16 v[36:39], a[12:15], v[104:107], v[36:39]
ds_read_b64_tr_b16 a[44:45], v11 offset:32768
ds_read_b64_tr_b16 a[46:47], v11 offset:34816
v_mfma_f32_16x16x32_bf16 v[52:55], a[12:15], v[108:111], v[52:55]
buffer_load_dwordx4 v[100:103], v19, s[12:15], s30 offen offset:1024 sc1
s_waitcnt lgkmcnt(8)
v_mfma_f32_16x16x32_bf16 v[24:27], a[16:19], v[112:115], v[24:27]
ds_read_b64_tr_b16 a[0:1], v8 offset:36864
s_waitcnt vmcnt(8)
v_mfma_f32_16x16x32_bf16 v[40:43], a[16:19], v[116:119], v[40:43]
ds_read_b64_tr_b16 a[2:3], v8 offset:38912
v_max3_u32 v2, v56, v60, v64
v_mfma_f32_16x16x32_bf16 v[28:31], a[20:23], v[112:115], v[28:31]
ds_read_b64_tr_b16 a[4:5], v9 offset:36864
v_max_u32 v2, v2, v68
v_mfma_f32_16x16x32_bf16 v[44:47], a[20:23], v[116:119], v[44:47]
ds_read_b64_tr_b16 a[6:7], v9 offset:38912
v_cmp_eq_u32 vcc, -1, v2
v_mfma_f32_16x16x32_bf16 v[32:35], a[24:27], v[112:115], v[32:35]
ds_read_b64_tr_b16 a[8:9], v10 offset:36864
v_mfma_f32_16x16x32_bf16 v[48:51], a[24:27], v[116:119], v[48:51]
ds_read_b64_tr_b16 a[10:11], v10 offset:38912
v_mfma_f32_16x16x32_bf16 v[36:39], a[28:31], v[112:115], v[36:39]
ds_read_b64_tr_b16 a[12:13], v11 offset:36864
ds_read_b64_tr_b16 a[14:15], v11 offset:38912
v_mfma_f32_16x16x32_bf16 v[52:55], a[28:31], v[116:119], v[52:55]
s_cbranch_vccnz L_o4_rt
L_o4_ok:
s_waitcnt lgkmcnt(8)
v_mfma_f32_16x16x32_bf16 v[24:27], a[32:35], v[56:59], v[24:27]
ds_read_b64_tr_b16 a[16:17], v8 offset:40960
ds_read_b64_tr_b16 a[18:19], v8 offset:43008
v_mfma_f32_16x16x32_bf16 v[40:43], a[32:35], v[60:63], v[40:43]
buffer_load_dwordx4 v[104:107], v6, s[12:15], s31 offen offset:0 sc1
v_mfma_f32_16x16x32_bf16 v[28:31], a[36:39], v[56:59], v[28:31]
ds_read_b64_tr_b16 a[20:21], v9 offset:40960
ds_read_b64_tr_b16 a[22:23], v9 offset:43008
v_mfma_f32_16x16x32_bf16 v[44:47], a[36:39], v[60:63], v[44:47]
buffer_load_dwordx4 v[108:111], v19, s[12:15], s31 offen offset:0 sc1
v_mfma_f32_16x16x32_bf16 v[32:35], a[40:43], v[56:59], v[32:35]
ds_read_b64_tr_b16 a[24:25], v10 offset:40960
ds_read_b64_tr_b16 a[26:27], v10 offset:43008
v_mfma_f32_16x16x32_bf16 v[48:51], a[40:43], v[60:63], v[48:51]
buffer_load_dwordx4 v[112:115], v6, s[12:15], s31 offen offset:1024 sc1
v_mfma_f32_16x16x32_bf16 v[36:39], a[44:47], v[56:59], v[36:39]
ds_read_b64_tr_b16 a[28:29], v11 offset:40960
ds_read_b64_tr_b16 a[30:31], v11 offset:43008
v_mfma_f32_16x16x32_bf16 v[52:55], a[44:47], v[60:63], v[52:55]
buffer_load_dwordx4 v[116:119], v19, s[12:15], s31 offen offset:1024 sc1
s_waitcnt lgkmcnt(8)
v_mfma_f32_16x16x32_bf16 v[24:27], a[0:3], v[64:67], v[24:27]
ds_read_b64_tr_b16 a[32:33], v8 offset:45056
s_waitcnt vmcnt(8)
v_mfma_f32_16x16x32_bf16 v[40:43], a[0:3], v[68:71], v[40:43]
ds_read_b64_tr_b16 a[34:35], v8 offset:47104
v_max3_u32 v2, v72, v76, v80
v_mfma_f32_16x16x32_bf16 v[28:31], a[4:7], v[64:67], v[28:31]
ds_read_b64_tr_b16 a[36:37], v9 offset:45056
v_max_u32 v2, v2, v84
v_mfma_f32_16x16x32_bf16 v[44:47], a[4:7], v[68:71], v[44:47]
ds_read_b64_tr_b16 a[38:39], v9 offset:47104
v_cmp_eq_u32 vcc, -1, v2
v_mfma_f32_16x16x32_bf16 v[32:35], a[8:11], v[64:67], v[32:35]
ds_read_b64_tr_b16 a[40:41], v10 offset:45056
v_mfma_f32_16x16x32_bf16 v[48:51], a[8:11], v[68:71], v[48:51]
ds_read_b64_tr_b16 a[42:43], v10 offset:47104
v_mfma_f32_16x16x32_bf16 v[36:39], a[12:15], v[64:67], v[36:39]
ds_read_b64_tr_b16 a[44:45], v11 offset:45056
ds_read_b64_tr_b16 a[46:47], v11 offset:47104
v_mfma_f32_16x16x32_bf16 v[52:55], a[12:15], v[68:71], v[52:55]
s_cbranch_vccnz L_o5_rt
L_o5_ok:
s_waitcnt lgkmcnt(8)
v_mfma_f32_16x16x32_bf16 v[24:27], a[16:19], v[72:75], v[24:27]
ds_read_b64_tr_b16 a[0:1], v8 offset:49152
ds_read_b64_tr_b16 a[2:3], v8 offset:51200
v_mfma_f32_16x16x32_bf16 v[40:43], a[16:19], v[76:79], v[40:43]
buffer_load_dwordx4 v[56:59], v6, s[12:15], s32 offen offset:0 sc1
v_mfma_f32_16x16x32_bf16 v[28:31], a[20:23], v[72:75], v[28:31]
ds_read_b64_tr_b16 a[4:5], v9 offset:49152
ds_read_b64_tr_b16 a[6:7], v9 offset:51200
v_mfma_f32_16x16x32_bf16 v[44:47], a[20:23], v[76:79], v[44:47]
buffer_load_dwordx4 v[60:63], v19, s[12:15], s32 offen offset:0 sc1
v_mfma_f32_16x16x32_bf16 v[32:35], a[24:27], v[72:75], v[32:35]
ds_read_b64_tr_b16 a[8:9], v10 offset:49152
ds_read_b64_tr_b16 a[10:11], v10 offset:51200
v_mfma_f32_16x16x32_bf16 v[48:51], a[24:27], v[76:79], v[48:51]
buffer_load_dwordx4 v[64:67], v6, s[12:15], s32 offen offset:1024 sc1
v_mfma_f32_16x16x32_bf16 v[36:39], a[28:31], v[72:75], v[36:39]
ds_read_b64_tr_b16 a[12:13], v11 offset:49152
ds_read_b64_tr_b16 a[14:15], v11 offset:51200
v_mfma_f32_16x16x32_bf16 v[52:55], a[28:31], v[76:79], v[52:55]
buffer_load_dwordx4 v[68:71], v19, s[12:15], s32 offen offset:1024 sc1
s_waitcnt lgkmcnt(8)
v_mfma_f32_16x16x32_bf16 v[24:27], a[32:35], v[80:83], v[24:27]
ds_read_b64_tr_b16 a[16:17], v8 offset:53248
s_waitcnt vmcnt(8)
v_mfma_f32_16x16x32_bf16 v[40:43], a[32:35], v[84:87], v[40:43]
ds_read_b64_tr_b16 a[18:19], v8 offset:55296
v_max3_u32 v2, v88, v92, v96
v_mfma_f32_16x16x32_bf16 v[28:31], a[36:39], v[80:83], v[28:31]
ds_read_b64_tr_b16 a[20:21], v9 offset:53248
v_max_u32 v2, v2, v100
v_mfma_f32_16x16x32_bf16 v[44:47], a[36:39], v[84:87], v[44:47]
ds_read_b64_tr_b16 a[22:23], v9 offset:55296
v_cmp_eq_u32 vcc, -1, v2
v_mfma_f32_16x16x32_bf16 v[32:35], a[40:43], v[80:83], v[32:35]
ds_read_b64_tr_b16 a[24:25], v10 offset:53248
v_mfma_f32_16x16x32_bf16 v[48:51], a[40:43], v[84:87], v[48:51]
ds_read_b64_tr_b16 a[26:27], v10 offset:55296
v_mfma_f32_16x16x32_bf16 v[36:39], a[44:47], v[80:83], v[36:39]
ds_read_b64_tr_b16 a[28:29], v11 offset:53248
ds_read_b64_tr_b16 a[30:31], v11 offset:55296
v_mfma_f32_16x16x32_bf16 v[52:55], a[44:47], v[84:87], v[52:55]
s_cbranch_vccnz L_o6_rt
L_o6_ok:
s_waitcnt lgkmcnt(8)
v_mfma_f32_16x16x32_bf16 v[24:27], a[0:3], v[88:91], v[24:27]
ds_read_b64_tr_b16 a[32:33], v8 offset:57344
ds_read_b64_tr_b16 a[34:35], v8 offset:59392
v_mfma_f32_16x16x32_bf16 v[40:43], a[0:3], v[92:95], v[40:43]
buffer_load_dwordx4 v[72:75], v6, s[12:15], s33 offen offset:0 sc1
v_mfma_f32_16x16x32_bf16 v[28:31], a[4:7], v[88:91], v[28:31]
ds_read_b64_tr_b16 a[36:37], v9 offset:57344
ds_read_b64_tr_b16 a[38:39], v9 offset:59392
v_mfma_f32_16x16x32_bf16 v[44:47], a[4:7], v[92:95], v[44:47]
buffer_load_dwordx4 v[76:79], v19, s[12:15], s33 offen offset:0 sc1
v_mfma_f32_16x16x32_bf16 v[32:35], a[8:11], v[88:91], v[32:35]
ds_read_b64_tr_b16 a[40:41], v10 offset:57344
ds_read_b64_tr_b16 a[42:43], v10 offset:59392
v_mfma_f32_16x16x32_bf16 v[48:51], a[8:11], v[92:95], v[48:51]
buffer_load_dwordx4 v[80:83], v6, s[12:15], s33 offen offset:1024 sc1
v_mfma_f32_16x16x32_bf16 v[36:39], a[12:15], v[88:91], v[36:39]
ds_read_b64_tr_b16 a[44:45], v11 offset:57344
ds_read_b64_tr_b16 a[46:47], v11 offset:59392
v_mfma_f32_16x16x32_bf16 v[52:55], a[12:15], v[92:95], v[52:55]
buffer_load_dwordx4 v[84:87], v19, s[12:15], s33 offen offset:1024 sc1
s_waitcnt lgkmcnt(8)
v_mfma_f32_16x16x32_bf16 v[24:27], a[16:19], v[96:99], v[24:27]
ds_read_b64_tr_b16 a[0:1], v8 offset:61440
s_waitcnt vmcnt(8)
v_mfma_f32_16x16x32_bf16 v[40:43], a[16:19], v[100:103], v[40:43]
ds_read_b64_tr_b16 a[2:3], v8 offset:63488
v_max3_u32 v2, v104, v108, v112
v_mfma_f32_16x16x32_bf16 v[28:31], a[20:23], v[96:99], v[28:31]
ds_read_b64_tr_b16 a[4:5], v9 offset:61440
v_max_u32 v2, v2, v116
v_mfma_f32_16x16x32_bf16 v[44:47], a[20:23], v[100:103], v[44:47]
ds_read_b64_tr_b16 a[6:7], v9 offset:63488
v_cmp_eq_u32 vcc, -1, v2
v_mfma_f32_16x16x32_bf16 v[32:35], a[24:27], v[96:99], v[32:35]
ds_read_b64_tr_b16 a[8:9], v10 offset:61440
v_mfma_f32_16x16x32_bf16 v[48:51], a[24:27], v[100:103], v[48:51]
ds_read_b64_tr_b16 a[10:11], v10 offset:63488
v_mfma_f32_16x16x32_bf16 v[36:39], a[28:31], v[96:99], v[36:39]
ds_read_b64_tr_b16 a[12:13], v11 offset:61440
ds_read_b64_tr_b16 a[14:15], v11 offset:63488
v_mfma_f32_16x16x32_bf16 v[52:55], a[28:31], v[100:103], v[52:55]
s_cbranch_vccnz L_o7_rt
L_o7_ok:
s_waitcnt lgkmcnt(8)
v_mfma_f32_16x16x32_bf16 v[24:27], a[32:35], v[104:107], v[24:27]
ds_read_b64_tr_b16 a[16:17], v12 offset:0
ds_read_b64_tr_b16 a[18:19], v12 offset:2048
v_mfma_f32_16x16x32_bf16 v[40:43], a[32:35], v[108:111], v[40:43]
buffer_load_dwordx4 v[88:91], v6, s[12:15], s34 offen offset:0 sc1
v_mfma_f32_16x16x32_bf16 v[28:31], a[36:39], v[104:107], v[28:31]
ds_read_b64_tr_b16 a[20:21], v13 offset:0
ds_read_b64_tr_b16 a[22:23], v13 offset:2048
v_mfma_f32_16x16x32_bf16 v[44:47], a[36:39], v[108:111], v[44:47]
buffer_load_dwordx4 v[92:95], v19, s[12:15], s34 offen offset:0 sc1
v_mfma_f32_16x16x32_bf16 v[32:35], a[40:43], v[104:107], v[32:35]
ds_read_b64_tr_b16 a[24:25], v14 offset:0
ds_read_b64_tr_b16 a[26:27], v14 offset:2048
v_mfma_f32_16x16x32_bf16 v[48:51], a[40:43], v[108:111], v[48:51]
buffer_load_dwordx4 v[96:99], v6, s[12:15], s34 offen offset:1024 sc1
v_mfma_f32_16x16x32_bf16 v[36:39], a[44:47], v[104:107], v[36:39]
ds_read_b64_tr_b16 a[28:29], v15 offset:0
ds_read_b64_tr_b16 a[30:31], v15 offset:2048
v_mfma_f32_16x16x32_bf16 v[52:55], a[44:47], v[108:111], v[52:55]
buffer_load_dwordx4 v[100:103], v19, s[12:15], s34 offen offset:1024 sc1
s_waitcnt lgkmcnt(8)
v_mfma_f32_16x16x32_bf16 v[24:27], a[0:3], v[112:115], v[24:27]
ds_read_b64_tr_b16 a[32:33], v12 offset:4096
s_waitcnt vmcnt(8)
v_mfma_f32_16x16x32_bf16 v[40:43], a[0:3], v[116:119], v[40:43]
ds_read_b64_tr_b16 a[34:35], v12 offset:6144
v_max3_u32 v2, v56, v60, v64
v_mfma_f32_16x16x32_bf16 v[28:31], a[4:7], v[112:115], v[28:31]
ds_read_b64_tr_b16 a[36:37], v13 offset:4096
v_max_u32 v2, v2, v68
v_mfma_f32_16x16x32_bf16 v[44:47], a[4:7], v[116:119], v[44:47]
ds_read_b64_tr_b16 a[38:39], v13 offset:6144
v_cmp_eq_u32 vcc, -1, v2
v_mfma_f32_16x16x32_bf16 v[32:35], a[8:11], v[112:115], v[32:35]
ds_read_b64_tr_b16 a[40:41], v14 offset:4096
v_mfma_f32_16x16x32_bf16 v[48:51], a[8:11], v[116:119], v[48:51]
ds_read_b64_tr_b16 a[42:43], v14 offset:6144
v_mfma_f32_16x16x32_bf16 v[36:39], a[12:15], v[112:115], v[36:39]
ds_read_b64_tr_b16 a[44:45], v15 offset:4096
ds_read_b64_tr_b16 a[46:47], v15 offset:6144
v_mfma_f32_16x16x32_bf16 v[52:55], a[12:15], v[116:119], v[52:55]
s_cbranch_vccnz L_o8_rt
L_o8_ok:
s_waitcnt lgkmcnt(8)
v_mfma_f32_16x16x32_bf16 v[24:27], a[16:19], v[56:59], v[24:27]
ds_read_b64_tr_b16 a[0:1], v12 offset:8192
ds_read_b64_tr_b16 a[2:3], v12 offset:10240
v_mfma_f32_16x16x32_bf16 v[40:43], a[16:19], v[60:63], v[40:43]
buffer_load_dwordx4 v[104:107], v6, s[12:15], s35 offen offset:0 sc1
v_mfma_f32_16x16x32_bf16 v[28:31], a[20:23], v[56:59], v[28:31]
ds_read_b64_tr_b16 a[4:5], v13 offset:8192
ds_read_b64_tr_b16 a[6:7], v13 offset:10240
v_mfma_f32_16x16x32_bf16 v[44:47], a[20:23], v[60:63], v[44:47]
buffer_load_dwordx4 v[108:111], v19, s[12:15], s35 offen offset:0 sc1
v_mfma_f32_16x16x32_bf16 v[32:35], a[24:27], v[56:59], v[32:35]
ds_read_b64_tr_b16 a[8:9], v14 offset:8192
ds_read_b64_tr_b16 a[10:11], v14 offset:10240
v_mfma_f32_16x16x32_bf16 v[48:51], a[24:27], v[60:63], v[48:51]
buffer_load_dwordx4 v[112:115], v6, s[12:15], s35 offen offset:1024 sc1
v_mfma_f32_16x16x32_bf16 v[36:39], a[28:31], v[56:59], v[36:39]
ds_read_b64_tr_b16 a[12:13], v15 offset:8192
ds_read_b64_tr_b16 a[14:15], v15 offset:10240
v_mfma_f32_16x16x32_bf16 v[52:55], a[28:31], v[60:63], v[52:55]
buffer_load_dwordx4 v[116:119], v19, s[12:15], s35 offen offset:1024 sc1
s_waitcnt lgkmcnt(8)
v_mfma_f32_16x16x32_bf16 v[24:27], a[32:35], v[64:67], v[24:27]
ds_read_b64_tr_b16 a[16:17], v12 offset:12288
s_waitcnt vmcnt(8)
v_mfma_f32_16x16x32_bf16 v[40:43], a[32:35], v[68:71], v[40:43]
ds_read_b64_tr_b16 a[18:19], v12 offset:14336
v_max3_u32 v2, v72, v76, v80
v_mfma_f32_16x16x32_bf16 v[28:31], a[36:39], v[64:67], v[28:31]
ds_read_b64_tr_b16 a[20:21], v13 offset:12288
v_max_u32 v2, v2, v84
v_mfma_f32_16x16x32_bf16 v[44:47], a[36:39], v[68:71], v[44:47]
ds_read_b64_tr_b16 a[22:23], v13 offset:14336
v_cmp_eq_u32 vcc, -1, v2
v_mfma_f32_16x16x32_bf16 v[32:35], a[40:43], v[64:67], v[32:35]
ds_read_b64_tr_b16 a[24:25], v14 offset:12288
v_mfma_f32_16x16x32_bf16 v[48:51], a[40:43], v[68:71], v[48:51]
ds_read_b64_tr_b16 a[26:27], v14 offset:14336
v_mfma_f32_16x16x32_bf16 v[36:39], a[44:47], v[64:67], v[36:39]
ds_read_b64_tr_b16 a[28:29], v15 offset:12288
ds_read_b64_tr_b16 a[30:31], v15 offset:14336
v_mfma_f32_16x16x32_bf16 v[52:55], a[44:47], v[68:71], v[52:55]
s_cbranch_vccnz L_o9_rt
L_o9_ok:
s_waitcnt lgkmcnt(8)
v_mfma_f32_16x16x32_bf16 v[24:27], a[0:3], v[72:75], v[24:27]
ds_read_b64_tr_b16 a[32:33], v12 offset:16384
ds_read_b64_tr_b16 a[34:35], v12 offset:18432
v_mfma_f32_16x16x32_bf16 v[40:43], a[0:3], v[76:79], v[40:43]
buffer_load_dwordx4 v[56:59], v6, s[12:15], s36 offen offset:0 sc1
v_mfma_f32_16x16x32_bf16 v[28:31], a[4:7], v[72:75], v[28:31]
ds_read_b64_tr_b16 a[36:37], v13 offset:16384
ds_read_b64_tr_b16 a[38:39], v13 offset:18432
v_mfma_f32_16x16x32_bf16 v[44:47], a[4:7], v[76:79], v[44:47]
buffer_load_dwordx4 v[60:63], v19, s[12:15], s36 offen offset:0 sc1
v_mfma_f32_16x16x32_bf16 v[32:35], a[8:11], v[72:75], v[32:35]
ds_read_b64_tr_b16 a[40:41], v14 offset:16384
ds_read_b64_tr_b16 a[42:43], v14 offset:18432
v_mfma_f32_16x16x32_bf16 v[48:51], a[8:11], v[76:79], v[48:51]
buffer_load_dwordx4 v[64:67], v6, s[12:15], s36 offen offset:1024 sc1
v_mfma_f32_16x16x32_bf16 v[36:39], a[12:15], v[72:75], v[36:39]
ds_read_b64_tr_b16 a[44:45], v15 offset:16384
ds_read_b64_tr_b16 a[46:47], v15 offset:18432
v_mfma_f32_16x16x32_bf16 v[52:55], a[12:15], v[76:79], v[52:55]
buffer_load_dwordx4 v[68:71], v19, s[12:15], s36 offen offset:1024 sc1
s_waitcnt lgkmcnt(8)
v_mfma_f32_16x16x32_bf16 v[24:27], a[16:19], v[80:83], v[24:27]
ds_read_b64_tr_b16 a[0:1], v12 offset:20480
s_waitcnt vmcnt(8)
v_mfma_f32_16x16x32_bf16 v[40:43], a[16:19], v[84:87], v[40:43]
ds_read_b64_tr_b16 a[2:3], v12 offset:22528
v_max3_u32 v2, v88, v92, v96
v_mfma_f32_16x16x32_bf16 v[28:31], a[20:23], v[80:83], v[28:31]
ds_read_b64_tr_b16 a[4:5], v13 offset:20480
v_max_u32 v2, v2, v100
v_mfma_f32_16x16x32_bf16 v[44:47], a[20:23], v[84:87], v[44:47]
ds_read_b64_tr_b16 a[6:7], v13 offset:22528
v_cmp_eq_u32 vcc, -1, v2
v_mfma_f32_16x16x32_bf16 v[32:35], a[24:27], v[80:83], v[32:35]
ds_read_b64_tr_b16 a[8:9], v14 offset:20480
v_mfma_f32_16x16x32_bf16 v[48:51], a[24:27], v[84:87], v[48:51]
ds_read_b64_tr_b16 a[10:11], v14 offset:22528
v_mfma_f32_16x16x32_bf16 v[36:39], a[28:31], v[80:83], v[36:39]
ds_read_b64_tr_b16 a[12:13], v15 offset:20480
ds_read_b64_tr_b16 a[14:15], v15 offset:22528
v_mfma_f32_16x16x32_bf16 v[52:55], a[28:31], v[84:87], v[52:55]
s_cbranch_vccnz L_o10_rt
L_o10_ok:
s_waitcnt lgkmcnt(8)
v_mfma_f32_16x16x32_bf16 v[24:27], a[32:35], v[88:91], v[24:27]
ds_read_b64_tr_b16 a[16:17], v12 offset:24576
ds_read_b64_tr_b16 a[18:19], v12 offset:26624
v_mfma_f32_16x16x32_bf16 v[40:43], a[32:35], v[92:95], v[40:43]
buffer_load_dwordx4 v[72:75], v6, s[12:15], s37 offen offset:0 sc1
v_mfma_f32_16x16x32_bf16 v[28:31], a[36:39], v[88:91], v[28:31]
ds_read_b64_tr_b16 a[20:21], v13 offset:24576
ds_read_b64_tr_b16 a[22:23], v13 offset:26624
v_mfma_f32_16x16x32_bf16 v[44:47], a[36:39], v[92:95], v[44:47]
buffer_load_dwordx4 v[76:79], v19, s[12:15], s37 offen offset:0 sc1
v_mfma_f32_16x16x32_bf16 v[32:35], a[40:43], v[88:91], v[32:35]
ds_read_b64_tr_b16 a[24:25], v14 offset:24576
ds_read_b64_tr_b16 a[26:27], v14 offset:26624
v_mfma_f32_16x16x32_bf16 v[48:51], a[40:43], v[92:95], v[48:51]
buffer_load_dwordx4 v[80:83], v6, s[12:15], s37 offen offset:1024 sc1
v_mfma_f32_16x16x32_bf16 v[36:39], a[44:47], v[88:91], v[36:39]
ds_read_b64_tr_b16 a[28:29], v15 offset:24576
ds_read_b64_tr_b16 a[30:31], v15 offset:26624
v_mfma_f32_16x16x32_bf16 v[52:55], a[44:47], v[92:95], v[52:55]
buffer_load_dwordx4 v[84:87], v19, s[12:15], s37 offen offset:1024 sc1
s_waitcnt lgkmcnt(8)
v_mfma_f32_16x16x32_bf16 v[24:27], a[0:3], v[96:99], v[24:27]
ds_read_b64_tr_b16 a[32:33], v12 offset:28672
s_waitcnt vmcnt(8)
v_mfma_f32_16x16x32_bf16 v[40:43], a[0:3], v[100:103], v[40:43]
ds_read_b64_tr_b16 a[34:35], v12 offset:30720
v_max3_u32 v2, v104, v108, v112
v_mfma_f32_16x16x32_bf16 v[28:31], a[4:7], v[96:99], v[28:31]
ds_read_b64_tr_b16 a[36:37], v13 offset:28672
v_max_u32 v2, v2, v116
v_mfma_f32_16x16x32_bf16 v[44:47], a[4:7], v[100:103], v[44:47]
ds_read_b64_tr_b16 a[38:39], v13 offset:30720
v_cmp_eq_u32 vcc, -1, v2
v_mfma_f32_16x16x32_bf16 v[32:35], a[8:11], v[96:99], v[32:35]
ds_read_b64_tr_b16 a[40:41], v14 offset:28672
v_mfma_f32_16x16x32_bf16 v[48:51], a[8:11], v[100:103], v[48:51]
ds_read_b64_tr_b16 a[42:43], v14 offset:30720
v_mfma_f32_16x16x32_bf16 v[36:39], a[12:15], v[96:99], v[36:39]
ds_read_b64_tr_b16 a[44:45], v15 offset:28672
ds_read_b64_tr_b16 a[46:47], v15 offset:30720
v_mfma_f32_16x16x32_bf16 v[52:55], a[12:15], v[100:103], v[52:55]
s_cbranch_vccnz L_o11_rt
L_o11_ok:
s_waitcnt lgkmcnt(8)
v_mfma_f32_16x16x32_bf16 v[24:27], a[16:19], v[104:107], v[24:27]
ds_read_b64_tr_b16 a[0:1], v12 offset:32768
ds_read_b64_tr_b16 a[2:3], v12 offset:34816
v_mfma_f32_16x16x32_bf16 v[40:43], a[16:19], v[108:111], v[40:43]
buffer_load_dwordx4 v[88:91], v6, s[12:15], s38 offen offset:0 sc1
v_mfma_f32_16x16x32_bf16 v[28:31], a[20:23], v[104:107], v[28:31]
ds_read_b64_tr_b16 a[4:5], v13 offset:32768
ds_read_b64_tr_b16 a[6:7], v13 offset:34816
v_mfma_f32_16x16x32_bf16 v[44:47], a[20:23], v[108:111], v[44:47]
buffer_load_dwordx4 v[92:95], v19, s[12:15], s38 offen offset:0 sc1
v_mfma_f32_16x16x32_bf16 v[32:35], a[24:27], v[104:107], v[32:35]
ds_read_b64_tr_b16 a[8:9], v14 offset:32768
ds_read_b64_tr_b16 a[10:11], v14 offset:34816
v_mfma_f32_16x16x32_bf16 v[48:51], a[24:27], v[108:111], v[48:51]
buffer_load_dwordx4 v[96:99], v6, s[12:15], s38 offen offset:1024 sc1
v_mfma_f32_16x16x32_bf16 v[36:39], a[28:31], v[104:107], v[36:39]
s_branch L_over7
L_pad7:
s_branch L_pad12
L_over7:
ds_read_b64_tr_b16 a[12:13], v15 offset:32768
ds_read_b64_tr_b16 a[14:15], v15 offset:34816
v_mfma_f32_16x16x32_bf16 v[52:55], a[28:31], v[108:111], v[52:55]
buffer_load_dwordx4 v[100:103], v19, s[12:15], s38 offen offset:1024 sc1
s_waitcnt lgkmcnt(8)
v_mfma_f32_16x16x32_bf16 v[24:27], a[32:35], v[112:115], v[24:27]
ds_read_b64_tr_b16 a[16:17], v12 offset:36864
s_waitcnt vmcnt(8)
v_mfma_f32_16x16x32_bf16 v[40:43], a[32:35], v[116:119], v[40:43]
ds_read_b64_tr_b16 a[18:19], v12 offset:38912
v_max3_u32 v2, v56, v60, v64
v_mfma_f32_16x16x32_bf16 v[28:31], a[36:39], v[112:115], v[28:31]
ds_read_b64_tr_b16 a[20:21], v13 offset:36864
v_max_u32 v2, v2, v68
v_mfma_f32_16x16x32_bf16 v[44:47], a[36:39], v[116:119], v[44:47]
ds_read_b64_tr_b16 a[22:23], v13 offset:38912
v_cmp_eq_u32 vcc, -1, v2
v_mfma_f32_16x16x32_bf16 v[32:35], a[40:43], v[112:115], v[32:35]
ds_read_b64_tr_b16 a[24:25], v14 offset:36864
v_mfma_f32_16x16x32_bf16 v[48:51], a[40:43], v[116:119], v[48:51]
ds_read_b64_tr_b16 a[26:27], v14 offset:38912
v_mfma_f32_16x16x32_bf16 v[36:39], a[44:47], v[112:115], v[36:39]
ds_read_b64_tr_b16 a[28:29], v15 offset:36864
ds_read_b64_tr_b16 a[30:31], v15 offset:38912
v_mfma_f32_16x16x32_bf16 v[52:55], a[44:47], v[116:119], v[52:55]
s_cbranch_vccnz L_o12_rt
L_o12_ok:
s_waitcnt lgkmcnt(8)
v_mfma_f32_16x16x32_bf16 v[24:27], a[0:3], v[56:59], v[24:27]
ds_read_b64_tr_b16 a[32:33], v12 offset:40960
ds_read_b64_tr_b16 a[34:35], v12 offset:43008
v_mfma_f32_16x16x32_bf16 v[40:43], a[0:3], v[60:63], v[40:43]
buffer_load_dwordx4 v[104:107], v6, s[12:15], s39 offen offset:0 sc1
v_mfma_f32_16x16x32_bf16 v[28:31], a[4:7], v[56:59], v[28:31]
ds_read_b64_tr_b16 a[36:37], v13 offset:40960
ds_read_b64_tr_b16 a[38:39], v13 offset:43008
v_mfma_f32_16x16x32_bf16 v[44:47], a[4:7], v[60:63], v[44:47]
buffer_load_dwordx4 v[108:111], v19, s[12:15], s39 offen offset:0 sc1
v_mfma_f32_16x16x32_bf16 v[32:35], a[8:11], v[56:59], v[32:35]
ds_read_b64_tr_b16 a[40:41], v14 offset:40960
ds_read_b64_tr_b16 a[42:43], v14 offset:43008
v_mfma_f32_16x16x32_bf16 v[48:51], a[8:11], v[60:63], v[48:51]
buffer_load_dwordx4 v[112:115], v6, s[12:15], s39 offen offset:1024 sc1
v_mfma_f32_16x16x32_bf16 v[36:39], a[12:15], v[56:59], v[36:39]
ds_read_b64_tr_b16 a[44:45], v15 offset:40960
ds_read_b64_tr_b16 a[46:47], v15 offset:43008
v_mfma_f32_16x16x32_bf16 v[52:55], a[12:15], v[60:63], v[52:55]
buffer_load_dwordx4 v[116:119], v19, s[12:15], s39 offen offset:1024 sc1
s_waitcnt lgkmcnt(8)
v_mfma_f32_16x16x32_bf16 v[24:27], a[16:19], v[64:67], v[24:27]
ds_read_b64_tr_b16 a[0:1], v12 offset:45056
s_waitcnt vmcnt(8)
v_mfma_f32_16x16x32_bf16 v[40:43], a[16:19], v[68:71], v[40:43]
ds_read_b64_tr_b16 a[2:3], v12 offset:47104
v_max3_u32 v2, v72, v76, v80
v_mfma_f32_16x16x32_bf16 v[28:31], a[20:23], v[64:67], v[28:31]
ds_read_b64_tr_b16 a[4:5], v13 offset:45056
v_max_u32 v2, v2, v84
v_mfma_f32_16x16x32_bf16 v[44:47], a[20:23], v[68:71], v[44:47]
ds_read_b64_tr_b16 a[6:7], v13 offset:47104
v_cmp_eq_u32 vcc, -1, v2
v_mfma_f32_16x16x32_bf16 v[32:35], a[24:27], v[64:67], v[32:35]
ds_read_b64_tr_b16 a[8:9], v14 offset:45056
v_mfma_f32_16x16x32_bf16 v[48:51], a[24:27], v[68:71], v[48:51]
ds_read_b64_tr_b16 a[10:11], v14 offset:47104
v_mfma_f32_16x16x32_bf16 v[36:39], a[28:31], v[64:67], v[36:39]
ds_read_b64_tr_b16 a[12:13], v15 offset:45056
ds_read_b64_tr_b16 a[14:15], v15 offset:47104
v_mfma_f32_16x16x32_bf16 v[52:55], a[28:31], v[68:71], v[52:55]
s_cbranch_vccnz L_o13_rt
L_o13_ok:
s_waitcnt lgkmcnt(8)
v_mfma_f32_16x16x32_bf16 v[24:27], a[32:35], v[72:75], v[24:27]
ds_read_b64_tr_b16 a[16:17], v12 offset:49152
ds_read_b64_tr_b16 a[18:19], v12 offset:51200
v_mfma_f32_16x16x32_bf16 v[40:43], a[32:35], v[76:79], v[40:43]
v_mfma_f32_16x16x32_bf16 v[28:31], a[36:39], v[72:75], v[28:31]
ds_read_b64_tr_b16 a[20:21], v13 offset:49152
ds_read_b64_tr_b16 a[22:23], v13 offset:51200
v_mfma_f32_16x16x32_bf16 v[44:47], a[36:39], v[76:79], v[44:47]
v_mfma_f32_16x16x32_bf16 v[32:35], a[40:43], v[72:75], v[32:35]
ds_read_b64_tr_b16 a[24:25], v14 offset:49152
ds_read_b64_tr_b16 a[26:27], v14 offset:51200
v_mfma_f32_16x16x32_bf16 v[48:51], a[40:43], v[76:79], v[48:51]
v_mfma_f32_16x16x32_bf16 v[36:39], a[44:47], v[72:75], v[36:39]
ds_read_b64_tr_b16 a[28:29], v15 offset:49152
ds_read_b64_tr_b16 a[30:31], v15 offset:51200
v_mfma_f32_16x16x32_bf16 v[52:55], a[44:47], v[76:79], v[52:55]
s_waitcnt lgkmcnt(8)
v_mfma_f32_16x16x32_bf16 v[24:27], a[0:3], v[80:83], v[24:27]
ds_read_b64_tr_b16 a[32:33], v12 offset:53248
s_waitcnt vmcnt(4)
v_mfma_f32_16x16x32_bf16 v[40:43], a[0:3], v[84:87], v[40:43]
ds_read_b64_tr_b16 a[34:35], v12 offset:55296
v_max3_u32 v2, v88, v92, v96
v_mfma_f32_16x16x32_bf16 v[28:31], a[4:7], v[80:83], v[28:31]
ds_read_b64_tr_b16 a[36:37], v13 offset:53248
v_max_u32 v2, v2, v100
v_mfma_f32_16x16x32_bf16 v[44:47], a[4:7], v[84:87], v[44:47]
ds_read_b64_tr_b16 a[38:39], v13 offset:55296
v_cmp_eq_u32 vcc, -1, v2
v_mfma_f32_16x16x32_bf16 v[32:35], a[8:11], v[80:83], v[32:35]
ds_read_b64_tr_b16 a[40:41], v14 offset:53248
v_mfma_f32_16x16x32_bf16 v[48:51], a[8:11], v[84:87], v[48:51]
ds_read_b64_tr_b16 a[42:43], v14 offset:55296
v_mfma_f32_16x16x32_bf16 v[36:39], a[12:15], v[80:83], v[36:39]
ds_read_b64_tr_b16 a[44:45], v15 offset:53248
ds_read_b64_tr_b16 a[46:47], v15 offset:55296
v_mfma_f32_16x16x32_bf16 v[52:55], a[12:15], v[84:87], v[52:55]
s_cbranch_vccnz L_o14_rt
L_o14_ok:
s_waitcnt lgkmcnt(8)
v_mfma_f32_16x16x32_bf16 v[24:27], a[16:19], v[88:91], v[24:27]
ds_read_b64_tr_b16 a[0:1], v12 offset:57344
ds_read_b64_tr_b16 a[2:3], v12 offset:59392
v_mfma_f32_16x16x32_bf16 v[40:43], a[16:19], v[92:95], v[40:43]
v_mfma_f32_16x16x32_bf16 v[28:31], a[20:23], v[88:91], v[28:31]
ds_read_b64_tr_b16 a[4:5], v13 offset:57344
ds_read_b64_tr_b16 a[6:7], v13 offset:59392
v_mfma_f32_16x16x32_bf16 v[44:47], a[20:23], v[92:95], v[44:47]
v_mfma_f32_16x16x32_bf16 v[32:35], a[24:27], v[88:91], v[32:35]
ds_read_b64_tr_b16 a[8:9], v14 offset:57344
ds_read_b64_tr_b16 a[10:11], v14 offset:59392
v_mfma_f32_16x16x32_bf16 v[48:51], a[24:27], v[92:95], v[48:51]
v_mfma_f32_16x16x32_bf16 v[36:39], a[28:31], v[88:91], v[36:39]
ds_read_b64_tr_b16 a[12:13], v15 offset:57344
ds_read_b64_tr_b16 a[14:15], v15 offset:59392
v_mfma_f32_16x16x32_bf16 v[52:55], a[28:31], v[92:95], v[52:55]
s_waitcnt lgkmcnt(8)
v_mfma_f32_16x16x32_bf16 v[24:27], a[32:35], v[96:99], v[24:27]
ds_read_b64_tr_b16 a[16:17], v12 offset:61440
s_waitcnt vmcnt(0)
v_mfma_f32_16x16x32_bf16 v[40:43], a[32:35], v[100:103], v[40:43]
ds_read_b64_tr_b16 a[18:19], v12 offset:63488
v_max3_u32 v2, v104, v108, v112
v_mfma_f32_16x16x32_bf16 v[28:31], a[36:39], v[96:99], v[28:31]
ds_read_b64_tr_b16 a[20:21], v13 offset:61440
v_max_u32 v2, v2, v116
v_mfma_f32_16x16x32_bf16 v[44:47], a[36:39], v[100:103], v[44:47]
ds_read_b64_tr_b16 a[22:23], v13 offset:63488
v_cmp_eq_u32 vcc, -1, v2
v_mfma_f32_16x16x32_bf16 v[32:35], a[40:43], v[96:99], v[32:35]
ds_read_b64_tr_b16 a[24:25], v14 offset:61440
v_mfma_f32_16x16x32_bf16 v[48:51], a[40:43], v[100:103], v[48:51]
ds_read_b64_tr_b16 a[26:27], v14 offset:63488
v_mfma_f32_16x16x32_bf16 v[36:39], a[44:47], v[96:99], v[36:39]
ds_read_b64_tr_b16 a[28:29], v15 offset:61440
ds_read_b64_tr_b16 a[30:31], v15 offset:63488
v_mfma_f32_16x16x32_bf16 v[52:55], a[44:47], v[100:103], v[52:55]
s_cbranch_vccnz L_o15_rt
L_o15_ok:
s_waitcnt lgkmcnt(8)
v_mfma_f32_16x16x32_bf16 v[24:27], a[0:3], v[104:107], v[24:27]
v_mfma_f32_16x16x32_bf16 v[40:43], a[0:3], v[108:111], v[40:43]
v_mfma_f32_16x16x32_bf16 v[28:31], a[4:7], v[104:107], v[28:31]
v_mfma_f32_16x16x32_bf16 v[44:47], a[4:7], v[108:111], v[44:47]
v_mfma_f32_16x16x32_bf16 v[32:35], a[8:11], v[104:107], v[32:35]
v_mfma_f32_16x16x32_bf16 v[48:51], a[8:11], v[108:111], v[48:51]
v_mfma_f32_16x16x32_bf16 v[36:39], a[12:15], v[104:107], v[36:39]
v_mfma_f32_16x16x32_bf16 v[52:55], a[12:15], v[108:111], v[52:55]
s_waitcnt lgkmcnt(0)
v_mfma_f32_16x16x32_bf16 v[24:27], a[16:19], v[112:115], v[24:27]
v_mfma_f32_16x16x32_bf16 v[40:43], a[16:19], v[116:119], v[40:43]
v_mfma_f32_16x16x32_bf16 v[28:31], a[20:23], v[112:115], v[28:31]
v_mfma_f32_16x16x32_bf16 v[44:47], a[20:23], v[116:119], v[44:47]
v_mfma_f32_16x16x32_bf16 v[32:35], a[24:27], v[112:115], v[32:35]
v_mfma_f32_16x16x32_bf16 v[48:51], a[24:27], v[116:119], v[48:51]
v_mfma_f32_16x16x32_bf16 v[36:39], a[28:31], v[112:115], v[36:39]
v_mfma_f32_16x16x32_bf16 v[52:55], a[28:31], v[116:119], v[52:55]
s_nop 0
v_cvt_pk_bf16_f32 v128, v24, v25
v_cvt_pk_bf16_f32 v129, v26, v27
v_cvt_pk_bf16_f32 v130, v28, v29
v_cvt_pk_bf16_f32 v131, v30, v31
v_cvt_pk_bf16_f32 v132, v32, v33
v_cvt_pk_bf16_f32 v133, v34, v35
v_cvt_pk_bf16_f32 v134, v36, v37
v_cvt_pk_bf16_f32 v135, v38, v39
v_cvt_pk_bf16_f32 v136, v40, v41
v_cvt_pk_bf16_f32 v137, v42, v43
v_cvt_pk_bf16_f32 v138, v44, v45
v_cvt_pk_bf16_f32 v139, v46, v47
v_cvt_pk_bf16_f32 v140, v48, v49
v_cvt_pk_bf16_f32 v141, v50, v51
v_cvt_pk_bf16_f32 v142, v52, v53
v_cvt_pk_bf16_f32 v143, v54, v55
v_mfma_f32_16x16x32_bf16 v[80:83], v[128:131], v[128:131], 0
v_mfma_f32_16x16x32_bf16 v[72:75], v[120:123], v[128:131], 0
v_mfma_f32_16x16x32_bf16 v[80:83], v[132:135], v[132:135], v[80:83]
v_mfma_f32_16x16x32_bf16 v[72:75], v[124:127], v[132:135], v[72:75]
v_mfma_f32_16x16x32_bf16 v[84:87], v[136:139], v[136:139], 0
v_mfma_f32_16x16x32_bf16 v[76:79], v[120:123], v[136:139], 0
v_mfma_f32_16x16x32_bf16 v[84:87], v[140:143], v[140:143], v[84:87]
v_mfma_f32_16x16x32_bf16 v[76:79], v[124:127], v[140:143], v[76:79]
s_nop 2
v_cndmask_b32_e64 v80, v80, v81, s[80:81]
v_cndmask_b32_e64 v82, v82, v83, s[90:91]
s_or_b64 vcc, s[82:83], s[90:91]
v_mov_b32 v75, s68
v_cndmask_b32 v73, v80, v82, vcc
v_cndmask_b32_e64 v84, v84, v85, s[80:81]
v_cndmask_b32_e64 v86, v86, v87, s[90:91]
s_or_b64 vcc, s[82:83], s[90:91]
v_mov_b32 v79, s68
v_cndmask_b32 v77, v84, v86, vcc
s_mov_b64 exec, s[92:93]
s_cmp_eq_u32 s69, 0
s_cbranch_scc1 L_stp_s
buffer_store_dwordx4 v[72:75], v144, s[12:15], s72 offen offset:0
buffer_store_dwordx4 v[76:79], v144, s[12:15], s72 offen offset:256
L_stp_d:
s_mov_b64 exec, -1
s_add_u32 s70, s75, 0
buffer_load_dwordx4 v[96:99], v145, s[12:15], s70 offen sc1
s_add_u32 s70, s75, 4096
buffer_load_dwordx4 v[100:103], v145, s[12:15], s70 offen sc1
s_add_u32 s70, s75, 8192
buffer_load_dwordx4 v[104:107], v145, s[12:15], s70 offen sc1
s_add_u32 s70, s75, 12288
buffer_load_dwordx4 v[108:111], v145, s[12:15], s70 offen sc1
s_add_u32 s70, s75, 16384
buffer_load_dwordx4 v[112:115], v145, s[12:15], s70 offen sc1
s_add_u32 s70, s75, 20480
buffer_load_dwordx4 v[116:119], v145, s[12:15], s70 offen sc1
s_add_u32 s70, s75, 24576
buffer_load_dwordx4 v[120:123], v145, s[12:15], s70 offen sc1
s_add_u32 s70, s75, 28672
buffer_load_dwordx4 v[124:127], v145, s[12:15], s70 offen sc1
s_barrier
ds_write_b64 v20, v[128:129] offset:0
ds_write_b64 v21, v[130:131] offset:0
ds_write_b64 v22, v[132:133] offset:0
ds_write_b64 v23, v[134:135] offset:0
ds_write_b64 v20, v[136:137] offset:2048
ds_write_b64 v21, v[138:139] offset:2048
ds_write_b64 v22, v[140:141] offset:2048
ds_write_b64 v23, v[142:143] offset:2048
v_lshrrev_b32 v2, 3, v1
v_lshrrev_b32 v3, 4, v1
v_and_b32 v13, 7, v1
v_xor_b32 v3, v3, v13
v_lshlrev_b32 v3, 4, v3
v_lshl_add_u32 v3, v2, 7, v3
s_lshl_b32 s70, s60, 12
v_add_u32 v9, s70, v3
v_xor_b32 v10, 64, v9
v_lshlrev_b32 v11, 11, v2
v_lshl_add_u32 v11, v13, 4, v11
s_lshl_b32 s70, s60, 5
v_add_u32 v12, s70, v2
s_lshl_b32 s74, s64, 18
s_lshl_b32 s70, s60, 16
s_add_u32 s74, s74, s70
s_lshl_b32 s70, s65, 7
s_add_u32 s74, s74, s70
s_mov_b32 s80, 0xff00ff00
s_mov_b32 s81, 0xff00ff00
s_lshl_b32 s70, s60, 5
s_add_u32 s70, s70, 161920
v_mov_b32 v14, s70
v_add_u32 v15, 16, v14
v_add_u32 v8, 161920, v16
v_lshlrev_b32 v8, 4, v13
v_add_u32 v8, 161920, v8
s_waitcnt vmcnt(0)
L_st_chk:
v_xor_b32 v88, s68, v99
v_xor_b32 v89, s68, v103
v_xor_b32 v90, s68, v107
v_xor_b32 v91, s68, v111
v_xor_b32 v92, s68, v115
v_xor_b32 v93, s68, v119
v_xor_b32 v94, s68, v123
v_xor_b32 v95, s68, v127
v_or3_b32 v88, v88, v89, v90
v_or3_b32 v91, v91, v92, v93
v_or3_b32 v88, v88, v94, v95
v_or_b32 v88, v88, v91
v_cmp_ne_u32 vcc, 0, v88
s_cbranch_vccnz L_st_rt
L_st_ok:
v_pk_add_f32 v[96:97], v[96:97], v[100:101]
v_add_f32 v98, v98, v102
v_pk_add_f32 v[104:105], v[104:105], v[108:109]
v_add_f32 v106, v106, v110
v_pk_add_f32 v[112:113], v[112:113], v[116:117]
v_add_f32 v114, v114, v118
v_pk_add_f32 v[120:121], v[120:121], v[124:125]
v_add_f32 v122, v122, v126
v_pk_add_f32 v[96:97], v[96:97], v[104:105]
v_add_f32 v98, v98, v106
v_pk_add_f32 v[112:113], v[112:113], v[120:121]
v_add_f32 v114, v114, v122
v_pk_add_f32 v[96:97], v[96:97], v[112:113]
v_add_f32 v98, v98, v114
v_mov_b32 v100, v96
v_mov_b32 v101, v97
v_mov_b32 v102, v98
v_permlane32_swap_b32 v96, v100
v_permlane32_swap_b32 v97, v101
v_permlane32_swap_b32 v98, v102
v_add_f32 v96, v96, v100
v_add_f32 v97, v97, v101
v_add_f32 v98, v98, v102
v_mul_f32 v73, 0x3a800000, v96
v_mul_f32 v97, 0x3a800000, v97
v_fma_f32 v97, -v73, v73, v97
v_fma_f32 v98, -v73, s84, v98
v_max_f32 v97, 0, v97
v_add_f32 v97, 0x3727c5ac, v97
v_rsq_f32 v74, v97
v_mov_b32 v75, s68
v_mul_f32 v98, v98, v74
v_ashrrev_i32 v99, 31, v98
v_or_b32 v99, 0x80000000, v99
v_xor_b32 v98, v98, v99
s_mov_b32 s70, 0xfffff800
v_and_or_b32 v72, v98, s70, v146
s_nop 1
v_mov_b32_dpp v78, v72 row_ror:1 row_mask:0xf bank_mask:0xf
v_max_u32 v76, v72, v78
v_min_u32 v77, v72, v78
s_nop 0
v_mov_b32_dpp v78, v76 row_ror:2 row_mask:0xf bank_mask:0xf
v_max_u32_dpp v79, v77, v77 row_ror:2 row_mask:0xf bank_mask:0xf
v_med3_u32 v77, v76, v78, v79
v_max_u32 v76, v76, v78
s_nop 1
v_mov_b32_dpp v78, v76 row_ror:4 row_mask:0xf bank_mask:0xf
v_max_u32_dpp v79, v77, v77 row_ror:4 row_mask:0xf bank_mask:0xf
v_med3_u32 v77, v76, v78, v79
v_max_u32 v76, v76, v78
s_nop 1
v_mov_b32_dpp v78, v76 row_ror:8 row_mask:0xf bank_mask:0xf
v_max_u32_dpp v79, v77, v77 row_ror:8 row_mask:0xf bank_mask:0xf
v_med3_u32 v77, v76, v78, v79
v_max_u32 v76, v76, v78
v_mov_b32 v78, v76
v_mov_b32 v79, v77
s_nop 0
v_permlane16_swap_b32 v76, v78
v_permlane16_swap_b32 v77, v79
v_max_u32 v79, v77, v79
v_med3_u32 v77, v76, v78, v79
v_max_u32 v76, v76, v78
v_cmp_eq_u32 vcc, v72, v77
v_cmp_eq_u32_e64 s[92:93], v72, v76
s_nop 0
v_cndmask_b32 v2, v14, v15, vcc
s_or_b64 exec, vcc, s[92:93]
ds_write_b128 v2, v[72:75]
s_mov_b64 exec, -1
v_cndmask_b32_e64 v5, v76, v77, s[80:81]
v_not_b32 v5, v5
v_bfe_u32 v6, v5, 1, 3
v_and_b32 v5, 127, v5
v_xor_b32 v6, v6, v13
v_lshlrev_b32 v6, 4, v6
v_lshl_add_u32 v6, v5, 7, v6
ds_read_b128 v[88:91], v6
v_readfirstlane_b32 s86, v77
v_readfirstlane_b32 s85, v76
v_add_f32 v80, 1.0, v74
v_mul_f32_e64 v56, -v73, v74
v_mov_b32 v82, v80
v_mov_b32 v58, v56
s_nop 0
v_permlane16_swap_b32 v80, v82
v_permlane16_swap_b32 v56, v58
s_waitcnt lgkmcnt(1)
s_barrier
s_sub_u32 s70, s64, s65
s_or_b32 s70, s70, s60
s_cbranch_scc1 L_norec
ds_read_b128 v[92:95], v8
s_lshl_b32 s70, s62, 3
s_lshl_b64 s[72:73], 0xff, s70
s_cmp_eq_u32 s69, 0
s_cselect_b64 s[72:73], 0, s[72:73]
s_andn2_b64 exec, -1, s[72:73]
s_waitcnt lgkmcnt(0)
buffer_store_dwordx4 v[92:95], v11, s[12:15], s87 offen sc1
s_mov_b64 exec, s[72:73]
buffer_store_dwordx4 v[92:95], v11, s[12:15], s87 offen
s_mov_b64 exec, -1
L_norec:
s_mov_b64 exec, 0xffff
s_waitcnt lgkmcnt(0)
buffer_store_dwordx4 v[88:91], v147, s[12:15], s88 offen sc1
s_mov_b64 exec, -1
s_not_b32 s95, s86
s_and_b32 s95, s95, 127
s_not_b32 s94, s85
s_and_b32 s94, s94, 127
v_pk_fma_f32 v[24:25], v[24:25], v[80:81], v[56:57] op_sel_hi:[1,0,0]
v_pk_fma_f32 v[26:27], v[26:27], v[80:81], v[56:57] op_sel_hi:[1,0,0]
v_cvt_pk_bf16_f32 v128, v24, v25
v_cvt_pk_bf16_f32 v129, v26, v27
ds_write_b64 v20, v[128:129] offset:32768
v_pk_fma_f32 v[28:29], v[28:29], v[80:81], v[56:57] op_sel_hi:[1,0,0]
v_pk_fma_f32 v[30:31], v[30:31], v[80:81], v[56:57] op_sel_hi:[1,0,0]
v_cvt_pk_bf16_f32 v130, v28, v29
v_cvt_pk_bf16_f32 v131, v30, v31
ds_write_b64 v21, v[130:131] offset:32768
v_pk_fma_f32 v[32:33], v[32:33], v[80:81], v[56:57] op_sel_hi:[1,0,0]
v_pk_fma_f32 v[34:35], v[34:35], v[80:81], v[56:57] op_sel_hi:[1,0,0]
v_cvt_pk_bf16_f32 v132, v32, v33
v_cvt_pk_bf16_f32 v133, v34, v35
ds_write_b64 v22, v[132:133] offset:32768
v_pk_fma_f32 v[36:37], v[36:37], v[80:81], v[56:57] op_sel_hi:[1,0,0]
v_pk_fma_f32 v[38:39], v[38:39], v[80:81], v[56:57] op_sel_hi:[1,0,0]
v_cvt_pk_bf16_f32 v134, v36, v37
v_cvt_pk_bf16_f32 v135, v38, v39
ds_write_b64 v23, v[134:135] offset:32768
v_pk_fma_f32 v[40:41], v[40:41], v[82:83], v[58:59] op_sel_hi:[1,0,0]
v_pk_fma_f32 v[42:43], v[42:43], v[82:83], v[58:59] op_sel_hi:[1,0,0]
v_cvt_pk_bf16_f32 v136, v40, v41
v_cvt_pk_bf16_f32 v137, v42, v43
ds_write_b64 v20, v[136:137] offset:34816
v_pk_fma_f32 v[44:45], v[44:45], v[82:83], v[58:59] op_sel_hi:[1,0,0]
v_pk_fma_f32 v[46:47], v[46:47], v[82:83], v[58:59] op_sel_hi:[1,0,0]
v_cvt_pk_bf16_f32 v138, v44, v45
v_cvt_pk_bf16_f32 v139, v46, v47
ds_write_b64 v21, v[138:139] offset:34816
v_pk_fma_f32 v[48:49], v[48:49], v[82:83], v[58:59] op_sel_hi:[1,0,0]
v_pk_fma_f32 v[50:51], v[50:51], v[82:83], v[58:59] op_sel_hi:[1,0,0]
v_cvt_pk_bf16_f32 v140, v48, v49
v_cvt_pk_bf16_f32 v141, v50, v51
ds_write_b64 v22, v[140:141] offset:34816
v_pk_fma_f32 v[52:53], v[52:53], v[82:83], v[58:59] op_sel_hi:[1,0,0]
v_pk_fma_f32 v[54:55], v[54:55], v[82:83], v[58:59] op_sel_hi:[1,0,0]
v_cvt_pk_bf16_f32 v142, v52, v53
v_cvt_pk_bf16_f32 v143, v54, v55
ds_write_b64 v23, v[142:143] offset:34816
s_waitcnt lgkmcnt(0)
ds_read_b128 v[96:99], v9 offset:32768
ds_read_b128 v[100:103], v10 offset:33792
ds_read_b128 v[104:107], v9 offset:34816
ds_read_b128 v[108:111], v10 offset:35840
v_add_u32 v2, 0, v12
v_cmp_ne_u32 vcc, s94, v2
v_cmp_ne_u32_e64 s[92:93], s95, v2
s_add_u32 s70, s74, 0
s_waitcnt lgkmcnt(3)
s_and_b64 exec, vcc, s[92:93]
buffer_store_dwordx4 v[96:99], v11, s[20:23], s70 offen nt
s_mov_b64 exec, -1
v_add_u32 v2, 8, v12
v_cmp_ne_u32 vcc, s94, v2
v_cmp_ne_u32_e64 s[92:93], s95, v2
s_add_u32 s70, s74, 16384
s_waitcnt lgkmcnt(2)
s_and_b64 exec, vcc, s[92:93]
buffer_store_dwordx4 v[100:103], v11, s[20:23], s70 offen nt
s_mov_b64 exec, -1
v_add_u32 v2, 16, v12
v_cmp_ne_u32 vcc, s94, v2
v_cmp_ne_u32_e64 s[92:93], s95, v2
s_add_u32 s70, s74, 32768
s_waitcnt lgkmcnt(1)
s_and_b64 exec, vcc, s[92:93]
buffer_store_dwordx4 v[104:107], v11, s[20:23], s70 offen nt
s_mov_b64 exec, -1
v_add_u32 v2, 24, v12
v_cmp_ne_u32 vcc, s94, v2
v_cmp_ne_u32_e64 s[92:93], s95, v2
s_add_u32 s70, s74, 49152
s_waitcnt lgkmcnt(0)
s_and_b64 exec, vcc, s[92:93]
buffer_store_dwordx4 v[108:111], v11, s[20:23], s70 offen nt
s_mov_b64 exec, -1
v_mov_b32 v2, 161792
s_barrier
ds_read_b32 v3, v2
ds_read_b32 v4, v2 offset:16
s_waitcnt lgkmcnt(0)
v_readfirstlane_b32 s72, v3
v_readfirstlane_b32 s73, v4
s_cmp_eq_u32 s85, s72
s_cselect_b32 s94, 255, s94
s_cmp_eq_u32 s85, s73
s_cselect_b32 s94, 255, s94
s_cmp_eq_u32 s86, s72
s_cselect_b32 s95, 255, s95
s_cmp_eq_u32 s86, s73
s_cselect_b32 s95, 255, s95
v_add_u32 v2, 0, v12
v_cmp_eq_u32 vcc, s94, v2
v_cmp_eq_u32_e64 s[92:93], s95, v2
s_add_u32 s70, s74, 0
s_or_b64 exec, vcc, s[92:93]
s_cbranch_execz L_nodef0
buffer_store_dwordx4 v[96:99], v11, s[20:23], s70 offen nt
L_nodef0:
s_mov_b64 exec, -1
v_add_u32 v2, 8, v12
v_cmp_eq_u32 vcc, s94, v2
v_cmp_eq_u32_e64 s[92:93], s95, v2
s_add_u32 s70, s74, 16384
s_or_b64 exec, vcc, s[92:93]
s_cbranch_execz L_nodef1
buffer_store_dwordx4 v[100:103], v11, s[20:23], s70 offen nt
L_nodef1:
s_mov_b64 exec, -1
v_add_u32 v2, 16, v12
v_cmp_eq_u32 vcc, s94, v2
v_cmp_eq_u32_e64 s[92:93], s95, v2
s_add_u32 s70, s74, 32768
s_or_b64 exec, vcc, s[92:93]
s_cbranch_execz L_nodef2
buffer_store_dwordx4 v[104:107], v11, s[20:23], s70 offen nt
L_nodef2:
s_mov_b64 exec, -1
v_add_u32 v2, 24, v12
v_cmp_eq_u32 vcc, s94, v2
v_cmp_eq_u32_e64 s[92:93], s95, v2
s_add_u32 s70, s74, 49152
s_or_b64 exec, vcc, s[92:93]
s_cbranch_execz L_nodef3
buffer_store_dwordx4 v[108:111], v11, s[20:23], s70 offen nt
L_nodef3:
s_mov_b64 exec, -1
L_end:
s_endpgm
L_eg_rt:
s_add_u32 s78, s78, 1
s_cmp_gt_u32 s78, 65536
s_cbranch_scc1 L_eg_ok
s_add_u32 s70, s87, 0
buffer_load_dwordx4 v[20:23], v44, s[12:15], s70 offen sc1
buffer_load_dwordx4 v[36:39], v45, s[12:15], s88 offen sc1
buffer_load_dwordx4 v[40:43], v46, s[12:15], 0 offen offset:0 sc1
s_waitcnt vmcnt(0)
s_branch L_eg_chk
L_pad8:
s_branch L_retF
L_kvrt:
s_add_u32 s78, s78, 1
s_cmp_gt_u32 s78, 65536
s_cbranch_scc1 L_kvok
s_bitcmp1_b32 s73, 0
s_cbranch_scc0 L_kvn0
v_cmp_eq_u32 vcc, -1, v84
s_cbranch_vccz L_kv0_p0
s_add_u32 s70, s65, 1
s_and_b32 s70, s70, 15
s_mul_i32 s70, s70, 4352
s_add_u32 s70, s70, s87
buffer_load_dwordx4 v[84:87], v18, s[12:15], s70 offen sc1
L_kv0_p0:
v_cmp_eq_u32 vcc, -1, v88
s_cbranch_vccz L_kv0_p1
s_add_u32 s70, s65, 2
s_and_b32 s70, s70, 15
s_mul_i32 s70, s70, 4352
s_add_u32 s70, s70, s87
buffer_load_dwordx4 v[88:91], v18, s[12:15], s70 offen sc1
L_kv0_p1:
v_cmp_eq_u32 vcc, -1, v92
s_cbranch_vccz L_kv0_p2
s_add_u32 s70, s65, 3
s_and_b32 s70, s70, 15
s_mul_i32 s70, s70, 4352
s_add_u32 s70, s70, s87
buffer_load_dwordx4 v[92:95], v18, s[12:15], s70 offen sc1
L_kv0_p2:
v_cmp_eq_u32 vcc, -1, v96
s_cbranch_vccz L_kv0_p3
s_add_u32 s70, s65, 4
s_and_b32 s70, s70, 15
s_mul_i32 s70, s70, 4352
s_add_u32 s70, s70, s87
buffer_load_dwordx4 v[96:99], v18, s[12:15], s70 offen sc1
L_kv0_p3:
L_kvn0:
s_bitcmp1_b32 s73, 1
s_cbranch_scc0 L_kvn1
v_cmp_eq_u32 vcc, -1, v100
s_cbranch_vccz L_kv1_p0
s_add_u32 s70, s65, 5
s_and_b32 s70, s70, 15
s_mul_i32 s70, s70, 4352
s_add_u32 s70, s70, s87
buffer_load_dwordx4 v[100:103], v18, s[12:15], s70 offen sc1
L_kv1_p0:
v_cmp_eq_u32 vcc, -1, v104
s_cbranch_vccz L_kv1_p1
s_add_u32 s70, s65, 6
s_and_b32 s70, s70, 15
s_mul_i32 s70, s70, 4352
s_add_u32 s70, s70, s87
buffer_load_dwordx4 v[104:107], v18, s[12:15], s70 offen sc1
L_kv1_p1:
v_cmp_eq_u32 vcc, -1, v108
s_cbranch_vccz L_kv1_p2
s_add_u32 s70, s65, 7
s_and_b32 s70, s70, 15
s_mul_i32 s70, s70, 4352
s_add_u32 s70, s70, s87
buffer_load_dwordx4 v[108:111], v18, s[12:15], s70 offen sc1
L_kv1_p2:
v_cmp_eq_u32 vcc, -1, v112
s_cbranch_vccz L_kv1_p3
s_add_u32 s70, s65, 8
s_and_b32 s70, s70, 15
s_mul_i32 s70, s70, 4352
s_add_u32 s70, s70, s87
buffer_load_dwordx4 v[112:115], v18, s[12:15], s70 offen sc1
L_kv1_p3:
L_kvn1:
s_bitcmp1_b32 s73, 2
s_cbranch_scc0 L_kvn2
v_cmp_eq_u32 vcc, -1, v116
s_cbranch_vccz L_kv2_p0
s_add_u32 s70, s65, 9
s_and_b32 s70, s70, 15
s_mul_i32 s70, s70, 4352
s_add_u32 s70, s70, s87
buffer_load_dwordx4 v[116:119], v18, s[12:15], s70 offen sc1
L_kv2_p0:
v_cmp_eq_u32 vcc, -1, v120
s_cbranch_vccz L_kv2_p1
s_add_u32 s70, s65, 10
s_and_b32 s70, s70, 15
s_mul_i32 s70, s70, 4352
s_add_u32 s70, s70, s87
buffer_load_dwordx4 v[120:123], v18, s[12:15], s70 offen sc1
L_kv2_p1:
v_cmp_eq_u32 vcc, -1, v124
s_cbranch_vccz L_kv2_p2
s_add_u32 s70, s65, 11
s_and_b32 s70, s70, 15
s_mul_i32 s70, s70, 4352
s_add_u32 s70, s70, s87
buffer_load_dwordx4 v[124:127], v18, s[12:15], s70 offen sc1
L_kv2_p2:
v_cmp_eq_u32 vcc, -1, v128
s_cbranch_vccz L_kv2_p3
s_add_u32 s70, s65, 12
s_and_b32 s70, s70, 15
s_mul_i32 s70, s70, 4352
s_add_u32 s70, s70, s87
buffer_load_dwordx4 v[128:131], v18, s[12:15], s70 offen sc1
L_kv2_p3:
L_kvn2:
s_bitcmp1_b32 s73, 3
s_cbranch_scc0 L_kvn3
v_cmp_eq_u32 vcc, -1, v132
s_cbranch_vccz L_kv3_p0
s_add_u32 s70, s65, 13
s_and_b32 s70, s70, 15
s_mul_i32 s70, s70, 4352
s_add_u32 s70, s70, s87
buffer_load_dwordx4 v[132:135], v18, s[12:15], s70 offen sc1
L_kv3_p0:
v_cmp_eq_u32 vcc, -1, v136
s_cbranch_vccz L_kv3_p1
s_add_u32 s70, s65, 14
s_and_b32 s70, s70, 15
s_mul_i32 s70, s70, 4352
s_add_u32 s70, s70, s87
buffer_load_dwordx4 v[136:139], v18, s[12:15], s70 offen sc1
L_kv3_p1:
v_cmp_eq_u32 vcc, -1, v140
s_cbranch_vccz L_kv3_p2
s_add_u32 s70, s65, 15
s_and_b32 s70, s70, 15
s_mul_i32 s70, s70, 4352
s_add_u32 s70, s70, s87
buffer_load_dwordx4 v[140:143], v18, s[12:15], s70 offen sc1
L_kv3_p2:
v_cmp_eq_u32 vcc, -1, v144
s_cbranch_vccz L_kv3_p3
s_add_u32 s70, s65, 16
s_and_b32 s70, s70, 15
s_mul_i32 s70, s70, 4352
s_add_u32 s70, s70, s87
buffer_load_dwordx4 v[144:147], v18, s[12:15], s70 offen sc1
L_kv3_p3:
L_kvn3:
s_bitcmp1_b32 s73, 4
s_cbranch_scc0 L_kvn4
buffer_load_dwordx4 v[148:151], v55, s[12:15], s88 offen sc1
L_kvn4:
s_waitcnt vmcnt(0)
s_branch L_kvr
s_endpgm
L_pad9:
s_branch L_pad13
L_pksame:
s_cmp_eq_u32 s73, 0
s_cbranch_scc1 L_pkf
s_add_u32 s78, s78, 1
s_cmp_le_u32 s78, 65536
s_cbranch_scc1 L_pk
s_branch L_pkf
L_pkx_rt:
s_add_u32 s78, s78, 1
s_cmp_gt_u32 s78, 65536
s_cbranch_scc1 L_pkx_ok
s_mov_b64 exec, s[92:93]
buffer_load_dwordx4 v[24:27], v58, s[12:15], 0 offen offset:0 sc1
s_branch L_over10
L_pad10:
s_branch L_pad15
L_over10:
buffer_load_dwordx4 v[28:31], v58, s[12:15], 0 offen offset:64 sc1
buffer_load_dwordx4 v[32:35], v58, s[12:15], 0 offen offset:128 sc1
buffer_load_dwordx4 v[36:39], v58, s[12:15], 0 offen offset:192 sc1
buffer_load_dwordx4 v[40:43], v58, s[12:15], 0 offen offset:256 sc1
buffer_load_dwordx4 v[44:47], v58, s[12:15], 0 offen offset:320 sc1
buffer_load_dwordx4 v[48:51], v58, s[12:15], 0 offen offset:384 sc1
buffer_load_dwordx4 v[52:55], v58, s[12:15], 0 offen offset:448 sc1
s_mov_b64 exec, -1
s_waitcnt vmcnt(0)
s_branch L_pkx_chk
L_pxp_s:
buffer_store_dwordx4 v[84:87], v60, s[12:15], s85 offen sc1
s_branch L_pxp_d
L_pad11:
s_branch L_pad16
L_px_rt:
s_add_u32 s78, s78, 1
s_cmp_gt_u32 s78, 65536
s_cbranch_scc1 L_px_ok
v_and_b32 v2, s91, v24
v_cmp_ne_u32 vcc, 0, v2
v_xor_b32 v24, s84, v24
s_cbranch_vccz L_px_p0
buffer_load_dwordx4 v[24:27], v61, s[12:15], s86 offen offset:0 sc1
L_px_p0:
v_and_b32 v2, s91, v28
v_cmp_ne_u32 vcc, 0, v2
v_xor_b32 v28, s84, v28
s_cbranch_vccz L_px_p1
buffer_load_dwordx4 v[28:31], v61, s[12:15], s86 offen offset:1024 sc1
L_px_p1:
v_and_b32 v2, s91, v32
v_cmp_ne_u32 vcc, 0, v2
v_xor_b32 v32, s84, v32
s_cbranch_vccz L_px_p2
buffer_load_dwordx4 v[32:35], v61, s[12:15], s86 offen offset:2048 sc1
L_px_p2:
v_and_b32 v2, s91, v36
v_cmp_ne_u32 vcc, 0, v2
v_xor_b32 v36, s84, v36
s_cbranch_vccz L_px_p3
buffer_load_dwordx4 v[36:39], v61, s[12:15], s86 offen offset:3072 sc1
L_px_p3:
s_waitcnt vmcnt(0)
s_branch L_px_chk
L_pad12:
s_branch L_pad17
L_yown:
v_bfi_b32 v40, s91, v59, v40
buffer_store_dwordx4 v[40:43], v62, s[12:15], s88 offen
s_add_u32 s88, s88, 8192
v_bfi_b32 v44, s91, v59, v44
buffer_store_dwordx4 v[44:47], v62, s[12:15], s88 offen
s_add_u32 s88, s88, 8192
v_bfi_b32 v48, s91, v59, v48
buffer_store_dwordx4 v[48:51], v62, s[12:15], s88 offen
s_add_u32 s88, s88, 8192
v_bfi_b32 v52, s91, v59, v52
buffer_store_dwordx4 v[52:55], v62, s[12:15], s88 offen
s_branch L_yd
L_h_rt:
s_add_u32 s78, s78, 1
s_cmp_gt_u32 s78, 65536
s_cbranch_scc1 L_h_ok
buffer_load_dwordx2 v[84:85], v64, s[12:15], s72 offen sc1
s_waitcnt vmcnt(0)
s_branch L_h_chk
L_pad13:
s_branch L_pad18
L_y_rt:
s_add_u32 s78, s78, 1
s_cmp_gt_u32 s78, 65536
s_cbranch_scc1 L_yf0
buffer_load_dwordx4 v[120:123], v18, s[12:15], s88 offen offset:0 sc1
buffer_load_dwordx4 v[124:127], v18, s[12:15], s88 offen offset:1024 sc1
buffer_load_dwordx4 v[128:131], v18, s[12:15], s88 offen offset:2048 sc1
buffer_load_dwordx4 v[132:135], v18, s[12:15], s88 offen offset:3072 sc1
buffer_load_dwordx4 v[136:139], v18, s[12:15], s71 offen offset:0 sc1
buffer_load_dwordx4 v[140:143], v18, s[12:15], s71 offen offset:1024 sc1
buffer_load_dwordx4 v[144:147], v18, s[12:15], s71 offen offset:2048 sc1
v_mov_b32 v88, s84
s_waitcnt vmcnt(14)
v_xor_b32 v24, s84, v24
v_xor_b32 v28, s84, v28
v_xor_b32 v32, s84, v32
v_xor_b32 v36, s84, v36
v_or3_b32 v2, v24, v28, v32
v_xor_b32 v92, s84, v92
v_xor_b32 v96, s84, v96
v_or3_b32 v2, v2, v36, v92
v_xor_b32 v100, s84, v100
v_xor_b32 v88, s84, v88
v_or3_b32 v2, v2, v96, v100
v_bitop3_b32 v2, v2, v88, s91 bitop3:0xa8
v_cmp_ne_u32 vcc, 0, v2
s_cbranch_vccz L_yf1
buffer_load_dwordx4 v[24:27], v18, s[12:15], s88 offen offset:0 sc1
buffer_load_dwordx4 v[28:31], v18, s[12:15], s88 offen offset:1024 sc1
buffer_load_dwordx4 v[32:35], v18, s[12:15], s88 offen offset:2048 sc1
buffer_load_dwordx4 v[36:39], v18, s[12:15], s88 offen offset:3072 sc1
buffer_load_dwordx4 v[92:95], v18, s[12:15], s71 offen offset:0 sc1
buffer_load_dwordx4 v[96:99], v18, s[12:15], s71 offen offset:1024 sc1
buffer_load_dwordx4 v[100:103], v18, s[12:15], s71 offen offset:2048 sc1
v_mov_b32 v88, s84
s_waitcnt vmcnt(14)
v_xor_b32 v40, s84, v40
v_xor_b32 v44, s84, v44
v_xor_b32 v48, s84, v48
v_xor_b32 v52, s84, v52
v_or3_b32 v2, v40, v44, v48
v_xor_b32 v104, s84, v104
v_xor_b32 v108, s84, v108
v_or3_b32 v2, v2, v52, v104
v_xor_b32 v112, s84, v112
v_xor_b32 v88, s84, v88
v_or3_b32 v2, v2, v108, v112
v_bitop3_b32 v2, v2, v88, s91 bitop3:0xa8
v_cmp_ne_u32 vcc, 0, v2
s_cbranch_vccz L_yf2
buffer_load_dwordx4 v[40:43], v18, s[12:15], s88 offen offset:0 sc1
buffer_load_dwordx4 v[44:47], v18, s[12:15], s88 offen offset:1024 sc1
buffer_load_dwordx4 v[48:51], v18, s[12:15], s88 offen offset:2048 sc1
buffer_load_dwordx4 v[52:55], v18, s[12:15], s88 offen offset:3072 sc1
buffer_load_dwordx4 v[104:107], v18, s[12:15], s71 offen offset:0 sc1
buffer_load_dwordx4 v[108:111], v18, s[12:15], s71 offen offset:1024 sc1
buffer_load_dwordx4 v[112:115], v18, s[12:15], s71 offen offset:2048 sc1
v_mov_b32 v88, s84
s_branch L_yr
L_yf1:
v_pk_add_f32 v[24:25], v[24:25], v[28:29]
v_pk_add_f32 v[26:27], v[26:27], v[30:31]
v_pk_add_f32 v[32:33], v[32:33], v[36:37]
v_pk_add_f32 v[34:35], v[34:35], v[38:39]
v_pk_add_f32 v[92:93], v[92:93], v[96:97]
v_pk_add_f32 v[94:95], v[94:95], v[98:99]
v_pk_add_f32 v[24:25], v[24:25], v[32:33]
v_pk_add_f32 v[26:27], v[26:27], v[34:35]
v_pk_add_f32 v[92:93], v[92:93], v[100:101]
v_pk_add_f32 v[94:95], v[94:95], v[102:103]
v_pk_add_f32 v[24:25], v[24:25], v[92:93]
v_pk_add_f32 v[26:27], v[26:27], v[94:95]
s_nop 0
v_add_f32_dpp v68, v24, v24 row_ror:8 row_mask:0xf bank_mask:0xf
v_add_f32_dpp v69, v25, v25 row_ror:8 row_mask:0xf bank_mask:0xf
v_add_f32_dpp v70, v26, v26 row_ror:8 row_mask:0xf bank_mask:0xf
v_add_f32_dpp v71, v27, v27 row_ror:8 row_mask:0xf bank_mask:0xf
s_branch L_yf
L_yf2:
v_pk_add_f32 v[40:41], v[40:41], v[44:45]
v_pk_add_f32 v[42:43], v[42:43], v[46:47]
v_pk_add_f32 v[48:49], v[48:49], v[52:53]
v_pk_add_f32 v[50:51], v[50:51], v[54:55]
v_pk_add_f32 v[104:105], v[104:105], v[108:109]
v_pk_add_f32 v[106:107], v[106:107], v[110:111]
v_pk_add_f32 v[40:41], v[40:41], v[48:49]
v_pk_add_f32 v[42:43], v[42:43], v[50:51]
v_pk_add_f32 v[104:105], v[104:105], v[112:113]
v_pk_add_f32 v[106:107], v[106:107], v[114:115]
v_pk_add_f32 v[40:41], v[40:41], v[104:105]
v_pk_add_f32 v[42:43], v[42:43], v[106:107]
s_nop 0
v_add_f32_dpp v68, v40, v40 row_ror:8 row_mask:0xf bank_mask:0xf
v_add_f32_dpp v69, v41, v41 row_ror:8 row_mask:0xf bank_mask:0xf
v_add_f32_dpp v70, v42, v42 row_ror:8 row_mask:0xf bank_mask:0xf
v_add_f32_dpp v71, v43, v43 row_ror:8 row_mask:0xf bank_mask:0xf
s_branch L_yf
L_kvp_s:
buffer_store_dwordx4 v[140:143], v16, s[12:15], s72 offen sc1
s_mov_b64 exec, s[92:93]
buffer_store_dwordx4 v[136:139], v4, s[12:15], s73 offen sc1
s_mov_b64 exec, -1
s_branch L_kvp_d
L_pad14:
s_branch L_retF
L_oown0:
buffer_store_dwordx4 v[52:55], v16, s[12:15], s70 offen
s_branch L_ood0
L_oown1:
buffer_store_dwordx4 v[76:79], v16, s[12:15], s70 offen
s_branch L_ood1
L_oown2:
buffer_store_dwordx4 v[100:103], v16, s[12:15], s70 offen
s_branch L_ood2
L_oown3:
buffer_store_dwordx4 v[124:127], v16, s[12:15], s70 offen
s_branch L_ood3
L_pad15:
s_branch L_retG
L_o0_rt:
s_add_u32 s78, s78, 1
s_cmp_gt_u32 s78, 65536
s_cbranch_scc1 L_o0_ok
buffer_load_dwordx4 v[56:59], v6, s[12:15], s24 offen offset:0 sc1
buffer_load_dwordx4 v[60:63], v19, s[12:15], s24 offen offset:0 sc1
buffer_load_dwordx4 v[64:67], v6, s[12:15], s24 offen offset:1024 sc1
buffer_load_dwordx4 v[68:71], v19, s[12:15], s24 offen offset:1024 sc1
s_waitcnt vmcnt(4)
v_max3_u32 v2, v72, v76, v80
v_max3_u32 v2, v2, v84, v88
v_max3_u32 v2, v2, v92, v96
v_max3_u32 v2, v2, v100, v100
v_cmp_eq_u32 vcc, -1, v2
s_cbranch_vccz L_o0_a
buffer_load_dwordx4 v[72:75], v6, s[12:15], s25 offen offset:0 sc1
buffer_load_dwordx4 v[76:79], v19, s[12:15], s25 offen offset:0 sc1
buffer_load_dwordx4 v[80:83], v6, s[12:15], s25 offen offset:1024 sc1
buffer_load_dwordx4 v[84:87], v19, s[12:15], s25 offen offset:1024 sc1
buffer_load_dwordx4 v[88:91], v6, s[12:15], s26 offen offset:0 sc1
buffer_load_dwordx4 v[92:95], v19, s[12:15], s26 offen offset:0 sc1
buffer_load_dwordx4 v[96:99], v6, s[12:15], s26 offen offset:1024 sc1
buffer_load_dwordx4 v[100:103], v19, s[12:15], s26 offen offset:1024 sc1
s_waitcnt vmcnt(8)
s_branch L_o0_b
L_o0_a:
s_waitcnt vmcnt(0)
L_o0_b:
v_max3_u32 v2, v56, v60, v64
v_max_u32 v2, v2, v68
v_cmp_eq_u32 vcc, -1, v2
s_cbranch_vccnz L_o0_rt
s_branch L_o0_ok
L_pad16:
s_branch L_retG
L_o1_rt:
s_add_u32 s78, s78, 1
s_cmp_gt_u32 s78, 65536
s_cbranch_scc1 L_o1_ok
buffer_load_dwordx4 v[72:75], v6, s[12:15], s25 offen offset:0 sc1
buffer_load_dwordx4 v[76:79], v19, s[12:15], s25 offen offset:0 sc1
buffer_load_dwordx4 v[80:83], v6, s[12:15], s25 offen offset:1024 sc1
buffer_load_dwordx4 v[84:87], v19, s[12:15], s25 offen offset:1024 sc1
s_waitcnt vmcnt(4)
v_max3_u32 v2, v88, v92, v96
v_max3_u32 v2, v2, v100, v104
v_max3_u32 v2, v2, v108, v112
v_max3_u32 v2, v2, v116, v116
v_cmp_eq_u32 vcc, -1, v2
s_cbranch_vccz L_o1_a
buffer_load_dwordx4 v[88:91], v6, s[12:15], s26 offen offset:0 sc1
buffer_load_dwordx4 v[92:95], v19, s[12:15], s26 offen offset:0 sc1
buffer_load_dwordx4 v[96:99], v6, s[12:15], s26 offen offset:1024 sc1
buffer_load_dwordx4 v[100:103], v19, s[12:15], s26 offen offset:1024 sc1
buffer_load_dwordx4 v[104:107], v6, s[12:15], s27 offen offset:0 sc1
buffer_load_dwordx4 v[108:111], v19, s[12:15], s27 offen offset:0 sc1
buffer_load_dwordx4 v[112:115], v6, s[12:15], s27 offen offset:1024 sc1
buffer_load_dwordx4 v[116:119], v19, s[12:15], s27 offen offset:1024 sc1
s_waitcnt vmcnt(8)
s_branch L_o1_b
L_o1_a:
s_waitcnt vmcnt(0)
L_o1_b:
v_max3_u32 v2, v72, v76, v80
v_max_u32 v2, v2, v84
v_cmp_eq_u32 vcc, -1, v2
s_cbranch_vccnz L_o1_rt
s_branch L_o1_ok
L_o2_rt:
s_add_u32 s78, s78, 1
s_cmp_gt_u32 s78, 65536
s_cbranch_scc1 L_o2_ok
buffer_load_dwordx4 v[88:91], v6, s[12:15], s26 offen offset:0 sc1
buffer_load_dwordx4 v[92:95], v19, s[12:15], s26 offen offset:0 sc1
buffer_load_dwordx4 v[96:99], v6, s[12:15], s26 offen offset:1024 sc1
buffer_load_dwordx4 v[100:103], v19, s[12:15], s26 offen offset:1024 sc1
s_waitcnt vmcnt(4)
v_max3_u32 v2, v104, v108, v112
v_max3_u32 v2, v2, v116, v56
v_max3_u32 v2, v2, v60, v64
v_max3_u32 v2, v2, v68, v68
v_cmp_eq_u32 vcc, -1, v2
s_cbranch_vccz L_o2_a
buffer_load_dwordx4 v[104:107], v6, s[12:15], s27 offen offset:0 sc1
buffer_load_dwordx4 v[108:111], v19, s[12:15], s27 offen offset:0 sc1
buffer_load_dwordx4 v[112:115], v6, s[12:15], s27 offen offset:1024 sc1
buffer_load_dwordx4 v[116:119], v19, s[12:15], s27 offen offset:1024 sc1
buffer_load_dwordx4 v[56:59], v6, s[12:15], s28 offen offset:0 sc1
buffer_load_dwordx4 v[60:63], v19, s[12:15], s28 offen offset:0 sc1
buffer_load_dwordx4 v[64:67], v6, s[12:15], s28 offen offset:1024 sc1
buffer_load_dwordx4 v[68:71], v19, s[12:15], s28 offen offset:1024 sc1
s_waitcnt vmcnt(8)
s_branch L_o2_b
L_o2_a:
s_waitcnt vmcnt(0)
L_o2_b:
v_max3_u32 v2, v88, v92, v96
v_max_u32 v2, v2, v100
v_cmp_eq_u32 vcc, -1, v2
s_cbranch_vccnz L_o2_rt
s_branch L_o2_ok
L_o3_rt:
s_add_u32 s78, s78, 1
s_cmp_gt_u32 s78, 65536
s_cbranch_scc1 L_o3_ok
buffer_load_dwordx4 v[104:107], v6, s[12:15], s27 offen offset:0 sc1
buffer_load_dwordx4 v[108:111], v19, s[12:15], s27 offen offset:0 sc1
buffer_load_dwordx4 v[112:115], v6, s[12:15], s27 offen offset:1024 sc1
buffer_load_dwordx4 v[116:119], v19, s[12:15], s27 offen offset:1024 sc1
s_waitcnt vmcnt(4)
v_max3_u32 v2, v56, v60, v64
v_max3_u32 v2, v2, v68, v72
v_max3_u32 v2, v2, v76, v80
v_max3_u32 v2, v2, v84, v84
v_cmp_eq_u32 vcc, -1, v2
s_cbranch_vccz L_o3_a
buffer_load_dwordx4 v[56:59], v6, s[12:15], s28 offen offset:0 sc1
buffer_load_dwordx4 v[60:63], v19, s[12:15], s28 offen offset:0 sc1
buffer_load_dwordx4 v[64:67], v6, s[12:15], s28 offen offset:1024 sc1
buffer_load_dwordx4 v[68:71], v19, s[12:15], s28 offen offset:1024 sc1
buffer_load_dwordx4 v[72:75], v6, s[12:15], s29 offen offset:0 sc1
buffer_load_dwordx4 v[76:79], v19, s[12:15], s29 offen offset:0 sc1
buffer_load_dwordx4 v[80:83], v6, s[12:15], s29 offen offset:1024 sc1
buffer_load_dwordx4 v[84:87], v19, s[12:15], s29 offen offset:1024 sc1
s_waitcnt vmcnt(8)
s_branch L_o3_b
L_o3_a:
s_waitcnt vmcnt(0)
L_o3_b:
v_max3_u32 v2, v104, v108, v112
v_max_u32 v2, v2, v116
v_cmp_eq_u32 vcc, -1, v2
s_cbranch_vccnz L_o3_rt
s_branch L_o3_ok
L_o4_rt:
s_add_u32 s78, s78, 1
s_cmp_gt_u32 s78, 65536
s_cbranch_scc1 L_o4_ok
buffer_load_dwordx4 v[56:59], v6, s[12:15], s28 offen offset:0 sc1
buffer_load_dwordx4 v[60:63], v19, s[12:15], s28 offen offset:0 sc1
buffer_load_dwordx4 v[64:67], v6, s[12:15], s28 offen offset:1024 sc1
buffer_load_dwordx4 v[68:71], v19, s[12:15], s28 offen offset:1024 sc1
s_waitcnt vmcnt(4)
v_max3_u32 v2, v72, v76, v80
v_max3_u32 v2, v2, v84, v88
v_max3_u32 v2, v2, v92, v96
v_max3_u32 v2, v2, v100, v100
v_cmp_eq_u32 vcc, -1, v2
s_cbranch_vccz L_o4_a
buffer_load_dwordx4 v[72:75], v6, s[12:15], s29 offen offset:0 sc1
buffer_load_dwordx4 v[76:79], v19, s[12:15], s29 offen offset:0 sc1
buffer_load_dwordx4 v[80:83], v6, s[12:15], s29 offen offset:1024 sc1
buffer_load_dwordx4 v[84:87], v19, s[12:15], s29 offen offset:1024 sc1
buffer_load_dwordx4 v[88:91], v6, s[12:15], s30 offen offset:0 sc1
buffer_load_dwordx4 v[92:95], v19, s[12:15], s30 offen offset:0 sc1
buffer_load_dwordx4 v[96:99], v6, s[12:15], s30 offen offset:1024 sc1
buffer_load_dwordx4 v[100:103], v19, s[12:15], s30 offen offset:1024 sc1
s_waitcnt vmcnt(8)
s_branch L_o4_b
L_o4_a:
s_waitcnt vmcnt(0)
L_o4_b:
v_max3_u32 v2, v56, v60, v64
v_max_u32 v2, v2, v68
v_cmp_eq_u32 vcc, -1, v2
s_cbranch_vccnz L_o4_rt
s_branch L_o4_ok
L_o5_rt:
s_add_u32 s78, s78, 1
s_cmp_gt_u32 s78, 65536
s_cbranch_scc1 L_o5_ok
buffer_load_dwordx4 v[72:75], v6, s[12:15], s29 offen offset:0 sc1
buffer_load_dwordx4 v[76:79], v19, s[12:15], s29 offen offset:0 sc1
buffer_load_dwordx4 v[80:83], v6, s[12:15], s29 offen offset:1024 sc1
buffer_load_dwordx4 v[84:87], v19, s[12:15], s29 offen offset:1024 sc1
s_waitcnt vmcnt(4)
v_max3_u32 v2, v88, v92, v96
v_max3_u32 v2, v2, v100, v104
v_max3_u32 v2, v2, v108, v112
v_max3_u32 v2, v2, v116, v116
v_cmp_eq_u32 vcc, -1, v2
s_cbranch_vccz L_o5_a
buffer_load_dwordx4 v[88:91], v6, s[12:15], s30 offen offset:0 sc1
buffer_load_dwordx4 v[92:95], v19, s[12:15], s30 offen offset:0 sc1
buffer_load_dwordx4 v[96:99], v6, s[12:15], s30 offen offset:1024 sc1
buffer_load_dwordx4 v[100:103], v19, s[12:15], s30 offen offset:1024 sc1
buffer_load_dwordx4 v[104:107], v6, s[12:15], s31 offen offset:0 sc1
buffer_load_dwordx4 v[108:111], v19, s[12:15], s31 offen offset:0 sc1
buffer_load_dwordx4 v[112:115], v6, s[12:15], s31 offen offset:1024 sc1
buffer_load_dwordx4 v[116:119], v19, s[12:15], s31 offen offset:1024 sc1
s_waitcnt vmcnt(8)
s_branch L_o5_b
L_o5_a:
s_waitcnt vmcnt(0)
L_o5_b:
v_max3_u32 v2, v72, v76, v80
v_max_u32 v2, v2, v84
v_cmp_eq_u32 vcc, -1, v2
s_cbranch_vccnz L_o5_rt
s_branch L_o5_ok
L_o6_rt:
s_add_u32 s78, s78, 1
s_cmp_gt_u32 s78, 65536
s_cbranch_scc1 L_o6_ok
buffer_load_dwordx4 v[88:91], v6, s[12:15], s30 offen offset:0 sc1
buffer_load_dwordx4 v[92:95], v19, s[12:15], s30 offen offset:0 sc1
buffer_load_dwordx4 v[96:99], v6, s[12:15], s30 offen offset:1024 sc1
buffer_load_dwordx4 v[100:103], v19, s[12:15], s30 offen offset:1024 sc1
s_waitcnt vmcnt(4)
v_max3_u32 v2, v104, v108, v112
v_max3_u32 v2, v2, v116, v56
v_max3_u32 v2, v2, v60, v64
v_max3_u32 v2, v2, v68, v68
v_cmp_eq_u32 vcc, -1, v2
s_cbranch_vccz L_o6_a
buffer_load_dwordx4 v[104:107], v6, s[12:15], s31 offen offset:0 sc1
buffer_load_dwordx4 v[108:111], v19, s[12:15], s31 offen offset:0 sc1
buffer_load_dwordx4 v[112:115], v6, s[12:15], s31 offen offset:1024 sc1
buffer_load_dwordx4 v[116:119], v19, s[12:15], s31 offen offset:1024 sc1
buffer_load_dwordx4 v[56:59], v6, s[12:15], s32 offen offset:0 sc1
buffer_load_dwordx4 v[60:63], v19, s[12:15], s32 offen offset:0 sc1
buffer_load_dwordx4 v[64:67], v6, s[12:15], s32 offen offset:1024 sc1
buffer_load_dwordx4 v[68:71], v19, s[12:15], s32 offen offset:1024 sc1
s_waitcnt vmcnt(8)
s_branch L_o6_b
L_o6_a:
s_waitcnt vmcnt(0)
L_o6_b:
v_max3_u32 v2, v88, v92, v96
v_max_u32 v2, v2, v100
v_cmp_eq_u32 vcc, -1, v2
s_cbranch_vccnz L_o6_rt
s_branch L_o6_ok
L_o7_rt:
s_add_u32 s78, s78, 1
s_cmp_gt_u32 s78, 65536
s_cbranch_scc1 L_o7_ok
buffer_load_dwordx4 v[104:107], v6, s[12:15], s31 offen offset:0 sc1
buffer_load_dwordx4 v[108:111], v19, s[12:15], s31 offen offset:0 sc1
buffer_load_dwordx4 v[112:115], v6, s[12:15], s31 offen offset:1024 sc1
buffer_load_dwordx4 v[116:119], v19, s[12:15], s31 offen offset:1024 sc1
s_waitcnt vmcnt(4)
v_max3_u32 v2, v56, v60, v64
v_max3_u32 v2, v2, v68, v72
v_max3_u32 v2, v2, v76, v80
v_max3_u32 v2, v2, v84, v84
v_cmp_eq_u32 vcc, -1, v2
s_cbranch_vccz L_o7_a
buffer_load_dwordx4 v[56:59], v6, s[12:15], s32 offen offset:0 sc1
buffer_load_dwordx4 v[60:63], v19, s[12:15], s32 offen offset:0 sc1
buffer_load_dwordx4 v[64:67], v6, s[12:15], s32 offen offset:1024 sc1
buffer_load_dwordx4 v[68:71], v19, s[12:15], s32 offen offset:1024 sc1
buffer_load_dwordx4 v[72:75], v6, s[12:15], s33 offen offset:0 sc1
buffer_load_dwordx4 v[76:79], v19, s[12:15], s33 offen offset:0 sc1
buffer_load_dwordx4 v[80:83], v6, s[12:15], s33 offen offset:1024 sc1
buffer_load_dwordx4 v[84:87], v19, s[12:15], s33 offen offset:1024 sc1
s_waitcnt vmcnt(8)
s_branch L_o7_b
L_o7_a:
s_waitcnt vmcnt(0)
L_o7_b:
v_max3_u32 v2, v104, v108, v112
v_max_u32 v2, v2, v116
v_cmp_eq_u32 vcc, -1, v2
s_cbranch_vccnz L_o7_rt
s_branch L_o7_ok
L_o8_rt:
s_add_u32 s78, s78, 1
s_cmp_gt_u32 s78, 65536
s_cbranch_scc1 L_o8_ok
buffer_load_dwordx4 v[56:59], v6, s[12:15], s32 offen offset:0 sc1
buffer_load_dwordx4 v[60:63], v19, s[12:15], s32 offen offset:0 sc1
buffer_load_dwordx4 v[64:67], v6, s[12:15], s32 offen offset:1024 sc1
buffer_load_dwordx4 v[68:71], v19, s[12:15], s32 offen offset:1024 sc1
s_waitcnt vmcnt(4)
v_max3_u32 v2, v72, v76, v80
v_max3_u32 v2, v2, v84, v88
v_max3_u32 v2, v2, v92, v96
v_max3_u32 v2, v2, v100, v100
v_cmp_eq_u32 vcc, -1, v2
s_cbranch_vccz L_o8_a
buffer_load_dwordx4 v[72:75], v6, s[12:15], s33 offen offset:0 sc1
buffer_load_dwordx4 v[76:79], v19, s[12:15], s33 offen offset:0 sc1
buffer_load_dwordx4 v[80:83], v6, s[12:15], s33 offen offset:1024 sc1
buffer_load_dwordx4 v[84:87], v19, s[12:15], s33 offen offset:1024 sc1
buffer_load_dwordx4 v[88:91], v6, s[12:15], s34 offen offset:0 sc1
buffer_load_dwordx4 v[92:95], v19, s[12:15], s34 offen offset:0 sc1
buffer_load_dwordx4 v[96:99], v6, s[12:15], s34 offen offset:1024 sc1
buffer_load_dwordx4 v[100:103], v19, s[12:15], s34 offen offset:1024 sc1
s_waitcnt vmcnt(8)
s_branch L_o8_b
L_o8_a:
s_waitcnt vmcnt(0)
L_o8_b:
v_max3_u32 v2, v56, v60, v64
v_max_u32 v2, v2, v68
v_cmp_eq_u32 vcc, -1, v2
s_cbranch_vccnz L_o8_rt
s_branch L_o8_ok
L_o9_rt:
s_add_u32 s78, s78, 1
s_cmp_gt_u32 s78, 65536
s_cbranch_scc1 L_o9_ok
buffer_load_dwordx4 v[72:75], v6, s[12:15], s33 offen offset:0 sc1
buffer_load_dwordx4 v[76:79], v19, s[12:15], s33 offen offset:0 sc1
buffer_load_dwordx4 v[80:83], v6, s[12:15], s33 offen offset:1024 sc1
buffer_load_dwordx4 v[84:87], v19, s[12:15], s33 offen offset:1024 sc1
s_waitcnt vmcnt(4)
v_max3_u32 v2, v88, v92, v96
v_max3_u32 v2, v2, v100, v104
v_max3_u32 v2, v2, v108, v112
v_max3_u32 v2, v2, v116, v116
v_cmp_eq_u32 vcc, -1, v2
s_cbranch_vccz L_o9_a
buffer_load_dwordx4 v[88:91], v6, s[12:15], s34 offen offset:0 sc1
buffer_load_dwordx4 v[92:95], v19, s[12:15], s34 offen offset:0 sc1
buffer_load_dwordx4 v[96:99], v6, s[12:15], s34 offen offset:1024 sc1
buffer_load_dwordx4 v[100:103], v19, s[12:15], s34 offen offset:1024 sc1
buffer_load_dwordx4 v[104:107], v6, s[12:15], s35 offen offset:0 sc1
buffer_load_dwordx4 v[108:111], v19, s[12:15], s35 offen offset:0 sc1
buffer_load_dwordx4 v[112:115], v6, s[12:15], s35 offen offset:1024 sc1
buffer_load_dwordx4 v[116:119], v19, s[12:15], s35 offen offset:1024 sc1
s_waitcnt vmcnt(8)
s_branch L_o9_b
L_o9_a:
s_waitcnt vmcnt(0)
L_o9_b:
v_max3_u32 v2, v72, v76, v80
v_max_u32 v2, v2, v84
v_cmp_eq_u32 vcc, -1, v2
s_cbranch_vccnz L_o9_rt
s_branch L_o9_ok
L_o10_rt:
s_add_u32 s78, s78, 1
s_cmp_gt_u32 s78, 65536
s_cbranch_scc1 L_o10_ok
buffer_load_dwordx4 v[88:91], v6, s[12:15], s34 offen offset:0 sc1
buffer_load_dwordx4 v[92:95], v19, s[12:15], s34 offen offset:0 sc1
buffer_load_dwordx4 v[96:99], v6, s[12:15], s34 offen offset:1024 sc1
buffer_load_dwordx4 v[100:103], v19, s[12:15], s34 offen offset:1024 sc1
s_waitcnt vmcnt(4)
v_max3_u32 v2, v104, v108, v112
v_max3_u32 v2, v2, v116, v56
v_max3_u32 v2, v2, v60, v64
v_max3_u32 v2, v2, v68, v68
v_cmp_eq_u32 vcc, -1, v2
s_cbranch_vccz L_o10_a
buffer_load_dwordx4 v[104:107], v6, s[12:15], s35 offen offset:0 sc1
buffer_load_dwordx4 v[108:111], v19, s[12:15], s35 offen offset:0 sc1
buffer_load_dwordx4 v[112:115], v6, s[12:15], s35 offen offset:1024 sc1
buffer_load_dwordx4 v[116:119], v19, s[12:15], s35 offen offset:1024 sc1
buffer_load_dwordx4 v[56:59], v6, s[12:15], s36 offen offset:0 sc1
buffer_load_dwordx4 v[60:63], v19, s[12:15], s36 offen offset:0 sc1
buffer_load_dwordx4 v[64:67], v6, s[12:15], s36 offen offset:1024 sc1
buffer_load_dwordx4 v[68:71], v19, s[12:15], s36 offen offset:1024 sc1
s_waitcnt vmcnt(8)
s_branch L_o10_b
L_o10_a:
s_waitcnt vmcnt(0)
L_o10_b:
v_max3_u32 v2, v88, v92, v96
v_max_u32 v2, v2, v100
v_cmp_eq_u32 vcc, -1, v2
s_cbranch_vccnz L_o10_rt
s_branch L_o10_ok
L_o11_rt:
s_add_u32 s78, s78, 1
s_cmp_gt_u32 s78, 65536
s_cbranch_scc1 L_o11_ok
buffer_load_dwordx4 v[104:107], v6, s[12:15], s35 offen offset:0 sc1
buffer_load_dwordx4 v[108:111], v19, s[12:15], s35 offen offset:0 sc1
buffer_load_dwordx4 v[112:115], v6, s[12:15], s35 offen offset:1024 sc1
buffer_load_dwordx4 v[116:119], v19, s[12:15], s35 offen offset:1024 sc1
s_waitcnt vmcnt(4)
v_max3_u32 v2, v56, v60, v64
v_max3_u32 v2, v2, v68, v72
v_max3_u32 v2, v2, v76, v80
v_max3_u32 v2, v2, v84, v84
v_cmp_eq_u32 vcc, -1, v2
s_cbranch_vccz L_o11_a
buffer_load_dwordx4 v[56:59], v6, s[12:15], s36 offen offset:0 sc1
buffer_load_dwordx4 v[60:63], v19, s[12:15], s36 offen offset:0 sc1
buffer_load_dwordx4 v[64:67], v6, s[12:15], s36 offen offset:1024 sc1
buffer_load_dwordx4 v[68:71], v19, s[12:15], s36 offen offset:1024 sc1
buffer_load_dwordx4 v[72:75], v6, s[12:15], s37 offen offset:0 sc1
buffer_load_dwordx4 v[76:79], v19, s[12:15], s37 offen offset:0 sc1
buffer_load_dwordx4 v[80:83], v6, s[12:15], s37 offen offset:1024 sc1
buffer_load_dwordx4 v[84:87], v19, s[12:15], s37 offen offset:1024 sc1
s_waitcnt vmcnt(8)
s_branch L_o11_b
L_o11_a:
s_waitcnt vmcnt(0)
L_o11_b:
v_max3_u32 v2, v104, v108, v112
v_max_u32 v2, v2, v116
v_cmp_eq_u32 vcc, -1, v2
s_cbranch_vccnz L_o11_rt
s_branch L_o11_ok
L_o12_rt:
s_add_u32 s78, s78, 1
s_cmp_gt_u32 s78, 65536
s_cbranch_scc1 L_o12_ok
buffer_load_dwordx4 v[56:59], v6, s[12:15], s36 offen offset:0 sc1
buffer_load_dwordx4 v[60:63], v19, s[12:15], s36 offen offset:0 sc1
buffer_load_dwordx4 v[64:67], v6, s[12:15], s36 offen offset:1024 sc1
buffer_load_dwordx4 v[68:71], v19, s[12:15], s36 offen offset:1024 sc1
s_waitcnt vmcnt(4)
v_max3_u32 v2, v72, v76, v80
v_max3_u32 v2, v2, v84, v88
v_max3_u32 v2, v2, v92, v96
v_max3_u32 v2, v2, v100, v100
v_cmp_eq_u32 vcc, -1, v2
s_cbranch_vccz L_o12_a
buffer_load_dwordx4 v[72:75], v6, s[12:15], s37 offen offset:0 sc1
buffer_load_dwordx4 v[76:79], v19, s[12:15], s37 offen offset:0 sc1
buffer_load_dwordx4 v[80:83], v6, s[12:15], s37 offen offset:1024 sc1
buffer_load_dwordx4 v[84:87], v19, s[12:15], s37 offen offset:1024 sc1
buffer_load_dwordx4 v[88:91], v6, s[12:15], s38 offen offset:0 sc1
buffer_load_dwordx4 v[92:95], v19, s[12:15], s38 offen offset:0 sc1
buffer_load_dwordx4 v[96:99], v6, s[12:15], s38 offen offset:1024 sc1
buffer_load_dwordx4 v[100:103], v19, s[12:15], s38 offen offset:1024 sc1
s_waitcnt vmcnt(8)
s_branch L_o12_b
L_o12_a:
s_waitcnt vmcnt(0)
L_o12_b:
v_max3_u32 v2, v56, v60, v64
v_max_u32 v2, v2, v68
v_cmp_eq_u32 vcc, -1, v2
s_cbranch_vccnz L_o12_rt
s_branch L_o12_ok
L_o13_rt:
s_add_u32 s78, s78, 1
s_cmp_gt_u32 s78, 65536
s_cbranch_scc1 L_o13_ok
buffer_load_dwordx4 v[72:75], v6, s[12:15], s37 offen offset:0 sc1
buffer_load_dwordx4 v[76:79], v19, s[12:15], s37 offen offset:0 sc1
buffer_load_dwordx4 v[80:83], v6, s[12:15], s37 offen offset:1024 sc1
buffer_load_dwordx4 v[84:87], v19, s[12:15], s37 offen offset:1024 sc1
s_waitcnt vmcnt(4)
v_max3_u32 v2, v88, v92, v96
v_max3_u32 v2, v2, v100, v104
v_max3_u32 v2, v2, v108, v112
v_max3_u32 v2, v2, v116, v116
v_cmp_eq_u32 vcc, -1, v2
s_cbranch_vccz L_o13_a
buffer_load_dwordx4 v[88:91], v6, s[12:15], s38 offen offset:0 sc1
buffer_load_dwordx4 v[92:95], v19, s[12:15], s38 offen offset:0 sc1
buffer_load_dwordx4 v[96:99], v6, s[12:15], s38 offen offset:1024 sc1
buffer_load_dwordx4 v[100:103], v19, s[12:15], s38 offen offset:1024 sc1
buffer_load_dwordx4 v[104:107], v6, s[12:15], s39 offen offset:0 sc1
buffer_load_dwordx4 v[108:111], v19, s[12:15], s39 offen offset:0 sc1
buffer_load_dwordx4 v[112:115], v6, s[12:15], s39 offen offset:1024 sc1
buffer_load_dwordx4 v[116:119], v19, s[12:15], s39 offen offset:1024 sc1
s_waitcnt vmcnt(8)
s_branch L_o13_b
L_o13_a:
s_waitcnt vmcnt(0)
L_o13_b:
v_max3_u32 v2, v72, v76, v80
v_max_u32 v2, v2, v84
v_cmp_eq_u32 vcc, -1, v2
s_cbranch_vccnz L_o13_rt
s_branch L_o13_ok
L_o14_rt:
s_add_u32 s78, s78, 1
s_cmp_gt_u32 s78, 65536
s_cbranch_scc1 L_o14_ok
buffer_load_dwordx4 v[88:91], v6, s[12:15], s38 offen offset:0 sc1
buffer_load_dwordx4 v[92:95], v19, s[12:15], s38 offen offset:0 sc1
buffer_load_dwordx4 v[96:99], v6, s[12:15], s38 offen offset:1024 sc1
buffer_load_dwordx4 v[100:103], v19, s[12:15], s38 offen offset:1024 sc1
s_waitcnt vmcnt(4)
v_max3_u32 v2, v104, v108, v112
v_max3_u32 v2, v2, v116, v116
v_cmp_eq_u32 vcc, -1, v2
s_cbranch_vccz L_o14_a
buffer_load_dwordx4 v[104:107], v6, s[12:15], s39 offen offset:0 sc1
buffer_load_dwordx4 v[108:111], v19, s[12:15], s39 offen offset:0 sc1
buffer_load_dwordx4 v[112:115], v6, s[12:15], s39 offen offset:1024 sc1
buffer_load_dwordx4 v[116:119], v19, s[12:15], s39 offen offset:1024 sc1
s_waitcnt vmcnt(4)
s_branch L_o14_b
L_o14_a:
s_waitcnt vmcnt(0)
L_o14_b:
v_max3_u32 v2, v88, v92, v96
v_max_u32 v2, v2, v100
v_cmp_eq_u32 vcc, -1, v2
s_cbranch_vccnz L_o14_rt
s_branch L_o14_ok
L_o15_rt:
s_add_u32 s78, s78, 1
s_cmp_gt_u32 s78, 65536
s_cbranch_scc1 L_o15_ok
buffer_load_dwordx4 v[104:107], v6, s[12:15], s39 offen offset:0 sc1
buffer_load_dwordx4 v[108:111], v19, s[12:15], s39 offen offset:0 sc1
buffer_load_dwordx4 v[112:115], v6, s[12:15], s39 offen offset:1024 sc1
buffer_load_dwordx4 v[116:119], v19, s[12:15], s39 offen offset:1024 sc1
s_waitcnt vmcnt(0)
L_o15_b:
v_max3_u32 v2, v104, v108, v112
v_max_u32 v2, v2, v116
v_cmp_eq_u32 vcc, -1, v2
s_cbranch_vccnz L_o15_rt
s_branch L_o15_ok
L_stp_s:
buffer_store_dwordx4 v[72:75], v144, s[12:15], s72 offen offset:0 sc1
buffer_store_dwordx4 v[76:79], v144, s[12:15], s72 offen offset:256 sc1
s_branch L_stp_d
L_pad17:
s_branch L_retG
L_st_rt:
s_add_u32 s78, s78, 1
s_cmp_gt_u32 s78, 65536
s_cbranch_scc1 L_st_ok
v_cmp_ne_u32 vcc, s68, v99
s_cbranch_vccz L_st_p0
s_add_u32 s70, s75, 0
buffer_load_dwordx4 v[96:99], v145, s[12:15], s70 offen sc1
L_st_p0:
v_cmp_ne_u32 vcc, s68, v103
s_cbranch_vccz L_st_p1
s_add_u32 s70, s75, 4096
buffer_load_dwordx4 v[100:103], v145, s[12:15], s70 offen sc1
L_st_p1:
v_cmp_ne_u32 vcc, s68, v107
s_cbranch_vccz L_st_p2
s_add_u32 s70, s75, 8192
buffer_load_dwordx4 v[104:107], v145, s[12:15], s70 offen sc1
L_st_p2:
v_cmp_ne_u32 vcc, s68, v111
s_cbranch_vccz L_st_p3
s_add_u32 s70, s75, 12288
buffer_load_dwordx4 v[108:111], v145, s[12:15], s70 offen sc1
L_st_p3:
s_branch L_over18
L_pad18:
s_branch L_retG
L_over18:
v_cmp_ne_u32 vcc, s68, v115
s_cbranch_vccz L_st_p4
s_add_u32 s70, s75, 16384
buffer_load_dwordx4 v[112:115], v145, s[12:15], s70 offen sc1
L_st_p4:
v_cmp_ne_u32 vcc, s68, v119
s_cbranch_vccz L_st_p5
s_add_u32 s70, s75, 20480
buffer_load_dwordx4 v[116:119], v145, s[12:15], s70 offen sc1
L_st_p5:
v_cmp_ne_u32 vcc, s68, v123
s_cbranch_vccz L_st_p6
s_add_u32 s70, s75, 24576
buffer_load_dwordx4 v[120:123], v145, s[12:15], s70 offen sc1
L_st_p6:
v_cmp_ne_u32 vcc, s68, v127
s_cbranch_vccz L_st_p7
s_add_u32 s70, s75, 28672
buffer_load_dwordx4 v[124:127], v145, s[12:15], s70 offen sc1
L_st_p7:
s_waitcnt vmcnt(0)
s_branch L_st_chk
L_fin:
.section .rodata,"a"
.p2align 6
.amdhsa_kernel sequential_preLN__linear_attn_block__moe_arch_mod__prompt_kernel
  .amdhsa_next_free_vgpr 256
  .amdhsa_next_free_sgpr 102
  .amdhsa_accum_offset 152
  .amdhsa_group_segment_fixed_size 0
  .amdhsa_kernarg_size 88
  .amdhsa_user_sgpr_count 2
  .amdhsa_user_sgpr_kernarg_segment_ptr 1
  .amdhsa_system_sgpr_workgroup_id_x 1
  .amdhsa_float_denorm_mode_32 3
.end_amdhsa_kernel
```

```asm
; @launch grid=(256,1,1) block=(512,1,1) lds=163840
.amdgcn_target "amdgcn-amd-amdhsa--gfx950"
.text
.p2alignl 12, 0xbf810000
.fill 832, 4, 0xbf810000
.globl sequential_preLN__linear_attn_block__moe_arch_mod__prompt_kernel
.p2align 8
.type sequential_preLN__linear_attn_block__moe_arch_mod__prompt_kernel,@function
sequential_preLN__linear_attn_block__moe_arch_mod__prompt_kernel:
s_cmp_ge_u32 s2, 256
s_cbranch_scc1 L_end
s_load_dwordx16 s[40:55], s[0:1], 0
s_load_dwordx2 s[56:57], s[0:1], 64
s_load_dwordx2 s[58:59], s[0:1], 80
s_getpc_b64 s[20:21]
L_pc:
s_sub_u32 s20, s20, L_pc-sequential_preLN__linear_attn_block__moe_arch_mod__prompt_kernel
s_subb_u32 s21, s21, 0
s_and_b32 s21, s21, 0xffff
s_mov_b32 s22, L_fin-sequential_preLN__linear_attn_block__moe_arch_mod__prompt_kernel
s_mov_b32 s23, 0x20000
s_lshr_b32 s70, s2, 3
s_mul_i32 s70, s70, 1536
v_lshlrev_b32 v81, 7, v0
v_cmp_gt_u32 vcc, 12, v0
s_nop 0
s_mov_b64 exec, vcc
buffer_load_dword v81, v81, s[20:23], s70 offen
s_mov_b64 exec, -1
v_lshrrev_b32 v2, 6, v0
v_and_b32 v1, 63, v0
v_readfirstlane_b32 s60, v2
s_and_b32 s62, s2, 7
s_lshr_b32 s63, s2, 3
s_lshl_b32 s64, s62, 1
s_and_b32 s70, s63, 1
s_add_u32 s64, s64, s70
s_lshr_b32 s65, s63, 1
s_lshl_b32 s79, s64, 4
s_add_u32 s79, s79, s65
s_mov_b32 s78, 0
s_mov_b32 s89, s65
s_lshr_b32 s61, s60, 2
s_and_b32 s60, s60, 3
s_lshr_b32 s66, s60, 1
s_and_b32 s67, s60, 1
v_lshlrev_b32 v16, 4, v1
s_cmp_eq_u32 s61, 0
s_cbranch_scc1 L_compute
s_setprio 1
v_mov_b32 v18, v16
s_lshl_b32 s70, s65, 2
s_add_u32 s70, s70, s60
s_lshl_b32 s70, s70, 16
v_lshrrev_b32 v2, 3, v1
v_lshlrev_b32 v5, 11, v2
v_add_u32 v5, s70, v5
v_lshrrev_b32 v3, 4, v1
v_and_b32 v4, 7, v1
v_xor_b32 v3, v3, v4
v_xor_b32 v6, 0, v3
v_lshl_add_u32 v6, v6, 4, v5
v_add_u32 v8, 0, v6
v_xor_b32 v6, 4, v3
v_lshl_add_u32 v6, v6, 4, v5
v_add_u32 v9, 15360, v6
v_xor_b32 v6, 0, v3
v_lshl_add_u32 v6, v6, 4, v5
v_add_u32 v10, 30720, v6
v_xor_b32 v6, 4, v3
v_lshl_add_u32 v6, v6, 4, v5
v_add_u32 v11, 46080, v6
s_lshl_b32 s70, s60, 4
v_add_u32 v5, s70, v2
v_mul_u32_u24 v5, 6144, v5
s_lshl_b32 s70, s64, 7
v_add_u32 v5, s70, v5
v_bfe_u32 v3, v1, 4, 1
v_lshlrev_b32 v3, 1, v3
v_xor_b32 v3, v3, v4
v_xor_b32 v6, 0, v3
v_lshl_add_u32 v6, v6, 4, v5
v_add_u32 v12, 0, v6
v_xor_b32 v6, 4, v3
v_lshl_add_u32 v6, v6, 4, v5
v_add_u32 v13, 48128, v6
v_xor_b32 v6, 0, v3
v_lshl_add_u32 v6, v6, 4, v5
v_add_u32 v14, 0, v6
v_xor_b32 v6, 4, v3
v_lshl_add_u32 v6, v6, 4, v5
v_add_u32 v15, 48128, v6
v_xor_b32 v6, 0, v3
v_lshl_add_u32 v6, v6, 4, v5
v_add_u32 v16, 4096, v6
v_xor_b32 v6, 4, v3
v_lshl_add_u32 v6, v6, 4, v5
v_add_u32 v17, 52224, v6
s_lshl_b32 s76, s60, 12
s_mul_i32 s77, s60, 6144
s_and_b32 s70, s64, 1
s_lshl_b32 s70, s70, 3
s_mov_b32 s70, 0
s_andn2_b32 s71, s65, 1
s_add_u32 s70, s70, s71
s_and_b32 s70, s70, 15
s_mul_i32 s75, s70, 393216
s_lshl_b32 s74, s70, 7
s_waitcnt lgkmcnt(0)
s_load_dword s68, s[58:59], 0
s_mov_b32 s4, s40
s_and_b32 s5, s41, 0xffff
s_mov_b32 s6, 4194304
s_mov_b32 s7, 0x20000
s_mov_b32 s8, s42
s_and_b32 s9, s43, 0xffff
s_mov_b32 s10, 6291456
s_mov_b32 s11, 0x20000
s_add_u32 m0, s76, 122880
s_nop 0
buffer_load_dwordx4 v8, s[4:7], s74 offen offset:0 lds
buffer_load_dwordx4 v9, s[4:7], s74 offen offset:1024 lds
buffer_load_dwordx4 v10, s[4:7], s74 offen offset:2048 lds
buffer_load_dwordx4 v11, s[4:7], s74 offen offset:3072 lds
s_add_u32 s74, s74, 128
s_and_b32 s74, s74, 2047
s_add_u32 m0, s77, 0
s_nop 0
buffer_load_dwordx4 v12, s[8:11], s75 offen offset:0 lds
buffer_load_dwordx4 v13, s[8:11], s75 offen offset:1024 lds
buffer_load_dwordx4 v14, s[8:11], s75 offen offset:2048 lds
buffer_load_dwordx4 v15, s[8:11], s75 offen offset:3072 lds
s_add_u32 m0, s77, 4096
s_nop 0
buffer_load_dwordx4 v16, s[8:11], s75 offen offset:0 lds
buffer_load_dwordx4 v17, s[8:11], s75 offen offset:1024 lds
s_add_u32 s75, s75, 393216
s_cmp_eq_u32 s75, 6291456
s_cselect_b32 s75, 0, s75
s_mov_b32 s12, s58
s_and_b32 s13, s59, 0xffff
s_mov_b32 s14, 268435456
s_mov_b32 s15, 0x20000
s_mov_b32 s16, s44
s_and_b32 s17, s45, 0xffff
s_mov_b32 s18, 2097152
s_mov_b32 s19, 0x20000
s_mov_b32 s20, s56
s_and_b32 s21, s57, 0xffff
s_mov_b32 s22, 4194304
s_mov_b32 s23, 0x20000
s_mov_b32 s24, s50
s_and_b32 s25, s51, 0xffff
s_mov_b32 s26, 7340032
s_mov_b32 s27, 0x20000
s_mov_b32 s28, s52
s_and_b32 s29, s53, 0xffff
s_mov_b32 s30, 7340032
s_mov_b32 s31, 0x20000
s_mov_b32 s32, s54
s_and_b32 s33, s55, 0xffff
s_mov_b32 s34, 7340032
s_mov_b32 s35, 0x20000
s_mov_b32 s36, s48
s_and_b32 s37, s49, 0xffff
s_mov_b32 s38, 2048
s_mov_b32 s39, 0x20000
s_lshl_b32 s70, s65, 7
s_lshl_b32 s71, s64, 3
s_add_u32 s70, s70, s71
s_lshl_b32 s71, s60, 1
s_add_u32 s87, s70, s71
v_lshrrev_b32 v2, 3, v1
v_lshlrev_b32 v3, 11, v2
v_bfe_u32 v5, v1, 4, 2
v_lshlrev_b32 v5, 1, v5
v_and_b32 v4, 7, v1
v_xor_b32 v5, v5, v4
v_lshl_add_u32 v3, v5, 4, v3
s_lshl_b32 s70, s65, 7
v_add_u32 v80, s70, v3
v_mov_b32 v72, -1
v_mov_b32 v73, -1
v_mov_b32 v74, -1
v_mov_b32 v75, -1
s_mul_i32 s80, s79, 4352
s_add_u32 s80, s80, 524288
s_and_b32 s81, s65, 7
s_lshl_b32 s81, s81, 19
s_lshr_b32 s70, s65, 1
s_xor_b32 s70, s70, s65
s_and_b32 s70, s70, 4
s_lshl_b32 s70, s70, 11
s_xor_b32 s70, s70, 2105344
s_add_u32 s81, s81, s70
s_mul_i32 s70, s66, 262144
s_add_u32 s81, s81, s70
s_lshr_b32 s70, s64, 2
s_lshl_b32 s70, s70, 14
s_add_u32 s81, s81, s70
s_and_b32 s70, s64, 3
s_lshl_b32 s70, s70, 11
s_add_u32 s81, s81, s70
s_lshl_b32 s70, s67, 10
s_add_u32 s81, s81, s70
s_mov_b32 s72, 0x6543e210
s_mov_b32 s73, 0xdcbaf987
s_lshl_b32 s70, s64, 2
s_lshr_b64 s[72:73], s[72:73], s70
s_and_b32 s3, s72, 15
v_mul_u32_u24 v76, 7168, v2
v_lshl_add_u32 v76, v4, 4, v76
v_lshlrev_b32 v77, 11, v2
v_lshl_add_u32 v77, v4, 4, v77
s_and_b32 s70, s65, 3
s_lshl_b32 s70, s70, 2
s_add_u32 s70, s70, s60
s_mul_i32 s85, s70, 458752
s_lshl_b32 s70, s3, 9
s_add_u32 s85, s85, s70
s_lshr_b32 s70, s65, 2
s_lshl_b32 s70, s70, 7
s_xor_b32 s71, s70, 128
v_add_u32 v78, s71, v76
v_add_u32 v76, s70, v76
s_and_b32 s70, s65, 3
s_lshl2_add_u32 s70, s3, s70
s_and_b32 s71, s65, 12
s_add_u32 s71, s71, s60
s_lshl_b32 s86, s70, 17
s_lshl_b32 s70, s71, 7
s_add_u32 s86, s86, s70
s_cmp_lt_u32 s3, 14
s_cselect_b32 s26, s26, 0
s_cselect_b32 s30, s30, 0
s_cselect_b32 s34, s34, 0
s_mov_b32 s90, 0x10001
s_movk_i32 s91, 0xff
v_mov_b32 v79, 0
s_lshl_b32 s70, s87, 4
s_add_u32 s70, s70, 8192
v_writelane_b32 v79, s70, 0
s_lshl_b32 s70, s79, 4
s_add_u32 s70, s70, 4096
v_writelane_b32 v79, s70, 1
s_lshl_b32 s70, s64, 7
s_add_u32 s70, s70, 6815744
v_writelane_b32 v79, s70, 2
s_lshl_b32 s70, s79, 10
s_add_u32 s70, s70, 65536
v_writelane_b32 v79, s70, 3
s_lshl_b32 s70, s60, 10
s_add_u32 s70, s70, s80
v_writelane_b32 v79, s70, 4
s_lshl_b32 s70, s67, 7
s_add_u32 s70, s70, s80
s_add_u32 s70, s70, 4096
v_writelane_b32 v79, s70, 5
s_and_b32 s71, s65, 3
s_lshl2_add_u32 s71, s3, s71
s_and_b32 s70, s65, 12
s_add_u32 s70, s70, s60
s_lshl_b32 s71, s71, 7
s_bitcmp1_b32 s70, 3
s_cselect_b32 s72, 0, 8192
s_add_u32 s71, s71, s72
s_and_b32 s70, s70, 7
s_lshl_b32 s70, s70, 16
s_add_u32 s70, s70, s71
s_add_u32 s70, s70, 7340032
v_writelane_b32 v79, s70, 6
s_lshl_b32 s71, s79, 2
s_add_u32 s71, s71, s60
s_lshl_b32 s70, s71, 9
s_add_u32 s70, s70, 6291456
v_writelane_b32 v79, s70, 7
s_lshl_b32 s71, s79, 2
s_add_u32 s71, s71, s60
s_lshl_b32 s70, s71, 8
s_add_u32 s70, s70, 6946816
v_writelane_b32 v79, s70, 8
s_add_u32 s70, s81, 0
v_writelane_b32 v79, s70, 9
s_add_u32 s70, s81, 65536
v_writelane_b32 v79, s70, 10
s_add_u32 s70, s81, 131072
v_writelane_b32 v79, s70, 11
s_add_u32 s70, s81, 196608
v_writelane_b32 v79, s70, 12
s_and_b32 s70, s65, 7
s_min_u32 s71, s60, 0
s_lshl_b32 s71, s71, 3
s_add_u32 s70, s70, s71
s_lshl_b32 s70, s70, 4
s_add_u32 s70, s70, s64
s_lshl_b32 s70, s70, 7
s_add_u32 s70, s70, 6815744
v_writelane_b32 v79, s70, 2
v_and_b32 v2, 7, v1
v_lshlrev_b32 v2, 7, v2
v_lshrrev_b32 v3, 3, v1
v_lshl_add_u32 v83, v3, 16, v2
v_add_u32 v83, s81, v83
s_mov_b32 exec_lo, 0
s_and_b32 s71, s65, 3
s_lshl2_add_u32 s71, s3, s71
s_and_b32 s70, s65, 12
s_add_u32 s70, s70, s60
s_lshl_b32 s71, s71, 7
s_bitcmp1_b32 s70, 3
s_cselect_b32 s72, 0, 8192
s_add_u32 s71, s71, s72
s_and_b32 s70, s70, 7
s_lshl_b32 s70, s70, 16
s_add_u32 s70, s70, s71
s_add_u32 s70, s70, 7340032
s_mov_b32 exec_hi, 0xff
v_and_b32 v2, 3, v1
v_lshl_add_u32 v83, v2, 14, s70
s_lshl_b32 s70, s60, 10
s_add_u32 s70, s70, s80
s_mov_b32 exec_hi, 0xff0000
v_and_b32 v2, 7, v1
v_lshl_add_u32 v83, v2, 7, s70
s_lshl_b32 s71, s79, 2
s_add_u32 s71, s71, s60
s_lshl_b32 s70, s71, 9
s_add_u32 s70, s70, 6291456
s_mov_b32 exec_hi, 0xf000000
v_and_b32 v2, 3, v1
v_lshl_add_u32 v83, v2, 7, s70
s_lshl_b32 s71, s79, 2
s_add_u32 s71, s71, s60
s_lshl_b32 s70, s71, 8
s_add_u32 s70, s70, 6946816
s_mov_b32 exec_hi, 0x30000000
v_and_b32 v2, 1, v1
v_lshl_add_u32 v83, v2, 7, s70
s_lshl_b32 s70, s67, 7
s_add_u32 s70, s70, s80
s_add_u32 s70, s70, 4096
s_mov_b32 exec_hi, 0xc0000000
v_and_b32 v2, 0, v1
v_lshl_add_u32 v83, v2, 7, s70
s_mov_b64 exec, -1
s_add_u32 m0, s76, 106496
s_nop 0
buffer_load_dwordx4 v8, s[4:7], s74 offen offset:0 lds
buffer_load_dwordx4 v9, s[4:7], s74 offen offset:1024 lds
buffer_load_dwordx4 v10, s[4:7], s74 offen offset:2048 lds
buffer_load_dwordx4 v11, s[4:7], s74 offen offset:3072 lds
s_add_u32 s74, s74, 128
s_and_b32 s74, s74, 2047
s_add_u32 m0, s77, 81920
s_nop 0
buffer_load_dwordx4 v12, s[8:11], s75 offen offset:0 lds
buffer_load_dwordx4 v13, s[8:11], s75 offen offset:1024 lds
buffer_load_dwordx4 v14, s[8:11], s75 offen offset:2048 lds
buffer_load_dwordx4 v15, s[8:11], s75 offen offset:3072 lds
s_add_u32 m0, s77, 86016
s_nop 0
buffer_load_dwordx4 v16, s[8:11], s75 offen offset:0 lds
buffer_load_dwordx4 v17, s[8:11], s75 offen offset:1024 lds
s_add_u32 s75, s75, 393216
s_cmp_eq_u32 s75, 6291456
s_cselect_b32 s75, 0, s75
s_waitcnt vmcnt(10)
s_barrier
s_add_u32 m0, s76, 65536
s_nop 0
buffer_load_dwordx4 v8, s[4:7], s74 offen offset:0 lds
buffer_load_dwordx4 v9, s[4:7], s74 offen offset:1024 lds
buffer_load_dwordx4 v10, s[4:7], s74 offen offset:2048 lds
buffer_load_dwordx4 v11, s[4:7], s74 offen offset:3072 lds
s_add_u32 s74, s74, 128
s_and_b32 s74, s74, 2047
s_add_u32 m0, s77, 40960
s_nop 0
buffer_load_dwordx4 v12, s[8:11], s75 offen offset:0 lds
buffer_load_dwordx4 v13, s[8:11], s75 offen offset:1024 lds
buffer_load_dwordx4 v14, s[8:11], s75 offen offset:2048 lds
buffer_load_dwordx4 v15, s[8:11], s75 offen offset:3072 lds
s_add_u32 m0, s77, 45056
s_nop 0
buffer_load_dwordx4 v16, s[8:11], s75 offen offset:0 lds
buffer_load_dwordx4 v17, s[8:11], s75 offen offset:1024 lds
s_add_u32 s75, s75, 393216
s_cmp_eq_u32 s75, 6291456
s_cselect_b32 s75, 0, s75
s_waitcnt vmcnt(10)
s_barrier
s_add_u32 m0, s76, 24576
s_nop 0
buffer_load_dwordx4 v8, s[4:7], s74 offen offset:0 lds
buffer_load_dwordx4 v9, s[4:7], s74 offen offset:1024 lds
buffer_load_dwordx4 v10, s[4:7], s74 offen offset:2048 lds
buffer_load_dwordx4 v11, s[4:7], s74 offen offset:3072 lds
s_add_u32 s74, s74, 128
s_and_b32 s74, s74, 2047
s_add_u32 m0, s77, 0
s_nop 0
buffer_load_dwordx4 v12, s[8:11], s75 offen offset:0 lds
buffer_load_dwordx4 v13, s[8:11], s75 offen offset:1024 lds
buffer_load_dwordx4 v14, s[8:11], s75 offen offset:2048 lds
buffer_load_dwordx4 v15, s[8:11], s75 offen offset:3072 lds
s_add_u32 m0, s77, 4096
s_nop 0
buffer_load_dwordx4 v16, s[8:11], s75 offen offset:0 lds
buffer_load_dwordx4 v17, s[8:11], s75 offen offset:1024 lds
s_add_u32 s75, s75, 393216
s_cmp_eq_u32 s75, 6291456
s_cselect_b32 s75, 0, s75
s_add_u32 m0, s76, 122880
s_nop 0
buffer_load_dwordx4 v8, s[4:7], s74 offen offset:0 lds
buffer_load_dwordx4 v9, s[4:7], s74 offen offset:1024 lds
buffer_load_dwordx4 v10, s[4:7], s74 offen offset:2048 lds
buffer_load_dwordx4 v11, s[4:7], s74 offen offset:3072 lds
s_add_u32 s74, s74, 128
s_and_b32 s74, s74, 2047
v_lshlrev_b32 v2, 3, v1
s_lshl_b32 s70, s60, 9
buffer_load_dwordx2 v[88:89], v2, s[36:39], s70 offen
s_lshl_b32 s70, s87, 11
buffer_load_dwordx4 v[20:23], v18, s[4:7], s70 offen offset:0
s_lshl_b32 s70, s87, 11
buffer_load_dwordx4 v[24:27], v18, s[4:7], s70 offen offset:1024
s_lshl_b32 s70, s87, 11
buffer_load_dwordx4 v[28:31], v18, s[4:7], s70 offen offset:2048
s_lshl_b32 s70, s87, 11
buffer_load_dwordx4 v[32:35], v18, s[4:7], s70 offen offset:3072
s_mov_b64 exec, 0x1ef
buffer_load_dword v81, v79, s[12:15], 0 offen
s_mov_b64 exec, -1
s_lshl_b32 s70, s64, 2
s_add_u32 s70, s70, s60
s_lshl_b32 s70, s70, 15
s_lshl_b32 s71, s65, 7
s_add_u32 s70, s70, s71
s_add_u32 s70, s70, 8388608
v_and_b32 v19, 0xf800, v77
v_mad_u32_u24 v19, v19, 3, v77
s_mov_b32 exec_hi, 0
buffer_store_dwordx4 v[72:75], v19, s[12:15], s70 offen sc1
s_mov_b64 exec, -1
s_waitcnt vmcnt(21)
s_barrier
s_add_u32 m0, s77, 81920
s_nop 0
buffer_load_dwordx4 v12, s[8:11], s75 offen offset:0 lds
buffer_load_dwordx4 v13, s[8:11], s75 offen offset:1024 lds
buffer_load_dwordx4 v14, s[8:11], s75 offen offset:2048 lds
buffer_load_dwordx4 v15, s[8:11], s75 offen offset:3072 lds
s_add_u32 m0, s77, 86016
s_nop 0
buffer_load_dwordx4 v16, s[8:11], s75 offen offset:0 lds
buffer_load_dwordx4 v17, s[8:11], s75 offen offset:1024 lds
s_add_u32 s75, s75, 393216
s_cmp_eq_u32 s75, 6291456
s_cselect_b32 s75, 0, s75
s_add_u32 m0, s76, 106496
s_nop 0
buffer_load_dwordx4 v8, s[4:7], s74 offen offset:0 lds
buffer_load_dwordx4 v9, s[4:7], s74 offen offset:1024 lds
buffer_load_dwordx4 v10, s[4:7], s74 offen offset:2048 lds
buffer_load_dwordx4 v11, s[4:7], s74 offen offset:3072 lds
s_add_u32 s74, s74, 128
s_and_b32 s74, s74, 2047
s_waitcnt vmcnt(21)
s_barrier
s_add_u32 m0, s77, 40960
s_nop 0
buffer_load_dwordx4 v12, s[8:11], s75 offen offset:0 lds
s_waitcnt vmcnt(13)
s_waitcnt lgkmcnt(0)
s_add_u32 s68, s68, 1
s_and_b32 s84, s68, 0xff
s_not_b32 s70, s68
v_and_b32 v82, 3, v1
v_lshrrev_b32_e64 v82, v82, s70
v_and_b32 v82, 1, v82
v_mul_u32_u24 v82, 0x10001, v82
buffer_load_dwordx4 v13, s[8:11], s75 offen offset:1024 lds
v_lshlrev_b32 v36, 16, v20
v_and_b32 v37, 0xffff0000, v20
v_lshlrev_b32 v38, 16, v21
v_and_b32 v39, 0xffff0000, v21
v_lshlrev_b32 v40, 16, v22
buffer_load_dwordx4 v14, s[8:11], s75 offen offset:2048 lds
v_and_b32 v41, 0xffff0000, v22
v_lshlrev_b32 v42, 16, v23
v_and_b32 v43, 0xffff0000, v23
v_lshlrev_b32 v44, 16, v24
v_and_b32 v45, 0xffff0000, v24
buffer_load_dwordx4 v15, s[8:11], s75 offen offset:3072 lds
v_lshlrev_b32 v46, 16, v25
v_and_b32 v47, 0xffff0000, v25
v_lshlrev_b32 v48, 16, v26
v_and_b32 v49, 0xffff0000, v26
v_lshlrev_b32 v50, 16, v27
s_add_u32 m0, s77, 45056
s_nop 0
buffer_load_dwordx4 v16, s[8:11], s75 offen offset:0 lds
v_and_b32 v51, 0xffff0000, v27
v_lshlrev_b32 v52, 16, v28
v_and_b32 v53, 0xffff0000, v28
v_lshlrev_b32 v54, 16, v29
v_and_b32 v55, 0xffff0000, v29
buffer_load_dwordx4 v17, s[8:11], s75 offen offset:1024 lds
s_add_u32 s75, s75, 393216
s_cmp_eq_u32 s75, 6291456
s_cselect_b32 s75, 0, s75
v_lshlrev_b32 v56, 16, v30
v_and_b32 v57, 0xffff0000, v30
v_lshlrev_b32 v58, 16, v31
v_and_b32 v59, 0xffff0000, v31
v_lshlrev_b32 v60, 16, v32
s_add_u32 m0, s76, 65536
s_nop 0
buffer_load_dwordx4 v8, s[4:7], s74 offen offset:0 lds
v_and_b32 v61, 0xffff0000, v32
v_lshlrev_b32 v62, 16, v33
v_and_b32 v63, 0xffff0000, v33
v_lshlrev_b32 v64, 16, v34
v_and_b32 v65, 0xffff0000, v34
buffer_load_dwordx4 v9, s[4:7], s74 offen offset:1024 lds
v_lshlrev_b32 v66, 16, v35
v_and_b32 v67, 0xffff0000, v35
v_add_f32 v20, v36, v40
v_add_f32 v28, v52, v56
v_add_f32 v21, v37, v41
buffer_load_dwordx4 v10, s[4:7], s74 offen offset:2048 lds
v_add_f32 v29, v53, v57
v_add_f32 v22, v38, v42
v_add_f32 v30, v54, v58
v_add_f32 v23, v39, v43
v_add_f32 v31, v55, v59
buffer_load_dwordx4 v11, s[4:7], s74 offen offset:3072 lds
s_add_u32 s74, s74, 128
s_and_b32 s74, s74, 2047
v_add_f32 v20, v20, v44
v_add_f32 v28, v28, v60
s_waitcnt vmcnt(14)
s_barrier
s_add_u32 m0, s77, 0
s_nop 0
buffer_load_dwordx4 v12, s[8:11], s75 offen offset:0 lds
v_add_f32 v21, v21, v45
v_add_f32 v29, v29, v61
v_add_f32 v22, v22, v46
v_add_f32 v30, v30, v62
v_add_f32 v23, v23, v47
buffer_load_dwordx4 v13, s[8:11], s75 offen offset:1024 lds
v_add_f32 v31, v31, v63
v_add_f32 v20, v20, v48
v_add_f32 v28, v28, v64
v_add_f32 v21, v21, v49
v_add_f32 v29, v29, v65
buffer_load_dwordx4 v14, s[8:11], s75 offen offset:2048 lds
v_add_f32 v22, v22, v50
v_add_f32 v30, v30, v66
v_add_f32 v23, v23, v51
v_add_f32 v31, v31, v67
v_add_f32 v20, v20, v21
buffer_load_dwordx4 v15, s[8:11], s75 offen offset:3072 lds
v_add_f32 v22, v22, v23
v_add_f32 v28, v28, v29
v_add_f32 v30, v30, v31
v_add_f32 v2, v20, v22
v_add_f32 v4, v28, v30
s_add_u32 m0, s77, 4096
s_nop 0
buffer_load_dwordx4 v16, s[8:11], s75 offen offset:0 lds
v_add_f32_dpp v2, v2, v2 row_ror:1 row_mask:0xf bank_mask:0xf
v_add_f32_dpp v4, v4, v4 row_ror:1 row_mask:0xf bank_mask:0xf
s_nop 0
v_add_f32_dpp v2, v2, v2 row_ror:2 row_mask:0xf bank_mask:0xf
v_add_f32_dpp v4, v4, v4 row_ror:2 row_mask:0xf bank_mask:0xf
s_nop 0
v_add_f32_dpp v2, v2, v2 row_ror:4 row_mask:0xf bank_mask:0xf
buffer_load_dwordx4 v17, s[8:11], s75 offen offset:1024 lds
s_add_u32 s75, s75, 393216
s_cmp_eq_u32 s75, 6291456
s_cselect_b32 s75, 0, s75
v_add_f32_dpp v4, v4, v4 row_ror:4 row_mask:0xf bank_mask:0xf
v_add_f32_dpp v2, v2, v2 row_ror:8 row_mask:0xf bank_mask:0xf
s_nop 0
v_add_f32_dpp v4, v4, v4 row_ror:8 row_mask:0xf bank_mask:0xf
v_mov_b32 v6, v2
v_mov_b32 v7, v4
s_add_u32 m0, s76, 24576
s_nop 0
buffer_load_dwordx4 v8, s[4:7], s74 offen offset:0 lds
v_permlane16_swap_b32 v2, v6
v_permlane16_swap_b32 v4, v7
v_add_f32 v2, v2, v6
v_add_f32 v4, v4, v7
v_mov_b32 v6, v2
buffer_load_dwordx4 v9, s[4:7], s74 offen offset:1024 lds
v_mov_b32 v7, v4
v_permlane32_swap_b32 v2, v6
s_nop 0
v_permlane32_swap_b32 v4, v7
v_add_f32 v2, v2, v6
v_add_f32 v4, v4, v7
buffer_load_dwordx4 v10, s[4:7], s74 offen offset:2048 lds
v_mul_f32 v2, 0xba800000, v2
v_mul_f32 v4, 0xba800000, v4
v_add_f32 v36, v36, v2
v_add_f32 v52, v52, v4
v_add_f32 v37, v37, v2
buffer_load_dwordx4 v11, s[4:7], s74 offen offset:3072 lds
s_add_u32 s74, s74, 128
s_and_b32 s74, s74, 2047
v_add_f32 v53, v53, v4
v_add_f32 v38, v38, v2
s_cmp_eq_u32 s60, 0
s_cbranch_scc1 L_pad0
s_cmp_eq_u32 s60, 1
s_cbranch_scc1 L_pad3
s_cmp_eq_u32 s60, 2
s_cbranch_scc1 L_pad4
s_branch L_ret4
L_ret4:
s_waitcnt vmcnt(14)
s_barrier
s_add_u32 m0, s77, 81920
s_nop 0
buffer_load_dwordx4 v12, s[8:11], s75 offen offset:0 lds
v_add_f32 v54, v54, v4
v_add_f32 v39, v39, v2
v_add_f32 v55, v55, v4
v_add_f32 v40, v40, v2
v_add_f32 v56, v56, v4
buffer_load_dwordx4 v13, s[8:11], s75 offen offset:1024 lds
v_add_f32 v41, v41, v2
v_add_f32 v57, v57, v4
v_add_f32 v42, v42, v2
v_add_f32 v58, v58, v4
v_add_f32 v43, v43, v2
buffer_load_dwordx4 v14, s[8:11], s75 offen offset:2048 lds
v_add_f32 v59, v59, v4
v_add_f32 v44, v44, v2
v_add_f32 v60, v60, v4
v_add_f32 v45, v45, v2
v_add_f32 v61, v61, v4
buffer_load_dwordx4 v15, s[8:11], s75 offen offset:3072 lds
v_add_f32 v46, v46, v2
v_add_f32 v62, v62, v4
v_add_f32 v47, v47, v2
v_add_f32 v63, v63, v4
v_add_f32 v48, v48, v2
s_add_u32 m0, s77, 86016
s_nop 0
buffer_load_dwordx4 v16, s[8:11], s75 offen offset:0 lds
v_add_f32 v64, v64, v4
v_add_f32 v49, v49, v2
v_add_f32 v65, v65, v4
v_add_f32 v50, v50, v2
v_add_f32 v66, v66, v4
buffer_load_dwordx4 v17, s[8:11], s75 offen offset:1024 lds
s_add_u32 s75, s75, 393216
s_cmp_eq_u32 s75, 6291456
s_cselect_b32 s75, 0, s75
v_add_f32 v51, v51, v2
v_add_f32 v67, v67, v4
v_mul_f32 v20, v36, v36
v_mul_f32 v28, v52, v52
v_mul_f32 v21, v37, v37
s_add_u32 m0, s76, 122880
s_nop 0
buffer_load_dwordx4 v8, s[4:7], s74 offen offset:0 lds
v_mul_f32 v29, v53, v53
v_fmac_f32 v20, v38, v38
v_fmac_f32 v28, v54, v54
v_fmac_f32 v21, v39, v39
v_fmac_f32 v29, v55, v55
buffer_load_dwordx4 v9, s[4:7], s74 offen offset:1024 lds
v_fmac_f32 v20, v40, v40
v_fmac_f32 v28, v56, v56
v_fmac_f32 v21, v41, v41
v_fmac_f32 v29, v57, v57
v_fmac_f32 v20, v42, v42
buffer_load_dwordx4 v10, s[4:7], s74 offen offset:2048 lds
v_fmac_f32 v28, v58, v58
v_fmac_f32 v21, v43, v43
v_fmac_f32 v29, v59, v59
v_fmac_f32 v20, v44, v44
v_fmac_f32 v28, v60, v60
buffer_load_dwordx4 v11, s[4:7], s74 offen offset:3072 lds
s_add_u32 s74, s74, 128
s_and_b32 s74, s74, 2047
v_fmac_f32 v21, v45, v45
v_fmac_f32 v29, v61, v61
s_waitcnt vmcnt(14)
s_barrier
s_add_u32 m0, s77, 40960
s_nop 0
buffer_load_dwordx4 v12, s[8:11], s75 offen offset:0 lds
v_fmac_f32 v20, v46, v46
v_fmac_f32 v28, v62, v62
v_fmac_f32 v21, v47, v47
v_fmac_f32 v29, v63, v63
v_fmac_f32 v20, v48, v48
buffer_load_dwordx4 v13, s[8:11], s75 offen offset:1024 lds
v_fmac_f32 v28, v64, v64
v_fmac_f32 v21, v49, v49
v_fmac_f32 v29, v65, v65
v_fmac_f32 v20, v50, v50
v_fmac_f32 v28, v66, v66
buffer_load_dwordx4 v14, s[8:11], s75 offen offset:2048 lds
v_fmac_f32 v21, v51, v51
v_fmac_f32 v29, v67, v67
v_add_f32 v3, v20, v21
v_add_f32 v5, v28, v29
s_nop 0
v_add_f32_dpp v3, v3, v3 row_ror:1 row_mask:0xf bank_mask:0xf
buffer_load_dwordx4 v15, s[8:11], s75 offen offset:3072 lds
v_add_f32_dpp v5, v5, v5 row_ror:1 row_mask:0xf bank_mask:0xf
v_add_f32_dpp v3, v3, v3 row_ror:2 row_mask:0xf bank_mask:0xf
s_nop 0
v_add_f32_dpp v5, v5, v5 row_ror:2 row_mask:0xf bank_mask:0xf
v_add_f32_dpp v3, v3, v3 row_ror:4 row_mask:0xf bank_mask:0xf
s_nop 0
v_add_f32_dpp v5, v5, v5 row_ror:4 row_mask:0xf bank_mask:0xf
s_add_u32 m0, s77, 45056
s_nop 0
s_branch L_over0
L_pad0:
s_branch L_ret4
L_over0:
buffer_load_dwordx4 v16, s[8:11], s75 offen offset:0 lds
v_add_f32_dpp v3, v3, v3 row_ror:8 row_mask:0xf bank_mask:0xf
v_add_f32_dpp v5, v5, v5 row_ror:8 row_mask:0xf bank_mask:0xf
v_mov_b32 v6, v3
v_mov_b32 v7, v5
s_nop 0
v_permlane16_swap_b32 v3, v6
buffer_load_dwordx4 v17, s[8:11], s75 offen offset:1024 lds
s_add_u32 s75, s75, 393216
s_cmp_eq_u32 s75, 6291456
s_cselect_b32 s75, 0, s75
v_permlane16_swap_b32 v5, v7
v_add_f32 v3, v3, v6
v_add_f32 v5, v5, v7
v_mov_b32 v6, v3
v_mov_b32 v7, v5
s_add_u32 m0, s76, 106496
s_nop 0
buffer_load_dwordx4 v8, s[4:7], s74 offen offset:0 lds
v_permlane32_swap_b32 v3, v6
v_permlane32_swap_b32 v5, v7
v_add_f32 v3, v3, v6
v_add_f32 v5, v5, v7
v_mov_b32 v6, 0x3727c5ac
buffer_load_dwordx4 v9, s[4:7], s74 offen offset:1024 lds
v_fmac_f32 v6, 0x3a800000, v3
v_rsq_f32 v3, v6
v_mov_b32 v6, 0x3727c5ac
v_fmac_f32 v6, 0x3a800000, v5
v_rsq_f32 v5, v6
buffer_load_dwordx4 v10, s[4:7], s74 offen offset:2048 lds
v_cmp_eq_u32 vcc, 1, v1
s_nop 1
v_cndmask_b32 v20, v2, v4, vcc
v_cndmask_b32 v21, v3, v5, vcc
v_mov_b32 v22, 0
v_mov_b32 v23, s68
buffer_load_dwordx4 v11, s[4:7], s74 offen offset:3072 lds
s_add_u32 s74, s74, 128
s_and_b32 s74, s74, 2047
buffer_load_dwordx4 a[0:3], v76, s[24:27], s85 offen nt
buffer_load_dwordx4 a[32:35], v78, s[28:31], s85 offen nt
s_add_u32 s85, s85, 57344
buffer_load_dwordx4 a[4:7], v76, s[24:27], s85 offen nt
buffer_load_dwordx4 a[36:39], v78, s[28:31], s85 offen nt
s_add_u32 s85, s85, 57344
buffer_load_dwordx4 a[8:11], v76, s[24:27], s85 offen nt
buffer_load_dwordx4 a[40:43], v78, s[28:31], s85 offen nt
s_add_u32 s85, s85, 57344
s_lshl_b32 s70, s87, 4
s_add_u32 s70, s70, 8192
s_mov_b64 exec, 3
buffer_store_dwordx4 v[20:23], v18, s[12:15], s70 offen sc1
s_mov_b64 exec, -1
s_waitcnt vmcnt(21)
s_barrier
s_add_u32 m0, s77, 0
s_nop 0
buffer_load_dwordx4 v12, s[8:11], s75 offen offset:0 lds
v_lshlrev_b32 v2, 16, v88
v_and_b32 v3, 0xffff0000, v88
v_lshlrev_b32 v4, 16, v89
buffer_load_dwordx4 v13, s[8:11], s75 offen offset:1024 lds
v_and_b32 v5, 0xffff0000, v89
v_add_f32 v2, v2, v3
v_add_f32 v4, v4, v5
buffer_load_dwordx4 v14, s[8:11], s75 offen offset:2048 lds
v_add_f32 v2, v2, v4
s_nop 1
v_add_f32_dpp v2, v2, v2 row_ror:1 row_mask:0xf bank_mask:0xf
s_nop 1
v_add_f32_dpp v2, v2, v2 row_ror:2 row_mask:0xf bank_mask:0xf
buffer_load_dwordx4 v15, s[8:11], s75 offen offset:3072 lds
s_nop 0
v_add_f32_dpp v2, v2, v2 row_ror:4 row_mask:0xf bank_mask:0xf
s_nop 1
v_add_f32_dpp v2, v2, v2 row_ror:8 row_mask:0xf bank_mask:0xf
v_mov_b32 v3, v2
s_add_u32 m0, s77, 4096
s_nop 0
buffer_load_dwordx4 v16, s[8:11], s75 offen offset:0 lds
v_permlane16_swap_b32 v2, v3
v_add_f32 v2, v2, v3
v_mov_b32 v3, v2
buffer_load_dwordx4 v17, s[8:11], s75 offen offset:1024 lds
s_add_u32 s75, s75, 393216
s_cmp_eq_u32 s75, 6291456
s_cselect_b32 s75, 0, s75
v_permlane32_swap_b32 v2, v3
v_add_f32 v2, v2, v3
s_lshl_b32 s70, s60, 2
s_add_u32 s70, s70, 162176
v_mov_b32 v3, s70
s_add_u32 m0, s76, 65536
s_nop 0
buffer_load_dwordx4 v8, s[4:7], s74 offen offset:0 lds
ds_write_b32 v3, v2
s_lshl_b32 s70, s60, 2
s_sub_u32 s70, s70, s65
s_lshl_b32 s70, s70, 4
v_add_u32 v4, s70, v1
v_min_u32 v4, 18, v4
buffer_load_dwordx4 v9, s[4:7], s74 offen offset:1024 lds
v_cmp_gt_u32 vcc, 16, v4
s_nop 1
v_cndmask_b32 v4, 18, v4, vcc
v_lshlrev_b32 v4, 3, v4
buffer_load_dwordx4 v10, s[4:7], s74 offen offset:2048 lds
v_add_u32 v4, 162048, v4
ds_write_b64 v4, v[88:89]
buffer_load_dwordx4 v11, s[4:7], s74 offen offset:3072 lds
s_add_u32 s74, s74, 128
s_and_b32 s74, s74, 2047
s_waitcnt vmcnt(21)
s_barrier
s_add_u32 m0, s77, 81920
s_nop 0
buffer_load_dwordx4 v12, s[8:11], s75 offen offset:0 lds
s_getreg_b32 s71, hwreg(HW_REG_XCC_ID, 0, 4)
v_mov_b32 v84, s71
buffer_load_dwordx4 v13, s[8:11], s75 offen offset:1024 lds
v_mov_b32 v85, 0
buffer_load_dwordx4 v14, s[8:11], s75 offen offset:2048 lds
v_mov_b32 v86, 0
buffer_load_dwordx4 v15, s[8:11], s75 offen offset:3072 lds
v_mov_b32 v87, s68
s_add_u32 m0, s77, 86016
s_nop 0
buffer_load_dwordx4 v16, s[8:11], s75 offen offset:0 lds
s_lshl_b32 s70, s79, 4
s_add_u32 s70, s70, 4096
v_mov_b32 v19, s70
buffer_load_dwordx4 v17, s[8:11], s75 offen offset:1024 lds
s_add_u32 s75, s75, 393216
s_cmp_eq_u32 s75, 6291456
s_cselect_b32 s75, 0, s75
s_lshl_b32 s70, s65, 4
s_add_u32 s70, s70, s64
s_lshl_b32 s70, s70, 4
s_add_u32 s70, s70, 40960
v_writelane_b32 v19, s70, 1
s_add_u32 m0, s76, 24576
s_nop 0
buffer_load_dwordx4 v8, s[4:7], s74 offen offset:0 lds
buffer_load_dwordx4 v9, s[4:7], s74 offen offset:1024 lds
buffer_load_dwordx4 v10, s[4:7], s74 offen offset:2048 lds
buffer_load_dwordx4 v11, s[4:7], s74 offen offset:3072 lds
s_add_u32 s74, s74, 128
s_and_b32 s74, s74, 2047
buffer_load_dwordx4 a[12:15], v76, s[24:27], s85 offen nt
buffer_load_dwordx4 a[44:47], v78, s[28:31], s85 offen nt
s_add_u32 s85, s85, 57344
buffer_load_dwordx4 a[16:19], v76, s[24:27], s85 offen nt
buffer_load_dwordx4 a[48:51], v78, s[28:31], s85 offen nt
s_add_u32 s85, s85, 57344
buffer_load_dwordx4 a[20:23], v76, s[24:27], s85 offen nt
buffer_load_dwordx4 a[52:55], v78, s[28:31], s85 offen nt
s_add_u32 s85, s85, 57344
s_mov_b64 exec, 3
buffer_store_dwordx4 v[84:87], v19, s[12:15], 0 offen sc1
s_mov_b64 exec, -1
s_mov_b32 s70, 7225344
s_load_dword s61, s[12:13], s70
s_waitcnt vmcnt(21)
s_barrier
s_add_u32 m0, s77, 40960
s_nop 0
buffer_load_dwordx4 v12, s[8:11], s75 offen offset:0 lds
buffer_load_dwordx4 v13, s[8:11], s75 offen offset:1024 lds
buffer_load_dwordx4 v14, s[8:11], s75 offen offset:2048 lds
buffer_load_dwordx4 v15, s[8:11], s75 offen offset:3072 lds
s_add_u32 m0, s77, 45056
s_nop 0
buffer_load_dwordx4 v16, s[8:11], s75 offen offset:0 lds
buffer_load_dwordx4 v17, s[8:11], s75 offen offset:1024 lds
s_add_u32 s75, s75, 393216
s_cmp_eq_u32 s75, 6291456
s_cselect_b32 s75, 0, s75
s_add_u32 m0, s76, 122880
s_nop 0
buffer_load_dwordx4 v8, s[4:7], s74 offen offset:0 lds
buffer_load_dwordx4 v9, s[4:7], s74 offen offset:1024 lds
buffer_load_dwordx4 v10, s[4:7], s74 offen offset:2048 lds
buffer_load_dwordx4 v11, s[4:7], s74 offen offset:3072 lds
s_add_u32 s74, s74, 128
s_and_b32 s74, s74, 2047
s_cmp_lt_u32 s3, 14
s_cbranch_scc1 L_norace
s_cmp_ge_u32 s60, 2
s_cbranch_scc1 L_norace
s_and_b32 s70, s3, 1
s_lshl4_add_u32 s70, s70, s65
s_lshl1_add_u32 s73, s70, s60
s_lshl_b32 s70, s73, 7
s_lshl_b32 s71, s60, 13
s_add_u32 s70, s70, s71
s_add_u32 s70, s70, 7208960
s_xor_b32 s71, s70, 0x2000
s_mov_b32 s72, 0x5bd1e995
s_waitcnt lgkmcnt(0)
s_load_dword s61, s[12:13], s70
s_load_dword s72, s[12:13], s71
s_lshr_b32 s70, s62, 2
s_xor_b32 s70, s70, s60
s_sub_u32 s70, 2, s70
s_lshl_b32 s71, s68, 2
s_waitcnt lgkmcnt(1)
s_cmp_eq_u32 s72, 0x5bd1e995
s_cselect_b32 s70, s70, 0
s_or_b32 s70, s70, s71
v_mov_b32 v19, s70
s_lshl_b32 s73, s73, 2
s_add_u32 s73, s73, 7225600
s_mov_b64 exec, 1
buffer_store_dword v19, off, s[12:15], s73 sc1
s_mov_b64 exec, -1
s_waitcnt lgkmcnt(0)
L_norace:
s_cmp_eq_u32 s60, 0
s_cbranch_scc1 L_pad5
s_cmp_eq_u32 s60, 1
s_cbranch_scc1 L_ret9
s_cmp_eq_u32 s60, 2
s_cbranch_scc1 L_ret9
s_branch L_ret9
L_ret9:
s_waitcnt vmcnt(21)
s_barrier
s_add_u32 m0, s77, 0
s_nop 0
buffer_load_dwordx4 v12, s[8:11], s75 offen offset:0 lds
buffer_load_dwordx4 v13, s[8:11], s75 offen offset:1024 lds
buffer_load_dwordx4 v14, s[8:11], s75 offen offset:2048 lds
buffer_load_dwordx4 v15, s[8:11], s75 offen offset:3072 lds
s_add_u32 m0, s77, 4096
s_nop 0
buffer_load_dwordx4 v16, s[8:11], s75 offen offset:0 lds
buffer_load_dwordx4 v17, s[8:11], s75 offen offset:1024 lds
s_add_u32 s75, s75, 393216
s_cmp_eq_u32 s75, 6291456
s_cselect_b32 s75, 0, s75
s_add_u32 m0, s76, 106496
s_nop 0
buffer_load_dwordx4 v8, s[4:7], s74 offen offset:0 lds
buffer_load_dwordx4 v9, s[4:7], s74 offen offset:1024 lds
buffer_load_dwordx4 v10, s[4:7], s74 offen offset:2048 lds
buffer_load_dwordx4 v11, s[4:7], s74 offen offset:3072 lds
s_add_u32 s74, s74, 128
s_and_b32 s74, s74, 2047
buffer_load_dwordx4 a[24:27], v76, s[24:27], s85 offen nt
buffer_load_dwordx4 a[56:59], v78, s[28:31], s85 offen nt
s_add_u32 s85, s85, 57344
buffer_load_dwordx4 a[28:31], v76, s[24:27], s85 offen nt
buffer_load_dwordx4 a[60:63], v78, s[28:31], s85 offen nt
s_add_u32 s85, s85, 57344
buffer_load_dwordx4 a[64:67], v77, s[32:35], s86 offen nt
s_add_u32 s86, s86, 16384
buffer_load_dwordx4 a[68:71], v77, s[32:35], s86 offen nt
s_add_u32 s86, s86, 16384
s_waitcnt vmcnt(20)
s_barrier
s_add_u32 m0, s77, 81920
s_nop 0
buffer_load_dwordx4 v12, s[8:11], s75 offen offset:0 lds
v_lshrrev_b32 v2, 4, v1
v_and_b32 v3, 15, v1
v_lshlrev_b32 v44, 10, v2
buffer_load_dwordx4 v13, s[8:11], s75 offen offset:1024 lds
v_lshl_add_u32 v44, v3, 4, v44
s_lshl_b32 s70, s60, 8
v_add_u32 v44, s70, v44
s_lshl_b32 s87, s64, 14
s_add_u32 s87, s87, 65536
buffer_load_dwordx4 v14, s[8:11], s75 offen offset:2048 lds
v_and_b32 v45, 31, v1
v_lshlrev_b32 v45, 4, v45
s_lshl_b32 s88, s65, 11
s_lshl_b32 s70, s60, 9
s_add_u32 s88, s88, s70
s_add_u32 s88, s88, 8192
buffer_load_dwordx4 v15, s[8:11], s75 offen offset:3072 lds
s_lshl_b32 s70, s64, 8
s_add_u32 s70, s70, 4096
v_lshlrev_b32 v4, 4, v3
v_add_u32 v4, s70, v4
v_add_u32 v5, 36864, v4
v_lshrrev_b32 v6, 5, v1
s_add_u32 m0, s77, 86016
s_nop 0
buffer_load_dwordx4 v16, s[8:11], s75 offen offset:0 lds
v_lshlrev_b32 v6, 11, v6
v_xor_b32 v5, v5, v6
v_lshrrev_b32 v6, 5, v1
buffer_load_dwordx4 v17, s[8:11], s75 offen offset:1024 lds
s_add_u32 s75, s75, 393216
s_cmp_eq_u32 s75, 6291456
s_cselect_b32 s75, 0, s75
v_lshlrev_b32 v6, 8, v6
v_xor_b32 v4, v4, v6
v_and_b32 v6, 1, v2
s_add_u32 m0, s76, 65536
s_nop 0
buffer_load_dwordx4 v8, s[4:7], s74 offen offset:0 lds
v_cmp_eq_u32 vcc, 1, v6
s_nop 1
v_cndmask_b32 v46, v4, v5, vcc
v_lshlrev_b32 v48, 2, v1
buffer_load_dwordx4 v9, s[4:7], s74 offen offset:1024 lds
v_add_u32 v48, 7225600, v48
buffer_load_dwordx4 v10, s[4:7], s74 offen offset:2048 lds
buffer_load_dwordx4 v11, s[4:7], s74 offen offset:3072 lds
s_add_u32 s74, s74, 128
s_and_b32 s74, s74, 2047
s_add_u32 s70, s87, 0
buffer_load_dwordx4 v[20:23], v44, s[12:15], s70 offen sc1
buffer_load_dwordx4 v[36:39], v45, s[12:15], s88 offen sc1
buffer_load_dwordx4 v[40:43], v46, s[12:15], 0 offen offset:0 sc1
buffer_load_dword v47, v48, s[12:15], 0 offen sc1
s_waitcnt vmcnt(24)
s_barrier
s_add_u32 m0, s77, 40960
s_nop 0
buffer_load_dwordx4 v12, s[8:11], s75 offen offset:0 lds
buffer_load_dwordx4 v13, s[8:11], s75 offen offset:1024 lds
buffer_load_dwordx4 v14, s[8:11], s75 offen offset:2048 lds
buffer_load_dwordx4 v15, s[8:11], s75 offen offset:3072 lds
s_add_u32 m0, s77, 45056
s_nop 0
buffer_load_dwordx4 v16, s[8:11], s75 offen offset:0 lds
buffer_load_dwordx4 v17, s[8:11], s75 offen offset:1024 lds
s_add_u32 s75, s75, 393216
s_cmp_eq_u32 s75, 6291456
s_cselect_b32 s75, 0, s75
s_add_u32 m0, s76, 24576
s_nop 0
buffer_load_dwordx4 v8, s[4:7], s74 offen offset:0 lds
buffer_load_dwordx4 v9, s[4:7], s74 offen offset:1024 lds
buffer_load_dwordx4 v10, s[4:7], s74 offen offset:2048 lds
buffer_load_dwordx4 v11, s[4:7], s74 offen offset:3072 lds
s_add_u32 s74, s74, 128
s_and_b32 s74, s74, 2047
buffer_load_dwordx4 a[72:75], v77, s[32:35], s86 offen nt
s_add_u32 s86, s86, 16384
buffer_load_dwordx4 a[76:79], v77, s[32:35], s86 offen nt
s_add_u32 s86, s86, 16384
buffer_load_dwordx4 a[80:83], v77, s[32:35], s86 offen nt
s_add_u32 s86, s86, 16384
s_waitcnt vmcnt(21)
s_barrier
s_add_u32 m0, s77, 0
s_nop 0
buffer_load_dwordx4 v12, s[8:11], s75 offen offset:0 lds
s_waitcnt vmcnt(14) lgkmcnt(0)
L_eg_chk:
v_xor_b32 v2, s68, v23
v_xor_b32 v3, s68, v39
v_xor_b32 v4, s68, v43
v_or3_b32 v2, v2, v3, v4
s_lshl_b32 s70, s68, 2
v_xor_b32 v3, s70, v47
v_lshrrev_b32 v3, 2, v3
v_or_b32 v2, v2, v3
v_cmp_ne_u32 vcc, 0, v2
s_cbranch_vccnz L_eg_rt
L_eg_ok:
v_mov_b32 v24, v20
v_mov_b32 v25, v21
buffer_load_dwordx4 v13, s[8:11], s75 offen offset:1024 lds
v_mov_b32 v26, v22
v_permlane16_swap_b32 v20, v24
v_permlane16_swap_b32 v21, v25
buffer_load_dwordx4 v14, s[8:11], s75 offen offset:2048 lds
v_permlane16_swap_b32 v22, v26
v_add_f32 v20, v20, v24
v_add_f32 v21, v21, v25
buffer_load_dwordx4 v15, s[8:11], s75 offen offset:3072 lds
v_add_f32 v22, v22, v26
v_mov_b32 v24, v20
v_mov_b32 v25, v21
s_add_u32 m0, s77, 4096
s_nop 0
buffer_load_dwordx4 v16, s[8:11], s75 offen offset:0 lds
v_mov_b32 v26, v22
v_permlane32_swap_b32 v20, v24
v_permlane32_swap_b32 v21, v25
buffer_load_dwordx4 v17, s[8:11], s75 offen offset:1024 lds
s_add_u32 s75, s75, 393216
s_cmp_eq_u32 s75, 6291456
s_cselect_b32 s75, 0, s75
v_permlane32_swap_b32 v22, v26
v_add_f32 v20, v20, v24
v_add_f32 v21, v21, v25
s_lshl_b32 s70, s63, 2
s_add_u32 s70, s70, s60
s_lshl_b32 s70, s70, 14
v_lshlrev_b32 v81, 10, v1
s_mov_b64 exec, 0xffff
buffer_load_dword v81, v81, s[16:19], s70 offen offset:384
s_mov_b64 exec, -1
buffer_load_dwordx4 a[84:87], v77, s[32:35], s86 offen nt
s_add_u32 s86, s86, 16384
buffer_load_dwordx4 a[88:91], v77, s[32:35], s86 offen nt
s_add_u32 s86, s86, 16384
buffer_load_dwordx4 a[92:95], v77, s[32:35], s86 offen nt
s_add_u32 s86, s86, 16384
s_waitcnt vmcnt(17)
s_barrier
s_mul_i32 s70, s60, 2
s_add_u32 s70, s70, 120
s_lshl_b32 s82, s89, 3
s_add_u32 s82, s82, s70
s_lshl_b32 s70, s70, 10
s_add_u32 m0, s70, 28672
s_and_b32 s82, s82, 127
s_lshl_b32 s82, s82, 14
buffer_load_dwordx4 v80, s[16:19], s82 offen lds
v_add_f32 v22, v22, v26
v_and_b32 v3, 15, v1
v_lshlrev_b32 v3, 2, v3
s_lshl_b32 s70, s60, 6
s_add_u32 s70, s70, 160768
v_add_u32 v3, s70, v3
ds_write_b32 v3, v20 offset:0
ds_write_b32 v3, v21 offset:256
ds_write_b32 v3, v22 offset:512
v_lshrrev_b32 v4, 2, v45
s_lshl_b32 s70, s60, 7
s_add_u32 s70, s70, 159744
v_add_u32 v4, s70, v4
s_add_u32 m0, m0, 1024
s_add_u32 s82, s82, 16384
s_and_b32 s82, s82, 0x1fffff
buffer_load_dwordx4 v80, s[16:19], s82 offen lds
ds_write_b32 v4, v36
ds_write_b32 v4, v37 offset:512
s_getreg_b32 s71, hwreg(HW_REG_XCC_ID, 0, 4)
v_cmp_ne_u32 vcc, s71, v40
s_nop 0
s_or_b32 s70, vcc_lo, vcc_hi
s_and_b32 s70, s70, 0xffff
s_cselect_b32 s69, 0, 1
v_and_b32 v5, 3, v47
v_cmp_eq_u32 vcc, 1, v5
s_nop 0
s_bcnt1_i32_b64 s70, vcc
v_cmp_eq_u32 vcc, 2, v5
s_nop 0
s_bcnt1_i32_b64 s71, vcc
s_cmp_gt_u32 s71, s70
s_cselect_b32 s61, 8192, 0
s_or_b32 s70, s69, s61
v_mov_b32 v5, s70
v_mov_b32 v6, 161536
ds_write_b32 v6, v5
s_mov_b32 exec_lo, 0
s_mov_b32 exec_hi, 0xff
v_xor_b32 v83, s61, v83
s_mov_b64 exec, -1
s_waitcnt vmcnt(6)
s_barrier
s_mul_i32 s70, s60, 10
s_add_u32 s70, s70, 80
s_lshl_b32 s82, s89, 3
s_add_u32 s82, s82, s70
s_lshl_b32 s70, s70, 10
s_add_u32 m0, s70, 28672
s_and_b32 s82, s82, 127
s_lshl_b32 s82, s82, 14
buffer_load_dwordx4 v80, s[16:19], s82 offen lds
s_add_u32 m0, m0, 1024
s_add_u32 s82, s82, 16384
s_and_b32 s82, s82, 0x1fffff
buffer_load_dwordx4 v80, s[16:19], s82 offen lds
s_add_u32 m0, m0, 1024
s_add_u32 s82, s82, 16384
s_and_b32 s82, s82, 0x1fffff
buffer_load_dwordx4 v80, s[16:19], s82 offen lds
s_add_u32 m0, m0, 1024
s_add_u32 s82, s82, 16384
s_and_b32 s82, s82, 0x1fffff
buffer_load_dwordx4 v80, s[16:19], s82 offen lds
s_add_u32 m0, m0, 1024
s_add_u32 s82, s82, 16384
s_and_b32 s82, s82, 0x1fffff
buffer_load_dwordx4 v80, s[16:19], s82 offen lds
s_add_u32 m0, m0, 1024
s_add_u32 s82, s82, 16384
s_and_b32 s82, s82, 0x1fffff
buffer_load_dwordx4 v80, s[16:19], s82 offen lds
s_add_u32 m0, m0, 1024
s_add_u32 s82, s82, 16384
s_and_b32 s82, s82, 0x1fffff
buffer_load_dwordx4 v80, s[16:19], s82 offen lds
s_add_u32 m0, m0, 1024
s_add_u32 s82, s82, 16384
s_and_b32 s82, s82, 0x1fffff
buffer_load_dwordx4 v80, s[16:19], s82 offen lds
s_add_u32 m0, m0, 1024
s_add_u32 s82, s82, 16384
s_and_b32 s82, s82, 0x1fffff
buffer_load_dwordx4 v80, s[16:19], s82 offen lds
s_add_u32 m0, m0, 1024
s_add_u32 s82, s82, 16384
s_and_b32 s82, s82, 0x1fffff
buffer_load_dwordx4 v80, s[16:19], s82 offen lds
s_setprio 0
s_waitcnt lgkmcnt(0)
s_barrier
s_mov_b32 exec_lo, 0x0
s_mov_b32 exec_hi, 0xf
buffer_load_dword v81, v83, s[12:15], 0 offen
s_mov_b64 exec, -1
s_mul_i32 s70, s60, 14
s_add_u32 s70, s70, 24
s_lshl_b32 s82, s89, 3
s_add_u32 s82, s82, s70
s_lshl_b32 s70, s70, 10
s_add_u32 m0, s70, 28672
s_and_b32 s82, s82, 127
s_lshl_b32 s82, s82, 14
buffer_load_dwordx4 v80, s[16:19], s82 offen lds
s_add_u32 m0, m0, 1024
s_add_u32 s82, s82, 16384
s_and_b32 s82, s82, 0x1fffff
buffer_load_dwordx4 v80, s[16:19], s82 offen lds
s_add_u32 m0, m0, 1024
s_add_u32 s82, s82, 16384
s_and_b32 s82, s82, 0x1fffff
buffer_load_dwordx4 v80, s[16:19], s82 offen lds
s_add_u32 m0, m0, 1024
s_add_u32 s82, s82, 16384
s_and_b32 s82, s82, 0x1fffff
buffer_load_dwordx4 v80, s[16:19], s82 offen lds
s_add_u32 m0, m0, 1024
s_add_u32 s82, s82, 16384
s_and_b32 s82, s82, 0x1fffff
buffer_load_dwordx4 v80, s[16:19], s82 offen lds
s_add_u32 m0, m0, 1024
s_add_u32 s82, s82, 16384
s_and_b32 s82, s82, 0x1fffff
buffer_load_dwordx4 v80, s[16:19], s82 offen lds
s_add_u32 m0, m0, 1024
s_add_u32 s82, s82, 16384
s_and_b32 s82, s82, 0x1fffff
buffer_load_dwordx4 v80, s[16:19], s82 offen lds
s_add_u32 m0, m0, 1024
s_add_u32 s82, s82, 16384
s_and_b32 s82, s82, 0x1fffff
buffer_load_dwordx4 v80, s[16:19], s82 offen lds
s_add_u32 m0, m0, 1024
s_add_u32 s82, s82, 16384
s_and_b32 s82, s82, 0x1fffff
buffer_load_dwordx4 v80, s[16:19], s82 offen lds
s_add_u32 m0, m0, 1024
s_add_u32 s82, s82, 16384
s_and_b32 s82, s82, 0x1fffff
buffer_load_dwordx4 v80, s[16:19], s82 offen lds
s_add_u32 m0, m0, 1024
s_add_u32 s82, s82, 16384
s_and_b32 s82, s82, 0x1fffff
buffer_load_dwordx4 v80, s[16:19], s82 offen lds
s_add_u32 m0, m0, 1024
s_add_u32 s82, s82, 16384
s_and_b32 s82, s82, 0x1fffff
buffer_load_dwordx4 v80, s[16:19], s82 offen lds
s_add_u32 m0, m0, 1024
s_add_u32 s82, s82, 16384
s_and_b32 s82, s82, 0x1fffff
buffer_load_dwordx4 v80, s[16:19], s82 offen lds
s_add_u32 m0, m0, 1024
s_add_u32 s82, s82, 16384
s_and_b32 s82, s82, 0x1fffff
buffer_load_dwordx4 v80, s[16:19], s82 offen lds
s_sub_i32 s70, s64, s65
s_lshl_b32 s70, s70, 18
v_add_u32 v8, s70, v8
v_add_u32 v9, s70, v9
v_add_u32 v10, s70, v10
v_add_u32 v11, s70, v11
v_lshrrev_b32 v2, 4, v1
v_bfe_u32 v3, v1, 2, 2
v_and_b32 v4, 1, v1
v_lshlrev_b32 v4, 4, v4
v_mov_b32 v5, 0x3f80
v_lshlrev_b32 v4, v4, v5
v_cmp_eq_u32 vcc, v2, v3
s_nop 1
v_cndmask_b32 v4, 0, v4, vcc
v_and_b32 v5, 2, v1
v_cmp_eq_u32 vcc, 0, v5
s_nop 1
v_cndmask_b32 v58, 0, v4, vcc
v_cndmask_b32_e64 v59, v4, 0, vcc
v_mov_b32 v56, 0
v_mov_b32 v57, 0
v_mov_b32 v60, 0
v_mov_b32 v61, 0
v_and_b32 v3, 15, v1
v_mul_u32_u24 v55, 4352, v3
v_lshrrev_b32 v2, 4, v1
v_lshl_add_u32 v55, v2, 5, v55
s_mul_i32 s87, s64, 69632
s_add_u32 s87, s87, 524288
s_lshl_b32 s70, s66, 7
s_lshl_b32 s71, s67, 4
s_add_u32 s88, s70, s71
s_add_u32 s88, s88, s87
s_add_u32 s88, s88, 4096
s_lshl_b32 s70, s60, 10
s_add_u32 s87, s87, s70
s_cmp_eq_u32 s60, 0
s_cbranch_scc1 L_pad1
s_cmp_eq_u32 s60, 1
s_cbranch_scc1 L_pad8
s_cmp_eq_u32 s60, 2
s_cbranch_scc1 L_pad14
s_branch L_retF
L_retF:
s_barrier
s_barrier
s_mul_i32 s70, s60, 6
s_add_u32 s70, s70, 0
s_lshl_b32 s82, s89, 3
s_add_u32 s82, s82, s70
s_lshl_b32 s70, s70, 10
s_add_u32 m0, s70, 28672
s_and_b32 s82, s82, 127
s_lshl_b32 s82, s82, 14
buffer_load_dwordx4 v80, s[16:19], s82 offen lds
s_add_u32 m0, m0, 1024
s_add_u32 s82, s82, 16384
s_and_b32 s82, s82, 0x1fffff
buffer_load_dwordx4 v80, s[16:19], s82 offen lds
s_add_u32 m0, m0, 1024
s_add_u32 s82, s82, 16384
s_and_b32 s82, s82, 0x1fffff
buffer_load_dwordx4 v80, s[16:19], s82 offen lds
s_add_u32 m0, m0, 1024
s_add_u32 s82, s82, 16384
s_and_b32 s82, s82, 0x1fffff
buffer_load_dwordx4 v80, s[16:19], s82 offen lds
s_add_u32 m0, m0, 1024
s_add_u32 s82, s82, 16384
s_and_b32 s82, s82, 0x1fffff
buffer_load_dwordx4 v80, s[16:19], s82 offen lds
s_add_u32 m0, m0, 1024
s_add_u32 s82, s82, 16384
s_and_b32 s82, s82, 0x1fffff
buffer_load_dwordx4 v80, s[16:19], s82 offen lds
s_lshl_b32 s70, s65, 7
s_mov_b32 m0, s76
s_nop 0
buffer_load_dwordx4 v8, s[4:7], s70 offen offset:0 lds
buffer_load_dwordx4 v9, s[4:7], s70 offen offset:1024 lds
buffer_load_dwordx4 v10, s[4:7], s70 offen offset:2048 lds
buffer_load_dwordx4 v11, s[4:7], s70 offen offset:3072 lds
s_add_u32 s70, s65, 1
s_and_b32 s70, s70, 15
s_mul_i32 s70, s70, 4352
s_add_u32 s70, s70, s87
buffer_load_dwordx4 v[84:87], v18, s[12:15], s70 offen sc1
s_add_u32 s70, s65, 2
s_and_b32 s70, s70, 15
s_mul_i32 s70, s70, 4352
s_add_u32 s70, s70, s87
buffer_load_dwordx4 v[88:91], v18, s[12:15], s70 offen sc1
s_add_u32 s70, s65, 3
s_branch L_over1
L_pad1:
s_branch L_retF
L_over1:
s_and_b32 s70, s70, 15
s_mul_i32 s70, s70, 4352
s_add_u32 s70, s70, s87
buffer_load_dwordx4 v[92:95], v18, s[12:15], s70 offen sc1
s_add_u32 s70, s65, 4
s_and_b32 s70, s70, 15
s_mul_i32 s70, s70, 4352
s_add_u32 s70, s70, s87
buffer_load_dwordx4 v[96:99], v18, s[12:15], s70 offen sc1
s_add_u32 s70, s65, 5
s_and_b32 s70, s70, 15
s_mul_i32 s70, s70, 4352
s_add_u32 s70, s70, s87
buffer_load_dwordx4 v[100:103], v18, s[12:15], s70 offen sc1
s_add_u32 s70, s65, 6
s_and_b32 s70, s70, 15
s_mul_i32 s70, s70, 4352
s_add_u32 s70, s70, s87
buffer_load_dwordx4 v[104:107], v18, s[12:15], s70 offen sc1
s_add_u32 s70, s65, 7
s_and_b32 s70, s70, 15
s_mul_i32 s70, s70, 4352
s_add_u32 s70, s70, s87
buffer_load_dwordx4 v[108:111], v18, s[12:15], s70 offen sc1
s_add_u32 s70, s65, 8
s_and_b32 s70, s70, 15
s_mul_i32 s70, s70, 4352
s_add_u32 s70, s70, s87
buffer_load_dwordx4 v[112:115], v18, s[12:15], s70 offen sc1
s_add_u32 s70, s65, 9
s_and_b32 s70, s70, 15
s_mul_i32 s70, s70, 4352
s_add_u32 s70, s70, s87
buffer_load_dwordx4 v[116:119], v18, s[12:15], s70 offen sc1
s_add_u32 s70, s65, 10
s_and_b32 s70, s70, 15
s_mul_i32 s70, s70, 4352
s_add_u32 s70, s70, s87
buffer_load_dwordx4 v[120:123], v18, s[12:15], s70 offen sc1
s_add_u32 s70, s65, 11
s_and_b32 s70, s70, 15
s_mul_i32 s70, s70, 4352
s_add_u32 s70, s70, s87
buffer_load_dwordx4 v[124:127], v18, s[12:15], s70 offen sc1
s_add_u32 s70, s65, 12
s_and_b32 s70, s70, 15
s_mul_i32 s70, s70, 4352
s_add_u32 s70, s70, s87
buffer_load_dwordx4 v[128:131], v18, s[12:15], s70 offen sc1
s_add_u32 s70, s65, 13
s_and_b32 s70, s70, 15
s_mul_i32 s70, s70, 4352
s_add_u32 s70, s70, s87
buffer_load_dwordx4 v[132:135], v18, s[12:15], s70 offen sc1
s_add_u32 s70, s65, 14
s_and_b32 s70, s70, 15
s_mul_i32 s70, s70, 4352
s_add_u32 s70, s70, s87
buffer_load_dwordx4 v[136:139], v18, s[12:15], s70 offen sc1
s_add_u32 s70, s65, 15
s_and_b32 s70, s70, 15
s_mul_i32 s70, s70, 4352
s_add_u32 s70, s70, s87
buffer_load_dwordx4 v[140:143], v18, s[12:15], s70 offen sc1
s_add_u32 s70, s65, 16
s_and_b32 s70, s70, 15
s_mul_i32 s70, s70, 4352
s_add_u32 s70, s70, s87
buffer_load_dwordx4 v[144:147], v18, s[12:15], s70 offen sc1
buffer_load_dwordx4 v[148:151], v55, s[12:15], s88 offen sc1
s_lshl_b32 s70, s66, 6
s_lshl_b32 s71, s67, 3
s_add_u32 s70, s70, s71
s_add_u32 s70, s70, 161600
v_lshrrev_b32 v4, 4, v1
v_lshlrev_b32 v4, 4, v4
v_add_u32 v4, s70, v4
s_lshl_b32 s70, s60, 10
s_add_u32 s70, s70, 24576
v_add_u32 v3, s70, v18
s_mov_b32 s73, 31
L_kvr:
s_bitcmp1_b32 s73, 0
s_cbranch_scc0 L_kvs0
s_waitcnt vmcnt(13)
v_max3_u32 v2, v84, v88, v92
v_max_u32 v2, v2, v96
v_cmp_eq_u32 vcc, -1, v2
s_cbranch_vccnz L_kvs0
s_bitset0_b32 s73, 0
v_mfma_f32_16x16x32_bf16 v[20:23], v[58:61], v[84:87], 0
v_mfma_f32_16x16x32_bf16 v[24:27], v[56:59], v[84:87], 0
v_mfma_f32_16x16x32_bf16 v[20:23], v[58:61], v[88:91], v[20:23]
v_mfma_f32_16x16x32_bf16 v[24:27], v[56:59], v[88:91], v[24:27]
v_mfma_f32_16x16x32_bf16 v[20:23], v[58:61], v[92:95], v[20:23]
v_mfma_f32_16x16x32_bf16 v[24:27], v[56:59], v[92:95], v[24:27]
v_mfma_f32_16x16x32_bf16 v[20:23], v[58:61], v[96:99], v[20:23]
v_mfma_f32_16x16x32_bf16 v[24:27], v[56:59], v[96:99], v[24:27]
L_kvs0:
s_bitcmp1_b32 s73, 1
s_cbranch_scc0 L_kvs1
s_waitcnt vmcnt(9)
v_max3_u32 v2, v100, v104, v108
v_max_u32 v2, v2, v112
v_cmp_eq_u32 vcc, -1, v2
s_cbranch_vccnz L_kvs1
s_bitset0_b32 s73, 1
v_mfma_f32_16x16x32_bf16 v[28:31], v[58:61], v[100:103], 0
v_mfma_f32_16x16x32_bf16 v[32:35], v[56:59], v[100:103], 0
v_mfma_f32_16x16x32_bf16 v[28:31], v[58:61], v[104:107], v[28:31]
v_mfma_f32_16x16x32_bf16 v[32:35], v[56:59], v[104:107], v[32:35]
v_mfma_f32_16x16x32_bf16 v[28:31], v[58:61], v[108:111], v[28:31]
v_mfma_f32_16x16x32_bf16 v[32:35], v[56:59], v[108:111], v[32:35]
v_mfma_f32_16x16x32_bf16 v[28:31], v[58:61], v[112:115], v[28:31]
v_mfma_f32_16x16x32_bf16 v[32:35], v[56:59], v[112:115], v[32:35]
L_kvs1:
s_bitcmp1_b32 s73, 2
s_cbranch_scc0 L_kvs2
s_waitcnt vmcnt(5)
v_max3_u32 v2, v116, v120, v124
v_max_u32 v2, v2, v128
v_cmp_eq_u32 vcc, -1, v2
s_cbranch_vccnz L_kvs2
s_bitset0_b32 s73, 2
v_mfma_f32_16x16x32_bf16 v[36:39], v[58:61], v[116:119], 0
v_mfma_f32_16x16x32_bf16 v[40:43], v[56:59], v[116:119], 0
v_mfma_f32_16x16x32_bf16 v[36:39], v[58:61], v[120:123], v[36:39]
v_mfma_f32_16x16x32_bf16 v[40:43], v[56:59], v[120:123], v[40:43]
v_mfma_f32_16x16x32_bf16 v[36:39], v[58:61], v[124:127], v[36:39]
v_mfma_f32_16x16x32_bf16 v[40:43], v[56:59], v[124:127], v[40:43]
v_mfma_f32_16x16x32_bf16 v[36:39], v[58:61], v[128:131], v[36:39]
v_mfma_f32_16x16x32_bf16 v[40:43], v[56:59], v[128:131], v[40:43]
L_kvs2:
s_bitcmp1_b32 s73, 3
s_cbranch_scc0 L_kvs3
s_waitcnt vmcnt(1)
v_max3_u32 v2, v132, v136, v140
v_max_u32 v2, v2, v144
v_cmp_eq_u32 vcc, -1, v2
s_cbranch_vccnz L_kvs3
s_bitset0_b32 s73, 3
v_mfma_f32_16x16x32_bf16 v[44:47], v[58:61], v[132:135], 0
v_mfma_f32_16x16x32_bf16 v[48:51], v[56:59], v[132:135], 0
v_mfma_f32_16x16x32_bf16 v[44:47], v[58:61], v[136:139], v[44:47]
v_mfma_f32_16x16x32_bf16 v[48:51], v[56:59], v[136:139], v[48:51]
v_mfma_f32_16x16x32_bf16 v[44:47], v[58:61], v[140:143], v[44:47]
v_mfma_f32_16x16x32_bf16 v[48:51], v[56:59], v[140:143], v[48:51]
v_mfma_f32_16x16x32_bf16 v[44:47], v[58:61], v[144:147], v[44:47]
v_mfma_f32_16x16x32_bf16 v[48:51], v[56:59], v[144:147], v[48:51]
L_kvs3:
s_bitcmp1_b32 s73, 4
s_cbranch_scc0 L_kvs4
s_waitcnt vmcnt(0)
v_xor_b32 v148, s84, v148
v_xor_b32 v149, s84, v149
v_xor_b32 v150, s84, v150
v_xor_b32 v151, s84, v151
v_or3_b32 v2, v148, v149, v150
v_bitop3_b32 v2, v2, v151, s91 bitop3:0xa8
v_cmp_ne_u32 vcc, 0, v2
s_cbranch_vccnz L_kvs4
s_bitset0_b32 s73, 4
v_add_f32_dpp v148, v148, v148 row_ror:1 row_mask:0xf bank_mask:0xf
v_add_f32_dpp v149, v149, v149 row_ror:1 row_mask:0xf bank_mask:0xf
v_add_f32_dpp v150, v150, v150 row_ror:1 row_mask:0xf bank_mask:0xf
v_add_f32_dpp v151, v151, v151 row_ror:1 row_mask:0xf bank_mask:0xf
v_add_f32_dpp v148, v148, v148 row_ror:2 row_mask:0xf bank_mask:0xf
v_add_f32_dpp v149, v149, v149 row_ror:2 row_mask:0xf bank_mask:0xf
v_add_f32_dpp v150, v150, v150 row_ror:2 row_mask:0xf bank_mask:0xf
v_add_f32_dpp v151, v151, v151 row_ror:2 row_mask:0xf bank_mask:0xf
v_add_f32_dpp v148, v148, v148 row_ror:4 row_mask:0xf bank_mask:0xf
v_add_f32_dpp v149, v149, v149 row_ror:4 row_mask:0xf bank_mask:0xf
v_add_f32_dpp v150, v150, v150 row_ror:4 row_mask:0xf bank_mask:0xf
v_add_f32_dpp v151, v151, v151 row_ror:4 row_mask:0xf bank_mask:0xf
v_add_f32_dpp v148, v148, v148 row_ror:8 row_mask:0xf bank_mask:0xf
v_add_f32_dpp v149, v149, v149 row_ror:8 row_mask:0xf bank_mask:0xf
v_add_f32_dpp v150, v150, v150 row_ror:8 row_mask:0xf bank_mask:0xf
v_add_f32_dpp v151, v151, v151 row_ror:8 row_mask:0xf bank_mask:0xf
v_cvt_pk_bf16_f32 v148, v148, v149
v_cvt_pk_bf16_f32 v149, v150, v151
ds_write_b64 v4, v[148:149]
L_kvs4:
s_cmp_lg_u32 s73, 0
s_cbranch_scc1 L_kvrt
L_kvok:
s_nop 3
v_pk_add_f32 v[20:21], v[20:21], v[28:29]
v_pk_add_f32 v[22:23], v[22:23], v[30:31]
v_pk_add_f32 v[24:25], v[24:25], v[32:33]
v_pk_add_f32 v[26:27], v[26:27], v[34:35]
v_pk_add_f32 v[36:37], v[36:37], v[44:45]
v_pk_add_f32 v[38:39], v[38:39], v[46:47]
v_pk_add_f32 v[40:41], v[40:41], v[48:49]
v_pk_add_f32 v[42:43], v[42:43], v[50:51]
v_pk_add_f32 v[20:21], v[20:21], v[36:37]
v_pk_add_f32 v[22:23], v[22:23], v[38:39]
v_pk_add_f32 v[24:25], v[24:25], v[40:41]
v_pk_add_f32 v[26:27], v[26:27], v[42:43]
v_cvt_pk_bf16_f32 v20, v20, v21
v_cvt_pk_bf16_f32 v21, v22, v23
v_cvt_pk_bf16_f32 v22, v24, v25
v_cvt_pk_bf16_f32 v23, v26, v27
ds_write_b128 v3, v[20:23]
s_waitcnt lgkmcnt(0)
s_barrier
s_mov_b32 exec_lo, 0x0
s_mov_b32 exec_hi, 0x3f000000
buffer_load_dword v81, v83, s[12:15], 0 offen
s_mov_b64 exec, -1
s_not_b32 s70, s68
v_mov_b32 v81, -1
v_writelane_b32 v81, s70, 62
v_writelane_b32 v81, s70, 63
s_mov_b32 exec_lo, 0
s_cmp_eq_u32 s69, 0
s_cselect_b32 exec_hi, 0, 0x3f000000
buffer_store_dword v81, v83, s[12:15], 0 offen offset:4
s_mov_b64 exec, -1
s_cmp_eq_u32 s60, 0
s_cbranch_scc1 L_pad2
s_cmp_eq_u32 s60, 1
s_cbranch_scc1 L_pad6
s_cmp_eq_u32 s60, 2
s_cbranch_scc1 L_pad7
s_branch L_pad9
L_retG:
v_lshrrev_b32 v2, 5, v1
v_lshlrev_b32 v2, 11, v2
v_bfe_u32 v3, v1, 3, 2
v_lshl_add_u32 v2, v3, 7, v2
v_bfe_u32 v3, v1, 4, 1
v_bfe_u32 v4, v1, 1, 2
v_xor_b32 v3, v3, v4
v_lshl_add_u32 v2, v3, 5, v2
v_and_b32 v3, 1, v1
v_lshl_add_u32 v2, v3, 4, v2
s_lshl_b32 s70, s60, 13
s_add_u32 s71, s70, 65536
v_add_u32 v100, s71, v2
v_xor_b32 v101, 64, v100
v_lshrrev_b32 v2, 2, v1
v_bfe_u32 v5, v1, 3, 2
v_xor_b32 v6, s60, v5
v_lshlrev_b32 v6, 5, v6
v_lshl_add_u32 v6, v2, 7, v6
v_and_b32 v7, 3, v1
v_lshl_add_u32 v6, v7, 3, v6
v_add_u32 v102, 65536, v6
s_lshl_b32 s71, s66, 16
s_add_u32 s70, s70, s71
s_add_u32 s70, s70, 49152
v_lshlrev_b32 v6, 5, v5
v_lshl_add_u32 v6, v2, 7, v6
v_lshl_add_u32 v6, v7, 3, v6
v_add_u32 v104, s70, v6
v_xor_b32 v105, 32, v104
v_xor_b32 v106, 64, v104
v_xor_b32 v107, 96, v104
v_lshrrev_b32 v5, 4, v1
v_xor_b32 v4, v4, v5
v_lshlrev_b32 v4, 5, v4
v_lshrrev_b32 v6, 3, v1
v_lshl_add_u32 v4, v6, 7, v4
v_lshl_add_u32 v4, v3, 4, v4
v_add_u32 v103, s70, v4
s_lshl_b32 s70, s60, 5
s_add_u32 s70, s70, 161792
v_mov_b32 v63, s70
v_add_u32 v114, 16, v63
v_lshl_add_u32 v56, v3, 4, v63
s_and_b32 s70, s65, 3
s_lshl_b32 s70, s70, 9
s_lshr_b32 s71, s62, 2
s_xor_b32 s71, s71, 0
s_lshl_b32 s71, s71, 13
s_add_u32 s71, s71, 8388608
s_xor_b32 s71, s71, s61
s_add_u32 s70, s70, s71
v_lshl_add_u32 v57, v5, 4, s70
v_lshlrev_b32 v60, 5, v5
v_lshl_add_u32 v60, v3, 4, v60
v_bfe_u32 v7, v1, 1, 1
v_lshl_add_u32 v60, v7, 7, v60
v_and_b32 v2, 3, v2
v_lshl_add_u32 v61, v2, 8, v60
v_lshlrev_b32 v62, 4, v3
v_lshl_add_u32 v62, v5, 5, v62
v_mov_b32 v59, s68
s_lshl_b32 s71, s79, 2
s_add_u32 s71, s71, s60
s_lshl_b32 s70, s71, 8
s_add_u32 s70, s70, 6946816
s_mov_b32 s85, s70
s_and_b32 s71, s65, 3
s_lshl2_add_u32 s71, s3, s71
s_and_b32 s70, s65, 12
s_add_u32 s70, s70, s60
s_lshl_b32 s71, s71, 7
s_bitcmp1_b32 s70, 3
s_cselect_b32 s72, 0, 8192
s_add_u32 s71, s71, s72
s_and_b32 s70, s70, 7
s_lshl_b32 s70, s70, 16
s_add_u32 s70, s70, s71
s_add_u32 s70, s70, 7340032
s_mov_b32 s88, s70
s_xor_b32 s88, s88, s61
s_lshl_b32 s70, s64, 14
s_add_u32 s86, s70, 6946816
s_and_b32 s70, s65, 3
v_mul_u32_u24 v2, 1, v7
v_xor_b32 v2, s70, v2
v_lshl_add_u32 v61, v2, 12, v61
s_lshl_b32 s87, s62, 11
s_xor_b32 s87, s87, 8192
s_add_u32 s87, s87, 6815744
s_xor_b32 s87, s87, s61
s_mov_b32 s94, 0
s_mov_b32 s95, 0
s_mov_b32 s92, 0x000f000f
s_mov_b32 s93, 0x000f000f
s_and_b32 s70, s65, 12
s_add_u32 s70, s70, s60
s_lshr_b32 s70, s70, 1
s_xor_b32 s24, s70, s62
s_xor_b32 s70, s69, 1
s_or_b32 s24, s24, s70
s_mov_b32 s32, 0xaaaaaaaa
s_mov_b32 s33, 0xaaaaaaaa
s_mov_b32 s38, 0
v_mov_b32 v64, 0x3f803f80
v_mov_b32 v65, 0x3f803f80
v_mov_b32 v66, 0x3f803f80
v_mov_b32 v67, 0x3f803f80
v_add_u32 v115, 64, v1
v_mov_b32 v2, 0
v_mov_b32 v95, 0
v_mov_b32 v99, 0
s_waitcnt vmcnt(0) lgkmcnt(0)
s_barrier
ds_write_b128 v100, a[0:3] offset:0
ds_write_b128 v101, a[4:7] offset:512
ds_write_b128 v100, a[8:11] offset:1024
ds_write_b128 v101, a[12:15] offset:1536
ds_write_b128 v100, a[16:19] offset:4096
ds_write_b128 v101, a[20:23] offset:4608
ds_write_b128 v100, a[24:27] offset:5120
ds_write_b128 v101, a[28:31] offset:5632
ds_write_b128 v100, a[32:35] offset:32768
ds_write_b128 v101, a[36:39] offset:33280
ds_write_b128 v100, a[40:43] offset:33792
ds_write_b128 v101, a[44:47] offset:34304
ds_write_b128 v100, a[48:51] offset:36864
ds_write_b128 v101, a[52:55] offset:37376
ds_write_b128 v100, a[56:59] offset:37888
ds_write_b128 v101, a[60:63] offset:38400
ds_write_b128 v103, a[64:67] offset:0
ds_write_b128 v103, a[68:71] offset:1024
ds_write_b128 v103, a[72:75] offset:2048
ds_write_b128 v103, a[76:79] offset:3072
ds_write_b128 v103, a[80:83] offset:4096
ds_write_b128 v103, a[84:87] offset:5120
ds_write_b128 v103, a[88:91] offset:6144
ds_write_b128 v103, a[92:95] offset:7168
s_waitcnt lgkmcnt(0)
ds_read_b64_tr_b16 a[64:65], v104 offset:0
ds_read_b64_tr_b16 a[66:67], v104 offset:2048
ds_read_b64_tr_b16 a[68:69], v104 offset:4096
ds_read_b64_tr_b16 a[70:71], v104 offset:6144
ds_read_b64_tr_b16 a[72:73], v105 offset:0
ds_read_b64_tr_b16 a[74:75], v105 offset:2048
ds_read_b64_tr_b16 a[76:77], v105 offset:4096
ds_read_b64_tr_b16 a[78:79], v105 offset:6144
ds_read_b64_tr_b16 a[80:81], v106 offset:0
ds_read_b64_tr_b16 a[82:83], v106 offset:2048
ds_read_b64_tr_b16 a[84:85], v106 offset:4096
ds_read_b64_tr_b16 a[86:87], v106 offset:6144
ds_read_b64_tr_b16 a[88:89], v107 offset:0
ds_read_b64_tr_b16 a[90:91], v107 offset:2048
ds_read_b64_tr_b16 a[92:93], v107 offset:4096
ds_read_b64_tr_b16 a[94:95], v107 offset:6144
s_barrier
ds_read_b64_tr_b16 a[0:1], v102 offset:0
ds_read_b64_tr_b16 a[2:3], v102 offset:2048
ds_read_b64_tr_b16 a[32:33], v102 offset:32768
ds_read_b64_tr_b16 a[34:35], v102 offset:34816
ds_read_b64_tr_b16 a[4:5], v102 offset:4096
ds_read_b64_tr_b16 a[6:7], v102 offset:6144
ds_read_b64_tr_b16 a[36:37], v102 offset:36864
ds_read_b64_tr_b16 a[38:39], v102 offset:38912
ds_read_b64_tr_b16 a[8:9], v102 offset:8192
ds_read_b64_tr_b16 a[10:11], v102 offset:10240
ds_read_b64_tr_b16 a[40:41], v102 offset:40960
ds_read_b64_tr_b16 a[42:43], v102 offset:43008
ds_read_b64_tr_b16 a[12:13], v102 offset:12288
ds_read_b64_tr_b16 a[14:15], v102 offset:14336
ds_read_b64_tr_b16 a[44:45], v102 offset:45056
ds_read_b64_tr_b16 a[46:47], v102 offset:47104
ds_read_b64_tr_b16 a[16:17], v102 offset:16384
ds_read_b64_tr_b16 a[18:19], v102 offset:18432
ds_read_b64_tr_b16 a[48:49], v102 offset:49152
ds_read_b64_tr_b16 a[50:51], v102 offset:51200
ds_read_b64_tr_b16 a[20:21], v102 offset:20480
ds_read_b64_tr_b16 a[22:23], v102 offset:22528
ds_read_b64_tr_b16 a[52:53], v102 offset:53248
ds_read_b64_tr_b16 a[54:55], v102 offset:55296
ds_read_b64_tr_b16 a[24:25], v102 offset:24576
ds_read_b64_tr_b16 a[26:27], v102 offset:26624
ds_read_b64_tr_b16 a[56:57], v102 offset:57344
ds_read_b64_tr_b16 a[58:59], v102 offset:59392
ds_read_b64_tr_b16 a[28:29], v102 offset:28672
ds_read_b64_tr_b16 a[30:31], v102 offset:30720
ds_read_b64_tr_b16 a[60:61], v102 offset:61440
ds_read_b64_tr_b16 a[62:63], v102 offset:63488
s_waitcnt lgkmcnt(0)
buffer_load_dwordx4 v[92:95], v18, s[12:15], s87 offen offset:0 sc1
buffer_load_dwordx4 v[96:99], v18, s[12:15], s87 offen offset:1024 sc1
v_mfma_f32_16x16x32_bf16 v[68:71], a[0:3], v[64:67], 0
v_mfma_f32_16x16x32_bf16 v[72:75], a[32:35], v[64:67], 0
v_mfma_f32_16x16x32_bf16 v[68:71], a[4:7], v[64:67], v[68:71]
v_mfma_f32_16x16x32_bf16 v[72:75], a[36:39], v[64:67], v[72:75]
v_mfma_f32_16x16x32_bf16 v[68:71], a[8:11], v[64:67], v[68:71]
v_mfma_f32_16x16x32_bf16 v[72:75], a[40:43], v[64:67], v[72:75]
v_mfma_f32_16x16x32_bf16 v[68:71], a[12:15], v[64:67], v[68:71]
v_mfma_f32_16x16x32_bf16 v[72:75], a[44:47], v[64:67], v[72:75]
v_mfma_f32_16x16x32_bf16 v[68:71], a[16:19], v[64:67], v[68:71]
v_mfma_f32_16x16x32_bf16 v[72:75], a[48:51], v[64:67], v[72:75]
v_mfma_f32_16x16x32_bf16 v[68:71], a[20:23], v[64:67], v[68:71]
v_mfma_f32_16x16x32_bf16 v[72:75], a[52:55], v[64:67], v[72:75]
v_mfma_f32_16x16x32_bf16 v[68:71], a[24:27], v[64:67], v[68:71]
v_mfma_f32_16x16x32_bf16 v[72:75], a[56:59], v[64:67], v[72:75]
v_mfma_f32_16x16x32_bf16 v[68:71], a[28:31], v[64:67], v[68:71]
v_mfma_f32_16x16x32_bf16 v[72:75], a[60:63], v[64:67], v[72:75]
L_pk:
s_waitcnt vmcnt(0)
L_pk2:
v_cmp_eq_u32_e64 s[80:81], s68, v95
v_cmp_eq_u32_e64 s[82:83], s68, v99
s_nop 0
v_cndmask_b32_e64 v108, 0, v92, s[80:81]
v_cndmask_b32_e64 v109, 0, v96, s[82:83]
s_and_b64 s[76:77], s[80:81], s[82:83]
v_max_u32 v110, v108, v109
v_min_u32 v111, v108, v109
s_cmp_eq_u64 s[76:77], -1
s_cselect_b32 s73, 0, 1
s_cbranch_scc1 L_pkc
s_not_b64 exec, s[80:81]
s_cselect_b64 exec, exec, 1
buffer_load_dwordx4 v[92:95], v18, s[12:15], s87 offen offset:0 sc1
s_not_b64 exec, s[82:83]
s_cselect_b64 exec, exec, 1
buffer_load_dwordx4 v[96:99], v18, s[12:15], s87 offen offset:1024 sc1
s_mov_b64 exec, -1
L_pkc:
v_cmp_le_u32 vcc, s95, v110
v_cmp_le_u32_e64 s[76:77], s95, v111
s_bcnt1_i32_b64 s70, vcc
s_bcnt1_i32_b64 s71, s[76:77]
s_add_u32 s70, s70, s71
s_cmp_eq_u32 s70, 2
s_cbranch_scc1 L_pksame
v_mov_b32_dpp v112, v110 row_ror:1 row_mask:0xf bank_mask:0xf
v_max_u32_dpp v113, v111, v111 row_ror:1 row_mask:0xf bank_mask:0xf
v_med3_u32 v111, v110, v112, v113
v_max_u32 v110, v110, v112
s_nop 1
v_mov_b32_dpp v112, v110 row_ror:2 row_mask:0xf bank_mask:0xf
v_max_u32_dpp v113, v111, v111 row_ror:2 row_mask:0xf bank_mask:0xf
v_med3_u32 v111, v110, v112, v113
v_max_u32 v110, v110, v112
s_nop 1
v_mov_b32_dpp v112, v110 row_ror:4 row_mask:0xf bank_mask:0xf
v_max_u32_dpp v113, v111, v111 row_ror:4 row_mask:0xf bank_mask:0xf
v_med3_u32 v111, v110, v112, v113
v_max_u32 v110, v110, v112
s_nop 1
v_mov_b32_dpp v112, v110 row_ror:8 row_mask:0xf bank_mask:0xf
v_max_u32_dpp v113, v111, v111 row_ror:8 row_mask:0xf bank_mask:0xf
v_med3_u32 v111, v110, v112, v113
v_max_u32 v110, v110, v112
v_mov_b32 v112, v110
v_mov_b32 v113, v111
s_nop 0
v_permlane16_swap_b32 v110, v112
v_permlane16_swap_b32 v111, v113
v_max_u32 v113, v111, v113
v_med3_u32 v111, v110, v112, v113
v_max_u32 v110, v110, v112
v_mov_b32 v112, v110
v_mov_b32 v113, v111
s_nop 0
v_permlane32_swap_b32 v110, v112
v_permlane32_swap_b32 v111, v113
v_max_u32 v113, v111, v113
v_med3_u32 v111, v110, v112, v113
v_max_u32 v110, v110, v112
v_readfirstlane_b32 s95, v111
s_nop 0
s_cmp_eq_u32 s95, 0
s_cbranch_scc1 L_pksame
v_cndmask_b32_e64 v58, v110, v111, s[32:33]
v_and_b32 v58, 127, v58
v_lshl_add_u32 v58, v58, 14, v57
s_mov_b64 exec, s[92:93]
buffer_load_dwordx4 v[24:27], v58, s[12:15], 0 offen offset:0 sc1
buffer_load_dwordx4 v[28:31], v58, s[12:15], 0 offen offset:64 sc1
buffer_load_dwordx4 v[32:35], v58, s[12:15], 0 offen offset:128 sc1
buffer_load_dwordx4 v[36:39], v58, s[12:15], 0 offen offset:192 sc1
buffer_load_dwordx4 v[40:43], v58, s[12:15], 0 offen offset:256 sc1
buffer_load_dwordx4 v[44:47], v58, s[12:15], 0 offen offset:320 sc1
buffer_load_dwordx4 v[48:51], v58, s[12:15], 0 offen offset:384 sc1
buffer_load_dwordx4 v[52:55], v58, s[12:15], 0 offen offset:448 sc1
s_mov_b64 exec, -1
v_cmp_eq_u32 vcc, v108, v111
v_cmp_eq_u32_e64 s[76:77], v108, v110
s_nop 0
v_cndmask_b32 v112, v63, v114, vcc
s_or_b64 exec, vcc, s[76:77]
ds_write_b96 v112, v[92:94]
s_mov_b64 exec, -1
v_cmp_eq_u32 vcc, v109, v111
v_cmp_eq_u32_e64 s[76:77], v109, v110
s_nop 0
v_cndmask_b32 v113, v63, v114, vcc
s_or_b64 exec, vcc, s[76:77]
ds_write_b96 v113, v[96:98]
s_mov_b64 exec, -1
ds_read_b96 v[20:22], v56
s_waitcnt lgkmcnt(0)
v_mul_f32_e64 v84, v68, -v21
v_mul_f32_e64 v85, v69, -v21
v_mul_f32_e64 v86, v70, -v21
v_mul_f32_e64 v87, v71, -v21
v_mul_f32_e64 v88, v72, -v21
v_mul_f32_e64 v89, v73, -v21
v_mul_f32_e64 v90, v74, -v21
v_mul_f32_e64 v91, v75, -v21
s_cmp_eq_u32 s73, 0
s_cbranch_scc1 L_pkf
s_waitcnt vmcnt(8)
s_add_u32 s78, s78, 1
s_cmp_le_u32 s78, 65536
s_cbranch_scc1 L_pk2
L_pkf:
s_waitcnt vmcnt(7)
v_mfma_f32_16x16x32_bf16 v[84:87], a[0:3], v[24:27], v[84:87]
v_mfma_f32_16x16x32_bf16 v[88:91], a[32:35], v[24:27], v[88:91]
s_waitcnt vmcnt(6)
v_mfma_f32_16x16x32_bf16 v[84:87], a[4:7], v[28:31], v[84:87]
v_mfma_f32_16x16x32_bf16 v[88:91], a[36:39], v[28:31], v[88:91]
s_waitcnt vmcnt(5)
v_mfma_f32_16x16x32_bf16 v[84:87], a[8:11], v[32:35], v[84:87]
v_max3_u32 v2, v24, v28, v32
v_mfma_f32_16x16x32_bf16 v[88:91], a[40:43], v[32:35], v[88:91]
s_waitcnt vmcnt(4)
v_mfma_f32_16x16x32_bf16 v[84:87], a[12:15], v[36:39], v[84:87]
v_mfma_f32_16x16x32_bf16 v[88:91], a[44:47], v[36:39], v[88:91]
s_waitcnt vmcnt(3)
v_mfma_f32_16x16x32_bf16 v[84:87], a[16:19], v[40:43], v[84:87]
v_mfma_f32_16x16x32_bf16 v[88:91], a[48:51], v[40:43], v[88:91]
s_waitcnt vmcnt(2)
v_mfma_f32_16x16x32_bf16 v[84:87], a[20:23], v[44:47], v[84:87]
v_max3_u32 v3, v36, v40, v44
v_mfma_f32_16x16x32_bf16 v[88:91], a[52:55], v[44:47], v[88:91]
s_waitcnt vmcnt(1)
v_mfma_f32_16x16x32_bf16 v[84:87], a[24:27], v[48:51], v[84:87]
v_mfma_f32_16x16x32_bf16 v[88:91], a[56:59], v[48:51], v[88:91]
s_waitcnt vmcnt(0)
v_mfma_f32_16x16x32_bf16 v[84:87], a[28:31], v[52:55], v[84:87]
v_max3_u32 v2, v2, v48, v52
v_max_u32 v2, v2, v3
v_cmp_eq_u32 vcc, -1, v2
v_mfma_f32_16x16x32_bf16 v[88:91], a[60:63], v[52:55], v[88:91]
s_and_b64 vcc, vcc, s[92:93]
s_cbranch_vccnz L_pkx_rt
L_pkx_ok:
s_mov_b32 s76, 0xcccccccc
s_mov_b32 s77, 0xcccccccc
s_nop 3
v_cndmask_b32_e64 v84, v84, v88, s[76:77]
v_cndmask_b32_e64 v85, v85, v89, s[76:77]
v_cndmask_b32_e64 v86, v86, v90, s[76:77]
v_cndmask_b32_e64 v87, v87, v91, s[76:77]
v_bfi_b32 v84, s91, v59, v84
s_mov_b64 exec, s[92:93]
s_cmp_eq_u32 s69, 0
s_cbranch_scc1 L_pxp_s
buffer_store_dwordx4 v[84:87], v60, s[12:15], s85 offen
L_pxp_d:
s_mov_b64 exec, -1
s_barrier
s_load_dword s70, s[12:13], 41152
s_waitcnt lgkmcnt(0)
buffer_load_dwordx4 v[24:27], v61, s[12:15], s86 offen offset:0 sc1
buffer_load_dwordx4 v[28:31], v61, s[12:15], s86 offen offset:1024 sc1
buffer_load_dwordx4 v[32:35], v61, s[12:15], s86 offen offset:2048 sc1
buffer_load_dwordx4 v[36:39], v61, s[12:15], s86 offen offset:3072 sc1
s_mov_b32 s92, 0x00030003
s_mov_b32 s93, 0x00030003
s_waitcnt vmcnt(0)
L_px_chk:
v_xor_b32 v24, s84, v24
v_xor_b32 v28, s84, v28
v_xor_b32 v32, s84, v32
v_xor_b32 v36, s84, v36
v_or3_b32 v2, v24, v28, v32
v_bitop3_b32 v2, v2, v36, s91 bitop3:0xa8
v_cmp_ne_u32 vcc, 0, v2
s_cbranch_vccnz L_px_rt
L_px_ok:
v_pk_add_f32 v[24:25], v[24:25], v[28:29]
v_pk_add_f32 v[32:33], v[32:33], v[36:37]
v_pk_add_f32 v[26:27], v[26:27], v[30:31]
v_pk_add_f32 v[34:35], v[34:35], v[38:39]
v_pk_add_f32 v[24:25], v[24:25], v[32:33]
v_pk_add_f32 v[26:27], v[26:27], v[34:35]
v_pk_mul_f32 v[24:25], v[24:25], v[22:23] op_sel_hi:[1,0]
v_pk_mul_f32 v[26:27], v[26:27], v[22:23] op_sel_hi:[1,0]
s_not_b64 vcc, s[76:77]
v_mul_f32_dpp v32, v24, v24 quad_perm:[2,3,0,1] row_mask:0xf bank_mask:0xf
v_mul_f32_dpp v33, v25, v25 quad_perm:[2,3,0,1] row_mask:0xf bank_mask:0xf
v_mul_f32_dpp v34, v26, v26 quad_perm:[2,3,0,1] row_mask:0xf bank_mask:0xf
v_mul_f32_dpp v35, v27, v27 quad_perm:[2,3,0,1] row_mask:0xf bank_mask:0xf
v_cndmask_b32_dpp v28, v26, v24, vcc quad_perm:[2,3,0,1] row_mask:0xf bank_mask:0xf
v_cndmask_b32_dpp v29, v27, v25, vcc quad_perm:[2,3,0,1] row_mask:0xf bank_mask:0xf
v_mul_f32 v28, 0xbfb8aa3b, v28
v_mul_f32 v29, 0xbfb8aa3b, v29
v_exp_f32 v28, v28
v_exp_f32 v29, v29
v_cndmask_b32 v32, v34, v32, vcc
v_cndmask_b32 v33, v35, v33, vcc
v_add_f32 v28, 1.0, v28
v_add_f32 v29, 1.0, v29
v_rcp_f32 v28, v28
v_rcp_f32 v29, v29
v_mul_f32 v24, v32, v28
v_mul_f32 v25, v33, v29
v_cvt_pk_bf16_f32 v28, v24, v25
s_nop 1
v_mov_b32_dpp v30, v28 row_shl:4 row_mask:0xf bank_mask:0xf
v_mov_b32_dpp v32, v28 row_shl:8 row_mask:0xf bank_mask:0xf
v_mov_b32_dpp v34, v28 row_shl:12 row_mask:0xf bank_mask:0xf
v_mov_b32_dpp v29, v28 row_shl:2 row_mask:0xf bank_mask:0xf
v_mov_b32_dpp v31, v28 row_shl:6 row_mask:0xf bank_mask:0xf
v_mov_b32_dpp v33, v28 row_shl:10 row_mask:0xf bank_mask:0xf
v_mov_b32_dpp v35, v28 row_shl:14 row_mask:0xf bank_mask:0xf
v_mfma_f32_16x16x32_bf16 v[40:43], a[64:67], v[28:31], 0
v_mfma_f32_16x16x32_bf16 v[44:47], a[72:75], v[28:31], 0
v_mfma_f32_16x16x32_bf16 v[40:43], a[68:71], v[32:35], v[40:43]
v_mfma_f32_16x16x32_bf16 v[44:47], a[76:79], v[32:35], v[44:47]
v_mfma_f32_16x16x32_bf16 v[48:51], a[80:83], v[28:31], 0
v_mfma_f32_16x16x32_bf16 v[52:55], a[88:91], v[28:31], 0
v_mfma_f32_16x16x32_bf16 v[48:51], a[84:87], v[32:35], v[48:51]
v_mfma_f32_16x16x32_bf16 v[52:55], a[92:95], v[32:35], v[52:55]
s_cmp_ge_u32 s3, 14
s_cbranch_scc1 L_noy
s_mov_b64 exec, s[92:93]
s_cmp_eq_u32 s24, 0
s_cbranch_scc1 L_yown
v_bfi_b32 v40, s91, v59, v40
buffer_store_dwordx4 v[40:43], v62, s[12:15], s88 offen sc1
s_add_u32 s88, s88, 16384
v_bfi_b32 v44, s91, v59, v44
buffer_store_dwordx4 v[44:47], v62, s[12:15], s88 offen sc1
s_add_u32 s88, s88, 16384
v_bfi_b32 v48, s91, v59, v48
buffer_store_dwordx4 v[48:51], v62, s[12:15], s88 offen sc1
s_add_u32 s88, s88, 16384
v_bfi_b32 v52, s91, v59, v52
buffer_store_dwordx4 v[52:55], v62, s[12:15], s88 offen sc1
L_yd:
s_mov_b64 exec, -1
L_noy:
s_or_b32 s70, s2, s60
s_branch L_over2
L_pad2:
s_branch L_pad10
L_over2:
s_cbranch_scc1 L_noep
v_mov_b32 v3, 0
s_mov_b64 exec, 1
buffer_store_dword v59, v3, s[12:15], 0 offen sc1
s_mov_b64 exec, -1
L_noep:
s_cmp_lt_u32 s63, 24
s_cbranch_scc1 L_ldone
s_cmp_lg_u32 s60, 1
s_cbranch_scc1 L_ldone
s_lshl_b32 s87, s62, 3
s_add_u32 s87, s87, s63
s_sub_u32 s87, s87, 24
s_and_b32 s88, s87, 31
s_lshl_b32 s88, s88, 14
s_bitcmp1_b32 s87, 5
s_cselect_b32 s70, 0, 8192
s_add_u32 s88, s88, s70
s_add_u32 s88, s88, 7340032
s_xor_b32 s88, s88, s61
s_add_u32 s71, s88, 4096
s_lshl_b32 s70, s87, 5
v_bfe_u32 v3, v1, 1, 2
v_lshl_add_u32 v7, v3, 3, s70
s_lshr_b32 s72, s62, 2
s_xor_b32 s72, s72, 0
s_lshl_b32 s72, s72, 13
s_add_u32 s72, s72, 8388608
s_xor_b32 s72, s72, s61
v_lshrrev_b32 v3, 4, v1
v_lshl_add_u32 v7, v3, 1, v7
v_and_b32 v64, 127, v20
v_lshl_add_u32 v64, v64, 14, v7
buffer_load_ushort v84, v64, s[12:15], s72 offen sc1
buffer_load_dwordx4 v[120:123], v18, s[12:15], s88 offen offset:0 sc1
buffer_load_dwordx4 v[124:127], v18, s[12:15], s88 offen offset:1024 sc1
buffer_load_dwordx4 v[128:131], v18, s[12:15], s88 offen offset:2048 sc1
buffer_load_dwordx4 v[132:135], v18, s[12:15], s88 offen offset:3072 sc1
buffer_load_dwordx4 v[136:139], v18, s[12:15], s71 offen offset:0 sc1
buffer_load_dwordx4 v[140:143], v18, s[12:15], s71 offen offset:1024 sc1
buffer_load_dwordx4 v[144:147], v18, s[12:15], s71 offen offset:2048 sc1
v_mov_b32 v88, s84
v_and_b32 v65, 0xfffff000, v20
v_not_b32 v4, v65
v_ashrrev_i32 v4, 31, v4
v_or_b32 v4, 0x80000000, v4
v_xor_b32 v65, v65, v4
v_mul_f32 v65, 0xbfb8aa3b, v65
v_exp_f32 v65, v65
s_nop 0
v_add_f32 v65, 1.0, v65
v_rcp_f32 v65, v65
v_bfe_u32 v66, v20, 1, 6
v_lshl_add_u32 v66, v66, 16, v7
v_bfe_u32 v4, v20, 7, 5
v_lshl_add_u32 v66, v4, 11, v66
v_add_f32 v67, 1.0, v22
v_mul_f32_e64 v21, -v21, v22
s_load_dword s94, s[12:13], 4096
s_waitcnt lgkmcnt(0)
buffer_load_dwordx4 v[24:27], v18, s[12:15], s88 offen offset:0 sc1
buffer_load_dwordx4 v[28:31], v18, s[12:15], s88 offen offset:1024 sc1
buffer_load_dwordx4 v[32:35], v18, s[12:15], s88 offen offset:2048 sc1
buffer_load_dwordx4 v[36:39], v18, s[12:15], s88 offen offset:3072 sc1
buffer_load_dwordx4 v[92:95], v18, s[12:15], s71 offen offset:0 sc1
buffer_load_dwordx4 v[96:99], v18, s[12:15], s71 offen offset:1024 sc1
buffer_load_dwordx4 v[100:103], v18, s[12:15], s71 offen offset:2048 sc1
s_load_dword s94, s[12:13], 4160
s_waitcnt lgkmcnt(0)
buffer_load_dwordx4 v[40:43], v18, s[12:15], s88 offen offset:0 sc1
buffer_load_dwordx4 v[44:47], v18, s[12:15], s88 offen offset:1024 sc1
buffer_load_dwordx4 v[48:51], v18, s[12:15], s88 offen offset:2048 sc1
buffer_load_dwordx4 v[52:55], v18, s[12:15], s88 offen offset:3072 sc1
buffer_load_dwordx4 v[104:107], v18, s[12:15], s71 offen offset:0 sc1
buffer_load_dwordx4 v[108:111], v18, s[12:15], s71 offen offset:1024 sc1
buffer_load_dwordx4 v[112:115], v18, s[12:15], s71 offen offset:2048 sc1
s_waitcnt vmcnt(21)
L_h_chk:
v_cmp_eq_u32 vcc, 0xffff, v84
s_cbranch_vccnz L_h_rt
L_h_ok:
v_lshlrev_b32 v84, 16, v84
v_fma_f32 v84, v84, v67, v21
L_yr:
s_waitcnt vmcnt(14)
v_xor_b32 v120, s84, v120
v_xor_b32 v124, s84, v124
v_xor_b32 v128, s84, v128
v_xor_b32 v132, s84, v132
v_or3_b32 v2, v120, v124, v128
v_xor_b32 v136, s84, v136
v_xor_b32 v140, s84, v140
v_or3_b32 v2, v2, v132, v136
v_xor_b32 v144, s84, v144
v_xor_b32 v88, s84, v88
v_or3_b32 v2, v2, v140, v144
v_bitop3_b32 v2, v2, v88, s91 bitop3:0xa8
v_cmp_ne_u32 vcc, 0, v2
s_cbranch_vccnz L_y_rt
L_yf0:
v_pk_add_f32 v[120:121], v[120:121], v[124:125]
v_pk_add_f32 v[122:123], v[122:123], v[126:127]
v_pk_add_f32 v[128:129], v[128:129], v[132:133]
v_pk_add_f32 v[130:131], v[130:131], v[134:135]
v_pk_add_f32 v[136:137], v[136:137], v[140:141]
v_pk_add_f32 v[138:139], v[138:139], v[142:143]
v_pk_add_f32 v[120:121], v[120:121], v[128:129]
v_pk_add_f32 v[122:123], v[122:123], v[130:131]
v_pk_add_f32 v[136:137], v[136:137], v[144:145]
v_pk_add_f32 v[138:139], v[138:139], v[146:147]
v_pk_add_f32 v[120:121], v[120:121], v[136:137]
v_pk_add_f32 v[122:123], v[122:123], v[138:139]
s_nop 1
v_permlane32_swap_b32 v120, v122
v_permlane32_swap_b32 v121, v123
v_add_f32 v68, v120, v122
v_add_f32 v69, v121, v123
L_yf:
s_nop 1
v_permlane16_swap_b32 v68, v69
v_add_f32 v68, v68, v69
s_mov_b32 s72, 0x00ff00ff
s_mov_b32 s73, 0x00ff00ff
v_add_f32_dpp v68, v68, v68 row_ror:8 row_mask:0xf bank_mask:0xf
v_fmac_f32 v84, v68, v65
v_cvt_pk_bf16_f32 v84, v84, v84
s_mov_b64 exec, s[72:73]
buffer_store_short v84, v66, s[20:23], 0 offen sc1
L_ldone:
s_endpgm
.p2alignl 12, 0xbf810000
.fill 0, 4, 0xbf810000
L_compute:
v_and_b32 v2, 15, v1
v_lshrrev_b32 v4, 4, v1
v_lshrrev_b32 v3, 1, v2
v_xor_b32 v3, v3, v4
v_lshlrev_b32 v2, 7, v2
s_lshl_b32 s70, s66, 13
v_add_u32 v2, s70, v2
v_xor_b32 v5, 0, v3
v_lshl_add_u32 v8, v5, 4, v2
v_add_u32 v10, 65536, v8
v_xor_b32 v5, 4, v3
v_lshl_add_u32 v9, v5, 4, v2
v_add_u32 v11, 65536, v9
v_lshrrev_b32 v2, 5, v1
v_mul_u32_u24 v2, 6144, v2
v_bfe_u32 v3, v1, 4, 1
v_lshl_add_u32 v2, v3, 10, v2
v_bfe_u32 v4, v1, 2, 2
v_lshl_add_u32 v2, v4, 7, v2
v_lshlrev_b32 v3, 1, v3
v_bfe_u32 v4, v1, 3, 1
v_or_b32 v3, v3, v4
s_lshl_b32 s70, s67, 1
v_xor_b32 v3, s70, v3
v_and_b32 v4, 3, v1
v_lshl_add_u32 v2, v4, 3, v2
v_xor_b32 v4, 0, v3
v_lshl_add_u32 v12, v4, 5, v2
v_add_u32 v14, 65536, v12
v_xor_b32 v4, 1, v3
v_lshl_add_u32 v13, v4, 5, v2
v_add_u32 v15, 65536, v13
s_waitcnt lgkmcnt(0)
s_mov_b32 s12, s58
s_and_b32 s13, s59, 0xffff
s_mov_b32 s14, 268435456
s_mov_b32 s15, 0x20000
s_load_dword s68, s[58:59], 0
s_mov_b32 s20, s56
s_and_b32 s21, s57, 0xffff
s_mov_b32 s22, 4194304
s_mov_b32 s23, 0x20000
s_lshl_b32 s87, s64, 4
s_add_u32 s87, s87, s65
s_mul_i32 s87, s87, 4352
s_add_u32 s87, s87, 524288
s_and_b32 s88, s65, 7
s_lshl_b32 s88, s88, 19
s_lshr_b32 s70, s65, 1
s_xor_b32 s70, s70, s65
s_and_b32 s70, s70, 4
s_lshl_b32 s70, s70, 11
s_xor_b32 s70, s70, 2105344
s_add_u32 s88, s88, s70
s_mul_i32 s70, s66, 262144
s_add_u32 s88, s88, s70
s_lshr_b32 s70, s64, 2
s_lshl_b32 s70, s70, 14
s_add_u32 s88, s88, s70
s_and_b32 s70, s64, 3
s_lshl_b32 s70, s70, 11
s_add_u32 s88, s88, s70
s_lshl_b32 s70, s67, 10
s_add_u32 s88, s88, s70
s_mov_b32 s70, 0x3f803f80
v_accvgpr_write_b32 a80, s70
v_accvgpr_write_b32 a81, s70
v_accvgpr_write_b32 a82, s70
v_accvgpr_write_b32 a83, s70
s_mov_b32 s80, 0x358637bd
s_mov_b32 s81, 0x358637bd
s_mov_b32 s82, 0x3f800008
s_mov_b32 s83, 0x3f800008
s_mov_b32 s90, 0x3fb8aa3b
s_mov_b32 s91, 0x3fb8aa3b
s_waitcnt lgkmcnt(0)
s_add_u32 s68, s68, 1
v_and_b32 v7, 3, v1
v_lshrrev_b32_e64 v7, v7, s68
v_and_b32 v7, 1, v7
v_mul_u32_u24 v7, 0x10001, v7
s_mov_b32 s76, 0x10001
s_mov_b32 s77, 0x07060302
s_movk_i32 s85, 0xff
v_mov_b32 v28, -1
v_mov_b32 v29, -1
v_mov_b32 v30, -1
v_mov_b32 v31, -1
s_and_b32 s94, s65, 3
s_or_b32 s94, s94, s66
s_barrier
ds_read_b128 a[0:3], v10 offset:57344
ds_read_b64_tr_b16 a[32:33], v12 offset:0
ds_read_b64_tr_b16 a[34:35], v12 offset:512
ds_read_b128 a[4:7], v10 offset:59392
ds_read_b128 a[8:11], v10 offset:61440
ds_read_b128 a[12:15], v10 offset:63488
ds_read_b64_tr_b16 a[36:37], v13 offset:0
ds_read_b64_tr_b16 a[38:39], v13 offset:512
ds_read_b64_tr_b16 a[40:41], v12 offset:2048
ds_read_b64_tr_b16 a[42:43], v12 offset:2560
ds_read_b64_tr_b16 a[44:45], v13 offset:2048
ds_read_b64_tr_b16 a[46:47], v13 offset:2560
ds_read_b64_tr_b16 a[48:49], v12 offset:4096
ds_read_b64_tr_b16 a[50:51], v12 offset:4608
ds_read_b64_tr_b16 a[52:53], v13 offset:4096
ds_read_b64_tr_b16 a[54:55], v13 offset:4608
s_waitcnt lgkmcnt(0)
s_cmp_lg_u32 s94, 0
s_cbranch_scc1 L_nocs0_0
v_mfma_f32_16x16x32_bf16 v[128:131], a[80:83], a[32:35], 0
v_mfma_f32_16x16x32_bf16 v[132:135], a[80:83], a[36:39], 0
v_mfma_f32_16x16x32_bf16 v[136:139], a[80:83], a[40:43], 0
v_mfma_f32_16x16x32_bf16 v[140:143], a[80:83], a[44:47], 0
v_mfma_f32_16x16x32_bf16 v[144:147], a[80:83], a[48:51], 0
v_mfma_f32_16x16x32_bf16 v[148:151], a[80:83], a[52:55], 0
L_nocs0_0:
v_mfma_f32_16x16x32_bf16 v[32:35], a[32:35], a[0:3], 0
ds_read_b128 a[16:19], v11 offset:57344
v_mfma_f32_16x16x32_bf16 v[56:59], a[32:35], a[4:7], 0
ds_read_b64_tr_b16 a[56:57], v12 offset:12288
v_mfma_f32_16x16x32_bf16 v[80:83], a[32:35], a[8:11], 0
ds_read_b64_tr_b16 a[58:59], v12 offset:12800
v_mfma_f32_16x16x32_bf16 v[104:107], a[32:35], a[12:15], 0
ds_read_b128 a[20:23], v11 offset:59392
v_mfma_f32_16x16x32_bf16 v[36:39], a[36:39], a[0:3], 0
ds_read_b128 a[24:27], v11 offset:61440
v_mfma_f32_16x16x32_bf16 v[60:63], a[36:39], a[4:7], 0
ds_read_b128 a[28:31], v11 offset:63488
v_mfma_f32_16x16x32_bf16 v[84:87], a[36:39], a[8:11], 0
ds_read_b64_tr_b16 a[60:61], v13 offset:12288
v_mfma_f32_16x16x32_bf16 v[108:111], a[36:39], a[12:15], 0
ds_read_b64_tr_b16 a[62:63], v13 offset:12800
v_mfma_f32_16x16x32_bf16 v[40:43], a[0:3], a[40:43], 0
ds_read_b64_tr_b16 a[64:65], v12 offset:14336
v_mfma_f32_16x16x32_bf16 v[64:67], a[4:7], a[40:43], 0
ds_read_b64_tr_b16 a[66:67], v12 offset:14848
v_mfma_f32_16x16x32_bf16 v[88:91], a[8:11], a[40:43], 0
ds_read_b64_tr_b16 a[68:69], v13 offset:14336
v_mfma_f32_16x16x32_bf16 v[112:115], a[12:15], a[40:43], 0
ds_read_b64_tr_b16 a[70:71], v13 offset:14848
v_mfma_f32_16x16x32_bf16 v[44:47], a[0:3], a[44:47], 0
ds_read_b64_tr_b16 a[72:73], v12 offset:16384
v_mfma_f32_16x16x32_bf16 v[68:71], a[4:7], a[44:47], 0
ds_read_b64_tr_b16 a[74:75], v12 offset:16896
v_mfma_f32_16x16x32_bf16 v[92:95], a[8:11], a[44:47], 0
ds_read_b64_tr_b16 a[76:77], v13 offset:16384
v_mfma_f32_16x16x32_bf16 v[116:119], a[12:15], a[44:47], 0
ds_read_b64_tr_b16 a[78:79], v13 offset:16896
v_mfma_f32_16x16x32_bf16 v[48:51], a[0:3], a[48:51], 0
v_mfma_f32_16x16x32_bf16 v[72:75], a[4:7], a[48:51], 0
v_mfma_f32_16x16x32_bf16 v[96:99], a[8:11], a[48:51], 0
v_mfma_f32_16x16x32_bf16 v[120:123], a[12:15], a[48:51], 0
v_mfma_f32_16x16x32_bf16 v[52:55], a[0:3], a[52:55], 0
v_mfma_f32_16x16x32_bf16 v[76:79], a[4:7], a[52:55], 0
v_mfma_f32_16x16x32_bf16 v[100:103], a[8:11], a[52:55], 0
v_mfma_f32_16x16x32_bf16 v[124:127], a[12:15], a[52:55], 0
s_waitcnt lgkmcnt(0)
s_cmp_lg_u32 s94, 0
s_cbranch_scc1 L_nocs0_1
v_mfma_f32_16x16x32_bf16 v[128:131], a[80:83], a[56:59], v[128:131]
v_mfma_f32_16x16x32_bf16 v[132:135], a[80:83], a[60:63], v[132:135]
v_mfma_f32_16x16x32_bf16 v[136:139], a[80:83], a[64:67], v[136:139]
v_mfma_f32_16x16x32_bf16 v[140:143], a[80:83], a[68:71], v[140:143]
v_mfma_f32_16x16x32_bf16 v[144:147], a[80:83], a[72:75], v[144:147]
v_mfma_f32_16x16x32_bf16 v[148:151], a[80:83], a[76:79], v[148:151]
L_nocs0_1:
v_mfma_f32_16x16x32_bf16 v[32:35], a[56:59], a[16:19], v[32:35]
s_barrier
ds_read_b128 a[0:3], v10 offset:40960
v_mfma_f32_16x16x32_bf16 v[56:59], a[56:59], a[20:23], v[56:59]
ds_read_b64_tr_b16 a[32:33], v14 offset:16384
v_mfma_f32_16x16x32_bf16 v[80:83], a[56:59], a[24:27], v[80:83]
ds_read_b64_tr_b16 a[34:35], v14 offset:16896
v_mfma_f32_16x16x32_bf16 v[104:107], a[56:59], a[28:31], v[104:107]
ds_read_b128 a[4:7], v10 offset:43008
v_mfma_f32_16x16x32_bf16 v[36:39], a[60:63], a[16:19], v[36:39]
ds_read_b128 a[8:11], v10 offset:45056
v_mfma_f32_16x16x32_bf16 v[60:63], a[60:63], a[20:23], v[60:63]
ds_read_b128 a[12:15], v10 offset:47104
v_mfma_f32_16x16x32_bf16 v[84:87], a[60:63], a[24:27], v[84:87]
ds_read_b64_tr_b16 a[36:37], v15 offset:16384
v_mfma_f32_16x16x32_bf16 v[108:111], a[60:63], a[28:31], v[108:111]
ds_read_b64_tr_b16 a[38:39], v15 offset:16896
v_mfma_f32_16x16x32_bf16 v[40:43], a[16:19], a[64:67], v[40:43]
ds_read_b64_tr_b16 a[40:41], v14 offset:18432
v_mfma_f32_16x16x32_bf16 v[64:67], a[20:23], a[64:67], v[64:67]
ds_read_b64_tr_b16 a[42:43], v14 offset:18944
v_mfma_f32_16x16x32_bf16 v[88:91], a[24:27], a[64:67], v[88:91]
ds_read_b64_tr_b16 a[44:45], v15 offset:18432
v_mfma_f32_16x16x32_bf16 v[112:115], a[28:31], a[64:67], v[112:115]
ds_read_b64_tr_b16 a[46:47], v15 offset:18944
v_mfma_f32_16x16x32_bf16 v[44:47], a[16:19], a[68:71], v[44:47]
ds_read_b64_tr_b16 a[48:49], v14 offset:20480
v_mfma_f32_16x16x32_bf16 v[68:71], a[20:23], a[68:71], v[68:71]
ds_read_b64_tr_b16 a[50:51], v14 offset:20992
v_mfma_f32_16x16x32_bf16 v[92:95], a[24:27], a[68:71], v[92:95]
ds_read_b64_tr_b16 a[52:53], v15 offset:20480
v_mfma_f32_16x16x32_bf16 v[116:119], a[28:31], a[68:71], v[116:119]
ds_read_b64_tr_b16 a[54:55], v15 offset:20992
v_mfma_f32_16x16x32_bf16 v[48:51], a[16:19], a[72:75], v[48:51]
v_mfma_f32_16x16x32_bf16 v[72:75], a[20:23], a[72:75], v[72:75]
v_mfma_f32_16x16x32_bf16 v[96:99], a[24:27], a[72:75], v[96:99]
v_mfma_f32_16x16x32_bf16 v[120:123], a[28:31], a[72:75], v[120:123]
v_mfma_f32_16x16x32_bf16 v[52:55], a[16:19], a[76:79], v[52:55]
v_mfma_f32_16x16x32_bf16 v[76:79], a[20:23], a[76:79], v[76:79]
v_mfma_f32_16x16x32_bf16 v[100:103], a[24:27], a[76:79], v[100:103]
v_mfma_f32_16x16x32_bf16 v[124:127], a[28:31], a[76:79], v[124:127]
s_waitcnt lgkmcnt(0)
s_cmp_lg_u32 s94, 0
s_cbranch_scc1 L_nocs1_0
v_mfma_f32_16x16x32_bf16 v[128:131], a[80:83], a[32:35], v[128:131]
v_mfma_f32_16x16x32_bf16 v[132:135], a[80:83], a[36:39], v[132:135]
v_mfma_f32_16x16x32_bf16 v[136:139], a[80:83], a[40:43], v[136:139]
v_mfma_f32_16x16x32_bf16 v[140:143], a[80:83], a[44:47], v[140:143]
v_mfma_f32_16x16x32_bf16 v[144:147], a[80:83], a[48:51], v[144:147]
v_mfma_f32_16x16x32_bf16 v[148:151], a[80:83], a[52:55], v[148:151]
L_nocs1_0:
v_mfma_f32_16x16x32_bf16 v[32:35], a[32:35], a[0:3], v[32:35]
ds_read_b128 a[16:19], v11 offset:40960
v_mfma_f32_16x16x32_bf16 v[56:59], a[32:35], a[4:7], v[56:59]
ds_read_b64_tr_b16 a[56:57], v14 offset:28672
v_mfma_f32_16x16x32_bf16 v[80:83], a[32:35], a[8:11], v[80:83]
ds_read_b64_tr_b16 a[58:59], v14 offset:29184
v_mfma_f32_16x16x32_bf16 v[104:107], a[32:35], a[12:15], v[104:107]
ds_read_b128 a[20:23], v11 offset:43008
v_mfma_f32_16x16x32_bf16 v[36:39], a[36:39], a[0:3], v[36:39]
ds_read_b128 a[24:27], v11 offset:45056
v_mfma_f32_16x16x32_bf16 v[60:63], a[36:39], a[4:7], v[60:63]
ds_read_b128 a[28:31], v11 offset:47104
v_mfma_f32_16x16x32_bf16 v[84:87], a[36:39], a[8:11], v[84:87]
ds_read_b64_tr_b16 a[60:61], v15 offset:28672
v_mfma_f32_16x16x32_bf16 v[108:111], a[36:39], a[12:15], v[108:111]
ds_read_b64_tr_b16 a[62:63], v15 offset:29184
v_mfma_f32_16x16x32_bf16 v[40:43], a[0:3], a[40:43], v[40:43]
ds_read_b64_tr_b16 a[64:65], v14 offset:30720
v_mfma_f32_16x16x32_bf16 v[64:67], a[4:7], a[40:43], v[64:67]
ds_read_b64_tr_b16 a[66:67], v14 offset:31232
v_mfma_f32_16x16x32_bf16 v[88:91], a[8:11], a[40:43], v[88:91]
ds_read_b64_tr_b16 a[68:69], v15 offset:30720
v_mfma_f32_16x16x32_bf16 v[112:115], a[12:15], a[40:43], v[112:115]
ds_read_b64_tr_b16 a[70:71], v15 offset:31232
v_mfma_f32_16x16x32_bf16 v[44:47], a[0:3], a[44:47], v[44:47]
ds_read_b64_tr_b16 a[72:73], v14 offset:32768
v_mfma_f32_16x16x32_bf16 v[68:71], a[4:7], a[44:47], v[68:71]
ds_read_b64_tr_b16 a[74:75], v14 offset:33280
v_mfma_f32_16x16x32_bf16 v[92:95], a[8:11], a[44:47], v[92:95]
ds_read_b64_tr_b16 a[76:77], v15 offset:32768
v_mfma_f32_16x16x32_bf16 v[116:119], a[12:15], a[44:47], v[116:119]
ds_read_b64_tr_b16 a[78:79], v15 offset:33280
v_mfma_f32_16x16x32_bf16 v[48:51], a[0:3], a[48:51], v[48:51]
v_mfma_f32_16x16x32_bf16 v[72:75], a[4:7], a[48:51], v[72:75]
v_mfma_f32_16x16x32_bf16 v[96:99], a[8:11], a[48:51], v[96:99]
v_mfma_f32_16x16x32_bf16 v[120:123], a[12:15], a[48:51], v[120:123]
v_mfma_f32_16x16x32_bf16 v[52:55], a[0:3], a[52:55], v[52:55]
v_mfma_f32_16x16x32_bf16 v[76:79], a[4:7], a[52:55], v[76:79]
v_mfma_f32_16x16x32_bf16 v[100:103], a[8:11], a[52:55], v[100:103]
v_mfma_f32_16x16x32_bf16 v[124:127], a[12:15], a[52:55], v[124:127]
s_waitcnt lgkmcnt(0)
s_cmp_lg_u32 s94, 0
s_cbranch_scc1 L_nocs1_1
v_mfma_f32_16x16x32_bf16 v[128:131], a[80:83], a[56:59], v[128:131]
v_mfma_f32_16x16x32_bf16 v[132:135], a[80:83], a[60:63], v[132:135]
v_mfma_f32_16x16x32_bf16 v[136:139], a[80:83], a[64:67], v[136:139]
v_mfma_f32_16x16x32_bf16 v[140:143], a[80:83], a[68:71], v[140:143]
v_mfma_f32_16x16x32_bf16 v[144:147], a[80:83], a[72:75], v[144:147]
v_mfma_f32_16x16x32_bf16 v[148:151], a[80:83], a[76:79], v[148:151]
L_nocs1_1:
v_mfma_f32_16x16x32_bf16 v[32:35], a[56:59], a[16:19], v[32:35]
s_barrier
ds_read_b128 a[0:3], v10 offset:0
v_mfma_f32_16x16x32_bf16 v[56:59], a[56:59], a[20:23], v[56:59]
ds_read_b64_tr_b16 a[32:33], v12 offset:40960
v_mfma_f32_16x16x32_bf16 v[80:83], a[56:59], a[24:27], v[80:83]
ds_read_b64_tr_b16 a[34:35], v12 offset:41472
v_mfma_f32_16x16x32_bf16 v[104:107], a[56:59], a[28:31], v[104:107]
ds_read_b128 a[4:7], v10 offset:2048
v_mfma_f32_16x16x32_bf16 v[36:39], a[60:63], a[16:19], v[36:39]
ds_read_b128 a[8:11], v10 offset:4096
v_mfma_f32_16x16x32_bf16 v[60:63], a[60:63], a[20:23], v[60:63]
ds_read_b128 a[12:15], v10 offset:6144
v_mfma_f32_16x16x32_bf16 v[84:87], a[60:63], a[24:27], v[84:87]
ds_read_b64_tr_b16 a[36:37], v13 offset:40960
v_mfma_f32_16x16x32_bf16 v[108:111], a[60:63], a[28:31], v[108:111]
ds_read_b64_tr_b16 a[38:39], v13 offset:41472
v_mfma_f32_16x16x32_bf16 v[40:43], a[16:19], a[64:67], v[40:43]
ds_read_b64_tr_b16 a[40:41], v12 offset:43008
v_mfma_f32_16x16x32_bf16 v[64:67], a[20:23], a[64:67], v[64:67]
ds_read_b64_tr_b16 a[42:43], v12 offset:43520
v_mfma_f32_16x16x32_bf16 v[88:91], a[24:27], a[64:67], v[88:91]
ds_read_b64_tr_b16 a[44:45], v13 offset:43008
v_mfma_f32_16x16x32_bf16 v[112:115], a[28:31], a[64:67], v[112:115]
ds_read_b64_tr_b16 a[46:47], v13 offset:43520
v_mfma_f32_16x16x32_bf16 v[44:47], a[16:19], a[68:71], v[44:47]
ds_read_b64_tr_b16 a[48:49], v12 offset:45056
v_mfma_f32_16x16x32_bf16 v[68:71], a[20:23], a[68:71], v[68:71]
ds_read_b64_tr_b16 a[50:51], v12 offset:45568
v_mfma_f32_16x16x32_bf16 v[92:95], a[24:27], a[68:71], v[92:95]
ds_read_b64_tr_b16 a[52:53], v13 offset:45056
v_mfma_f32_16x16x32_bf16 v[116:119], a[28:31], a[68:71], v[116:119]
ds_read_b64_tr_b16 a[54:55], v13 offset:45568
v_mfma_f32_16x16x32_bf16 v[48:51], a[16:19], a[72:75], v[48:51]
v_mfma_f32_16x16x32_bf16 v[72:75], a[20:23], a[72:75], v[72:75]
v_mfma_f32_16x16x32_bf16 v[96:99], a[24:27], a[72:75], v[96:99]
v_mfma_f32_16x16x32_bf16 v[120:123], a[28:31], a[72:75], v[120:123]
v_mfma_f32_16x16x32_bf16 v[52:55], a[16:19], a[76:79], v[52:55]
v_mfma_f32_16x16x32_bf16 v[76:79], a[20:23], a[76:79], v[76:79]
v_mfma_f32_16x16x32_bf16 v[100:103], a[24:27], a[76:79], v[100:103]
v_mfma_f32_16x16x32_bf16 v[124:127], a[28:31], a[76:79], v[124:127]
s_waitcnt lgkmcnt(0)
s_cmp_lg_u32 s94, 0
s_cbranch_scc1 L_nocs2_0
v_mfma_f32_16x16x32_bf16 v[128:131], a[80:83], a[32:35], v[128:131]
v_mfma_f32_16x16x32_bf16 v[132:135], a[80:83], a[36:39], v[132:135]
v_mfma_f32_16x16x32_bf16 v[136:139], a[80:83], a[40:43], v[136:139]
v_mfma_f32_16x16x32_bf16 v[140:143], a[80:83], a[44:47], v[140:143]
v_mfma_f32_16x16x32_bf16 v[144:147], a[80:83], a[48:51], v[144:147]
v_mfma_f32_16x16x32_bf16 v[148:151], a[80:83], a[52:55], v[148:151]
L_nocs2_0:
v_mfma_f32_16x16x32_bf16 v[32:35], a[32:35], a[0:3], v[32:35]
ds_read_b128 a[16:19], v11 offset:0
v_mfma_f32_16x16x32_bf16 v[56:59], a[32:35], a[4:7], v[56:59]
ds_read_b64_tr_b16 a[56:57], v12 offset:53248
v_mfma_f32_16x16x32_bf16 v[80:83], a[32:35], a[8:11], v[80:83]
ds_read_b64_tr_b16 a[58:59], v12 offset:53760
v_mfma_f32_16x16x32_bf16 v[104:107], a[32:35], a[12:15], v[104:107]
ds_read_b128 a[20:23], v11 offset:2048
v_mfma_f32_16x16x32_bf16 v[36:39], a[36:39], a[0:3], v[36:39]
ds_read_b128 a[24:27], v11 offset:4096
v_mfma_f32_16x16x32_bf16 v[60:63], a[36:39], a[4:7], v[60:63]
ds_read_b128 a[28:31], v11 offset:6144
v_mfma_f32_16x16x32_bf16 v[84:87], a[36:39], a[8:11], v[84:87]
ds_read_b64_tr_b16 a[60:61], v13 offset:53248
v_mfma_f32_16x16x32_bf16 v[108:111], a[36:39], a[12:15], v[108:111]
ds_read_b64_tr_b16 a[62:63], v13 offset:53760
v_mfma_f32_16x16x32_bf16 v[40:43], a[0:3], a[40:43], v[40:43]
ds_read_b64_tr_b16 a[64:65], v12 offset:55296
v_mfma_f32_16x16x32_bf16 v[64:67], a[4:7], a[40:43], v[64:67]
ds_read_b64_tr_b16 a[66:67], v12 offset:55808
v_mfma_f32_16x16x32_bf16 v[88:91], a[8:11], a[40:43], v[88:91]
ds_read_b64_tr_b16 a[68:69], v13 offset:55296
v_mfma_f32_16x16x32_bf16 v[112:115], a[12:15], a[40:43], v[112:115]
ds_read_b64_tr_b16 a[70:71], v13 offset:55808
v_mfma_f32_16x16x32_bf16 v[44:47], a[0:3], a[44:47], v[44:47]
ds_read_b64_tr_b16 a[72:73], v12 offset:57344
v_mfma_f32_16x16x32_bf16 v[68:71], a[4:7], a[44:47], v[68:71]
ds_read_b64_tr_b16 a[74:75], v12 offset:57856
v_mfma_f32_16x16x32_bf16 v[92:95], a[8:11], a[44:47], v[92:95]
ds_read_b64_tr_b16 a[76:77], v13 offset:57344
v_mfma_f32_16x16x32_bf16 v[116:119], a[12:15], a[44:47], v[116:119]
ds_read_b64_tr_b16 a[78:79], v13 offset:57856
v_mfma_f32_16x16x32_bf16 v[48:51], a[0:3], a[48:51], v[48:51]
s_lshl_b32 s70, s60, 10
s_add_u32 s70, s70, s87
buffer_store_dwordx4 v[28:31], v16, s[12:15], s70 offen sc1
v_mfma_f32_16x16x32_bf16 v[72:75], a[4:7], a[48:51], v[72:75]
v_mfma_f32_16x16x32_bf16 v[96:99], a[8:11], a[48:51], v[96:99]
v_mfma_f32_16x16x32_bf16 v[120:123], a[12:15], a[48:51], v[120:123]
v_mfma_f32_16x16x32_bf16 v[52:55], a[0:3], a[52:55], v[52:55]
v_mfma_f32_16x16x32_bf16 v[76:79], a[4:7], a[52:55], v[76:79]
v_mfma_f32_16x16x32_bf16 v[100:103], a[8:11], a[52:55], v[100:103]
v_mfma_f32_16x16x32_bf16 v[124:127], a[12:15], a[52:55], v[124:127]
s_waitcnt lgkmcnt(0)
s_cmp_lg_u32 s94, 0
s_cbranch_scc1 L_nocs2_1
v_mfma_f32_16x16x32_bf16 v[128:131], a[80:83], a[56:59], v[128:131]
v_mfma_f32_16x16x32_bf16 v[132:135], a[80:83], a[60:63], v[132:135]
v_mfma_f32_16x16x32_bf16 v[136:139], a[80:83], a[64:67], v[136:139]
v_mfma_f32_16x16x32_bf16 v[140:143], a[80:83], a[68:71], v[140:143]
v_mfma_f32_16x16x32_bf16 v[144:147], a[80:83], a[72:75], v[144:147]
v_mfma_f32_16x16x32_bf16 v[148:151], a[80:83], a[76:79], v[148:151]
L_nocs2_1:
v_mfma_f32_16x16x32_bf16 v[32:35], a[56:59], a[16:19], v[32:35]
s_barrier
ds_read_b128 a[0:3], v8 offset:24576
v_mfma_f32_16x16x32_bf16 v[56:59], a[56:59], a[20:23], v[56:59]
ds_read_b64_tr_b16 a[32:33], v12 offset:0
v_mfma_f32_16x16x32_bf16 v[80:83], a[56:59], a[24:27], v[80:83]
ds_read_b64_tr_b16 a[34:35], v12 offset:512
v_mfma_f32_16x16x32_bf16 v[104:107], a[56:59], a[28:31], v[104:107]
ds_read_b128 a[4:7], v8 offset:26624
v_mfma_f32_16x16x32_bf16 v[36:39], a[60:63], a[16:19], v[36:39]
ds_read_b128 a[8:11], v8 offset:28672
v_mfma_f32_16x16x32_bf16 v[60:63], a[60:63], a[20:23], v[60:63]
ds_read_b128 a[12:15], v8 offset:30720
v_mfma_f32_16x16x32_bf16 v[84:87], a[60:63], a[24:27], v[84:87]
ds_read_b64_tr_b16 a[36:37], v13 offset:0
v_mfma_f32_16x16x32_bf16 v[108:111], a[60:63], a[28:31], v[108:111]
ds_read_b64_tr_b16 a[38:39], v13 offset:512
v_mfma_f32_16x16x32_bf16 v[40:43], a[16:19], a[64:67], v[40:43]
ds_read_b64_tr_b16 a[40:41], v12 offset:2048
v_mfma_f32_16x16x32_bf16 v[64:67], a[20:23], a[64:67], v[64:67]
ds_read_b64_tr_b16 a[42:43], v12 offset:2560
v_mfma_f32_16x16x32_bf16 v[88:91], a[24:27], a[64:67], v[88:91]
ds_read_b64_tr_b16 a[44:45], v13 offset:2048
v_mfma_f32_16x16x32_bf16 v[112:115], a[28:31], a[64:67], v[112:115]
ds_read_b64_tr_b16 a[46:47], v13 offset:2560
v_mfma_f32_16x16x32_bf16 v[44:47], a[16:19], a[68:71], v[44:47]
ds_read_b64_tr_b16 a[48:49], v12 offset:4096
v_mfma_f32_16x16x32_bf16 v[68:71], a[20:23], a[68:71], v[68:71]
ds_read_b64_tr_b16 a[50:51], v12 offset:4608
v_mfma_f32_16x16x32_bf16 v[92:95], a[24:27], a[68:71], v[92:95]
ds_read_b64_tr_b16 a[52:53], v13 offset:4096
v_mfma_f32_16x16x32_bf16 v[116:119], a[28:31], a[68:71], v[116:119]
ds_read_b64_tr_b16 a[54:55], v13 offset:4608
v_mfma_f32_16x16x32_bf16 v[48:51], a[16:19], a[72:75], v[48:51]
v_mfma_f32_16x16x32_bf16 v[72:75], a[20:23], a[72:75], v[72:75]
v_mfma_f32_16x16x32_bf16 v[96:99], a[24:27], a[72:75], v[96:99]
v_mfma_f32_16x16x32_bf16 v[120:123], a[28:31], a[72:75], v[120:123]
v_mfma_f32_16x16x32_bf16 v[52:55], a[16:19], a[76:79], v[52:55]
v_mfma_f32_16x16x32_bf16 v[76:79], a[20:23], a[76:79], v[76:79]
v_mfma_f32_16x16x32_bf16 v[100:103], a[24:27], a[76:79], v[100:103]
v_mfma_f32_16x16x32_bf16 v[124:127], a[28:31], a[76:79], v[124:127]
s_waitcnt lgkmcnt(0)
s_cmp_lg_u32 s94, 0
s_cbranch_scc1 L_nocs3_0
v_mfma_f32_16x16x32_bf16 v[128:131], a[80:83], a[32:35], v[128:131]
v_mfma_f32_16x16x32_bf16 v[132:135], a[80:83], a[36:39], v[132:135]
v_mfma_f32_16x16x32_bf16 v[136:139], a[80:83], a[40:43], v[136:139]
v_mfma_f32_16x16x32_bf16 v[140:143], a[80:83], a[44:47], v[140:143]
v_mfma_f32_16x16x32_bf16 v[144:147], a[80:83], a[48:51], v[144:147]
v_mfma_f32_16x16x32_bf16 v[148:151], a[80:83], a[52:55], v[148:151]
L_nocs3_0:
v_mfma_f32_16x16x32_bf16 v[32:35], a[32:35], a[0:3], v[32:35]
ds_read_b128 a[16:19], v9 offset:24576
v_mfma_f32_16x16x32_bf16 v[56:59], a[32:35], a[4:7], v[56:59]
ds_read_b64_tr_b16 a[56:57], v12 offset:12288
v_mfma_f32_16x16x32_bf16 v[80:83], a[32:35], a[8:11], v[80:83]
ds_read_b64_tr_b16 a[58:59], v12 offset:12800
v_mfma_f32_16x16x32_bf16 v[104:107], a[32:35], a[12:15], v[104:107]
ds_read_b128 a[20:23], v9 offset:26624
v_mfma_f32_16x16x32_bf16 v[36:39], a[36:39], a[0:3], v[36:39]
ds_read_b128 a[24:27], v9 offset:28672
v_mfma_f32_16x16x32_bf16 v[60:63], a[36:39], a[4:7], v[60:63]
ds_read_b128 a[28:31], v9 offset:30720
v_mfma_f32_16x16x32_bf16 v[84:87], a[36:39], a[8:11], v[84:87]
ds_read_b64_tr_b16 a[60:61], v13 offset:12288
v_mfma_f32_16x16x32_bf16 v[108:111], a[36:39], a[12:15], v[108:111]
ds_read_b64_tr_b16 a[62:63], v13 offset:12800
v_mfma_f32_16x16x32_bf16 v[40:43], a[0:3], a[40:43], v[40:43]
ds_read_b64_tr_b16 a[64:65], v12 offset:14336
v_mfma_f32_16x16x32_bf16 v[64:67], a[4:7], a[40:43], v[64:67]
ds_read_b64_tr_b16 a[66:67], v12 offset:14848
v_mfma_f32_16x16x32_bf16 v[88:91], a[8:11], a[40:43], v[88:91]
ds_read_b64_tr_b16 a[68:69], v13 offset:14336
v_mfma_f32_16x16x32_bf16 v[112:115], a[12:15], a[40:43], v[112:115]
ds_read_b64_tr_b16 a[70:71], v13 offset:14848
v_mfma_f32_16x16x32_bf16 v[44:47], a[0:3], a[44:47], v[44:47]
ds_read_b64_tr_b16 a[72:73], v12 offset:16384
v_mfma_f32_16x16x32_bf16 v[68:71], a[4:7], a[44:47], v[68:71]
ds_read_b64_tr_b16 a[74:75], v12 offset:16896
v_mfma_f32_16x16x32_bf16 v[92:95], a[8:11], a[44:47], v[92:95]
ds_read_b64_tr_b16 a[76:77], v13 offset:16384
v_mfma_f32_16x16x32_bf16 v[116:119], a[12:15], a[44:47], v[116:119]
ds_read_b64_tr_b16 a[78:79], v13 offset:16896
v_mfma_f32_16x16x32_bf16 v[48:51], a[0:3], a[48:51], v[48:51]
v_mfma_f32_16x16x32_bf16 v[72:75], a[4:7], a[48:51], v[72:75]
v_mfma_f32_16x16x32_bf16 v[96:99], a[8:11], a[48:51], v[96:99]
v_mfma_f32_16x16x32_bf16 v[120:123], a[12:15], a[48:51], v[120:123]
v_mfma_f32_16x16x32_bf16 v[52:55], a[0:3], a[52:55], v[52:55]
v_mfma_f32_16x16x32_bf16 v[76:79], a[4:7], a[52:55], v[76:79]
v_mfma_f32_16x16x32_bf16 v[100:103], a[8:11], a[52:55], v[100:103]
v_mfma_f32_16x16x32_bf16 v[124:127], a[12:15], a[52:55], v[124:127]
s_waitcnt lgkmcnt(0)
s_cmp_lg_u32 s94, 0
s_cbranch_scc1 L_nocs3_1
v_mfma_f32_16x16x32_bf16 v[128:131], a[80:83], a[56:59], v[128:131]
v_mfma_f32_16x16x32_bf16 v[132:135], a[80:83], a[60:63], v[132:135]
v_mfma_f32_16x16x32_bf16 v[136:139], a[80:83], a[64:67], v[136:139]
v_mfma_f32_16x16x32_bf16 v[140:143], a[80:83], a[68:71], v[140:143]
v_mfma_f32_16x16x32_bf16 v[144:147], a[80:83], a[72:75], v[144:147]
v_mfma_f32_16x16x32_bf16 v[148:151], a[80:83], a[76:79], v[148:151]
L_nocs3_1:
v_mfma_f32_16x16x32_bf16 v[32:35], a[56:59], a[16:19], v[32:35]
s_barrier
ds_read_b128 a[0:3], v10 offset:57344
v_mfma_f32_16x16x32_bf16 v[56:59], a[56:59], a[20:23], v[56:59]
ds_read_b64_tr_b16 a[32:33], v14 offset:16384
v_mfma_f32_16x16x32_bf16 v[80:83], a[56:59], a[24:27], v[80:83]
ds_read_b64_tr_b16 a[34:35], v14 offset:16896
v_mfma_f32_16x16x32_bf16 v[104:107], a[56:59], a[28:31], v[104:107]
ds_read_b128 a[4:7], v10 offset:59392
v_mfma_f32_16x16x32_bf16 v[36:39], a[60:63], a[16:19], v[36:39]
ds_read_b128 a[8:11], v10 offset:61440
v_mfma_f32_16x16x32_bf16 v[60:63], a[60:63], a[20:23], v[60:63]
ds_read_b128 a[12:15], v10 offset:63488
v_mfma_f32_16x16x32_bf16 v[84:87], a[60:63], a[24:27], v[84:87]
ds_read_b64_tr_b16 a[36:37], v15 offset:16384
v_mfma_f32_16x16x32_bf16 v[108:111], a[60:63], a[28:31], v[108:111]
ds_read_b64_tr_b16 a[38:39], v15 offset:16896
v_mfma_f32_16x16x32_bf16 v[40:43], a[16:19], a[64:67], v[40:43]
ds_read_b64_tr_b16 a[40:41], v14 offset:18432
v_mfma_f32_16x16x32_bf16 v[64:67], a[20:23], a[64:67], v[64:67]
ds_read_b64_tr_b16 a[42:43], v14 offset:18944
v_mfma_f32_16x16x32_bf16 v[88:91], a[24:27], a[64:67], v[88:91]
ds_read_b64_tr_b16 a[44:45], v15 offset:18432
v_mfma_f32_16x16x32_bf16 v[112:115], a[28:31], a[64:67], v[112:115]
ds_read_b64_tr_b16 a[46:47], v15 offset:18944
v_mfma_f32_16x16x32_bf16 v[44:47], a[16:19], a[68:71], v[44:47]
ds_read_b64_tr_b16 a[48:49], v14 offset:20480
v_mfma_f32_16x16x32_bf16 v[68:71], a[20:23], a[68:71], v[68:71]
ds_read_b64_tr_b16 a[50:51], v14 offset:20992
v_mfma_f32_16x16x32_bf16 v[92:95], a[24:27], a[68:71], v[92:95]
ds_read_b64_tr_b16 a[52:53], v15 offset:20480
v_mfma_f32_16x16x32_bf16 v[116:119], a[28:31], a[68:71], v[116:119]
ds_read_b64_tr_b16 a[54:55], v15 offset:20992
v_mfma_f32_16x16x32_bf16 v[48:51], a[16:19], a[72:75], v[48:51]
v_mfma_f32_16x16x32_bf16 v[72:75], a[20:23], a[72:75], v[72:75]
v_mfma_f32_16x16x32_bf16 v[96:99], a[24:27], a[72:75], v[96:99]
v_mfma_f32_16x16x32_bf16 v[120:123], a[28:31], a[72:75], v[120:123]
v_mfma_f32_16x16x32_bf16 v[52:55], a[16:19], a[76:79], v[52:55]
v_mfma_f32_16x16x32_bf16 v[76:79], a[20:23], a[76:79], v[76:79]
v_mfma_f32_16x16x32_bf16 v[100:103], a[24:27], a[76:79], v[100:103]
v_mfma_f32_16x16x32_bf16 v[124:127], a[28:31], a[76:79], v[124:127]
s_waitcnt lgkmcnt(0)
v_mfma_f32_16x16x32_bf16 v[32:35], a[32:35], a[0:3], v[32:35]
ds_read_b128 a[16:19], v11 offset:57344
v_mfma_f32_16x16x32_bf16 v[56:59], a[32:35], a[4:7], v[56:59]
ds_read_b64_tr_b16 a[56:57], v14 offset:28672
v_mfma_f32_16x16x32_bf16 v[80:83], a[32:35], a[8:11], v[80:83]
ds_read_b64_tr_b16 a[58:59], v14 offset:29184
v_mfma_f32_16x16x32_bf16 v[104:107], a[32:35], a[12:15], v[104:107]
ds_read_b128 a[20:23], v11 offset:59392
v_mfma_f32_16x16x32_bf16 v[36:39], a[36:39], a[0:3], v[36:39]
ds_read_b128 a[24:27], v11 offset:61440
v_mfma_f32_16x16x32_bf16 v[60:63], a[36:39], a[4:7], v[60:63]
ds_read_b128 a[28:31], v11 offset:63488
v_mfma_f32_16x16x32_bf16 v[84:87], a[36:39], a[8:11], v[84:87]
ds_read_b64_tr_b16 a[60:61], v15 offset:28672
v_mfma_f32_16x16x32_bf16 v[108:111], a[36:39], a[12:15], v[108:111]
ds_read_b64_tr_b16 a[62:63], v15 offset:29184
v_mfma_f32_16x16x32_bf16 v[40:43], a[0:3], a[40:43], v[40:43]
ds_read_b64_tr_b16 a[64:65], v14 offset:30720
v_mfma_f32_16x16x32_bf16 v[64:67], a[4:7], a[40:43], v[64:67]
ds_read_b64_tr_b16 a[66:67], v14 offset:31232
v_mfma_f32_16x16x32_bf16 v[88:91], a[8:11], a[40:43], v[88:91]
ds_read_b64_tr_b16 a[68:69], v15 offset:30720
v_mfma_f32_16x16x32_bf16 v[112:115], a[12:15], a[40:43], v[112:115]
ds_read_b64_tr_b16 a[70:71], v15 offset:31232
v_mfma_f32_16x16x32_bf16 v[44:47], a[0:3], a[44:47], v[44:47]
ds_read_b64_tr_b16 a[72:73], v14 offset:32768
v_mfma_f32_16x16x32_bf16 v[68:71], a[4:7], a[44:47], v[68:71]
ds_read_b64_tr_b16 a[74:75], v14 offset:33280
v_mfma_f32_16x16x32_bf16 v[92:95], a[8:11], a[44:47], v[92:95]
ds_read_b64_tr_b16 a[76:77], v15 offset:32768
v_mfma_f32_16x16x32_bf16 v[116:119], a[12:15], a[44:47], v[116:119]
ds_read_b64_tr_b16 a[78:79], v15 offset:33280
v_mfma_f32_16x16x32_bf16 v[48:51], a[0:3], a[48:51], v[48:51]
s_add_u32 s70, s88, 0
buffer_store_dwordx4 v[28:31], v16, s[12:15], s70 offen sc1
v_mfma_f32_16x16x32_bf16 v[72:75], a[4:7], a[48:51], v[72:75]
v_mfma_f32_16x16x32_bf16 v[96:99], a[8:11], a[48:51], v[96:99]
s_add_u32 s70, s88, 65536
buffer_store_dwordx4 v[28:31], v16, s[12:15], s70 offen sc1
v_mfma_f32_16x16x32_bf16 v[120:123], a[12:15], a[48:51], v[120:123]
v_mfma_f32_16x16x32_bf16 v[52:55], a[0:3], a[52:55], v[52:55]
v_mfma_f32_16x16x32_bf16 v[76:79], a[4:7], a[52:55], v[76:79]
v_mfma_f32_16x16x32_bf16 v[100:103], a[8:11], a[52:55], v[100:103]
v_mfma_f32_16x16x32_bf16 v[124:127], a[12:15], a[52:55], v[124:127]
s_waitcnt lgkmcnt(0)
v_mfma_f32_16x16x32_bf16 v[32:35], a[56:59], a[16:19], v[32:35]
s_branch L_over3
L_pad3:
s_branch L_ret4
L_over3:
s_barrier
ds_read_b128 a[0:3], v10 offset:40960
v_mfma_f32_16x16x32_bf16 v[56:59], a[56:59], a[20:23], v[56:59]
ds_read_b64_tr_b16 a[32:33], v12 offset:40960
v_mfma_f32_16x16x32_bf16 v[80:83], a[56:59], a[24:27], v[80:83]
ds_read_b64_tr_b16 a[34:35], v12 offset:41472
v_mfma_f32_16x16x32_bf16 v[104:107], a[56:59], a[28:31], v[104:107]
ds_read_b128 a[4:7], v10 offset:43008
v_mfma_f32_16x16x32_bf16 v[36:39], a[60:63], a[16:19], v[36:39]
ds_read_b128 a[8:11], v10 offset:45056
v_mfma_f32_16x16x32_bf16 v[60:63], a[60:63], a[20:23], v[60:63]
ds_read_b128 a[12:15], v10 offset:47104
v_mfma_f32_16x16x32_bf16 v[84:87], a[60:63], a[24:27], v[84:87]
ds_read_b64_tr_b16 a[36:37], v13 offset:40960
v_mfma_f32_16x16x32_bf16 v[108:111], a[60:63], a[28:31], v[108:111]
ds_read_b64_tr_b16 a[38:39], v13 offset:41472
v_mfma_f32_16x16x32_bf16 v[40:43], a[16:19], a[64:67], v[40:43]
ds_read_b64_tr_b16 a[40:41], v12 offset:43008
v_mfma_f32_16x16x32_bf16 v[64:67], a[20:23], a[64:67], v[64:67]
ds_read_b64_tr_b16 a[42:43], v12 offset:43520
v_mfma_f32_16x16x32_bf16 v[88:91], a[24:27], a[64:67], v[88:91]
ds_read_b64_tr_b16 a[44:45], v13 offset:43008
v_mfma_f32_16x16x32_bf16 v[112:115], a[28:31], a[64:67], v[112:115]
ds_read_b64_tr_b16 a[46:47], v13 offset:43520
v_mfma_f32_16x16x32_bf16 v[44:47], a[16:19], a[68:71], v[44:47]
ds_read_b64_tr_b16 a[48:49], v12 offset:45056
v_mfma_f32_16x16x32_bf16 v[68:71], a[20:23], a[68:71], v[68:71]
ds_read_b64_tr_b16 a[50:51], v12 offset:45568
v_mfma_f32_16x16x32_bf16 v[92:95], a[24:27], a[68:71], v[92:95]
ds_read_b64_tr_b16 a[52:53], v13 offset:45056
v_mfma_f32_16x16x32_bf16 v[116:119], a[28:31], a[68:71], v[116:119]
ds_read_b64_tr_b16 a[54:55], v13 offset:45568
v_mfma_f32_16x16x32_bf16 v[48:51], a[16:19], a[72:75], v[48:51]
v_mfma_f32_16x16x32_bf16 v[72:75], a[20:23], a[72:75], v[72:75]
v_mfma_f32_16x16x32_bf16 v[96:99], a[24:27], a[72:75], v[96:99]
v_mfma_f32_16x16x32_bf16 v[120:123], a[28:31], a[72:75], v[120:123]
v_mfma_f32_16x16x32_bf16 v[52:55], a[16:19], a[76:79], v[52:55]
v_mfma_f32_16x16x32_bf16 v[76:79], a[20:23], a[76:79], v[76:79]
v_mfma_f32_16x16x32_bf16 v[100:103], a[24:27], a[76:79], v[100:103]
v_mfma_f32_16x16x32_bf16 v[124:127], a[28:31], a[76:79], v[124:127]
s_waitcnt lgkmcnt(0)
v_mfma_f32_16x16x32_bf16 v[32:35], a[32:35], a[0:3], v[32:35]
ds_read_b128 a[16:19], v11 offset:40960
v_mfma_f32_16x16x32_bf16 v[56:59], a[32:35], a[4:7], v[56:59]
ds_read_b64_tr_b16 a[56:57], v12 offset:53248
v_mfma_f32_16x16x32_bf16 v[80:83], a[32:35], a[8:11], v[80:83]
ds_read_b64_tr_b16 a[58:59], v12 offset:53760
v_mfma_f32_16x16x32_bf16 v[104:107], a[32:35], a[12:15], v[104:107]
ds_read_b128 a[20:23], v11 offset:43008
v_mfma_f32_16x16x32_bf16 v[36:39], a[36:39], a[0:3], v[36:39]
ds_read_b128 a[24:27], v11 offset:45056
v_mfma_f32_16x16x32_bf16 v[60:63], a[36:39], a[4:7], v[60:63]
ds_read_b128 a[28:31], v11 offset:47104
v_mfma_f32_16x16x32_bf16 v[84:87], a[36:39], a[8:11], v[84:87]
ds_read_b64_tr_b16 a[60:61], v13 offset:53248
v_mfma_f32_16x16x32_bf16 v[108:111], a[36:39], a[12:15], v[108:111]
ds_read_b64_tr_b16 a[62:63], v13 offset:53760
v_mfma_f32_16x16x32_bf16 v[40:43], a[0:3], a[40:43], v[40:43]
ds_read_b64_tr_b16 a[64:65], v12 offset:55296
v_mfma_f32_16x16x32_bf16 v[64:67], a[4:7], a[40:43], v[64:67]
ds_read_b64_tr_b16 a[66:67], v12 offset:55808
v_mfma_f32_16x16x32_bf16 v[88:91], a[8:11], a[40:43], v[88:91]
ds_read_b64_tr_b16 a[68:69], v13 offset:55296
v_mfma_f32_16x16x32_bf16 v[112:115], a[12:15], a[40:43], v[112:115]
ds_read_b64_tr_b16 a[70:71], v13 offset:55808
v_mfma_f32_16x16x32_bf16 v[44:47], a[0:3], a[44:47], v[44:47]
ds_read_b64_tr_b16 a[72:73], v12 offset:57344
v_mfma_f32_16x16x32_bf16 v[68:71], a[4:7], a[44:47], v[68:71]
ds_read_b64_tr_b16 a[74:75], v12 offset:57856
v_mfma_f32_16x16x32_bf16 v[92:95], a[8:11], a[44:47], v[92:95]
ds_read_b64_tr_b16 a[76:77], v13 offset:57344
v_mfma_f32_16x16x32_bf16 v[116:119], a[12:15], a[44:47], v[116:119]
ds_read_b64_tr_b16 a[78:79], v13 offset:57856
v_mfma_f32_16x16x32_bf16 v[48:51], a[0:3], a[48:51], v[48:51]
s_cmp_lg_u32 s94, 0
s_cbranch_scc1 L_nocsp
v_and_b32 v2, 16, v1
v_cmp_ne_u32 vcc, 0, v2
s_nop 1
v_cndmask_b32 v24, v128, v132, vcc
v_cndmask_b32 v25, v136, v140, vcc
v_cndmask_b32 v26, v144, v148, vcc
v_mov_b32 v27, s68
s_lshl_b32 s70, s64, 4
s_lshr_b32 s71, s65, 2
s_add_u32 s70, s70, s71
s_lshl_b32 s70, s70, 10
s_lshl_b32 s71, s67, 9
s_add_u32 s70, s70, s71
s_add_u32 s70, s70, 65536
s_mov_b64 exec, 0xffffffff
buffer_store_dwordx4 v[24:27], v16, s[12:15], s70 offen sc1
s_mov_b64 exec, -1
L_nocsp:
v_mfma_f32_16x16x32_bf16 v[72:75], a[4:7], a[48:51], v[72:75]
v_mfma_f32_16x16x32_bf16 v[96:99], a[8:11], a[48:51], v[96:99]
s_add_u32 s70, s88, 131072
buffer_store_dwordx4 v[28:31], v16, s[12:15], s70 offen sc1
v_mfma_f32_16x16x32_bf16 v[120:123], a[12:15], a[48:51], v[120:123]
v_mfma_f32_16x16x32_bf16 v[52:55], a[0:3], a[52:55], v[52:55]
s_add_u32 s70, s88, 196608
buffer_store_dwordx4 v[28:31], v16, s[12:15], s70 offen sc1
v_mfma_f32_16x16x32_bf16 v[76:79], a[4:7], a[52:55], v[76:79]
v_mfma_f32_16x16x32_bf16 v[100:103], a[8:11], a[52:55], v[100:103]
v_mfma_f32_16x16x32_bf16 v[124:127], a[12:15], a[52:55], v[124:127]
s_waitcnt lgkmcnt(0)
v_mfma_f32_16x16x32_bf16 v[32:35], a[56:59], a[16:19], v[32:35]
s_barrier
ds_read_b128 a[0:3], v10 offset:0
v_mfma_f32_16x16x32_bf16 v[56:59], a[56:59], a[20:23], v[56:59]
ds_read_b64_tr_b16 a[32:33], v12 offset:0
v_mfma_f32_16x16x32_bf16 v[80:83], a[56:59], a[24:27], v[80:83]
ds_read_b64_tr_b16 a[34:35], v12 offset:512
v_mfma_f32_16x16x32_bf16 v[104:107], a[56:59], a[28:31], v[104:107]
ds_read_b128 a[4:7], v10 offset:2048
v_mfma_f32_16x16x32_bf16 v[36:39], a[60:63], a[16:19], v[36:39]
ds_read_b128 a[8:11], v10 offset:4096
v_mfma_f32_16x16x32_bf16 v[60:63], a[60:63], a[20:23], v[60:63]
ds_read_b128 a[12:15], v10 offset:6144
v_mfma_f32_16x16x32_bf16 v[84:87], a[60:63], a[24:27], v[84:87]
ds_read_b64_tr_b16 a[36:37], v13 offset:0
v_mfma_f32_16x16x32_bf16 v[108:111], a[60:63], a[28:31], v[108:111]
ds_read_b64_tr_b16 a[38:39], v13 offset:512
v_mfma_f32_16x16x32_bf16 v[40:43], a[16:19], a[64:67], v[40:43]
ds_read_b64_tr_b16 a[40:41], v12 offset:2048
v_mfma_f32_16x16x32_bf16 v[64:67], a[20:23], a[64:67], v[64:67]
ds_read_b64_tr_b16 a[42:43], v12 offset:2560
v_mfma_f32_16x16x32_bf16 v[88:91], a[24:27], a[64:67], v[88:91]
ds_read_b64_tr_b16 a[44:45], v13 offset:2048
v_mfma_f32_16x16x32_bf16 v[112:115], a[28:31], a[64:67], v[112:115]
ds_read_b64_tr_b16 a[46:47], v13 offset:2560
v_mfma_f32_16x16x32_bf16 v[44:47], a[16:19], a[68:71], v[44:47]
ds_read_b64_tr_b16 a[48:49], v12 offset:4096
v_mfma_f32_16x16x32_bf16 v[68:71], a[20:23], a[68:71], v[68:71]
ds_read_b64_tr_b16 a[50:51], v12 offset:4608
v_mfma_f32_16x16x32_bf16 v[92:95], a[24:27], a[68:71], v[92:95]
ds_read_b64_tr_b16 a[52:53], v13 offset:4096
v_mfma_f32_16x16x32_bf16 v[116:119], a[28:31], a[68:71], v[116:119]
ds_read_b64_tr_b16 a[54:55], v13 offset:4608
v_mfma_f32_16x16x32_bf16 v[48:51], a[16:19], a[72:75], v[48:51]
v_mfma_f32_16x16x32_bf16 v[72:75], a[20:23], a[72:75], v[72:75]
v_mfma_f32_16x16x32_bf16 v[96:99], a[24:27], a[72:75], v[96:99]
v_mfma_f32_16x16x32_bf16 v[120:123], a[28:31], a[72:75], v[120:123]
v_mfma_f32_16x16x32_bf16 v[52:55], a[16:19], a[76:79], v[52:55]
v_mfma_f32_16x16x32_bf16 v[76:79], a[20:23], a[76:79], v[76:79]
v_mfma_f32_16x16x32_bf16 v[100:103], a[24:27], a[76:79], v[100:103]
v_mfma_f32_16x16x32_bf16 v[124:127], a[28:31], a[76:79], v[124:127]
s_waitcnt lgkmcnt(0)
v_mfma_f32_16x16x32_bf16 v[32:35], a[32:35], a[0:3], v[32:35]
ds_read_b128 a[16:19], v11 offset:0
v_mfma_f32_16x16x32_bf16 v[56:59], a[32:35], a[4:7], v[56:59]
ds_read_b64_tr_b16 a[56:57], v12 offset:12288
v_mfma_f32_16x16x32_bf16 v[80:83], a[32:35], a[8:11], v[80:83]
ds_read_b64_tr_b16 a[58:59], v12 offset:12800
v_mfma_f32_16x16x32_bf16 v[104:107], a[32:35], a[12:15], v[104:107]
ds_read_b128 a[20:23], v11 offset:2048
v_mfma_f32_16x16x32_bf16 v[36:39], a[36:39], a[0:3], v[36:39]
ds_read_b128 a[24:27], v11 offset:4096
v_mfma_f32_16x16x32_bf16 v[60:63], a[36:39], a[4:7], v[60:63]
ds_read_b128 a[28:31], v11 offset:6144
v_mfma_f32_16x16x32_bf16 v[84:87], a[36:39], a[8:11], v[84:87]
ds_read_b64_tr_b16 a[60:61], v13 offset:12288
v_mfma_f32_16x16x32_bf16 v[108:111], a[36:39], a[12:15], v[108:111]
ds_read_b64_tr_b16 a[62:63], v13 offset:12800
v_mfma_f32_16x16x32_bf16 v[40:43], a[0:3], a[40:43], v[40:43]
ds_read_b64_tr_b16 a[64:65], v12 offset:14336
v_mfma_f32_16x16x32_bf16 v[64:67], a[4:7], a[40:43], v[64:67]
ds_read_b64_tr_b16 a[66:67], v12 offset:14848
v_mfma_f32_16x16x32_bf16 v[88:91], a[8:11], a[40:43], v[88:91]
ds_read_b64_tr_b16 a[68:69], v13 offset:14336
v_mfma_f32_16x16x32_bf16 v[112:115], a[12:15], a[40:43], v[112:115]
ds_read_b64_tr_b16 a[70:71], v13 offset:14848
v_mfma_f32_16x16x32_bf16 v[44:47], a[0:3], a[44:47], v[44:47]
ds_read_b64_tr_b16 a[72:73], v12 offset:16384
v_mfma_f32_16x16x32_bf16 v[68:71], a[4:7], a[44:47], v[68:71]
ds_read_b64_tr_b16 a[74:75], v12 offset:16896
v_mfma_f32_16x16x32_bf16 v[92:95], a[8:11], a[44:47], v[92:95]
ds_read_b64_tr_b16 a[76:77], v13 offset:16384
v_mfma_f32_16x16x32_bf16 v[116:119], a[12:15], a[44:47], v[116:119]
ds_read_b64_tr_b16 a[78:79], v13 offset:16896
v_mfma_f32_16x16x32_bf16 v[48:51], a[0:3], a[48:51], v[48:51]
v_mfma_f32_16x16x32_bf16 v[72:75], a[4:7], a[48:51], v[72:75]
v_mfma_f32_16x16x32_bf16 v[96:99], a[8:11], a[48:51], v[96:99]
v_mfma_f32_16x16x32_bf16 v[120:123], a[12:15], a[48:51], v[120:123]
v_mfma_f32_16x16x32_bf16 v[52:55], a[0:3], a[52:55], v[52:55]
v_mfma_f32_16x16x32_bf16 v[76:79], a[4:7], a[52:55], v[76:79]
v_mfma_f32_16x16x32_bf16 v[100:103], a[8:11], a[52:55], v[100:103]
v_mfma_f32_16x16x32_bf16 v[124:127], a[12:15], a[52:55], v[124:127]
s_waitcnt lgkmcnt(0)
v_mfma_f32_16x16x32_bf16 v[32:35], a[56:59], a[16:19], v[32:35]
s_barrier
ds_read_b128 a[0:3], v8 offset:24576
v_mfma_f32_16x16x32_bf16 v[56:59], a[56:59], a[20:23], v[56:59]
ds_read_b64_tr_b16 a[32:33], v14 offset:16384
v_mfma_f32_16x16x32_bf16 v[80:83], a[56:59], a[24:27], v[80:83]
ds_read_b64_tr_b16 a[34:35], v14 offset:16896
v_mfma_f32_16x16x32_bf16 v[104:107], a[56:59], a[28:31], v[104:107]
ds_read_b128 a[4:7], v8 offset:26624
v_mfma_f32_16x16x32_bf16 v[36:39], a[60:63], a[16:19], v[36:39]
ds_read_b128 a[8:11], v8 offset:28672
v_mfma_f32_16x16x32_bf16 v[60:63], a[60:63], a[20:23], v[60:63]
ds_read_b128 a[12:15], v8 offset:30720
v_mfma_f32_16x16x32_bf16 v[84:87], a[60:63], a[24:27], v[84:87]
ds_read_b64_tr_b16 a[36:37], v15 offset:16384
v_mfma_f32_16x16x32_bf16 v[108:111], a[60:63], a[28:31], v[108:111]
ds_read_b64_tr_b16 a[38:39], v15 offset:16896
v_mfma_f32_16x16x32_bf16 v[40:43], a[16:19], a[64:67], v[40:43]
ds_read_b64_tr_b16 a[40:41], v14 offset:18432
v_mfma_f32_16x16x32_bf16 v[64:67], a[20:23], a[64:67], v[64:67]
ds_read_b64_tr_b16 a[42:43], v14 offset:18944
v_mfma_f32_16x16x32_bf16 v[88:91], a[24:27], a[64:67], v[88:91]
ds_read_b64_tr_b16 a[44:45], v15 offset:18432
v_mfma_f32_16x16x32_bf16 v[112:115], a[28:31], a[64:67], v[112:115]
ds_read_b64_tr_b16 a[46:47], v15 offset:18944
v_mfma_f32_16x16x32_bf16 v[44:47], a[16:19], a[68:71], v[44:47]
ds_read_b64_tr_b16 a[48:49], v14 offset:20480
v_mfma_f32_16x16x32_bf16 v[68:71], a[20:23], a[68:71], v[68:71]
ds_read_b64_tr_b16 a[50:51], v14 offset:20992
v_mfma_f32_16x16x32_bf16 v[92:95], a[24:27], a[68:71], v[92:95]
ds_read_b64_tr_b16 a[52:53], v15 offset:20480
v_mfma_f32_16x16x32_bf16 v[116:119], a[28:31], a[68:71], v[116:119]
ds_read_b64_tr_b16 a[54:55], v15 offset:20992
v_mfma_f32_16x16x32_bf16 v[48:51], a[16:19], a[72:75], v[48:51]
v_mfma_f32_16x16x32_bf16 v[72:75], a[20:23], a[72:75], v[72:75]
v_mfma_f32_16x16x32_bf16 v[96:99], a[24:27], a[72:75], v[96:99]
v_mfma_f32_16x16x32_bf16 v[120:123], a[28:31], a[72:75], v[120:123]
v_mfma_f32_16x16x32_bf16 v[52:55], a[16:19], a[76:79], v[52:55]
v_mfma_f32_16x16x32_bf16 v[76:79], a[20:23], a[76:79], v[76:79]
v_mfma_f32_16x16x32_bf16 v[100:103], a[24:27], a[76:79], v[100:103]
v_mfma_f32_16x16x32_bf16 v[124:127], a[28:31], a[76:79], v[124:127]
s_waitcnt lgkmcnt(0)
v_mfma_f32_16x16x32_bf16 v[32:35], a[32:35], a[0:3], v[32:35]
ds_read_b128 a[16:19], v9 offset:24576
v_mfma_f32_16x16x32_bf16 v[56:59], a[32:35], a[4:7], v[56:59]
ds_read_b64_tr_b16 a[56:57], v14 offset:28672
v_mfma_f32_16x16x32_bf16 v[80:83], a[32:35], a[8:11], v[80:83]
ds_read_b64_tr_b16 a[58:59], v14 offset:29184
v_mfma_f32_16x16x32_bf16 v[104:107], a[32:35], a[12:15], v[104:107]
ds_read_b128 a[20:23], v9 offset:26624
v_mfma_f32_16x16x32_bf16 v[36:39], a[36:39], a[0:3], v[36:39]
ds_read_b128 a[24:27], v9 offset:28672
v_mfma_f32_16x16x32_bf16 v[60:63], a[36:39], a[4:7], v[60:63]
ds_read_b128 a[28:31], v9 offset:30720
v_mfma_f32_16x16x32_bf16 v[84:87], a[36:39], a[8:11], v[84:87]
ds_read_b64_tr_b16 a[60:61], v15 offset:28672
v_mfma_f32_16x16x32_bf16 v[108:111], a[36:39], a[12:15], v[108:111]
ds_read_b64_tr_b16 a[62:63], v15 offset:29184
v_mfma_f32_16x16x32_bf16 v[40:43], a[0:3], a[40:43], v[40:43]
ds_read_b64_tr_b16 a[64:65], v14 offset:30720
v_mfma_f32_16x16x32_bf16 v[64:67], a[4:7], a[40:43], v[64:67]
ds_read_b64_tr_b16 a[66:67], v14 offset:31232
v_mfma_f32_16x16x32_bf16 v[88:91], a[8:11], a[40:43], v[88:91]
ds_read_b64_tr_b16 a[68:69], v15 offset:30720
v_mfma_f32_16x16x32_bf16 v[112:115], a[12:15], a[40:43], v[112:115]
ds_read_b64_tr_b16 a[70:71], v15 offset:31232
v_mfma_f32_16x16x32_bf16 v[44:47], a[0:3], a[44:47], v[44:47]
ds_read_b64_tr_b16 a[72:73], v14 offset:32768
v_mfma_f32_16x16x32_bf16 v[68:71], a[4:7], a[44:47], v[68:71]
ds_read_b64_tr_b16 a[74:75], v14 offset:33280
v_mfma_f32_16x16x32_bf16 v[92:95], a[8:11], a[44:47], v[92:95]
ds_read_b64_tr_b16 a[76:77], v15 offset:32768
v_mfma_f32_16x16x32_bf16 v[116:119], a[12:15], a[44:47], v[116:119]
ds_read_b64_tr_b16 a[78:79], v15 offset:33280
v_mfma_f32_16x16x32_bf16 v[48:51], a[0:3], a[48:51], v[48:51]
s_waitcnt vmcnt(0)
v_mfma_f32_16x16x32_bf16 v[72:75], a[4:7], a[48:51], v[72:75]
v_mfma_f32_16x16x32_bf16 v[96:99], a[8:11], a[48:51], v[96:99]
v_mfma_f32_16x16x32_bf16 v[120:123], a[12:15], a[48:51], v[120:123]
v_mfma_f32_16x16x32_bf16 v[52:55], a[0:3], a[52:55], v[52:55]
v_mfma_f32_16x16x32_bf16 v[76:79], a[4:7], a[52:55], v[76:79]
v_mfma_f32_16x16x32_bf16 v[100:103], a[8:11], a[52:55], v[100:103]
v_mfma_f32_16x16x32_bf16 v[124:127], a[12:15], a[52:55], v[124:127]
s_waitcnt lgkmcnt(0)
v_mfma_f32_16x16x32_bf16 v[32:35], a[56:59], a[16:19], v[32:35]
s_barrier
ds_read_b128 a[0:3], v10 offset:57344
v_mfma_f32_16x16x32_bf16 v[56:59], a[56:59], a[20:23], v[56:59]
ds_read_b64_tr_b16 a[32:33], v12 offset:40960
v_mfma_f32_16x16x32_bf16 v[80:83], a[56:59], a[24:27], v[80:83]
ds_read_b64_tr_b16 a[34:35], v12 offset:41472
v_mfma_f32_16x16x32_bf16 v[104:107], a[56:59], a[28:31], v[104:107]
ds_read_b128 a[4:7], v10 offset:59392
v_mfma_f32_16x16x32_bf16 v[36:39], a[60:63], a[16:19], v[36:39]
ds_read_b128 a[8:11], v10 offset:61440
v_mfma_f32_16x16x32_bf16 v[60:63], a[60:63], a[20:23], v[60:63]
ds_read_b128 a[12:15], v10 offset:63488
v_mfma_f32_16x16x32_bf16 v[84:87], a[60:63], a[24:27], v[84:87]
ds_read_b64_tr_b16 a[36:37], v13 offset:40960
v_mfma_f32_16x16x32_bf16 v[108:111], a[60:63], a[28:31], v[108:111]
ds_read_b64_tr_b16 a[38:39], v13 offset:41472
v_mfma_f32_16x16x32_bf16 v[40:43], a[16:19], a[64:67], v[40:43]
ds_read_b64_tr_b16 a[40:41], v12 offset:43008
v_mfma_f32_16x16x32_bf16 v[64:67], a[20:23], a[64:67], v[64:67]
ds_read_b64_tr_b16 a[42:43], v12 offset:43520
v_mfma_f32_16x16x32_bf16 v[88:91], a[24:27], a[64:67], v[88:91]
ds_read_b64_tr_b16 a[44:45], v13 offset:43008
v_mfma_f32_16x16x32_bf16 v[112:115], a[28:31], a[64:67], v[112:115]
ds_read_b64_tr_b16 a[46:47], v13 offset:43520
v_mfma_f32_16x16x32_bf16 v[44:47], a[16:19], a[68:71], v[44:47]
ds_read_b64_tr_b16 a[48:49], v12 offset:45056
v_mfma_f32_16x16x32_bf16 v[68:71], a[20:23], a[68:71], v[68:71]
ds_read_b64_tr_b16 a[50:51], v12 offset:45568
v_mfma_f32_16x16x32_bf16 v[92:95], a[24:27], a[68:71], v[92:95]
ds_read_b64_tr_b16 a[52:53], v13 offset:45056
v_mfma_f32_16x16x32_bf16 v[116:119], a[28:31], a[68:71], v[116:119]
ds_read_b64_tr_b16 a[54:55], v13 offset:45568
v_mfma_f32_16x16x32_bf16 v[48:51], a[16:19], a[72:75], v[48:51]
v_mfma_f32_16x16x32_bf16 v[72:75], a[20:23], a[72:75], v[72:75]
v_mfma_f32_16x16x32_bf16 v[96:99], a[24:27], a[72:75], v[96:99]
v_mfma_f32_16x16x32_bf16 v[120:123], a[28:31], a[72:75], v[120:123]
v_mfma_f32_16x16x32_bf16 v[52:55], a[16:19], a[76:79], v[52:55]
v_mfma_f32_16x16x32_bf16 v[76:79], a[20:23], a[76:79], v[76:79]
v_mfma_f32_16x16x32_bf16 v[100:103], a[24:27], a[76:79], v[100:103]
v_mfma_f32_16x16x32_bf16 v[124:127], a[28:31], a[76:79], v[124:127]
s_waitcnt lgkmcnt(0)
v_mfma_f32_16x16x32_bf16 v[32:35], a[32:35], a[0:3], v[32:35]
ds_read_b128 a[16:19], v11 offset:57344
v_mfma_f32_16x16x32_bf16 v[56:59], a[32:35], a[4:7], v[56:59]
ds_read_b64_tr_b16 a[56:57], v12 offset:53248
v_mfma_f32_16x16x32_bf16 v[80:83], a[32:35], a[8:11], v[80:83]
ds_read_b64_tr_b16 a[58:59], v12 offset:53760
v_mfma_f32_16x16x32_bf16 v[104:107], a[32:35], a[12:15], v[104:107]
ds_read_b128 a[20:23], v11 offset:59392
v_mfma_f32_16x16x32_bf16 v[36:39], a[36:39], a[0:3], v[36:39]
ds_read_b128 a[24:27], v11 offset:61440
v_mfma_f32_16x16x32_bf16 v[60:63], a[36:39], a[4:7], v[60:63]
ds_read_b128 a[28:31], v11 offset:63488
v_mfma_f32_16x16x32_bf16 v[84:87], a[36:39], a[8:11], v[84:87]
ds_read_b64_tr_b16 a[60:61], v13 offset:53248
v_mfma_f32_16x16x32_bf16 v[108:111], a[36:39], a[12:15], v[108:111]
ds_read_b64_tr_b16 a[62:63], v13 offset:53760
v_mfma_f32_16x16x32_bf16 v[40:43], a[0:3], a[40:43], v[40:43]
ds_read_b64_tr_b16 a[64:65], v12 offset:55296
v_mfma_f32_16x16x32_bf16 v[64:67], a[4:7], a[40:43], v[64:67]
ds_read_b64_tr_b16 a[66:67], v12 offset:55808
v_mfma_f32_16x16x32_bf16 v[88:91], a[8:11], a[40:43], v[88:91]
ds_read_b64_tr_b16 a[68:69], v13 offset:55296
v_mfma_f32_16x16x32_bf16 v[112:115], a[12:15], a[40:43], v[112:115]
ds_read_b64_tr_b16 a[70:71], v13 offset:55808
v_mfma_f32_16x16x32_bf16 v[44:47], a[0:3], a[44:47], v[44:47]
ds_read_b64_tr_b16 a[72:73], v12 offset:57344
v_mfma_f32_16x16x32_bf16 v[68:71], a[4:7], a[44:47], v[68:71]
ds_read_b64_tr_b16 a[74:75], v12 offset:57856
v_mfma_f32_16x16x32_bf16 v[92:95], a[8:11], a[44:47], v[92:95]
ds_read_b64_tr_b16 a[76:77], v13 offset:57344
v_mfma_f32_16x16x32_bf16 v[116:119], a[12:15], a[44:47], v[116:119]
ds_read_b64_tr_b16 a[78:79], v13 offset:57856
v_mfma_f32_16x16x32_bf16 v[48:51], a[0:3], a[48:51], v[48:51]
v_mfma_f32_16x16x32_bf16 v[72:75], a[4:7], a[48:51], v[72:75]
v_mfma_f32_16x16x32_bf16 v[96:99], a[8:11], a[48:51], v[96:99]
v_mfma_f32_16x16x32_bf16 v[120:123], a[12:15], a[48:51], v[120:123]
v_mfma_f32_16x16x32_bf16 v[52:55], a[0:3], a[52:55], v[52:55]
v_mfma_f32_16x16x32_bf16 v[76:79], a[4:7], a[52:55], v[76:79]
v_mfma_f32_16x16x32_bf16 v[100:103], a[8:11], a[52:55], v[100:103]
v_mfma_f32_16x16x32_bf16 v[124:127], a[12:15], a[52:55], v[124:127]
s_waitcnt lgkmcnt(0)
v_mfma_f32_16x16x32_bf16 v[32:35], a[56:59], a[16:19], v[32:35]
s_barrier
ds_read_b128 a[0:3], v10 offset:40960
v_mfma_f32_16x16x32_bf16 v[56:59], a[56:59], a[20:23], v[56:59]
ds_read_b64_tr_b16 a[32:33], v12 offset:0
v_mfma_f32_16x16x32_bf16 v[80:83], a[56:59], a[24:27], v[80:83]
ds_read_b64_tr_b16 a[34:35], v12 offset:512
v_mfma_f32_16x16x32_bf16 v[104:107], a[56:59], a[28:31], v[104:107]
ds_read_b128 a[4:7], v10 offset:43008
v_mfma_f32_16x16x32_bf16 v[36:39], a[60:63], a[16:19], v[36:39]
ds_read_b128 a[8:11], v10 offset:45056
v_mfma_f32_16x16x32_bf16 v[60:63], a[60:63], a[20:23], v[60:63]
ds_read_b128 a[12:15], v10 offset:47104
v_mfma_f32_16x16x32_bf16 v[84:87], a[60:63], a[24:27], v[84:87]
ds_read_b64_tr_b16 a[36:37], v13 offset:0
v_mfma_f32_16x16x32_bf16 v[108:111], a[60:63], a[28:31], v[108:111]
ds_read_b64_tr_b16 a[38:39], v13 offset:512
v_mfma_f32_16x16x32_bf16 v[40:43], a[16:19], a[64:67], v[40:43]
ds_read_b64_tr_b16 a[40:41], v12 offset:2048
v_mfma_f32_16x16x32_bf16 v[64:67], a[20:23], a[64:67], v[64:67]
ds_read_b64_tr_b16 a[42:43], v12 offset:2560
v_mfma_f32_16x16x32_bf16 v[88:91], a[24:27], a[64:67], v[88:91]
ds_read_b64_tr_b16 a[44:45], v13 offset:2048
v_mfma_f32_16x16x32_bf16 v[112:115], a[28:31], a[64:67], v[112:115]
ds_read_b64_tr_b16 a[46:47], v13 offset:2560
v_mfma_f32_16x16x32_bf16 v[44:47], a[16:19], a[68:71], v[44:47]
ds_read_b64_tr_b16 a[48:49], v12 offset:4096
v_mfma_f32_16x16x32_bf16 v[68:71], a[20:23], a[68:71], v[68:71]
ds_read_b64_tr_b16 a[50:51], v12 offset:4608
v_mfma_f32_16x16x32_bf16 v[92:95], a[24:27], a[68:71], v[92:95]
ds_read_b64_tr_b16 a[52:53], v13 offset:4096
v_mfma_f32_16x16x32_bf16 v[116:119], a[28:31], a[68:71], v[116:119]
ds_read_b64_tr_b16 a[54:55], v13 offset:4608
v_mfma_f32_16x16x32_bf16 v[48:51], a[16:19], a[72:75], v[48:51]
v_mfma_f32_16x16x32_bf16 v[72:75], a[20:23], a[72:75], v[72:75]
v_mfma_f32_16x16x32_bf16 v[96:99], a[24:27], a[72:75], v[96:99]
v_mfma_f32_16x16x32_bf16 v[120:123], a[28:31], a[72:75], v[120:123]
v_mfma_f32_16x16x32_bf16 v[52:55], a[16:19], a[76:79], v[52:55]
v_mfma_f32_16x16x32_bf16 v[76:79], a[20:23], a[76:79], v[76:79]
v_mfma_f32_16x16x32_bf16 v[100:103], a[24:27], a[76:79], v[100:103]
v_mfma_f32_16x16x32_bf16 v[124:127], a[28:31], a[76:79], v[124:127]
s_waitcnt lgkmcnt(0)
v_mfma_f32_16x16x32_bf16 v[32:35], a[32:35], a[0:3], v[32:35]
ds_read_b128 a[16:19], v11 offset:40960
v_mfma_f32_16x16x32_bf16 v[56:59], a[32:35], a[4:7], v[56:59]
ds_read_b64_tr_b16 a[56:57], v12 offset:12288
v_mfma_f32_16x16x32_bf16 v[80:83], a[32:35], a[8:11], v[80:83]
ds_read_b64_tr_b16 a[58:59], v12 offset:12800
v_mfma_f32_16x16x32_bf16 v[104:107], a[32:35], a[12:15], v[104:107]
ds_read_b128 a[20:23], v11 offset:43008
v_mfma_f32_16x16x32_bf16 v[36:39], a[36:39], a[0:3], v[36:39]
ds_read_b128 a[24:27], v11 offset:45056
v_mfma_f32_16x16x32_bf16 v[60:63], a[36:39], a[4:7], v[60:63]
ds_read_b128 a[28:31], v11 offset:47104
v_mfma_f32_16x16x32_bf16 v[84:87], a[36:39], a[8:11], v[84:87]
ds_read_b64_tr_b16 a[60:61], v13 offset:12288
v_mfma_f32_16x16x32_bf16 v[108:111], a[36:39], a[12:15], v[108:111]
ds_read_b64_tr_b16 a[62:63], v13 offset:12800
v_mfma_f32_16x16x32_bf16 v[40:43], a[0:3], a[40:43], v[40:43]
ds_read_b64_tr_b16 a[64:65], v12 offset:14336
v_mfma_f32_16x16x32_bf16 v[64:67], a[4:7], a[40:43], v[64:67]
ds_read_b64_tr_b16 a[66:67], v12 offset:14848
v_mfma_f32_16x16x32_bf16 v[88:91], a[8:11], a[40:43], v[88:91]
ds_read_b64_tr_b16 a[68:69], v13 offset:14336
v_mfma_f32_16x16x32_bf16 v[112:115], a[12:15], a[40:43], v[112:115]
ds_read_b64_tr_b16 a[70:71], v13 offset:14848
v_mfma_f32_16x16x32_bf16 v[44:47], a[0:3], a[44:47], v[44:47]
ds_read_b64_tr_b16 a[72:73], v12 offset:16384
v_mfma_f32_16x16x32_bf16 v[68:71], a[4:7], a[44:47], v[68:71]
ds_read_b64_tr_b16 a[74:75], v12 offset:16896
v_mfma_f32_16x16x32_bf16 v[92:95], a[8:11], a[44:47], v[92:95]
ds_read_b64_tr_b16 a[76:77], v13 offset:16384
v_mfma_f32_16x16x32_bf16 v[116:119], a[12:15], a[44:47], v[116:119]
ds_read_b64_tr_b16 a[78:79], v13 offset:16896
v_mfma_f32_16x16x32_bf16 v[48:51], a[0:3], a[48:51], v[48:51]
v_mfma_f32_16x16x32_bf16 v[72:75], a[4:7], a[48:51], v[72:75]
v_mfma_f32_16x16x32_bf16 v[96:99], a[8:11], a[48:51], v[96:99]
v_mfma_f32_16x16x32_bf16 v[120:123], a[12:15], a[48:51], v[120:123]
v_mfma_f32_16x16x32_bf16 v[52:55], a[0:3], a[52:55], v[52:55]
v_mfma_f32_16x16x32_bf16 v[76:79], a[4:7], a[52:55], v[76:79]
v_mfma_f32_16x16x32_bf16 v[100:103], a[8:11], a[52:55], v[100:103]
v_mfma_f32_16x16x32_bf16 v[124:127], a[12:15], a[52:55], v[124:127]
s_waitcnt lgkmcnt(0)
v_mfma_f32_16x16x32_bf16 v[32:35], a[56:59], a[16:19], v[32:35]
s_barrier
ds_read_b128 a[0:3], v10 offset:0
v_mfma_f32_16x16x32_bf16 v[56:59], a[56:59], a[20:23], v[56:59]
ds_read_b64_tr_b16 a[32:33], v14 offset:16384
v_mfma_f32_16x16x32_bf16 v[80:83], a[56:59], a[24:27], v[80:83]
ds_read_b64_tr_b16 a[34:35], v14 offset:16896
v_mfma_f32_16x16x32_bf16 v[104:107], a[56:59], a[28:31], v[104:107]
ds_read_b128 a[4:7], v10 offset:2048
v_mfma_f32_16x16x32_bf16 v[36:39], a[60:63], a[16:19], v[36:39]
ds_read_b128 a[8:11], v10 offset:4096
v_mfma_f32_16x16x32_bf16 v[60:63], a[60:63], a[20:23], v[60:63]
ds_read_b128 a[12:15], v10 offset:6144
v_mfma_f32_16x16x32_bf16 v[84:87], a[60:63], a[24:27], v[84:87]
ds_read_b64_tr_b16 a[36:37], v15 offset:16384
v_mfma_f32_16x16x32_bf16 v[108:111], a[60:63], a[28:31], v[108:111]
ds_read_b64_tr_b16 a[38:39], v15 offset:16896
v_mfma_f32_16x16x32_bf16 v[40:43], a[16:19], a[64:67], v[40:43]
ds_read_b64_tr_b16 a[40:41], v14 offset:18432
v_mfma_f32_16x16x32_bf16 v[64:67], a[20:23], a[64:67], v[64:67]
ds_read_b64_tr_b16 a[42:43], v14 offset:18944
v_mfma_f32_16x16x32_bf16 v[88:91], a[24:27], a[64:67], v[88:91]
ds_read_b64_tr_b16 a[44:45], v15 offset:18432
v_mfma_f32_16x16x32_bf16 v[112:115], a[28:31], a[64:67], v[112:115]
ds_read_b64_tr_b16 a[46:47], v15 offset:18944
v_mfma_f32_16x16x32_bf16 v[44:47], a[16:19], a[68:71], v[44:47]
ds_read_b64_tr_b16 a[48:49], v14 offset:20480
v_mfma_f32_16x16x32_bf16 v[68:71], a[20:23], a[68:71], v[68:71]
ds_read_b64_tr_b16 a[50:51], v14 offset:20992
v_mfma_f32_16x16x32_bf16 v[92:95], a[24:27], a[68:71], v[92:95]
ds_read_b64_tr_b16 a[52:53], v15 offset:20480
v_mfma_f32_16x16x32_bf16 v[116:119], a[28:31], a[68:71], v[116:119]
ds_read_b64_tr_b16 a[54:55], v15 offset:20992
v_mfma_f32_16x16x32_bf16 v[48:51], a[16:19], a[72:75], v[48:51]
v_mfma_f32_16x16x32_bf16 v[72:75], a[20:23], a[72:75], v[72:75]
v_mfma_f32_16x16x32_bf16 v[96:99], a[24:27], a[72:75], v[96:99]
v_mfma_f32_16x16x32_bf16 v[120:123], a[28:31], a[72:75], v[120:123]
v_mfma_f32_16x16x32_bf16 v[52:55], a[16:19], a[76:79], v[52:55]
v_mfma_f32_16x16x32_bf16 v[76:79], a[20:23], a[76:79], v[76:79]
v_mfma_f32_16x16x32_bf16 v[100:103], a[24:27], a[76:79], v[100:103]
v_mfma_f32_16x16x32_bf16 v[124:127], a[28:31], a[76:79], v[124:127]
s_waitcnt lgkmcnt(0)
v_mfma_f32_16x16x32_bf16 v[32:35], a[32:35], a[0:3], v[32:35]
ds_read_b128 a[16:19], v11 offset:0
v_mfma_f32_16x16x32_bf16 v[56:59], a[32:35], a[4:7], v[56:59]
ds_read_b64_tr_b16 a[56:57], v14 offset:28672
v_mfma_f32_16x16x32_bf16 v[80:83], a[32:35], a[8:11], v[80:83]
ds_read_b64_tr_b16 a[58:59], v14 offset:29184
v_mfma_f32_16x16x32_bf16 v[104:107], a[32:35], a[12:15], v[104:107]
ds_read_b128 a[20:23], v11 offset:2048
v_mfma_f32_16x16x32_bf16 v[36:39], a[36:39], a[0:3], v[36:39]
ds_read_b128 a[24:27], v11 offset:4096
v_mfma_f32_16x16x32_bf16 v[60:63], a[36:39], a[4:7], v[60:63]
ds_read_b128 a[28:31], v11 offset:6144
v_mfma_f32_16x16x32_bf16 v[84:87], a[36:39], a[8:11], v[84:87]
ds_read_b64_tr_b16 a[60:61], v15 offset:28672
v_mfma_f32_16x16x32_bf16 v[108:111], a[36:39], a[12:15], v[108:111]
ds_read_b64_tr_b16 a[62:63], v15 offset:29184
v_mfma_f32_16x16x32_bf16 v[40:43], a[0:3], a[40:43], v[40:43]
ds_read_b64_tr_b16 a[64:65], v14 offset:30720
v_mfma_f32_16x16x32_bf16 v[64:67], a[4:7], a[40:43], v[64:67]
ds_read_b64_tr_b16 a[66:67], v14 offset:31232
v_mfma_f32_16x16x32_bf16 v[88:91], a[8:11], a[40:43], v[88:91]
ds_read_b64_tr_b16 a[68:69], v15 offset:30720
v_mfma_f32_16x16x32_bf16 v[112:115], a[12:15], a[40:43], v[112:115]
ds_read_b64_tr_b16 a[70:71], v15 offset:31232
v_mfma_f32_16x16x32_bf16 v[44:47], a[0:3], a[44:47], v[44:47]
ds_read_b64_tr_b16 a[72:73], v14 offset:32768
v_mfma_f32_16x16x32_bf16 v[68:71], a[4:7], a[44:47], v[68:71]
ds_read_b64_tr_b16 a[74:75], v14 offset:33280
v_mfma_f32_16x16x32_bf16 v[92:95], a[8:11], a[44:47], v[92:95]
ds_read_b64_tr_b16 a[76:77], v15 offset:32768
v_mfma_f32_16x16x32_bf16 v[116:119], a[12:15], a[44:47], v[116:119]
ds_read_b64_tr_b16 a[78:79], v15 offset:33280
v_mfma_f32_16x16x32_bf16 v[48:51], a[0:3], a[48:51], v[48:51]
v_mfma_f32_16x16x32_bf16 v[72:75], a[4:7], a[48:51], v[72:75]
v_mfma_f32_16x16x32_bf16 v[96:99], a[8:11], a[48:51], v[96:99]
v_mfma_f32_16x16x32_bf16 v[120:123], a[12:15], a[48:51], v[120:123]
v_mfma_f32_16x16x32_bf16 v[52:55], a[0:3], a[52:55], v[52:55]
v_mfma_f32_16x16x32_bf16 v[76:79], a[4:7], a[52:55], v[76:79]
v_mfma_f32_16x16x32_bf16 v[100:103], a[8:11], a[52:55], v[100:103]
v_mfma_f32_16x16x32_bf16 v[124:127], a[12:15], a[52:55], v[124:127]
s_waitcnt lgkmcnt(0)
v_mfma_f32_16x16x32_bf16 v[32:35], a[56:59], a[16:19], v[32:35]
s_barrier
ds_read_b128 a[0:3], v8 offset:24576
v_mfma_f32_16x16x32_bf16 v[56:59], a[56:59], a[20:23], v[56:59]
ds_read_b64_tr_b16 a[32:33], v12 offset:40960
v_mfma_f32_16x16x32_bf16 v[80:83], a[56:59], a[24:27], v[80:83]
ds_read_b64_tr_b16 a[34:35], v12 offset:41472
v_mfma_f32_16x16x32_bf16 v[104:107], a[56:59], a[28:31], v[104:107]
s_branch L_over4
L_pad4:
s_branch L_ret4
L_over4:
ds_read_b128 a[4:7], v8 offset:26624
v_mfma_f32_16x16x32_bf16 v[36:39], a[60:63], a[16:19], v[36:39]
ds_read_b128 a[8:11], v8 offset:28672
v_mfma_f32_16x16x32_bf16 v[60:63], a[60:63], a[20:23], v[60:63]
ds_read_b128 a[12:15], v8 offset:30720
v_mfma_f32_16x16x32_bf16 v[84:87], a[60:63], a[24:27], v[84:87]
ds_read_b64_tr_b16 a[36:37], v13 offset:40960
v_mfma_f32_16x16x32_bf16 v[108:111], a[60:63], a[28:31], v[108:111]
ds_read_b64_tr_b16 a[38:39], v13 offset:41472
v_mfma_f32_16x16x32_bf16 v[40:43], a[16:19], a[64:67], v[40:43]
ds_read_b64_tr_b16 a[40:41], v12 offset:43008
v_mfma_f32_16x16x32_bf16 v[64:67], a[20:23], a[64:67], v[64:67]
ds_read_b64_tr_b16 a[42:43], v12 offset:43520
v_mfma_f32_16x16x32_bf16 v[88:91], a[24:27], a[64:67], v[88:91]
ds_read_b64_tr_b16 a[44:45], v13 offset:43008
v_mfma_f32_16x16x32_bf16 v[112:115], a[28:31], a[64:67], v[112:115]
ds_read_b64_tr_b16 a[46:47], v13 offset:43520
v_mfma_f32_16x16x32_bf16 v[44:47], a[16:19], a[68:71], v[44:47]
ds_read_b64_tr_b16 a[48:49], v12 offset:45056
v_mfma_f32_16x16x32_bf16 v[68:71], a[20:23], a[68:71], v[68:71]
ds_read_b64_tr_b16 a[50:51], v12 offset:45568
v_mfma_f32_16x16x32_bf16 v[92:95], a[24:27], a[68:71], v[92:95]
ds_read_b64_tr_b16 a[52:53], v13 offset:45056
v_mfma_f32_16x16x32_bf16 v[116:119], a[28:31], a[68:71], v[116:119]
ds_read_b64_tr_b16 a[54:55], v13 offset:45568
v_mfma_f32_16x16x32_bf16 v[48:51], a[16:19], a[72:75], v[48:51]
v_mfma_f32_16x16x32_bf16 v[72:75], a[20:23], a[72:75], v[72:75]
v_mfma_f32_16x16x32_bf16 v[96:99], a[24:27], a[72:75], v[96:99]
v_mfma_f32_16x16x32_bf16 v[120:123], a[28:31], a[72:75], v[120:123]
v_mfma_f32_16x16x32_bf16 v[52:55], a[16:19], a[76:79], v[52:55]
v_mfma_f32_16x16x32_bf16 v[76:79], a[20:23], a[76:79], v[76:79]
v_mfma_f32_16x16x32_bf16 v[100:103], a[24:27], a[76:79], v[100:103]
v_mfma_f32_16x16x32_bf16 v[124:127], a[28:31], a[76:79], v[124:127]
s_waitcnt lgkmcnt(0)
v_mfma_f32_16x16x32_bf16 v[32:35], a[32:35], a[0:3], v[32:35]
ds_read_b128 a[16:19], v9 offset:24576
v_mfma_f32_16x16x32_bf16 v[56:59], a[32:35], a[4:7], v[56:59]
ds_read_b64_tr_b16 a[56:57], v12 offset:53248
v_mfma_f32_16x16x32_bf16 v[80:83], a[32:35], a[8:11], v[80:83]
ds_read_b64_tr_b16 a[58:59], v12 offset:53760
v_mfma_f32_16x16x32_bf16 v[104:107], a[32:35], a[12:15], v[104:107]
ds_read_b128 a[20:23], v9 offset:26624
v_mfma_f32_16x16x32_bf16 v[36:39], a[36:39], a[0:3], v[36:39]
ds_read_b128 a[24:27], v9 offset:28672
v_mfma_f32_16x16x32_bf16 v[60:63], a[36:39], a[4:7], v[60:63]
ds_read_b128 a[28:31], v9 offset:30720
v_mfma_f32_16x16x32_bf16 v[84:87], a[36:39], a[8:11], v[84:87]
ds_read_b64_tr_b16 a[60:61], v13 offset:53248
v_mfma_f32_16x16x32_bf16 v[108:111], a[36:39], a[12:15], v[108:111]
ds_read_b64_tr_b16 a[62:63], v13 offset:53760
v_mfma_f32_16x16x32_bf16 v[40:43], a[0:3], a[40:43], v[40:43]
ds_read_b64_tr_b16 a[64:65], v12 offset:55296
v_mfma_f32_16x16x32_bf16 v[64:67], a[4:7], a[40:43], v[64:67]
ds_read_b64_tr_b16 a[66:67], v12 offset:55808
v_mfma_f32_16x16x32_bf16 v[88:91], a[8:11], a[40:43], v[88:91]
ds_read_b64_tr_b16 a[68:69], v13 offset:55296
v_mfma_f32_16x16x32_bf16 v[112:115], a[12:15], a[40:43], v[112:115]
ds_read_b64_tr_b16 a[70:71], v13 offset:55808
v_mfma_f32_16x16x32_bf16 v[44:47], a[0:3], a[44:47], v[44:47]
ds_read_b64_tr_b16 a[72:73], v12 offset:57344
v_mfma_f32_16x16x32_bf16 v[68:71], a[4:7], a[44:47], v[68:71]
ds_read_b64_tr_b16 a[74:75], v12 offset:57856
v_mfma_f32_16x16x32_bf16 v[92:95], a[8:11], a[44:47], v[92:95]
ds_read_b64_tr_b16 a[76:77], v13 offset:57344
v_mfma_f32_16x16x32_bf16 v[116:119], a[12:15], a[44:47], v[116:119]
ds_read_b64_tr_b16 a[78:79], v13 offset:57856
v_mfma_f32_16x16x32_bf16 v[48:51], a[0:3], a[48:51], v[48:51]
v_mfma_f32_16x16x32_bf16 v[72:75], a[4:7], a[48:51], v[72:75]
v_mfma_f32_16x16x32_bf16 v[96:99], a[8:11], a[48:51], v[96:99]
v_mfma_f32_16x16x32_bf16 v[120:123], a[12:15], a[48:51], v[120:123]
v_mfma_f32_16x16x32_bf16 v[52:55], a[0:3], a[52:55], v[52:55]
v_mfma_f32_16x16x32_bf16 v[76:79], a[4:7], a[52:55], v[76:79]
v_mfma_f32_16x16x32_bf16 v[100:103], a[8:11], a[52:55], v[100:103]
v_mfma_f32_16x16x32_bf16 v[124:127], a[12:15], a[52:55], v[124:127]
s_waitcnt lgkmcnt(0)
v_mfma_f32_16x16x32_bf16 v[32:35], a[56:59], a[16:19], v[32:35]
s_barrier
ds_read_b128 a[0:3], v10 offset:57344
v_mfma_f32_16x16x32_bf16 v[56:59], a[56:59], a[20:23], v[56:59]
ds_read_b64_tr_b16 a[32:33], v12 offset:0
v_mfma_f32_16x16x32_bf16 v[80:83], a[56:59], a[24:27], v[80:83]
ds_read_b64_tr_b16 a[34:35], v12 offset:512
v_mfma_f32_16x16x32_bf16 v[104:107], a[56:59], a[28:31], v[104:107]
ds_read_b128 a[4:7], v10 offset:59392
v_mfma_f32_16x16x32_bf16 v[36:39], a[60:63], a[16:19], v[36:39]
ds_read_b128 a[8:11], v10 offset:61440
v_mfma_f32_16x16x32_bf16 v[60:63], a[60:63], a[20:23], v[60:63]
ds_read_b128 a[12:15], v10 offset:63488
v_mfma_f32_16x16x32_bf16 v[84:87], a[60:63], a[24:27], v[84:87]
ds_read_b64_tr_b16 a[36:37], v13 offset:0
v_mfma_f32_16x16x32_bf16 v[108:111], a[60:63], a[28:31], v[108:111]
ds_read_b64_tr_b16 a[38:39], v13 offset:512
v_mfma_f32_16x16x32_bf16 v[40:43], a[16:19], a[64:67], v[40:43]
ds_read_b64_tr_b16 a[40:41], v12 offset:2048
v_mfma_f32_16x16x32_bf16 v[64:67], a[20:23], a[64:67], v[64:67]
ds_read_b64_tr_b16 a[42:43], v12 offset:2560
v_mfma_f32_16x16x32_bf16 v[88:91], a[24:27], a[64:67], v[88:91]
ds_read_b64_tr_b16 a[44:45], v13 offset:2048
v_mfma_f32_16x16x32_bf16 v[112:115], a[28:31], a[64:67], v[112:115]
ds_read_b64_tr_b16 a[46:47], v13 offset:2560
v_mfma_f32_16x16x32_bf16 v[44:47], a[16:19], a[68:71], v[44:47]
ds_read_b64_tr_b16 a[48:49], v12 offset:4096
v_mfma_f32_16x16x32_bf16 v[68:71], a[20:23], a[68:71], v[68:71]
ds_read_b64_tr_b16 a[50:51], v12 offset:4608
v_mfma_f32_16x16x32_bf16 v[92:95], a[24:27], a[68:71], v[92:95]
ds_read_b64_tr_b16 a[52:53], v13 offset:4096
v_mfma_f32_16x16x32_bf16 v[116:119], a[28:31], a[68:71], v[116:119]
ds_read_b64_tr_b16 a[54:55], v13 offset:4608
v_mfma_f32_16x16x32_bf16 v[48:51], a[16:19], a[72:75], v[48:51]
v_mfma_f32_16x16x32_bf16 v[72:75], a[20:23], a[72:75], v[72:75]
v_mfma_f32_16x16x32_bf16 v[96:99], a[24:27], a[72:75], v[96:99]
v_mfma_f32_16x16x32_bf16 v[120:123], a[28:31], a[72:75], v[120:123]
v_mfma_f32_16x16x32_bf16 v[52:55], a[16:19], a[76:79], v[52:55]
v_mfma_f32_16x16x32_bf16 v[76:79], a[20:23], a[76:79], v[76:79]
v_mfma_f32_16x16x32_bf16 v[100:103], a[24:27], a[76:79], v[100:103]
v_mfma_f32_16x16x32_bf16 v[124:127], a[28:31], a[76:79], v[124:127]
s_waitcnt lgkmcnt(0)
v_mfma_f32_16x16x32_bf16 v[32:35], a[32:35], a[0:3], v[32:35]
ds_read_b128 a[16:19], v11 offset:57344
v_mfma_f32_16x16x32_bf16 v[56:59], a[32:35], a[4:7], v[56:59]
ds_read_b64_tr_b16 a[56:57], v12 offset:12288
v_mfma_f32_16x16x32_bf16 v[80:83], a[32:35], a[8:11], v[80:83]
ds_read_b64_tr_b16 a[58:59], v12 offset:12800
v_mfma_f32_16x16x32_bf16 v[104:107], a[32:35], a[12:15], v[104:107]
ds_read_b128 a[20:23], v11 offset:59392
v_mfma_f32_16x16x32_bf16 v[36:39], a[36:39], a[0:3], v[36:39]
ds_read_b128 a[24:27], v11 offset:61440
v_mfma_f32_16x16x32_bf16 v[60:63], a[36:39], a[4:7], v[60:63]
ds_read_b128 a[28:31], v11 offset:63488
v_mfma_f32_16x16x32_bf16 v[84:87], a[36:39], a[8:11], v[84:87]
ds_read_b64_tr_b16 a[60:61], v13 offset:12288
v_mfma_f32_16x16x32_bf16 v[108:111], a[36:39], a[12:15], v[108:111]
ds_read_b64_tr_b16 a[62:63], v13 offset:12800
v_mfma_f32_16x16x32_bf16 v[40:43], a[0:3], a[40:43], v[40:43]
ds_read_b64_tr_b16 a[64:65], v12 offset:14336
v_mfma_f32_16x16x32_bf16 v[64:67], a[4:7], a[40:43], v[64:67]
ds_read_b64_tr_b16 a[66:67], v12 offset:14848
v_mfma_f32_16x16x32_bf16 v[88:91], a[8:11], a[40:43], v[88:91]
ds_read_b64_tr_b16 a[68:69], v13 offset:14336
v_mfma_f32_16x16x32_bf16 v[112:115], a[12:15], a[40:43], v[112:115]
ds_read_b64_tr_b16 a[70:71], v13 offset:14848
v_mfma_f32_16x16x32_bf16 v[44:47], a[0:3], a[44:47], v[44:47]
ds_read_b64_tr_b16 a[72:73], v12 offset:16384
v_mfma_f32_16x16x32_bf16 v[68:71], a[4:7], a[44:47], v[68:71]
ds_read_b64_tr_b16 a[74:75], v12 offset:16896
v_mfma_f32_16x16x32_bf16 v[92:95], a[8:11], a[44:47], v[92:95]
ds_read_b64_tr_b16 a[76:77], v13 offset:16384
v_mfma_f32_16x16x32_bf16 v[116:119], a[12:15], a[44:47], v[116:119]
ds_read_b64_tr_b16 a[78:79], v13 offset:16896
v_mfma_f32_16x16x32_bf16 v[48:51], a[0:3], a[48:51], v[48:51]
v_mfma_f32_16x16x32_bf16 v[72:75], a[4:7], a[48:51], v[72:75]
v_mfma_f32_16x16x32_bf16 v[96:99], a[8:11], a[48:51], v[96:99]
v_mfma_f32_16x16x32_bf16 v[120:123], a[12:15], a[48:51], v[120:123]
v_mfma_f32_16x16x32_bf16 v[52:55], a[0:3], a[52:55], v[52:55]
v_mfma_f32_16x16x32_bf16 v[76:79], a[4:7], a[52:55], v[76:79]
v_mfma_f32_16x16x32_bf16 v[100:103], a[8:11], a[52:55], v[100:103]
v_mfma_f32_16x16x32_bf16 v[124:127], a[12:15], a[52:55], v[124:127]
s_waitcnt lgkmcnt(0)
v_mfma_f32_16x16x32_bf16 v[32:35], a[56:59], a[16:19], v[32:35]
s_barrier
ds_read_b128 a[0:3], v10 offset:40960
v_mfma_f32_16x16x32_bf16 v[56:59], a[56:59], a[20:23], v[56:59]
ds_read_b64_tr_b16 a[32:33], v14 offset:16384
v_mfma_f32_16x16x32_bf16 v[80:83], a[56:59], a[24:27], v[80:83]
ds_read_b64_tr_b16 a[34:35], v14 offset:16896
v_mfma_f32_16x16x32_bf16 v[104:107], a[56:59], a[28:31], v[104:107]
ds_read_b128 a[4:7], v10 offset:43008
v_mfma_f32_16x16x32_bf16 v[36:39], a[60:63], a[16:19], v[36:39]
ds_read_b128 a[8:11], v10 offset:45056
v_mfma_f32_16x16x32_bf16 v[60:63], a[60:63], a[20:23], v[60:63]
ds_read_b128 a[12:15], v10 offset:47104
v_mfma_f32_16x16x32_bf16 v[84:87], a[60:63], a[24:27], v[84:87]
ds_read_b64_tr_b16 a[36:37], v15 offset:16384
v_mfma_f32_16x16x32_bf16 v[108:111], a[60:63], a[28:31], v[108:111]
ds_read_b64_tr_b16 a[38:39], v15 offset:16896
v_mfma_f32_16x16x32_bf16 v[40:43], a[16:19], a[64:67], v[40:43]
ds_read_b64_tr_b16 a[40:41], v14 offset:18432
v_mfma_f32_16x16x32_bf16 v[64:67], a[20:23], a[64:67], v[64:67]
ds_read_b64_tr_b16 a[42:43], v14 offset:18944
v_mfma_f32_16x16x32_bf16 v[88:91], a[24:27], a[64:67], v[88:91]
ds_read_b64_tr_b16 a[44:45], v15 offset:18432
v_mfma_f32_16x16x32_bf16 v[112:115], a[28:31], a[64:67], v[112:115]
ds_read_b64_tr_b16 a[46:47], v15 offset:18944
v_mfma_f32_16x16x32_bf16 v[44:47], a[16:19], a[68:71], v[44:47]
ds_read_b64_tr_b16 a[48:49], v14 offset:20480
v_mfma_f32_16x16x32_bf16 v[68:71], a[20:23], a[68:71], v[68:71]
ds_read_b64_tr_b16 a[50:51], v14 offset:20992
v_mfma_f32_16x16x32_bf16 v[92:95], a[24:27], a[68:71], v[92:95]
ds_read_b64_tr_b16 a[52:53], v15 offset:20480
v_mfma_f32_16x16x32_bf16 v[116:119], a[28:31], a[68:71], v[116:119]
ds_read_b64_tr_b16 a[54:55], v15 offset:20992
v_mfma_f32_16x16x32_bf16 v[48:51], a[16:19], a[72:75], v[48:51]
v_mfma_f32_16x16x32_bf16 v[72:75], a[20:23], a[72:75], v[72:75]
v_mfma_f32_16x16x32_bf16 v[96:99], a[24:27], a[72:75], v[96:99]
v_mfma_f32_16x16x32_bf16 v[120:123], a[28:31], a[72:75], v[120:123]
v_mfma_f32_16x16x32_bf16 v[52:55], a[16:19], a[76:79], v[52:55]
v_mfma_f32_16x16x32_bf16 v[76:79], a[20:23], a[76:79], v[76:79]
v_mfma_f32_16x16x32_bf16 v[100:103], a[24:27], a[76:79], v[100:103]
v_mfma_f32_16x16x32_bf16 v[124:127], a[28:31], a[76:79], v[124:127]
s_waitcnt lgkmcnt(0)
v_mfma_f32_16x16x32_bf16 v[32:35], a[32:35], a[0:3], v[32:35]
ds_read_b128 a[16:19], v11 offset:40960
v_mfma_f32_16x16x32_bf16 v[56:59], a[32:35], a[4:7], v[56:59]
ds_read_b64_tr_b16 a[56:57], v14 offset:28672
v_mfma_f32_16x16x32_bf16 v[80:83], a[32:35], a[8:11], v[80:83]
ds_read_b64_tr_b16 a[58:59], v14 offset:29184
v_mfma_f32_16x16x32_bf16 v[104:107], a[32:35], a[12:15], v[104:107]
ds_read_b128 a[20:23], v11 offset:43008
v_mfma_f32_16x16x32_bf16 v[36:39], a[36:39], a[0:3], v[36:39]
ds_read_b128 a[24:27], v11 offset:45056
v_mfma_f32_16x16x32_bf16 v[60:63], a[36:39], a[4:7], v[60:63]
ds_read_b128 a[28:31], v11 offset:47104
v_mfma_f32_16x16x32_bf16 v[84:87], a[36:39], a[8:11], v[84:87]
ds_read_b64_tr_b16 a[60:61], v15 offset:28672
v_mfma_f32_16x16x32_bf16 v[108:111], a[36:39], a[12:15], v[108:111]
ds_read_b64_tr_b16 a[62:63], v15 offset:29184
v_mfma_f32_16x16x32_bf16 v[40:43], a[0:3], a[40:43], v[40:43]
ds_read_b64_tr_b16 a[64:65], v14 offset:30720
v_mfma_f32_16x16x32_bf16 v[64:67], a[4:7], a[40:43], v[64:67]
ds_read_b64_tr_b16 a[66:67], v14 offset:31232
v_mfma_f32_16x16x32_bf16 v[88:91], a[8:11], a[40:43], v[88:91]
ds_read_b64_tr_b16 a[68:69], v15 offset:30720
v_mfma_f32_16x16x32_bf16 v[112:115], a[12:15], a[40:43], v[112:115]
ds_read_b64_tr_b16 a[70:71], v15 offset:31232
v_mfma_f32_16x16x32_bf16 v[44:47], a[0:3], a[44:47], v[44:47]
ds_read_b64_tr_b16 a[72:73], v14 offset:32768
v_mfma_f32_16x16x32_bf16 v[68:71], a[4:7], a[44:47], v[68:71]
ds_read_b64_tr_b16 a[74:75], v14 offset:33280
v_mfma_f32_16x16x32_bf16 v[92:95], a[8:11], a[44:47], v[92:95]
ds_read_b64_tr_b16 a[76:77], v15 offset:32768
v_mfma_f32_16x16x32_bf16 v[116:119], a[12:15], a[44:47], v[116:119]
ds_read_b64_tr_b16 a[78:79], v15 offset:33280
v_mfma_f32_16x16x32_bf16 v[48:51], a[0:3], a[48:51], v[48:51]
v_mfma_f32_16x16x32_bf16 v[72:75], a[4:7], a[48:51], v[72:75]
v_mfma_f32_16x16x32_bf16 v[96:99], a[8:11], a[48:51], v[96:99]
v_mfma_f32_16x16x32_bf16 v[120:123], a[12:15], a[48:51], v[120:123]
v_mfma_f32_16x16x32_bf16 v[52:55], a[0:3], a[52:55], v[52:55]
v_mfma_f32_16x16x32_bf16 v[76:79], a[4:7], a[52:55], v[76:79]
v_mfma_f32_16x16x32_bf16 v[100:103], a[8:11], a[52:55], v[100:103]
v_mfma_f32_16x16x32_bf16 v[124:127], a[12:15], a[52:55], v[124:127]
s_waitcnt lgkmcnt(0)
v_mfma_f32_16x16x32_bf16 v[32:35], a[56:59], a[16:19], v[32:35]
s_barrier
ds_read_b128 a[0:3], v10 offset:0
v_mfma_f32_16x16x32_bf16 v[56:59], a[56:59], a[20:23], v[56:59]
ds_read_b64_tr_b16 a[32:33], v12 offset:40960
v_mfma_f32_16x16x32_bf16 v[80:83], a[56:59], a[24:27], v[80:83]
ds_read_b64_tr_b16 a[34:35], v12 offset:41472
v_mfma_f32_16x16x32_bf16 v[104:107], a[56:59], a[28:31], v[104:107]
ds_read_b128 a[4:7], v10 offset:2048
v_mfma_f32_16x16x32_bf16 v[36:39], a[60:63], a[16:19], v[36:39]
ds_read_b128 a[8:11], v10 offset:4096
v_mfma_f32_16x16x32_bf16 v[60:63], a[60:63], a[20:23], v[60:63]
ds_read_b128 a[12:15], v10 offset:6144
v_mfma_f32_16x16x32_bf16 v[84:87], a[60:63], a[24:27], v[84:87]
ds_read_b64_tr_b16 a[36:37], v13 offset:40960
v_mfma_f32_16x16x32_bf16 v[108:111], a[60:63], a[28:31], v[108:111]
ds_read_b64_tr_b16 a[38:39], v13 offset:41472
v_mfma_f32_16x16x32_bf16 v[40:43], a[16:19], a[64:67], v[40:43]
ds_read_b64_tr_b16 a[40:41], v12 offset:43008
v_mfma_f32_16x16x32_bf16 v[64:67], a[20:23], a[64:67], v[64:67]
ds_read_b64_tr_b16 a[42:43], v12 offset:43520
v_mfma_f32_16x16x32_bf16 v[88:91], a[24:27], a[64:67], v[88:91]
ds_read_b64_tr_b16 a[44:45], v13 offset:43008
v_mfma_f32_16x16x32_bf16 v[112:115], a[28:31], a[64:67], v[112:115]
ds_read_b64_tr_b16 a[46:47], v13 offset:43520
v_mfma_f32_16x16x32_bf16 v[44:47], a[16:19], a[68:71], v[44:47]
ds_read_b64_tr_b16 a[48:49], v12 offset:45056
v_mfma_f32_16x16x32_bf16 v[68:71], a[20:23], a[68:71], v[68:71]
ds_read_b64_tr_b16 a[50:51], v12 offset:45568
v_mfma_f32_16x16x32_bf16 v[92:95], a[24:27], a[68:71], v[92:95]
ds_read_b64_tr_b16 a[52:53], v13 offset:45056
v_mfma_f32_16x16x32_bf16 v[116:119], a[28:31], a[68:71], v[116:119]
ds_read_b64_tr_b16 a[54:55], v13 offset:45568
v_mfma_f32_16x16x32_bf16 v[48:51], a[16:19], a[72:75], v[48:51]
v_mfma_f32_16x16x32_bf16 v[72:75], a[20:23], a[72:75], v[72:75]
v_mfma_f32_16x16x32_bf16 v[96:99], a[24:27], a[72:75], v[96:99]
v_mfma_f32_16x16x32_bf16 v[120:123], a[28:31], a[72:75], v[120:123]
v_mfma_f32_16x16x32_bf16 v[52:55], a[16:19], a[76:79], v[52:55]
v_mfma_f32_16x16x32_bf16 v[76:79], a[20:23], a[76:79], v[76:79]
v_mfma_f32_16x16x32_bf16 v[100:103], a[24:27], a[76:79], v[100:103]
v_mfma_f32_16x16x32_bf16 v[124:127], a[28:31], a[76:79], v[124:127]
s_waitcnt lgkmcnt(0)
v_mfma_f32_16x16x32_bf16 v[32:35], a[32:35], a[0:3], v[32:35]
ds_read_b128 a[16:19], v11 offset:0
v_mfma_f32_16x16x32_bf16 v[56:59], a[32:35], a[4:7], v[56:59]
ds_read_b64_tr_b16 a[56:57], v12 offset:53248
v_mfma_f32_16x16x32_bf16 v[80:83], a[32:35], a[8:11], v[80:83]
ds_read_b64_tr_b16 a[58:59], v12 offset:53760
v_mfma_f32_16x16x32_bf16 v[104:107], a[32:35], a[12:15], v[104:107]
ds_read_b128 a[20:23], v11 offset:2048
v_mfma_f32_16x16x32_bf16 v[36:39], a[36:39], a[0:3], v[36:39]
ds_read_b128 a[24:27], v11 offset:4096
v_mfma_f32_16x16x32_bf16 v[60:63], a[36:39], a[4:7], v[60:63]
ds_read_b128 a[28:31], v11 offset:6144
v_mfma_f32_16x16x32_bf16 v[84:87], a[36:39], a[8:11], v[84:87]
ds_read_b64_tr_b16 a[60:61], v13 offset:53248
v_mfma_f32_16x16x32_bf16 v[108:111], a[36:39], a[12:15], v[108:111]
ds_read_b64_tr_b16 a[62:63], v13 offset:53760
v_mfma_f32_16x16x32_bf16 v[40:43], a[0:3], a[40:43], v[40:43]
ds_read_b64_tr_b16 a[64:65], v12 offset:55296
v_mfma_f32_16x16x32_bf16 v[64:67], a[4:7], a[40:43], v[64:67]
ds_read_b64_tr_b16 a[66:67], v12 offset:55808
v_mfma_f32_16x16x32_bf16 v[88:91], a[8:11], a[40:43], v[88:91]
ds_read_b64_tr_b16 a[68:69], v13 offset:55296
v_mfma_f32_16x16x32_bf16 v[112:115], a[12:15], a[40:43], v[112:115]
ds_read_b64_tr_b16 a[70:71], v13 offset:55808
v_mfma_f32_16x16x32_bf16 v[44:47], a[0:3], a[44:47], v[44:47]
ds_read_b64_tr_b16 a[72:73], v12 offset:57344
v_mfma_f32_16x16x32_bf16 v[68:71], a[4:7], a[44:47], v[68:71]
ds_read_b64_tr_b16 a[74:75], v12 offset:57856
v_mfma_f32_16x16x32_bf16 v[92:95], a[8:11], a[44:47], v[92:95]
ds_read_b64_tr_b16 a[76:77], v13 offset:57344
v_mfma_f32_16x16x32_bf16 v[116:119], a[12:15], a[44:47], v[116:119]
ds_read_b64_tr_b16 a[78:79], v13 offset:57856
v_mfma_f32_16x16x32_bf16 v[48:51], a[0:3], a[48:51], v[48:51]
v_lshrrev_b32 v2, 4, v1
v_lshlrev_b32 v2, 4, v2
s_lshl_b32 s70, s66, 8
s_add_u32 s70, s70, 159744
v_add_u32 v17, s70, v2
v_mfma_f32_16x16x32_bf16 v[72:75], a[4:7], a[48:51], v[72:75]
v_mfma_f32_16x16x32_bf16 v[96:99], a[8:11], a[48:51], v[96:99]
v_and_b32 v2, 15, v1
v_lshlrev_b32 v2, 2, v2
s_lshl_b32 s70, s67, 7
s_add_u32 s70, s70, 160768
v_add_u32 v18, s70, v2
v_mfma_f32_16x16x32_bf16 v[120:123], a[12:15], a[48:51], v[120:123]
v_mfma_f32_16x16x32_bf16 v[52:55], a[0:3], a[52:55], v[52:55]
v_mfma_f32_16x16x32_bf16 v[76:79], a[4:7], a[52:55], v[76:79]
v_mfma_f32_16x16x32_bf16 v[100:103], a[8:11], a[52:55], v[100:103]
v_mfma_f32_16x16x32_bf16 v[124:127], a[12:15], a[52:55], v[124:127]
s_waitcnt lgkmcnt(0)
v_mfma_f32_16x16x32_bf16 v[32:35], a[56:59], a[16:19], v[32:35]
s_barrier
ds_read_b128 a[0:3], v8 offset:24576
v_mfma_f32_16x16x32_bf16 v[56:59], a[56:59], a[20:23], v[56:59]
ds_read_b64_tr_b16 a[32:33], v12 offset:0
v_mfma_f32_16x16x32_bf16 v[80:83], a[56:59], a[24:27], v[80:83]
ds_read_b64_tr_b16 a[34:35], v12 offset:512
v_mfma_f32_16x16x32_bf16 v[104:107], a[56:59], a[28:31], v[104:107]
ds_read_b128 a[4:7], v8 offset:26624
v_mfma_f32_16x16x32_bf16 v[36:39], a[60:63], a[16:19], v[36:39]
ds_read_b128 a[8:11], v8 offset:28672
v_mfma_f32_16x16x32_bf16 v[60:63], a[60:63], a[20:23], v[60:63]
ds_read_b128 a[12:15], v8 offset:30720
v_mfma_f32_16x16x32_bf16 v[84:87], a[60:63], a[24:27], v[84:87]
ds_read_b64_tr_b16 a[36:37], v13 offset:0
v_mfma_f32_16x16x32_bf16 v[108:111], a[60:63], a[28:31], v[108:111]
ds_read_b64_tr_b16 a[38:39], v13 offset:512
v_mfma_f32_16x16x32_bf16 v[40:43], a[16:19], a[64:67], v[40:43]
ds_read_b64_tr_b16 a[40:41], v12 offset:2048
v_mfma_f32_16x16x32_bf16 v[64:67], a[20:23], a[64:67], v[64:67]
ds_read_b64_tr_b16 a[42:43], v12 offset:2560
v_mfma_f32_16x16x32_bf16 v[88:91], a[24:27], a[64:67], v[88:91]
ds_read_b64_tr_b16 a[44:45], v13 offset:2048
v_mfma_f32_16x16x32_bf16 v[112:115], a[28:31], a[64:67], v[112:115]
ds_read_b64_tr_b16 a[46:47], v13 offset:2560
v_mfma_f32_16x16x32_bf16 v[44:47], a[16:19], a[68:71], v[44:47]
ds_read_b64_tr_b16 a[48:49], v12 offset:4096
v_mfma_f32_16x16x32_bf16 v[68:71], a[20:23], a[68:71], v[68:71]
ds_read_b64_tr_b16 a[50:51], v12 offset:4608
v_mfma_f32_16x16x32_bf16 v[92:95], a[24:27], a[68:71], v[92:95]
ds_read_b64_tr_b16 a[52:53], v13 offset:4096
v_mfma_f32_16x16x32_bf16 v[116:119], a[28:31], a[68:71], v[116:119]
ds_read_b64_tr_b16 a[54:55], v13 offset:4608
v_mfma_f32_16x16x32_bf16 v[48:51], a[16:19], a[72:75], v[48:51]
v_mfma_f32_16x16x32_bf16 v[72:75], a[20:23], a[72:75], v[72:75]
v_mfma_f32_16x16x32_bf16 v[96:99], a[24:27], a[72:75], v[96:99]
v_mfma_f32_16x16x32_bf16 v[120:123], a[28:31], a[72:75], v[120:123]
v_mfma_f32_16x16x32_bf16 v[52:55], a[16:19], a[76:79], v[52:55]
v_mfma_f32_16x16x32_bf16 v[76:79], a[20:23], a[76:79], v[76:79]
v_mfma_f32_16x16x32_bf16 v[100:103], a[24:27], a[76:79], v[100:103]
v_mfma_f32_16x16x32_bf16 v[124:127], a[28:31], a[76:79], v[124:127]
s_waitcnt lgkmcnt(0)
v_mfma_f32_16x16x32_bf16 v[32:35], a[32:35], a[0:3], v[32:35]
ds_read_b128 a[16:19], v9 offset:24576
v_mfma_f32_16x16x32_bf16 v[56:59], a[32:35], a[4:7], v[56:59]
ds_read_b64_tr_b16 a[56:57], v12 offset:12288
v_mfma_f32_16x16x32_bf16 v[80:83], a[32:35], a[8:11], v[80:83]
ds_read_b64_tr_b16 a[58:59], v12 offset:12800
v_mfma_f32_16x16x32_bf16 v[104:107], a[32:35], a[12:15], v[104:107]
ds_read_b128 a[20:23], v9 offset:26624
v_mfma_f32_16x16x32_bf16 v[36:39], a[36:39], a[0:3], v[36:39]
ds_read_b128 a[24:27], v9 offset:28672
v_mfma_f32_16x16x32_bf16 v[60:63], a[36:39], a[4:7], v[60:63]
ds_read_b128 a[28:31], v9 offset:30720
v_mfma_f32_16x16x32_bf16 v[84:87], a[36:39], a[8:11], v[84:87]
ds_read_b64_tr_b16 a[60:61], v13 offset:12288
v_mfma_f32_16x16x32_bf16 v[108:111], a[36:39], a[12:15], v[108:111]
ds_read_b64_tr_b16 a[62:63], v13 offset:12800
v_mfma_f32_16x16x32_bf16 v[40:43], a[0:3], a[40:43], v[40:43]
ds_read_b64_tr_b16 a[64:65], v12 offset:14336
v_mfma_f32_16x16x32_bf16 v[64:67], a[4:7], a[40:43], v[64:67]
ds_read_b64_tr_b16 a[66:67], v12 offset:14848
v_mfma_f32_16x16x32_bf16 v[88:91], a[8:11], a[40:43], v[88:91]
ds_read_b64_tr_b16 a[68:69], v13 offset:14336
v_mfma_f32_16x16x32_bf16 v[112:115], a[12:15], a[40:43], v[112:115]
ds_read_b64_tr_b16 a[70:71], v13 offset:14848
v_mfma_f32_16x16x32_bf16 v[44:47], a[0:3], a[44:47], v[44:47]
ds_read_b64_tr_b16 a[72:73], v12 offset:16384
v_mfma_f32_16x16x32_bf16 v[68:71], a[4:7], a[44:47], v[68:71]
ds_read_b64_tr_b16 a[74:75], v12 offset:16896
v_mfma_f32_16x16x32_bf16 v[92:95], a[8:11], a[44:47], v[92:95]
ds_read_b64_tr_b16 a[76:77], v13 offset:16384
v_mfma_f32_16x16x32_bf16 v[116:119], a[12:15], a[44:47], v[116:119]
ds_read_b64_tr_b16 a[78:79], v13 offset:16896
v_mfma_f32_16x16x32_bf16 v[48:51], a[0:3], a[48:51], v[48:51]
v_mfma_f32_16x16x32_bf16 v[72:75], a[4:7], a[48:51], v[72:75]
v_mfma_f32_16x16x32_bf16 v[96:99], a[8:11], a[48:51], v[96:99]
v_mfma_f32_16x16x32_bf16 v[120:123], a[12:15], a[48:51], v[120:123]
v_mfma_f32_16x16x32_bf16 v[52:55], a[0:3], a[52:55], v[52:55]
v_mfma_f32_16x16x32_bf16 v[76:79], a[4:7], a[52:55], v[76:79]
v_mfma_f32_16x16x32_bf16 v[100:103], a[8:11], a[52:55], v[100:103]
v_mfma_f32_16x16x32_bf16 v[124:127], a[12:15], a[52:55], v[124:127]
s_waitcnt lgkmcnt(0)
v_mfma_f32_16x16x32_bf16 v[40:43], a[16:19], a[64:67], v[40:43]
s_barrier
ds_read_b128 v[20:23], v17 offset:0
v_mfma_f32_16x16x32_bf16 v[64:67], a[20:23], a[64:67], v[64:67]
ds_read_b128 v[24:27], v17 offset:512
v_mfma_f32_16x16x32_bf16 v[88:91], a[24:27], a[64:67], v[88:91]
ds_read_b32 v6, v18 offset:256
v_mfma_f32_16x16x32_bf16 v[112:115], a[28:31], a[64:67], v[112:115]
ds_read_b32 v8, v18 offset:320
v_mfma_f32_16x16x32_bf16 v[44:47], a[16:19], a[68:71], v[44:47]
ds_read_b32 v10, v18 offset:512
v_mfma_f32_16x16x32_bf16 v[68:71], a[20:23], a[68:71], v[68:71]
ds_read_b32 v18, v18 offset:576
v_mfma_f32_16x16x32_bf16 v[92:95], a[24:27], a[68:71], v[92:95]
v_mov_b32 v19, 161536
ds_read_b32 v19, v19
v_mfma_f32_16x16x32_bf16 v[116:119], a[28:31], a[68:71], v[116:119]
ds_read_b128 v[128:131], v17 offset:64
v_mfma_f32_16x16x32_bf16 v[48:51], a[16:19], a[72:75], v[48:51]
ds_read_b128 v[132:135], v17 offset:576
v_mfma_f32_16x16x32_bf16 v[72:75], a[20:23], a[72:75], v[72:75]
ds_read_b128 v[136:139], v17 offset:128
v_mfma_f32_16x16x32_bf16 v[96:99], a[24:27], a[72:75], v[96:99]
ds_read_b128 v[140:143], v17 offset:640
v_mfma_f32_16x16x32_bf16 v[120:123], a[28:31], a[72:75], v[120:123]
ds_read_b128 v[144:147], v17 offset:192
v_mfma_f32_16x16x32_bf16 v[52:55], a[16:19], a[76:79], v[52:55]
ds_read_b128 v[148:151], v17 offset:704
v_mfma_f32_16x16x32_bf16 v[76:79], a[20:23], a[76:79], v[76:79]
v_mfma_f32_16x16x32_bf16 v[100:103], a[24:27], a[76:79], v[100:103]
v_mfma_f32_16x16x32_bf16 v[124:127], a[28:31], a[76:79], v[124:127]
v_mfma_f32_16x16x32_bf16 v[32:35], a[56:59], a[16:19], v[32:35]
v_mfma_f32_16x16x32_bf16 v[56:59], a[56:59], a[20:23], v[56:59]
v_mfma_f32_16x16x32_bf16 v[80:83], a[56:59], a[24:27], v[80:83]
v_mfma_f32_16x16x32_bf16 v[104:107], a[56:59], a[28:31], v[104:107]
v_mfma_f32_16x16x32_bf16 v[36:39], a[60:63], a[16:19], v[36:39]
v_mfma_f32_16x16x32_bf16 v[60:63], a[60:63], a[20:23], v[60:63]
v_mfma_f32_16x16x32_bf16 v[84:87], a[60:63], a[24:27], v[84:87]
v_mfma_f32_16x16x32_bf16 v[108:111], a[60:63], a[28:31], v[108:111]
s_waitcnt lgkmcnt(0)
v_readfirstlane_b32 s69, v19
s_nop 0
s_and_b32 s61, s69, 0x2000
s_and_b32 s69, s69, 1
s_xor_b32 s88, s88, s61
v_pk_mul_f32 v[28:29], v[24:25], s[90:91]
v_pk_mul_f32 v[30:31], v[26:27], s[90:91]
v_pk_fma_f32 v[40:41], v[20:21], v[6:7], v[40:41] op_sel:[0,0,0] op_sel_hi:[1,0,1]
v_pk_fma_f32 v[44:45], v[20:21], v[8:9], v[44:45] op_sel:[0,0,0] op_sel_hi:[1,0,1]
v_pk_fma_f32 v[42:43], v[22:23], v[6:7], v[42:43] op_sel:[0,0,0] op_sel_hi:[1,0,1]
v_pk_fma_f32 v[46:47], v[22:23], v[8:9], v[46:47] op_sel:[0,0,0] op_sel_hi:[1,0,1]
v_pk_mul_f32 v[2:3], v[40:41], v[28:29]
v_pk_mul_f32 v[12:13], v[44:45], v[28:29]
v_pk_mul_f32 v[4:5], v[42:43], v[30:31]
v_pk_mul_f32 v[14:15], v[46:47], v[30:31]
v_pk_fma_f32 v[40:41], v[40:41], v[24:25], s[82:83]
v_pk_fma_f32 v[44:45], v[44:45], v[24:25], s[82:83]
v_pk_fma_f32 v[42:43], v[42:43], v[26:27], s[82:83]
v_pk_fma_f32 v[46:47], v[46:47], v[26:27], s[82:83]
v_exp_f32_e64 v2, v2 clamp
v_exp_f32_e64 v12, v12 clamp
v_exp_f32_e64 v3, v3 clamp
v_exp_f32_e64 v13, v13 clamp
v_exp_f32_e64 v4, v4 clamp
v_exp_f32_e64 v14, v14 clamp
v_exp_f32_e64 v5, v5 clamp
v_exp_f32_e64 v15, v15 clamp
v_pk_add_f32 v[2:3], v[2:3], s[80:81]
v_pk_add_f32 v[12:13], v[12:13], s[80:81]
v_pk_add_f32 v[4:5], v[4:5], s[80:81]
v_pk_add_f32 v[14:15], v[14:15], s[80:81]
v_max_f32 v40, v40, v2
v_max_f32 v44, v44, v12
v_max_f32 v41, v41, v3
v_max_f32 v45, v45, v13
v_max_f32 v42, v42, v4
v_max_f32 v46, v46, v14
v_max_f32 v43, v43, v5
v_max_f32 v47, v47, v15
v_cvt_pk_bf16_f32 v40, v40, v41
v_cvt_pk_bf16_f32 v44, v44, v45
v_cvt_pk_bf16_f32 v41, v42, v43
v_cvt_pk_bf16_f32 v45, v46, v47
v_pk_fma_f32 v[48:49], v[20:21], v[10:11], v[48:49] op_sel:[0,0,0] op_sel_hi:[1,0,1]
v_pk_fma_f32 v[52:53], v[20:21], v[18:19], v[52:53] op_sel:[0,0,0] op_sel_hi:[1,0,1]
v_pk_fma_f32 v[50:51], v[22:23], v[10:11], v[50:51] op_sel:[0,0,0] op_sel_hi:[1,0,1]
v_pk_fma_f32 v[54:55], v[22:23], v[18:19], v[54:55] op_sel:[0,0,0] op_sel_hi:[1,0,1]
v_pk_mul_f32 v[48:49], v[48:49], v[24:25]
v_pk_mul_f32 v[52:53], v[52:53], v[24:25]
v_pk_mul_f32 v[50:51], v[50:51], v[26:27]
v_pk_mul_f32 v[54:55], v[54:55], v[26:27]
v_cvt_pk_bf16_f32 v48, v48, v49
v_cvt_pk_bf16_f32 v52, v52, v53
v_cvt_pk_bf16_f32 v49, v50, v51
v_cvt_pk_bf16_f32 v53, v54, v55
v_pk_mul_f32 v[28:29], v[132:133], s[90:91]
v_pk_mul_f32 v[30:31], v[134:135], s[90:91]
v_pk_fma_f32 v[64:65], v[128:129], v[6:7], v[64:65] op_sel:[0,0,0] op_sel_hi:[1,0,1]
v_pk_fma_f32 v[68:69], v[128:129], v[8:9], v[68:69] op_sel:[0,0,0] op_sel_hi:[1,0,1]
v_pk_fma_f32 v[66:67], v[130:131], v[6:7], v[66:67] op_sel:[0,0,0] op_sel_hi:[1,0,1]
v_pk_fma_f32 v[70:71], v[130:131], v[8:9], v[70:71] op_sel:[0,0,0] op_sel_hi:[1,0,1]
v_pk_mul_f32 v[2:3], v[64:65], v[28:29]
v_pk_mul_f32 v[12:13], v[68:69], v[28:29]
v_pk_mul_f32 v[4:5], v[66:67], v[30:31]
v_pk_mul_f32 v[14:15], v[70:71], v[30:31]
v_pk_fma_f32 v[64:65], v[64:65], v[132:133], s[82:83]
v_pk_fma_f32 v[68:69], v[68:69], v[132:133], s[82:83]
v_pk_fma_f32 v[66:67], v[66:67], v[134:135], s[82:83]
v_pk_fma_f32 v[70:71], v[70:71], v[134:135], s[82:83]
v_exp_f32_e64 v2, v2 clamp
v_exp_f32_e64 v12, v12 clamp
v_exp_f32_e64 v3, v3 clamp
s_branch L_over5
L_pad5:
s_branch L_ret9
L_over5:
v_exp_f32_e64 v13, v13 clamp
v_exp_f32_e64 v4, v4 clamp
v_exp_f32_e64 v14, v14 clamp
v_exp_f32_e64 v5, v5 clamp
v_exp_f32_e64 v15, v15 clamp
v_pk_add_f32 v[2:3], v[2:3], s[80:81]
v_pk_add_f32 v[12:13], v[12:13], s[80:81]
v_pk_add_f32 v[4:5], v[4:5], s[80:81]
v_pk_add_f32 v[14:15], v[14:15], s[80:81]
v_max_f32 v64, v64, v2
v_max_f32 v68, v68, v12
v_max_f32 v65, v65, v3
v_max_f32 v69, v69, v13
v_max_f32 v66, v66, v4
v_max_f32 v70, v70, v14
v_max_f32 v67, v67, v5
v_max_f32 v71, v71, v15
v_cvt_pk_bf16_f32 v42, v64, v65
v_cvt_pk_bf16_f32 v46, v68, v69
v_cvt_pk_bf16_f32 v43, v66, v67
v_cvt_pk_bf16_f32 v47, v70, v71
v_pk_fma_f32 v[72:73], v[128:129], v[10:11], v[72:73] op_sel:[0,0,0] op_sel_hi:[1,0,1]
v_pk_fma_f32 v[76:77], v[128:129], v[18:19], v[76:77] op_sel:[0,0,0] op_sel_hi:[1,0,1]
v_pk_fma_f32 v[74:75], v[130:131], v[10:11], v[74:75] op_sel:[0,0,0] op_sel_hi:[1,0,1]
v_pk_fma_f32 v[78:79], v[130:131], v[18:19], v[78:79] op_sel:[0,0,0] op_sel_hi:[1,0,1]
v_pk_mul_f32 v[72:73], v[72:73], v[132:133]
v_pk_mul_f32 v[76:77], v[76:77], v[132:133]
v_pk_mul_f32 v[74:75], v[74:75], v[134:135]
v_pk_mul_f32 v[78:79], v[78:79], v[134:135]
v_cvt_pk_bf16_f32 v50, v72, v73
v_cvt_pk_bf16_f32 v54, v76, v77
v_cvt_pk_bf16_f32 v51, v74, v75
v_cvt_pk_bf16_f32 v55, v78, v79
s_nop 0
v_mfma_f32_16x16x32_bf16 v[64:67], v[40:43], v[48:51], 0
v_mfma_f32_16x16x32_bf16 v[68:71], v[40:43], v[52:55], 0
v_mfma_f32_16x16x32_bf16 v[20:23], v[40:43], a[80:83], 0
v_mfma_f32_16x16x32_bf16 v[72:75], v[44:47], v[48:51], 0
v_mfma_f32_16x16x32_bf16 v[76:79], v[44:47], v[52:55], 0
v_mfma_f32_16x16x32_bf16 v[24:27], v[44:47], a[80:83], 0
v_pk_mul_f32 v[28:29], v[140:141], s[90:91]
v_pk_mul_f32 v[30:31], v[142:143], s[90:91]
v_pk_fma_f32 v[88:89], v[136:137], v[6:7], v[88:89] op_sel:[0,0,0] op_sel_hi:[1,0,1]
v_pk_fma_f32 v[92:93], v[136:137], v[8:9], v[92:93] op_sel:[0,0,0] op_sel_hi:[1,0,1]
v_pk_fma_f32 v[90:91], v[138:139], v[6:7], v[90:91] op_sel:[0,0,0] op_sel_hi:[1,0,1]
v_pk_fma_f32 v[94:95], v[138:139], v[8:9], v[94:95] op_sel:[0,0,0] op_sel_hi:[1,0,1]
v_pk_mul_f32 v[2:3], v[88:89], v[28:29]
v_pk_mul_f32 v[12:13], v[92:93], v[28:29]
v_pk_mul_f32 v[4:5], v[90:91], v[30:31]
v_pk_mul_f32 v[14:15], v[94:95], v[30:31]
v_pk_fma_f32 v[88:89], v[88:89], v[140:141], s[82:83]
v_pk_fma_f32 v[92:93], v[92:93], v[140:141], s[82:83]
v_pk_fma_f32 v[90:91], v[90:91], v[142:143], s[82:83]
v_pk_fma_f32 v[94:95], v[94:95], v[142:143], s[82:83]
v_exp_f32_e64 v2, v2 clamp
v_exp_f32_e64 v12, v12 clamp
v_exp_f32_e64 v3, v3 clamp
v_exp_f32_e64 v13, v13 clamp
v_exp_f32_e64 v4, v4 clamp
v_exp_f32_e64 v14, v14 clamp
v_exp_f32_e64 v5, v5 clamp
v_exp_f32_e64 v15, v15 clamp
v_pk_add_f32 v[2:3], v[2:3], s[80:81]
v_pk_add_f32 v[12:13], v[12:13], s[80:81]
v_pk_add_f32 v[4:5], v[4:5], s[80:81]
v_pk_add_f32 v[14:15], v[14:15], s[80:81]
v_max_f32 v88, v88, v2
v_max_f32 v92, v92, v12
v_max_f32 v89, v89, v3
v_max_f32 v93, v93, v13
v_max_f32 v90, v90, v4
v_max_f32 v94, v94, v14
v_max_f32 v91, v91, v5
v_max_f32 v95, v95, v15
v_cvt_pk_bf16_f32 v88, v88, v89
v_cvt_pk_bf16_f32 v92, v92, v93
v_cvt_pk_bf16_f32 v89, v90, v91
v_cvt_pk_bf16_f32 v93, v94, v95
v_pk_fma_f32 v[96:97], v[136:137], v[10:11], v[96:97] op_sel:[0,0,0] op_sel_hi:[1,0,1]
v_pk_fma_f32 v[100:101], v[136:137], v[18:19], v[100:101] op_sel:[0,0,0] op_sel_hi:[1,0,1]
v_pk_fma_f32 v[98:99], v[138:139], v[10:11], v[98:99] op_sel:[0,0,0] op_sel_hi:[1,0,1]
v_pk_fma_f32 v[102:103], v[138:139], v[18:19], v[102:103] op_sel:[0,0,0] op_sel_hi:[1,0,1]
v_pk_mul_f32 v[96:97], v[96:97], v[140:141]
v_pk_mul_f32 v[100:101], v[100:101], v[140:141]
v_pk_mul_f32 v[98:99], v[98:99], v[142:143]
v_pk_mul_f32 v[102:103], v[102:103], v[142:143]
v_cvt_pk_bf16_f32 v96, v96, v97
v_cvt_pk_bf16_f32 v100, v100, v101
v_cvt_pk_bf16_f32 v97, v98, v99
v_cvt_pk_bf16_f32 v101, v102, v103
v_pk_mul_f32 v[28:29], v[148:149], s[90:91]
v_pk_mul_f32 v[30:31], v[150:151], s[90:91]
v_pk_fma_f32 v[112:113], v[144:145], v[6:7], v[112:113] op_sel:[0,0,0] op_sel_hi:[1,0,1]
v_pk_fma_f32 v[116:117], v[144:145], v[8:9], v[116:117] op_sel:[0,0,0] op_sel_hi:[1,0,1]
v_pk_fma_f32 v[114:115], v[146:147], v[6:7], v[114:115] op_sel:[0,0,0] op_sel_hi:[1,0,1]
v_pk_fma_f32 v[118:119], v[146:147], v[8:9], v[118:119] op_sel:[0,0,0] op_sel_hi:[1,0,1]
v_pk_mul_f32 v[2:3], v[112:113], v[28:29]
v_pk_mul_f32 v[12:13], v[116:117], v[28:29]
v_pk_mul_f32 v[4:5], v[114:115], v[30:31]
v_pk_mul_f32 v[14:15], v[118:119], v[30:31]
v_pk_fma_f32 v[112:113], v[112:113], v[148:149], s[82:83]
v_pk_fma_f32 v[116:117], v[116:117], v[148:149], s[82:83]
v_pk_fma_f32 v[114:115], v[114:115], v[150:151], s[82:83]
v_pk_fma_f32 v[118:119], v[118:119], v[150:151], s[82:83]
v_exp_f32_e64 v2, v2 clamp
v_exp_f32_e64 v12, v12 clamp
v_exp_f32_e64 v3, v3 clamp
v_exp_f32_e64 v13, v13 clamp
v_exp_f32_e64 v4, v4 clamp
v_exp_f32_e64 v14, v14 clamp
v_exp_f32_e64 v5, v5 clamp
v_exp_f32_e64 v15, v15 clamp
v_pk_add_f32 v[2:3], v[2:3], s[80:81]
v_pk_add_f32 v[12:13], v[12:13], s[80:81]
v_pk_add_f32 v[4:5], v[4:5], s[80:81]
v_pk_add_f32 v[14:15], v[14:15], s[80:81]
v_max_f32 v112, v112, v2
v_max_f32 v116, v116, v12
v_max_f32 v113, v113, v3
v_max_f32 v117, v117, v13
v_max_f32 v114, v114, v4
v_max_f32 v118, v118, v14
v_max_f32 v115, v115, v5
v_max_f32 v119, v119, v15
v_cvt_pk_bf16_f32 v90, v112, v113
v_cvt_pk_bf16_f32 v94, v116, v117
v_cvt_pk_bf16_f32 v91, v114, v115
v_cvt_pk_bf16_f32 v95, v118, v119
v_pk_fma_f32 v[120:121], v[144:145], v[10:11], v[120:121] op_sel:[0,0,0] op_sel_hi:[1,0,1]
v_pk_fma_f32 v[124:125], v[144:145], v[18:19], v[124:125] op_sel:[0,0,0] op_sel_hi:[1,0,1]
v_pk_fma_f32 v[122:123], v[146:147], v[10:11], v[122:123] op_sel:[0,0,0] op_sel_hi:[1,0,1]
v_pk_fma_f32 v[126:127], v[146:147], v[18:19], v[126:127] op_sel:[0,0,0] op_sel_hi:[1,0,1]
v_pk_mul_f32 v[120:121], v[120:121], v[148:149]
v_pk_mul_f32 v[124:125], v[124:125], v[148:149]
v_pk_mul_f32 v[122:123], v[122:123], v[150:151]
v_pk_mul_f32 v[126:127], v[126:127], v[150:151]
v_cvt_pk_bf16_f32 v98, v120, v121
v_cvt_pk_bf16_f32 v102, v124, v125
v_cvt_pk_bf16_f32 v99, v122, v123
v_cvt_pk_bf16_f32 v103, v126, v127
s_nop 0
v_mfma_f32_16x16x32_bf16 v[64:67], v[88:91], v[96:99], v[64:67]
v_mfma_f32_16x16x32_bf16 v[68:71], v[88:91], v[100:103], v[68:71]
v_mfma_f32_16x16x32_bf16 v[20:23], v[88:91], a[80:83], v[20:23]
v_mfma_f32_16x16x32_bf16 v[72:75], v[92:95], v[96:99], v[72:75]
v_mfma_f32_16x16x32_bf16 v[76:79], v[92:95], v[100:103], v[76:79]
v_mfma_f32_16x16x32_bf16 v[24:27], v[92:95], a[80:83], v[24:27]
s_lshl_b32 s70, s60, 11
s_add_u32 s70, s70, 16384
v_add_u32 v2, s70, v16
v_xor_b32 v3, 4096, v2
v_lshrrev_b32 v4, 4, v1
v_lshlrev_b32 v5, 4, v4
v_lshlrev_b32 v4, 5, v4
s_lshl_b32 s70, s60, 6
s_add_u32 s70, s70, 163584
v_add_u32 v5, s70, v5
v_xor_b32 v6, 128, v5
s_lshl_b32 s72, s67, 1
s_add_u32 s72, s72, s66
s_lshl_b32 s72, s72, 10
s_add_u32 s72, s72, s87
s_lshl_b32 s73, s67, 7
s_lshl_b32 s70, s66, 4
s_add_u32 s73, s73, s70
s_add_u32 s73, s73, s87
s_add_u32 s73, s73, 4096
s_mov_b32 s92, 0x00010001
s_mov_b32 s93, 0x00010001
v_mov_b32 v15, s68
s_cmp_eq_u32 s66, 0
s_cbranch_scc0 L_ex1
ds_write_b128 v2, v[68:71]
ds_write_b128 v2, v[76:79] offset:1024
ds_write_b128 v5, v[24:27]
s_waitcnt lgkmcnt(0)
s_barrier
ds_read_b128 v[128:131], v3
ds_read_b128 v[132:135], v3 offset:1024
ds_read_b128 v[136:139], v6
s_waitcnt lgkmcnt(1)
v_pk_add_f32 v[128:129], v[128:129], v[64:65]
v_pk_add_f32 v[130:131], v[130:131], v[66:67]
v_pk_add_f32 v[132:133], v[132:133], v[72:73]
v_pk_add_f32 v[134:135], v[134:135], v[74:75]
s_waitcnt lgkmcnt(0)
v_pk_add_f32 v[136:137], v[136:137], v[20:21]
v_pk_add_f32 v[138:139], v[138:139], v[22:23]
s_branch L_ex_d
L_ex1:
ds_write_b128 v2, v[64:67]
ds_write_b128 v2, v[72:75] offset:1024
ds_write_b128 v5, v[20:23]
s_waitcnt lgkmcnt(0)
s_barrier
ds_read_b128 v[128:131], v3
ds_read_b128 v[132:135], v3 offset:1024
ds_read_b128 v[136:139], v6
s_waitcnt lgkmcnt(1)
v_pk_add_f32 v[128:129], v[128:129], v[68:69]
v_pk_add_f32 v[130:131], v[130:131], v[70:71]
v_pk_add_f32 v[132:133], v[132:133], v[76:77]
v_pk_add_f32 v[134:135], v[134:135], v[78:79]
s_waitcnt lgkmcnt(0)
v_pk_add_f32 v[136:137], v[136:137], v[24:25]
v_pk_add_f32 v[138:139], v[138:139], v[26:27]
L_ex_d:
v_cvt_pk_bf16_f32 v140, v128, v129
v_cvt_pk_bf16_f32 v141, v130, v131
v_cvt_pk_bf16_f32 v142, v132, v133
v_cvt_pk_bf16_f32 v143, v134, v135
v_bfi_b32 v136, s85, v15, v136
v_bfi_b32 v137, s85, v15, v137
v_bfi_b32 v138, s85, v15, v138
v_bfi_b32 v139, s85, v15, v139
s_cmp_eq_u32 s69, 0
s_cbranch_scc1 L_kvp_s
buffer_store_dwordx4 v[140:143], v16, s[12:15], s72 offen
s_mov_b64 exec, s[92:93]
buffer_store_dwordx4 v[136:139], v4, s[12:15], s73 offen
s_mov_b64 exec, -1
L_kvp_d:
s_barrier
v_and_b32 v2, 15, v1
v_lshlrev_b32 v2, 2, v2
s_lshl_b32 s70, s66, 8
s_add_u32 s70, s70, 159744
v_add_u32 v2, s70, v2
v_lshrrev_b32 v3, 4, v1
v_lshlrev_b32 v3, 4, v3
s_lshl_b32 s70, s67, 7
s_add_u32 s70, s70, 160768
v_add_u32 v5, s70, v3
ds_read_b32 v8, v2 offset:0
ds_read_b32 v128, v2 offset:512
ds_read_b32 v10, v2 offset:64
ds_read_b32 v130, v2 offset:576
ds_read_b32 v12, v2 offset:128
ds_read_b32 v132, v2 offset:640
ds_read_b32 v14, v2 offset:192
ds_read_b32 v134, v2 offset:704
ds_read_b128 v[144:147], v5 offset:0
ds_read_b128 v[148:151], v5 offset:64
s_lshl_b32 s70, s67, 11
s_add_u32 s70, s70, 24576
v_add_u32 v17, s70, v16
s_lshl_b32 s70, s67, 6
s_add_u32 s70, s70, 161600
v_add_u32 v18, s70, v3
s_waitcnt lgkmcnt(0)
v_mul_f32 v20, s90, v128
v_mul_f32 v22, s90, v130
v_mul_f32 v4, s90, v132
v_mul_f32 v6, s90, v134
v_pk_fma_f32 v[32:33], v[144:145], v[8:9], v[32:33] op_sel:[0,0,0] op_sel_hi:[1,0,1]
v_pk_fma_f32 v[36:37], v[148:149], v[8:9], v[36:37] op_sel:[0,0,0] op_sel_hi:[1,0,1]
v_pk_fma_f32 v[34:35], v[146:147], v[8:9], v[34:35] op_sel:[0,0,0] op_sel_hi:[1,0,1]
v_pk_fma_f32 v[38:39], v[150:151], v[8:9], v[38:39] op_sel:[0,0,0] op_sel_hi:[1,0,1]
v_pk_mul_f32 v[24:25], v[32:33], v[20:21] op_sel:[0,0] op_sel_hi:[1,0]
v_pk_mul_f32 v[28:29], v[36:37], v[20:21] op_sel:[0,0] op_sel_hi:[1,0]
v_pk_mul_f32 v[26:27], v[34:35], v[20:21] op_sel:[0,0] op_sel_hi:[1,0]
v_pk_mul_f32 v[30:31], v[38:39], v[20:21] op_sel:[0,0] op_sel_hi:[1,0]
v_pk_fma_f32 v[32:33], v[32:33], v[128:129], s[82:83] op_sel:[0,0,0] op_sel_hi:[1,0,1]
v_pk_fma_f32 v[36:37], v[36:37], v[128:129], s[82:83] op_sel:[0,0,0] op_sel_hi:[1,0,1]
v_pk_fma_f32 v[34:35], v[34:35], v[128:129], s[82:83] op_sel:[0,0,0] op_sel_hi:[1,0,1]
v_pk_fma_f32 v[38:39], v[38:39], v[128:129], s[82:83] op_sel:[0,0,0] op_sel_hi:[1,0,1]
v_exp_f32_e64 v24, v24 clamp
v_exp_f32_e64 v28, v28 clamp
v_exp_f32_e64 v25, v25 clamp
v_exp_f32_e64 v29, v29 clamp
v_exp_f32_e64 v26, v26 clamp
v_exp_f32_e64 v30, v30 clamp
v_exp_f32_e64 v27, v27 clamp
v_exp_f32_e64 v31, v31 clamp
v_pk_add_f32 v[24:25], v[24:25], s[80:81]
v_pk_add_f32 v[28:29], v[28:29], s[80:81]
v_pk_add_f32 v[26:27], v[26:27], s[80:81]
v_pk_add_f32 v[30:31], v[30:31], s[80:81]
v_max_f32 v32, v32, v24
v_max_f32 v36, v36, v28
v_max_f32 v33, v33, v25
v_max_f32 v37, v37, v29
v_max_f32 v34, v34, v26
v_max_f32 v38, v38, v30
v_max_f32 v35, v35, v27
v_max_f32 v39, v39, v31
v_cvt_pk_bf16_f32 v32, v32, v33
v_cvt_pk_bf16_f32 v33, v34, v35
v_cvt_pk_bf16_f32 v34, v36, v37
v_cvt_pk_bf16_f32 v35, v38, v39
v_pk_fma_f32 v[56:57], v[144:145], v[10:11], v[56:57] op_sel:[0,0,0] op_sel_hi:[1,0,1]
v_pk_fma_f32 v[60:61], v[148:149], v[10:11], v[60:61] op_sel:[0,0,0] op_sel_hi:[1,0,1]
v_pk_fma_f32 v[58:59], v[146:147], v[10:11], v[58:59] op_sel:[0,0,0] op_sel_hi:[1,0,1]
v_pk_fma_f32 v[62:63], v[150:151], v[10:11], v[62:63] op_sel:[0,0,0] op_sel_hi:[1,0,1]
v_pk_mul_f32 v[24:25], v[56:57], v[22:23] op_sel:[0,0] op_sel_hi:[1,0]
v_pk_mul_f32 v[28:29], v[60:61], v[22:23] op_sel:[0,0] op_sel_hi:[1,0]
v_pk_mul_f32 v[26:27], v[58:59], v[22:23] op_sel:[0,0] op_sel_hi:[1,0]
v_pk_mul_f32 v[30:31], v[62:63], v[22:23] op_sel:[0,0] op_sel_hi:[1,0]
v_pk_fma_f32 v[56:57], v[56:57], v[130:131], s[82:83] op_sel:[0,0,0] op_sel_hi:[1,0,1]
v_pk_fma_f32 v[60:61], v[60:61], v[130:131], s[82:83] op_sel:[0,0,0] op_sel_hi:[1,0,1]
v_pk_fma_f32 v[58:59], v[58:59], v[130:131], s[82:83] op_sel:[0,0,0] op_sel_hi:[1,0,1]
v_pk_fma_f32 v[62:63], v[62:63], v[130:131], s[82:83] op_sel:[0,0,0] op_sel_hi:[1,0,1]
v_exp_f32_e64 v24, v24 clamp
v_exp_f32_e64 v28, v28 clamp
v_exp_f32_e64 v25, v25 clamp
v_exp_f32_e64 v29, v29 clamp
v_exp_f32_e64 v26, v26 clamp
v_exp_f32_e64 v30, v30 clamp
v_exp_f32_e64 v27, v27 clamp
v_exp_f32_e64 v31, v31 clamp
v_pk_add_f32 v[24:25], v[24:25], s[80:81]
v_pk_add_f32 v[28:29], v[28:29], s[80:81]
v_pk_add_f32 v[26:27], v[26:27], s[80:81]
v_pk_add_f32 v[30:31], v[30:31], s[80:81]
v_max_f32 v56, v56, v24
v_max_f32 v60, v60, v28
v_max_f32 v57, v57, v25
v_max_f32 v61, v61, v29
v_max_f32 v58, v58, v26
v_max_f32 v62, v62, v30
v_max_f32 v59, v59, v27
v_max_f32 v63, v63, v31
v_cvt_pk_bf16_f32 v56, v56, v57
v_cvt_pk_bf16_f32 v57, v58, v59
v_cvt_pk_bf16_f32 v58, v60, v61
v_cvt_pk_bf16_f32 v59, v62, v63
v_pk_fma_f32 v[80:81], v[144:145], v[12:13], v[80:81] op_sel:[0,0,0] op_sel_hi:[1,0,1]
v_pk_fma_f32 v[84:85], v[148:149], v[12:13], v[84:85] op_sel:[0,0,0] op_sel_hi:[1,0,1]
v_pk_fma_f32 v[82:83], v[146:147], v[12:13], v[82:83] op_sel:[0,0,0] op_sel_hi:[1,0,1]
v_pk_fma_f32 v[86:87], v[150:151], v[12:13], v[86:87] op_sel:[0,0,0] op_sel_hi:[1,0,1]
v_pk_mul_f32 v[24:25], v[80:81], v[4:5] op_sel:[0,0] op_sel_hi:[1,0]
v_pk_mul_f32 v[28:29], v[84:85], v[4:5] op_sel:[0,0] op_sel_hi:[1,0]
v_pk_mul_f32 v[26:27], v[82:83], v[4:5] op_sel:[0,0] op_sel_hi:[1,0]
v_pk_mul_f32 v[30:31], v[86:87], v[4:5] op_sel:[0,0] op_sel_hi:[1,0]
v_pk_fma_f32 v[80:81], v[80:81], v[132:133], s[82:83] op_sel:[0,0,0] op_sel_hi:[1,0,1]
v_pk_fma_f32 v[84:85], v[84:85], v[132:133], s[82:83] op_sel:[0,0,0] op_sel_hi:[1,0,1]
v_pk_fma_f32 v[82:83], v[82:83], v[132:133], s[82:83] op_sel:[0,0,0] op_sel_hi:[1,0,1]
v_pk_fma_f32 v[86:87], v[86:87], v[132:133], s[82:83] op_sel:[0,0,0] op_sel_hi:[1,0,1]
v_exp_f32_e64 v24, v24 clamp
v_exp_f32_e64 v28, v28 clamp
v_exp_f32_e64 v25, v25 clamp
v_exp_f32_e64 v29, v29 clamp
v_exp_f32_e64 v26, v26 clamp
v_exp_f32_e64 v30, v30 clamp
v_exp_f32_e64 v27, v27 clamp
v_exp_f32_e64 v31, v31 clamp
v_pk_add_f32 v[24:25], v[24:25], s[80:81]
v_pk_add_f32 v[28:29], v[28:29], s[80:81]
v_pk_add_f32 v[26:27], v[26:27], s[80:81]
v_pk_add_f32 v[30:31], v[30:31], s[80:81]
v_max_f32 v80, v80, v24
v_max_f32 v84, v84, v28
v_max_f32 v81, v81, v25
v_max_f32 v85, v85, v29
v_max_f32 v82, v82, v26
v_max_f32 v86, v86, v30
v_max_f32 v83, v83, v27
v_max_f32 v87, v87, v31
v_cvt_pk_bf16_f32 v80, v80, v81
v_cvt_pk_bf16_f32 v81, v82, v83
v_cvt_pk_bf16_f32 v82, v84, v85
v_cvt_pk_bf16_f32 v83, v86, v87
v_pk_fma_f32 v[104:105], v[144:145], v[14:15], v[104:105] op_sel:[0,0,0] op_sel_hi:[1,0,1]
v_pk_fma_f32 v[108:109], v[148:149], v[14:15], v[108:109] op_sel:[0,0,0] op_sel_hi:[1,0,1]
v_pk_fma_f32 v[106:107], v[146:147], v[14:15], v[106:107] op_sel:[0,0,0] op_sel_hi:[1,0,1]
v_pk_fma_f32 v[110:111], v[150:151], v[14:15], v[110:111] op_sel:[0,0,0] op_sel_hi:[1,0,1]
v_pk_mul_f32 v[24:25], v[104:105], v[6:7] op_sel:[0,0] op_sel_hi:[1,0]
v_pk_mul_f32 v[28:29], v[108:109], v[6:7] op_sel:[0,0] op_sel_hi:[1,0]
v_pk_mul_f32 v[26:27], v[106:107], v[6:7] op_sel:[0,0] op_sel_hi:[1,0]
v_pk_mul_f32 v[30:31], v[110:111], v[6:7] op_sel:[0,0] op_sel_hi:[1,0]
v_pk_fma_f32 v[104:105], v[104:105], v[134:135], s[82:83] op_sel:[0,0,0] op_sel_hi:[1,0,1]
v_pk_fma_f32 v[108:109], v[108:109], v[134:135], s[82:83] op_sel:[0,0,0] op_sel_hi:[1,0,1]
v_pk_fma_f32 v[106:107], v[106:107], v[134:135], s[82:83] op_sel:[0,0,0] op_sel_hi:[1,0,1]
v_pk_fma_f32 v[110:111], v[110:111], v[134:135], s[82:83] op_sel:[0,0,0] op_sel_hi:[1,0,1]
v_exp_f32_e64 v24, v24 clamp
v_exp_f32_e64 v28, v28 clamp
v_exp_f32_e64 v25, v25 clamp
v_exp_f32_e64 v29, v29 clamp
v_exp_f32_e64 v26, v26 clamp
v_exp_f32_e64 v30, v30 clamp
v_exp_f32_e64 v27, v27 clamp
v_exp_f32_e64 v31, v31 clamp
v_pk_add_f32 v[24:25], v[24:25], s[80:81]
v_pk_add_f32 v[28:29], v[28:29], s[80:81]
v_pk_add_f32 v[26:27], v[26:27], s[80:81]
v_pk_add_f32 v[30:31], v[30:31], s[80:81]
v_max_f32 v104, v104, v24
v_max_f32 v108, v108, v28
v_max_f32 v105, v105, v25
v_max_f32 v109, v109, v29
v_max_f32 v106, v106, v26
v_max_f32 v110, v110, v30
v_max_f32 v107, v107, v27
v_max_f32 v111, v111, v31
v_cvt_pk_bf16_f32 v104, v104, v105
v_cvt_pk_bf16_f32 v105, v106, v107
v_cvt_pk_bf16_f32 v106, v108, v109
v_cvt_pk_bf16_f32 v107, v110, v111
v_lshrrev_b32 v2, 4, v1
v_bfe_u32 v3, v1, 2, 2
v_lshl_add_u32 v4, v2, 2, v3
v_lshlrev_b32 v5, 7, v4
v_bfe_u32 v4, v4, 1, 2
v_lshl_add_u32 v5, v4, 5, v5
v_and_b32 v4, 3, v1
v_lshl_add_u32 v5, v4, 3, v5
v_add_u32 v8, 28672, v5
v_xor_b32 v9, 32, v8
v_xor_b32 v10, 64, v8
v_xor_b32 v11, 96, v8
v_add_u32 v12, 65536, v8
v_add_u32 v13, 65536, v9
v_add_u32 v14, 65536, v10
v_add_u32 v15, 65536, v11
v_and_b32 v3, 15, v1
v_lshrrev_b32 v4, 1, v3
v_lshrrev_b32 v5, 1, v2
v_xor_b32 v4, v4, v5
v_lshlrev_b32 v4, 4, v4
v_lshl_add_u32 v4, v3, 7, v4
v_and_b32 v5, 1, v2
v_lshl_add_u32 v4, v5, 3, v4
s_lshl_b32 s70, s60, 12
v_add_u32 v20, s70, v4
v_xor_b32 v21, 32, v20
v_xor_b32 v22, 64, v20
v_xor_b32 v23, 96, v20
s_and_b32 s74, s64, 7
s_lshl_b32 s74, s74, 19
s_lshr_b32 s70, s64, 1
s_xor_b32 s70, s70, s64
s_and_b32 s70, s70, 4
s_lshl_b32 s70, s70, 11
s_xor_b32 s70, s70, 2105344
s_add_u32 s74, s74, s70
s_mul_i32 s70, s60, 131072
s_add_u32 s74, s74, s70
s_xor_b32 s74, s74, s61
v_add_u32 v6, s74, v16
v_add_u32 v19, 65536, v6
s_and_b32 s70, s89, 12
s_add_u32 s74, s89, s70
s_lshl_b32 s74, s74, 11
s_mov_b32 s24, s74
s_add_u32 s25, s24, 10240
s_bitcmp1_b32 s25, 13
s_cselect_b32 s70, 8192, 0
s_sub_u32 s25, s25, s70
s_and_b32 s25, s25, 65535
s_add_u32 s26, s25, 10240
s_bitcmp1_b32 s26, 13
s_cselect_b32 s70, 8192, 0
s_sub_u32 s26, s26, s70
s_and_b32 s26, s26, 65535
s_add_u32 s27, s26, 10240
s_bitcmp1_b32 s27, 13
s_cselect_b32 s70, 8192, 0
s_sub_u32 s27, s27, s70
s_and_b32 s27, s27, 65535
s_add_u32 s28, s27, 10240
s_bitcmp1_b32 s28, 13
s_cselect_b32 s70, 8192, 0
s_sub_u32 s28, s28, s70
s_and_b32 s28, s28, 65535
s_add_u32 s29, s28, 10240
s_bitcmp1_b32 s29, 13
s_cselect_b32 s70, 8192, 0
s_sub_u32 s29, s29, s70
s_and_b32 s29, s29, 65535
s_add_u32 s30, s29, 10240
s_bitcmp1_b32 s30, 13
s_cselect_b32 s70, 8192, 0
s_sub_u32 s30, s30, s70
s_and_b32 s30, s30, 65535
s_add_u32 s31, s30, 10240
s_bitcmp1_b32 s31, 13
s_cselect_b32 s70, 8192, 0
s_sub_u32 s31, s31, s70
s_and_b32 s31, s31, 65535
s_add_u32 s32, s31, 10240
s_bitcmp1_b32 s32, 13
s_cselect_b32 s70, 8192, 0
s_sub_u32 s32, s32, s70
s_and_b32 s32, s32, 65535
s_add_u32 s33, s32, 10240
s_bitcmp1_b32 s33, 13
s_cselect_b32 s70, 8192, 0
s_sub_u32 s33, s33, s70
s_and_b32 s33, s33, 65535
s_add_u32 s34, s33, 10240
s_bitcmp1_b32 s34, 13
s_cselect_b32 s70, 8192, 0
s_sub_u32 s34, s34, s70
s_and_b32 s34, s34, 65535
s_add_u32 s35, s34, 10240
s_bitcmp1_b32 s35, 13
s_cselect_b32 s70, 8192, 0
s_sub_u32 s35, s35, s70
s_and_b32 s35, s35, 65535
s_add_u32 s36, s35, 10240
s_bitcmp1_b32 s36, 13
s_cselect_b32 s70, 8192, 0
s_sub_u32 s36, s36, s70
s_and_b32 s36, s36, 65535
s_add_u32 s37, s36, 10240
s_bitcmp1_b32 s37, 13
s_cselect_b32 s70, 8192, 0
s_sub_u32 s37, s37, s70
s_and_b32 s37, s37, 65535
s_add_u32 s38, s37, 10240
s_bitcmp1_b32 s38, 13
s_cselect_b32 s70, 8192, 0
s_sub_u32 s38, s38, s70
s_and_b32 s38, s38, 65535
s_add_u32 s39, s38, 10240
s_bitcmp1_b32 s39, 13
s_cselect_b32 s70, 8192, 0
s_sub_u32 s39, s39, s70
s_and_b32 s39, s39, 65535
s_barrier
ds_read_b128 a[0:3], v17
ds_read_b128 a[4:7], v17 offset:1024
ds_read_b128 a[8:11], v18
s_waitcnt lgkmcnt(0)
v_mfma_f32_16x16x32_bf16 v[48:51], a[8:11], v[32:35], 0
v_mfma_f32_16x16x32_bf16 v[40:43], a[0:3], v[32:35], 0
v_mfma_f32_16x16x32_bf16 v[44:47], a[4:7], v[32:35], 0
v_mfma_f32_16x16x32_bf16 v[72:75], a[8:11], v[56:59], 0
v_mfma_f32_16x16x32_bf16 v[64:67], a[0:3], v[56:59], 0
v_mfma_f32_16x16x32_bf16 v[68:71], a[4:7], v[56:59], 0
v_mfma_f32_16x16x32_bf16 v[96:99], a[8:11], v[80:83], 0
v_mfma_f32_16x16x32_bf16 v[88:91], a[0:3], v[80:83], 0
v_mfma_f32_16x16x32_bf16 v[92:95], a[4:7], v[80:83], 0
v_mfma_f32_16x16x32_bf16 v[120:123], a[8:11], v[104:107], 0
v_mfma_f32_16x16x32_bf16 v[112:115], a[0:3], v[104:107], 0
v_mfma_f32_16x16x32_bf16 v[116:119], a[4:7], v[104:107], 0
s_lshr_b32 s71, s65, 1
s_xor_b32 s71, s71, s62
s_xor_b32 s70, s69, 1
s_or_b32 s71, s71, s70
v_add_f32 v48, s80, v48
v_rcp_f32 v48, v48
s_nop 0
v_pk_mul_f32 v[40:41], v[40:41], v[48:49] op_sel_hi:[1,0]
v_pk_mul_f32 v[42:43], v[42:43], v[48:49] op_sel_hi:[1,0]
v_pk_mul_f32 v[44:45], v[44:45], v[48:49] op_sel_hi:[1,0]
v_pk_mul_f32 v[46:47], v[46:47], v[48:49] op_sel_hi:[1,0]
v_cvt_pk_bf16_f32 v52, v40, v41
v_cvt_pk_bf16_f32 v53, v42, v43
v_cvt_pk_bf16_f32 v54, v44, v45
v_cvt_pk_bf16_f32 v55, v46, v47
s_add_u32 s70, s88, 0
s_cmp_eq_u32 s71, 0
s_cbranch_scc1 L_oown0
buffer_store_dwordx4 v[52:55], v16, s[12:15], s70 offen sc1
L_ood0:
v_add_f32 v72, s80, v72
v_rcp_f32 v72, v72
s_nop 0
v_pk_mul_f32 v[64:65], v[64:65], v[72:73] op_sel_hi:[1,0]
v_pk_mul_f32 v[66:67], v[66:67], v[72:73] op_sel_hi:[1,0]
v_pk_mul_f32 v[68:69], v[68:69], v[72:73] op_sel_hi:[1,0]
v_pk_mul_f32 v[70:71], v[70:71], v[72:73] op_sel_hi:[1,0]
v_cvt_pk_bf16_f32 v76, v64, v65
v_cvt_pk_bf16_f32 v77, v66, v67
v_cvt_pk_bf16_f32 v78, v68, v69
v_cvt_pk_bf16_f32 v79, v70, v71
s_add_u32 s70, s88, 65536
s_cmp_eq_u32 s71, 0
s_cbranch_scc1 L_oown1
buffer_store_dwordx4 v[76:79], v16, s[12:15], s70 offen sc1
L_ood1:
v_add_f32 v96, s80, v96
v_rcp_f32 v96, v96
s_nop 0
v_pk_mul_f32 v[88:89], v[88:89], v[96:97] op_sel_hi:[1,0]
v_pk_mul_f32 v[90:91], v[90:91], v[96:97] op_sel_hi:[1,0]
v_pk_mul_f32 v[92:93], v[92:93], v[96:97] op_sel_hi:[1,0]
v_pk_mul_f32 v[94:95], v[94:95], v[96:97] op_sel_hi:[1,0]
v_cvt_pk_bf16_f32 v100, v88, v89
v_cvt_pk_bf16_f32 v101, v90, v91
v_cvt_pk_bf16_f32 v102, v92, v93
v_cvt_pk_bf16_f32 v103, v94, v95
s_add_u32 s70, s88, 131072
s_cmp_eq_u32 s71, 0
s_cbranch_scc1 L_oown2
buffer_store_dwordx4 v[100:103], v16, s[12:15], s70 offen sc1
L_ood2:
v_add_f32 v120, s80, v120
v_rcp_f32 v120, v120
s_nop 0
v_pk_mul_f32 v[112:113], v[112:113], v[120:121] op_sel_hi:[1,0]
v_pk_mul_f32 v[114:115], v[114:115], v[120:121] op_sel_hi:[1,0]
v_pk_mul_f32 v[116:117], v[116:117], v[120:121] op_sel_hi:[1,0]
v_pk_mul_f32 v[118:119], v[118:119], v[120:121] op_sel_hi:[1,0]
v_cvt_pk_bf16_f32 v124, v112, v113
v_cvt_pk_bf16_f32 v125, v114, v115
v_cvt_pk_bf16_f32 v126, v116, v117
v_cvt_pk_bf16_f32 v127, v118, v119
s_add_u32 s70, s88, 196608
s_cmp_eq_u32 s71, 0
s_cbranch_scc1 L_oown3
buffer_store_dwordx4 v[124:127], v16, s[12:15], s70 offen sc1
L_ood3:
v_xor_b32 v7, s76, v7
ds_read_b64 v[26:27], v20 offset:0
ds_read_b64 v[30:31], v21 offset:0
ds_read_b64 v[34:35], v22 offset:0
ds_read_b64 v[38:39], v23 offset:0
ds_read_b64 v[42:43], v20 offset:2048
ds_read_b64 v[46:47], v21 offset:2048
ds_read_b64 v[50:51], v22 offset:2048
ds_read_b64 v[54:55], v23 offset:2048
s_waitcnt lgkmcnt(0)
ds_read_b64_tr_b16 a[0:1], v8 offset:0
ds_read_b64_tr_b16 a[2:3], v8 offset:2048
s_branch L_over6
L_pad6:
s_branch L_pad11
L_over6:
ds_read_b64_tr_b16 a[4:5], v9 offset:0
ds_read_b64_tr_b16 a[6:7], v9 offset:2048
ds_read_b64_tr_b16 a[8:9], v10 offset:0
ds_read_b64_tr_b16 a[10:11], v10 offset:2048
ds_read_b64_tr_b16 a[12:13], v11 offset:0
ds_read_b64_tr_b16 a[14:15], v11 offset:2048
ds_read_b64_tr_b16 a[16:17], v8 offset:4096
ds_read_b64_tr_b16 a[18:19], v8 offset:6144
ds_read_b64_tr_b16 a[20:21], v9 offset:4096
ds_read_b64_tr_b16 a[22:23], v9 offset:6144
ds_read_b64_tr_b16 a[24:25], v10 offset:4096
ds_read_b64_tr_b16 a[26:27], v10 offset:6144
ds_read_b64_tr_b16 a[28:29], v11 offset:4096
ds_read_b64_tr_b16 a[30:31], v11 offset:6144
v_lshlrev_b32 v24, 16, v26
v_and_b32 v25, 0xffff0000, v26
v_lshlrev_b32 v26, 16, v27
v_and_b32 v27, 0xffff0000, v27
v_lshlrev_b32 v28, 16, v30
v_and_b32 v29, 0xffff0000, v30
v_lshlrev_b32 v30, 16, v31
v_and_b32 v31, 0xffff0000, v31
v_lshlrev_b32 v32, 16, v34
v_and_b32 v33, 0xffff0000, v34
v_lshlrev_b32 v34, 16, v35
v_and_b32 v35, 0xffff0000, v35
v_lshlrev_b32 v36, 16, v38
v_and_b32 v37, 0xffff0000, v38
v_lshlrev_b32 v38, 16, v39
v_and_b32 v39, 0xffff0000, v39
v_lshlrev_b32 v40, 16, v42
v_and_b32 v41, 0xffff0000, v42
v_lshlrev_b32 v42, 16, v43
v_and_b32 v43, 0xffff0000, v43
v_lshlrev_b32 v44, 16, v46
v_and_b32 v45, 0xffff0000, v46
v_lshlrev_b32 v46, 16, v47
v_and_b32 v47, 0xffff0000, v47
v_lshlrev_b32 v48, 16, v50
v_and_b32 v49, 0xffff0000, v50
v_lshlrev_b32 v50, 16, v51
v_and_b32 v51, 0xffff0000, v51
v_lshlrev_b32 v52, 16, v54
v_and_b32 v53, 0xffff0000, v54
v_lshlrev_b32 v54, 16, v55
v_and_b32 v55, 0xffff0000, v55
v_lshrrev_b32 v2, 4, v1
v_lshlrev_b32 v2, 3, v2
v_add_u32 v2, 162048, v2
v_mov_b32 v3, 162176
ds_read_b64 v[136:137], v2 offset:0
ds_read_b64 v[138:139], v2 offset:32
ds_read_b64 v[140:141], v2 offset:64
ds_read_b64 v[142:143], v2 offset:96
ds_read_b128 v[148:151], v3
s_waitcnt lgkmcnt(0)
v_add_f32 v148, v148, v149
v_add_f32 v150, v150, v151
v_add_f32 v148, v148, v150
s_nop 0
v_readfirstlane_b32 s84, v148
v_and_b32 v2, 3, v1
v_cmp_eq_u32 vcc, 0, v2
v_mov_b32 v3, 0x3f803f80
s_nop 0
v_cndmask_b32 v3, 0, v3, vcc
v_cmp_eq_u32 vcc, 2, v2
s_nop 1
v_cndmask_b32 v120, v3, v136, vcc
v_cndmask_b32 v121, v3, v137, vcc
v_cndmask_b32 v122, v3, v138, vcc
v_cndmask_b32 v123, v3, v139, vcc
v_cndmask_b32 v124, v3, v140, vcc
v_cndmask_b32 v125, v3, v141, vcc
v_cndmask_b32 v126, v3, v142, vcc
v_cndmask_b32 v127, v3, v143, vcc
v_and_b32 v2, 15, v1
v_lshrrev_b32 v3, 5, v1
v_lshlrev_b32 v4, 4, v2
v_mov_b32 v144, v4
s_lshl_b32 s75, s64, 15
s_lshl_b32 s70, s60, 9
s_add_u32 s75, s75, s70
s_add_u32 s75, s75, 6291456
s_lshl_b32 s70, s65, 11
s_add_u32 s72, s75, s70
s_mov_b32 s92, 0x00f0000f
s_mov_b32 s93, 0xf0000f00
s_mov_b32 s80, 0x22222222
s_mov_b32 s81, 0x22222222
s_mov_b32 s82, 0x44444444
s_mov_b32 s83, 0x44444444
s_mov_b32 s90, 0x88888888
s_mov_b32 s91, 0x88888888
v_and_b32 v2, 31, v1
v_lshlrev_b32 v5, 4, v2
v_lshl_add_u32 v145, v3, 11, v5
s_lshl_b32 s70, s64, 7
s_lshl_b32 s71, s60, 5
s_add_u32 s70, s70, s71
s_add_u32 s87, s70, 6815744
s_lshr_b32 s70, s70, 4
v_lshl_add_u32 v146, v2, 7, s70
s_lshl_b32 s70, s64, 2
s_add_u32 s70, s70, s60
s_lshl_b32 s70, s70, 15
s_lshl_b32 s71, s65, 7
s_add_u32 s70, s70, s71
s_add_u32 s88, s70, 8388608
v_bfe_u32 v2, v1, 3, 1
v_and_b32 v3, 7, v1
v_lshlrev_b32 v147, 14, v2
v_lshl_add_u32 v147, v3, 4, v147
v_bfe_u32 v2, v1, 4, 1
v_lshl_add_u32 v147, v2, 13, v147
buffer_load_dwordx4 v[56:59], v6, s[12:15], s24 offen offset:0 sc1
buffer_load_dwordx4 v[60:63], v19, s[12:15], s24 offen offset:0 sc1
buffer_load_dwordx4 v[64:67], v6, s[12:15], s24 offen offset:1024 sc1
buffer_load_dwordx4 v[68:71], v19, s[12:15], s24 offen offset:1024 sc1
buffer_load_dwordx4 v[72:75], v6, s[12:15], s25 offen offset:0 sc1
buffer_load_dwordx4 v[76:79], v19, s[12:15], s25 offen offset:0 sc1
buffer_load_dwordx4 v[80:83], v6, s[12:15], s25 offen offset:1024 sc1
buffer_load_dwordx4 v[84:87], v19, s[12:15], s25 offen offset:1024 sc1
buffer_load_dwordx4 v[88:91], v6, s[12:15], s26 offen offset:0 sc1
buffer_load_dwordx4 v[92:95], v19, s[12:15], s26 offen offset:0 sc1
buffer_load_dwordx4 v[96:99], v6, s[12:15], s26 offen offset:1024 sc1
buffer_load_dwordx4 v[100:103], v19, s[12:15], s26 offen offset:1024 sc1
s_waitcnt vmcnt(8)
v_max3_u32 v2, v56, v60, v64
v_max_u32 v2, v2, v68
v_cmp_eq_u32 vcc, -1, v2
s_cbranch_vccnz L_o0_rt
L_o0_ok:
s_waitcnt lgkmcnt(8)
v_mfma_f32_16x16x32_bf16 v[24:27], a[0:3], v[56:59], v[24:27]
ds_read_b64_tr_b16 a[32:33], v8 offset:8192
ds_read_b64_tr_b16 a[34:35], v8 offset:10240
v_mfma_f32_16x16x32_bf16 v[40:43], a[0:3], v[60:63], v[40:43]
buffer_load_dwordx4 v[104:107], v6, s[12:15], s27 offen offset:0 sc1
v_mfma_f32_16x16x32_bf16 v[28:31], a[4:7], v[56:59], v[28:31]
ds_read_b64_tr_b16 a[36:37], v9 offset:8192
ds_read_b64_tr_b16 a[38:39], v9 offset:10240
v_mfma_f32_16x16x32_bf16 v[44:47], a[4:7], v[60:63], v[44:47]
buffer_load_dwordx4 v[108:111], v19, s[12:15], s27 offen offset:0 sc1
v_mfma_f32_16x16x32_bf16 v[32:35], a[8:11], v[56:59], v[32:35]
ds_read_b64_tr_b16 a[40:41], v10 offset:8192
ds_read_b64_tr_b16 a[42:43], v10 offset:10240
v_mfma_f32_16x16x32_bf16 v[48:51], a[8:11], v[60:63], v[48:51]
buffer_load_dwordx4 v[112:115], v6, s[12:15], s27 offen offset:1024 sc1
v_mfma_f32_16x16x32_bf16 v[36:39], a[12:15], v[56:59], v[36:39]
ds_read_b64_tr_b16 a[44:45], v11 offset:8192
ds_read_b64_tr_b16 a[46:47], v11 offset:10240
v_mfma_f32_16x16x32_bf16 v[52:55], a[12:15], v[60:63], v[52:55]
buffer_load_dwordx4 v[116:119], v19, s[12:15], s27 offen offset:1024 sc1
s_waitcnt lgkmcnt(8)
v_mfma_f32_16x16x32_bf16 v[24:27], a[16:19], v[64:67], v[24:27]
ds_read_b64_tr_b16 a[0:1], v8 offset:12288
s_waitcnt vmcnt(8)
v_mfma_f32_16x16x32_bf16 v[40:43], a[16:19], v[68:71], v[40:43]
ds_read_b64_tr_b16 a[2:3], v8 offset:14336
v_max3_u32 v2, v72, v76, v80
v_mfma_f32_16x16x32_bf16 v[28:31], a[20:23], v[64:67], v[28:31]
ds_read_b64_tr_b16 a[4:5], v9 offset:12288
v_max_u32 v2, v2, v84
v_mfma_f32_16x16x32_bf16 v[44:47], a[20:23], v[68:71], v[44:47]
ds_read_b64_tr_b16 a[6:7], v9 offset:14336
v_cmp_eq_u32 vcc, -1, v2
v_mfma_f32_16x16x32_bf16 v[32:35], a[24:27], v[64:67], v[32:35]
ds_read_b64_tr_b16 a[8:9], v10 offset:12288
v_mfma_f32_16x16x32_bf16 v[48:51], a[24:27], v[68:71], v[48:51]
ds_read_b64_tr_b16 a[10:11], v10 offset:14336
v_mfma_f32_16x16x32_bf16 v[36:39], a[28:31], v[64:67], v[36:39]
ds_read_b64_tr_b16 a[12:13], v11 offset:12288
ds_read_b64_tr_b16 a[14:15], v11 offset:14336
v_mfma_f32_16x16x32_bf16 v[52:55], a[28:31], v[68:71], v[52:55]
s_cbranch_vccnz L_o1_rt
L_o1_ok:
s_waitcnt lgkmcnt(8)
v_mfma_f32_16x16x32_bf16 v[24:27], a[32:35], v[72:75], v[24:27]
ds_read_b64_tr_b16 a[16:17], v8 offset:16384
ds_read_b64_tr_b16 a[18:19], v8 offset:18432
v_mfma_f32_16x16x32_bf16 v[40:43], a[32:35], v[76:79], v[40:43]
buffer_load_dwordx4 v[56:59], v6, s[12:15], s28 offen offset:0 sc1
v_mfma_f32_16x16x32_bf16 v[28:31], a[36:39], v[72:75], v[28:31]
ds_read_b64_tr_b16 a[20:21], v9 offset:16384
ds_read_b64_tr_b16 a[22:23], v9 offset:18432
v_mfma_f32_16x16x32_bf16 v[44:47], a[36:39], v[76:79], v[44:47]
buffer_load_dwordx4 v[60:63], v19, s[12:15], s28 offen offset:0 sc1
v_mfma_f32_16x16x32_bf16 v[32:35], a[40:43], v[72:75], v[32:35]
ds_read_b64_tr_b16 a[24:25], v10 offset:16384
ds_read_b64_tr_b16 a[26:27], v10 offset:18432
v_mfma_f32_16x16x32_bf16 v[48:51], a[40:43], v[76:79], v[48:51]
buffer_load_dwordx4 v[64:67], v6, s[12:15], s28 offen offset:1024 sc1
v_mfma_f32_16x16x32_bf16 v[36:39], a[44:47], v[72:75], v[36:39]
ds_read_b64_tr_b16 a[28:29], v11 offset:16384
ds_read_b64_tr_b16 a[30:31], v11 offset:18432
v_mfma_f32_16x16x32_bf16 v[52:55], a[44:47], v[76:79], v[52:55]
buffer_load_dwordx4 v[68:71], v19, s[12:15], s28 offen offset:1024 sc1
s_waitcnt lgkmcnt(8)
v_mfma_f32_16x16x32_bf16 v[24:27], a[0:3], v[80:83], v[24:27]
ds_read_b64_tr_b16 a[32:33], v8 offset:20480
s_waitcnt vmcnt(8)
v_mfma_f32_16x16x32_bf16 v[40:43], a[0:3], v[84:87], v[40:43]
ds_read_b64_tr_b16 a[34:35], v8 offset:22528
v_max3_u32 v2, v88, v92, v96
v_mfma_f32_16x16x32_bf16 v[28:31], a[4:7], v[80:83], v[28:31]
ds_read_b64_tr_b16 a[36:37], v9 offset:20480
v_max_u32 v2, v2, v100
v_mfma_f32_16x16x32_bf16 v[44:47], a[4:7], v[84:87], v[44:47]
ds_read_b64_tr_b16 a[38:39], v9 offset:22528
v_cmp_eq_u32 vcc, -1, v2
v_mfma_f32_16x16x32_bf16 v[32:35], a[8:11], v[80:83], v[32:35]
ds_read_b64_tr_b16 a[40:41], v10 offset:20480
v_mfma_f32_16x16x32_bf16 v[48:51], a[8:11], v[84:87], v[48:51]
ds_read_b64_tr_b16 a[42:43], v10 offset:22528
v_mfma_f32_16x16x32_bf16 v[36:39], a[12:15], v[80:83], v[36:39]
ds_read_b64_tr_b16 a[44:45], v11 offset:20480
ds_read_b64_tr_b16 a[46:47], v11 offset:22528
v_mfma_f32_16x16x32_bf16 v[52:55], a[12:15], v[84:87], v[52:55]
s_cbranch_vccnz L_o2_rt
L_o2_ok:
s_waitcnt lgkmcnt(8)
v_mfma_f32_16x16x32_bf16 v[24:27], a[16:19], v[88:91], v[24:27]
ds_read_b64_tr_b16 a[0:1], v8 offset:24576
ds_read_b64_tr_b16 a[2:3], v8 offset:26624
v_mfma_f32_16x16x32_bf16 v[40:43], a[16:19], v[92:95], v[40:43]
buffer_load_dwordx4 v[72:75], v6, s[12:15], s29 offen offset:0 sc1
v_mfma_f32_16x16x32_bf16 v[28:31], a[20:23], v[88:91], v[28:31]
ds_read_b64_tr_b16 a[4:5], v9 offset:24576
ds_read_b64_tr_b16 a[6:7], v9 offset:26624
v_mfma_f32_16x16x32_bf16 v[44:47], a[20:23], v[92:95], v[44:47]
buffer_load_dwordx4 v[76:79], v19, s[12:15], s29 offen offset:0 sc1
v_mfma_f32_16x16x32_bf16 v[32:35], a[24:27], v[88:91], v[32:35]
ds_read_b64_tr_b16 a[8:9], v10 offset:24576
ds_read_b64_tr_b16 a[10:11], v10 offset:26624
v_mfma_f32_16x16x32_bf16 v[48:51], a[24:27], v[92:95], v[48:51]
buffer_load_dwordx4 v[80:83], v6, s[12:15], s29 offen offset:1024 sc1
v_mfma_f32_16x16x32_bf16 v[36:39], a[28:31], v[88:91], v[36:39]
ds_read_b64_tr_b16 a[12:13], v11 offset:24576
ds_read_b64_tr_b16 a[14:15], v11 offset:26624
v_mfma_f32_16x16x32_bf16 v[52:55], a[28:31], v[92:95], v[52:55]
buffer_load_dwordx4 v[84:87], v19, s[12:15], s29 offen offset:1024 sc1
s_waitcnt lgkmcnt(8)
v_mfma_f32_16x16x32_bf16 v[24:27], a[32:35], v[96:99], v[24:27]
ds_read_b64_tr_b16 a[16:17], v8 offset:28672
s_waitcnt vmcnt(8)
v_mfma_f32_16x16x32_bf16 v[40:43], a[32:35], v[100:103], v[40:43]
ds_read_b64_tr_b16 a[18:19], v8 offset:30720
v_max3_u32 v2, v104, v108, v112
v_mfma_f32_16x16x32_bf16 v[28:31], a[36:39], v[96:99], v[28:31]
ds_read_b64_tr_b16 a[20:21], v9 offset:28672
v_max_u32 v2, v2, v116
v_mfma_f32_16x16x32_bf16 v[44:47], a[36:39], v[100:103], v[44:47]
ds_read_b64_tr_b16 a[22:23], v9 offset:30720
v_cmp_eq_u32 vcc, -1, v2
v_mfma_f32_16x16x32_bf16 v[32:35], a[40:43], v[96:99], v[32:35]
ds_read_b64_tr_b16 a[24:25], v10 offset:28672
v_mfma_f32_16x16x32_bf16 v[48:51], a[40:43], v[100:103], v[48:51]
ds_read_b64_tr_b16 a[26:27], v10 offset:30720
v_mfma_f32_16x16x32_bf16 v[36:39], a[44:47], v[96:99], v[36:39]
ds_read_b64_tr_b16 a[28:29], v11 offset:28672
ds_read_b64_tr_b16 a[30:31], v11 offset:30720
v_mfma_f32_16x16x32_bf16 v[52:55], a[44:47], v[100:103], v[52:55]
s_cbranch_vccnz L_o3_rt
L_o3_ok:
s_waitcnt lgkmcnt(8)
v_mfma_f32_16x16x32_bf16 v[24:27], a[0:3], v[104:107], v[24:27]
ds_read_b64_tr_b16 a[32:33], v8 offset:32768
ds_read_b64_tr_b16 a[34:35], v8 offset:34816
v_mfma_f32_16x16x32_bf16 v[40:43], a[0:3], v[108:111], v[40:43]
buffer_load_dwordx4 v[88:91], v6, s[12:15], s30 offen offset:0 sc1
v_mfma_f32_16x16x32_bf16 v[28:31], a[4:7], v[104:107], v[28:31]
ds_read_b64_tr_b16 a[36:37], v9 offset:32768
ds_read_b64_tr_b16 a[38:39], v9 offset:34816
v_mfma_f32_16x16x32_bf16 v[44:47], a[4:7], v[108:111], v[44:47]
buffer_load_dwordx4 v[92:95], v19, s[12:15], s30 offen offset:0 sc1
v_mfma_f32_16x16x32_bf16 v[32:35], a[8:11], v[104:107], v[32:35]
ds_read_b64_tr_b16 a[40:41], v10 offset:32768
ds_read_b64_tr_b16 a[42:43], v10 offset:34816
v_mfma_f32_16x16x32_bf16 v[48:51], a[8:11], v[108:111], v[48:51]
buffer_load_dwordx4 v[96:99], v6, s[12:15], s30 offen offset:1024 sc1
v_mfma_f32_16x16x32_bf16 v[36:39], a[12:15], v[104:107], v[36:39]
ds_read_b64_tr_b16 a[44:45], v11 offset:32768
ds_read_b64_tr_b16 a[46:47], v11 offset:34816
v_mfma_f32_16x16x32_bf16 v[52:55], a[12:15], v[108:111], v[52:55]
buffer_load_dwordx4 v[100:103], v19, s[12:15], s30 offen offset:1024 sc1
s_waitcnt lgkmcnt(8)
v_mfma_f32_16x16x32_bf16 v[24:27], a[16:19], v[112:115], v[24:27]
ds_read_b64_tr_b16 a[0:1], v8 offset:36864
s_waitcnt vmcnt(8)
v_mfma_f32_16x16x32_bf16 v[40:43], a[16:19], v[116:119], v[40:43]
ds_read_b64_tr_b16 a[2:3], v8 offset:38912
v_max3_u32 v2, v56, v60, v64
v_mfma_f32_16x16x32_bf16 v[28:31], a[20:23], v[112:115], v[28:31]
ds_read_b64_tr_b16 a[4:5], v9 offset:36864
v_max_u32 v2, v2, v68
v_mfma_f32_16x16x32_bf16 v[44:47], a[20:23], v[116:119], v[44:47]
ds_read_b64_tr_b16 a[6:7], v9 offset:38912
v_cmp_eq_u32 vcc, -1, v2
v_mfma_f32_16x16x32_bf16 v[32:35], a[24:27], v[112:115], v[32:35]
ds_read_b64_tr_b16 a[8:9], v10 offset:36864
v_mfma_f32_16x16x32_bf16 v[48:51], a[24:27], v[116:119], v[48:51]
ds_read_b64_tr_b16 a[10:11], v10 offset:38912
v_mfma_f32_16x16x32_bf16 v[36:39], a[28:31], v[112:115], v[36:39]
ds_read_b64_tr_b16 a[12:13], v11 offset:36864
ds_read_b64_tr_b16 a[14:15], v11 offset:38912
v_mfma_f32_16x16x32_bf16 v[52:55], a[28:31], v[116:119], v[52:55]
s_cbranch_vccnz L_o4_rt
L_o4_ok:
s_waitcnt lgkmcnt(8)
v_mfma_f32_16x16x32_bf16 v[24:27], a[32:35], v[56:59], v[24:27]
ds_read_b64_tr_b16 a[16:17], v8 offset:40960
ds_read_b64_tr_b16 a[18:19], v8 offset:43008
v_mfma_f32_16x16x32_bf16 v[40:43], a[32:35], v[60:63], v[40:43]
buffer_load_dwordx4 v[104:107], v6, s[12:15], s31 offen offset:0 sc1
v_mfma_f32_16x16x32_bf16 v[28:31], a[36:39], v[56:59], v[28:31]
ds_read_b64_tr_b16 a[20:21], v9 offset:40960
ds_read_b64_tr_b16 a[22:23], v9 offset:43008
v_mfma_f32_16x16x32_bf16 v[44:47], a[36:39], v[60:63], v[44:47]
buffer_load_dwordx4 v[108:111], v19, s[12:15], s31 offen offset:0 sc1
v_mfma_f32_16x16x32_bf16 v[32:35], a[40:43], v[56:59], v[32:35]
ds_read_b64_tr_b16 a[24:25], v10 offset:40960
ds_read_b64_tr_b16 a[26:27], v10 offset:43008
v_mfma_f32_16x16x32_bf16 v[48:51], a[40:43], v[60:63], v[48:51]
buffer_load_dwordx4 v[112:115], v6, s[12:15], s31 offen offset:1024 sc1
v_mfma_f32_16x16x32_bf16 v[36:39], a[44:47], v[56:59], v[36:39]
ds_read_b64_tr_b16 a[28:29], v11 offset:40960
ds_read_b64_tr_b16 a[30:31], v11 offset:43008
v_mfma_f32_16x16x32_bf16 v[52:55], a[44:47], v[60:63], v[52:55]
buffer_load_dwordx4 v[116:119], v19, s[12:15], s31 offen offset:1024 sc1
s_waitcnt lgkmcnt(8)
v_mfma_f32_16x16x32_bf16 v[24:27], a[0:3], v[64:67], v[24:27]
ds_read_b64_tr_b16 a[32:33], v8 offset:45056
s_waitcnt vmcnt(8)
v_mfma_f32_16x16x32_bf16 v[40:43], a[0:3], v[68:71], v[40:43]
ds_read_b64_tr_b16 a[34:35], v8 offset:47104
v_max3_u32 v2, v72, v76, v80
v_mfma_f32_16x16x32_bf16 v[28:31], a[4:7], v[64:67], v[28:31]
ds_read_b64_tr_b16 a[36:37], v9 offset:45056
v_max_u32 v2, v2, v84
v_mfma_f32_16x16x32_bf16 v[44:47], a[4:7], v[68:71], v[44:47]
ds_read_b64_tr_b16 a[38:39], v9 offset:47104
v_cmp_eq_u32 vcc, -1, v2
v_mfma_f32_16x16x32_bf16 v[32:35], a[8:11], v[64:67], v[32:35]
ds_read_b64_tr_b16 a[40:41], v10 offset:45056
v_mfma_f32_16x16x32_bf16 v[48:51], a[8:11], v[68:71], v[48:51]
ds_read_b64_tr_b16 a[42:43], v10 offset:47104
v_mfma_f32_16x16x32_bf16 v[36:39], a[12:15], v[64:67], v[36:39]
ds_read_b64_tr_b16 a[44:45], v11 offset:45056
ds_read_b64_tr_b16 a[46:47], v11 offset:47104
v_mfma_f32_16x16x32_bf16 v[52:55], a[12:15], v[68:71], v[52:55]
s_cbranch_vccnz L_o5_rt
L_o5_ok:
s_waitcnt lgkmcnt(8)
v_mfma_f32_16x16x32_bf16 v[24:27], a[16:19], v[72:75], v[24:27]
ds_read_b64_tr_b16 a[0:1], v8 offset:49152
ds_read_b64_tr_b16 a[2:3], v8 offset:51200
v_mfma_f32_16x16x32_bf16 v[40:43], a[16:19], v[76:79], v[40:43]
buffer_load_dwordx4 v[56:59], v6, s[12:15], s32 offen offset:0 sc1
v_mfma_f32_16x16x32_bf16 v[28:31], a[20:23], v[72:75], v[28:31]
ds_read_b64_tr_b16 a[4:5], v9 offset:49152
ds_read_b64_tr_b16 a[6:7], v9 offset:51200
v_mfma_f32_16x16x32_bf16 v[44:47], a[20:23], v[76:79], v[44:47]
buffer_load_dwordx4 v[60:63], v19, s[12:15], s32 offen offset:0 sc1
v_mfma_f32_16x16x32_bf16 v[32:35], a[24:27], v[72:75], v[32:35]
ds_read_b64_tr_b16 a[8:9], v10 offset:49152
ds_read_b64_tr_b16 a[10:11], v10 offset:51200
v_mfma_f32_16x16x32_bf16 v[48:51], a[24:27], v[76:79], v[48:51]
buffer_load_dwordx4 v[64:67], v6, s[12:15], s32 offen offset:1024 sc1
v_mfma_f32_16x16x32_bf16 v[36:39], a[28:31], v[72:75], v[36:39]
ds_read_b64_tr_b16 a[12:13], v11 offset:49152
ds_read_b64_tr_b16 a[14:15], v11 offset:51200
v_mfma_f32_16x16x32_bf16 v[52:55], a[28:31], v[76:79], v[52:55]
buffer_load_dwordx4 v[68:71], v19, s[12:15], s32 offen offset:1024 sc1
s_waitcnt lgkmcnt(8)
v_mfma_f32_16x16x32_bf16 v[24:27], a[32:35], v[80:83], v[24:27]
ds_read_b64_tr_b16 a[16:17], v8 offset:53248
s_waitcnt vmcnt(8)
v_mfma_f32_16x16x32_bf16 v[40:43], a[32:35], v[84:87], v[40:43]
ds_read_b64_tr_b16 a[18:19], v8 offset:55296
v_max3_u32 v2, v88, v92, v96
v_mfma_f32_16x16x32_bf16 v[28:31], a[36:39], v[80:83], v[28:31]
ds_read_b64_tr_b16 a[20:21], v9 offset:53248
v_max_u32 v2, v2, v100
v_mfma_f32_16x16x32_bf16 v[44:47], a[36:39], v[84:87], v[44:47]
ds_read_b64_tr_b16 a[22:23], v9 offset:55296
v_cmp_eq_u32 vcc, -1, v2
v_mfma_f32_16x16x32_bf16 v[32:35], a[40:43], v[80:83], v[32:35]
ds_read_b64_tr_b16 a[24:25], v10 offset:53248
v_mfma_f32_16x16x32_bf16 v[48:51], a[40:43], v[84:87], v[48:51]
ds_read_b64_tr_b16 a[26:27], v10 offset:55296
v_mfma_f32_16x16x32_bf16 v[36:39], a[44:47], v[80:83], v[36:39]
ds_read_b64_tr_b16 a[28:29], v11 offset:53248
ds_read_b64_tr_b16 a[30:31], v11 offset:55296
v_mfma_f32_16x16x32_bf16 v[52:55], a[44:47], v[84:87], v[52:55]
s_cbranch_vccnz L_o6_rt
L_o6_ok:
s_waitcnt lgkmcnt(8)
v_mfma_f32_16x16x32_bf16 v[24:27], a[0:3], v[88:91], v[24:27]
ds_read_b64_tr_b16 a[32:33], v8 offset:57344
ds_read_b64_tr_b16 a[34:35], v8 offset:59392
v_mfma_f32_16x16x32_bf16 v[40:43], a[0:3], v[92:95], v[40:43]
buffer_load_dwordx4 v[72:75], v6, s[12:15], s33 offen offset:0 sc1
v_mfma_f32_16x16x32_bf16 v[28:31], a[4:7], v[88:91], v[28:31]
ds_read_b64_tr_b16 a[36:37], v9 offset:57344
ds_read_b64_tr_b16 a[38:39], v9 offset:59392
v_mfma_f32_16x16x32_bf16 v[44:47], a[4:7], v[92:95], v[44:47]
buffer_load_dwordx4 v[76:79], v19, s[12:15], s33 offen offset:0 sc1
v_mfma_f32_16x16x32_bf16 v[32:35], a[8:11], v[88:91], v[32:35]
ds_read_b64_tr_b16 a[40:41], v10 offset:57344
ds_read_b64_tr_b16 a[42:43], v10 offset:59392
v_mfma_f32_16x16x32_bf16 v[48:51], a[8:11], v[92:95], v[48:51]
buffer_load_dwordx4 v[80:83], v6, s[12:15], s33 offen offset:1024 sc1
v_mfma_f32_16x16x32_bf16 v[36:39], a[12:15], v[88:91], v[36:39]
ds_read_b64_tr_b16 a[44:45], v11 offset:57344
ds_read_b64_tr_b16 a[46:47], v11 offset:59392
v_mfma_f32_16x16x32_bf16 v[52:55], a[12:15], v[92:95], v[52:55]
buffer_load_dwordx4 v[84:87], v19, s[12:15], s33 offen offset:1024 sc1
s_waitcnt lgkmcnt(8)
v_mfma_f32_16x16x32_bf16 v[24:27], a[16:19], v[96:99], v[24:27]
ds_read_b64_tr_b16 a[0:1], v8 offset:61440
s_waitcnt vmcnt(8)
v_mfma_f32_16x16x32_bf16 v[40:43], a[16:19], v[100:103], v[40:43]
ds_read_b64_tr_b16 a[2:3], v8 offset:63488
v_max3_u32 v2, v104, v108, v112
v_mfma_f32_16x16x32_bf16 v[28:31], a[20:23], v[96:99], v[28:31]
ds_read_b64_tr_b16 a[4:5], v9 offset:61440
v_max_u32 v2, v2, v116
v_mfma_f32_16x16x32_bf16 v[44:47], a[20:23], v[100:103], v[44:47]
ds_read_b64_tr_b16 a[6:7], v9 offset:63488
v_cmp_eq_u32 vcc, -1, v2
v_mfma_f32_16x16x32_bf16 v[32:35], a[24:27], v[96:99], v[32:35]
ds_read_b64_tr_b16 a[8:9], v10 offset:61440
v_mfma_f32_16x16x32_bf16 v[48:51], a[24:27], v[100:103], v[48:51]
ds_read_b64_tr_b16 a[10:11], v10 offset:63488
v_mfma_f32_16x16x32_bf16 v[36:39], a[28:31], v[96:99], v[36:39]
ds_read_b64_tr_b16 a[12:13], v11 offset:61440
ds_read_b64_tr_b16 a[14:15], v11 offset:63488
v_mfma_f32_16x16x32_bf16 v[52:55], a[28:31], v[100:103], v[52:55]
s_cbranch_vccnz L_o7_rt
L_o7_ok:
s_waitcnt lgkmcnt(8)
v_mfma_f32_16x16x32_bf16 v[24:27], a[32:35], v[104:107], v[24:27]
ds_read_b64_tr_b16 a[16:17], v12 offset:0
ds_read_b64_tr_b16 a[18:19], v12 offset:2048
v_mfma_f32_16x16x32_bf16 v[40:43], a[32:35], v[108:111], v[40:43]
buffer_load_dwordx4 v[88:91], v6, s[12:15], s34 offen offset:0 sc1
v_mfma_f32_16x16x32_bf16 v[28:31], a[36:39], v[104:107], v[28:31]
ds_read_b64_tr_b16 a[20:21], v13 offset:0
ds_read_b64_tr_b16 a[22:23], v13 offset:2048
v_mfma_f32_16x16x32_bf16 v[44:47], a[36:39], v[108:111], v[44:47]
buffer_load_dwordx4 v[92:95], v19, s[12:15], s34 offen offset:0 sc1
v_mfma_f32_16x16x32_bf16 v[32:35], a[40:43], v[104:107], v[32:35]
ds_read_b64_tr_b16 a[24:25], v14 offset:0
ds_read_b64_tr_b16 a[26:27], v14 offset:2048
v_mfma_f32_16x16x32_bf16 v[48:51], a[40:43], v[108:111], v[48:51]
buffer_load_dwordx4 v[96:99], v6, s[12:15], s34 offen offset:1024 sc1
v_mfma_f32_16x16x32_bf16 v[36:39], a[44:47], v[104:107], v[36:39]
ds_read_b64_tr_b16 a[28:29], v15 offset:0
ds_read_b64_tr_b16 a[30:31], v15 offset:2048
v_mfma_f32_16x16x32_bf16 v[52:55], a[44:47], v[108:111], v[52:55]
buffer_load_dwordx4 v[100:103], v19, s[12:15], s34 offen offset:1024 sc1
s_waitcnt lgkmcnt(8)
v_mfma_f32_16x16x32_bf16 v[24:27], a[0:3], v[112:115], v[24:27]
ds_read_b64_tr_b16 a[32:33], v12 offset:4096
s_waitcnt vmcnt(8)
v_mfma_f32_16x16x32_bf16 v[40:43], a[0:3], v[116:119], v[40:43]
ds_read_b64_tr_b16 a[34:35], v12 offset:6144
v_max3_u32 v2, v56, v60, v64
v_mfma_f32_16x16x32_bf16 v[28:31], a[4:7], v[112:115], v[28:31]
ds_read_b64_tr_b16 a[36:37], v13 offset:4096
v_max_u32 v2, v2, v68
v_mfma_f32_16x16x32_bf16 v[44:47], a[4:7], v[116:119], v[44:47]
ds_read_b64_tr_b16 a[38:39], v13 offset:6144
v_cmp_eq_u32 vcc, -1, v2
v_mfma_f32_16x16x32_bf16 v[32:35], a[8:11], v[112:115], v[32:35]
ds_read_b64_tr_b16 a[40:41], v14 offset:4096
v_mfma_f32_16x16x32_bf16 v[48:51], a[8:11], v[116:119], v[48:51]
ds_read_b64_tr_b16 a[42:43], v14 offset:6144
v_mfma_f32_16x16x32_bf16 v[36:39], a[12:15], v[112:115], v[36:39]
ds_read_b64_tr_b16 a[44:45], v15 offset:4096
ds_read_b64_tr_b16 a[46:47], v15 offset:6144
v_mfma_f32_16x16x32_bf16 v[52:55], a[12:15], v[116:119], v[52:55]
s_cbranch_vccnz L_o8_rt
L_o8_ok:
s_waitcnt lgkmcnt(8)
v_mfma_f32_16x16x32_bf16 v[24:27], a[16:19], v[56:59], v[24:27]
ds_read_b64_tr_b16 a[0:1], v12 offset:8192
ds_read_b64_tr_b16 a[2:3], v12 offset:10240
v_mfma_f32_16x16x32_bf16 v[40:43], a[16:19], v[60:63], v[40:43]
buffer_load_dwordx4 v[104:107], v6, s[12:15], s35 offen offset:0 sc1
v_mfma_f32_16x16x32_bf16 v[28:31], a[20:23], v[56:59], v[28:31]
ds_read_b64_tr_b16 a[4:5], v13 offset:8192
ds_read_b64_tr_b16 a[6:7], v13 offset:10240
v_mfma_f32_16x16x32_bf16 v[44:47], a[20:23], v[60:63], v[44:47]
buffer_load_dwordx4 v[108:111], v19, s[12:15], s35 offen offset:0 sc1
v_mfma_f32_16x16x32_bf16 v[32:35], a[24:27], v[56:59], v[32:35]
ds_read_b64_tr_b16 a[8:9], v14 offset:8192
ds_read_b64_tr_b16 a[10:11], v14 offset:10240
v_mfma_f32_16x16x32_bf16 v[48:51], a[24:27], v[60:63], v[48:51]
buffer_load_dwordx4 v[112:115], v6, s[12:15], s35 offen offset:1024 sc1
v_mfma_f32_16x16x32_bf16 v[36:39], a[28:31], v[56:59], v[36:39]
ds_read_b64_tr_b16 a[12:13], v15 offset:8192
ds_read_b64_tr_b16 a[14:15], v15 offset:10240
v_mfma_f32_16x16x32_bf16 v[52:55], a[28:31], v[60:63], v[52:55]
buffer_load_dwordx4 v[116:119], v19, s[12:15], s35 offen offset:1024 sc1
s_waitcnt lgkmcnt(8)
v_mfma_f32_16x16x32_bf16 v[24:27], a[32:35], v[64:67], v[24:27]
ds_read_b64_tr_b16 a[16:17], v12 offset:12288
s_waitcnt vmcnt(8)
v_mfma_f32_16x16x32_bf16 v[40:43], a[32:35], v[68:71], v[40:43]
ds_read_b64_tr_b16 a[18:19], v12 offset:14336
v_max3_u32 v2, v72, v76, v80
v_mfma_f32_16x16x32_bf16 v[28:31], a[36:39], v[64:67], v[28:31]
ds_read_b64_tr_b16 a[20:21], v13 offset:12288
v_max_u32 v2, v2, v84
v_mfma_f32_16x16x32_bf16 v[44:47], a[36:39], v[68:71], v[44:47]
ds_read_b64_tr_b16 a[22:23], v13 offset:14336
v_cmp_eq_u32 vcc, -1, v2
v_mfma_f32_16x16x32_bf16 v[32:35], a[40:43], v[64:67], v[32:35]
ds_read_b64_tr_b16 a[24:25], v14 offset:12288
v_mfma_f32_16x16x32_bf16 v[48:51], a[40:43], v[68:71], v[48:51]
ds_read_b64_tr_b16 a[26:27], v14 offset:14336
v_mfma_f32_16x16x32_bf16 v[36:39], a[44:47], v[64:67], v[36:39]
ds_read_b64_tr_b16 a[28:29], v15 offset:12288
ds_read_b64_tr_b16 a[30:31], v15 offset:14336
v_mfma_f32_16x16x32_bf16 v[52:55], a[44:47], v[68:71], v[52:55]
s_cbranch_vccnz L_o9_rt
L_o9_ok:
s_waitcnt lgkmcnt(8)
v_mfma_f32_16x16x32_bf16 v[24:27], a[0:3], v[72:75], v[24:27]
ds_read_b64_tr_b16 a[32:33], v12 offset:16384
ds_read_b64_tr_b16 a[34:35], v12 offset:18432
v_mfma_f32_16x16x32_bf16 v[40:43], a[0:3], v[76:79], v[40:43]
buffer_load_dwordx4 v[56:59], v6, s[12:15], s36 offen offset:0 sc1
v_mfma_f32_16x16x32_bf16 v[28:31], a[4:7], v[72:75], v[28:31]
ds_read_b64_tr_b16 a[36:37], v13 offset:16384
ds_read_b64_tr_b16 a[38:39], v13 offset:18432
v_mfma_f32_16x16x32_bf16 v[44:47], a[4:7], v[76:79], v[44:47]
buffer_load_dwordx4 v[60:63], v19, s[12:15], s36 offen offset:0 sc1
v_mfma_f32_16x16x32_bf16 v[32:35], a[8:11], v[72:75], v[32:35]
ds_read_b64_tr_b16 a[40:41], v14 offset:16384
ds_read_b64_tr_b16 a[42:43], v14 offset:18432
v_mfma_f32_16x16x32_bf16 v[48:51], a[8:11], v[76:79], v[48:51]
buffer_load_dwordx4 v[64:67], v6, s[12:15], s36 offen offset:1024 sc1
v_mfma_f32_16x16x32_bf16 v[36:39], a[12:15], v[72:75], v[36:39]
ds_read_b64_tr_b16 a[44:45], v15 offset:16384
ds_read_b64_tr_b16 a[46:47], v15 offset:18432
v_mfma_f32_16x16x32_bf16 v[52:55], a[12:15], v[76:79], v[52:55]
buffer_load_dwordx4 v[68:71], v19, s[12:15], s36 offen offset:1024 sc1
s_waitcnt lgkmcnt(8)
v_mfma_f32_16x16x32_bf16 v[24:27], a[16:19], v[80:83], v[24:27]
ds_read_b64_tr_b16 a[0:1], v12 offset:20480
s_waitcnt vmcnt(8)
v_mfma_f32_16x16x32_bf16 v[40:43], a[16:19], v[84:87], v[40:43]
ds_read_b64_tr_b16 a[2:3], v12 offset:22528
v_max3_u32 v2, v88, v92, v96
v_mfma_f32_16x16x32_bf16 v[28:31], a[20:23], v[80:83], v[28:31]
ds_read_b64_tr_b16 a[4:5], v13 offset:20480
v_max_u32 v2, v2, v100
v_mfma_f32_16x16x32_bf16 v[44:47], a[20:23], v[84:87], v[44:47]
ds_read_b64_tr_b16 a[6:7], v13 offset:22528
v_cmp_eq_u32 vcc, -1, v2
v_mfma_f32_16x16x32_bf16 v[32:35], a[24:27], v[80:83], v[32:35]
ds_read_b64_tr_b16 a[8:9], v14 offset:20480
v_mfma_f32_16x16x32_bf16 v[48:51], a[24:27], v[84:87], v[48:51]
ds_read_b64_tr_b16 a[10:11], v14 offset:22528
v_mfma_f32_16x16x32_bf16 v[36:39], a[28:31], v[80:83], v[36:39]
ds_read_b64_tr_b16 a[12:13], v15 offset:20480
ds_read_b64_tr_b16 a[14:15], v15 offset:22528
v_mfma_f32_16x16x32_bf16 v[52:55], a[28:31], v[84:87], v[52:55]
s_cbranch_vccnz L_o10_rt
L_o10_ok:
s_waitcnt lgkmcnt(8)
v_mfma_f32_16x16x32_bf16 v[24:27], a[32:35], v[88:91], v[24:27]
ds_read_b64_tr_b16 a[16:17], v12 offset:24576
ds_read_b64_tr_b16 a[18:19], v12 offset:26624
v_mfma_f32_16x16x32_bf16 v[40:43], a[32:35], v[92:95], v[40:43]
buffer_load_dwordx4 v[72:75], v6, s[12:15], s37 offen offset:0 sc1
v_mfma_f32_16x16x32_bf16 v[28:31], a[36:39], v[88:91], v[28:31]
ds_read_b64_tr_b16 a[20:21], v13 offset:24576
ds_read_b64_tr_b16 a[22:23], v13 offset:26624
v_mfma_f32_16x16x32_bf16 v[44:47], a[36:39], v[92:95], v[44:47]
buffer_load_dwordx4 v[76:79], v19, s[12:15], s37 offen offset:0 sc1
s_branch L_over7
L_pad7:
s_branch L_pad12
L_over7:
v_mfma_f32_16x16x32_bf16 v[32:35], a[40:43], v[88:91], v[32:35]
ds_read_b64_tr_b16 a[24:25], v14 offset:24576
ds_read_b64_tr_b16 a[26:27], v14 offset:26624
v_mfma_f32_16x16x32_bf16 v[48:51], a[40:43], v[92:95], v[48:51]
buffer_load_dwordx4 v[80:83], v6, s[12:15], s37 offen offset:1024 sc1
v_mfma_f32_16x16x32_bf16 v[36:39], a[44:47], v[88:91], v[36:39]
ds_read_b64_tr_b16 a[28:29], v15 offset:24576
ds_read_b64_tr_b16 a[30:31], v15 offset:26624
v_mfma_f32_16x16x32_bf16 v[52:55], a[44:47], v[92:95], v[52:55]
buffer_load_dwordx4 v[84:87], v19, s[12:15], s37 offen offset:1024 sc1
s_waitcnt lgkmcnt(8)
v_mfma_f32_16x16x32_bf16 v[24:27], a[0:3], v[96:99], v[24:27]
ds_read_b64_tr_b16 a[32:33], v12 offset:28672
s_waitcnt vmcnt(8)
v_mfma_f32_16x16x32_bf16 v[40:43], a[0:3], v[100:103], v[40:43]
ds_read_b64_tr_b16 a[34:35], v12 offset:30720
v_max3_u32 v2, v104, v108, v112
v_mfma_f32_16x16x32_bf16 v[28:31], a[4:7], v[96:99], v[28:31]
ds_read_b64_tr_b16 a[36:37], v13 offset:28672
v_max_u32 v2, v2, v116
v_mfma_f32_16x16x32_bf16 v[44:47], a[4:7], v[100:103], v[44:47]
ds_read_b64_tr_b16 a[38:39], v13 offset:30720
v_cmp_eq_u32 vcc, -1, v2
v_mfma_f32_16x16x32_bf16 v[32:35], a[8:11], v[96:99], v[32:35]
ds_read_b64_tr_b16 a[40:41], v14 offset:28672
v_mfma_f32_16x16x32_bf16 v[48:51], a[8:11], v[100:103], v[48:51]
ds_read_b64_tr_b16 a[42:43], v14 offset:30720
v_mfma_f32_16x16x32_bf16 v[36:39], a[12:15], v[96:99], v[36:39]
ds_read_b64_tr_b16 a[44:45], v15 offset:28672
ds_read_b64_tr_b16 a[46:47], v15 offset:30720
v_mfma_f32_16x16x32_bf16 v[52:55], a[12:15], v[100:103], v[52:55]
s_cbranch_vccnz L_o11_rt
L_o11_ok:
s_waitcnt lgkmcnt(8)
v_mfma_f32_16x16x32_bf16 v[24:27], a[16:19], v[104:107], v[24:27]
ds_read_b64_tr_b16 a[0:1], v12 offset:32768
ds_read_b64_tr_b16 a[2:3], v12 offset:34816
v_mfma_f32_16x16x32_bf16 v[40:43], a[16:19], v[108:111], v[40:43]
buffer_load_dwordx4 v[88:91], v6, s[12:15], s38 offen offset:0 sc1
v_mfma_f32_16x16x32_bf16 v[28:31], a[20:23], v[104:107], v[28:31]
ds_read_b64_tr_b16 a[4:5], v13 offset:32768
ds_read_b64_tr_b16 a[6:7], v13 offset:34816
v_mfma_f32_16x16x32_bf16 v[44:47], a[20:23], v[108:111], v[44:47]
buffer_load_dwordx4 v[92:95], v19, s[12:15], s38 offen offset:0 sc1
v_mfma_f32_16x16x32_bf16 v[32:35], a[24:27], v[104:107], v[32:35]
ds_read_b64_tr_b16 a[8:9], v14 offset:32768
ds_read_b64_tr_b16 a[10:11], v14 offset:34816
v_mfma_f32_16x16x32_bf16 v[48:51], a[24:27], v[108:111], v[48:51]
buffer_load_dwordx4 v[96:99], v6, s[12:15], s38 offen offset:1024 sc1
v_mfma_f32_16x16x32_bf16 v[36:39], a[28:31], v[104:107], v[36:39]
ds_read_b64_tr_b16 a[12:13], v15 offset:32768
ds_read_b64_tr_b16 a[14:15], v15 offset:34816
v_mfma_f32_16x16x32_bf16 v[52:55], a[28:31], v[108:111], v[52:55]
buffer_load_dwordx4 v[100:103], v19, s[12:15], s38 offen offset:1024 sc1
s_waitcnt lgkmcnt(8)
v_mfma_f32_16x16x32_bf16 v[24:27], a[32:35], v[112:115], v[24:27]
ds_read_b64_tr_b16 a[16:17], v12 offset:36864
s_waitcnt vmcnt(8)
v_mfma_f32_16x16x32_bf16 v[40:43], a[32:35], v[116:119], v[40:43]
ds_read_b64_tr_b16 a[18:19], v12 offset:38912
v_max3_u32 v2, v56, v60, v64
v_mfma_f32_16x16x32_bf16 v[28:31], a[36:39], v[112:115], v[28:31]
ds_read_b64_tr_b16 a[20:21], v13 offset:36864
v_max_u32 v2, v2, v68
v_mfma_f32_16x16x32_bf16 v[44:47], a[36:39], v[116:119], v[44:47]
ds_read_b64_tr_b16 a[22:23], v13 offset:38912
v_cmp_eq_u32 vcc, -1, v2
v_mfma_f32_16x16x32_bf16 v[32:35], a[40:43], v[112:115], v[32:35]
ds_read_b64_tr_b16 a[24:25], v14 offset:36864
v_mfma_f32_16x16x32_bf16 v[48:51], a[40:43], v[116:119], v[48:51]
ds_read_b64_tr_b16 a[26:27], v14 offset:38912
v_mfma_f32_16x16x32_bf16 v[36:39], a[44:47], v[112:115], v[36:39]
ds_read_b64_tr_b16 a[28:29], v15 offset:36864
ds_read_b64_tr_b16 a[30:31], v15 offset:38912
v_mfma_f32_16x16x32_bf16 v[52:55], a[44:47], v[116:119], v[52:55]
s_cbranch_vccnz L_o12_rt
L_o12_ok:
s_waitcnt lgkmcnt(8)
v_mfma_f32_16x16x32_bf16 v[24:27], a[0:3], v[56:59], v[24:27]
ds_read_b64_tr_b16 a[32:33], v12 offset:40960
ds_read_b64_tr_b16 a[34:35], v12 offset:43008
v_mfma_f32_16x16x32_bf16 v[40:43], a[0:3], v[60:63], v[40:43]
buffer_load_dwordx4 v[104:107], v6, s[12:15], s39 offen offset:0 sc1
v_mfma_f32_16x16x32_bf16 v[28:31], a[4:7], v[56:59], v[28:31]
ds_read_b64_tr_b16 a[36:37], v13 offset:40960
ds_read_b64_tr_b16 a[38:39], v13 offset:43008
v_mfma_f32_16x16x32_bf16 v[44:47], a[4:7], v[60:63], v[44:47]
buffer_load_dwordx4 v[108:111], v19, s[12:15], s39 offen offset:0 sc1
v_mfma_f32_16x16x32_bf16 v[32:35], a[8:11], v[56:59], v[32:35]
ds_read_b64_tr_b16 a[40:41], v14 offset:40960
ds_read_b64_tr_b16 a[42:43], v14 offset:43008
v_mfma_f32_16x16x32_bf16 v[48:51], a[8:11], v[60:63], v[48:51]
buffer_load_dwordx4 v[112:115], v6, s[12:15], s39 offen offset:1024 sc1
v_mfma_f32_16x16x32_bf16 v[36:39], a[12:15], v[56:59], v[36:39]
ds_read_b64_tr_b16 a[44:45], v15 offset:40960
ds_read_b64_tr_b16 a[46:47], v15 offset:43008
v_mfma_f32_16x16x32_bf16 v[52:55], a[12:15], v[60:63], v[52:55]
buffer_load_dwordx4 v[116:119], v19, s[12:15], s39 offen offset:1024 sc1
s_waitcnt lgkmcnt(8)
v_mfma_f32_16x16x32_bf16 v[24:27], a[16:19], v[64:67], v[24:27]
ds_read_b64_tr_b16 a[0:1], v12 offset:45056
s_waitcnt vmcnt(8)
v_mfma_f32_16x16x32_bf16 v[40:43], a[16:19], v[68:71], v[40:43]
ds_read_b64_tr_b16 a[2:3], v12 offset:47104
v_max3_u32 v2, v72, v76, v80
v_mfma_f32_16x16x32_bf16 v[28:31], a[20:23], v[64:67], v[28:31]
ds_read_b64_tr_b16 a[4:5], v13 offset:45056
v_max_u32 v2, v2, v84
v_mfma_f32_16x16x32_bf16 v[44:47], a[20:23], v[68:71], v[44:47]
ds_read_b64_tr_b16 a[6:7], v13 offset:47104
v_cmp_eq_u32 vcc, -1, v2
v_mfma_f32_16x16x32_bf16 v[32:35], a[24:27], v[64:67], v[32:35]
ds_read_b64_tr_b16 a[8:9], v14 offset:45056
v_mfma_f32_16x16x32_bf16 v[48:51], a[24:27], v[68:71], v[48:51]
ds_read_b64_tr_b16 a[10:11], v14 offset:47104
v_mfma_f32_16x16x32_bf16 v[36:39], a[28:31], v[64:67], v[36:39]
ds_read_b64_tr_b16 a[12:13], v15 offset:45056
ds_read_b64_tr_b16 a[14:15], v15 offset:47104
v_mfma_f32_16x16x32_bf16 v[52:55], a[28:31], v[68:71], v[52:55]
s_cbranch_vccnz L_o13_rt
L_o13_ok:
s_waitcnt lgkmcnt(8)
v_mfma_f32_16x16x32_bf16 v[24:27], a[32:35], v[72:75], v[24:27]
ds_read_b64_tr_b16 a[16:17], v12 offset:49152
ds_read_b64_tr_b16 a[18:19], v12 offset:51200
v_mfma_f32_16x16x32_bf16 v[40:43], a[32:35], v[76:79], v[40:43]
v_mfma_f32_16x16x32_bf16 v[28:31], a[36:39], v[72:75], v[28:31]
ds_read_b64_tr_b16 a[20:21], v13 offset:49152
ds_read_b64_tr_b16 a[22:23], v13 offset:51200
v_mfma_f32_16x16x32_bf16 v[44:47], a[36:39], v[76:79], v[44:47]
v_mfma_f32_16x16x32_bf16 v[32:35], a[40:43], v[72:75], v[32:35]
ds_read_b64_tr_b16 a[24:25], v14 offset:49152
ds_read_b64_tr_b16 a[26:27], v14 offset:51200
v_mfma_f32_16x16x32_bf16 v[48:51], a[40:43], v[76:79], v[48:51]
v_mfma_f32_16x16x32_bf16 v[36:39], a[44:47], v[72:75], v[36:39]
ds_read_b64_tr_b16 a[28:29], v15 offset:49152
ds_read_b64_tr_b16 a[30:31], v15 offset:51200
v_mfma_f32_16x16x32_bf16 v[52:55], a[44:47], v[76:79], v[52:55]
s_waitcnt lgkmcnt(8)
v_mfma_f32_16x16x32_bf16 v[24:27], a[0:3], v[80:83], v[24:27]
ds_read_b64_tr_b16 a[32:33], v12 offset:53248
s_waitcnt vmcnt(4)
v_mfma_f32_16x16x32_bf16 v[40:43], a[0:3], v[84:87], v[40:43]
ds_read_b64_tr_b16 a[34:35], v12 offset:55296
v_max3_u32 v2, v88, v92, v96
v_mfma_f32_16x16x32_bf16 v[28:31], a[4:7], v[80:83], v[28:31]
ds_read_b64_tr_b16 a[36:37], v13 offset:53248
v_max_u32 v2, v2, v100
v_mfma_f32_16x16x32_bf16 v[44:47], a[4:7], v[84:87], v[44:47]
ds_read_b64_tr_b16 a[38:39], v13 offset:55296
v_cmp_eq_u32 vcc, -1, v2
v_mfma_f32_16x16x32_bf16 v[32:35], a[8:11], v[80:83], v[32:35]
ds_read_b64_tr_b16 a[40:41], v14 offset:53248
v_mfma_f32_16x16x32_bf16 v[48:51], a[8:11], v[84:87], v[48:51]
ds_read_b64_tr_b16 a[42:43], v14 offset:55296
v_mfma_f32_16x16x32_bf16 v[36:39], a[12:15], v[80:83], v[36:39]
ds_read_b64_tr_b16 a[44:45], v15 offset:53248
ds_read_b64_tr_b16 a[46:47], v15 offset:55296
v_mfma_f32_16x16x32_bf16 v[52:55], a[12:15], v[84:87], v[52:55]
s_cbranch_vccnz L_o14_rt
L_o14_ok:
s_waitcnt lgkmcnt(8)
v_mfma_f32_16x16x32_bf16 v[24:27], a[16:19], v[88:91], v[24:27]
ds_read_b64_tr_b16 a[0:1], v12 offset:57344
ds_read_b64_tr_b16 a[2:3], v12 offset:59392
v_mfma_f32_16x16x32_bf16 v[40:43], a[16:19], v[92:95], v[40:43]
v_mfma_f32_16x16x32_bf16 v[28:31], a[20:23], v[88:91], v[28:31]
ds_read_b64_tr_b16 a[4:5], v13 offset:57344
ds_read_b64_tr_b16 a[6:7], v13 offset:59392
v_mfma_f32_16x16x32_bf16 v[44:47], a[20:23], v[92:95], v[44:47]
v_mfma_f32_16x16x32_bf16 v[32:35], a[24:27], v[88:91], v[32:35]
ds_read_b64_tr_b16 a[8:9], v14 offset:57344
ds_read_b64_tr_b16 a[10:11], v14 offset:59392
v_mfma_f32_16x16x32_bf16 v[48:51], a[24:27], v[92:95], v[48:51]
v_mfma_f32_16x16x32_bf16 v[36:39], a[28:31], v[88:91], v[36:39]
ds_read_b64_tr_b16 a[12:13], v15 offset:57344
ds_read_b64_tr_b16 a[14:15], v15 offset:59392
v_mfma_f32_16x16x32_bf16 v[52:55], a[28:31], v[92:95], v[52:55]
s_waitcnt lgkmcnt(8)
v_mfma_f32_16x16x32_bf16 v[24:27], a[32:35], v[96:99], v[24:27]
ds_read_b64_tr_b16 a[16:17], v12 offset:61440
s_waitcnt vmcnt(0)
v_mfma_f32_16x16x32_bf16 v[40:43], a[32:35], v[100:103], v[40:43]
ds_read_b64_tr_b16 a[18:19], v12 offset:63488
v_max3_u32 v2, v104, v108, v112
v_mfma_f32_16x16x32_bf16 v[28:31], a[36:39], v[96:99], v[28:31]
ds_read_b64_tr_b16 a[20:21], v13 offset:61440
v_max_u32 v2, v2, v116
v_mfma_f32_16x16x32_bf16 v[44:47], a[36:39], v[100:103], v[44:47]
ds_read_b64_tr_b16 a[22:23], v13 offset:63488
v_cmp_eq_u32 vcc, -1, v2
v_mfma_f32_16x16x32_bf16 v[32:35], a[40:43], v[96:99], v[32:35]
ds_read_b64_tr_b16 a[24:25], v14 offset:61440
v_mfma_f32_16x16x32_bf16 v[48:51], a[40:43], v[100:103], v[48:51]
ds_read_b64_tr_b16 a[26:27], v14 offset:63488
v_mfma_f32_16x16x32_bf16 v[36:39], a[44:47], v[96:99], v[36:39]
ds_read_b64_tr_b16 a[28:29], v15 offset:61440
ds_read_b64_tr_b16 a[30:31], v15 offset:63488
v_mfma_f32_16x16x32_bf16 v[52:55], a[44:47], v[100:103], v[52:55]
s_cbranch_vccnz L_o15_rt
L_o15_ok:
s_waitcnt lgkmcnt(8)
v_mfma_f32_16x16x32_bf16 v[24:27], a[0:3], v[104:107], v[24:27]
v_mfma_f32_16x16x32_bf16 v[40:43], a[0:3], v[108:111], v[40:43]
v_mfma_f32_16x16x32_bf16 v[28:31], a[4:7], v[104:107], v[28:31]
v_mfma_f32_16x16x32_bf16 v[44:47], a[4:7], v[108:111], v[44:47]
v_mfma_f32_16x16x32_bf16 v[32:35], a[8:11], v[104:107], v[32:35]
v_mfma_f32_16x16x32_bf16 v[48:51], a[8:11], v[108:111], v[48:51]
v_mfma_f32_16x16x32_bf16 v[36:39], a[12:15], v[104:107], v[36:39]
v_mfma_f32_16x16x32_bf16 v[52:55], a[12:15], v[108:111], v[52:55]
s_waitcnt lgkmcnt(0)
v_mfma_f32_16x16x32_bf16 v[24:27], a[16:19], v[112:115], v[24:27]
v_mfma_f32_16x16x32_bf16 v[40:43], a[16:19], v[116:119], v[40:43]
v_mfma_f32_16x16x32_bf16 v[28:31], a[20:23], v[112:115], v[28:31]
v_mfma_f32_16x16x32_bf16 v[44:47], a[20:23], v[116:119], v[44:47]
v_mfma_f32_16x16x32_bf16 v[32:35], a[24:27], v[112:115], v[32:35]
v_mfma_f32_16x16x32_bf16 v[48:51], a[24:27], v[116:119], v[48:51]
v_mfma_f32_16x16x32_bf16 v[36:39], a[28:31], v[112:115], v[36:39]
v_mfma_f32_16x16x32_bf16 v[52:55], a[28:31], v[116:119], v[52:55]
s_nop 0
v_cvt_pk_bf16_f32 v128, v24, v25
v_cvt_pk_bf16_f32 v129, v26, v27
v_cvt_pk_bf16_f32 v130, v28, v29
v_cvt_pk_bf16_f32 v131, v30, v31
v_cvt_pk_bf16_f32 v132, v32, v33
v_cvt_pk_bf16_f32 v133, v34, v35
v_cvt_pk_bf16_f32 v134, v36, v37
v_cvt_pk_bf16_f32 v135, v38, v39
v_cvt_pk_bf16_f32 v136, v40, v41
v_cvt_pk_bf16_f32 v137, v42, v43
v_cvt_pk_bf16_f32 v138, v44, v45
v_cvt_pk_bf16_f32 v139, v46, v47
v_cvt_pk_bf16_f32 v140, v48, v49
v_cvt_pk_bf16_f32 v141, v50, v51
v_cvt_pk_bf16_f32 v142, v52, v53
v_cvt_pk_bf16_f32 v143, v54, v55
v_mfma_f32_16x16x32_bf16 v[80:83], v[128:131], v[128:131], 0
v_mfma_f32_16x16x32_bf16 v[72:75], v[120:123], v[128:131], 0
v_mfma_f32_16x16x32_bf16 v[80:83], v[132:135], v[132:135], v[80:83]
v_mfma_f32_16x16x32_bf16 v[72:75], v[124:127], v[132:135], v[72:75]
v_mfma_f32_16x16x32_bf16 v[84:87], v[136:139], v[136:139], 0
v_mfma_f32_16x16x32_bf16 v[76:79], v[120:123], v[136:139], 0
v_mfma_f32_16x16x32_bf16 v[84:87], v[140:143], v[140:143], v[84:87]
v_mfma_f32_16x16x32_bf16 v[76:79], v[124:127], v[140:143], v[76:79]
s_nop 2
v_cndmask_b32_e64 v80, v80, v81, s[80:81]
v_cndmask_b32_e64 v82, v82, v83, s[90:91]
s_or_b64 vcc, s[82:83], s[90:91]
v_mov_b32 v75, s68
v_cndmask_b32 v73, v80, v82, vcc
v_cndmask_b32_e64 v84, v84, v85, s[80:81]
v_cndmask_b32_e64 v86, v86, v87, s[90:91]
s_or_b64 vcc, s[82:83], s[90:91]
v_mov_b32 v79, s68
v_cndmask_b32 v77, v84, v86, vcc
s_mov_b64 exec, s[92:93]
s_cmp_eq_u32 s69, 0
s_cbranch_scc1 L_stp_s
buffer_store_dwordx4 v[72:75], v144, s[12:15], s72 offen offset:0
buffer_store_dwordx4 v[76:79], v144, s[12:15], s72 offen offset:256
L_stp_d:
s_mov_b64 exec, -1
s_barrier
s_add_u32 s70, s75, 0
buffer_load_dwordx4 v[96:99], v145, s[12:15], s70 offen sc1
s_add_u32 s70, s75, 4096
buffer_load_dwordx4 v[100:103], v145, s[12:15], s70 offen sc1
s_add_u32 s70, s75, 8192
buffer_load_dwordx4 v[104:107], v145, s[12:15], s70 offen sc1
s_add_u32 s70, s75, 12288
buffer_load_dwordx4 v[108:111], v145, s[12:15], s70 offen sc1
s_add_u32 s70, s75, 16384
buffer_load_dwordx4 v[112:115], v145, s[12:15], s70 offen sc1
s_add_u32 s70, s75, 20480
buffer_load_dwordx4 v[116:119], v145, s[12:15], s70 offen sc1
s_add_u32 s70, s75, 24576
buffer_load_dwordx4 v[120:123], v145, s[12:15], s70 offen sc1
s_add_u32 s70, s75, 28672
buffer_load_dwordx4 v[124:127], v145, s[12:15], s70 offen sc1
ds_write_b64 v20, v[128:129] offset:0
ds_write_b64 v21, v[130:131] offset:0
ds_write_b64 v22, v[132:133] offset:0
ds_write_b64 v23, v[134:135] offset:0
ds_write_b64 v20, v[136:137] offset:2048
ds_write_b64 v21, v[138:139] offset:2048
ds_write_b64 v22, v[140:141] offset:2048
ds_write_b64 v23, v[142:143] offset:2048
v_lshrrev_b32 v2, 3, v1
v_lshrrev_b32 v3, 4, v1
v_and_b32 v13, 7, v1
v_xor_b32 v3, v3, v13
v_lshlrev_b32 v3, 4, v3
v_lshl_add_u32 v3, v2, 7, v3
s_lshl_b32 s70, s60, 12
v_add_u32 v9, s70, v3
v_xor_b32 v10, 64, v9
v_lshlrev_b32 v11, 11, v2
v_lshl_add_u32 v11, v13, 4, v11
v_mov_b32 v12, v2
s_lshl_b32 s76, s60, 12
s_lshl_b32 s74, s64, 18
s_lshl_b32 s70, s60, 16
s_add_u32 s74, s74, s70
s_lshl_b32 s70, s65, 7
s_add_u32 s74, s74, s70
s_mov_b32 s80, 0xff00ff00
s_mov_b32 s81, 0xff00ff00
s_lshl_b32 s70, s60, 5
s_add_u32 s70, s70, 161920
v_mov_b32 v14, s70
v_add_u32 v15, 16, v14
v_add_u32 v8, 161920, v16
v_lshlrev_b32 v8, 4, v13
v_add_u32 v8, 161920, v8
v_xor_b32 v17, 8192, v11
v_xor_b32 v17, s61, v17
s_waitcnt vmcnt(0)
L_st_chk:
v_xor_b32 v88, s68, v99
v_xor_b32 v89, s68, v103
v_xor_b32 v90, s68, v107
v_xor_b32 v91, s68, v111
v_xor_b32 v92, s68, v115
v_xor_b32 v93, s68, v119
v_xor_b32 v94, s68, v123
v_xor_b32 v95, s68, v127
v_or3_b32 v88, v88, v89, v90
v_or3_b32 v91, v91, v92, v93
v_or3_b32 v88, v88, v94, v95
v_or_b32 v88, v88, v91
v_cmp_ne_u32 vcc, 0, v88
s_cbranch_vccnz L_st_rt
L_st_ok:
v_pk_add_f32 v[96:97], v[96:97], v[100:101]
v_add_f32 v98, v98, v102
v_pk_add_f32 v[104:105], v[104:105], v[108:109]
v_add_f32 v106, v106, v110
v_pk_add_f32 v[112:113], v[112:113], v[116:117]
v_add_f32 v114, v114, v118
v_pk_add_f32 v[120:121], v[120:121], v[124:125]
v_add_f32 v122, v122, v126
v_pk_add_f32 v[96:97], v[96:97], v[104:105]
v_add_f32 v98, v98, v106
v_pk_add_f32 v[112:113], v[112:113], v[120:121]
v_add_f32 v114, v114, v122
v_pk_add_f32 v[96:97], v[96:97], v[112:113]
v_add_f32 v98, v98, v114
v_mov_b32 v100, v96
v_mov_b32 v101, v97
v_mov_b32 v102, v98
v_permlane32_swap_b32 v96, v100
v_permlane32_swap_b32 v97, v101
v_permlane32_swap_b32 v98, v102
v_add_f32 v96, v96, v100
v_add_f32 v97, v97, v101
v_add_f32 v98, v98, v102
v_mul_f32 v73, 0x3a800000, v96
v_mul_f32 v97, 0x3a800000, v97
v_fma_f32 v97, -v73, v73, v97
v_fma_f32 v98, -v73, s84, v98
v_max_f32 v97, 0, v97
v_add_f32 v97, 0x3727c5ac, v97
v_rsq_f32 v74, v97
v_mov_b32 v75, s68
v_mul_f32 v98, v98, v74
v_ashrrev_i32 v99, 31, v98
v_or_b32 v99, 0x80000000, v99
v_xor_b32 v98, v98, v99
s_mov_b32 s70, 0xfffff000
v_and_or_b32 v72, v98, s70, v146
s_nop 1
v_mov_b32_dpp v78, v72 row_ror:1 row_mask:0xf bank_mask:0xf
v_max_u32 v76, v72, v78
v_min_u32 v77, v72, v78
s_nop 0
v_mov_b32_dpp v78, v76 row_ror:2 row_mask:0xf bank_mask:0xf
v_max_u32_dpp v79, v77, v77 row_ror:2 row_mask:0xf bank_mask:0xf
v_med3_u32 v77, v76, v78, v79
v_max_u32 v76, v76, v78
s_nop 1
v_mov_b32_dpp v78, v76 row_ror:4 row_mask:0xf bank_mask:0xf
v_max_u32_dpp v79, v77, v77 row_ror:4 row_mask:0xf bank_mask:0xf
v_med3_u32 v77, v76, v78, v79
v_max_u32 v76, v76, v78
s_nop 1
v_mov_b32_dpp v78, v76 row_ror:8 row_mask:0xf bank_mask:0xf
v_max_u32_dpp v79, v77, v77 row_ror:8 row_mask:0xf bank_mask:0xf
v_med3_u32 v77, v76, v78, v79
v_max_u32 v76, v76, v78
v_mov_b32 v78, v76
v_mov_b32 v79, v77
s_nop 0
v_permlane16_swap_b32 v76, v78
v_permlane16_swap_b32 v77, v79
v_max_u32 v79, v77, v79
v_med3_u32 v77, v76, v78, v79
v_max_u32 v76, v76, v78
v_cmp_eq_u32 vcc, v72, v77
v_cmp_eq_u32_e64 s[92:93], v72, v76
s_nop 0
v_cndmask_b32 v2, v14, v15, vcc
v_addc_co_u32_e64 v72, s[72:73], 0, v72, vcc
s_or_b64 exec, vcc, s[92:93]
ds_write_b128 v2, v[72:75]
s_mov_b64 exec, -1
v_cndmask_b32_e64 v5, v76, v77, s[80:81]
v_bfe_u32 v6, v5, 8, 3
v_bfe_u32 v5, v5, 7, 5
v_xor_b32 v6, v6, v13
v_lshl_add_u32 v6, v6, 4, s76
v_lshl_add_u32 v6, v5, 7, v6
ds_read_b128 v[88:91], v6
v_readfirstlane_b32 s86, v77
v_readfirstlane_b32 s85, v76
v_add_f32 v80, 1.0, v74
v_mul_f32_e64 v56, -v73, v74
v_mov_b32 v82, v80
v_mov_b32 v58, v56
s_nop 0
v_permlane16_swap_b32 v80, v82
v_permlane16_swap_b32 v56, v58
s_waitcnt lgkmcnt(1)
s_barrier
s_sub_u32 s70, s64, s65
s_or_b32 s70, s70, s60
s_cbranch_scc1 L_norec
ds_read_b128 v[92:95], v8
s_lshl_b32 s70, s62, 3
s_lshl_b64 s[72:73], 0xff, s70
s_cmp_eq_u32 s69, 0
s_cselect_b64 s[72:73], 0, s[72:73]
s_andn2_b64 exec, -1, s[72:73]
s_waitcnt lgkmcnt(0)
buffer_store_dwordx4 v[92:95], v17, s[12:15], s87 offen sc1
s_mov_b64 exec, s[72:73]
buffer_store_dwordx4 v[92:95], v17, s[12:15], s87 offen
s_mov_b64 exec, -1
L_norec:
s_mov_b32 exec_hi, 0
s_waitcnt lgkmcnt(0)
buffer_store_dwordx4 v[88:91], v147, s[12:15], s88 offen sc1
s_mov_b64 exec, -1
s_bfe_u32 s95, s86, 0x50007
s_bfe_u32 s94, s85, 0x50007
s_add_u32 s86, s86, 1
v_pk_fma_f32 v[24:25], v[24:25], v[80:81], v[56:57] op_sel_hi:[1,0,0]
v_pk_fma_f32 v[26:27], v[26:27], v[80:81], v[56:57] op_sel_hi:[1,0,0]
v_cvt_pk_bf16_f32 v128, v24, v25
v_cvt_pk_bf16_f32 v129, v26, v27
ds_write_b64 v20, v[128:129] offset:32768
v_pk_fma_f32 v[28:29], v[28:29], v[80:81], v[56:57] op_sel_hi:[1,0,0]
v_pk_fma_f32 v[30:31], v[30:31], v[80:81], v[56:57] op_sel_hi:[1,0,0]
v_cvt_pk_bf16_f32 v130, v28, v29
v_cvt_pk_bf16_f32 v131, v30, v31
ds_write_b64 v21, v[130:131] offset:32768
v_pk_fma_f32 v[32:33], v[32:33], v[80:81], v[56:57] op_sel_hi:[1,0,0]
v_pk_fma_f32 v[34:35], v[34:35], v[80:81], v[56:57] op_sel_hi:[1,0,0]
v_cvt_pk_bf16_f32 v132, v32, v33
v_cvt_pk_bf16_f32 v133, v34, v35
ds_write_b64 v22, v[132:133] offset:32768
v_pk_fma_f32 v[36:37], v[36:37], v[80:81], v[56:57] op_sel_hi:[1,0,0]
v_pk_fma_f32 v[38:39], v[38:39], v[80:81], v[56:57] op_sel_hi:[1,0,0]
v_cvt_pk_bf16_f32 v134, v36, v37
v_cvt_pk_bf16_f32 v135, v38, v39
ds_write_b64 v23, v[134:135] offset:32768
v_pk_fma_f32 v[40:41], v[40:41], v[82:83], v[58:59] op_sel_hi:[1,0,0]
v_pk_fma_f32 v[42:43], v[42:43], v[82:83], v[58:59] op_sel_hi:[1,0,0]
v_cvt_pk_bf16_f32 v136, v40, v41
v_cvt_pk_bf16_f32 v137, v42, v43
ds_write_b64 v20, v[136:137] offset:34816
v_pk_fma_f32 v[44:45], v[44:45], v[82:83], v[58:59] op_sel_hi:[1,0,0]
v_pk_fma_f32 v[46:47], v[46:47], v[82:83], v[58:59] op_sel_hi:[1,0,0]
v_cvt_pk_bf16_f32 v138, v44, v45
v_cvt_pk_bf16_f32 v139, v46, v47
ds_write_b64 v21, v[138:139] offset:34816
v_pk_fma_f32 v[48:49], v[48:49], v[82:83], v[58:59] op_sel_hi:[1,0,0]
v_pk_fma_f32 v[50:51], v[50:51], v[82:83], v[58:59] op_sel_hi:[1,0,0]
v_cvt_pk_bf16_f32 v140, v48, v49
v_cvt_pk_bf16_f32 v141, v50, v51
ds_write_b64 v22, v[140:141] offset:34816
v_pk_fma_f32 v[52:53], v[52:53], v[82:83], v[58:59] op_sel_hi:[1,0,0]
v_pk_fma_f32 v[54:55], v[54:55], v[82:83], v[58:59] op_sel_hi:[1,0,0]
v_cvt_pk_bf16_f32 v142, v52, v53
v_cvt_pk_bf16_f32 v143, v54, v55
ds_write_b64 v23, v[142:143] offset:34816
s_waitcnt lgkmcnt(0)
ds_read_b128 v[96:99], v9 offset:32768
ds_read_b128 v[100:103], v10 offset:33792
ds_read_b128 v[104:107], v9 offset:34816
ds_read_b128 v[108:111], v10 offset:35840
v_add_u32 v2, 0, v12
v_cmp_ne_u32 vcc, s94, v2
v_cmp_ne_u32_e64 s[92:93], s95, v2
s_add_u32 s70, s74, 0
s_waitcnt lgkmcnt(3)
s_and_b64 exec, vcc, s[92:93]
buffer_store_dwordx4 v[96:99], v11, s[20:23], s70 offen nt
s_mov_b64 exec, -1
v_add_u32 v2, 8, v12
v_cmp_ne_u32 vcc, s94, v2
v_cmp_ne_u32_e64 s[92:93], s95, v2
s_add_u32 s70, s74, 16384
s_waitcnt lgkmcnt(2)
s_and_b64 exec, vcc, s[92:93]
buffer_store_dwordx4 v[100:103], v11, s[20:23], s70 offen nt
s_mov_b64 exec, -1
v_add_u32 v2, 16, v12
v_cmp_ne_u32 vcc, s94, v2
v_cmp_ne_u32_e64 s[92:93], s95, v2
s_add_u32 s70, s74, 32768
s_waitcnt lgkmcnt(1)
s_and_b64 exec, vcc, s[92:93]
buffer_store_dwordx4 v[104:107], v11, s[20:23], s70 offen nt
s_mov_b64 exec, -1
v_add_u32 v2, 24, v12
v_cmp_ne_u32 vcc, s94, v2
v_cmp_ne_u32_e64 s[92:93], s95, v2
s_add_u32 s70, s74, 49152
s_waitcnt lgkmcnt(0)
s_and_b64 exec, vcc, s[92:93]
buffer_store_dwordx4 v[108:111], v11, s[20:23], s70 offen nt
s_mov_b64 exec, -1
v_mov_b32 v2, 161792
s_barrier
ds_read_b32 v3, v2
ds_read_b32 v4, v2 offset:16
s_waitcnt lgkmcnt(0)
v_readfirstlane_b32 s72, v3
v_readfirstlane_b32 s73, v4
s_cmp_eq_u32 s85, s72
s_cselect_b32 s94, 255, s94
s_cmp_eq_u32 s85, s73
s_cselect_b32 s94, 255, s94
s_cmp_eq_u32 s86, s72
s_cselect_b32 s95, 255, s95
s_cmp_eq_u32 s86, s73
s_cselect_b32 s95, 255, s95
v_add_u32 v2, 0, v12
v_cmp_eq_u32 vcc, s94, v2
v_cmp_eq_u32_e64 s[92:93], s95, v2
s_add_u32 s70, s74, 0
s_or_b64 exec, vcc, s[92:93]
s_cbranch_execz L_nodef0
buffer_store_dwordx4 v[96:99], v11, s[20:23], s70 offen nt
L_nodef0:
s_mov_b64 exec, -1
v_add_u32 v2, 8, v12
v_cmp_eq_u32 vcc, s94, v2
v_cmp_eq_u32_e64 s[92:93], s95, v2
s_add_u32 s70, s74, 16384
s_or_b64 exec, vcc, s[92:93]
s_cbranch_execz L_nodef1
buffer_store_dwordx4 v[100:103], v11, s[20:23], s70 offen nt
L_nodef1:
s_mov_b64 exec, -1
v_add_u32 v2, 16, v12
v_cmp_eq_u32 vcc, s94, v2
v_cmp_eq_u32_e64 s[92:93], s95, v2
s_add_u32 s70, s74, 32768
s_or_b64 exec, vcc, s[92:93]
s_cbranch_execz L_nodef2
buffer_store_dwordx4 v[104:107], v11, s[20:23], s70 offen nt
L_nodef2:
s_mov_b64 exec, -1
v_add_u32 v2, 24, v12
v_cmp_eq_u32 vcc, s94, v2
v_cmp_eq_u32_e64 s[92:93], s95, v2
s_add_u32 s70, s74, 49152
s_or_b64 exec, vcc, s[92:93]
s_cbranch_execz L_nodef3
buffer_store_dwordx4 v[108:111], v11, s[20:23], s70 offen nt
L_nodef3:
s_mov_b64 exec, -1
L_end:
s_endpgm
L_eg_rt:
s_add_u32 s78, s78, 1
s_cmp_gt_u32 s78, 65536
s_cbranch_scc1 L_eg_ok
s_add_u32 s70, s87, 0
buffer_load_dwordx4 v[20:23], v44, s[12:15], s70 offen sc1
buffer_load_dwordx4 v[36:39], v45, s[12:15], s88 offen sc1
buffer_load_dwordx4 v[40:43], v46, s[12:15], 0 offen offset:0 sc1
buffer_load_dword v47, v48, s[12:15], 0 offen sc1
s_waitcnt vmcnt(0)
s_branch L_eg_chk
L_pad8:
s_branch L_retF
L_kvrt:
s_add_u32 s78, s78, 1
s_cmp_gt_u32 s78, 65536
s_cbranch_scc1 L_kvok
s_bitcmp1_b32 s73, 0
s_cbranch_scc0 L_kvn0
v_cmp_eq_u32 vcc, -1, v84
s_cbranch_vccz L_kv0_p0
s_add_u32 s70, s65, 1
s_and_b32 s70, s70, 15
s_mul_i32 s70, s70, 4352
s_add_u32 s70, s70, s87
buffer_load_dwordx4 v[84:87], v18, s[12:15], s70 offen sc1
L_kv0_p0:
v_cmp_eq_u32 vcc, -1, v88
s_cbranch_vccz L_kv0_p1
s_add_u32 s70, s65, 2
s_and_b32 s70, s70, 15
s_mul_i32 s70, s70, 4352
s_add_u32 s70, s70, s87
buffer_load_dwordx4 v[88:91], v18, s[12:15], s70 offen sc1
L_kv0_p1:
v_cmp_eq_u32 vcc, -1, v92
s_cbranch_vccz L_kv0_p2
s_add_u32 s70, s65, 3
s_and_b32 s70, s70, 15
s_mul_i32 s70, s70, 4352
s_add_u32 s70, s70, s87
buffer_load_dwordx4 v[92:95], v18, s[12:15], s70 offen sc1
L_kv0_p2:
v_cmp_eq_u32 vcc, -1, v96
s_cbranch_vccz L_kv0_p3
s_add_u32 s70, s65, 4
s_and_b32 s70, s70, 15
s_mul_i32 s70, s70, 4352
s_add_u32 s70, s70, s87
buffer_load_dwordx4 v[96:99], v18, s[12:15], s70 offen sc1
L_kv0_p3:
L_kvn0:
s_bitcmp1_b32 s73, 1
s_cbranch_scc0 L_kvn1
v_cmp_eq_u32 vcc, -1, v100
s_cbranch_vccz L_kv1_p0
s_add_u32 s70, s65, 5
s_and_b32 s70, s70, 15
s_mul_i32 s70, s70, 4352
s_add_u32 s70, s70, s87
buffer_load_dwordx4 v[100:103], v18, s[12:15], s70 offen sc1
L_kv1_p0:
v_cmp_eq_u32 vcc, -1, v104
s_cbranch_vccz L_kv1_p1
s_add_u32 s70, s65, 6
s_and_b32 s70, s70, 15
s_mul_i32 s70, s70, 4352
s_add_u32 s70, s70, s87
buffer_load_dwordx4 v[104:107], v18, s[12:15], s70 offen sc1
L_kv1_p1:
v_cmp_eq_u32 vcc, -1, v108
s_cbranch_vccz L_kv1_p2
s_add_u32 s70, s65, 7
s_and_b32 s70, s70, 15
s_mul_i32 s70, s70, 4352
s_add_u32 s70, s70, s87
buffer_load_dwordx4 v[108:111], v18, s[12:15], s70 offen sc1
L_kv1_p2:
v_cmp_eq_u32 vcc, -1, v112
s_cbranch_vccz L_kv1_p3
s_add_u32 s70, s65, 8
s_and_b32 s70, s70, 15
s_mul_i32 s70, s70, 4352
s_add_u32 s70, s70, s87
buffer_load_dwordx4 v[112:115], v18, s[12:15], s70 offen sc1
L_kv1_p3:
L_kvn1:
s_bitcmp1_b32 s73, 2
s_cbranch_scc0 L_kvn2
s_branch L_over9
L_pad9:
s_branch L_pad13
L_over9:
v_cmp_eq_u32 vcc, -1, v116
s_cbranch_vccz L_kv2_p0
s_add_u32 s70, s65, 9
s_and_b32 s70, s70, 15
s_mul_i32 s70, s70, 4352
s_add_u32 s70, s70, s87
buffer_load_dwordx4 v[116:119], v18, s[12:15], s70 offen sc1
L_kv2_p0:
v_cmp_eq_u32 vcc, -1, v120
s_cbranch_vccz L_kv2_p1
s_add_u32 s70, s65, 10
s_and_b32 s70, s70, 15
s_mul_i32 s70, s70, 4352
s_add_u32 s70, s70, s87
buffer_load_dwordx4 v[120:123], v18, s[12:15], s70 offen sc1
L_kv2_p1:
v_cmp_eq_u32 vcc, -1, v124
s_cbranch_vccz L_kv2_p2
s_add_u32 s70, s65, 11
s_and_b32 s70, s70, 15
s_mul_i32 s70, s70, 4352
s_add_u32 s70, s70, s87
buffer_load_dwordx4 v[124:127], v18, s[12:15], s70 offen sc1
L_kv2_p2:
v_cmp_eq_u32 vcc, -1, v128
s_cbranch_vccz L_kv2_p3
s_add_u32 s70, s65, 12
s_and_b32 s70, s70, 15
s_mul_i32 s70, s70, 4352
s_add_u32 s70, s70, s87
buffer_load_dwordx4 v[128:131], v18, s[12:15], s70 offen sc1
L_kv2_p3:
L_kvn2:
s_bitcmp1_b32 s73, 3
s_cbranch_scc0 L_kvn3
v_cmp_eq_u32 vcc, -1, v132
s_cbranch_vccz L_kv3_p0
s_add_u32 s70, s65, 13
s_and_b32 s70, s70, 15
s_mul_i32 s70, s70, 4352
s_add_u32 s70, s70, s87
buffer_load_dwordx4 v[132:135], v18, s[12:15], s70 offen sc1
L_kv3_p0:
v_cmp_eq_u32 vcc, -1, v136
s_cbranch_vccz L_kv3_p1
s_add_u32 s70, s65, 14
s_and_b32 s70, s70, 15
s_mul_i32 s70, s70, 4352
s_add_u32 s70, s70, s87
buffer_load_dwordx4 v[136:139], v18, s[12:15], s70 offen sc1
L_kv3_p1:
v_cmp_eq_u32 vcc, -1, v140
s_cbranch_vccz L_kv3_p2
s_add_u32 s70, s65, 15
s_and_b32 s70, s70, 15
s_mul_i32 s70, s70, 4352
s_add_u32 s70, s70, s87
buffer_load_dwordx4 v[140:143], v18, s[12:15], s70 offen sc1
L_kv3_p2:
v_cmp_eq_u32 vcc, -1, v144
s_cbranch_vccz L_kv3_p3
s_add_u32 s70, s65, 16
s_and_b32 s70, s70, 15
s_mul_i32 s70, s70, 4352
s_add_u32 s70, s70, s87
buffer_load_dwordx4 v[144:147], v18, s[12:15], s70 offen sc1
L_kv3_p3:
L_kvn3:
s_bitcmp1_b32 s73, 4
s_cbranch_scc0 L_kvn4
buffer_load_dwordx4 v[148:151], v55, s[12:15], s88 offen sc1
L_kvn4:
s_waitcnt vmcnt(0)
s_branch L_kvr
L_pad10:
s_branch L_pad15
L_pksame:
s_cmp_eq_u32 s73, 0
s_cbranch_scc1 L_pkf
s_add_u32 s78, s78, 1
s_cmp_le_u32 s78, 65536
s_cbranch_scc1 L_pk
s_branch L_pkf
L_pkx_rt:
s_add_u32 s78, s78, 1
s_cmp_gt_u32 s78, 65536
s_cbranch_scc1 L_pkx_ok
s_mov_b64 exec, s[92:93]
buffer_load_dwordx4 v[24:27], v58, s[12:15], 0 offen offset:0 sc1
buffer_load_dwordx4 v[28:31], v58, s[12:15], 0 offen offset:64 sc1
buffer_load_dwordx4 v[32:35], v58, s[12:15], 0 offen offset:128 sc1
buffer_load_dwordx4 v[36:39], v58, s[12:15], 0 offen offset:192 sc1
buffer_load_dwordx4 v[40:43], v58, s[12:15], 0 offen offset:256 sc1
buffer_load_dwordx4 v[44:47], v58, s[12:15], 0 offen offset:320 sc1
buffer_load_dwordx4 v[48:51], v58, s[12:15], 0 offen offset:384 sc1
buffer_load_dwordx4 v[52:55], v58, s[12:15], 0 offen offset:448 sc1
s_mov_b64 exec, -1
v_mul_f32_e64 v84, v68, -v21
v_mul_f32_e64 v85, v69, -v21
v_mul_f32_e64 v86, v70, -v21
v_mul_f32_e64 v87, v71, -v21
v_mul_f32_e64 v88, v72, -v21
v_mul_f32_e64 v89, v73, -v21
v_mul_f32_e64 v90, v74, -v21
v_mul_f32_e64 v91, v75, -v21
s_branch L_pkf
L_pxp_s:
buffer_store_dwordx4 v[84:87], v60, s[12:15], s85 offen sc1
s_branch L_pxp_d
L_pad11:
s_branch L_pad16
L_px_rt:
s_add_u32 s78, s78, 1
s_cmp_gt_u32 s78, 65536
s_cbranch_scc1 L_px_ok
v_and_b32 v2, s91, v24
v_cmp_ne_u32 vcc, 0, v2
v_xor_b32 v24, s84, v24
s_cbranch_vccz L_px_p0
buffer_load_dwordx4 v[24:27], v61, s[12:15], s86 offen offset:0 sc1
L_px_p0:
v_and_b32 v2, s91, v28
v_cmp_ne_u32 vcc, 0, v2
v_xor_b32 v28, s84, v28
s_cbranch_vccz L_px_p1
buffer_load_dwordx4 v[28:31], v61, s[12:15], s86 offen offset:1024 sc1
L_px_p1:
v_and_b32 v2, s91, v32
v_cmp_ne_u32 vcc, 0, v2
v_xor_b32 v32, s84, v32
s_cbranch_vccz L_px_p2
buffer_load_dwordx4 v[32:35], v61, s[12:15], s86 offen offset:2048 sc1
L_px_p2:
v_and_b32 v2, s91, v36
v_cmp_ne_u32 vcc, 0, v2
v_xor_b32 v36, s84, v36
s_cbranch_vccz L_px_p3
buffer_load_dwordx4 v[36:39], v61, s[12:15], s86 offen offset:3072 sc1
L_px_p3:
s_waitcnt vmcnt(0)
s_branch L_px_chk
L_pad12:
s_branch L_pad17
L_yown:
v_bfi_b32 v40, s91, v59, v40
buffer_store_dwordx4 v[40:43], v62, s[12:15], s88 offen
s_add_u32 s88, s88, 16384
v_bfi_b32 v44, s91, v59, v44
buffer_store_dwordx4 v[44:47], v62, s[12:15], s88 offen
s_add_u32 s88, s88, 16384
v_bfi_b32 v48, s91, v59, v48
buffer_store_dwordx4 v[48:51], v62, s[12:15], s88 offen
s_add_u32 s88, s88, 16384
v_bfi_b32 v52, s91, v59, v52
buffer_store_dwordx4 v[52:55], v62, s[12:15], s88 offen
s_branch L_yd
L_h_rt:
s_add_u32 s78, s78, 1
s_cmp_gt_u32 s78, 65536
s_cbranch_scc1 L_h_ok
buffer_load_ushort v84, v64, s[12:15], s72 offen sc1
s_waitcnt vmcnt(0)
s_branch L_h_chk
L_pad13:
s_branch L_pad18
L_y_rt:
s_add_u32 s78, s78, 1
s_cmp_gt_u32 s78, 65536
s_cbranch_scc1 L_yf0
buffer_load_dwordx4 v[120:123], v18, s[12:15], s88 offen offset:0 sc1
buffer_load_dwordx4 v[124:127], v18, s[12:15], s88 offen offset:1024 sc1
buffer_load_dwordx4 v[128:131], v18, s[12:15], s88 offen offset:2048 sc1
buffer_load_dwordx4 v[132:135], v18, s[12:15], s88 offen offset:3072 sc1
buffer_load_dwordx4 v[136:139], v18, s[12:15], s71 offen offset:0 sc1
buffer_load_dwordx4 v[140:143], v18, s[12:15], s71 offen offset:1024 sc1
buffer_load_dwordx4 v[144:147], v18, s[12:15], s71 offen offset:2048 sc1
v_mov_b32 v88, s84
s_waitcnt vmcnt(14)
v_xor_b32 v24, s84, v24
v_xor_b32 v28, s84, v28
v_xor_b32 v32, s84, v32
v_xor_b32 v36, s84, v36
v_or3_b32 v2, v24, v28, v32
v_xor_b32 v92, s84, v92
v_xor_b32 v96, s84, v96
v_or3_b32 v2, v2, v36, v92
v_xor_b32 v100, s84, v100
v_xor_b32 v88, s84, v88
v_or3_b32 v2, v2, v96, v100
v_bitop3_b32 v2, v2, v88, s91 bitop3:0xa8
v_cmp_ne_u32 vcc, 0, v2
s_cbranch_vccz L_yf1
buffer_load_dwordx4 v[24:27], v18, s[12:15], s88 offen offset:0 sc1
buffer_load_dwordx4 v[28:31], v18, s[12:15], s88 offen offset:1024 sc1
buffer_load_dwordx4 v[32:35], v18, s[12:15], s88 offen offset:2048 sc1
buffer_load_dwordx4 v[36:39], v18, s[12:15], s88 offen offset:3072 sc1
buffer_load_dwordx4 v[92:95], v18, s[12:15], s71 offen offset:0 sc1
buffer_load_dwordx4 v[96:99], v18, s[12:15], s71 offen offset:1024 sc1
buffer_load_dwordx4 v[100:103], v18, s[12:15], s71 offen offset:2048 sc1
v_mov_b32 v88, s84
s_waitcnt vmcnt(14)
v_xor_b32 v40, s84, v40
v_xor_b32 v44, s84, v44
v_xor_b32 v48, s84, v48
v_xor_b32 v52, s84, v52
v_or3_b32 v2, v40, v44, v48
v_xor_b32 v104, s84, v104
v_xor_b32 v108, s84, v108
v_or3_b32 v2, v2, v52, v104
v_xor_b32 v112, s84, v112
v_xor_b32 v88, s84, v88
v_or3_b32 v2, v2, v108, v112
v_bitop3_b32 v2, v2, v88, s91 bitop3:0xa8
v_cmp_ne_u32 vcc, 0, v2
s_cbranch_vccz L_yf2
buffer_load_dwordx4 v[40:43], v18, s[12:15], s88 offen offset:0 sc1
buffer_load_dwordx4 v[44:47], v18, s[12:15], s88 offen offset:1024 sc1
buffer_load_dwordx4 v[48:51], v18, s[12:15], s88 offen offset:2048 sc1
buffer_load_dwordx4 v[52:55], v18, s[12:15], s88 offen offset:3072 sc1
buffer_load_dwordx4 v[104:107], v18, s[12:15], s71 offen offset:0 sc1
buffer_load_dwordx4 v[108:111], v18, s[12:15], s71 offen offset:1024 sc1
buffer_load_dwordx4 v[112:115], v18, s[12:15], s71 offen offset:2048 sc1
v_mov_b32 v88, s84
s_branch L_yr
L_yf1:
v_pk_add_f32 v[24:25], v[24:25], v[28:29]
v_pk_add_f32 v[26:27], v[26:27], v[30:31]
v_pk_add_f32 v[32:33], v[32:33], v[36:37]
v_pk_add_f32 v[34:35], v[34:35], v[38:39]
v_pk_add_f32 v[92:93], v[92:93], v[96:97]
v_pk_add_f32 v[94:95], v[94:95], v[98:99]
v_pk_add_f32 v[24:25], v[24:25], v[32:33]
v_pk_add_f32 v[26:27], v[26:27], v[34:35]
v_pk_add_f32 v[92:93], v[92:93], v[100:101]
v_pk_add_f32 v[94:95], v[94:95], v[102:103]
v_pk_add_f32 v[24:25], v[24:25], v[92:93]
v_pk_add_f32 v[26:27], v[26:27], v[94:95]
s_nop 1
v_permlane32_swap_b32 v24, v26
v_permlane32_swap_b32 v25, v27
v_add_f32 v68, v24, v26
v_add_f32 v69, v25, v27
s_nop 0
s_branch L_yf
L_yf2:
v_pk_add_f32 v[40:41], v[40:41], v[44:45]
v_pk_add_f32 v[42:43], v[42:43], v[46:47]
v_pk_add_f32 v[48:49], v[48:49], v[52:53]
v_pk_add_f32 v[50:51], v[50:51], v[54:55]
v_pk_add_f32 v[104:105], v[104:105], v[108:109]
v_pk_add_f32 v[106:107], v[106:107], v[110:111]
v_pk_add_f32 v[40:41], v[40:41], v[48:49]
v_pk_add_f32 v[42:43], v[42:43], v[50:51]
v_pk_add_f32 v[104:105], v[104:105], v[112:113]
v_pk_add_f32 v[106:107], v[106:107], v[114:115]
v_pk_add_f32 v[40:41], v[40:41], v[104:105]
v_pk_add_f32 v[42:43], v[42:43], v[106:107]
s_nop 1
v_permlane32_swap_b32 v40, v42
v_permlane32_swap_b32 v41, v43
v_add_f32 v68, v40, v42
v_add_f32 v69, v41, v43
s_nop 0
s_branch L_yf
L_kvp_s:
buffer_store_dwordx4 v[140:143], v16, s[12:15], s72 offen sc1
s_mov_b64 exec, s[92:93]
buffer_store_dwordx4 v[136:139], v4, s[12:15], s73 offen sc1
s_mov_b64 exec, -1
s_branch L_kvp_d
L_pad14:
s_branch L_retF
L_oown0:
buffer_store_dwordx4 v[52:55], v16, s[12:15], s70 offen
s_branch L_ood0
L_oown1:
buffer_store_dwordx4 v[76:79], v16, s[12:15], s70 offen
s_branch L_ood1
L_oown2:
buffer_store_dwordx4 v[100:103], v16, s[12:15], s70 offen
s_branch L_ood2
L_oown3:
buffer_store_dwordx4 v[124:127], v16, s[12:15], s70 offen
s_branch L_ood3
L_pad15:
s_branch L_retG
L_o0_rt:
s_add_u32 s78, s78, 1
s_cmp_gt_u32 s78, 65536
s_cbranch_scc1 L_o0_ok
buffer_load_dwordx4 v[56:59], v6, s[12:15], s24 offen offset:0 sc1
buffer_load_dwordx4 v[60:63], v19, s[12:15], s24 offen offset:0 sc1
buffer_load_dwordx4 v[64:67], v6, s[12:15], s24 offen offset:1024 sc1
buffer_load_dwordx4 v[68:71], v19, s[12:15], s24 offen offset:1024 sc1
s_waitcnt vmcnt(4)
v_max3_u32 v2, v72, v76, v80
v_max3_u32 v2, v2, v84, v88
v_max3_u32 v2, v2, v92, v96
v_max3_u32 v2, v2, v100, v100
v_cmp_eq_u32 vcc, -1, v2
s_cbranch_vccz L_o0_a
buffer_load_dwordx4 v[72:75], v6, s[12:15], s25 offen offset:0 sc1
buffer_load_dwordx4 v[76:79], v19, s[12:15], s25 offen offset:0 sc1
buffer_load_dwordx4 v[80:83], v6, s[12:15], s25 offen offset:1024 sc1
buffer_load_dwordx4 v[84:87], v19, s[12:15], s25 offen offset:1024 sc1
buffer_load_dwordx4 v[88:91], v6, s[12:15], s26 offen offset:0 sc1
buffer_load_dwordx4 v[92:95], v19, s[12:15], s26 offen offset:0 sc1
buffer_load_dwordx4 v[96:99], v6, s[12:15], s26 offen offset:1024 sc1
buffer_load_dwordx4 v[100:103], v19, s[12:15], s26 offen offset:1024 sc1
s_waitcnt vmcnt(8)
s_branch L_o0_b
L_o0_a:
s_waitcnt vmcnt(0)
L_o0_b:
v_max3_u32 v2, v56, v60, v64
v_max_u32 v2, v2, v68
v_cmp_eq_u32 vcc, -1, v2
s_cbranch_vccnz L_o0_rt
s_branch L_o0_ok
L_pad16:
s_branch L_retG
L_o1_rt:
s_add_u32 s78, s78, 1
s_cmp_gt_u32 s78, 65536
s_cbranch_scc1 L_o1_ok
buffer_load_dwordx4 v[72:75], v6, s[12:15], s25 offen offset:0 sc1
buffer_load_dwordx4 v[76:79], v19, s[12:15], s25 offen offset:0 sc1
buffer_load_dwordx4 v[80:83], v6, s[12:15], s25 offen offset:1024 sc1
buffer_load_dwordx4 v[84:87], v19, s[12:15], s25 offen offset:1024 sc1
s_waitcnt vmcnt(4)
v_max3_u32 v2, v88, v92, v96
v_max3_u32 v2, v2, v100, v104
v_max3_u32 v2, v2, v108, v112
v_max3_u32 v2, v2, v116, v116
v_cmp_eq_u32 vcc, -1, v2
s_cbranch_vccz L_o1_a
buffer_load_dwordx4 v[88:91], v6, s[12:15], s26 offen offset:0 sc1
buffer_load_dwordx4 v[92:95], v19, s[12:15], s26 offen offset:0 sc1
buffer_load_dwordx4 v[96:99], v6, s[12:15], s26 offen offset:1024 sc1
buffer_load_dwordx4 v[100:103], v19, s[12:15], s26 offen offset:1024 sc1
buffer_load_dwordx4 v[104:107], v6, s[12:15], s27 offen offset:0 sc1
buffer_load_dwordx4 v[108:111], v19, s[12:15], s27 offen offset:0 sc1
buffer_load_dwordx4 v[112:115], v6, s[12:15], s27 offen offset:1024 sc1
buffer_load_dwordx4 v[116:119], v19, s[12:15], s27 offen offset:1024 sc1
s_waitcnt vmcnt(8)
s_branch L_o1_b
L_o1_a:
s_waitcnt vmcnt(0)
L_o1_b:
v_max3_u32 v2, v72, v76, v80
v_max_u32 v2, v2, v84
v_cmp_eq_u32 vcc, -1, v2
s_cbranch_vccnz L_o1_rt
s_branch L_o1_ok
L_o2_rt:
s_add_u32 s78, s78, 1
s_cmp_gt_u32 s78, 65536
s_cbranch_scc1 L_o2_ok
buffer_load_dwordx4 v[88:91], v6, s[12:15], s26 offen offset:0 sc1
buffer_load_dwordx4 v[92:95], v19, s[12:15], s26 offen offset:0 sc1
buffer_load_dwordx4 v[96:99], v6, s[12:15], s26 offen offset:1024 sc1
buffer_load_dwordx4 v[100:103], v19, s[12:15], s26 offen offset:1024 sc1
s_waitcnt vmcnt(4)
v_max3_u32 v2, v104, v108, v112
v_max3_u32 v2, v2, v116, v56
v_max3_u32 v2, v2, v60, v64
v_max3_u32 v2, v2, v68, v68
v_cmp_eq_u32 vcc, -1, v2
s_cbranch_vccz L_o2_a
buffer_load_dwordx4 v[104:107], v6, s[12:15], s27 offen offset:0 sc1
buffer_load_dwordx4 v[108:111], v19, s[12:15], s27 offen offset:0 sc1
buffer_load_dwordx4 v[112:115], v6, s[12:15], s27 offen offset:1024 sc1
buffer_load_dwordx4 v[116:119], v19, s[12:15], s27 offen offset:1024 sc1
buffer_load_dwordx4 v[56:59], v6, s[12:15], s28 offen offset:0 sc1
buffer_load_dwordx4 v[60:63], v19, s[12:15], s28 offen offset:0 sc1
buffer_load_dwordx4 v[64:67], v6, s[12:15], s28 offen offset:1024 sc1
buffer_load_dwordx4 v[68:71], v19, s[12:15], s28 offen offset:1024 sc1
s_waitcnt vmcnt(8)
s_branch L_o2_b
L_o2_a:
s_waitcnt vmcnt(0)
L_o2_b:
v_max3_u32 v2, v88, v92, v96
v_max_u32 v2, v2, v100
v_cmp_eq_u32 vcc, -1, v2
s_cbranch_vccnz L_o2_rt
s_branch L_o2_ok
L_o3_rt:
s_add_u32 s78, s78, 1
s_cmp_gt_u32 s78, 65536
s_cbranch_scc1 L_o3_ok
buffer_load_dwordx4 v[104:107], v6, s[12:15], s27 offen offset:0 sc1
buffer_load_dwordx4 v[108:111], v19, s[12:15], s27 offen offset:0 sc1
buffer_load_dwordx4 v[112:115], v6, s[12:15], s27 offen offset:1024 sc1
buffer_load_dwordx4 v[116:119], v19, s[12:15], s27 offen offset:1024 sc1
s_waitcnt vmcnt(4)
v_max3_u32 v2, v56, v60, v64
v_max3_u32 v2, v2, v68, v72
v_max3_u32 v2, v2, v76, v80
v_max3_u32 v2, v2, v84, v84
v_cmp_eq_u32 vcc, -1, v2
s_cbranch_vccz L_o3_a
buffer_load_dwordx4 v[56:59], v6, s[12:15], s28 offen offset:0 sc1
buffer_load_dwordx4 v[60:63], v19, s[12:15], s28 offen offset:0 sc1
buffer_load_dwordx4 v[64:67], v6, s[12:15], s28 offen offset:1024 sc1
buffer_load_dwordx4 v[68:71], v19, s[12:15], s28 offen offset:1024 sc1
buffer_load_dwordx4 v[72:75], v6, s[12:15], s29 offen offset:0 sc1
buffer_load_dwordx4 v[76:79], v19, s[12:15], s29 offen offset:0 sc1
buffer_load_dwordx4 v[80:83], v6, s[12:15], s29 offen offset:1024 sc1
buffer_load_dwordx4 v[84:87], v19, s[12:15], s29 offen offset:1024 sc1
s_waitcnt vmcnt(8)
s_branch L_o3_b
L_o3_a:
s_waitcnt vmcnt(0)
L_o3_b:
v_max3_u32 v2, v104, v108, v112
v_max_u32 v2, v2, v116
v_cmp_eq_u32 vcc, -1, v2
s_cbranch_vccnz L_o3_rt
s_branch L_o3_ok
L_o4_rt:
s_add_u32 s78, s78, 1
s_cmp_gt_u32 s78, 65536
s_cbranch_scc1 L_o4_ok
buffer_load_dwordx4 v[56:59], v6, s[12:15], s28 offen offset:0 sc1
buffer_load_dwordx4 v[60:63], v19, s[12:15], s28 offen offset:0 sc1
buffer_load_dwordx4 v[64:67], v6, s[12:15], s28 offen offset:1024 sc1
buffer_load_dwordx4 v[68:71], v19, s[12:15], s28 offen offset:1024 sc1
s_waitcnt vmcnt(4)
v_max3_u32 v2, v72, v76, v80
v_max3_u32 v2, v2, v84, v88
v_max3_u32 v2, v2, v92, v96
v_max3_u32 v2, v2, v100, v100
v_cmp_eq_u32 vcc, -1, v2
s_cbranch_vccz L_o4_a
buffer_load_dwordx4 v[72:75], v6, s[12:15], s29 offen offset:0 sc1
buffer_load_dwordx4 v[76:79], v19, s[12:15], s29 offen offset:0 sc1
buffer_load_dwordx4 v[80:83], v6, s[12:15], s29 offen offset:1024 sc1
buffer_load_dwordx4 v[84:87], v19, s[12:15], s29 offen offset:1024 sc1
buffer_load_dwordx4 v[88:91], v6, s[12:15], s30 offen offset:0 sc1
buffer_load_dwordx4 v[92:95], v19, s[12:15], s30 offen offset:0 sc1
buffer_load_dwordx4 v[96:99], v6, s[12:15], s30 offen offset:1024 sc1
buffer_load_dwordx4 v[100:103], v19, s[12:15], s30 offen offset:1024 sc1
s_waitcnt vmcnt(8)
s_branch L_o4_b
L_o4_a:
s_waitcnt vmcnt(0)
L_o4_b:
v_max3_u32 v2, v56, v60, v64
v_max_u32 v2, v2, v68
v_cmp_eq_u32 vcc, -1, v2
s_cbranch_vccnz L_o4_rt
s_branch L_o4_ok
L_o5_rt:
s_add_u32 s78, s78, 1
s_cmp_gt_u32 s78, 65536
s_cbranch_scc1 L_o5_ok
buffer_load_dwordx4 v[72:75], v6, s[12:15], s29 offen offset:0 sc1
buffer_load_dwordx4 v[76:79], v19, s[12:15], s29 offen offset:0 sc1
buffer_load_dwordx4 v[80:83], v6, s[12:15], s29 offen offset:1024 sc1
buffer_load_dwordx4 v[84:87], v19, s[12:15], s29 offen offset:1024 sc1
s_waitcnt vmcnt(4)
v_max3_u32 v2, v88, v92, v96
v_max3_u32 v2, v2, v100, v104
v_max3_u32 v2, v2, v108, v112
v_max3_u32 v2, v2, v116, v116
v_cmp_eq_u32 vcc, -1, v2
s_cbranch_vccz L_o5_a
buffer_load_dwordx4 v[88:91], v6, s[12:15], s30 offen offset:0 sc1
buffer_load_dwordx4 v[92:95], v19, s[12:15], s30 offen offset:0 sc1
buffer_load_dwordx4 v[96:99], v6, s[12:15], s30 offen offset:1024 sc1
buffer_load_dwordx4 v[100:103], v19, s[12:15], s30 offen offset:1024 sc1
buffer_load_dwordx4 v[104:107], v6, s[12:15], s31 offen offset:0 sc1
buffer_load_dwordx4 v[108:111], v19, s[12:15], s31 offen offset:0 sc1
buffer_load_dwordx4 v[112:115], v6, s[12:15], s31 offen offset:1024 sc1
buffer_load_dwordx4 v[116:119], v19, s[12:15], s31 offen offset:1024 sc1
s_waitcnt vmcnt(8)
s_branch L_o5_b
L_o5_a:
s_waitcnt vmcnt(0)
L_o5_b:
v_max3_u32 v2, v72, v76, v80
v_max_u32 v2, v2, v84
v_cmp_eq_u32 vcc, -1, v2
s_cbranch_vccnz L_o5_rt
s_branch L_o5_ok
L_o6_rt:
s_add_u32 s78, s78, 1
s_cmp_gt_u32 s78, 65536
s_cbranch_scc1 L_o6_ok
buffer_load_dwordx4 v[88:91], v6, s[12:15], s30 offen offset:0 sc1
buffer_load_dwordx4 v[92:95], v19, s[12:15], s30 offen offset:0 sc1
buffer_load_dwordx4 v[96:99], v6, s[12:15], s30 offen offset:1024 sc1
buffer_load_dwordx4 v[100:103], v19, s[12:15], s30 offen offset:1024 sc1
s_waitcnt vmcnt(4)
v_max3_u32 v2, v104, v108, v112
v_max3_u32 v2, v2, v116, v56
v_max3_u32 v2, v2, v60, v64
v_max3_u32 v2, v2, v68, v68
v_cmp_eq_u32 vcc, -1, v2
s_cbranch_vccz L_o6_a
buffer_load_dwordx4 v[104:107], v6, s[12:15], s31 offen offset:0 sc1
buffer_load_dwordx4 v[108:111], v19, s[12:15], s31 offen offset:0 sc1
buffer_load_dwordx4 v[112:115], v6, s[12:15], s31 offen offset:1024 sc1
buffer_load_dwordx4 v[116:119], v19, s[12:15], s31 offen offset:1024 sc1
buffer_load_dwordx4 v[56:59], v6, s[12:15], s32 offen offset:0 sc1
buffer_load_dwordx4 v[60:63], v19, s[12:15], s32 offen offset:0 sc1
buffer_load_dwordx4 v[64:67], v6, s[12:15], s32 offen offset:1024 sc1
buffer_load_dwordx4 v[68:71], v19, s[12:15], s32 offen offset:1024 sc1
s_waitcnt vmcnt(8)
s_branch L_o6_b
L_o6_a:
s_waitcnt vmcnt(0)
L_o6_b:
v_max3_u32 v2, v88, v92, v96
v_max_u32 v2, v2, v100
v_cmp_eq_u32 vcc, -1, v2
s_cbranch_vccnz L_o6_rt
s_branch L_o6_ok
L_o7_rt:
s_add_u32 s78, s78, 1
s_cmp_gt_u32 s78, 65536
s_cbranch_scc1 L_o7_ok
buffer_load_dwordx4 v[104:107], v6, s[12:15], s31 offen offset:0 sc1
buffer_load_dwordx4 v[108:111], v19, s[12:15], s31 offen offset:0 sc1
buffer_load_dwordx4 v[112:115], v6, s[12:15], s31 offen offset:1024 sc1
buffer_load_dwordx4 v[116:119], v19, s[12:15], s31 offen offset:1024 sc1
s_waitcnt vmcnt(4)
v_max3_u32 v2, v56, v60, v64
v_max3_u32 v2, v2, v68, v72
v_max3_u32 v2, v2, v76, v80
v_max3_u32 v2, v2, v84, v84
v_cmp_eq_u32 vcc, -1, v2
s_cbranch_vccz L_o7_a
buffer_load_dwordx4 v[56:59], v6, s[12:15], s32 offen offset:0 sc1
buffer_load_dwordx4 v[60:63], v19, s[12:15], s32 offen offset:0 sc1
buffer_load_dwordx4 v[64:67], v6, s[12:15], s32 offen offset:1024 sc1
buffer_load_dwordx4 v[68:71], v19, s[12:15], s32 offen offset:1024 sc1
buffer_load_dwordx4 v[72:75], v6, s[12:15], s33 offen offset:0 sc1
buffer_load_dwordx4 v[76:79], v19, s[12:15], s33 offen offset:0 sc1
buffer_load_dwordx4 v[80:83], v6, s[12:15], s33 offen offset:1024 sc1
buffer_load_dwordx4 v[84:87], v19, s[12:15], s33 offen offset:1024 sc1
s_waitcnt vmcnt(8)
s_branch L_o7_b
L_o7_a:
s_waitcnt vmcnt(0)
L_o7_b:
v_max3_u32 v2, v104, v108, v112
v_max_u32 v2, v2, v116
v_cmp_eq_u32 vcc, -1, v2
s_cbranch_vccnz L_o7_rt
s_branch L_o7_ok
L_o8_rt:
s_add_u32 s78, s78, 1
s_cmp_gt_u32 s78, 65536
s_cbranch_scc1 L_o8_ok
buffer_load_dwordx4 v[56:59], v6, s[12:15], s32 offen offset:0 sc1
buffer_load_dwordx4 v[60:63], v19, s[12:15], s32 offen offset:0 sc1
buffer_load_dwordx4 v[64:67], v6, s[12:15], s32 offen offset:1024 sc1
buffer_load_dwordx4 v[68:71], v19, s[12:15], s32 offen offset:1024 sc1
s_waitcnt vmcnt(4)
v_max3_u32 v2, v72, v76, v80
v_max3_u32 v2, v2, v84, v88
v_max3_u32 v2, v2, v92, v96
v_max3_u32 v2, v2, v100, v100
v_cmp_eq_u32 vcc, -1, v2
s_cbranch_vccz L_o8_a
buffer_load_dwordx4 v[72:75], v6, s[12:15], s33 offen offset:0 sc1
buffer_load_dwordx4 v[76:79], v19, s[12:15], s33 offen offset:0 sc1
buffer_load_dwordx4 v[80:83], v6, s[12:15], s33 offen offset:1024 sc1
buffer_load_dwordx4 v[84:87], v19, s[12:15], s33 offen offset:1024 sc1
buffer_load_dwordx4 v[88:91], v6, s[12:15], s34 offen offset:0 sc1
buffer_load_dwordx4 v[92:95], v19, s[12:15], s34 offen offset:0 sc1
buffer_load_dwordx4 v[96:99], v6, s[12:15], s34 offen offset:1024 sc1
buffer_load_dwordx4 v[100:103], v19, s[12:15], s34 offen offset:1024 sc1
s_waitcnt vmcnt(8)
s_branch L_o8_b
L_o8_a:
s_waitcnt vmcnt(0)
L_o8_b:
v_max3_u32 v2, v56, v60, v64
v_max_u32 v2, v2, v68
v_cmp_eq_u32 vcc, -1, v2
s_cbranch_vccnz L_o8_rt
s_branch L_o8_ok
L_o9_rt:
s_add_u32 s78, s78, 1
s_cmp_gt_u32 s78, 65536
s_cbranch_scc1 L_o9_ok
buffer_load_dwordx4 v[72:75], v6, s[12:15], s33 offen offset:0 sc1
buffer_load_dwordx4 v[76:79], v19, s[12:15], s33 offen offset:0 sc1
buffer_load_dwordx4 v[80:83], v6, s[12:15], s33 offen offset:1024 sc1
buffer_load_dwordx4 v[84:87], v19, s[12:15], s33 offen offset:1024 sc1
s_waitcnt vmcnt(4)
v_max3_u32 v2, v88, v92, v96
v_max3_u32 v2, v2, v100, v104
v_max3_u32 v2, v2, v108, v112
v_max3_u32 v2, v2, v116, v116
v_cmp_eq_u32 vcc, -1, v2
s_cbranch_vccz L_o9_a
buffer_load_dwordx4 v[88:91], v6, s[12:15], s34 offen offset:0 sc1
buffer_load_dwordx4 v[92:95], v19, s[12:15], s34 offen offset:0 sc1
buffer_load_dwordx4 v[96:99], v6, s[12:15], s34 offen offset:1024 sc1
buffer_load_dwordx4 v[100:103], v19, s[12:15], s34 offen offset:1024 sc1
buffer_load_dwordx4 v[104:107], v6, s[12:15], s35 offen offset:0 sc1
buffer_load_dwordx4 v[108:111], v19, s[12:15], s35 offen offset:0 sc1
buffer_load_dwordx4 v[112:115], v6, s[12:15], s35 offen offset:1024 sc1
buffer_load_dwordx4 v[116:119], v19, s[12:15], s35 offen offset:1024 sc1
s_waitcnt vmcnt(8)
s_branch L_o9_b
L_o9_a:
s_waitcnt vmcnt(0)
L_o9_b:
v_max3_u32 v2, v72, v76, v80
v_max_u32 v2, v2, v84
v_cmp_eq_u32 vcc, -1, v2
s_cbranch_vccnz L_o9_rt
s_branch L_o9_ok
L_o10_rt:
s_add_u32 s78, s78, 1
s_cmp_gt_u32 s78, 65536
s_cbranch_scc1 L_o10_ok
buffer_load_dwordx4 v[88:91], v6, s[12:15], s34 offen offset:0 sc1
buffer_load_dwordx4 v[92:95], v19, s[12:15], s34 offen offset:0 sc1
buffer_load_dwordx4 v[96:99], v6, s[12:15], s34 offen offset:1024 sc1
buffer_load_dwordx4 v[100:103], v19, s[12:15], s34 offen offset:1024 sc1
s_waitcnt vmcnt(4)
v_max3_u32 v2, v104, v108, v112
v_max3_u32 v2, v2, v116, v56
v_max3_u32 v2, v2, v60, v64
v_max3_u32 v2, v2, v68, v68
v_cmp_eq_u32 vcc, -1, v2
s_cbranch_vccz L_o10_a
buffer_load_dwordx4 v[104:107], v6, s[12:15], s35 offen offset:0 sc1
buffer_load_dwordx4 v[108:111], v19, s[12:15], s35 offen offset:0 sc1
buffer_load_dwordx4 v[112:115], v6, s[12:15], s35 offen offset:1024 sc1
buffer_load_dwordx4 v[116:119], v19, s[12:15], s35 offen offset:1024 sc1
buffer_load_dwordx4 v[56:59], v6, s[12:15], s36 offen offset:0 sc1
buffer_load_dwordx4 v[60:63], v19, s[12:15], s36 offen offset:0 sc1
buffer_load_dwordx4 v[64:67], v6, s[12:15], s36 offen offset:1024 sc1
buffer_load_dwordx4 v[68:71], v19, s[12:15], s36 offen offset:1024 sc1
s_waitcnt vmcnt(8)
s_branch L_o10_b
L_o10_a:
s_waitcnt vmcnt(0)
L_o10_b:
v_max3_u32 v2, v88, v92, v96
v_max_u32 v2, v2, v100
v_cmp_eq_u32 vcc, -1, v2
s_cbranch_vccnz L_o10_rt
s_branch L_o10_ok
L_o11_rt:
s_add_u32 s78, s78, 1
s_cmp_gt_u32 s78, 65536
s_cbranch_scc1 L_o11_ok
buffer_load_dwordx4 v[104:107], v6, s[12:15], s35 offen offset:0 sc1
buffer_load_dwordx4 v[108:111], v19, s[12:15], s35 offen offset:0 sc1
buffer_load_dwordx4 v[112:115], v6, s[12:15], s35 offen offset:1024 sc1
buffer_load_dwordx4 v[116:119], v19, s[12:15], s35 offen offset:1024 sc1
s_waitcnt vmcnt(4)
v_max3_u32 v2, v56, v60, v64
v_max3_u32 v2, v2, v68, v72
v_max3_u32 v2, v2, v76, v80
v_max3_u32 v2, v2, v84, v84
v_cmp_eq_u32 vcc, -1, v2
s_cbranch_vccz L_o11_a
buffer_load_dwordx4 v[56:59], v6, s[12:15], s36 offen offset:0 sc1
buffer_load_dwordx4 v[60:63], v19, s[12:15], s36 offen offset:0 sc1
buffer_load_dwordx4 v[64:67], v6, s[12:15], s36 offen offset:1024 sc1
buffer_load_dwordx4 v[68:71], v19, s[12:15], s36 offen offset:1024 sc1
buffer_load_dwordx4 v[72:75], v6, s[12:15], s37 offen offset:0 sc1
buffer_load_dwordx4 v[76:79], v19, s[12:15], s37 offen offset:0 sc1
buffer_load_dwordx4 v[80:83], v6, s[12:15], s37 offen offset:1024 sc1
buffer_load_dwordx4 v[84:87], v19, s[12:15], s37 offen offset:1024 sc1
s_waitcnt vmcnt(8)
s_branch L_o11_b
L_o11_a:
s_waitcnt vmcnt(0)
L_o11_b:
v_max3_u32 v2, v104, v108, v112
v_max_u32 v2, v2, v116
v_cmp_eq_u32 vcc, -1, v2
s_cbranch_vccnz L_o11_rt
s_branch L_o11_ok
L_o12_rt:
s_add_u32 s78, s78, 1
s_cmp_gt_u32 s78, 65536
s_cbranch_scc1 L_o12_ok
buffer_load_dwordx4 v[56:59], v6, s[12:15], s36 offen offset:0 sc1
buffer_load_dwordx4 v[60:63], v19, s[12:15], s36 offen offset:0 sc1
buffer_load_dwordx4 v[64:67], v6, s[12:15], s36 offen offset:1024 sc1
buffer_load_dwordx4 v[68:71], v19, s[12:15], s36 offen offset:1024 sc1
s_waitcnt vmcnt(4)
v_max3_u32 v2, v72, v76, v80
v_max3_u32 v2, v2, v84, v88
v_max3_u32 v2, v2, v92, v96
v_max3_u32 v2, v2, v100, v100
v_cmp_eq_u32 vcc, -1, v2
s_cbranch_vccz L_o12_a
buffer_load_dwordx4 v[72:75], v6, s[12:15], s37 offen offset:0 sc1
buffer_load_dwordx4 v[76:79], v19, s[12:15], s37 offen offset:0 sc1
buffer_load_dwordx4 v[80:83], v6, s[12:15], s37 offen offset:1024 sc1
buffer_load_dwordx4 v[84:87], v19, s[12:15], s37 offen offset:1024 sc1
buffer_load_dwordx4 v[88:91], v6, s[12:15], s38 offen offset:0 sc1
buffer_load_dwordx4 v[92:95], v19, s[12:15], s38 offen offset:0 sc1
buffer_load_dwordx4 v[96:99], v6, s[12:15], s38 offen offset:1024 sc1
buffer_load_dwordx4 v[100:103], v19, s[12:15], s38 offen offset:1024 sc1
s_waitcnt vmcnt(8)
s_branch L_o12_b
L_o12_a:
s_waitcnt vmcnt(0)
L_o12_b:
v_max3_u32 v2, v56, v60, v64
v_max_u32 v2, v2, v68
v_cmp_eq_u32 vcc, -1, v2
s_cbranch_vccnz L_o12_rt
s_branch L_o12_ok
L_o13_rt:
s_add_u32 s78, s78, 1
s_cmp_gt_u32 s78, 65536
s_cbranch_scc1 L_o13_ok
buffer_load_dwordx4 v[72:75], v6, s[12:15], s37 offen offset:0 sc1
buffer_load_dwordx4 v[76:79], v19, s[12:15], s37 offen offset:0 sc1
buffer_load_dwordx4 v[80:83], v6, s[12:15], s37 offen offset:1024 sc1
buffer_load_dwordx4 v[84:87], v19, s[12:15], s37 offen offset:1024 sc1
s_waitcnt vmcnt(4)
v_max3_u32 v2, v88, v92, v96
v_max3_u32 v2, v2, v100, v104
v_max3_u32 v2, v2, v108, v112
v_max3_u32 v2, v2, v116, v116
v_cmp_eq_u32 vcc, -1, v2
s_cbranch_vccz L_o13_a
buffer_load_dwordx4 v[88:91], v6, s[12:15], s38 offen offset:0 sc1
buffer_load_dwordx4 v[92:95], v19, s[12:15], s38 offen offset:0 sc1
buffer_load_dwordx4 v[96:99], v6, s[12:15], s38 offen offset:1024 sc1
buffer_load_dwordx4 v[100:103], v19, s[12:15], s38 offen offset:1024 sc1
buffer_load_dwordx4 v[104:107], v6, s[12:15], s39 offen offset:0 sc1
s_branch L_over17
L_pad17:
s_branch L_retG
L_over17:
buffer_load_dwordx4 v[108:111], v19, s[12:15], s39 offen offset:0 sc1
buffer_load_dwordx4 v[112:115], v6, s[12:15], s39 offen offset:1024 sc1
buffer_load_dwordx4 v[116:119], v19, s[12:15], s39 offen offset:1024 sc1
s_waitcnt vmcnt(8)
s_branch L_o13_b
L_o13_a:
s_waitcnt vmcnt(0)
L_o13_b:
v_max3_u32 v2, v72, v76, v80
v_max_u32 v2, v2, v84
v_cmp_eq_u32 vcc, -1, v2
s_cbranch_vccnz L_o13_rt
s_branch L_o13_ok
L_o14_rt:
s_add_u32 s78, s78, 1
s_cmp_gt_u32 s78, 65536
s_cbranch_scc1 L_o14_ok
buffer_load_dwordx4 v[88:91], v6, s[12:15], s38 offen offset:0 sc1
buffer_load_dwordx4 v[92:95], v19, s[12:15], s38 offen offset:0 sc1
buffer_load_dwordx4 v[96:99], v6, s[12:15], s38 offen offset:1024 sc1
buffer_load_dwordx4 v[100:103], v19, s[12:15], s38 offen offset:1024 sc1
s_waitcnt vmcnt(4)
v_max3_u32 v2, v104, v108, v112
v_max3_u32 v2, v2, v116, v116
v_cmp_eq_u32 vcc, -1, v2
s_cbranch_vccz L_o14_a
buffer_load_dwordx4 v[104:107], v6, s[12:15], s39 offen offset:0 sc1
buffer_load_dwordx4 v[108:111], v19, s[12:15], s39 offen offset:0 sc1
buffer_load_dwordx4 v[112:115], v6, s[12:15], s39 offen offset:1024 sc1
buffer_load_dwordx4 v[116:119], v19, s[12:15], s39 offen offset:1024 sc1
s_waitcnt vmcnt(4)
s_branch L_o14_b
L_o14_a:
s_waitcnt vmcnt(0)
L_o14_b:
v_max3_u32 v2, v88, v92, v96
v_max_u32 v2, v2, v100
v_cmp_eq_u32 vcc, -1, v2
s_cbranch_vccnz L_o14_rt
s_branch L_o14_ok
L_o15_rt:
s_add_u32 s78, s78, 1
s_cmp_gt_u32 s78, 65536
s_cbranch_scc1 L_o15_ok
buffer_load_dwordx4 v[104:107], v6, s[12:15], s39 offen offset:0 sc1
buffer_load_dwordx4 v[108:111], v19, s[12:15], s39 offen offset:0 sc1
buffer_load_dwordx4 v[112:115], v6, s[12:15], s39 offen offset:1024 sc1
buffer_load_dwordx4 v[116:119], v19, s[12:15], s39 offen offset:1024 sc1
s_waitcnt vmcnt(0)
L_o15_b:
v_max3_u32 v2, v104, v108, v112
v_max_u32 v2, v2, v116
v_cmp_eq_u32 vcc, -1, v2
s_cbranch_vccnz L_o15_rt
s_branch L_o15_ok
L_stp_s:
buffer_store_dwordx4 v[72:75], v144, s[12:15], s72 offen offset:0 sc1
buffer_store_dwordx4 v[76:79], v144, s[12:15], s72 offen offset:256 sc1
s_branch L_stp_d
L_pad18:
s_branch L_retG
L_st_rt:
s_add_u32 s78, s78, 1
s_cmp_gt_u32 s78, 65536
s_cbranch_scc1 L_st_ok
v_cmp_ne_u32 vcc, s68, v99
s_cbranch_vccz L_st_p0
s_add_u32 s70, s75, 0
buffer_load_dwordx4 v[96:99], v145, s[12:15], s70 offen sc1
L_st_p0:
v_cmp_ne_u32 vcc, s68, v103
s_cbranch_vccz L_st_p1
s_add_u32 s70, s75, 4096
buffer_load_dwordx4 v[100:103], v145, s[12:15], s70 offen sc1
L_st_p1:
v_cmp_ne_u32 vcc, s68, v107
s_cbranch_vccz L_st_p2
s_add_u32 s70, s75, 8192
buffer_load_dwordx4 v[104:107], v145, s[12:15], s70 offen sc1
L_st_p2:
v_cmp_ne_u32 vcc, s68, v111
s_cbranch_vccz L_st_p3
s_add_u32 s70, s75, 12288
buffer_load_dwordx4 v[108:111], v145, s[12:15], s70 offen sc1
L_st_p3:
v_cmp_ne_u32 vcc, s68, v115
s_cbranch_vccz L_st_p4
s_add_u32 s70, s75, 16384
buffer_load_dwordx4 v[112:115], v145, s[12:15], s70 offen sc1
L_st_p4:
v_cmp_ne_u32 vcc, s68, v119
s_cbranch_vccz L_st_p5
s_add_u32 s70, s75, 20480
buffer_load_dwordx4 v[116:119], v145, s[12:15], s70 offen sc1
L_st_p5:
v_cmp_ne_u32 vcc, s68, v123
s_cbranch_vccz L_st_p6
s_add_u32 s70, s75, 24576
buffer_load_dwordx4 v[120:123], v145, s[12:15], s70 offen sc1
L_st_p6:
v_cmp_ne_u32 vcc, s68, v127
s_cbranch_vccz L_st_p7
s_add_u32 s70, s75, 28672
buffer_load_dwordx4 v[124:127], v145, s[12:15], s70 offen sc1
L_st_p7:
s_waitcnt vmcnt(0)
s_branch L_st_chk
L_fin:
.section .rodata,"a"
.p2align 6
.amdhsa_kernel sequential_preLN__linear_attn_block__moe_arch_mod__prompt_kernel
  .amdhsa_next_free_vgpr 256
  .amdhsa_next_free_sgpr 102
  .amdhsa_accum_offset 152
  .amdhsa_group_segment_fixed_size 0
  .amdhsa_kernarg_size 88
  .amdhsa_user_sgpr_count 2
  .amdhsa_user_sgpr_kernarg_segment_ptr 1
  .amdhsa_system_sgpr_workgroup_id_x 1
  .amdhsa_float_denorm_mode_32 3
.end_amdhsa_kernel
```

```asm
; @launch grid=(256,1,1) block=(512,1,1) lds=163840
.amdgcn_target "amdgcn-amd-amdhsa--gfx950"
.text
.p2alignl 12, 0xbf810000
.fill 832, 4, 0xbf810000
.globl sequential_preLN__linear_attn_block__moe_arch_mod__prompt_kernel
.p2align 8
.type sequential_preLN__linear_attn_block__moe_arch_mod__prompt_kernel,@function
sequential_preLN__linear_attn_block__moe_arch_mod__prompt_kernel:
s_cmp_ge_u32 s2, 256
s_cbranch_scc1 L_end
s_load_dwordx16 s[40:55], s[0:1], 0
s_load_dwordx2 s[56:57], s[0:1], 64
s_load_dwordx2 s[58:59], s[0:1], 80
s_getpc_b64 s[20:21]
L_pc:
s_sub_u32 s20, s20, L_pc-sequential_preLN__linear_attn_block__moe_arch_mod__prompt_kernel
s_subb_u32 s21, s21, 0
s_and_b32 s21, s21, 0xffff
s_mov_b32 s22, L_fin-sequential_preLN__linear_attn_block__moe_arch_mod__prompt_kernel
s_mov_b32 s23, 0x20000
s_lshr_b32 s70, s2, 3
s_mul_i32 s70, s70, 1536
v_lshlrev_b32 v81, 7, v0
v_cmp_gt_u32 vcc, 12, v0
s_nop 0
s_mov_b64 exec, vcc
buffer_load_dword v81, v81, s[20:23], s70 offen
s_mov_b64 exec, -1
v_lshrrev_b32 v2, 6, v0
v_and_b32 v1, 63, v0
v_readfirstlane_b32 s60, v2
s_and_b32 s62, s2, 7
s_lshr_b32 s63, s2, 3
s_lshl_b32 s64, s62, 1
s_and_b32 s70, s63, 1
s_add_u32 s64, s64, s70
s_lshr_b32 s65, s63, 1
s_lshl_b32 s79, s64, 4
s_add_u32 s79, s79, s65
s_mov_b32 s78, 0
s_mul_i32 s70, s62, 2
s_add_u32 s89, s65, s70
s_and_b32 s89, s89, 15
s_lshr_b32 s61, s60, 2
s_and_b32 s60, s60, 3
s_lshr_b32 s66, s60, 1
s_and_b32 s67, s60, 1
v_lshlrev_b32 v16, 4, v1
s_cmp_eq_u32 s61, 0
s_cbranch_scc1 L_compute
s_setprio 1
v_mov_b32 v18, v16
s_lshl_b32 s70, s65, 2
s_add_u32 s70, s70, s60
s_lshl_b32 s70, s70, 16
v_lshrrev_b32 v2, 3, v1
v_lshlrev_b32 v5, 11, v2
v_add_u32 v5, s70, v5
v_lshrrev_b32 v3, 4, v1
v_and_b32 v4, 7, v1
v_xor_b32 v3, v3, v4
v_xor_b32_e64 v6, 0, v3
v_lshl_add_u32 v6, v6, 4, v5
v_add_u32 v8, 0, v6
v_xor_b32 v6, 4, v3
v_lshl_add_u32 v6, v6, 4, v5
v_add_u32 v9, 15360, v6
v_xor_b32 v6, 0, v3
v_lshl_add_u32 v6, v6, 4, v5
v_add_u32 v10, 30720, v6
v_xor_b32 v6, 4, v3
v_lshl_add_u32 v6, v6, 4, v5
v_add_u32 v11, 46080, v6
s_lshl_b32 s70, s60, 4
v_add_u32 v5, s70, v2
v_mul_u32_u24 v5, 6144, v5
s_lshl_b32 s70, s64, 7
v_add_u32 v5, s70, v5
v_bfe_u32 v3, v1, 4, 1
v_lshlrev_b32 v3, 1, v3
v_xor_b32 v3, v3, v4
v_xor_b32 v6, 0, v3
v_lshl_add_u32 v6, v6, 4, v5
v_add_u32 v12, 0, v6
v_xor_b32 v6, 4, v3
v_lshl_add_u32 v6, v6, 4, v5
v_add_u32 v13, 48128, v6
v_xor_b32 v6, 0, v3
v_lshl_add_u32 v6, v6, 4, v5
v_add_u32 v14, 0, v6
v_xor_b32 v6, 4, v3
v_lshl_add_u32 v6, v6, 4, v5
v_add_u32 v15, 48128, v6
v_xor_b32 v6, 0, v3
v_lshl_add_u32 v6, v6, 4, v5
v_add_u32 v16, 4096, v6
v_xor_b32 v6, 4, v3
v_lshl_add_u32 v6, v6, 4, v5
v_add_u32 v17, 52224, v6
s_lshl_b32 s76, s60, 12
s_mul_i32 s77, s60, 6144
s_and_b32 s70, s64, 1
s_lshl_b32 s70, s70, 3
s_mov_b32 s70, 0
s_andn2_b32 s71, s65, 1
s_add_u32 s70, s70, s71
s_and_b32 s70, s70, 15
s_mul_i32 s75, s70, 393216
s_lshl_b32 s74, s70, 7
s_waitcnt lgkmcnt(0)
s_load_dword s68, s[58:59], 0
s_mov_b32 s4, s40
s_and_b32 s5, s41, 0xffff
s_mov_b32 s6, 4194304
s_mov_b32 s7, 0x20000
s_mov_b32 s8, s42
s_and_b32 s9, s43, 0xffff
s_mov_b32 s10, 6291456
s_mov_b32 s11, 0x20000
s_add_u32 m0, s76, 122880
s_nop 0
buffer_load_dwordx4 v8, s[4:7], s74 offen offset:0 lds
buffer_load_dwordx4 v9, s[4:7], s74 offen offset:1024 lds
buffer_load_dwordx4 v10, s[4:7], s74 offen offset:2048 lds
buffer_load_dwordx4 v11, s[4:7], s74 offen offset:3072 lds
s_add_u32 s74, s74, 128
s_and_b32 s74, s74, 2047
s_add_u32 m0, s77, 0
s_nop 0
buffer_load_dwordx4 v12, s[8:11], s75 offen offset:0 lds
buffer_load_dwordx4 v13, s[8:11], s75 offen offset:1024 lds
buffer_load_dwordx4 v14, s[8:11], s75 offen offset:2048 lds
buffer_load_dwordx4 v15, s[8:11], s75 offen offset:3072 lds
s_add_u32 m0, s77, 4096
s_nop 0
buffer_load_dwordx4 v16, s[8:11], s75 offen offset:0 lds
buffer_load_dwordx4 v17, s[8:11], s75 offen offset:1024 lds
s_add_u32 s75, s75, 393216
s_cmp_eq_u32 s75, 6291456
s_cselect_b32 s75, 0, s75
s_mov_b32 s12, s58
s_and_b32 s13, s59, 0xffff
s_mov_b32 s14, 268435456
s_mov_b32 s15, 0x20000
s_mov_b32 s16, s44
s_and_b32 s17, s45, 0xffff
s_mov_b32 s18, 2097152
s_mov_b32 s19, 0x20000
s_mov_b32 s20, s56
s_and_b32 s21, s57, 0xffff
s_mov_b32 s22, 4194304
s_mov_b32 s23, 0x20000
s_mov_b32 s24, s50
s_and_b32 s25, s51, 0xffff
s_mov_b32 s26, 7340032
s_mov_b32 s27, 0x20000
s_mov_b32 s28, s52
s_and_b32 s29, s53, 0xffff
s_mov_b32 s30, 7340032
s_mov_b32 s31, 0x20000
s_mov_b32 s32, s54
s_and_b32 s33, s55, 0xffff
s_mov_b32 s34, 7340032
s_mov_b32 s35, 0x20000
s_mov_b32 s36, s48
s_and_b32 s37, s49, 0xffff
s_mov_b32 s38, 2048
s_mov_b32 s39, 0x20000
s_lshl_b32 s70, s65, 7
s_lshl_b32 s71, s64, 3
s_add_u32 s70, s70, s71
s_lshl_b32 s71, s60, 1
s_add_u32 s87, s70, s71
v_lshrrev_b32 v2, 3, v1
v_lshlrev_b32 v3, 11, v2
v_bfe_u32 v5, v1, 4, 2
v_lshlrev_b32 v5, 1, v5
v_and_b32 v4, 7, v1
v_xor_b32 v5, v5, v4
v_lshl_add_u32 v3, v5, 4, v3
s_lshl_b32 s70, s65, 7
v_add_u32 v80, s70, v3
v_mov_b32 v72, -1
v_mov_b32 v73, -1
v_mov_b32 v74, -1
v_mov_b32 v75, -1
s_mul_i32 s80, s79, 4352
s_add_u32 s80, s80, 524288
s_and_b32 s81, s65, 7
s_lshl_b32 s81, s81, 19
s_lshr_b32 s70, s65, 1
s_xor_b32 s70, s70, s65
s_and_b32 s70, s70, 4
s_lshl_b32 s70, s70, 11
s_xor_b32 s70, s70, 2105344
s_add_u32 s81, s81, s70
s_mul_i32 s70, s66, 262144
s_add_u32 s81, s81, s70
s_lshr_b32 s70, s64, 2
s_lshl_b32 s70, s70, 14
s_add_u32 s81, s81, s70
s_and_b32 s70, s64, 3
s_lshl_b32 s70, s70, 11
s_add_u32 s81, s81, s70
s_lshl_b32 s70, s67, 10
s_add_u32 s81, s81, s70
s_mov_b32 s72, 0x6543e210
s_mov_b32 s73, 0xdcbaf987
s_lshl_b32 s70, s64, 2
s_lshr_b64 s[72:73], s[72:73], s70
s_and_b32 s3, s72, 15
v_mul_u32_u24 v76, 7168, v2
v_lshl_add_u32 v76, v4, 4, v76
v_lshlrev_b32 v77, 11, v2
v_lshl_add_u32 v77, v4, 4, v77
s_and_b32 s70, s65, 3
s_lshl_b32 s70, s70, 2
s_add_u32 s70, s70, s60
s_mul_i32 s85, s70, 458752
s_lshl_b32 s70, s3, 9
s_add_u32 s85, s85, s70
s_lshr_b32 s70, s65, 2
s_lshl_b32 s70, s70, 7
s_xor_b32 s71, s70, 128
v_add_u32 v78, s71, v76
v_add_u32 v76, s70, v76
s_and_b32 s70, s65, 3
s_lshl2_add_u32 s70, s3, s70
s_and_b32 s71, s65, 12
s_add_u32 s71, s71, s60
s_lshl_b32 s86, s70, 17
s_lshl_b32 s70, s71, 7
s_add_u32 s86, s86, s70
s_cmp_lt_u32 s3, 14
s_cselect_b32 s26, s26, 0
s_cselect_b32 s30, s30, 0
s_cselect_b32 s34, s34, 0
s_mov_b32 s90, 0x10001
s_movk_i32 s91, 0xff
v_mov_b32 v79, 0
s_lshl_b32 s70, s87, 4
s_add_u32 s70, s70, 8192
v_writelane_b32 v79, s70, 0
s_lshl_b32 s70, s79, 4
s_add_u32 s70, s70, 4096
v_writelane_b32 v79, s70, 1
s_lshl_b32 s70, s64, 7
s_add_u32 s70, s70, 6815744
v_writelane_b32 v79, s70, 2
s_lshl_b32 s70, s79, 10
s_add_u32 s70, s70, 65536
v_writelane_b32 v79, s70, 3
s_lshl_b32 s70, s60, 10
s_add_u32 s70, s70, s80
v_writelane_b32 v79, s70, 4
s_lshl_b32 s70, s67, 7
s_add_u32 s70, s70, s80
s_add_u32 s70, s70, 4096
v_writelane_b32 v79, s70, 5
s_and_b32 s71, s65, 3
s_lshl2_add_u32 s71, s3, s71
s_and_b32 s70, s65, 12
s_add_u32 s70, s70, s60
s_lshl_b32 s71, s71, 7
s_bitcmp1_b32 s70, 3
s_cselect_b32 s72, 0, 8192
s_add_u32 s71, s71, s72
s_and_b32 s70, s70, 7
s_lshl_b32 s70, s70, 16
s_add_u32 s70, s70, s71
s_add_u32 s70, s70, 7340032
v_writelane_b32 v79, s70, 6
s_lshl_b32 s71, s79, 2
s_add_u32 s71, s71, s60
s_lshl_b32 s70, s71, 9
s_add_u32 s70, s70, 6291456
v_writelane_b32 v79, s70, 7
s_lshl_b32 s71, s79, 2
s_add_u32 s71, s71, s60
s_lshl_b32 s70, s71, 8
s_add_u32 s70, s70, 6946816
v_writelane_b32 v79, s70, 8
s_add_u32 s70, s81, 0
v_writelane_b32 v79, s70, 9
s_add_u32 s70, s81, 65536
v_writelane_b32 v79, s70, 10
s_add_u32 s70, s81, 131072
v_writelane_b32 v79, s70, 11
s_add_u32 s70, s81, 196608
v_writelane_b32 v79, s70, 12
s_and_b32 s70, s65, 7
s_min_u32 s71, s60, 0
s_lshl_b32 s71, s71, 3
s_add_u32 s70, s70, s71
s_lshl_b32 s70, s70, 4
s_add_u32 s70, s70, s64
s_lshl_b32 s70, s70, 7
s_add_u32 s70, s70, 6815744
v_writelane_b32 v79, s70, 2
v_and_b32 v2, 7, v1
v_lshlrev_b32 v2, 7, v2
v_lshrrev_b32 v3, 3, v1
v_lshl_add_u32 v83, v3, 16, v2
v_add_u32 v83, s81, v83
s_mov_b32 exec_lo, 0
s_and_b32 s71, s65, 3
s_lshl2_add_u32 s71, s3, s71
s_and_b32 s70, s65, 12
s_add_u32 s70, s70, s60
s_lshl_b32 s71, s71, 7
s_bitcmp1_b32 s70, 3
s_cselect_b32 s72, 0, 8192
s_add_u32 s71, s71, s72
s_and_b32 s70, s70, 7
s_lshl_b32 s70, s70, 16
s_add_u32 s70, s70, s71
s_add_u32 s70, s70, 7340032
s_mov_b32 exec_hi, 0xff
v_and_b32 v2, 3, v1
v_lshl_add_u32 v83, v2, 14, s70
s_lshl_b32 s70, s60, 10
s_add_u32 s70, s70, s80
s_mov_b32 exec_hi, 0xff0000
v_and_b32 v2, 7, v1
v_lshl_add_u32 v83, v2, 7, s70
s_lshl_b32 s71, s79, 2
s_add_u32 s71, s71, s60
s_lshl_b32 s70, s71, 9
s_add_u32 s70, s70, 6291456
s_mov_b32 exec_hi, 0xf000000
v_and_b32 v2, 3, v1
v_lshl_add_u32 v83, v2, 7, s70
s_lshl_b32 s71, s79, 2
s_add_u32 s71, s71, s60
s_lshl_b32 s70, s71, 8
s_add_u32 s70, s70, 6946816
s_mov_b32 exec_hi, 0x30000000
v_and_b32 v2, 1, v1
v_lshl_add_u32 v83, v2, 7, s70
s_lshl_b32 s70, s67, 7
s_add_u32 s70, s70, s80
s_add_u32 s70, s70, 4096
s_mov_b32 exec_hi, 0xc0000000
v_and_b32 v2, 0, v1
v_lshl_add_u32 v83, v2, 7, s70
s_mov_b64 exec, -1
s_add_u32 m0, s76, 106496
s_nop 0
buffer_load_dwordx4 v8, s[4:7], s74 offen offset:0 lds
buffer_load_dwordx4 v9, s[4:7], s74 offen offset:1024 lds
buffer_load_dwordx4 v10, s[4:7], s74 offen offset:2048 lds
buffer_load_dwordx4 v11, s[4:7], s74 offen offset:3072 lds
s_add_u32 s74, s74, 128
s_and_b32 s74, s74, 2047
s_add_u32 m0, s77, 81920
s_nop 0
buffer_load_dwordx4 v12, s[8:11], s75 offen offset:0 lds
buffer_load_dwordx4 v13, s[8:11], s75 offen offset:1024 lds
buffer_load_dwordx4 v14, s[8:11], s75 offen offset:2048 lds
buffer_load_dwordx4 v15, s[8:11], s75 offen offset:3072 lds
s_add_u32 m0, s77, 86016
s_nop 0
buffer_load_dwordx4 v16, s[8:11], s75 offen offset:0 lds
buffer_load_dwordx4 v17, s[8:11], s75 offen offset:1024 lds
s_add_u32 s75, s75, 393216
s_cmp_eq_u32 s75, 6291456
s_cselect_b32 s75, 0, s75
s_cmp_lt_u32 s3, 14
s_cbranch_scc1 L_norace
s_cmp_ge_u32 s60, 2
s_cbranch_scc1 L_norace
s_and_b32 s70, s3, 1
s_lshl4_add_u32 s70, s70, s65
s_lshl1_add_u32 s73, s70, s60
s_lshl_b32 s70, s73, 7
s_lshl_b32 s71, s60, 13
s_add_u32 s70, s70, s71
s_xor_b32 s70, s70, 401408
s_xor_b32 s71, s70, 0x2000
s_mov_b32 s69, 0x5bd1e995
s_waitcnt lgkmcnt(0)
s_load_dword s61, s[12:13], s70
s_load_dword s69, s[12:13], s71
s_lshr_b32 s70, s62, 2
s_xor_b32 s70, s70, s60
s_sub_u32 s70, 2, s70
s_add_u32 s71, s68, 1
s_lshl_b32 s71, s71, 2
s_lshl_b32 s73, s73, 2
s_add_u32 s73, s73, 7225600
s_waitcnt lgkmcnt(1)
s_cmp_eq_u32 s69, 0x5bd1e995
s_cselect_b32 s70, s70, 0
s_or_b32 s70, s70, s71
v_mov_b32_e64 v19, s70
s_mov_b64 exec, 1
buffer_store_dword v19, off, s[12:15], s73 sc1
s_mov_b64 exec, -1
L_norace:
s_waitcnt vmcnt(10)
s_barrier
s_add_u32 m0, s76, 65536
s_nop 0
buffer_load_dwordx4 v8, s[4:7], s74 offen offset:0 lds
buffer_load_dwordx4 v9, s[4:7], s74 offen offset:1024 lds
buffer_load_dwordx4 v10, s[4:7], s74 offen offset:2048 lds
buffer_load_dwordx4 v11, s[4:7], s74 offen offset:3072 lds
s_add_u32 s74, s74, 128
s_and_b32 s74, s74, 2047
s_add_u32 m0, s77, 40960
s_nop 0
buffer_load_dwordx4 v12, s[8:11], s75 offen offset:0 lds
buffer_load_dwordx4 v13, s[8:11], s75 offen offset:1024 lds
buffer_load_dwordx4 v14, s[8:11], s75 offen offset:2048 lds
buffer_load_dwordx4 v15, s[8:11], s75 offen offset:3072 lds
s_add_u32 m0, s77, 45056
s_nop 0
buffer_load_dwordx4 v16, s[8:11], s75 offen offset:0 lds
buffer_load_dwordx4 v17, s[8:11], s75 offen offset:1024 lds
s_add_u32 s75, s75, 393216
s_cmp_eq_u32 s75, 6291456
s_cselect_b32 s75, 0, s75
s_waitcnt vmcnt(10)
s_barrier
s_add_u32 m0, s76, 24576
s_nop 0
buffer_load_dwordx4 v8, s[4:7], s74 offen offset:0 lds
buffer_load_dwordx4 v9, s[4:7], s74 offen offset:1024 lds
buffer_load_dwordx4 v10, s[4:7], s74 offen offset:2048 lds
buffer_load_dwordx4 v11, s[4:7], s74 offen offset:3072 lds
s_add_u32 s74, s74, 128
s_and_b32 s74, s74, 2047
s_add_u32 m0, s77, 0
s_nop 0
buffer_load_dwordx4 v12, s[8:11], s75 offen offset:0 lds
buffer_load_dwordx4 v13, s[8:11], s75 offen offset:1024 lds
buffer_load_dwordx4 v14, s[8:11], s75 offen offset:2048 lds
buffer_load_dwordx4 v15, s[8:11], s75 offen offset:3072 lds
s_add_u32 m0, s77, 4096
s_nop 0
buffer_load_dwordx4 v16, s[8:11], s75 offen offset:0 lds
buffer_load_dwordx4 v17, s[8:11], s75 offen offset:1024 lds
s_add_u32 s75, s75, 393216
s_cmp_eq_u32 s75, 6291456
s_cselect_b32 s75, 0, s75
s_add_u32 m0, s76, 122880
s_nop 0
buffer_load_dwordx4 v8, s[4:7], s74 offen offset:0 lds
buffer_load_dwordx4 v9, s[4:7], s74 offen offset:1024 lds
buffer_load_dwordx4 v10, s[4:7], s74 offen offset:2048 lds
buffer_load_dwordx4 v11, s[4:7], s74 offen offset:3072 lds
s_add_u32 s74, s74, 128
s_and_b32 s74, s74, 2047
v_lshlrev_b32_e64 v2, 3, v1
s_lshl_b32 s70, s60, 9
buffer_load_dwordx2 v[88:89], v2, s[36:39], s70 offen
s_lshl_b32 s70, s87, 11
buffer_load_dwordx4 v[20:23], v18, s[4:7], s70 offen offset:0
s_lshl_b32 s70, s87, 11
buffer_load_dwordx4 v[24:27], v18, s[4:7], s70 offen offset:1024
s_lshl_b32 s70, s87, 11
buffer_load_dwordx4 v[28:31], v18, s[4:7], s70 offen offset:2048
s_lshl_b32 s70, s87, 11
buffer_load_dwordx4 v[32:35], v18, s[4:7], s70 offen offset:3072
s_mov_b64 exec, 0x1ef
buffer_load_dword v81, v79, s[12:15], 0 offen
s_mov_b64 exec, -1
s_lshl_b32 s70, s64, 2
s_add_u32 s70, s70, s60
s_lshl_b32 s70, s70, 15
s_lshl_b32 s71, s65, 7
s_add_u32 s70, s70, s71
s_add_u32 s70, s70, 8388608
v_and_b32 v19, 0xf800, v77
v_mad_u32_u24 v19, v19, 3, v77
s_mov_b32 exec_hi, 0
buffer_store_dwordx4 v[72:75], v19, s[12:15], s70 offen sc1
s_mov_b64 exec, -1
s_waitcnt vmcnt(21)
s_barrier
s_add_u32 m0, s77, 81920
s_nop 0
buffer_load_dwordx4 v12, s[8:11], s75 offen offset:0 lds
buffer_load_dwordx4 v13, s[8:11], s75 offen offset:1024 lds
buffer_load_dwordx4 v14, s[8:11], s75 offen offset:2048 lds
buffer_load_dwordx4 v15, s[8:11], s75 offen offset:3072 lds
s_add_u32 m0, s77, 86016
s_nop 0
buffer_load_dwordx4 v16, s[8:11], s75 offen offset:0 lds
buffer_load_dwordx4 v17, s[8:11], s75 offen offset:1024 lds
s_add_u32 s75, s75, 393216
s_cmp_eq_u32 s75, 6291456
s_cselect_b32 s75, 0, s75
s_add_u32 m0, s76, 106496
s_nop 0
buffer_load_dwordx4 v8, s[4:7], s74 offen offset:0 lds
buffer_load_dwordx4 v9, s[4:7], s74 offen offset:1024 lds
buffer_load_dwordx4 v10, s[4:7], s74 offen offset:2048 lds
buffer_load_dwordx4 v11, s[4:7], s74 offen offset:3072 lds
s_add_u32 s74, s74, 128
s_and_b32 s74, s74, 2047
s_waitcnt vmcnt(21)
s_barrier
s_add_u32 m0, s77, 40960
s_nop 0
buffer_load_dwordx4 v12, s[8:11], s75 offen offset:0 lds
s_waitcnt vmcnt(13)
s_waitcnt lgkmcnt(0)
s_add_u32 s68, s68, 1
s_and_b32 s84, s68, 0xff
s_not_b32 s70, s68
v_and_b32 v82, 3, v1
v_lshrrev_b32_e64 v82, v82, s70
v_and_b32 v82, 1, v82
v_mul_u32_u24 v82, 0x10001, v82
buffer_load_dwordx4 v13, s[8:11], s75 offen offset:1024 lds
v_lshlrev_b32 v36, 16, v20
v_and_b32 v37, 0xffff0000, v20
v_lshlrev_b32 v38, 16, v21
v_and_b32 v39, 0xffff0000, v21
v_lshlrev_b32 v40, 16, v22
buffer_load_dwordx4 v14, s[8:11], s75 offen offset:2048 lds
v_and_b32 v41, 0xffff0000, v22
v_lshlrev_b32 v42, 16, v23
v_and_b32 v43, 0xffff0000, v23
v_lshlrev_b32 v44, 16, v24
v_and_b32 v45, 0xffff0000, v24
buffer_load_dwordx4 v15, s[8:11], s75 offen offset:3072 lds
v_lshlrev_b32 v46, 16, v25
v_and_b32 v47, 0xffff0000, v25
v_lshlrev_b32 v48, 16, v26
v_and_b32 v49, 0xffff0000, v26
v_lshlrev_b32 v50, 16, v27
s_add_u32 m0, s77, 45056
s_nop 0
buffer_load_dwordx4 v16, s[8:11], s75 offen offset:0 lds
v_and_b32 v51, 0xffff0000, v27
v_lshlrev_b32 v52, 16, v28
v_and_b32 v53, 0xffff0000, v28
v_lshlrev_b32 v54, 16, v29
v_and_b32 v55, 0xffff0000, v29
buffer_load_dwordx4 v17, s[8:11], s75 offen offset:1024 lds
s_add_u32 s75, s75, 393216
s_cmp_eq_u32 s75, 6291456
s_cselect_b32 s75, 0, s75
v_lshlrev_b32 v56, 16, v30
v_and_b32 v57, 0xffff0000, v30
v_lshlrev_b32 v58, 16, v31
v_and_b32 v59, 0xffff0000, v31
v_lshlrev_b32 v60, 16, v32
s_add_u32 m0, s76, 65536
s_nop 0
buffer_load_dwordx4 v8, s[4:7], s74 offen offset:0 lds
v_and_b32 v61, 0xffff0000, v32
v_lshlrev_b32 v62, 16, v33
v_and_b32 v63, 0xffff0000, v33
v_lshlrev_b32 v64, 16, v34
v_and_b32 v65, 0xffff0000, v34
buffer_load_dwordx4 v9, s[4:7], s74 offen offset:1024 lds
v_lshlrev_b32 v66, 16, v35
v_and_b32 v67, 0xffff0000, v35
v_add_f32 v20, v36, v40
v_add_f32 v28, v52, v56
v_add_f32 v21, v37, v41
buffer_load_dwordx4 v10, s[4:7], s74 offen offset:2048 lds
v_add_f32 v29, v53, v57
v_add_f32 v22, v38, v42
v_add_f32 v30, v54, v58
v_add_f32 v23, v39, v43
v_add_f32 v31, v55, v59
buffer_load_dwordx4 v11, s[4:7], s74 offen offset:3072 lds
s_add_u32 s74, s74, 128
s_and_b32 s74, s74, 2047
v_add_f32 v20, v20, v44
v_add_f32 v28, v28, v60
s_waitcnt vmcnt(14)
s_barrier
s_add_u32 m0, s77, 0
s_nop 0
buffer_load_dwordx4 v12, s[8:11], s75 offen offset:0 lds
v_add_f32_e64 v21, v21, v45
v_add_f32 v29, v29, v61
v_add_f32 v22, v22, v46
v_add_f32 v30, v30, v62
v_add_f32 v23, v23, v47
buffer_load_dwordx4 v13, s[8:11], s75 offen offset:1024 lds
v_add_f32 v31, v31, v63
v_add_f32 v20, v20, v48
v_add_f32 v28, v28, v64
v_add_f32 v21, v21, v49
v_add_f32 v29, v29, v65
buffer_load_dwordx4 v14, s[8:11], s75 offen offset:2048 lds
v_add_f32 v22, v22, v50
v_add_f32 v30, v30, v66
v_add_f32 v23, v23, v51
v_add_f32 v31, v31, v67
v_add_f32 v20, v20, v21
buffer_load_dwordx4 v15, s[8:11], s75 offen offset:3072 lds
v_add_f32 v22, v22, v23
v_add_f32 v28, v28, v29
v_add_f32 v30, v30, v31
v_add_f32 v2, v20, v22
v_add_f32 v4, v28, v30
s_add_u32 m0, s77, 4096
s_nop 0
buffer_load_dwordx4 v16, s[8:11], s75 offen offset:0 lds
v_add_f32_dpp v2, v2, v2 row_ror:1 row_mask:0xf bank_mask:0xf
v_add_f32_dpp v4, v4, v4 row_ror:1 row_mask:0xf bank_mask:0xf
s_nop 0
v_add_f32_dpp v2, v2, v2 row_ror:2 row_mask:0xf bank_mask:0xf
v_add_f32_dpp v4, v4, v4 row_ror:2 row_mask:0xf bank_mask:0xf
s_nop 0
v_add_f32_dpp v2, v2, v2 row_ror:4 row_mask:0xf bank_mask:0xf
buffer_load_dwordx4 v17, s[8:11], s75 offen offset:1024 lds
s_add_u32 s75, s75, 393216
s_cmp_eq_u32 s75, 6291456
s_cselect_b32 s75, 0, s75
v_add_f32_dpp v4, v4, v4 row_ror:4 row_mask:0xf bank_mask:0xf
v_add_f32_dpp v2, v2, v2 row_ror:8 row_mask:0xf bank_mask:0xf
s_nop 0
v_add_f32_dpp v4, v4, v4 row_ror:8 row_mask:0xf bank_mask:0xf
v_mov_b32 v6, v2
v_mov_b32 v7, v4
s_add_u32 m0, s76, 24576
s_nop 0
buffer_load_dwordx4 v8, s[4:7], s74 offen offset:0 lds
v_permlane16_swap_b32 v2, v6
v_permlane16_swap_b32 v4, v7
v_add_f32 v2, v2, v6
v_add_f32 v4, v4, v7
v_mov_b32 v6, v2
buffer_load_dwordx4 v9, s[4:7], s74 offen offset:1024 lds
v_mov_b32 v7, v4
v_permlane32_swap_b32 v2, v6
s_nop 0
v_permlane32_swap_b32 v4, v7
v_add_f32 v2, v2, v6
v_add_f32 v4, v4, v7
buffer_load_dwordx4 v10, s[4:7], s74 offen offset:2048 lds
v_mul_f32 v2, 0xba800000, v2
v_mul_f32 v4, 0xba800000, v4
v_add_f32 v36, v36, v2
v_add_f32 v52, v52, v4
v_add_f32_e64 v37, v37, v2
buffer_load_dwordx4 v11, s[4:7], s74 offen offset:3072 lds
s_add_u32 s74, s74, 128
s_and_b32 s74, s74, 2047
v_add_f32 v53, v53, v4
v_add_f32 v38, v38, v2
s_cmp_eq_u32 s60, 0
s_cbranch_scc1 L_pad0
s_cmp_eq_u32 s60, 1
s_cbranch_scc1 L_pad3
s_cmp_eq_u32 s60, 2
s_cbranch_scc1 L_pad4
s_branch L_pad5
L_ret4:
s_waitcnt vmcnt(14)
s_barrier
s_add_u32 m0, s77, 81920
s_nop 0
buffer_load_dwordx4 v12, s[8:11], s75 offen offset:0 lds
v_add_f32 v54, v54, v4
v_add_f32 v39, v39, v2
v_add_f32 v55, v55, v4
v_add_f32 v40, v40, v2
v_add_f32 v56, v56, v4
buffer_load_dwordx4 v13, s[8:11], s75 offen offset:1024 lds
v_add_f32 v41, v41, v2
v_add_f32 v57, v57, v4
v_add_f32 v42, v42, v2
v_add_f32 v58, v58, v4
v_add_f32 v43, v43, v2
buffer_load_dwordx4 v14, s[8:11], s75 offen offset:2048 lds
v_add_f32 v59, v59, v4
v_add_f32 v44, v44, v2
v_add_f32 v60, v60, v4
v_add_f32 v45, v45, v2
v_add_f32 v61, v61, v4
buffer_load_dwordx4 v15, s[8:11], s75 offen offset:3072 lds
v_add_f32 v46, v46, v2
v_add_f32 v62, v62, v4
v_add_f32 v47, v47, v2
v_add_f32 v63, v63, v4
v_add_f32 v48, v48, v2
s_add_u32 m0, s77, 86016
s_nop 0
buffer_load_dwordx4 v16, s[8:11], s75 offen offset:0 lds
v_add_f32 v64, v64, v4
v_add_f32 v49, v49, v2
v_add_f32 v65, v65, v4
v_add_f32 v50, v50, v2
v_add_f32 v66, v66, v4
buffer_load_dwordx4 v17, s[8:11], s75 offen offset:1024 lds
s_add_u32 s75, s75, 393216
s_cmp_eq_u32 s75, 6291456
s_cselect_b32 s75, 0, s75
v_add_f32 v51, v51, v2
v_add_f32 v67, v67, v4
v_mul_f32 v20, v36, v36
v_mul_f32 v28, v52, v52
v_mul_f32 v21, v37, v37
s_add_u32 m0, s76, 122880
s_nop 0
buffer_load_dwordx4 v8, s[4:7], s74 offen offset:0 lds
v_mul_f32 v29, v53, v53
v_fmac_f32 v20, v38, v38
v_fmac_f32 v28, v54, v54
v_fmac_f32 v21, v39, v39
v_fmac_f32 v29, v55, v55
buffer_load_dwordx4 v9, s[4:7], s74 offen offset:1024 lds
v_fmac_f32 v20, v40, v40
v_fmac_f32 v28, v56, v56
v_fmac_f32 v21, v41, v41
v_fmac_f32 v29, v57, v57
v_fmac_f32 v20, v42, v42
buffer_load_dwordx4 v10, s[4:7], s74 offen offset:2048 lds
v_fmac_f32 v28, v58, v58
v_fmac_f32 v21, v43, v43
v_fmac_f32 v29, v59, v59
v_fmac_f32 v20, v44, v44
v_fmac_f32 v28, v60, v60
buffer_load_dwordx4 v11, s[4:7], s74 offen offset:3072 lds
s_add_u32 s74, s74, 128
s_and_b32 s74, s74, 2047
v_fmac_f32 v21, v45, v45
s_branch L_over0
L_pad0:
s_branch L_ret4
L_over0:
v_fmac_f32 v29, v61, v61
s_waitcnt vmcnt(14)
s_barrier
s_add_u32 m0, s77, 40960
s_nop 0
buffer_load_dwordx4 v12, s[8:11], s75 offen offset:0 lds
v_fmac_f32 v20, v46, v46
v_fmac_f32 v28, v62, v62
v_fmac_f32 v21, v47, v47
v_fmac_f32 v29, v63, v63
v_fmac_f32 v20, v48, v48
buffer_load_dwordx4 v13, s[8:11], s75 offen offset:1024 lds
v_fmac_f32 v28, v64, v64
v_fmac_f32 v21, v49, v49
v_fmac_f32 v29, v65, v65
v_fmac_f32 v20, v50, v50
v_fmac_f32 v28, v66, v66
buffer_load_dwordx4 v14, s[8:11], s75 offen offset:2048 lds
v_fmac_f32 v21, v51, v51
v_fmac_f32 v29, v67, v67
v_add_f32 v3, v20, v21
v_add_f32 v5, v28, v29
s_nop 0
v_add_f32_dpp v3, v3, v3 row_ror:1 row_mask:0xf bank_mask:0xf
buffer_load_dwordx4 v15, s[8:11], s75 offen offset:3072 lds
v_add_f32_dpp v5, v5, v5 row_ror:1 row_mask:0xf bank_mask:0xf
v_add_f32_dpp v3, v3, v3 row_ror:2 row_mask:0xf bank_mask:0xf
s_nop 0
v_add_f32_dpp v5, v5, v5 row_ror:2 row_mask:0xf bank_mask:0xf
v_add_f32_dpp v3, v3, v3 row_ror:4 row_mask:0xf bank_mask:0xf
s_nop 0
v_add_f32_dpp v5, v5, v5 row_ror:4 row_mask:0xf bank_mask:0xf
s_add_u32 m0, s77, 45056
s_nop 0
buffer_load_dwordx4 v16, s[8:11], s75 offen offset:0 lds
v_add_f32_dpp v3, v3, v3 row_ror:8 row_mask:0xf bank_mask:0xf
v_add_f32_dpp v5, v5, v5 row_ror:8 row_mask:0xf bank_mask:0xf
v_mov_b32 v6, v3
v_mov_b32 v7, v5
s_nop 0
v_permlane16_swap_b32 v3, v6
buffer_load_dwordx4 v17, s[8:11], s75 offen offset:1024 lds
s_add_u32 s75, s75, 393216
s_cmp_eq_u32 s75, 6291456
s_cselect_b32 s75, 0, s75
v_permlane16_swap_b32 v5, v7
v_add_f32 v3, v3, v6
v_add_f32 v5, v5, v7
v_mov_b32 v6, v3
v_mov_b32 v7, v5
s_add_u32 m0, s76, 106496
s_nop 0
buffer_load_dwordx4 v8, s[4:7], s74 offen offset:0 lds
v_permlane32_swap_b32 v3, v6
v_permlane32_swap_b32 v5, v7
v_add_f32 v3, v3, v6
v_add_f32 v5, v5, v7
v_mov_b32 v6, 0x3727c5ac
buffer_load_dwordx4 v9, s[4:7], s74 offen offset:1024 lds
v_fmac_f32 v6, 0x3a800000, v3
v_rsq_f32 v3, v6
v_mov_b32 v6, 0x3727c5ac
v_fmac_f32 v6, 0x3a800000, v5
v_rsq_f32 v5, v6
buffer_load_dwordx4 v10, s[4:7], s74 offen offset:2048 lds
v_cmp_eq_u32 vcc, 1, v1
s_nop 1
v_cndmask_b32 v20, v2, v4, vcc
v_cndmask_b32 v21, v3, v5, vcc
v_mov_b32 v22, 0
v_mov_b32 v23, s68
buffer_load_dwordx4 v11, s[4:7], s74 offen offset:3072 lds
s_add_u32 s74, s74, 128
s_and_b32 s74, s74, 2047
buffer_load_dwordx4 a[0:3], v76, s[24:27], s85 offen nt
buffer_load_dwordx4 a[32:35], v78, s[28:31], s85 offen nt
s_add_u32 s85, s85, 57344
buffer_load_dwordx4 a[4:7], v76, s[24:27], s85 offen nt
buffer_load_dwordx4 a[36:39], v78, s[28:31], s85 offen nt
s_add_u32 s85, s85, 57344
buffer_load_dwordx4 a[8:11], v76, s[24:27], s85 offen nt
buffer_load_dwordx4 a[40:43], v78, s[28:31], s85 offen nt
s_add_u32 s85, s85, 57344
s_lshl_b32 s70, s87, 4
s_add_u32 s70, s70, 8192
s_mov_b64 exec, 3
buffer_store_dwordx4 v[20:23], v18, s[12:15], s70 offen sc1
s_mov_b64 exec, -1
s_waitcnt vmcnt(21)
s_barrier
s_add_u32 m0, s77, 0
s_nop 0
buffer_load_dwordx4 v12, s[8:11], s75 offen offset:0 lds
v_lshlrev_b32 v2, 16, v88
v_and_b32 v3, 0xffff0000, v88
v_lshlrev_b32_e64 v4, 16, v89
buffer_load_dwordx4 v13, s[8:11], s75 offen offset:1024 lds
v_and_b32 v5, 0xffff0000, v89
v_add_f32 v2, v2, v3
v_add_f32 v4, v4, v5
buffer_load_dwordx4 v14, s[8:11], s75 offen offset:2048 lds
v_add_f32 v2, v2, v4
s_nop 1
v_add_f32_dpp v2, v2, v2 row_ror:1 row_mask:0xf bank_mask:0xf
s_nop 1
v_add_f32_dpp v2, v2, v2 row_ror:2 row_mask:0xf bank_mask:0xf
buffer_load_dwordx4 v15, s[8:11], s75 offen offset:3072 lds
s_nop 0
v_add_f32_dpp v2, v2, v2 row_ror:4 row_mask:0xf bank_mask:0xf
s_nop 1
v_add_f32_dpp v2, v2, v2 row_ror:8 row_mask:0xf bank_mask:0xf
v_mov_b32 v3, v2
s_add_u32 m0, s77, 4096
s_nop 0
buffer_load_dwordx4 v16, s[8:11], s75 offen offset:0 lds
v_permlane16_swap_b32 v2, v3
v_add_f32 v2, v2, v3
v_mov_b32 v3, v2
buffer_load_dwordx4 v17, s[8:11], s75 offen offset:1024 lds
s_add_u32 s75, s75, 393216
s_cmp_eq_u32 s75, 6291456
s_cselect_b32 s75, 0, s75
v_permlane32_swap_b32 v2, v3
v_add_f32 v2, v2, v3
s_lshl_b32 s70, s60, 2
s_add_u32 s70, s70, 162176
v_mov_b32 v3, s70
s_add_u32 m0, s76, 65536
s_nop 0
buffer_load_dwordx4 v8, s[4:7], s74 offen offset:0 lds
ds_write_b32 v3, v2
s_lshl_b32 s70, s60, 2
s_sub_u32 s70, s70, s65
s_lshl_b32 s70, s70, 4
v_add_u32 v4, s70, v1
v_min_u32_e64 v4, 18, v4
buffer_load_dwordx4 v9, s[4:7], s74 offen offset:1024 lds
v_cmp_gt_u32 vcc, 16, v4
s_nop 1
v_cndmask_b32 v4, 18, v4, vcc
v_lshlrev_b32 v4, 3, v4
buffer_load_dwordx4 v10, s[4:7], s74 offen offset:2048 lds
v_add_u32 v4, 162048, v4
ds_write_b64 v4, v[88:89]
buffer_load_dwordx4 v11, s[4:7], s74 offen offset:3072 lds
s_add_u32 s74, s74, 128
s_and_b32 s74, s74, 2047
s_waitcnt vmcnt(21)
s_barrier
s_add_u32 m0, s77, 81920
s_nop 0
buffer_load_dwordx4 v12, s[8:11], s75 offen offset:0 lds
s_getreg_b32 s71, hwreg(HW_REG_XCC_ID, 0, 4)
v_mov_b32 v84, s71
buffer_load_dwordx4 v13, s[8:11], s75 offen offset:1024 lds
v_mov_b32 v85, 0
buffer_load_dwordx4 v14, s[8:11], s75 offen offset:2048 lds
v_mov_b32 v86, 0
buffer_load_dwordx4 v15, s[8:11], s75 offen offset:3072 lds
v_mov_b32 v87, s68
s_add_u32 m0, s77, 86016
s_nop 0
buffer_load_dwordx4 v16, s[8:11], s75 offen offset:0 lds
s_lshl_b32 s70, s79, 4
s_add_u32 s70, s70, 4096
v_mov_b32 v19, s70
buffer_load_dwordx4 v17, s[8:11], s75 offen offset:1024 lds
s_add_u32 s75, s75, 393216
s_cmp_eq_u32 s75, 6291456
s_cselect_b32 s75, 0, s75
s_lshl_b32 s70, s65, 4
s_add_u32 s70, s70, s64
s_lshl_b32 s70, s70, 4
s_add_u32 s70, s70, 40960
v_writelane_b32 v19, s70, 1
s_add_u32 m0, s76, 24576
s_nop 0
buffer_load_dwordx4 v8, s[4:7], s74 offen offset:0 lds
buffer_load_dwordx4 v9, s[4:7], s74 offen offset:1024 lds
buffer_load_dwordx4 v10, s[4:7], s74 offen offset:2048 lds
buffer_load_dwordx4 v11, s[4:7], s74 offen offset:3072 lds
s_add_u32 s74, s74, 128
s_and_b32 s74, s74, 2047
buffer_load_dwordx4 a[12:15], v76, s[24:27], s85 offen nt
buffer_load_dwordx4 a[44:47], v78, s[28:31], s85 offen nt
s_add_u32 s85, s85, 57344
buffer_load_dwordx4 a[16:19], v76, s[24:27], s85 offen nt
buffer_load_dwordx4 a[48:51], v78, s[28:31], s85 offen nt
s_add_u32 s85, s85, 57344
buffer_load_dwordx4 a[20:23], v76, s[24:27], s85 offen nt
buffer_load_dwordx4 a[52:55], v78, s[28:31], s85 offen nt
s_add_u32 s85, s85, 57344
s_mov_b64 exec, 3
buffer_store_dwordx4 v[84:87], v19, s[12:15], 0 offen sc1
s_mov_b64 exec, -1
s_waitcnt vmcnt(21)
s_barrier
s_add_u32 m0, s77, 40960
s_nop 0
buffer_load_dwordx4 v12, s[8:11], s75 offen offset:0 lds
buffer_load_dwordx4 v13, s[8:11], s75 offen offset:1024 lds
buffer_load_dwordx4 v14, s[8:11], s75 offen offset:2048 lds
buffer_load_dwordx4 v15, s[8:11], s75 offen offset:3072 lds
s_add_u32 m0, s77, 45056
s_nop 0
buffer_load_dwordx4 v16, s[8:11], s75 offen offset:0 lds
buffer_load_dwordx4 v17, s[8:11], s75 offen offset:1024 lds
s_add_u32 s75, s75, 393216
s_cmp_eq_u32 s75, 6291456
s_cselect_b32 s75, 0, s75
s_add_u32 m0, s76, 122880
s_nop 0
buffer_load_dwordx4 v8, s[4:7], s74 offen offset:0 lds
buffer_load_dwordx4 v9, s[4:7], s74 offen offset:1024 lds
buffer_load_dwordx4 v10, s[4:7], s74 offen offset:2048 lds
buffer_load_dwordx4 v11, s[4:7], s74 offen offset:3072 lds
s_add_u32 s74, s74, 128
s_and_b32 s74, s74, 2047
s_cmp_eq_u32 s60, 0
s_cbranch_scc1 L_pad6
s_cmp_eq_u32 s60, 1
s_cbranch_scc1 L_ret9
s_cmp_eq_u32 s60, 2
s_cbranch_scc1 L_ret9
s_branch L_ret9
L_ret9:
s_waitcnt vmcnt(21)
s_barrier
s_add_u32 m0, s77, 0
s_nop 0
buffer_load_dwordx4 v12, s[8:11], s75 offen offset:0 lds
buffer_load_dwordx4 v13, s[8:11], s75 offen offset:1024 lds
buffer_load_dwordx4 v14, s[8:11], s75 offen offset:2048 lds
buffer_load_dwordx4 v15, s[8:11], s75 offen offset:3072 lds
s_add_u32 m0, s77, 4096
s_nop 0
buffer_load_dwordx4 v16, s[8:11], s75 offen offset:0 lds
buffer_load_dwordx4 v17, s[8:11], s75 offen offset:1024 lds
s_add_u32 s75, s75, 393216
s_cmp_eq_u32 s75, 6291456
s_cselect_b32 s75, 0, s75
s_add_u32 m0, s76, 106496
s_nop 0
buffer_load_dwordx4 v8, s[4:7], s74 offen offset:0 lds
buffer_load_dwordx4 v9, s[4:7], s74 offen offset:1024 lds
buffer_load_dwordx4 v10, s[4:7], s74 offen offset:2048 lds
buffer_load_dwordx4 v11, s[4:7], s74 offen offset:3072 lds
s_add_u32 s74, s74, 128
s_and_b32 s74, s74, 2047
buffer_load_dwordx4 a[24:27], v76, s[24:27], s85 offen nt
buffer_load_dwordx4 a[56:59], v78, s[28:31], s85 offen nt
s_add_u32 s85, s85, 57344
buffer_load_dwordx4 a[28:31], v76, s[24:27], s85 offen nt
buffer_load_dwordx4 a[60:63], v78, s[28:31], s85 offen nt
s_add_u32 s85, s85, 57344
buffer_load_dwordx4 a[64:67], v77, s[32:35], s86 offen nt
s_add_u32 s86, s86, 16384
buffer_load_dwordx4 a[68:71], v77, s[32:35], s86 offen nt
s_add_u32 s86, s86, 16384
s_waitcnt vmcnt(20)
s_barrier
s_add_u32 m0, s77, 81920
s_nop 0
buffer_load_dwordx4 v12, s[8:11], s75 offen offset:0 lds
v_lshrrev_b32 v2, 4, v1
v_and_b32 v3, 15, v1
v_lshlrev_b32 v44, 10, v2
buffer_load_dwordx4 v13, s[8:11], s75 offen offset:1024 lds
v_lshl_add_u32 v44, v3, 4, v44
s_lshl_b32 s70, s60, 8
v_add_u32 v44, s70, v44
s_lshl_b32 s87, s64, 14
s_add_u32 s87, s87, 65536
buffer_load_dwordx4 v14, s[8:11], s75 offen offset:2048 lds
v_and_b32 v45, 31, v1
v_lshlrev_b32 v45, 4, v45
s_lshl_b32 s88, s65, 11
s_lshl_b32 s70, s60, 9
s_add_u32 s88, s88, s70
s_add_u32 s88, s88, 8192
buffer_load_dwordx4 v15, s[8:11], s75 offen offset:3072 lds
s_lshl_b32 s70, s64, 8
s_add_u32 s70, s70, 4096
v_lshlrev_b32 v4, 4, v3
v_add_u32 v4, s70, v4
v_add_u32 v5, 36864, v4
v_lshrrev_b32 v6, 5, v1
s_add_u32 m0, s77, 86016
s_nop 0
buffer_load_dwordx4 v16, s[8:11], s75 offen offset:0 lds
v_lshlrev_b32 v6, 11, v6
v_xor_b32 v5, v5, v6
v_lshrrev_b32 v6, 5, v1
buffer_load_dwordx4 v17, s[8:11], s75 offen offset:1024 lds
s_add_u32 s75, s75, 393216
s_cmp_eq_u32 s75, 6291456
s_cselect_b32 s75, 0, s75
v_lshlrev_b32 v6, 8, v6
v_xor_b32 v4, v4, v6
v_and_b32 v6, 1, v2
s_add_u32 m0, s76, 65536
s_nop 0
buffer_load_dwordx4 v8, s[4:7], s74 offen offset:0 lds
v_cmp_eq_u32 vcc, 1, v6
s_nop 1
v_cndmask_b32 v46, v4, v5, vcc
v_lshlrev_b32 v48, 2, v1
buffer_load_dwordx4 v9, s[4:7], s74 offen offset:1024 lds
v_add_u32 v48, 7225600, v48
buffer_load_dwordx4 v10, s[4:7], s74 offen offset:2048 lds
buffer_load_dwordx4 v11, s[4:7], s74 offen offset:3072 lds
s_add_u32 s74, s74, 128
s_and_b32 s74, s74, 2047
s_add_u32 s70, s87, 0
buffer_load_dwordx4 v[20:23], v44, s[12:15], s70 offen sc1
buffer_load_dwordx4 v[36:39], v45, s[12:15], s88 offen sc1
buffer_load_dwordx4 v[40:43], v46, s[12:15], 0 offen offset:0 sc1
buffer_load_dword v47, v48, s[12:15], 0 offen sc1
s_waitcnt vmcnt(24)
s_barrier
s_add_u32 m0, s77, 40960
s_nop 0
buffer_load_dwordx4 v12, s[8:11], s75 offen offset:0 lds
buffer_load_dwordx4 v13, s[8:11], s75 offen offset:1024 lds
buffer_load_dwordx4 v14, s[8:11], s75 offen offset:2048 lds
buffer_load_dwordx4 v15, s[8:11], s75 offen offset:3072 lds
s_add_u32 m0, s77, 45056
s_nop 0
buffer_load_dwordx4 v16, s[8:11], s75 offen offset:0 lds
buffer_load_dwordx4 v17, s[8:11], s75 offen offset:1024 lds
s_add_u32 s75, s75, 393216
s_cmp_eq_u32 s75, 6291456
s_cselect_b32 s75, 0, s75
s_add_u32 m0, s76, 24576
s_nop 0
buffer_load_dwordx4 v8, s[4:7], s74 offen offset:0 lds
buffer_load_dwordx4 v9, s[4:7], s74 offen offset:1024 lds
buffer_load_dwordx4 v10, s[4:7], s74 offen offset:2048 lds
buffer_load_dwordx4 v11, s[4:7], s74 offen offset:3072 lds
s_add_u32 s74, s74, 128
s_and_b32 s74, s74, 2047
buffer_load_dwordx4 a[72:75], v77, s[32:35], s86 offen nt
s_add_u32 s86, s86, 16384
buffer_load_dwordx4 a[76:79], v77, s[32:35], s86 offen nt
s_add_u32 s86, s86, 16384
buffer_load_dwordx4 a[80:83], v77, s[32:35], s86 offen nt
s_add_u32 s86, s86, 16384
s_waitcnt vmcnt(21)
s_barrier
s_add_u32 m0, s77, 0
s_nop 0
buffer_load_dwordx4 v12, s[8:11], s75 offen offset:0 lds
s_waitcnt vmcnt(14) lgkmcnt(0)
L_eg_chk:
v_xor_b32 v2, s68, v23
v_xor_b32 v3, s68, v39
v_xor_b32 v4, s68, v43
v_or3_b32 v2, v2, v3, v4
s_lshl_b32 s70, s68, 2
v_xor_b32 v3, s70, v47
v_lshrrev_b32 v3, 2, v3
v_or_b32 v2, v2, v3
v_cmp_ne_u32 vcc, 0, v2
s_cbranch_vccnz L_eg_rt
L_eg_ok:

v_mov_b32 v24, v20
v_mov_b32 v25, v21
buffer_load_dwordx4 v13, s[8:11], s75 offen offset:1024 lds
v_mov_b32_e64 v26, v22
v_permlane16_swap_b32 v20, v24
v_permlane16_swap_b32 v21, v25
buffer_load_dwordx4 v14, s[8:11], s75 offen offset:2048 lds
v_permlane16_swap_b32 v22, v26
v_add_f32 v20, v20, v24
v_add_f32 v21, v21, v25
buffer_load_dwordx4 v15, s[8:11], s75 offen offset:3072 lds
v_add_f32 v22, v22, v26
v_mov_b32 v24, v20
v_mov_b32 v25, v21
s_add_u32 m0, s77, 4096
s_nop 0
buffer_load_dwordx4 v16, s[8:11], s75 offen offset:0 lds
v_mov_b32 v26, v22
v_permlane32_swap_b32 v20, v24
v_permlane32_swap_b32 v21, v25
buffer_load_dwordx4 v17, s[8:11], s75 offen offset:1024 lds
s_add_u32 s75, s75, 393216
s_cmp_eq_u32 s75, 6291456
s_cselect_b32 s75, 0, s75
v_permlane32_swap_b32 v22, v26
v_add_f32 v20, v20, v24
v_add_f32 v21, v21, v25
s_cmp_gt_u32 s65, 3
s_subb_u32 s70, s65, 0
s_cmp_gt_u32 s65, 11
s_subb_u32 s70, s70, 0
s_mov_b32 s71, 22181
s_bitcmp1_b32 s71, s64
s_cselect_b32 s71, 14, 0
s_cselect_b32 s72, 0, 0xf700
s_or_b32 s72, s72, 0xf7
s_add_u32 s70, s70, s71
s_lshl2_add_u32 s70, s70, s60
s_mul_i32 s70, s70, 25600
v_lshlrev_b32 v19, 10, v1
s_bitcmp1_b32 s72, s65
s_cselect_b32 exec_lo, 33554431, 0
s_mov_b32 exec_hi, 0
buffer_load_dword v81, v19, s[16:19], s70 offen offset:384
s_mov_b64 exec, -1
buffer_load_dwordx4 a[84:87], v77, s[32:35], s86 offen nt
s_add_u32 s86, s86, 16384
buffer_load_dwordx4 a[88:91], v77, s[32:35], s86 offen nt
s_add_u32 s86, s86, 16384
buffer_load_dwordx4 a[92:95], v77, s[32:35], s86 offen nt
s_add_u32 s86, s86, 16384
s_waitcnt vmcnt(17)
s_barrier
s_mul_i32 s70, s60, 2
s_add_u32 s70, s70, 120
s_lshl_b32 s82, s89, 3
s_add_u32 s82, s82, s70
s_lshl_b32 s70, s70, 10
s_add_u32 m0, s70, 28672
s_and_b32 s82, s82, 127
s_lshl_b32 s82, s82, 14
buffer_load_dwordx4 v80, s[16:19], s82 offen lds
v_add_f32 v22, v22, v26
v_and_b32 v3, 15, v1
v_lshlrev_b32 v3, 2, v3
s_lshl_b32 s70, s60, 6
s_add_u32 s70, s70, 160768
v_add_u32 v3, s70, v3
ds_write_b32 v3, v20 offset:0
ds_write_b32 v3, v21 offset:256
ds_write_b32 v3, v22 offset:512
v_lshrrev_b32 v4, 2, v45
s_lshl_b32 s70, s60, 7
s_add_u32 s70, s70, 159744
v_add_u32_e64 v4, s70, v4
s_add_u32 m0, m0, 1024
s_add_u32 s82, s82, 16384
s_and_b32 s82, s82, 0x1fffff
buffer_load_dwordx4 v80, s[16:19], s82 offen lds
ds_write_b32 v4, v36
ds_write_b32 v4, v37 offset:512
s_getreg_b32 s71, hwreg(HW_REG_XCC_ID, 0, 4)
v_cmp_ne_u32 vcc, s71, v40
s_nop 0
s_or_b32 s70, vcc_lo, vcc_hi
s_and_b32 s70, s70, 0xffff
s_cselect_b32 s69, 0, 1
v_and_b32 v5, 3, v47
v_cmp_eq_u32 vcc, 1, v5
s_nop 0
s_bcnt1_i32_b64 s70, vcc
v_cmp_eq_u32 vcc, 2, v5
s_nop 0
s_bcnt1_i32_b64 s71, vcc
s_cmp_gt_u32 s71, s70
s_cselect_b32 s61, 8192, 0
s_or_b32 s70, s69, s61
v_mov_b32 v5, s70
v_mov_b32 v6, 161536
ds_write_b32 v6, v5
s_mov_b32 exec_lo, 0
s_mov_b32 exec_hi, 0xff
v_xor_b32 v83, s61, v83
s_mov_b64 exec, -1
s_waitcnt vmcnt(6)
s_barrier
s_mul_i32 s70, s60, 10
s_add_u32 s70, s70, 80
s_lshl_b32 s82, s89, 3
s_add_u32 s82, s82, s70
s_lshl_b32 s70, s70, 10
s_add_u32 m0, s70, 28672
s_and_b32 s82, s82, 127
s_lshl_b32 s82, s82, 14
buffer_load_dwordx4 v80, s[16:19], s82 offen lds
s_add_u32 m0, m0, 1024
s_add_u32 s82, s82, 16384
s_and_b32 s82, s82, 0x1fffff
buffer_load_dwordx4 v80, s[16:19], s82 offen lds
s_add_u32 m0, m0, 1024
s_add_u32 s82, s82, 16384
s_and_b32 s82, s82, 0x1fffff
buffer_load_dwordx4 v80, s[16:19], s82 offen lds
s_add_u32 m0, m0, 1024
s_add_u32 s82, s82, 16384
s_and_b32 s82, s82, 0x1fffff
buffer_load_dwordx4 v80, s[16:19], s82 offen lds
s_add_u32 m0, m0, 1024
s_add_u32 s82, s82, 16384
s_and_b32 s82, s82, 0x1fffff
buffer_load_dwordx4 v80, s[16:19], s82 offen lds
s_add_u32 m0, m0, 1024
s_add_u32 s82, s82, 16384
s_and_b32 s82, s82, 0x1fffff
buffer_load_dwordx4 v80, s[16:19], s82 offen lds
s_add_u32 m0, m0, 1024
s_add_u32 s82, s82, 16384
s_and_b32 s82, s82, 0x1fffff
buffer_load_dwordx4 v80, s[16:19], s82 offen lds
s_add_u32 m0, m0, 1024
s_add_u32 s82, s82, 16384
s_and_b32 s82, s82, 0x1fffff
buffer_load_dwordx4 v80, s[16:19], s82 offen lds
s_add_u32 m0, m0, 1024
s_add_u32 s82, s82, 16384
s_and_b32 s82, s82, 0x1fffff
buffer_load_dwordx4 v80, s[16:19], s82 offen lds
s_add_u32 m0, m0, 1024
s_add_u32 s82, s82, 16384
s_and_b32 s82, s82, 0x1fffff
buffer_load_dwordx4 v80, s[16:19], s82 offen lds
s_setprio 0
s_waitcnt lgkmcnt(0)
s_barrier
s_mov_b32 exec_lo, 0x0
s_mov_b32 exec_hi, 0x3f00000f
buffer_load_dword v81, v83, s[12:15], 0 offen
s_mov_b64 exec, -1
s_mul_i32 s70, s60, 12
s_add_u32 s70, s70, 16
s_lshl_b32 s82, s89, 3
s_add_u32 s82, s82, s70
s_lshl_b32 s70, s70, 10
s_add_u32 m0, s70, 28672
s_and_b32 s82, s82, 127
s_lshl_b32 s82, s82, 14
buffer_load_dwordx4 v80, s[16:19], s82 offen lds
s_add_u32 m0, m0, 1024
s_add_u32 s82, s82, 16384
s_and_b32 s82, s82, 0x1fffff
buffer_load_dwordx4 v80, s[16:19], s82 offen lds
s_add_u32 m0, m0, 1024
s_add_u32 s82, s82, 16384
s_and_b32 s82, s82, 0x1fffff
buffer_load_dwordx4 v80, s[16:19], s82 offen lds
s_add_u32 m0, m0, 1024
s_add_u32 s82, s82, 16384
s_and_b32 s82, s82, 0x1fffff
buffer_load_dwordx4 v80, s[16:19], s82 offen lds
s_add_u32 m0, m0, 1024
s_add_u32 s82, s82, 16384
s_and_b32 s82, s82, 0x1fffff
buffer_load_dwordx4 v80, s[16:19], s82 offen lds
s_add_u32 m0, m0, 1024
s_add_u32 s82, s82, 16384
s_and_b32 s82, s82, 0x1fffff
buffer_load_dwordx4 v80, s[16:19], s82 offen lds
s_add_u32 m0, m0, 1024
s_add_u32 s82, s82, 16384
s_and_b32 s82, s82, 0x1fffff
buffer_load_dwordx4 v80, s[16:19], s82 offen lds
s_add_u32 m0, m0, 1024
s_add_u32 s82, s82, 16384
s_and_b32 s82, s82, 0x1fffff
buffer_load_dwordx4 v80, s[16:19], s82 offen lds
s_add_u32 m0, m0, 1024
s_add_u32 s82, s82, 16384
s_and_b32 s82, s82, 0x1fffff
buffer_load_dwordx4 v80, s[16:19], s82 offen lds
s_add_u32 m0, m0, 1024
s_add_u32 s82, s82, 16384
s_and_b32 s82, s82, 0x1fffff
buffer_load_dwordx4 v80, s[16:19], s82 offen lds
s_add_u32 m0, m0, 1024
s_add_u32 s82, s82, 16384
s_and_b32 s82, s82, 0x1fffff
buffer_load_dwordx4 v80, s[16:19], s82 offen lds
s_add_u32 m0, m0, 1024
s_add_u32 s82, s82, 16384
s_and_b32 s82, s82, 0x1fffff
buffer_load_dwordx4 v80, s[16:19], s82 offen lds
s_sub_i32 s70, s64, s65
s_lshl_b32 s70, s70, 18
v_add_u32 v8, s70, v8
v_add_u32 v9, s70, v9
v_add_u32 v10, s70, v10
v_add_u32 v11, s70, v11
v_lshrrev_b32 v2, 4, v1
v_bfe_u32 v3, v1, 2, 2
v_and_b32 v4, 1, v1
v_lshlrev_b32 v4, 4, v4
v_mov_b32 v5, 0x3f80
v_lshlrev_b32 v4, v4, v5
v_cmp_eq_u32 vcc, v2, v3
s_nop 1
v_cndmask_b32 v4, 0, v4, vcc
v_and_b32 v5, 2, v1
v_cmp_eq_u32 vcc, 0, v5
s_nop 1
v_cndmask_b32 v58, 0, v4, vcc
v_cndmask_b32_e64 v59, v4, 0, vcc
v_mov_b32 v56, 0
v_mov_b32 v57, 0
v_mov_b32 v60, 0
v_mov_b32 v61, 0
v_and_b32 v3, 15, v1
v_mul_u32_u24 v55, 4352, v3
v_lshrrev_b32 v2, 4, v1
v_lshl_add_u32 v55, v2, 5, v55
s_mul_i32 s87, s64, 69632
s_add_u32 s87, s87, 524288
s_lshl_b32 s70, s66, 7
s_lshl_b32 s71, s67, 4
s_add_u32 s88, s70, s71
s_add_u32 s88, s88, s87
s_add_u32 s88, s88, 4096
s_lshl_b32 s70, s60, 10
s_add_u32 s87, s87, s70
s_cmp_eq_u32 s60, 0
s_cbranch_scc1 L_pad1
s_cmp_eq_u32 s60, 1
s_cbranch_scc1 L_pad9
s_cmp_eq_u32 s60, 2
s_cbranch_scc1 L_pad14
s_branch L_retF
L_retF:
s_barrier
s_barrier
s_mul_i32 s70, s60, 4
s_add_u32 s70, s70, 0
s_lshl_b32 s82, s89, 3
s_add_u32 s82, s82, s70
s_lshl_b32 s70, s70, 10
s_add_u32 m0, s70, 28672
s_and_b32 s82, s82, 127
s_lshl_b32 s82, s82, 14
buffer_load_dwordx4 v80, s[16:19], s82 offen lds
s_add_u32 m0, m0, 1024
s_add_u32 s82, s82, 16384
s_and_b32 s82, s82, 0x1fffff
buffer_load_dwordx4 v80, s[16:19], s82 offen lds
s_add_u32 m0, m0, 1024
s_add_u32 s82, s82, 16384
s_and_b32 s82, s82, 0x1fffff
buffer_load_dwordx4 v80, s[16:19], s82 offen lds
s_add_u32 m0, m0, 1024
s_add_u32 s82, s82, 16384
s_and_b32 s82, s82, 0x1fffff
buffer_load_dwordx4 v80, s[16:19], s82 offen lds
s_lshl_b32 s70, s65, 7
s_mov_b32 m0, s76
s_nop 0
buffer_load_dwordx4 v8, s[4:7], s70 offen offset:0 lds
buffer_load_dwordx4 v9, s[4:7], s70 offen offset:1024 lds
buffer_load_dwordx4 v10, s[4:7], s70 offen offset:2048 lds
buffer_load_dwordx4 v11, s[4:7], s70 offen offset:3072 lds
s_add_u32 s70, s65, 1
s_and_b32 s70, s70, 15
s_mul_i32 s70, s70, 4352
s_add_u32 s70, s70, s87
buffer_load_dwordx4 v[84:87], v18, s[12:15], s70 offen sc1
s_add_u32 s70, s65, 2
s_and_b32 s70, s70, 15
s_mul_i32 s70, s70, 4352
s_add_u32 s70, s70, s87
buffer_load_dwordx4 v[88:91], v18, s[12:15], s70 offen sc1
s_add_u32 s70, s65, 3
s_and_b32 s70, s70, 15
s_mul_i32 s70, s70, 4352
s_add_u32 s70, s70, s87
buffer_load_dwordx4 v[92:95], v18, s[12:15], s70 offen sc1
s_add_u32 s70, s65, 4
s_and_b32 s70, s70, 15
s_mul_i32 s70, s70, 4352
s_branch L_over1
L_pad1:
s_branch L_retF
L_over1:
s_add_u32 s70, s70, s87
buffer_load_dwordx4 v[96:99], v18, s[12:15], s70 offen sc1
s_add_u32 s70, s65, 5
s_and_b32 s70, s70, 15
s_mul_i32 s70, s70, 4352
s_add_u32 s70, s70, s87
buffer_load_dwordx4 v[100:103], v18, s[12:15], s70 offen sc1
s_add_u32 s70, s65, 6
s_and_b32 s70, s70, 15
s_mul_i32 s70, s70, 4352
s_add_u32 s70, s70, s87
buffer_load_dwordx4 v[104:107], v18, s[12:15], s70 offen sc1
s_add_u32 s70, s65, 7
s_and_b32 s70, s70, 15
s_mul_i32 s70, s70, 4352
s_add_u32 s70, s70, s87
buffer_load_dwordx4 v[108:111], v18, s[12:15], s70 offen sc1
s_add_u32 s70, s65, 8
s_and_b32 s70, s70, 15
s_mul_i32 s70, s70, 4352
s_add_u32 s70, s70, s87
buffer_load_dwordx4 v[112:115], v18, s[12:15], s70 offen sc1
s_add_u32 s70, s65, 9
s_and_b32 s70, s70, 15
s_mul_i32 s70, s70, 4352
s_add_u32 s70, s70, s87
buffer_load_dwordx4 v[116:119], v18, s[12:15], s70 offen sc1
s_add_u32 s70, s65, 10
s_and_b32 s70, s70, 15
s_mul_i32 s70, s70, 4352
s_add_u32 s70, s70, s87
buffer_load_dwordx4 v[120:123], v18, s[12:15], s70 offen sc1
s_add_u32 s70, s65, 11
s_and_b32 s70, s70, 15
s_mul_i32 s70, s70, 4352
s_add_u32 s70, s70, s87
buffer_load_dwordx4 v[124:127], v18, s[12:15], s70 offen sc1
s_add_u32 s70, s65, 12
s_and_b32 s70, s70, 15
s_mul_i32 s70, s70, 4352
s_add_u32 s70, s70, s87
buffer_load_dwordx4 v[128:131], v18, s[12:15], s70 offen sc1
s_add_u32 s70, s65, 13
s_and_b32 s70, s70, 15
s_mul_i32 s70, s70, 4352
s_add_u32 s70, s70, s87
buffer_load_dwordx4 v[132:135], v18, s[12:15], s70 offen sc1
s_add_u32 s70, s65, 14
s_and_b32 s70, s70, 15
s_mul_i32 s70, s70, 4352
s_add_u32 s70, s70, s87
buffer_load_dwordx4 v[136:139], v18, s[12:15], s70 offen sc1
s_add_u32 s70, s65, 15
s_and_b32 s70, s70, 15
s_mul_i32 s70, s70, 4352
s_add_u32 s70, s70, s87
buffer_load_dwordx4 v[140:143], v18, s[12:15], s70 offen sc1
s_add_u32 s70, s65, 16
s_and_b32 s70, s70, 15
s_mul_i32 s70, s70, 4352
s_add_u32 s70, s70, s87
buffer_load_dwordx4 v[144:147], v18, s[12:15], s70 offen sc1
buffer_load_dwordx4 v[148:151], v55, s[12:15], s88 offen sc1
s_lshl_b32 s70, s66, 6
s_lshl_b32 s71, s67, 3
s_add_u32 s70, s70, s71
s_add_u32 s70, s70, 161600
v_lshrrev_b32 v4, 4, v1
v_lshlrev_b32 v4, 4, v4
v_add_u32 v4, s70, v4
s_lshl_b32 s70, s60, 10
s_add_u32 s70, s70, 24576
v_add_u32_e64 v3, s70, v18
s_mov_b32 s73, 31
L_kvr:
s_bitcmp1_b32 s73, 0
s_cbranch_scc0 L_kvs0
s_waitcnt vmcnt(13)
v_max3_u32 v2, v84, v88, v92
v_max_u32 v2, v2, v96
v_cmp_eq_u32 vcc, -1, v2
s_cbranch_vccnz L_kvs0
s_bitset0_b32 s73, 0
v_mfma_f32_16x16x32_bf16 v[20:23], v[58:61], v[84:87], 0
v_mfma_f32_16x16x32_bf16 v[24:27], v[56:59], v[84:87], 0
v_mfma_f32_16x16x32_bf16 v[20:23], v[58:61], v[88:91], v[20:23]
v_mfma_f32_16x16x32_bf16 v[24:27], v[56:59], v[88:91], v[24:27]
v_mfma_f32_16x16x32_bf16 v[20:23], v[58:61], v[92:95], v[20:23]
v_mfma_f32_16x16x32_bf16 v[24:27], v[56:59], v[92:95], v[24:27]
v_mfma_f32_16x16x32_bf16 v[20:23], v[58:61], v[96:99], v[20:23]
v_mfma_f32_16x16x32_bf16 v[24:27], v[56:59], v[96:99], v[24:27]
L_kvs0:
s_bitcmp1_b32 s73, 1
s_cbranch_scc0 L_kvs1
s_waitcnt vmcnt(9)
v_max3_u32 v2, v100, v104, v108
v_max_u32 v2, v2, v112
v_cmp_eq_u32_e64 vcc, -1, v2
s_cbranch_vccnz L_kvs1
s_bitset0_b32 s73, 1
v_mfma_f32_16x16x32_bf16 v[28:31], v[58:61], v[100:103], 0
v_mfma_f32_16x16x32_bf16 v[32:35], v[56:59], v[100:103], 0
v_mfma_f32_16x16x32_bf16 v[28:31], v[58:61], v[104:107], v[28:31]
v_mfma_f32_16x16x32_bf16 v[32:35], v[56:59], v[104:107], v[32:35]
v_mfma_f32_16x16x32_bf16 v[28:31], v[58:61], v[108:111], v[28:31]
v_mfma_f32_16x16x32_bf16 v[32:35], v[56:59], v[108:111], v[32:35]
v_mfma_f32_16x16x32_bf16 v[28:31], v[58:61], v[112:115], v[28:31]
v_mfma_f32_16x16x32_bf16 v[32:35], v[56:59], v[112:115], v[32:35]
L_kvs1:
s_bitcmp1_b32 s73, 2
s_cbranch_scc0 L_kvs2
s_waitcnt vmcnt(5)
v_max3_u32 v2, v116, v120, v124
v_max_u32 v2, v2, v128
v_cmp_eq_u32_e64 vcc, -1, v2
s_cbranch_vccnz L_kvs2
s_bitset0_b32 s73, 2
v_mfma_f32_16x16x32_bf16 v[36:39], v[58:61], v[116:119], 0
v_mfma_f32_16x16x32_bf16 v[40:43], v[56:59], v[116:119], 0
v_mfma_f32_16x16x32_bf16 v[36:39], v[58:61], v[120:123], v[36:39]
v_mfma_f32_16x16x32_bf16 v[40:43], v[56:59], v[120:123], v[40:43]
v_mfma_f32_16x16x32_bf16 v[36:39], v[58:61], v[124:127], v[36:39]
v_mfma_f32_16x16x32_bf16 v[40:43], v[56:59], v[124:127], v[40:43]
v_mfma_f32_16x16x32_bf16 v[36:39], v[58:61], v[128:131], v[36:39]
v_mfma_f32_16x16x32_bf16 v[40:43], v[56:59], v[128:131], v[40:43]
L_kvs2:
s_bitcmp1_b32 s73, 3
s_cbranch_scc0 L_kvs3
s_waitcnt vmcnt(1)
v_max3_u32 v2, v132, v136, v140
v_max_u32 v2, v2, v144
v_cmp_eq_u32_e64 vcc, -1, v2
s_cbranch_vccnz L_kvs3
s_bitset0_b32 s73, 3
v_mfma_f32_16x16x32_bf16 v[44:47], v[58:61], v[132:135], 0
v_mfma_f32_16x16x32_bf16 v[48:51], v[56:59], v[132:135], 0
v_mfma_f32_16x16x32_bf16 v[44:47], v[58:61], v[136:139], v[44:47]
v_mfma_f32_16x16x32_bf16 v[48:51], v[56:59], v[136:139], v[48:51]
v_mfma_f32_16x16x32_bf16 v[44:47], v[58:61], v[140:143], v[44:47]
v_mfma_f32_16x16x32_bf16 v[48:51], v[56:59], v[140:143], v[48:51]
v_mfma_f32_16x16x32_bf16 v[44:47], v[58:61], v[144:147], v[44:47]
v_mfma_f32_16x16x32_bf16 v[48:51], v[56:59], v[144:147], v[48:51]
L_kvs3:
s_bitcmp1_b32 s73, 4
s_cbranch_scc0 L_kvs4
s_waitcnt vmcnt(0)
v_xor_b32 v148, s84, v148
v_xor_b32_e64 v149, s84, v149
v_xor_b32 v150, s84, v150
v_xor_b32 v151, s84, v151
v_or3_b32 v2, v148, v149, v150
v_bitop3_b32 v2, v2, v151, s91 bitop3:0xa8
v_cmp_ne_u32 vcc, 0, v2
s_cbranch_vccnz L_kvs4
s_bitset0_b32 s73, 4
v_add_f32_dpp v148, v148, v148 row_ror:1 row_mask:0xf bank_mask:0xf
v_add_f32_dpp v149, v149, v149 row_ror:1 row_mask:0xf bank_mask:0xf
v_add_f32_dpp v150, v150, v150 row_ror:1 row_mask:0xf bank_mask:0xf
v_add_f32_dpp v151, v151, v151 row_ror:1 row_mask:0xf bank_mask:0xf
v_add_f32_dpp v148, v148, v148 row_ror:2 row_mask:0xf bank_mask:0xf
v_add_f32_dpp v149, v149, v149 row_ror:2 row_mask:0xf bank_mask:0xf
v_add_f32_dpp v150, v150, v150 row_ror:2 row_mask:0xf bank_mask:0xf
v_add_f32_dpp v151, v151, v151 row_ror:2 row_mask:0xf bank_mask:0xf
v_add_f32_dpp v148, v148, v148 row_ror:4 row_mask:0xf bank_mask:0xf
v_add_f32_dpp v149, v149, v149 row_ror:4 row_mask:0xf bank_mask:0xf
v_add_f32_dpp v150, v150, v150 row_ror:4 row_mask:0xf bank_mask:0xf
v_add_f32_dpp v151, v151, v151 row_ror:4 row_mask:0xf bank_mask:0xf
v_add_f32_dpp v148, v148, v148 row_ror:8 row_mask:0xf bank_mask:0xf
v_add_f32_dpp v149, v149, v149 row_ror:8 row_mask:0xf bank_mask:0xf
v_add_f32_dpp v150, v150, v150 row_ror:8 row_mask:0xf bank_mask:0xf
v_add_f32_dpp v151, v151, v151 row_ror:8 row_mask:0xf bank_mask:0xf
v_cvt_pk_bf16_f32 v148, v148, v149
v_cvt_pk_bf16_f32 v149, v150, v151
ds_write_b64 v4, v[148:149]
L_kvs4:
s_cmp_lg_u32 s73, 0
s_cbranch_scc1 L_kvrt
L_kvok:
s_nop 3
v_pk_add_f32 v[20:21], v[20:21], v[28:29]
v_pk_add_f32 v[22:23], v[22:23], v[30:31]
v_pk_add_f32 v[24:25], v[24:25], v[32:33]
v_pk_add_f32 v[26:27], v[26:27], v[34:35]
v_pk_add_f32 v[36:37], v[36:37], v[44:45]
v_pk_add_f32 v[38:39], v[38:39], v[46:47]
v_pk_add_f32 v[40:41], v[40:41], v[48:49]
v_pk_add_f32 v[42:43], v[42:43], v[50:51]
v_pk_add_f32 v[20:21], v[20:21], v[36:37]
v_pk_add_f32 v[22:23], v[22:23], v[38:39]
v_pk_add_f32 v[24:25], v[24:25], v[40:41]
v_pk_add_f32 v[26:27], v[26:27], v[42:43]
v_cvt_pk_bf16_f32 v20, v20, v21
v_cvt_pk_bf16_f32 v21, v22, v23
v_cvt_pk_bf16_f32 v22, v24, v25
v_cvt_pk_bf16_f32 v23, v26, v27
ds_write_b128 v3, v[20:23]
s_waitcnt lgkmcnt(0)
s_barrier
s_not_b32 s70, s68
v_mov_b32 v81, -1
v_writelane_b32 v81, s70, 62
v_writelane_b32 v81, s70, 63
s_mov_b32 exec_lo, 0
s_cmp_eq_u32 s69, 0
s_cselect_b32 exec_hi, 0, 0x3f000000
buffer_store_dword v81, v83, s[12:15], 0 offen offset:4
s_mov_b64 exec, -1
s_mul_i32 s70, s60, 4
s_add_u32 s70, s70, 64
s_lshl_b32 s82, s89, 3
s_add_u32 s82, s82, s70
s_lshl_b32 s70, s70, 10
s_add_u32 m0, s70, 28672
s_and_b32 s82, s82, 127
s_lshl_b32 s82, s82, 14
buffer_load_dwordx4 v80, s[16:19], s82 offen lds
s_add_u32 m0, m0, 1024
s_add_u32 s82, s82, 16384
s_and_b32 s82, s82, 0x1fffff
buffer_load_dwordx4 v80, s[16:19], s82 offen lds
s_add_u32 m0, m0, 1024
s_add_u32 s82, s82, 16384
s_and_b32 s82, s82, 0x1fffff
buffer_load_dwordx4 v80, s[16:19], s82 offen lds
s_add_u32 m0, m0, 1024
s_add_u32 s82, s82, 16384
s_and_b32 s82, s82, 0x1fffff
buffer_load_dwordx4 v80, s[16:19], s82 offen lds
s_cmp_eq_u32 s60, 0
s_cbranch_scc1 L_pad2
s_cmp_eq_u32 s60, 1
s_cbranch_scc1 L_pad7
s_cmp_eq_u32 s60, 2
s_cbranch_scc1 L_pad8
s_branch L_pad10
L_retG:
v_lshrrev_b32 v2, 5, v1
v_lshlrev_b32_e64 v2, 11, v2
v_bfe_u32 v3, v1, 3, 2
v_lshl_add_u32 v2, v3, 7, v2
v_bfe_u32 v3, v1, 4, 1
v_bfe_u32 v4, v1, 1, 2
v_xor_b32 v3, v3, v4
v_lshl_add_u32 v2, v3, 5, v2
v_and_b32 v3, 1, v1
v_lshl_add_u32 v2, v3, 4, v2
s_lshl_b32 s70, s60, 13
s_add_u32 s71, s70, 65536
v_add_u32 v100, s71, v2
v_xor_b32 v101, 64, v100
v_lshrrev_b32 v2, 2, v1
v_bfe_u32 v5, v1, 3, 2
v_xor_b32 v6, s60, v5
v_lshlrev_b32 v6, 5, v6
v_lshl_add_u32 v6, v2, 7, v6
v_and_b32_e64 v7, 3, v1
v_lshl_add_u32 v6, v7, 3, v6
v_add_u32 v102, 65536, v6
s_lshl_b32 s71, s66, 16
s_add_u32 s70, s70, s71
s_add_u32 s70, s70, 49152
v_lshlrev_b32 v6, 5, v5
v_lshl_add_u32 v6, v2, 7, v6
v_lshl_add_u32 v6, v7, 3, v6
v_add_u32 v104, s70, v6
v_xor_b32 v105, 32, v104
v_xor_b32 v106, 64, v104
v_xor_b32 v107, 96, v104
v_lshrrev_b32 v5, 4, v1
v_xor_b32 v4, v4, v5
v_lshlrev_b32 v4, 5, v4
v_lshrrev_b32 v6, 3, v1
v_lshl_add_u32 v4, v6, 7, v4
v_lshl_add_u32 v4, v3, 4, v4
v_add_u32 v103, s70, v4
s_lshl_b32 s70, s60, 5
s_add_u32 s70, s70, 161792
v_mov_b32 v63, s70
v_add_u32 v114, 16, v63
v_lshl_add_u32 v56, v3, 4, v63
s_and_b32 s70, s65, 3
s_lshl_b32 s70, s70, 9
s_lshr_b32 s71, s62, 2
s_xor_b32 s71, s71, 0
s_lshl_b32 s71, s71, 13
s_add_u32 s71, s71, 8388608
s_xor_b32 s71, s71, s61
s_add_u32 s70, s70, s71
v_lshl_add_u32 v57, v5, 4, s70
v_lshlrev_b32 v60, 5, v5
v_lshl_add_u32 v60, v3, 4, v60
v_bfe_u32 v7, v1, 1, 1
v_lshl_add_u32 v60, v7, 7, v60
v_and_b32 v2, 3, v2
v_lshl_add_u32 v61, v2, 8, v60
v_lshlrev_b32 v62, 4, v3
v_lshl_add_u32 v62, v5, 5, v62
v_mov_b32 v59, s68
s_lshl_b32 s71, s79, 2
s_add_u32 s71, s71, s60
s_lshl_b32 s70, s71, 8
s_add_u32 s70, s70, 6946816
s_mov_b32 s85, s70
s_and_b32 s71, s65, 3
s_lshl2_add_u32 s71, s3, s71
s_and_b32 s70, s65, 12
s_add_u32 s70, s70, s60
s_lshl_b32 s71, s71, 7
s_bitcmp1_b32 s70, 3
s_cselect_b32 s72, 0, 8192
s_add_u32 s71, s71, s72
s_and_b32 s70, s70, 7
s_lshl_b32 s70, s70, 16
s_add_u32 s70, s70, s71
s_add_u32 s70, s70, 7340032
s_mov_b32 s88, s70
s_xor_b32 s88, s88, s61
s_lshl_b32 s70, s64, 14
s_add_u32 s86, s70, 6946816
s_and_b32 s70, s65, 3
v_mul_u32_u24 v2, 1, v7
v_xor_b32 v2, s70, v2
v_lshl_add_u32 v61, v2, 12, v61
s_lshl_b32 s87, s62, 11
s_xor_b32 s87, s87, 8192
s_add_u32 s87, s87, 6815744
s_xor_b32 s87, s87, s61
s_mov_b32 s94, 0
s_mov_b32 s95, 0
s_mov_b32 s92, 0x000f000f
s_mov_b32 s93, 0x000f000f
s_and_b32 s70, s65, 12
s_add_u32 s70, s70, s60
s_lshr_b32 s70, s70, 1
s_xor_b32 s24, s70, s62
s_xor_b32 s70, s69, 1
s_or_b32 s24, s24, s70
s_mov_b32 s32, 0xaaaaaaaa
s_mov_b32 s33, 0xaaaaaaaa
s_mov_b32 s38, 0
v_mov_b32 v64, 0x3f803f80
v_mov_b32 v65, 0x3f803f80
v_mov_b32 v66, 0x3f803f80
v_mov_b32 v67, 0x3f803f80
v_add_u32 v115, 64, v1
v_mov_b32 v2, 0
v_mov_b32 v95, 0
v_mov_b32 v99, 0
s_waitcnt vmcnt(0)
s_barrier
s_waitcnt vmcnt(0) lgkmcnt(0)
s_barrier
ds_write_b128 v100, a[0:3] offset:0
ds_write_b128 v101, a[4:7] offset:512
ds_write_b128 v100, a[8:11] offset:1024
ds_write_b128 v101, a[12:15] offset:1536
ds_write_b128 v100, a[16:19] offset:4096
ds_write_b128 v101, a[20:23] offset:4608
ds_write_b128 v100, a[24:27] offset:5120
ds_write_b128 v101, a[28:31] offset:5632
ds_write_b128 v100, a[32:35] offset:32768
ds_write_b128 v101, a[36:39] offset:33280
ds_write_b128 v100, a[40:43] offset:33792
ds_write_b128 v101, a[44:47] offset:34304
ds_write_b128 v100, a[48:51] offset:36864
ds_write_b128 v101, a[52:55] offset:37376
ds_write_b128 v100, a[56:59] offset:37888
ds_write_b128 v101, a[60:63] offset:38400
ds_write_b128 v103, a[64:67] offset:0
ds_write_b128 v103, a[68:71] offset:1024
ds_write_b128 v103, a[72:75] offset:2048
ds_write_b128 v103, a[76:79] offset:3072
ds_write_b128 v103, a[80:83] offset:4096
ds_write_b128 v103, a[84:87] offset:5120
ds_write_b128 v103, a[88:91] offset:6144
ds_write_b128 v103, a[92:95] offset:7168
s_waitcnt lgkmcnt(0)
ds_read_b64_tr_b16 a[64:65], v104 offset:0
ds_read_b64_tr_b16 a[66:67], v104 offset:2048
ds_read_b64_tr_b16 a[68:69], v104 offset:4096
ds_read_b64_tr_b16 a[70:71], v104 offset:6144
ds_read_b64_tr_b16 a[72:73], v105 offset:0
ds_read_b64_tr_b16 a[74:75], v105 offset:2048
ds_read_b64_tr_b16 a[76:77], v105 offset:4096
ds_read_b64_tr_b16 a[78:79], v105 offset:6144
ds_read_b64_tr_b16 a[80:81], v106 offset:0
ds_read_b64_tr_b16 a[82:83], v106 offset:2048
ds_read_b64_tr_b16 a[84:85], v106 offset:4096
ds_read_b64_tr_b16 a[86:87], v106 offset:6144
ds_read_b64_tr_b16 a[88:89], v107 offset:0
ds_read_b64_tr_b16 a[90:91], v107 offset:2048
ds_read_b64_tr_b16 a[92:93], v107 offset:4096
ds_read_b64_tr_b16 a[94:95], v107 offset:6144
s_barrier
ds_read_b64_tr_b16 a[0:1], v102 offset:0
ds_read_b64_tr_b16 a[2:3], v102 offset:2048
ds_read_b64_tr_b16 a[32:33], v102 offset:32768
ds_read_b64_tr_b16 a[34:35], v102 offset:34816
ds_read_b64_tr_b16 a[4:5], v102 offset:4096
ds_read_b64_tr_b16 a[6:7], v102 offset:6144
ds_read_b64_tr_b16 a[36:37], v102 offset:36864
ds_read_b64_tr_b16 a[38:39], v102 offset:38912
ds_read_b64_tr_b16 a[8:9], v102 offset:8192
ds_read_b64_tr_b16 a[10:11], v102 offset:10240
ds_read_b64_tr_b16 a[40:41], v102 offset:40960
ds_read_b64_tr_b16 a[42:43], v102 offset:43008
ds_read_b64_tr_b16 a[12:13], v102 offset:12288
ds_read_b64_tr_b16 a[14:15], v102 offset:14336
ds_read_b64_tr_b16 a[44:45], v102 offset:45056
ds_read_b64_tr_b16 a[46:47], v102 offset:47104
ds_read_b64_tr_b16 a[16:17], v102 offset:16384
ds_read_b64_tr_b16 a[18:19], v102 offset:18432
ds_read_b64_tr_b16 a[48:49], v102 offset:49152
ds_read_b64_tr_b16 a[50:51], v102 offset:51200
ds_read_b64_tr_b16 a[20:21], v102 offset:20480
ds_read_b64_tr_b16 a[22:23], v102 offset:22528
ds_read_b64_tr_b16 a[52:53], v102 offset:53248
ds_read_b64_tr_b16 a[54:55], v102 offset:55296
ds_read_b64_tr_b16 a[24:25], v102 offset:24576
ds_read_b64_tr_b16 a[26:27], v102 offset:26624
ds_read_b64_tr_b16 a[56:57], v102 offset:57344
ds_read_b64_tr_b16 a[58:59], v102 offset:59392
ds_read_b64_tr_b16 a[28:29], v102 offset:28672
ds_read_b64_tr_b16 a[30:31], v102 offset:30720
ds_read_b64_tr_b16 a[60:61], v102 offset:61440
ds_read_b64_tr_b16 a[62:63], v102 offset:63488
s_waitcnt lgkmcnt(0)
buffer_load_dwordx4 v[92:95], v18, s[12:15], s87 offen offset:0 sc1
buffer_load_dwordx4 v[96:99], v18, s[12:15], s87 offen offset:1024 sc1
v_mfma_f32_16x16x32_bf16 v[68:71], a[0:3], v[64:67], 0
v_mfma_f32_16x16x32_bf16 v[72:75], a[32:35], v[64:67], 0
v_mfma_f32_16x16x32_bf16 v[68:71], a[4:7], v[64:67], v[68:71]
v_mfma_f32_16x16x32_bf16 v[72:75], a[36:39], v[64:67], v[72:75]
v_mfma_f32_16x16x32_bf16 v[68:71], a[8:11], v[64:67], v[68:71]
v_mfma_f32_16x16x32_bf16 v[72:75], a[40:43], v[64:67], v[72:75]
v_mfma_f32_16x16x32_bf16 v[68:71], a[12:15], v[64:67], v[68:71]
v_mfma_f32_16x16x32_bf16 v[72:75], a[44:47], v[64:67], v[72:75]
v_mfma_f32_16x16x32_bf16 v[68:71], a[16:19], v[64:67], v[68:71]
v_mfma_f32_16x16x32_bf16 v[72:75], a[48:51], v[64:67], v[72:75]
v_mfma_f32_16x16x32_bf16 v[68:71], a[20:23], v[64:67], v[68:71]
v_mfma_f32_16x16x32_bf16 v[72:75], a[52:55], v[64:67], v[72:75]
v_mfma_f32_16x16x32_bf16 v[68:71], a[24:27], v[64:67], v[68:71]
v_mfma_f32_16x16x32_bf16 v[72:75], a[56:59], v[64:67], v[72:75]
v_mfma_f32_16x16x32_bf16 v[68:71], a[28:31], v[64:67], v[68:71]
v_mfma_f32_16x16x32_bf16 v[72:75], a[60:63], v[64:67], v[72:75]
L_pk:
s_waitcnt vmcnt(0)
L_pk2:
v_cmp_eq_u32_e64 s[80:81], s68, v95
v_cmp_eq_u32_e64 s[82:83], s68, v99
s_nop 0
v_cndmask_b32_e64 v108, 0, v92, s[80:81]
v_cndmask_b32_e64 v109, 0, v96, s[82:83]
s_and_b64 s[76:77], s[80:81], s[82:83]
v_max_u32 v110, v108, v109
v_min_u32 v111, v108, v109
s_cmp_eq_u64 s[76:77], -1
s_cselect_b32 s73, 0, 1
s_cbranch_scc1 L_pkc
s_not_b64 exec, s[80:81]
s_cselect_b64 exec, exec, 1
buffer_load_dwordx4 v[92:95], v18, s[12:15], s87 offen offset:0 sc1
s_not_b64 exec, s[82:83]
s_cselect_b64 exec, exec, 1
buffer_load_dwordx4 v[96:99], v18, s[12:15], s87 offen offset:1024 sc1
s_mov_b64 exec, -1
L_pkc:
v_cmp_le_u32 vcc, s95, v110
v_cmp_le_u32_e64 s[76:77], s95, v111
s_bcnt1_i32_b64 s70, vcc
s_bcnt1_i32_b64 s71, s[76:77]
s_add_u32 s70, s70, s71
s_cmp_eq_u32 s70, 2
s_cbranch_scc1 L_pksame
v_mov_b32_dpp v112, v110 row_ror:1 row_mask:0xf bank_mask:0xf
v_max_u32_dpp v113, v111, v111 row_ror:1 row_mask:0xf bank_mask:0xf
v_med3_u32 v111, v110, v112, v113
v_max_u32 v110, v110, v112
s_nop 1
v_mov_b32_dpp v112, v110 row_ror:2 row_mask:0xf bank_mask:0xf
v_max_u32_dpp v113, v111, v111 row_ror:2 row_mask:0xf bank_mask:0xf
v_med3_u32 v111, v110, v112, v113
v_max_u32 v110, v110, v112
s_nop 1
v_mov_b32_dpp v112, v110 row_ror:4 row_mask:0xf bank_mask:0xf
v_max_u32_dpp v113, v111, v111 row_ror:4 row_mask:0xf bank_mask:0xf
v_med3_u32 v111, v110, v112, v113
v_max_u32 v110, v110, v112
s_nop 1
v_mov_b32_dpp v112, v110 row_ror:8 row_mask:0xf bank_mask:0xf
v_max_u32_dpp v113, v111, v111 row_ror:8 row_mask:0xf bank_mask:0xf
v_med3_u32 v111, v110, v112, v113
v_max_u32 v110, v110, v112
v_mov_b32 v112, v110
v_mov_b32 v113, v111
s_nop 0
v_permlane16_swap_b32 v110, v112
v_permlane16_swap_b32 v111, v113
v_max_u32 v113, v111, v113
v_med3_u32 v111, v110, v112, v113
v_max_u32 v110, v110, v112
v_mov_b32 v112, v110
v_mov_b32 v113, v111
s_nop 0
v_permlane32_swap_b32 v110, v112
v_permlane32_swap_b32 v111, v113
v_max_u32 v113, v111, v113
v_med3_u32 v111, v110, v112, v113
v_max_u32 v110, v110, v112
v_readfirstlane_b32 s95, v111
s_nop 0
s_cmp_eq_u32 s95, 0
s_cbranch_scc1 L_pksame
v_cndmask_b32_e64 v58, v110, v111, s[32:33]
v_and_b32 v58, 127, v58
v_lshl_add_u32 v58, v58, 14, v57
s_mov_b64 exec, s[92:93]
buffer_load_dwordx4 v[24:27], v58, s[12:15], 0 offen offset:0 sc1
buffer_load_dwordx4 v[28:31], v58, s[12:15], 0 offen offset:64 sc1
buffer_load_dwordx4 v[32:35], v58, s[12:15], 0 offen offset:128 sc1
buffer_load_dwordx4 v[36:39], v58, s[12:15], 0 offen offset:192 sc1
buffer_load_dwordx4 v[40:43], v58, s[12:15], 0 offen offset:256 sc1
buffer_load_dwordx4 v[44:47], v58, s[12:15], 0 offen offset:320 sc1
buffer_load_dwordx4 v[48:51], v58, s[12:15], 0 offen offset:384 sc1
buffer_load_dwordx4 v[52:55], v58, s[12:15], 0 offen offset:448 sc1
s_mov_b64 exec, -1
v_cmp_eq_u32 vcc, v108, v111
v_cmp_eq_u32_e64 s[76:77], v108, v110
s_nop 0
v_cndmask_b32 v112, v63, v114, vcc
s_or_b64 exec, vcc, s[76:77]
ds_write_b96 v112, v[92:94]
s_mov_b64 exec, -1
v_cmp_eq_u32 vcc, v109, v111
v_cmp_eq_u32_e64 s[76:77], v109, v110
s_nop 0
v_cndmask_b32 v113, v63, v114, vcc
s_or_b64 exec, vcc, s[76:77]
ds_write_b96 v113, v[96:98]
s_mov_b64 exec, -1
ds_read_b96 v[20:22], v56
s_waitcnt lgkmcnt(0)
v_mul_f32_e64 v84, v68, -v21
v_mul_f32_e64 v85, v69, -v21
v_mul_f32_e64 v86, v70, -v21
v_mul_f32_e64 v87, v71, -v21
v_mul_f32_e64 v88, v72, -v21
v_mul_f32_e64 v89, v73, -v21
v_mul_f32_e64 v90, v74, -v21
v_mul_f32_e64 v91, v75, -v21
s_cmp_eq_u32 s73, 0
s_cbranch_scc1 L_pkf
s_waitcnt vmcnt(8)
s_add_u32 s78, s78, 1
s_cmp_le_u32 s78, 65536
s_cbranch_scc1 L_pk2
L_pkf:
s_waitcnt vmcnt(7)
v_mfma_f32_16x16x32_bf16 v[84:87], a[0:3], v[24:27], v[84:87]
v_mfma_f32_16x16x32_bf16 v[88:91], a[32:35], v[24:27], v[88:91]
s_waitcnt vmcnt(6)
v_mfma_f32_16x16x32_bf16 v[84:87], a[4:7], v[28:31], v[84:87]
v_mfma_f32_16x16x32_bf16 v[88:91], a[36:39], v[28:31], v[88:91]
s_waitcnt vmcnt(5)
v_mfma_f32_16x16x32_bf16 v[84:87], a[8:11], v[32:35], v[84:87]
v_max3_u32 v2, v24, v28, v32
v_mfma_f32_16x16x32_bf16 v[88:91], a[40:43], v[32:35], v[88:91]
s_waitcnt vmcnt(4)
v_mfma_f32_16x16x32_bf16 v[84:87], a[12:15], v[36:39], v[84:87]
v_mfma_f32_16x16x32_bf16 v[88:91], a[44:47], v[36:39], v[88:91]
s_waitcnt vmcnt(3)
v_mfma_f32_16x16x32_bf16 v[84:87], a[16:19], v[40:43], v[84:87]
v_mfma_f32_16x16x32_bf16 v[88:91], a[48:51], v[40:43], v[88:91]
s_waitcnt vmcnt(2)
v_mfma_f32_16x16x32_bf16 v[84:87], a[20:23], v[44:47], v[84:87]
v_max3_u32 v3, v36, v40, v44
v_mfma_f32_16x16x32_bf16 v[88:91], a[52:55], v[44:47], v[88:91]
s_waitcnt vmcnt(1)
v_mfma_f32_16x16x32_bf16 v[84:87], a[24:27], v[48:51], v[84:87]
v_mfma_f32_16x16x32_bf16 v[88:91], a[56:59], v[48:51], v[88:91]
s_waitcnt vmcnt(0)
v_mfma_f32_16x16x32_bf16 v[84:87], a[28:31], v[52:55], v[84:87]
v_max3_u32 v2, v2, v48, v52
v_max_u32 v2, v2, v3
v_cmp_eq_u32 vcc, -1, v2
v_mfma_f32_16x16x32_bf16 v[88:91], a[60:63], v[52:55], v[88:91]
s_and_b64 vcc, vcc, s[92:93]
s_cbranch_vccnz L_pkx_rt
L_pkx_ok:
s_mov_b32 s76, 0xcccccccc
s_mov_b32 s77, 0xcccccccc
s_nop 3
v_cndmask_b32_e64 v84, v84, v88, s[76:77]
v_cndmask_b32_e64 v85, v85, v89, s[76:77]
v_cndmask_b32_e64 v86, v86, v90, s[76:77]
v_cndmask_b32_e64 v87, v87, v91, s[76:77]
v_bfi_b32 v84, s91, v59, v84
s_mov_b64 exec, s[92:93]
s_cmp_eq_u32 s69, 0
s_cbranch_scc1 L_pxp_s
buffer_store_dwordx4 v[84:87], v60, s[12:15], s85 offen
L_pxp_d:
s_mov_b64 exec, -1
s_barrier
s_load_dword s70, s[12:13], 41152
s_waitcnt lgkmcnt(0)
buffer_load_dwordx4 v[24:27], v61, s[12:15], s86 offen offset:0 sc1
buffer_load_dwordx4 v[28:31], v61, s[12:15], s86 offen offset:1024 sc1
buffer_load_dwordx4 v[32:35], v61, s[12:15], s86 offen offset:2048 sc1
buffer_load_dwordx4 v[36:39], v61, s[12:15], s86 offen offset:3072 sc1
s_mov_b32 s92, 0x00030003
s_mov_b32 s93, 0x00030003
s_waitcnt vmcnt(0)
L_px_chk:
v_xor_b32 v24, s84, v24
v_xor_b32 v28, s84, v28
v_xor_b32 v32, s84, v32
v_xor_b32_e64 v36, s84, v36
v_or3_b32 v2, v24, v28, v32
v_bitop3_b32 v2, v2, v36, s91 bitop3:0xa8
v_cmp_ne_u32 vcc, 0, v2
s_cbranch_vccnz L_px_rt
L_px_ok:
v_pk_add_f32 v[24:25], v[24:25], v[28:29]
v_pk_add_f32 v[32:33], v[32:33], v[36:37]
v_pk_add_f32 v[26:27], v[26:27], v[30:31]
v_pk_add_f32 v[34:35], v[34:35], v[38:39]
v_pk_add_f32 v[24:25], v[24:25], v[32:33]
v_pk_add_f32 v[26:27], v[26:27], v[34:35]
v_pk_mul_f32 v[24:25], v[24:25], v[22:23] op_sel_hi:[1,0]
v_pk_mul_f32 v[26:27], v[26:27], v[22:23] op_sel_hi:[1,0]
s_not_b64 vcc, s[76:77]
v_mul_f32_dpp v32, v24, v24 quad_perm:[2,3,0,1] row_mask:0xf bank_mask:0xf
v_mul_f32_dpp v33, v25, v25 quad_perm:[2,3,0,1] row_mask:0xf bank_mask:0xf
v_mul_f32_dpp v34, v26, v26 quad_perm:[2,3,0,1] row_mask:0xf bank_mask:0xf
v_mul_f32_dpp v35, v27, v27 quad_perm:[2,3,0,1] row_mask:0xf bank_mask:0xf
v_cndmask_b32_dpp v28, v26, v24, vcc quad_perm:[2,3,0,1] row_mask:0xf bank_mask:0xf
v_cndmask_b32_dpp v29, v27, v25, vcc quad_perm:[2,3,0,1] row_mask:0xf bank_mask:0xf
v_mul_f32 v28, 0xbfb8aa3b, v28
v_mul_f32 v29, 0xbfb8aa3b, v29
v_exp_f32 v28, v28
v_exp_f32 v29, v29
v_cndmask_b32 v32, v34, v32, vcc
v_cndmask_b32 v33, v35, v33, vcc
v_add_f32 v28, 1.0, v28
v_add_f32 v29, 1.0, v29
v_rcp_f32 v28, v28
v_rcp_f32 v29, v29
v_mul_f32 v24, v32, v28
v_mul_f32 v25, v33, v29
v_cvt_pk_bf16_f32 v28, v24, v25
s_nop 1
v_mov_b32_dpp v30, v28 row_shl:4 row_mask:0xf bank_mask:0xf
v_mov_b32_dpp v32, v28 row_shl:8 row_mask:0xf bank_mask:0xf
v_mov_b32_dpp v34, v28 row_shl:12 row_mask:0xf bank_mask:0xf
v_mov_b32_dpp v29, v28 row_shl:2 row_mask:0xf bank_mask:0xf
v_mov_b32_dpp v31, v28 row_shl:6 row_mask:0xf bank_mask:0xf
v_mov_b32_dpp v33, v28 row_shl:10 row_mask:0xf bank_mask:0xf
v_mov_b32_dpp v35, v28 row_shl:14 row_mask:0xf bank_mask:0xf
v_mfma_f32_16x16x32_bf16 v[40:43], a[64:67], v[28:31], 0
v_mfma_f32_16x16x32_bf16 v[44:47], a[72:75], v[28:31], 0
v_mfma_f32_16x16x32_bf16 v[40:43], a[68:71], v[32:35], v[40:43]
v_mfma_f32_16x16x32_bf16 v[44:47], a[76:79], v[32:35], v[44:47]
v_mfma_f32_16x16x32_bf16 v[48:51], a[80:83], v[28:31], 0
v_mfma_f32_16x16x32_bf16 v[52:55], a[88:91], v[28:31], 0
v_mfma_f32_16x16x32_bf16 v[48:51], a[84:87], v[32:35], v[48:51]
s_branch L_over2
L_pad2:
s_branch L_pad11
L_over2:
v_mfma_f32_16x16x32_bf16 v[52:55], a[92:95], v[32:35], v[52:55]
s_cmp_ge_u32 s3, 14
s_cbranch_scc1 L_noy
s_mov_b64 exec, s[92:93]
s_cmp_eq_u32 s24, 0
s_cbranch_scc1 L_yown
v_bfi_b32 v40, s91, v59, v40
buffer_store_dwordx4 v[40:43], v62, s[12:15], s88 offen sc1
s_add_u32 s88, s88, 16384
v_bfi_b32 v44, s91, v59, v44
buffer_store_dwordx4 v[44:47], v62, s[12:15], s88 offen sc1
s_add_u32 s88, s88, 16384
v_bfi_b32 v48, s91, v59, v48
buffer_store_dwordx4 v[48:51], v62, s[12:15], s88 offen sc1
s_add_u32 s88, s88, 16384
v_bfi_b32 v52, s91, v59, v52
buffer_store_dwordx4 v[52:55], v62, s[12:15], s88 offen sc1
L_yd:
s_mov_b64 exec, -1
L_noy:
s_or_b32 s70, s2, s60
s_cbranch_scc1 L_noep
v_mov_b32 v3, 0
s_mov_b64 exec, 1
buffer_store_dword v59, v3, s[12:15], 0 offen sc1
s_mov_b64 exec, -1
L_noep:
s_cmp_lt_u32 s63, 24
s_cbranch_scc1 L_ldone
s_cmp_lg_u32 s60, 1
s_cbranch_scc1 L_ldone
s_lshl_b32 s87, s62, 3
s_add_u32 s87, s87, s63
s_sub_u32 s87, s87, 24
s_and_b32 s88, s87, 31
s_lshl_b32 s88, s88, 14
s_bitcmp1_b32 s87, 5
s_cselect_b32 s70, 0, 8192
s_add_u32 s88, s88, s70
s_add_u32 s88, s88, 7340032
s_xor_b32 s88, s88, s61
s_add_u32 s71, s88, 4096
s_lshl_b32 s70, s87, 5
v_bfe_u32 v3, v1, 1, 2
v_lshl_add_u32 v7, v3, 3, s70
s_lshr_b32 s72, s62, 2
s_xor_b32 s72, s72, 0
s_lshl_b32 s72, s72, 13
s_add_u32 s72, s72, 8388608
s_xor_b32 s72, s72, s61
v_lshrrev_b32_e64 v3, 4, v1
v_lshl_add_u32 v7, v3, 1, v7
v_and_b32 v64, 127, v20
v_lshl_add_u32 v64, v64, 14, v7
buffer_load_ushort v84, v64, s[12:15], s72 offen sc1
buffer_load_dwordx4 v[120:123], v18, s[12:15], s88 offen offset:0 sc1
buffer_load_dwordx4 v[124:127], v18, s[12:15], s88 offen offset:1024 sc1
buffer_load_dwordx4 v[128:131], v18, s[12:15], s88 offen offset:2048 sc1
buffer_load_dwordx4 v[132:135], v18, s[12:15], s88 offen offset:3072 sc1
buffer_load_dwordx4 v[136:139], v18, s[12:15], s71 offen offset:0 sc1
buffer_load_dwordx4 v[140:143], v18, s[12:15], s71 offen offset:1024 sc1
buffer_load_dwordx4 v[144:147], v18, s[12:15], s71 offen offset:2048 sc1
v_mov_b32 v88, s84
v_and_b32 v65, 0xfffff000, v20
v_not_b32 v4, v65
v_ashrrev_i32 v4, 31, v4
v_or_b32 v4, 0x80000000, v4
v_xor_b32 v65, v65, v4
v_mul_f32 v65, 0xbfb8aa3b, v65
v_exp_f32 v65, v65
s_nop 0
v_add_f32 v65, 1.0, v65
v_rcp_f32 v65, v65
v_bfe_u32 v66, v20, 1, 6
v_lshl_add_u32 v66, v66, 16, v7
v_bfe_u32 v4, v20, 7, 5
v_lshl_add_u32 v66, v4, 11, v66
v_add_f32 v67, 1.0, v22
v_mul_f32_e64 v21, -v21, v22
s_load_dword s94, s[12:13], 4096
s_waitcnt lgkmcnt(0)
buffer_load_dwordx4 v[24:27], v18, s[12:15], s88 offen offset:0 sc1
buffer_load_dwordx4 v[28:31], v18, s[12:15], s88 offen offset:1024 sc1
buffer_load_dwordx4 v[32:35], v18, s[12:15], s88 offen offset:2048 sc1
buffer_load_dwordx4 v[36:39], v18, s[12:15], s88 offen offset:3072 sc1
buffer_load_dwordx4 v[92:95], v18, s[12:15], s71 offen offset:0 sc1
buffer_load_dwordx4 v[96:99], v18, s[12:15], s71 offen offset:1024 sc1
buffer_load_dwordx4 v[100:103], v18, s[12:15], s71 offen offset:2048 sc1
s_load_dword s94, s[12:13], 4160
s_waitcnt lgkmcnt(0)
buffer_load_dwordx4 v[40:43], v18, s[12:15], s88 offen offset:0 sc1
buffer_load_dwordx4 v[44:47], v18, s[12:15], s88 offen offset:1024 sc1
buffer_load_dwordx4 v[48:51], v18, s[12:15], s88 offen offset:2048 sc1
buffer_load_dwordx4 v[52:55], v18, s[12:15], s88 offen offset:3072 sc1
buffer_load_dwordx4 v[104:107], v18, s[12:15], s71 offen offset:0 sc1
buffer_load_dwordx4 v[108:111], v18, s[12:15], s71 offen offset:1024 sc1
buffer_load_dwordx4 v[112:115], v18, s[12:15], s71 offen offset:2048 sc1
s_waitcnt vmcnt(21)
L_h_chk:
v_cmp_eq_u32 vcc, 0xffff, v84
s_cbranch_vccnz L_h_rt
L_h_ok:
v_lshlrev_b32 v84, 16, v84
v_fma_f32 v84, v84, v67, v21
L_yr:
s_waitcnt vmcnt(14)
v_xor_b32 v120, s84, v120
v_xor_b32 v124, s84, v124
v_xor_b32 v128, s84, v128
v_xor_b32_e64 v132, s84, v132
v_or3_b32 v2, v120, v124, v128
v_xor_b32 v136, s84, v136
v_xor_b32 v140, s84, v140
v_or3_b32 v2, v2, v132, v136
v_xor_b32 v144, s84, v144
v_xor_b32 v88, s84, v88
v_or3_b32 v2, v2, v140, v144
v_bitop3_b32 v2, v2, v88, s91 bitop3:0xa8
v_cmp_ne_u32 vcc, 0, v2
s_cbranch_vccnz L_y_rt
L_yf0:
v_pk_add_f32 v[120:121], v[120:121], v[124:125]
v_pk_add_f32 v[122:123], v[122:123], v[126:127]
v_pk_add_f32 v[128:129], v[128:129], v[132:133]
v_pk_add_f32 v[130:131], v[130:131], v[134:135]
v_pk_add_f32 v[136:137], v[136:137], v[140:141]
v_pk_add_f32 v[138:139], v[138:139], v[142:143]
v_pk_add_f32 v[120:121], v[120:121], v[128:129]
v_pk_add_f32 v[122:123], v[122:123], v[130:131]
v_pk_add_f32 v[136:137], v[136:137], v[144:145]
v_pk_add_f32 v[138:139], v[138:139], v[146:147]
v_pk_add_f32 v[120:121], v[120:121], v[136:137]
v_pk_add_f32 v[122:123], v[122:123], v[138:139]
s_nop 1
v_permlane32_swap_b32 v120, v122
v_permlane32_swap_b32 v121, v123
v_add_f32 v68, v120, v122
v_add_f32 v69, v121, v123
L_yf:
s_nop 1
v_permlane16_swap_b32 v68, v69
v_add_f32 v68, v68, v69
s_mov_b32 s72, 0x00ff00ff
s_mov_b32 s73, 0x00ff00ff
v_add_f32_dpp v68, v68, v68 row_ror:8 row_mask:0xf bank_mask:0xf
v_fmac_f32 v84, v68, v65
v_cvt_pk_bf16_f32 v84, v84, v84
s_mov_b64 exec, s[72:73]
buffer_store_short v84, v66, s[20:23], 0 offen sc1
L_ldone:
s_endpgm
.p2alignl 12, 0xbf810000
.fill 160, 4, 0xbf810000
L_compute:
v_and_b32 v2, 15, v1
v_lshrrev_b32 v4, 4, v1
v_lshrrev_b32 v3, 1, v2
v_xor_b32 v3, v3, v4
v_lshlrev_b32 v2, 7, v2
s_lshl_b32 s70, s66, 13
v_add_u32 v2, s70, v2
v_xor_b32 v5, 0, v3
v_lshl_add_u32 v8, v5, 4, v2
v_add_u32 v10, 65536, v8
v_xor_b32 v5, 4, v3
v_lshl_add_u32 v9, v5, 4, v2
v_add_u32 v11, 65536, v9
v_lshrrev_b32 v2, 5, v1
v_mul_u32_u24 v2, 6144, v2
v_bfe_u32 v3, v1, 4, 1
v_lshl_add_u32 v2, v3, 10, v2
v_bfe_u32 v4, v1, 2, 2
v_lshl_add_u32 v2, v4, 7, v2
v_lshlrev_b32 v3, 1, v3
v_bfe_u32 v4, v1, 3, 1
v_or_b32 v3, v3, v4
s_lshl_b32 s70, s67, 1
v_xor_b32 v3, s70, v3
v_and_b32 v4, 3, v1
v_lshl_add_u32 v2, v4, 3, v2
v_xor_b32 v4, 0, v3
v_lshl_add_u32 v12, v4, 5, v2
v_add_u32 v14, 65536, v12
v_xor_b32 v4, 1, v3
v_lshl_add_u32 v13, v4, 5, v2
v_add_u32 v15, 65536, v13
s_waitcnt lgkmcnt(0)
s_mov_b32 s12, s58
s_and_b32 s13, s59, 0xffff
s_mov_b32 s14, 268435456
s_mov_b32 s15, 0x20000
s_load_dword s68, s[58:59], 0
s_mov_b32 s20, s56
s_and_b32 s21, s57, 0xffff
s_mov_b32 s22, 4194304
s_mov_b32 s23, 0x20000
s_lshl_b32 s87, s64, 4
s_add_u32 s87, s87, s65
s_mul_i32 s87, s87, 4352
s_add_u32 s87, s87, 524288
s_and_b32 s88, s65, 7
s_lshl_b32 s88, s88, 19
s_lshr_b32 s70, s65, 1
s_xor_b32 s70, s70, s65
s_and_b32 s70, s70, 4
s_lshl_b32 s70, s70, 11
s_xor_b32 s70, s70, 2105344
s_add_u32 s88, s88, s70
s_mul_i32 s70, s66, 262144
s_add_u32 s88, s88, s70
s_lshr_b32 s70, s64, 2
s_lshl_b32 s70, s70, 14
s_add_u32 s88, s88, s70
s_and_b32 s70, s64, 3
s_lshl_b32 s70, s70, 11
s_add_u32 s88, s88, s70
s_lshl_b32 s70, s67, 10
s_add_u32 s88, s88, s70
s_mov_b32 s70, 0x3f803f80
v_accvgpr_write_b32 a80, s70
v_accvgpr_write_b32 a81, s70
v_accvgpr_write_b32 a82, s70
v_accvgpr_write_b32 a83, s70
s_mov_b32 s80, 0x358637bd
s_mov_b32 s81, 0x358637bd
s_mov_b32 s82, 0x3f800008
s_mov_b32 s83, 0x3f800008
s_mov_b32 s90, 0x3fb8aa3b
s_mov_b32 s91, 0x3fb8aa3b
s_waitcnt lgkmcnt(0)
s_add_u32 s68, s68, 1
v_and_b32 v7, 3, v1
v_lshrrev_b32_e64 v7, v7, s68
v_and_b32 v7, 1, v7
v_mul_u32_u24 v7, 0x10001, v7
s_mov_b32 s76, 0x10001
s_mov_b32 s77, 0x07060302
s_movk_i32 s85, 0xff
v_mov_b32 v28, -1
v_mov_b32 v29, -1
v_mov_b32 v30, -1
v_mov_b32 v31, -1
s_and_b32 s94, s65, 3
s_or_b32 s94, s94, s66
s_barrier
ds_read_b128 a[0:3], v10 offset:57344
ds_read_b64_tr_b16 a[32:33], v12 offset:0
ds_read_b64_tr_b16 a[34:35], v12 offset:512
ds_read_b128 a[4:7], v10 offset:59392
ds_read_b128 a[8:11], v10 offset:61440
ds_read_b128 a[12:15], v10 offset:63488
ds_read_b64_tr_b16 a[36:37], v13 offset:0
ds_read_b64_tr_b16 a[38:39], v13 offset:512
ds_read_b64_tr_b16 a[40:41], v12 offset:2048
ds_read_b64_tr_b16 a[42:43], v12 offset:2560
ds_read_b64_tr_b16 a[44:45], v13 offset:2048
ds_read_b64_tr_b16 a[46:47], v13 offset:2560
ds_read_b64_tr_b16 a[48:49], v12 offset:4096
ds_read_b64_tr_b16 a[50:51], v12 offset:4608
ds_read_b64_tr_b16 a[52:53], v13 offset:4096
ds_read_b64_tr_b16 a[54:55], v13 offset:4608
s_waitcnt lgkmcnt(0)
s_cmp_lg_u32 s94, 0
s_cbranch_scc1 L_nocs0_0
v_mfma_f32_16x16x32_bf16 v[128:131], a[80:83], a[32:35], 0
v_mfma_f32_16x16x32_bf16 v[132:135], a[80:83], a[36:39], 0
v_mfma_f32_16x16x32_bf16 v[136:139], a[80:83], a[40:43], 0
v_mfma_f32_16x16x32_bf16 v[140:143], a[80:83], a[44:47], 0
v_mfma_f32_16x16x32_bf16 v[144:147], a[80:83], a[48:51], 0
v_mfma_f32_16x16x32_bf16 v[148:151], a[80:83], a[52:55], 0
L_nocs0_0:
v_mfma_f32_16x16x32_bf16 v[32:35], a[32:35], a[0:3], 0
ds_read_b128 a[16:19], v11 offset:57344
v_mfma_f32_16x16x32_bf16 v[56:59], a[32:35], a[4:7], 0
ds_read_b64_tr_b16 a[56:57], v12 offset:12288
v_mfma_f32_16x16x32_bf16 v[80:83], a[32:35], a[8:11], 0
ds_read_b64_tr_b16 a[58:59], v12 offset:12800
v_mfma_f32_16x16x32_bf16 v[104:107], a[32:35], a[12:15], 0
ds_read_b128 a[20:23], v11 offset:59392
v_mfma_f32_16x16x32_bf16 v[36:39], a[36:39], a[0:3], 0
ds_read_b128 a[24:27], v11 offset:61440
v_mfma_f32_16x16x32_bf16 v[60:63], a[36:39], a[4:7], 0
ds_read_b128 a[28:31], v11 offset:63488
v_mfma_f32_16x16x32_bf16 v[84:87], a[36:39], a[8:11], 0
ds_read_b64_tr_b16 a[60:61], v13 offset:12288
v_mfma_f32_16x16x32_bf16 v[108:111], a[36:39], a[12:15], 0
ds_read_b64_tr_b16 a[62:63], v13 offset:12800
v_mfma_f32_16x16x32_bf16 v[40:43], a[0:3], a[40:43], 0
ds_read_b64_tr_b16 a[64:65], v12 offset:14336
v_mfma_f32_16x16x32_bf16 v[64:67], a[4:7], a[40:43], 0
ds_read_b64_tr_b16 a[66:67], v12 offset:14848
v_mfma_f32_16x16x32_bf16 v[88:91], a[8:11], a[40:43], 0
ds_read_b64_tr_b16 a[68:69], v13 offset:14336
v_mfma_f32_16x16x32_bf16 v[112:115], a[12:15], a[40:43], 0
ds_read_b64_tr_b16 a[70:71], v13 offset:14848
v_mfma_f32_16x16x32_bf16 v[44:47], a[0:3], a[44:47], 0
ds_read_b64_tr_b16 a[72:73], v12 offset:16384
v_mfma_f32_16x16x32_bf16 v[68:71], a[4:7], a[44:47], 0
ds_read_b64_tr_b16 a[74:75], v12 offset:16896
v_mfma_f32_16x16x32_bf16 v[92:95], a[8:11], a[44:47], 0
ds_read_b64_tr_b16 a[76:77], v13 offset:16384
v_mfma_f32_16x16x32_bf16 v[116:119], a[12:15], a[44:47], 0
ds_read_b64_tr_b16 a[78:79], v13 offset:16896
v_mfma_f32_16x16x32_bf16 v[48:51], a[0:3], a[48:51], 0
v_mfma_f32_16x16x32_bf16 v[72:75], a[4:7], a[48:51], 0
v_mfma_f32_16x16x32_bf16 v[96:99], a[8:11], a[48:51], 0
v_mfma_f32_16x16x32_bf16 v[120:123], a[12:15], a[48:51], 0
v_mfma_f32_16x16x32_bf16 v[52:55], a[0:3], a[52:55], 0
v_mfma_f32_16x16x32_bf16 v[76:79], a[4:7], a[52:55], 0
v_mfma_f32_16x16x32_bf16 v[100:103], a[8:11], a[52:55], 0
v_mfma_f32_16x16x32_bf16 v[124:127], a[12:15], a[52:55], 0
s_waitcnt lgkmcnt(0)
s_cmp_lg_u32 s94, 0
s_cbranch_scc1 L_nocs0_1
v_mfma_f32_16x16x32_bf16 v[128:131], a[80:83], a[56:59], v[128:131]
v_mfma_f32_16x16x32_bf16 v[132:135], a[80:83], a[60:63], v[132:135]
v_mfma_f32_16x16x32_bf16 v[136:139], a[80:83], a[64:67], v[136:139]
v_mfma_f32_16x16x32_bf16 v[140:143], a[80:83], a[68:71], v[140:143]
v_mfma_f32_16x16x32_bf16 v[144:147], a[80:83], a[72:75], v[144:147]
v_mfma_f32_16x16x32_bf16 v[148:151], a[80:83], a[76:79], v[148:151]
L_nocs0_1:
v_mfma_f32_16x16x32_bf16 v[32:35], a[56:59], a[16:19], v[32:35]
s_barrier
ds_read_b128 a[0:3], v10 offset:40960
v_mfma_f32_16x16x32_bf16 v[56:59], a[56:59], a[20:23], v[56:59]
ds_read_b64_tr_b16 a[32:33], v14 offset:16384
v_mfma_f32_16x16x32_bf16 v[80:83], a[56:59], a[24:27], v[80:83]
ds_read_b64_tr_b16 a[34:35], v14 offset:16896
v_mfma_f32_16x16x32_bf16 v[104:107], a[56:59], a[28:31], v[104:107]
ds_read_b128 a[4:7], v10 offset:43008
v_mfma_f32_16x16x32_bf16 v[36:39], a[60:63], a[16:19], v[36:39]
ds_read_b128 a[8:11], v10 offset:45056
v_mfma_f32_16x16x32_bf16 v[60:63], a[60:63], a[20:23], v[60:63]
ds_read_b128 a[12:15], v10 offset:47104
v_mfma_f32_16x16x32_bf16 v[84:87], a[60:63], a[24:27], v[84:87]
ds_read_b64_tr_b16 a[36:37], v15 offset:16384
v_mfma_f32_16x16x32_bf16 v[108:111], a[60:63], a[28:31], v[108:111]
ds_read_b64_tr_b16 a[38:39], v15 offset:16896
v_mfma_f32_16x16x32_bf16 v[40:43], a[16:19], a[64:67], v[40:43]
ds_read_b64_tr_b16 a[40:41], v14 offset:18432
v_mfma_f32_16x16x32_bf16 v[64:67], a[20:23], a[64:67], v[64:67]
ds_read_b64_tr_b16 a[42:43], v14 offset:18944
v_mfma_f32_16x16x32_bf16 v[88:91], a[24:27], a[64:67], v[88:91]
ds_read_b64_tr_b16 a[44:45], v15 offset:18432
v_mfma_f32_16x16x32_bf16 v[112:115], a[28:31], a[64:67], v[112:115]
ds_read_b64_tr_b16 a[46:47], v15 offset:18944
v_mfma_f32_16x16x32_bf16 v[44:47], a[16:19], a[68:71], v[44:47]
ds_read_b64_tr_b16 a[48:49], v14 offset:20480
v_mfma_f32_16x16x32_bf16 v[68:71], a[20:23], a[68:71], v[68:71]
ds_read_b64_tr_b16 a[50:51], v14 offset:20992
v_mfma_f32_16x16x32_bf16 v[92:95], a[24:27], a[68:71], v[92:95]
ds_read_b64_tr_b16 a[52:53], v15 offset:20480
v_mfma_f32_16x16x32_bf16 v[116:119], a[28:31], a[68:71], v[116:119]
ds_read_b64_tr_b16 a[54:55], v15 offset:20992
v_mfma_f32_16x16x32_bf16 v[48:51], a[16:19], a[72:75], v[48:51]
v_mfma_f32_16x16x32_bf16 v[72:75], a[20:23], a[72:75], v[72:75]
v_mfma_f32_16x16x32_bf16 v[96:99], a[24:27], a[72:75], v[96:99]
v_mfma_f32_16x16x32_bf16 v[120:123], a[28:31], a[72:75], v[120:123]
v_mfma_f32_16x16x32_bf16 v[52:55], a[16:19], a[76:79], v[52:55]
v_mfma_f32_16x16x32_bf16 v[76:79], a[20:23], a[76:79], v[76:79]
v_mfma_f32_16x16x32_bf16 v[100:103], a[24:27], a[76:79], v[100:103]
v_mfma_f32_16x16x32_bf16 v[124:127], a[28:31], a[76:79], v[124:127]
s_waitcnt lgkmcnt(0)
s_cmp_lg_u32 s94, 0
s_cbranch_scc1 L_nocs1_0
v_mfma_f32_16x16x32_bf16 v[128:131], a[80:83], a[32:35], v[128:131]
v_mfma_f32_16x16x32_bf16 v[132:135], a[80:83], a[36:39], v[132:135]
v_mfma_f32_16x16x32_bf16 v[136:139], a[80:83], a[40:43], v[136:139]
v_mfma_f32_16x16x32_bf16 v[140:143], a[80:83], a[44:47], v[140:143]
v_mfma_f32_16x16x32_bf16 v[144:147], a[80:83], a[48:51], v[144:147]
v_mfma_f32_16x16x32_bf16 v[148:151], a[80:83], a[52:55], v[148:151]
L_nocs1_0:
v_mfma_f32_16x16x32_bf16 v[32:35], a[32:35], a[0:3], v[32:35]
ds_read_b128 a[16:19], v11 offset:40960
v_mfma_f32_16x16x32_bf16 v[56:59], a[32:35], a[4:7], v[56:59]
ds_read_b64_tr_b16 a[56:57], v14 offset:28672
v_mfma_f32_16x16x32_bf16 v[80:83], a[32:35], a[8:11], v[80:83]
ds_read_b64_tr_b16 a[58:59], v14 offset:29184
v_mfma_f32_16x16x32_bf16 v[104:107], a[32:35], a[12:15], v[104:107]
ds_read_b128 a[20:23], v11 offset:43008
v_mfma_f32_16x16x32_bf16 v[36:39], a[36:39], a[0:3], v[36:39]
ds_read_b128 a[24:27], v11 offset:45056
v_mfma_f32_16x16x32_bf16 v[60:63], a[36:39], a[4:7], v[60:63]
ds_read_b128 a[28:31], v11 offset:47104
v_mfma_f32_16x16x32_bf16 v[84:87], a[36:39], a[8:11], v[84:87]
ds_read_b64_tr_b16 a[60:61], v15 offset:28672
v_mfma_f32_16x16x32_bf16 v[108:111], a[36:39], a[12:15], v[108:111]
ds_read_b64_tr_b16 a[62:63], v15 offset:29184
v_mfma_f32_16x16x32_bf16 v[40:43], a[0:3], a[40:43], v[40:43]
ds_read_b64_tr_b16 a[64:65], v14 offset:30720
v_mfma_f32_16x16x32_bf16 v[64:67], a[4:7], a[40:43], v[64:67]
ds_read_b64_tr_b16 a[66:67], v14 offset:31232
v_mfma_f32_16x16x32_bf16 v[88:91], a[8:11], a[40:43], v[88:91]
ds_read_b64_tr_b16 a[68:69], v15 offset:30720
v_mfma_f32_16x16x32_bf16 v[112:115], a[12:15], a[40:43], v[112:115]
ds_read_b64_tr_b16 a[70:71], v15 offset:31232
v_mfma_f32_16x16x32_bf16 v[44:47], a[0:3], a[44:47], v[44:47]
ds_read_b64_tr_b16 a[72:73], v14 offset:32768
v_mfma_f32_16x16x32_bf16 v[68:71], a[4:7], a[44:47], v[68:71]
ds_read_b64_tr_b16 a[74:75], v14 offset:33280
v_mfma_f32_16x16x32_bf16 v[92:95], a[8:11], a[44:47], v[92:95]
ds_read_b64_tr_b16 a[76:77], v15 offset:32768
v_mfma_f32_16x16x32_bf16 v[116:119], a[12:15], a[44:47], v[116:119]
ds_read_b64_tr_b16 a[78:79], v15 offset:33280
v_mfma_f32_16x16x32_bf16 v[48:51], a[0:3], a[48:51], v[48:51]
v_mfma_f32_16x16x32_bf16 v[72:75], a[4:7], a[48:51], v[72:75]
v_mfma_f32_16x16x32_bf16 v[96:99], a[8:11], a[48:51], v[96:99]
v_mfma_f32_16x16x32_bf16 v[120:123], a[12:15], a[48:51], v[120:123]
v_mfma_f32_16x16x32_bf16 v[52:55], a[0:3], a[52:55], v[52:55]
v_mfma_f32_16x16x32_bf16 v[76:79], a[4:7], a[52:55], v[76:79]
v_mfma_f32_16x16x32_bf16 v[100:103], a[8:11], a[52:55], v[100:103]
v_mfma_f32_16x16x32_bf16 v[124:127], a[12:15], a[52:55], v[124:127]
s_waitcnt lgkmcnt(0)
s_cmp_lg_u32 s94, 0
s_cbranch_scc1 L_nocs1_1
v_mfma_f32_16x16x32_bf16 v[128:131], a[80:83], a[56:59], v[128:131]
v_mfma_f32_16x16x32_bf16 v[132:135], a[80:83], a[60:63], v[132:135]
v_mfma_f32_16x16x32_bf16 v[136:139], a[80:83], a[64:67], v[136:139]
v_mfma_f32_16x16x32_bf16 v[140:143], a[80:83], a[68:71], v[140:143]
v_mfma_f32_16x16x32_bf16 v[144:147], a[80:83], a[72:75], v[144:147]
v_mfma_f32_16x16x32_bf16 v[148:151], a[80:83], a[76:79], v[148:151]
L_nocs1_1:
v_mfma_f32_16x16x32_bf16 v[32:35], a[56:59], a[16:19], v[32:35]
s_barrier
ds_read_b128 a[0:3], v10 offset:0
v_mfma_f32_16x16x32_bf16 v[56:59], a[56:59], a[20:23], v[56:59]
ds_read_b64_tr_b16 a[32:33], v12 offset:40960
v_mfma_f32_16x16x32_bf16 v[80:83], a[56:59], a[24:27], v[80:83]
ds_read_b64_tr_b16 a[34:35], v12 offset:41472
v_mfma_f32_16x16x32_bf16 v[104:107], a[56:59], a[28:31], v[104:107]
ds_read_b128 a[4:7], v10 offset:2048
v_mfma_f32_16x16x32_bf16 v[36:39], a[60:63], a[16:19], v[36:39]
ds_read_b128 a[8:11], v10 offset:4096
v_mfma_f32_16x16x32_bf16 v[60:63], a[60:63], a[20:23], v[60:63]
ds_read_b128 a[12:15], v10 offset:6144
v_mfma_f32_16x16x32_bf16 v[84:87], a[60:63], a[24:27], v[84:87]
ds_read_b64_tr_b16 a[36:37], v13 offset:40960
v_mfma_f32_16x16x32_bf16 v[108:111], a[60:63], a[28:31], v[108:111]
ds_read_b64_tr_b16 a[38:39], v13 offset:41472
v_mfma_f32_16x16x32_bf16 v[40:43], a[16:19], a[64:67], v[40:43]
ds_read_b64_tr_b16 a[40:41], v12 offset:43008
v_mfma_f32_16x16x32_bf16 v[64:67], a[20:23], a[64:67], v[64:67]
ds_read_b64_tr_b16 a[42:43], v12 offset:43520
v_mfma_f32_16x16x32_bf16 v[88:91], a[24:27], a[64:67], v[88:91]
ds_read_b64_tr_b16 a[44:45], v13 offset:43008
v_mfma_f32_16x16x32_bf16 v[112:115], a[28:31], a[64:67], v[112:115]
ds_read_b64_tr_b16 a[46:47], v13 offset:43520
v_mfma_f32_16x16x32_bf16 v[44:47], a[16:19], a[68:71], v[44:47]
ds_read_b64_tr_b16 a[48:49], v12 offset:45056
v_mfma_f32_16x16x32_bf16 v[68:71], a[20:23], a[68:71], v[68:71]
ds_read_b64_tr_b16 a[50:51], v12 offset:45568
v_mfma_f32_16x16x32_bf16 v[92:95], a[24:27], a[68:71], v[92:95]
ds_read_b64_tr_b16 a[52:53], v13 offset:45056
v_mfma_f32_16x16x32_bf16 v[116:119], a[28:31], a[68:71], v[116:119]
ds_read_b64_tr_b16 a[54:55], v13 offset:45568
v_mfma_f32_16x16x32_bf16 v[48:51], a[16:19], a[72:75], v[48:51]
v_mfma_f32_16x16x32_bf16 v[72:75], a[20:23], a[72:75], v[72:75]
v_mfma_f32_16x16x32_bf16 v[96:99], a[24:27], a[72:75], v[96:99]
v_mfma_f32_16x16x32_bf16 v[120:123], a[28:31], a[72:75], v[120:123]
v_mfma_f32_16x16x32_bf16 v[52:55], a[16:19], a[76:79], v[52:55]
v_mfma_f32_16x16x32_bf16 v[76:79], a[20:23], a[76:79], v[76:79]
v_mfma_f32_16x16x32_bf16 v[100:103], a[24:27], a[76:79], v[100:103]
v_mfma_f32_16x16x32_bf16 v[124:127], a[28:31], a[76:79], v[124:127]
s_waitcnt lgkmcnt(0)
s_cmp_lg_u32 s94, 0
s_cbranch_scc1 L_nocs2_0
v_mfma_f32_16x16x32_bf16 v[128:131], a[80:83], a[32:35], v[128:131]
v_mfma_f32_16x16x32_bf16 v[132:135], a[80:83], a[36:39], v[132:135]
v_mfma_f32_16x16x32_bf16 v[136:139], a[80:83], a[40:43], v[136:139]
v_mfma_f32_16x16x32_bf16 v[140:143], a[80:83], a[44:47], v[140:143]
v_mfma_f32_16x16x32_bf16 v[144:147], a[80:83], a[48:51], v[144:147]
v_mfma_f32_16x16x32_bf16 v[148:151], a[80:83], a[52:55], v[148:151]
L_nocs2_0:
v_mfma_f32_16x16x32_bf16 v[32:35], a[32:35], a[0:3], v[32:35]
ds_read_b128 a[16:19], v11 offset:0
v_mfma_f32_16x16x32_bf16 v[56:59], a[32:35], a[4:7], v[56:59]
ds_read_b64_tr_b16 a[56:57], v12 offset:53248
v_mfma_f32_16x16x32_bf16 v[80:83], a[32:35], a[8:11], v[80:83]
ds_read_b64_tr_b16 a[58:59], v12 offset:53760
v_mfma_f32_16x16x32_bf16 v[104:107], a[32:35], a[12:15], v[104:107]
ds_read_b128 a[20:23], v11 offset:2048
v_mfma_f32_16x16x32_bf16 v[36:39], a[36:39], a[0:3], v[36:39]
ds_read_b128 a[24:27], v11 offset:4096
v_mfma_f32_16x16x32_bf16 v[60:63], a[36:39], a[4:7], v[60:63]
ds_read_b128 a[28:31], v11 offset:6144
v_mfma_f32_16x16x32_bf16 v[84:87], a[36:39], a[8:11], v[84:87]
ds_read_b64_tr_b16 a[60:61], v13 offset:53248
v_mfma_f32_16x16x32_bf16 v[108:111], a[36:39], a[12:15], v[108:111]
ds_read_b64_tr_b16 a[62:63], v13 offset:53760
v_mfma_f32_16x16x32_bf16 v[40:43], a[0:3], a[40:43], v[40:43]
ds_read_b64_tr_b16 a[64:65], v12 offset:55296
v_mfma_f32_16x16x32_bf16 v[64:67], a[4:7], a[40:43], v[64:67]
ds_read_b64_tr_b16 a[66:67], v12 offset:55808
v_mfma_f32_16x16x32_bf16 v[88:91], a[8:11], a[40:43], v[88:91]
ds_read_b64_tr_b16 a[68:69], v13 offset:55296
v_mfma_f32_16x16x32_bf16 v[112:115], a[12:15], a[40:43], v[112:115]
ds_read_b64_tr_b16 a[70:71], v13 offset:55808
v_mfma_f32_16x16x32_bf16 v[44:47], a[0:3], a[44:47], v[44:47]
ds_read_b64_tr_b16 a[72:73], v12 offset:57344
v_mfma_f32_16x16x32_bf16 v[68:71], a[4:7], a[44:47], v[68:71]
ds_read_b64_tr_b16 a[74:75], v12 offset:57856
v_mfma_f32_16x16x32_bf16 v[92:95], a[8:11], a[44:47], v[92:95]
ds_read_b64_tr_b16 a[76:77], v13 offset:57344
v_mfma_f32_16x16x32_bf16 v[116:119], a[12:15], a[44:47], v[116:119]
ds_read_b64_tr_b16 a[78:79], v13 offset:57856
v_mfma_f32_16x16x32_bf16 v[48:51], a[0:3], a[48:51], v[48:51]
s_lshl_b32 s70, s60, 10
s_add_u32 s70, s70, s87
buffer_store_dwordx4 v[28:31], v16, s[12:15], s70 offen sc1
v_mfma_f32_16x16x32_bf16 v[72:75], a[4:7], a[48:51], v[72:75]
v_mfma_f32_16x16x32_bf16 v[96:99], a[8:11], a[48:51], v[96:99]
v_mfma_f32_16x16x32_bf16 v[120:123], a[12:15], a[48:51], v[120:123]
v_mfma_f32_16x16x32_bf16 v[52:55], a[0:3], a[52:55], v[52:55]
v_mfma_f32_16x16x32_bf16 v[76:79], a[4:7], a[52:55], v[76:79]
v_mfma_f32_16x16x32_bf16 v[100:103], a[8:11], a[52:55], v[100:103]
v_mfma_f32_16x16x32_bf16 v[124:127], a[12:15], a[52:55], v[124:127]
s_waitcnt lgkmcnt(0)
s_cmp_lg_u32 s94, 0
s_cbranch_scc1 L_nocs2_1
v_mfma_f32_16x16x32_bf16 v[128:131], a[80:83], a[56:59], v[128:131]
v_mfma_f32_16x16x32_bf16 v[132:135], a[80:83], a[60:63], v[132:135]
v_mfma_f32_16x16x32_bf16 v[136:139], a[80:83], a[64:67], v[136:139]
v_mfma_f32_16x16x32_bf16 v[140:143], a[80:83], a[68:71], v[140:143]
v_mfma_f32_16x16x32_bf16 v[144:147], a[80:83], a[72:75], v[144:147]
v_mfma_f32_16x16x32_bf16 v[148:151], a[80:83], a[76:79], v[148:151]
L_nocs2_1:
v_mfma_f32_16x16x32_bf16 v[32:35], a[56:59], a[16:19], v[32:35]
s_barrier
ds_read_b128 a[0:3], v8 offset:24576
v_mfma_f32_16x16x32_bf16 v[56:59], a[56:59], a[20:23], v[56:59]
ds_read_b64_tr_b16 a[32:33], v12 offset:0
v_mfma_f32_16x16x32_bf16 v[80:83], a[56:59], a[24:27], v[80:83]
ds_read_b64_tr_b16 a[34:35], v12 offset:512
v_mfma_f32_16x16x32_bf16 v[104:107], a[56:59], a[28:31], v[104:107]
ds_read_b128 a[4:7], v8 offset:26624
v_mfma_f32_16x16x32_bf16 v[36:39], a[60:63], a[16:19], v[36:39]
ds_read_b128 a[8:11], v8 offset:28672
v_mfma_f32_16x16x32_bf16 v[60:63], a[60:63], a[20:23], v[60:63]
ds_read_b128 a[12:15], v8 offset:30720
v_mfma_f32_16x16x32_bf16 v[84:87], a[60:63], a[24:27], v[84:87]
ds_read_b64_tr_b16 a[36:37], v13 offset:0
v_mfma_f32_16x16x32_bf16 v[108:111], a[60:63], a[28:31], v[108:111]
ds_read_b64_tr_b16 a[38:39], v13 offset:512
v_mfma_f32_16x16x32_bf16 v[40:43], a[16:19], a[64:67], v[40:43]
ds_read_b64_tr_b16 a[40:41], v12 offset:2048
v_mfma_f32_16x16x32_bf16 v[64:67], a[20:23], a[64:67], v[64:67]
ds_read_b64_tr_b16 a[42:43], v12 offset:2560
v_mfma_f32_16x16x32_bf16 v[88:91], a[24:27], a[64:67], v[88:91]
ds_read_b64_tr_b16 a[44:45], v13 offset:2048
v_mfma_f32_16x16x32_bf16 v[112:115], a[28:31], a[64:67], v[112:115]
ds_read_b64_tr_b16 a[46:47], v13 offset:2560
v_mfma_f32_16x16x32_bf16 v[44:47], a[16:19], a[68:71], v[44:47]
ds_read_b64_tr_b16 a[48:49], v12 offset:4096
v_mfma_f32_16x16x32_bf16 v[68:71], a[20:23], a[68:71], v[68:71]
ds_read_b64_tr_b16 a[50:51], v12 offset:4608
v_mfma_f32_16x16x32_bf16 v[92:95], a[24:27], a[68:71], v[92:95]
ds_read_b64_tr_b16 a[52:53], v13 offset:4096
v_mfma_f32_16x16x32_bf16 v[116:119], a[28:31], a[68:71], v[116:119]
ds_read_b64_tr_b16 a[54:55], v13 offset:4608
v_mfma_f32_16x16x32_bf16 v[48:51], a[16:19], a[72:75], v[48:51]
v_mfma_f32_16x16x32_bf16 v[72:75], a[20:23], a[72:75], v[72:75]
v_mfma_f32_16x16x32_bf16 v[96:99], a[24:27], a[72:75], v[96:99]
v_mfma_f32_16x16x32_bf16 v[120:123], a[28:31], a[72:75], v[120:123]
v_mfma_f32_16x16x32_bf16 v[52:55], a[16:19], a[76:79], v[52:55]
v_mfma_f32_16x16x32_bf16 v[76:79], a[20:23], a[76:79], v[76:79]
v_mfma_f32_16x16x32_bf16 v[100:103], a[24:27], a[76:79], v[100:103]
v_mfma_f32_16x16x32_bf16 v[124:127], a[28:31], a[76:79], v[124:127]
s_waitcnt lgkmcnt(0)
s_cmp_lg_u32 s94, 0
s_cbranch_scc1 L_nocs3_0
v_mfma_f32_16x16x32_bf16 v[128:131], a[80:83], a[32:35], v[128:131]
v_mfma_f32_16x16x32_bf16 v[132:135], a[80:83], a[36:39], v[132:135]
v_mfma_f32_16x16x32_bf16 v[136:139], a[80:83], a[40:43], v[136:139]
v_mfma_f32_16x16x32_bf16 v[140:143], a[80:83], a[44:47], v[140:143]
v_mfma_f32_16x16x32_bf16 v[144:147], a[80:83], a[48:51], v[144:147]
v_mfma_f32_16x16x32_bf16 v[148:151], a[80:83], a[52:55], v[148:151]
L_nocs3_0:
v_mfma_f32_16x16x32_bf16 v[32:35], a[32:35], a[0:3], v[32:35]
ds_read_b128 a[16:19], v9 offset:24576
v_mfma_f32_16x16x32_bf16 v[56:59], a[32:35], a[4:7], v[56:59]
ds_read_b64_tr_b16 a[56:57], v12 offset:12288
v_mfma_f32_16x16x32_bf16 v[80:83], a[32:35], a[8:11], v[80:83]
ds_read_b64_tr_b16 a[58:59], v12 offset:12800
v_mfma_f32_16x16x32_bf16 v[104:107], a[32:35], a[12:15], v[104:107]
ds_read_b128 a[20:23], v9 offset:26624
v_mfma_f32_16x16x32_bf16 v[36:39], a[36:39], a[0:3], v[36:39]
ds_read_b128 a[24:27], v9 offset:28672
v_mfma_f32_16x16x32_bf16 v[60:63], a[36:39], a[4:7], v[60:63]
ds_read_b128 a[28:31], v9 offset:30720
v_mfma_f32_16x16x32_bf16 v[84:87], a[36:39], a[8:11], v[84:87]
ds_read_b64_tr_b16 a[60:61], v13 offset:12288
v_mfma_f32_16x16x32_bf16 v[108:111], a[36:39], a[12:15], v[108:111]
ds_read_b64_tr_b16 a[62:63], v13 offset:12800
v_mfma_f32_16x16x32_bf16 v[40:43], a[0:3], a[40:43], v[40:43]
ds_read_b64_tr_b16 a[64:65], v12 offset:14336
v_mfma_f32_16x16x32_bf16 v[64:67], a[4:7], a[40:43], v[64:67]
ds_read_b64_tr_b16 a[66:67], v12 offset:14848
v_mfma_f32_16x16x32_bf16 v[88:91], a[8:11], a[40:43], v[88:91]
ds_read_b64_tr_b16 a[68:69], v13 offset:14336
v_mfma_f32_16x16x32_bf16 v[112:115], a[12:15], a[40:43], v[112:115]
ds_read_b64_tr_b16 a[70:71], v13 offset:14848
v_mfma_f32_16x16x32_bf16 v[44:47], a[0:3], a[44:47], v[44:47]
ds_read_b64_tr_b16 a[72:73], v12 offset:16384
v_mfma_f32_16x16x32_bf16 v[68:71], a[4:7], a[44:47], v[68:71]
ds_read_b64_tr_b16 a[74:75], v12 offset:16896
v_mfma_f32_16x16x32_bf16 v[92:95], a[8:11], a[44:47], v[92:95]
ds_read_b64_tr_b16 a[76:77], v13 offset:16384
v_mfma_f32_16x16x32_bf16 v[116:119], a[12:15], a[44:47], v[116:119]
ds_read_b64_tr_b16 a[78:79], v13 offset:16896
v_mfma_f32_16x16x32_bf16 v[48:51], a[0:3], a[48:51], v[48:51]
v_mfma_f32_16x16x32_bf16 v[72:75], a[4:7], a[48:51], v[72:75]
v_mfma_f32_16x16x32_bf16 v[96:99], a[8:11], a[48:51], v[96:99]
v_mfma_f32_16x16x32_bf16 v[120:123], a[12:15], a[48:51], v[120:123]
v_mfma_f32_16x16x32_bf16 v[52:55], a[0:3], a[52:55], v[52:55]
v_mfma_f32_16x16x32_bf16 v[76:79], a[4:7], a[52:55], v[76:79]
v_mfma_f32_16x16x32_bf16 v[100:103], a[8:11], a[52:55], v[100:103]
v_mfma_f32_16x16x32_bf16 v[124:127], a[12:15], a[52:55], v[124:127]
s_waitcnt lgkmcnt(0)
s_cmp_lg_u32 s94, 0
s_cbranch_scc1 L_nocs3_1
v_mfma_f32_16x16x32_bf16 v[128:131], a[80:83], a[56:59], v[128:131]
v_mfma_f32_16x16x32_bf16 v[132:135], a[80:83], a[60:63], v[132:135]
v_mfma_f32_16x16x32_bf16 v[136:139], a[80:83], a[64:67], v[136:139]
v_mfma_f32_16x16x32_bf16 v[140:143], a[80:83], a[68:71], v[140:143]
v_mfma_f32_16x16x32_bf16 v[144:147], a[80:83], a[72:75], v[144:147]
v_mfma_f32_16x16x32_bf16 v[148:151], a[80:83], a[76:79], v[148:151]
L_nocs3_1:
v_mfma_f32_16x16x32_bf16 v[32:35], a[56:59], a[16:19], v[32:35]
s_barrier
ds_read_b128 a[0:3], v10 offset:57344
v_mfma_f32_16x16x32_bf16 v[56:59], a[56:59], a[20:23], v[56:59]
ds_read_b64_tr_b16 a[32:33], v14 offset:16384
v_mfma_f32_16x16x32_bf16 v[80:83], a[56:59], a[24:27], v[80:83]
ds_read_b64_tr_b16 a[34:35], v14 offset:16896
s_branch L_over3
L_pad3:
s_branch L_ret4
L_over3:
v_mfma_f32_16x16x32_bf16 v[104:107], a[56:59], a[28:31], v[104:107]
ds_read_b128 a[4:7], v10 offset:59392
v_mfma_f32_16x16x32_bf16 v[36:39], a[60:63], a[16:19], v[36:39]
ds_read_b128 a[8:11], v10 offset:61440
v_mfma_f32_16x16x32_bf16 v[60:63], a[60:63], a[20:23], v[60:63]
ds_read_b128 a[12:15], v10 offset:63488
v_mfma_f32_16x16x32_bf16 v[84:87], a[60:63], a[24:27], v[84:87]
ds_read_b64_tr_b16 a[36:37], v15 offset:16384
v_mfma_f32_16x16x32_bf16 v[108:111], a[60:63], a[28:31], v[108:111]
ds_read_b64_tr_b16 a[38:39], v15 offset:16896
v_mfma_f32_16x16x32_bf16 v[40:43], a[16:19], a[64:67], v[40:43]
ds_read_b64_tr_b16 a[40:41], v14 offset:18432
v_mfma_f32_16x16x32_bf16 v[64:67], a[20:23], a[64:67], v[64:67]
ds_read_b64_tr_b16 a[42:43], v14 offset:18944
v_mfma_f32_16x16x32_bf16 v[88:91], a[24:27], a[64:67], v[88:91]
ds_read_b64_tr_b16 a[44:45], v15 offset:18432
v_mfma_f32_16x16x32_bf16 v[112:115], a[28:31], a[64:67], v[112:115]
ds_read_b64_tr_b16 a[46:47], v15 offset:18944
v_mfma_f32_16x16x32_bf16 v[44:47], a[16:19], a[68:71], v[44:47]
ds_read_b64_tr_b16 a[48:49], v14 offset:20480
v_mfma_f32_16x16x32_bf16 v[68:71], a[20:23], a[68:71], v[68:71]
ds_read_b64_tr_b16 a[50:51], v14 offset:20992
v_mfma_f32_16x16x32_bf16 v[92:95], a[24:27], a[68:71], v[92:95]
ds_read_b64_tr_b16 a[52:53], v15 offset:20480
v_mfma_f32_16x16x32_bf16 v[116:119], a[28:31], a[68:71], v[116:119]
ds_read_b64_tr_b16 a[54:55], v15 offset:20992
v_mfma_f32_16x16x32_bf16 v[48:51], a[16:19], a[72:75], v[48:51]
v_mfma_f32_16x16x32_bf16 v[72:75], a[20:23], a[72:75], v[72:75]
v_mfma_f32_16x16x32_bf16 v[96:99], a[24:27], a[72:75], v[96:99]
v_mfma_f32_16x16x32_bf16 v[120:123], a[28:31], a[72:75], v[120:123]
v_mfma_f32_16x16x32_bf16 v[52:55], a[16:19], a[76:79], v[52:55]
v_mfma_f32_16x16x32_bf16 v[76:79], a[20:23], a[76:79], v[76:79]
v_mfma_f32_16x16x32_bf16 v[100:103], a[24:27], a[76:79], v[100:103]
v_mfma_f32_16x16x32_bf16 v[124:127], a[28:31], a[76:79], v[124:127]
s_waitcnt lgkmcnt(0)
v_mfma_f32_16x16x32_bf16 v[32:35], a[32:35], a[0:3], v[32:35]
ds_read_b128 a[16:19], v11 offset:57344
v_mfma_f32_16x16x32_bf16 v[56:59], a[32:35], a[4:7], v[56:59]
ds_read_b64_tr_b16 a[56:57], v14 offset:28672
v_mfma_f32_16x16x32_bf16 v[80:83], a[32:35], a[8:11], v[80:83]
ds_read_b64_tr_b16 a[58:59], v14 offset:29184
v_mfma_f32_16x16x32_bf16 v[104:107], a[32:35], a[12:15], v[104:107]
ds_read_b128 a[20:23], v11 offset:59392
v_mfma_f32_16x16x32_bf16 v[36:39], a[36:39], a[0:3], v[36:39]
ds_read_b128 a[24:27], v11 offset:61440
v_mfma_f32_16x16x32_bf16 v[60:63], a[36:39], a[4:7], v[60:63]
ds_read_b128 a[28:31], v11 offset:63488
v_mfma_f32_16x16x32_bf16 v[84:87], a[36:39], a[8:11], v[84:87]
ds_read_b64_tr_b16 a[60:61], v15 offset:28672
v_mfma_f32_16x16x32_bf16 v[108:111], a[36:39], a[12:15], v[108:111]
ds_read_b64_tr_b16 a[62:63], v15 offset:29184
v_mfma_f32_16x16x32_bf16 v[40:43], a[0:3], a[40:43], v[40:43]
ds_read_b64_tr_b16 a[64:65], v14 offset:30720
v_mfma_f32_16x16x32_bf16 v[64:67], a[4:7], a[40:43], v[64:67]
ds_read_b64_tr_b16 a[66:67], v14 offset:31232
v_mfma_f32_16x16x32_bf16 v[88:91], a[8:11], a[40:43], v[88:91]
ds_read_b64_tr_b16 a[68:69], v15 offset:30720
v_mfma_f32_16x16x32_bf16 v[112:115], a[12:15], a[40:43], v[112:115]
ds_read_b64_tr_b16 a[70:71], v15 offset:31232
v_mfma_f32_16x16x32_bf16 v[44:47], a[0:3], a[44:47], v[44:47]
ds_read_b64_tr_b16 a[72:73], v14 offset:32768
v_mfma_f32_16x16x32_bf16 v[68:71], a[4:7], a[44:47], v[68:71]
ds_read_b64_tr_b16 a[74:75], v14 offset:33280
v_mfma_f32_16x16x32_bf16 v[92:95], a[8:11], a[44:47], v[92:95]
ds_read_b64_tr_b16 a[76:77], v15 offset:32768
v_mfma_f32_16x16x32_bf16 v[116:119], a[12:15], a[44:47], v[116:119]
ds_read_b64_tr_b16 a[78:79], v15 offset:33280
v_mfma_f32_16x16x32_bf16 v[48:51], a[0:3], a[48:51], v[48:51]
s_add_u32 s70, s88, 0
buffer_store_dwordx4 v[28:31], v16, s[12:15], s70 offen sc1
v_mfma_f32_16x16x32_bf16 v[72:75], a[4:7], a[48:51], v[72:75]
v_mfma_f32_16x16x32_bf16 v[96:99], a[8:11], a[48:51], v[96:99]
s_add_u32 s70, s88, 65536
buffer_store_dwordx4 v[28:31], v16, s[12:15], s70 offen sc1
v_mfma_f32_16x16x32_bf16 v[120:123], a[12:15], a[48:51], v[120:123]
v_mfma_f32_16x16x32_bf16 v[52:55], a[0:3], a[52:55], v[52:55]
v_mfma_f32_16x16x32_bf16 v[76:79], a[4:7], a[52:55], v[76:79]
v_mfma_f32_16x16x32_bf16 v[100:103], a[8:11], a[52:55], v[100:103]
v_mfma_f32_16x16x32_bf16 v[124:127], a[12:15], a[52:55], v[124:127]
s_waitcnt lgkmcnt(0)
v_mfma_f32_16x16x32_bf16 v[32:35], a[56:59], a[16:19], v[32:35]
s_barrier
ds_read_b128 a[0:3], v10 offset:40960
v_mfma_f32_16x16x32_bf16 v[56:59], a[56:59], a[20:23], v[56:59]
ds_read_b64_tr_b16 a[32:33], v12 offset:40960
v_mfma_f32_16x16x32_bf16 v[80:83], a[56:59], a[24:27], v[80:83]
ds_read_b64_tr_b16 a[34:35], v12 offset:41472
v_mfma_f32_16x16x32_bf16 v[104:107], a[56:59], a[28:31], v[104:107]
ds_read_b128 a[4:7], v10 offset:43008
v_mfma_f32_16x16x32_bf16 v[36:39], a[60:63], a[16:19], v[36:39]
ds_read_b128 a[8:11], v10 offset:45056
v_mfma_f32_16x16x32_bf16 v[60:63], a[60:63], a[20:23], v[60:63]
ds_read_b128 a[12:15], v10 offset:47104
v_mfma_f32_16x16x32_bf16 v[84:87], a[60:63], a[24:27], v[84:87]
ds_read_b64_tr_b16 a[36:37], v13 offset:40960
v_mfma_f32_16x16x32_bf16 v[108:111], a[60:63], a[28:31], v[108:111]
ds_read_b64_tr_b16 a[38:39], v13 offset:41472
v_mfma_f32_16x16x32_bf16 v[40:43], a[16:19], a[64:67], v[40:43]
ds_read_b64_tr_b16 a[40:41], v12 offset:43008
v_mfma_f32_16x16x32_bf16 v[64:67], a[20:23], a[64:67], v[64:67]
ds_read_b64_tr_b16 a[42:43], v12 offset:43520
v_mfma_f32_16x16x32_bf16 v[88:91], a[24:27], a[64:67], v[88:91]
ds_read_b64_tr_b16 a[44:45], v13 offset:43008
v_mfma_f32_16x16x32_bf16 v[112:115], a[28:31], a[64:67], v[112:115]
ds_read_b64_tr_b16 a[46:47], v13 offset:43520
v_mfma_f32_16x16x32_bf16 v[44:47], a[16:19], a[68:71], v[44:47]
ds_read_b64_tr_b16 a[48:49], v12 offset:45056
v_mfma_f32_16x16x32_bf16 v[68:71], a[20:23], a[68:71], v[68:71]
ds_read_b64_tr_b16 a[50:51], v12 offset:45568
v_mfma_f32_16x16x32_bf16 v[92:95], a[24:27], a[68:71], v[92:95]
ds_read_b64_tr_b16 a[52:53], v13 offset:45056
v_mfma_f32_16x16x32_bf16 v[116:119], a[28:31], a[68:71], v[116:119]
ds_read_b64_tr_b16 a[54:55], v13 offset:45568
v_mfma_f32_16x16x32_bf16 v[48:51], a[16:19], a[72:75], v[48:51]
v_mfma_f32_16x16x32_bf16 v[72:75], a[20:23], a[72:75], v[72:75]
v_mfma_f32_16x16x32_bf16 v[96:99], a[24:27], a[72:75], v[96:99]
v_mfma_f32_16x16x32_bf16 v[120:123], a[28:31], a[72:75], v[120:123]
v_mfma_f32_16x16x32_bf16 v[52:55], a[16:19], a[76:79], v[52:55]
v_mfma_f32_16x16x32_bf16 v[76:79], a[20:23], a[76:79], v[76:79]
v_mfma_f32_16x16x32_bf16 v[100:103], a[24:27], a[76:79], v[100:103]
v_mfma_f32_16x16x32_bf16 v[124:127], a[28:31], a[76:79], v[124:127]
s_waitcnt lgkmcnt(0)
v_mfma_f32_16x16x32_bf16 v[32:35], a[32:35], a[0:3], v[32:35]
ds_read_b128 a[16:19], v11 offset:40960
v_mfma_f32_16x16x32_bf16 v[56:59], a[32:35], a[4:7], v[56:59]
ds_read_b64_tr_b16 a[56:57], v12 offset:53248
v_mfma_f32_16x16x32_bf16 v[80:83], a[32:35], a[8:11], v[80:83]
ds_read_b64_tr_b16 a[58:59], v12 offset:53760
v_mfma_f32_16x16x32_bf16 v[104:107], a[32:35], a[12:15], v[104:107]
ds_read_b128 a[20:23], v11 offset:43008
v_mfma_f32_16x16x32_bf16 v[36:39], a[36:39], a[0:3], v[36:39]
ds_read_b128 a[24:27], v11 offset:45056
v_mfma_f32_16x16x32_bf16 v[60:63], a[36:39], a[4:7], v[60:63]
ds_read_b128 a[28:31], v11 offset:47104
v_mfma_f32_16x16x32_bf16 v[84:87], a[36:39], a[8:11], v[84:87]
ds_read_b64_tr_b16 a[60:61], v13 offset:53248
v_mfma_f32_16x16x32_bf16 v[108:111], a[36:39], a[12:15], v[108:111]
ds_read_b64_tr_b16 a[62:63], v13 offset:53760
v_mfma_f32_16x16x32_bf16 v[40:43], a[0:3], a[40:43], v[40:43]
ds_read_b64_tr_b16 a[64:65], v12 offset:55296
v_mfma_f32_16x16x32_bf16 v[64:67], a[4:7], a[40:43], v[64:67]
ds_read_b64_tr_b16 a[66:67], v12 offset:55808
v_mfma_f32_16x16x32_bf16 v[88:91], a[8:11], a[40:43], v[88:91]
ds_read_b64_tr_b16 a[68:69], v13 offset:55296
v_mfma_f32_16x16x32_bf16 v[112:115], a[12:15], a[40:43], v[112:115]
ds_read_b64_tr_b16 a[70:71], v13 offset:55808
v_mfma_f32_16x16x32_bf16 v[44:47], a[0:3], a[44:47], v[44:47]
ds_read_b64_tr_b16 a[72:73], v12 offset:57344
v_mfma_f32_16x16x32_bf16 v[68:71], a[4:7], a[44:47], v[68:71]
ds_read_b64_tr_b16 a[74:75], v12 offset:57856
v_mfma_f32_16x16x32_bf16 v[92:95], a[8:11], a[44:47], v[92:95]
ds_read_b64_tr_b16 a[76:77], v13 offset:57344
v_mfma_f32_16x16x32_bf16 v[116:119], a[12:15], a[44:47], v[116:119]
ds_read_b64_tr_b16 a[78:79], v13 offset:57856
v_mfma_f32_16x16x32_bf16 v[48:51], a[0:3], a[48:51], v[48:51]
s_cmp_lg_u32 s94, 0
s_cbranch_scc1 L_nocsp
v_and_b32 v2, 16, v1
v_cmp_ne_u32 vcc, 0, v2
s_nop 1
v_cndmask_b32 v24, v128, v132, vcc
v_cndmask_b32 v25, v136, v140, vcc
v_cndmask_b32 v26, v144, v148, vcc
v_mov_b32 v27, s68
s_lshl_b32 s70, s64, 4
s_lshr_b32 s71, s65, 2
s_add_u32 s70, s70, s71
s_lshl_b32 s70, s70, 10
s_lshl_b32 s71, s67, 9
s_add_u32 s70, s70, s71
s_add_u32 s70, s70, 65536
s_mov_b64 exec, 0xffffffff
buffer_store_dwordx4 v[24:27], v16, s[12:15], s70 offen sc1
s_mov_b64 exec, -1
L_nocsp:
v_mfma_f32_16x16x32_bf16 v[72:75], a[4:7], a[48:51], v[72:75]
v_mfma_f32_16x16x32_bf16 v[96:99], a[8:11], a[48:51], v[96:99]
s_add_u32 s70, s88, 131072
buffer_store_dwordx4 v[28:31], v16, s[12:15], s70 offen sc1
v_mfma_f32_16x16x32_bf16 v[120:123], a[12:15], a[48:51], v[120:123]
v_mfma_f32_16x16x32_bf16 v[52:55], a[0:3], a[52:55], v[52:55]
s_add_u32 s70, s88, 196608
buffer_store_dwordx4 v[28:31], v16, s[12:15], s70 offen sc1
v_mfma_f32_16x16x32_bf16 v[76:79], a[4:7], a[52:55], v[76:79]
v_mfma_f32_16x16x32_bf16 v[100:103], a[8:11], a[52:55], v[100:103]
v_mfma_f32_16x16x32_bf16 v[124:127], a[12:15], a[52:55], v[124:127]
s_waitcnt lgkmcnt(0)
v_mfma_f32_16x16x32_bf16 v[32:35], a[56:59], a[16:19], v[32:35]
s_barrier
ds_read_b128 a[0:3], v10 offset:0
v_mfma_f32_16x16x32_bf16 v[56:59], a[56:59], a[20:23], v[56:59]
ds_read_b64_tr_b16 a[32:33], v12 offset:0
v_mfma_f32_16x16x32_bf16 v[80:83], a[56:59], a[24:27], v[80:83]
ds_read_b64_tr_b16 a[34:35], v12 offset:512
v_mfma_f32_16x16x32_bf16 v[104:107], a[56:59], a[28:31], v[104:107]
ds_read_b128 a[4:7], v10 offset:2048
v_mfma_f32_16x16x32_bf16 v[36:39], a[60:63], a[16:19], v[36:39]
ds_read_b128 a[8:11], v10 offset:4096
v_mfma_f32_16x16x32_bf16 v[60:63], a[60:63], a[20:23], v[60:63]
ds_read_b128 a[12:15], v10 offset:6144
v_mfma_f32_16x16x32_bf16 v[84:87], a[60:63], a[24:27], v[84:87]
ds_read_b64_tr_b16 a[36:37], v13 offset:0
v_mfma_f32_16x16x32_bf16 v[108:111], a[60:63], a[28:31], v[108:111]
ds_read_b64_tr_b16 a[38:39], v13 offset:512
v_mfma_f32_16x16x32_bf16 v[40:43], a[16:19], a[64:67], v[40:43]
ds_read_b64_tr_b16 a[40:41], v12 offset:2048
v_mfma_f32_16x16x32_bf16 v[64:67], a[20:23], a[64:67], v[64:67]
ds_read_b64_tr_b16 a[42:43], v12 offset:2560
v_mfma_f32_16x16x32_bf16 v[88:91], a[24:27], a[64:67], v[88:91]
ds_read_b64_tr_b16 a[44:45], v13 offset:2048
v_mfma_f32_16x16x32_bf16 v[112:115], a[28:31], a[64:67], v[112:115]
ds_read_b64_tr_b16 a[46:47], v13 offset:2560
v_mfma_f32_16x16x32_bf16 v[44:47], a[16:19], a[68:71], v[44:47]
ds_read_b64_tr_b16 a[48:49], v12 offset:4096
v_mfma_f32_16x16x32_bf16 v[68:71], a[20:23], a[68:71], v[68:71]
ds_read_b64_tr_b16 a[50:51], v12 offset:4608
v_mfma_f32_16x16x32_bf16 v[92:95], a[24:27], a[68:71], v[92:95]
ds_read_b64_tr_b16 a[52:53], v13 offset:4096
v_mfma_f32_16x16x32_bf16 v[116:119], a[28:31], a[68:71], v[116:119]
ds_read_b64_tr_b16 a[54:55], v13 offset:4608
v_mfma_f32_16x16x32_bf16 v[48:51], a[16:19], a[72:75], v[48:51]
v_mfma_f32_16x16x32_bf16 v[72:75], a[20:23], a[72:75], v[72:75]
v_mfma_f32_16x16x32_bf16 v[96:99], a[24:27], a[72:75], v[96:99]
v_mfma_f32_16x16x32_bf16 v[120:123], a[28:31], a[72:75], v[120:123]
v_mfma_f32_16x16x32_bf16 v[52:55], a[16:19], a[76:79], v[52:55]
v_mfma_f32_16x16x32_bf16 v[76:79], a[20:23], a[76:79], v[76:79]
v_mfma_f32_16x16x32_bf16 v[100:103], a[24:27], a[76:79], v[100:103]
v_mfma_f32_16x16x32_bf16 v[124:127], a[28:31], a[76:79], v[124:127]
s_waitcnt lgkmcnt(0)
v_mfma_f32_16x16x32_bf16 v[32:35], a[32:35], a[0:3], v[32:35]
ds_read_b128 a[16:19], v11 offset:0
v_mfma_f32_16x16x32_bf16 v[56:59], a[32:35], a[4:7], v[56:59]
ds_read_b64_tr_b16 a[56:57], v12 offset:12288
v_mfma_f32_16x16x32_bf16 v[80:83], a[32:35], a[8:11], v[80:83]
ds_read_b64_tr_b16 a[58:59], v12 offset:12800
v_mfma_f32_16x16x32_bf16 v[104:107], a[32:35], a[12:15], v[104:107]
ds_read_b128 a[20:23], v11 offset:2048
v_mfma_f32_16x16x32_bf16 v[36:39], a[36:39], a[0:3], v[36:39]
ds_read_b128 a[24:27], v11 offset:4096
v_mfma_f32_16x16x32_bf16 v[60:63], a[36:39], a[4:7], v[60:63]
ds_read_b128 a[28:31], v11 offset:6144
v_mfma_f32_16x16x32_bf16 v[84:87], a[36:39], a[8:11], v[84:87]
ds_read_b64_tr_b16 a[60:61], v13 offset:12288
v_mfma_f32_16x16x32_bf16 v[108:111], a[36:39], a[12:15], v[108:111]
ds_read_b64_tr_b16 a[62:63], v13 offset:12800
v_mfma_f32_16x16x32_bf16 v[40:43], a[0:3], a[40:43], v[40:43]
ds_read_b64_tr_b16 a[64:65], v12 offset:14336
v_mfma_f32_16x16x32_bf16 v[64:67], a[4:7], a[40:43], v[64:67]
ds_read_b64_tr_b16 a[66:67], v12 offset:14848
v_mfma_f32_16x16x32_bf16 v[88:91], a[8:11], a[40:43], v[88:91]
ds_read_b64_tr_b16 a[68:69], v13 offset:14336
v_mfma_f32_16x16x32_bf16 v[112:115], a[12:15], a[40:43], v[112:115]
ds_read_b64_tr_b16 a[70:71], v13 offset:14848
v_mfma_f32_16x16x32_bf16 v[44:47], a[0:3], a[44:47], v[44:47]
ds_read_b64_tr_b16 a[72:73], v12 offset:16384
v_mfma_f32_16x16x32_bf16 v[68:71], a[4:7], a[44:47], v[68:71]
ds_read_b64_tr_b16 a[74:75], v12 offset:16896
v_mfma_f32_16x16x32_bf16 v[92:95], a[8:11], a[44:47], v[92:95]
ds_read_b64_tr_b16 a[76:77], v13 offset:16384
v_mfma_f32_16x16x32_bf16 v[116:119], a[12:15], a[44:47], v[116:119]
ds_read_b64_tr_b16 a[78:79], v13 offset:16896
v_mfma_f32_16x16x32_bf16 v[48:51], a[0:3], a[48:51], v[48:51]
v_mfma_f32_16x16x32_bf16 v[72:75], a[4:7], a[48:51], v[72:75]
v_mfma_f32_16x16x32_bf16 v[96:99], a[8:11], a[48:51], v[96:99]
v_mfma_f32_16x16x32_bf16 v[120:123], a[12:15], a[48:51], v[120:123]
v_mfma_f32_16x16x32_bf16 v[52:55], a[0:3], a[52:55], v[52:55]
v_mfma_f32_16x16x32_bf16 v[76:79], a[4:7], a[52:55], v[76:79]
v_mfma_f32_16x16x32_bf16 v[100:103], a[8:11], a[52:55], v[100:103]
v_mfma_f32_16x16x32_bf16 v[124:127], a[12:15], a[52:55], v[124:127]
s_waitcnt lgkmcnt(0)
v_mfma_f32_16x16x32_bf16 v[32:35], a[56:59], a[16:19], v[32:35]
s_barrier
ds_read_b128 a[0:3], v8 offset:24576
v_mfma_f32_16x16x32_bf16 v[56:59], a[56:59], a[20:23], v[56:59]
ds_read_b64_tr_b16 a[32:33], v14 offset:16384
v_mfma_f32_16x16x32_bf16 v[80:83], a[56:59], a[24:27], v[80:83]
ds_read_b64_tr_b16 a[34:35], v14 offset:16896
v_mfma_f32_16x16x32_bf16 v[104:107], a[56:59], a[28:31], v[104:107]
ds_read_b128 a[4:7], v8 offset:26624
v_mfma_f32_16x16x32_bf16 v[36:39], a[60:63], a[16:19], v[36:39]
ds_read_b128 a[8:11], v8 offset:28672
v_mfma_f32_16x16x32_bf16 v[60:63], a[60:63], a[20:23], v[60:63]
ds_read_b128 a[12:15], v8 offset:30720
v_mfma_f32_16x16x32_bf16 v[84:87], a[60:63], a[24:27], v[84:87]
ds_read_b64_tr_b16 a[36:37], v15 offset:16384
v_mfma_f32_16x16x32_bf16 v[108:111], a[60:63], a[28:31], v[108:111]
ds_read_b64_tr_b16 a[38:39], v15 offset:16896
v_mfma_f32_16x16x32_bf16 v[40:43], a[16:19], a[64:67], v[40:43]
ds_read_b64_tr_b16 a[40:41], v14 offset:18432
v_mfma_f32_16x16x32_bf16 v[64:67], a[20:23], a[64:67], v[64:67]
ds_read_b64_tr_b16 a[42:43], v14 offset:18944
v_mfma_f32_16x16x32_bf16 v[88:91], a[24:27], a[64:67], v[88:91]
ds_read_b64_tr_b16 a[44:45], v15 offset:18432
v_mfma_f32_16x16x32_bf16 v[112:115], a[28:31], a[64:67], v[112:115]
ds_read_b64_tr_b16 a[46:47], v15 offset:18944
v_mfma_f32_16x16x32_bf16 v[44:47], a[16:19], a[68:71], v[44:47]
ds_read_b64_tr_b16 a[48:49], v14 offset:20480
v_mfma_f32_16x16x32_bf16 v[68:71], a[20:23], a[68:71], v[68:71]
ds_read_b64_tr_b16 a[50:51], v14 offset:20992
v_mfma_f32_16x16x32_bf16 v[92:95], a[24:27], a[68:71], v[92:95]
ds_read_b64_tr_b16 a[52:53], v15 offset:20480
v_mfma_f32_16x16x32_bf16 v[116:119], a[28:31], a[68:71], v[116:119]
ds_read_b64_tr_b16 a[54:55], v15 offset:20992
v_mfma_f32_16x16x32_bf16 v[48:51], a[16:19], a[72:75], v[48:51]
v_mfma_f32_16x16x32_bf16 v[72:75], a[20:23], a[72:75], v[72:75]
v_mfma_f32_16x16x32_bf16 v[96:99], a[24:27], a[72:75], v[96:99]
v_mfma_f32_16x16x32_bf16 v[120:123], a[28:31], a[72:75], v[120:123]
v_mfma_f32_16x16x32_bf16 v[52:55], a[16:19], a[76:79], v[52:55]
v_mfma_f32_16x16x32_bf16 v[76:79], a[20:23], a[76:79], v[76:79]
v_mfma_f32_16x16x32_bf16 v[100:103], a[24:27], a[76:79], v[100:103]
v_mfma_f32_16x16x32_bf16 v[124:127], a[28:31], a[76:79], v[124:127]
s_waitcnt lgkmcnt(0)
v_mfma_f32_16x16x32_bf16 v[32:35], a[32:35], a[0:3], v[32:35]
ds_read_b128 a[16:19], v9 offset:24576
v_mfma_f32_16x16x32_bf16 v[56:59], a[32:35], a[4:7], v[56:59]
ds_read_b64_tr_b16 a[56:57], v14 offset:28672
v_mfma_f32_16x16x32_bf16 v[80:83], a[32:35], a[8:11], v[80:83]
ds_read_b64_tr_b16 a[58:59], v14 offset:29184
v_mfma_f32_16x16x32_bf16 v[104:107], a[32:35], a[12:15], v[104:107]
ds_read_b128 a[20:23], v9 offset:26624
v_mfma_f32_16x16x32_bf16 v[36:39], a[36:39], a[0:3], v[36:39]
ds_read_b128 a[24:27], v9 offset:28672
v_mfma_f32_16x16x32_bf16 v[60:63], a[36:39], a[4:7], v[60:63]
ds_read_b128 a[28:31], v9 offset:30720
v_mfma_f32_16x16x32_bf16 v[84:87], a[36:39], a[8:11], v[84:87]
ds_read_b64_tr_b16 a[60:61], v15 offset:28672
v_mfma_f32_16x16x32_bf16 v[108:111], a[36:39], a[12:15], v[108:111]
ds_read_b64_tr_b16 a[62:63], v15 offset:29184
v_mfma_f32_16x16x32_bf16 v[40:43], a[0:3], a[40:43], v[40:43]
ds_read_b64_tr_b16 a[64:65], v14 offset:30720
v_mfma_f32_16x16x32_bf16 v[64:67], a[4:7], a[40:43], v[64:67]
ds_read_b64_tr_b16 a[66:67], v14 offset:31232
v_mfma_f32_16x16x32_bf16 v[88:91], a[8:11], a[40:43], v[88:91]
ds_read_b64_tr_b16 a[68:69], v15 offset:30720
v_mfma_f32_16x16x32_bf16 v[112:115], a[12:15], a[40:43], v[112:115]
ds_read_b64_tr_b16 a[70:71], v15 offset:31232
v_mfma_f32_16x16x32_bf16 v[44:47], a[0:3], a[44:47], v[44:47]
ds_read_b64_tr_b16 a[72:73], v14 offset:32768
v_mfma_f32_16x16x32_bf16 v[68:71], a[4:7], a[44:47], v[68:71]
ds_read_b64_tr_b16 a[74:75], v14 offset:33280
v_mfma_f32_16x16x32_bf16 v[92:95], a[8:11], a[44:47], v[92:95]
ds_read_b64_tr_b16 a[76:77], v15 offset:32768
v_mfma_f32_16x16x32_bf16 v[116:119], a[12:15], a[44:47], v[116:119]
ds_read_b64_tr_b16 a[78:79], v15 offset:33280
v_mfma_f32_16x16x32_bf16 v[48:51], a[0:3], a[48:51], v[48:51]
s_waitcnt vmcnt(0)
v_mfma_f32_16x16x32_bf16 v[72:75], a[4:7], a[48:51], v[72:75]
v_mfma_f32_16x16x32_bf16 v[96:99], a[8:11], a[48:51], v[96:99]
v_mfma_f32_16x16x32_bf16 v[120:123], a[12:15], a[48:51], v[120:123]
v_mfma_f32_16x16x32_bf16 v[52:55], a[0:3], a[52:55], v[52:55]
v_mfma_f32_16x16x32_bf16 v[76:79], a[4:7], a[52:55], v[76:79]
v_mfma_f32_16x16x32_bf16 v[100:103], a[8:11], a[52:55], v[100:103]
v_mfma_f32_16x16x32_bf16 v[124:127], a[12:15], a[52:55], v[124:127]
s_waitcnt lgkmcnt(0)
v_mfma_f32_16x16x32_bf16 v[32:35], a[56:59], a[16:19], v[32:35]
s_barrier
ds_read_b128 a[0:3], v10 offset:57344
v_mfma_f32_16x16x32_bf16 v[56:59], a[56:59], a[20:23], v[56:59]
ds_read_b64_tr_b16 a[32:33], v12 offset:40960
v_mfma_f32_16x16x32_bf16 v[80:83], a[56:59], a[24:27], v[80:83]
ds_read_b64_tr_b16 a[34:35], v12 offset:41472
v_mfma_f32_16x16x32_bf16 v[104:107], a[56:59], a[28:31], v[104:107]
ds_read_b128 a[4:7], v10 offset:59392
v_mfma_f32_16x16x32_bf16 v[36:39], a[60:63], a[16:19], v[36:39]
ds_read_b128 a[8:11], v10 offset:61440
v_mfma_f32_16x16x32_bf16 v[60:63], a[60:63], a[20:23], v[60:63]
ds_read_b128 a[12:15], v10 offset:63488
v_mfma_f32_16x16x32_bf16 v[84:87], a[60:63], a[24:27], v[84:87]
ds_read_b64_tr_b16 a[36:37], v13 offset:40960
v_mfma_f32_16x16x32_bf16 v[108:111], a[60:63], a[28:31], v[108:111]
ds_read_b64_tr_b16 a[38:39], v13 offset:41472
v_mfma_f32_16x16x32_bf16 v[40:43], a[16:19], a[64:67], v[40:43]
ds_read_b64_tr_b16 a[40:41], v12 offset:43008
v_mfma_f32_16x16x32_bf16 v[64:67], a[20:23], a[64:67], v[64:67]
ds_read_b64_tr_b16 a[42:43], v12 offset:43520
v_mfma_f32_16x16x32_bf16 v[88:91], a[24:27], a[64:67], v[88:91]
ds_read_b64_tr_b16 a[44:45], v13 offset:43008
v_mfma_f32_16x16x32_bf16 v[112:115], a[28:31], a[64:67], v[112:115]
ds_read_b64_tr_b16 a[46:47], v13 offset:43520
v_mfma_f32_16x16x32_bf16 v[44:47], a[16:19], a[68:71], v[44:47]
ds_read_b64_tr_b16 a[48:49], v12 offset:45056
v_mfma_f32_16x16x32_bf16 v[68:71], a[20:23], a[68:71], v[68:71]
ds_read_b64_tr_b16 a[50:51], v12 offset:45568
v_mfma_f32_16x16x32_bf16 v[92:95], a[24:27], a[68:71], v[92:95]
ds_read_b64_tr_b16 a[52:53], v13 offset:45056
v_mfma_f32_16x16x32_bf16 v[116:119], a[28:31], a[68:71], v[116:119]
ds_read_b64_tr_b16 a[54:55], v13 offset:45568
v_mfma_f32_16x16x32_bf16 v[48:51], a[16:19], a[72:75], v[48:51]
v_mfma_f32_16x16x32_bf16 v[72:75], a[20:23], a[72:75], v[72:75]
v_mfma_f32_16x16x32_bf16 v[96:99], a[24:27], a[72:75], v[96:99]
v_mfma_f32_16x16x32_bf16 v[120:123], a[28:31], a[72:75], v[120:123]
v_mfma_f32_16x16x32_bf16 v[52:55], a[16:19], a[76:79], v[52:55]
v_mfma_f32_16x16x32_bf16 v[76:79], a[20:23], a[76:79], v[76:79]
v_mfma_f32_16x16x32_bf16 v[100:103], a[24:27], a[76:79], v[100:103]
v_mfma_f32_16x16x32_bf16 v[124:127], a[28:31], a[76:79], v[124:127]
s_waitcnt lgkmcnt(0)
v_mfma_f32_16x16x32_bf16 v[32:35], a[32:35], a[0:3], v[32:35]
ds_read_b128 a[16:19], v11 offset:57344
v_mfma_f32_16x16x32_bf16 v[56:59], a[32:35], a[4:7], v[56:59]
ds_read_b64_tr_b16 a[56:57], v12 offset:53248
v_mfma_f32_16x16x32_bf16 v[80:83], a[32:35], a[8:11], v[80:83]
ds_read_b64_tr_b16 a[58:59], v12 offset:53760
v_mfma_f32_16x16x32_bf16 v[104:107], a[32:35], a[12:15], v[104:107]
ds_read_b128 a[20:23], v11 offset:59392
v_mfma_f32_16x16x32_bf16 v[36:39], a[36:39], a[0:3], v[36:39]
ds_read_b128 a[24:27], v11 offset:61440
v_mfma_f32_16x16x32_bf16 v[60:63], a[36:39], a[4:7], v[60:63]
ds_read_b128 a[28:31], v11 offset:63488
v_mfma_f32_16x16x32_bf16 v[84:87], a[36:39], a[8:11], v[84:87]
ds_read_b64_tr_b16 a[60:61], v13 offset:53248
v_mfma_f32_16x16x32_bf16 v[108:111], a[36:39], a[12:15], v[108:111]
ds_read_b64_tr_b16 a[62:63], v13 offset:53760
v_mfma_f32_16x16x32_bf16 v[40:43], a[0:3], a[40:43], v[40:43]
ds_read_b64_tr_b16 a[64:65], v12 offset:55296
v_mfma_f32_16x16x32_bf16 v[64:67], a[4:7], a[40:43], v[64:67]
ds_read_b64_tr_b16 a[66:67], v12 offset:55808
v_mfma_f32_16x16x32_bf16 v[88:91], a[8:11], a[40:43], v[88:91]
ds_read_b64_tr_b16 a[68:69], v13 offset:55296
v_mfma_f32_16x16x32_bf16 v[112:115], a[12:15], a[40:43], v[112:115]
ds_read_b64_tr_b16 a[70:71], v13 offset:55808
v_mfma_f32_16x16x32_bf16 v[44:47], a[0:3], a[44:47], v[44:47]
ds_read_b64_tr_b16 a[72:73], v12 offset:57344
v_mfma_f32_16x16x32_bf16 v[68:71], a[4:7], a[44:47], v[68:71]
ds_read_b64_tr_b16 a[74:75], v12 offset:57856
v_mfma_f32_16x16x32_bf16 v[92:95], a[8:11], a[44:47], v[92:95]
ds_read_b64_tr_b16 a[76:77], v13 offset:57344
v_mfma_f32_16x16x32_bf16 v[116:119], a[12:15], a[44:47], v[116:119]
ds_read_b64_tr_b16 a[78:79], v13 offset:57856
v_mfma_f32_16x16x32_bf16 v[48:51], a[0:3], a[48:51], v[48:51]
v_mfma_f32_16x16x32_bf16 v[72:75], a[4:7], a[48:51], v[72:75]
v_mfma_f32_16x16x32_bf16 v[96:99], a[8:11], a[48:51], v[96:99]
v_mfma_f32_16x16x32_bf16 v[120:123], a[12:15], a[48:51], v[120:123]
v_mfma_f32_16x16x32_bf16 v[52:55], a[0:3], a[52:55], v[52:55]
v_mfma_f32_16x16x32_bf16 v[76:79], a[4:7], a[52:55], v[76:79]
v_mfma_f32_16x16x32_bf16 v[100:103], a[8:11], a[52:55], v[100:103]
v_mfma_f32_16x16x32_bf16 v[124:127], a[12:15], a[52:55], v[124:127]
s_waitcnt lgkmcnt(0)
v_mfma_f32_16x16x32_bf16 v[32:35], a[56:59], a[16:19], v[32:35]
s_barrier
ds_read_b128 a[0:3], v10 offset:40960
v_mfma_f32_16x16x32_bf16 v[56:59], a[56:59], a[20:23], v[56:59]
ds_read_b64_tr_b16 a[32:33], v12 offset:0
v_mfma_f32_16x16x32_bf16 v[80:83], a[56:59], a[24:27], v[80:83]
ds_read_b64_tr_b16 a[34:35], v12 offset:512
v_mfma_f32_16x16x32_bf16 v[104:107], a[56:59], a[28:31], v[104:107]
ds_read_b128 a[4:7], v10 offset:43008
v_mfma_f32_16x16x32_bf16 v[36:39], a[60:63], a[16:19], v[36:39]
ds_read_b128 a[8:11], v10 offset:45056
v_mfma_f32_16x16x32_bf16 v[60:63], a[60:63], a[20:23], v[60:63]
ds_read_b128 a[12:15], v10 offset:47104
v_mfma_f32_16x16x32_bf16 v[84:87], a[60:63], a[24:27], v[84:87]
ds_read_b64_tr_b16 a[36:37], v13 offset:0
v_mfma_f32_16x16x32_bf16 v[108:111], a[60:63], a[28:31], v[108:111]
ds_read_b64_tr_b16 a[38:39], v13 offset:512
v_mfma_f32_16x16x32_bf16 v[40:43], a[16:19], a[64:67], v[40:43]
ds_read_b64_tr_b16 a[40:41], v12 offset:2048
v_mfma_f32_16x16x32_bf16 v[64:67], a[20:23], a[64:67], v[64:67]
ds_read_b64_tr_b16 a[42:43], v12 offset:2560
v_mfma_f32_16x16x32_bf16 v[88:91], a[24:27], a[64:67], v[88:91]
ds_read_b64_tr_b16 a[44:45], v13 offset:2048
v_mfma_f32_16x16x32_bf16 v[112:115], a[28:31], a[64:67], v[112:115]
ds_read_b64_tr_b16 a[46:47], v13 offset:2560
v_mfma_f32_16x16x32_bf16 v[44:47], a[16:19], a[68:71], v[44:47]
ds_read_b64_tr_b16 a[48:49], v12 offset:4096
v_mfma_f32_16x16x32_bf16 v[68:71], a[20:23], a[68:71], v[68:71]
ds_read_b64_tr_b16 a[50:51], v12 offset:4608
v_mfma_f32_16x16x32_bf16 v[92:95], a[24:27], a[68:71], v[92:95]
ds_read_b64_tr_b16 a[52:53], v13 offset:4096
v_mfma_f32_16x16x32_bf16 v[116:119], a[28:31], a[68:71], v[116:119]
ds_read_b64_tr_b16 a[54:55], v13 offset:4608
v_mfma_f32_16x16x32_bf16 v[48:51], a[16:19], a[72:75], v[48:51]
v_mfma_f32_16x16x32_bf16 v[72:75], a[20:23], a[72:75], v[72:75]
v_mfma_f32_16x16x32_bf16 v[96:99], a[24:27], a[72:75], v[96:99]
v_mfma_f32_16x16x32_bf16 v[120:123], a[28:31], a[72:75], v[120:123]
v_mfma_f32_16x16x32_bf16 v[52:55], a[16:19], a[76:79], v[52:55]
v_mfma_f32_16x16x32_bf16 v[76:79], a[20:23], a[76:79], v[76:79]
v_mfma_f32_16x16x32_bf16 v[100:103], a[24:27], a[76:79], v[100:103]
v_mfma_f32_16x16x32_bf16 v[124:127], a[28:31], a[76:79], v[124:127]
s_waitcnt lgkmcnt(0)
v_mfma_f32_16x16x32_bf16 v[32:35], a[32:35], a[0:3], v[32:35]
ds_read_b128 a[16:19], v11 offset:40960
v_mfma_f32_16x16x32_bf16 v[56:59], a[32:35], a[4:7], v[56:59]
ds_read_b64_tr_b16 a[56:57], v12 offset:12288
v_mfma_f32_16x16x32_bf16 v[80:83], a[32:35], a[8:11], v[80:83]
ds_read_b64_tr_b16 a[58:59], v12 offset:12800
v_mfma_f32_16x16x32_bf16 v[104:107], a[32:35], a[12:15], v[104:107]
ds_read_b128 a[20:23], v11 offset:43008
v_mfma_f32_16x16x32_bf16 v[36:39], a[36:39], a[0:3], v[36:39]
ds_read_b128 a[24:27], v11 offset:45056
v_mfma_f32_16x16x32_bf16 v[60:63], a[36:39], a[4:7], v[60:63]
ds_read_b128 a[28:31], v11 offset:47104
v_mfma_f32_16x16x32_bf16 v[84:87], a[36:39], a[8:11], v[84:87]
ds_read_b64_tr_b16 a[60:61], v13 offset:12288
v_mfma_f32_16x16x32_bf16 v[108:111], a[36:39], a[12:15], v[108:111]
ds_read_b64_tr_b16 a[62:63], v13 offset:12800
v_mfma_f32_16x16x32_bf16 v[40:43], a[0:3], a[40:43], v[40:43]
ds_read_b64_tr_b16 a[64:65], v12 offset:14336
v_mfma_f32_16x16x32_bf16 v[64:67], a[4:7], a[40:43], v[64:67]
ds_read_b64_tr_b16 a[66:67], v12 offset:14848
v_mfma_f32_16x16x32_bf16 v[88:91], a[8:11], a[40:43], v[88:91]
ds_read_b64_tr_b16 a[68:69], v13 offset:14336
v_mfma_f32_16x16x32_bf16 v[112:115], a[12:15], a[40:43], v[112:115]
ds_read_b64_tr_b16 a[70:71], v13 offset:14848
v_mfma_f32_16x16x32_bf16 v[44:47], a[0:3], a[44:47], v[44:47]
ds_read_b64_tr_b16 a[72:73], v12 offset:16384
v_mfma_f32_16x16x32_bf16 v[68:71], a[4:7], a[44:47], v[68:71]
ds_read_b64_tr_b16 a[74:75], v12 offset:16896
v_mfma_f32_16x16x32_bf16 v[92:95], a[8:11], a[44:47], v[92:95]
ds_read_b64_tr_b16 a[76:77], v13 offset:16384
v_mfma_f32_16x16x32_bf16 v[116:119], a[12:15], a[44:47], v[116:119]
ds_read_b64_tr_b16 a[78:79], v13 offset:16896
v_mfma_f32_16x16x32_bf16 v[48:51], a[0:3], a[48:51], v[48:51]
v_mfma_f32_16x16x32_bf16 v[72:75], a[4:7], a[48:51], v[72:75]
v_mfma_f32_16x16x32_bf16 v[96:99], a[8:11], a[48:51], v[96:99]
v_mfma_f32_16x16x32_bf16 v[120:123], a[12:15], a[48:51], v[120:123]
v_mfma_f32_16x16x32_bf16 v[52:55], a[0:3], a[52:55], v[52:55]
v_mfma_f32_16x16x32_bf16 v[76:79], a[4:7], a[52:55], v[76:79]
v_mfma_f32_16x16x32_bf16 v[100:103], a[8:11], a[52:55], v[100:103]
v_mfma_f32_16x16x32_bf16 v[124:127], a[12:15], a[52:55], v[124:127]
s_waitcnt lgkmcnt(0)
v_mfma_f32_16x16x32_bf16 v[32:35], a[56:59], a[16:19], v[32:35]
s_barrier
ds_read_b128 a[0:3], v10 offset:0
v_mfma_f32_16x16x32_bf16 v[56:59], a[56:59], a[20:23], v[56:59]
ds_read_b64_tr_b16 a[32:33], v14 offset:16384
v_mfma_f32_16x16x32_bf16 v[80:83], a[56:59], a[24:27], v[80:83]
ds_read_b64_tr_b16 a[34:35], v14 offset:16896
v_mfma_f32_16x16x32_bf16 v[104:107], a[56:59], a[28:31], v[104:107]
ds_read_b128 a[4:7], v10 offset:2048
v_mfma_f32_16x16x32_bf16 v[36:39], a[60:63], a[16:19], v[36:39]
s_branch L_over4
L_pad4:
s_branch L_ret4
L_over4:
ds_read_b128 a[8:11], v10 offset:4096
v_mfma_f32_16x16x32_bf16 v[60:63], a[60:63], a[20:23], v[60:63]
ds_read_b128 a[12:15], v10 offset:6144
v_mfma_f32_16x16x32_bf16 v[84:87], a[60:63], a[24:27], v[84:87]
ds_read_b64_tr_b16 a[36:37], v15 offset:16384
v_mfma_f32_16x16x32_bf16 v[108:111], a[60:63], a[28:31], v[108:111]
ds_read_b64_tr_b16 a[38:39], v15 offset:16896
v_mfma_f32_16x16x32_bf16 v[40:43], a[16:19], a[64:67], v[40:43]
ds_read_b64_tr_b16 a[40:41], v14 offset:18432
v_mfma_f32_16x16x32_bf16 v[64:67], a[20:23], a[64:67], v[64:67]
ds_read_b64_tr_b16 a[42:43], v14 offset:18944
v_mfma_f32_16x16x32_bf16 v[88:91], a[24:27], a[64:67], v[88:91]
ds_read_b64_tr_b16 a[44:45], v15 offset:18432
v_mfma_f32_16x16x32_bf16 v[112:115], a[28:31], a[64:67], v[112:115]
ds_read_b64_tr_b16 a[46:47], v15 offset:18944
v_mfma_f32_16x16x32_bf16 v[44:47], a[16:19], a[68:71], v[44:47]
ds_read_b64_tr_b16 a[48:49], v14 offset:20480
v_mfma_f32_16x16x32_bf16 v[68:71], a[20:23], a[68:71], v[68:71]
ds_read_b64_tr_b16 a[50:51], v14 offset:20992
v_mfma_f32_16x16x32_bf16 v[92:95], a[24:27], a[68:71], v[92:95]
ds_read_b64_tr_b16 a[52:53], v15 offset:20480
v_mfma_f32_16x16x32_bf16 v[116:119], a[28:31], a[68:71], v[116:119]
ds_read_b64_tr_b16 a[54:55], v15 offset:20992
v_mfma_f32_16x16x32_bf16 v[48:51], a[16:19], a[72:75], v[48:51]
v_mfma_f32_16x16x32_bf16 v[72:75], a[20:23], a[72:75], v[72:75]
v_mfma_f32_16x16x32_bf16 v[96:99], a[24:27], a[72:75], v[96:99]
v_mfma_f32_16x16x32_bf16 v[120:123], a[28:31], a[72:75], v[120:123]
v_mfma_f32_16x16x32_bf16 v[52:55], a[16:19], a[76:79], v[52:55]
v_mfma_f32_16x16x32_bf16 v[76:79], a[20:23], a[76:79], v[76:79]
v_mfma_f32_16x16x32_bf16 v[100:103], a[24:27], a[76:79], v[100:103]
v_mfma_f32_16x16x32_bf16 v[124:127], a[28:31], a[76:79], v[124:127]
s_waitcnt lgkmcnt(0)
v_mfma_f32_16x16x32_bf16 v[32:35], a[32:35], a[0:3], v[32:35]
ds_read_b128 a[16:19], v11 offset:0
v_mfma_f32_16x16x32_bf16 v[56:59], a[32:35], a[4:7], v[56:59]
ds_read_b64_tr_b16 a[56:57], v14 offset:28672
v_mfma_f32_16x16x32_bf16 v[80:83], a[32:35], a[8:11], v[80:83]
ds_read_b64_tr_b16 a[58:59], v14 offset:29184
v_mfma_f32_16x16x32_bf16 v[104:107], a[32:35], a[12:15], v[104:107]
ds_read_b128 a[20:23], v11 offset:2048
v_mfma_f32_16x16x32_bf16 v[36:39], a[36:39], a[0:3], v[36:39]
ds_read_b128 a[24:27], v11 offset:4096
v_mfma_f32_16x16x32_bf16 v[60:63], a[36:39], a[4:7], v[60:63]
ds_read_b128 a[28:31], v11 offset:6144
v_mfma_f32_16x16x32_bf16 v[84:87], a[36:39], a[8:11], v[84:87]
ds_read_b64_tr_b16 a[60:61], v15 offset:28672
v_mfma_f32_16x16x32_bf16 v[108:111], a[36:39], a[12:15], v[108:111]
ds_read_b64_tr_b16 a[62:63], v15 offset:29184
v_mfma_f32_16x16x32_bf16 v[40:43], a[0:3], a[40:43], v[40:43]
ds_read_b64_tr_b16 a[64:65], v14 offset:30720
v_mfma_f32_16x16x32_bf16 v[64:67], a[4:7], a[40:43], v[64:67]
ds_read_b64_tr_b16 a[66:67], v14 offset:31232
v_mfma_f32_16x16x32_bf16 v[88:91], a[8:11], a[40:43], v[88:91]
ds_read_b64_tr_b16 a[68:69], v15 offset:30720
v_mfma_f32_16x16x32_bf16 v[112:115], a[12:15], a[40:43], v[112:115]
ds_read_b64_tr_b16 a[70:71], v15 offset:31232
v_mfma_f32_16x16x32_bf16 v[44:47], a[0:3], a[44:47], v[44:47]
ds_read_b64_tr_b16 a[72:73], v14 offset:32768
v_mfma_f32_16x16x32_bf16 v[68:71], a[4:7], a[44:47], v[68:71]
ds_read_b64_tr_b16 a[74:75], v14 offset:33280
v_mfma_f32_16x16x32_bf16 v[92:95], a[8:11], a[44:47], v[92:95]
ds_read_b64_tr_b16 a[76:77], v15 offset:32768
v_mfma_f32_16x16x32_bf16 v[116:119], a[12:15], a[44:47], v[116:119]
ds_read_b64_tr_b16 a[78:79], v15 offset:33280
v_mfma_f32_16x16x32_bf16 v[48:51], a[0:3], a[48:51], v[48:51]
v_mfma_f32_16x16x32_bf16 v[72:75], a[4:7], a[48:51], v[72:75]
v_mfma_f32_16x16x32_bf16 v[96:99], a[8:11], a[48:51], v[96:99]
v_mfma_f32_16x16x32_bf16 v[120:123], a[12:15], a[48:51], v[120:123]
v_mfma_f32_16x16x32_bf16 v[52:55], a[0:3], a[52:55], v[52:55]
v_mfma_f32_16x16x32_bf16 v[76:79], a[4:7], a[52:55], v[76:79]
v_mfma_f32_16x16x32_bf16 v[100:103], a[8:11], a[52:55], v[100:103]
v_mfma_f32_16x16x32_bf16 v[124:127], a[12:15], a[52:55], v[124:127]
s_waitcnt lgkmcnt(0)
v_mfma_f32_16x16x32_bf16 v[32:35], a[56:59], a[16:19], v[32:35]
s_barrier
ds_read_b128 a[0:3], v8 offset:24576
v_mfma_f32_16x16x32_bf16 v[56:59], a[56:59], a[20:23], v[56:59]
ds_read_b64_tr_b16 a[32:33], v12 offset:40960
v_mfma_f32_16x16x32_bf16 v[80:83], a[56:59], a[24:27], v[80:83]
ds_read_b64_tr_b16 a[34:35], v12 offset:41472
v_mfma_f32_16x16x32_bf16 v[104:107], a[56:59], a[28:31], v[104:107]
ds_read_b128 a[4:7], v8 offset:26624
v_mfma_f32_16x16x32_bf16 v[36:39], a[60:63], a[16:19], v[36:39]
ds_read_b128 a[8:11], v8 offset:28672
v_mfma_f32_16x16x32_bf16 v[60:63], a[60:63], a[20:23], v[60:63]
ds_read_b128 a[12:15], v8 offset:30720
v_mfma_f32_16x16x32_bf16 v[84:87], a[60:63], a[24:27], v[84:87]
ds_read_b64_tr_b16 a[36:37], v13 offset:40960
v_mfma_f32_16x16x32_bf16 v[108:111], a[60:63], a[28:31], v[108:111]
ds_read_b64_tr_b16 a[38:39], v13 offset:41472
v_mfma_f32_16x16x32_bf16 v[40:43], a[16:19], a[64:67], v[40:43]
ds_read_b64_tr_b16 a[40:41], v12 offset:43008
v_mfma_f32_16x16x32_bf16 v[64:67], a[20:23], a[64:67], v[64:67]
ds_read_b64_tr_b16 a[42:43], v12 offset:43520
v_mfma_f32_16x16x32_bf16 v[88:91], a[24:27], a[64:67], v[88:91]
ds_read_b64_tr_b16 a[44:45], v13 offset:43008
v_mfma_f32_16x16x32_bf16 v[112:115], a[28:31], a[64:67], v[112:115]
ds_read_b64_tr_b16 a[46:47], v13 offset:43520
v_mfma_f32_16x16x32_bf16 v[44:47], a[16:19], a[68:71], v[44:47]
ds_read_b64_tr_b16 a[48:49], v12 offset:45056
v_mfma_f32_16x16x32_bf16 v[68:71], a[20:23], a[68:71], v[68:71]
ds_read_b64_tr_b16 a[50:51], v12 offset:45568
v_mfma_f32_16x16x32_bf16 v[92:95], a[24:27], a[68:71], v[92:95]
ds_read_b64_tr_b16 a[52:53], v13 offset:45056
v_mfma_f32_16x16x32_bf16 v[116:119], a[28:31], a[68:71], v[116:119]
ds_read_b64_tr_b16 a[54:55], v13 offset:45568
v_mfma_f32_16x16x32_bf16 v[48:51], a[16:19], a[72:75], v[48:51]
v_mfma_f32_16x16x32_bf16 v[72:75], a[20:23], a[72:75], v[72:75]
v_mfma_f32_16x16x32_bf16 v[96:99], a[24:27], a[72:75], v[96:99]
v_mfma_f32_16x16x32_bf16 v[120:123], a[28:31], a[72:75], v[120:123]
v_mfma_f32_16x16x32_bf16 v[52:55], a[16:19], a[76:79], v[52:55]
v_mfma_f32_16x16x32_bf16 v[76:79], a[20:23], a[76:79], v[76:79]
v_mfma_f32_16x16x32_bf16 v[100:103], a[24:27], a[76:79], v[100:103]
v_mfma_f32_16x16x32_bf16 v[124:127], a[28:31], a[76:79], v[124:127]
s_waitcnt lgkmcnt(0)
v_mfma_f32_16x16x32_bf16 v[32:35], a[32:35], a[0:3], v[32:35]
ds_read_b128 a[16:19], v9 offset:24576
v_mfma_f32_16x16x32_bf16 v[56:59], a[32:35], a[4:7], v[56:59]
ds_read_b64_tr_b16 a[56:57], v12 offset:53248
v_mfma_f32_16x16x32_bf16 v[80:83], a[32:35], a[8:11], v[80:83]
ds_read_b64_tr_b16 a[58:59], v12 offset:53760
v_mfma_f32_16x16x32_bf16 v[104:107], a[32:35], a[12:15], v[104:107]
ds_read_b128 a[20:23], v9 offset:26624
v_mfma_f32_16x16x32_bf16 v[36:39], a[36:39], a[0:3], v[36:39]
ds_read_b128 a[24:27], v9 offset:28672
v_mfma_f32_16x16x32_bf16 v[60:63], a[36:39], a[4:7], v[60:63]
ds_read_b128 a[28:31], v9 offset:30720
v_mfma_f32_16x16x32_bf16 v[84:87], a[36:39], a[8:11], v[84:87]
ds_read_b64_tr_b16 a[60:61], v13 offset:53248
v_mfma_f32_16x16x32_bf16 v[108:111], a[36:39], a[12:15], v[108:111]
ds_read_b64_tr_b16 a[62:63], v13 offset:53760
v_mfma_f32_16x16x32_bf16 v[40:43], a[0:3], a[40:43], v[40:43]
ds_read_b64_tr_b16 a[64:65], v12 offset:55296
v_mfma_f32_16x16x32_bf16 v[64:67], a[4:7], a[40:43], v[64:67]
ds_read_b64_tr_b16 a[66:67], v12 offset:55808
v_mfma_f32_16x16x32_bf16 v[88:91], a[8:11], a[40:43], v[88:91]
ds_read_b64_tr_b16 a[68:69], v13 offset:55296
v_mfma_f32_16x16x32_bf16 v[112:115], a[12:15], a[40:43], v[112:115]
ds_read_b64_tr_b16 a[70:71], v13 offset:55808
v_mfma_f32_16x16x32_bf16 v[44:47], a[0:3], a[44:47], v[44:47]
ds_read_b64_tr_b16 a[72:73], v12 offset:57344
v_mfma_f32_16x16x32_bf16 v[68:71], a[4:7], a[44:47], v[68:71]
ds_read_b64_tr_b16 a[74:75], v12 offset:57856
v_mfma_f32_16x16x32_bf16 v[92:95], a[8:11], a[44:47], v[92:95]
ds_read_b64_tr_b16 a[76:77], v13 offset:57344
v_mfma_f32_16x16x32_bf16 v[116:119], a[12:15], a[44:47], v[116:119]
ds_read_b64_tr_b16 a[78:79], v13 offset:57856
v_mfma_f32_16x16x32_bf16 v[48:51], a[0:3], a[48:51], v[48:51]
v_mfma_f32_16x16x32_bf16 v[72:75], a[4:7], a[48:51], v[72:75]
v_mfma_f32_16x16x32_bf16 v[96:99], a[8:11], a[48:51], v[96:99]
v_mfma_f32_16x16x32_bf16 v[120:123], a[12:15], a[48:51], v[120:123]
v_mfma_f32_16x16x32_bf16 v[52:55], a[0:3], a[52:55], v[52:55]
v_mfma_f32_16x16x32_bf16 v[76:79], a[4:7], a[52:55], v[76:79]
v_mfma_f32_16x16x32_bf16 v[100:103], a[8:11], a[52:55], v[100:103]
v_mfma_f32_16x16x32_bf16 v[124:127], a[12:15], a[52:55], v[124:127]
s_waitcnt lgkmcnt(0)
v_mfma_f32_16x16x32_bf16 v[32:35], a[56:59], a[16:19], v[32:35]
s_barrier
ds_read_b128 a[0:3], v10 offset:57344
v_mfma_f32_16x16x32_bf16 v[56:59], a[56:59], a[20:23], v[56:59]
ds_read_b64_tr_b16 a[32:33], v12 offset:0
v_mfma_f32_16x16x32_bf16 v[80:83], a[56:59], a[24:27], v[80:83]
ds_read_b64_tr_b16 a[34:35], v12 offset:512
v_mfma_f32_16x16x32_bf16 v[104:107], a[56:59], a[28:31], v[104:107]
ds_read_b128 a[4:7], v10 offset:59392
v_mfma_f32_16x16x32_bf16 v[36:39], a[60:63], a[16:19], v[36:39]
ds_read_b128 a[8:11], v10 offset:61440
v_mfma_f32_16x16x32_bf16 v[60:63], a[60:63], a[20:23], v[60:63]
ds_read_b128 a[12:15], v10 offset:63488
v_mfma_f32_16x16x32_bf16 v[84:87], a[60:63], a[24:27], v[84:87]
ds_read_b64_tr_b16 a[36:37], v13 offset:0
v_mfma_f32_16x16x32_bf16 v[108:111], a[60:63], a[28:31], v[108:111]
ds_read_b64_tr_b16 a[38:39], v13 offset:512
v_mfma_f32_16x16x32_bf16 v[40:43], a[16:19], a[64:67], v[40:43]
ds_read_b64_tr_b16 a[40:41], v12 offset:2048
v_mfma_f32_16x16x32_bf16 v[64:67], a[20:23], a[64:67], v[64:67]
ds_read_b64_tr_b16 a[42:43], v12 offset:2560
v_mfma_f32_16x16x32_bf16 v[88:91], a[24:27], a[64:67], v[88:91]
ds_read_b64_tr_b16 a[44:45], v13 offset:2048
v_mfma_f32_16x16x32_bf16 v[112:115], a[28:31], a[64:67], v[112:115]
ds_read_b64_tr_b16 a[46:47], v13 offset:2560
v_mfma_f32_16x16x32_bf16 v[44:47], a[16:19], a[68:71], v[44:47]
ds_read_b64_tr_b16 a[48:49], v12 offset:4096
v_mfma_f32_16x16x32_bf16 v[68:71], a[20:23], a[68:71], v[68:71]
ds_read_b64_tr_b16 a[50:51], v12 offset:4608
v_mfma_f32_16x16x32_bf16 v[92:95], a[24:27], a[68:71], v[92:95]
ds_read_b64_tr_b16 a[52:53], v13 offset:4096
v_mfma_f32_16x16x32_bf16 v[116:119], a[28:31], a[68:71], v[116:119]
ds_read_b64_tr_b16 a[54:55], v13 offset:4608
v_mfma_f32_16x16x32_bf16 v[48:51], a[16:19], a[72:75], v[48:51]
v_mfma_f32_16x16x32_bf16 v[72:75], a[20:23], a[72:75], v[72:75]
v_mfma_f32_16x16x32_bf16 v[96:99], a[24:27], a[72:75], v[96:99]
v_mfma_f32_16x16x32_bf16 v[120:123], a[28:31], a[72:75], v[120:123]
v_mfma_f32_16x16x32_bf16 v[52:55], a[16:19], a[76:79], v[52:55]
v_mfma_f32_16x16x32_bf16 v[76:79], a[20:23], a[76:79], v[76:79]
v_mfma_f32_16x16x32_bf16 v[100:103], a[24:27], a[76:79], v[100:103]
v_mfma_f32_16x16x32_bf16 v[124:127], a[28:31], a[76:79], v[124:127]
s_waitcnt lgkmcnt(0)
v_mfma_f32_16x16x32_bf16 v[32:35], a[32:35], a[0:3], v[32:35]
ds_read_b128 a[16:19], v11 offset:57344
v_mfma_f32_16x16x32_bf16 v[56:59], a[32:35], a[4:7], v[56:59]
ds_read_b64_tr_b16 a[56:57], v12 offset:12288
v_mfma_f32_16x16x32_bf16 v[80:83], a[32:35], a[8:11], v[80:83]
ds_read_b64_tr_b16 a[58:59], v12 offset:12800
v_mfma_f32_16x16x32_bf16 v[104:107], a[32:35], a[12:15], v[104:107]
ds_read_b128 a[20:23], v11 offset:59392
v_mfma_f32_16x16x32_bf16 v[36:39], a[36:39], a[0:3], v[36:39]
ds_read_b128 a[24:27], v11 offset:61440
v_mfma_f32_16x16x32_bf16 v[60:63], a[36:39], a[4:7], v[60:63]
ds_read_b128 a[28:31], v11 offset:63488
v_mfma_f32_16x16x32_bf16 v[84:87], a[36:39], a[8:11], v[84:87]
ds_read_b64_tr_b16 a[60:61], v13 offset:12288
v_mfma_f32_16x16x32_bf16 v[108:111], a[36:39], a[12:15], v[108:111]
ds_read_b64_tr_b16 a[62:63], v13 offset:12800
v_mfma_f32_16x16x32_bf16 v[40:43], a[0:3], a[40:43], v[40:43]
ds_read_b64_tr_b16 a[64:65], v12 offset:14336
v_mfma_f32_16x16x32_bf16 v[64:67], a[4:7], a[40:43], v[64:67]
ds_read_b64_tr_b16 a[66:67], v12 offset:14848
v_mfma_f32_16x16x32_bf16 v[88:91], a[8:11], a[40:43], v[88:91]
ds_read_b64_tr_b16 a[68:69], v13 offset:14336
v_mfma_f32_16x16x32_bf16 v[112:115], a[12:15], a[40:43], v[112:115]
ds_read_b64_tr_b16 a[70:71], v13 offset:14848
v_mfma_f32_16x16x32_bf16 v[44:47], a[0:3], a[44:47], v[44:47]
ds_read_b64_tr_b16 a[72:73], v12 offset:16384
v_mfma_f32_16x16x32_bf16 v[68:71], a[4:7], a[44:47], v[68:71]
ds_read_b64_tr_b16 a[74:75], v12 offset:16896
v_mfma_f32_16x16x32_bf16 v[92:95], a[8:11], a[44:47], v[92:95]
ds_read_b64_tr_b16 a[76:77], v13 offset:16384
v_mfma_f32_16x16x32_bf16 v[116:119], a[12:15], a[44:47], v[116:119]
ds_read_b64_tr_b16 a[78:79], v13 offset:16896
v_mfma_f32_16x16x32_bf16 v[48:51], a[0:3], a[48:51], v[48:51]
v_mfma_f32_16x16x32_bf16 v[72:75], a[4:7], a[48:51], v[72:75]
v_mfma_f32_16x16x32_bf16 v[96:99], a[8:11], a[48:51], v[96:99]
v_mfma_f32_16x16x32_bf16 v[120:123], a[12:15], a[48:51], v[120:123]
v_mfma_f32_16x16x32_bf16 v[52:55], a[0:3], a[52:55], v[52:55]
v_mfma_f32_16x16x32_bf16 v[76:79], a[4:7], a[52:55], v[76:79]
v_mfma_f32_16x16x32_bf16 v[100:103], a[8:11], a[52:55], v[100:103]
v_mfma_f32_16x16x32_bf16 v[124:127], a[12:15], a[52:55], v[124:127]
s_waitcnt lgkmcnt(0)
v_mfma_f32_16x16x32_bf16 v[32:35], a[56:59], a[16:19], v[32:35]
s_barrier
ds_read_b128 a[0:3], v10 offset:40960
v_mfma_f32_16x16x32_bf16 v[56:59], a[56:59], a[20:23], v[56:59]
ds_read_b64_tr_b16 a[32:33], v14 offset:16384
v_mfma_f32_16x16x32_bf16 v[80:83], a[56:59], a[24:27], v[80:83]
ds_read_b64_tr_b16 a[34:35], v14 offset:16896
v_mfma_f32_16x16x32_bf16 v[104:107], a[56:59], a[28:31], v[104:107]
ds_read_b128 a[4:7], v10 offset:43008
v_mfma_f32_16x16x32_bf16 v[36:39], a[60:63], a[16:19], v[36:39]
ds_read_b128 a[8:11], v10 offset:45056
v_mfma_f32_16x16x32_bf16 v[60:63], a[60:63], a[20:23], v[60:63]
ds_read_b128 a[12:15], v10 offset:47104
v_mfma_f32_16x16x32_bf16 v[84:87], a[60:63], a[24:27], v[84:87]
ds_read_b64_tr_b16 a[36:37], v15 offset:16384
v_mfma_f32_16x16x32_bf16 v[108:111], a[60:63], a[28:31], v[108:111]
ds_read_b64_tr_b16 a[38:39], v15 offset:16896
v_mfma_f32_16x16x32_bf16 v[40:43], a[16:19], a[64:67], v[40:43]
ds_read_b64_tr_b16 a[40:41], v14 offset:18432
v_mfma_f32_16x16x32_bf16 v[64:67], a[20:23], a[64:67], v[64:67]
ds_read_b64_tr_b16 a[42:43], v14 offset:18944
v_mfma_f32_16x16x32_bf16 v[88:91], a[24:27], a[64:67], v[88:91]
ds_read_b64_tr_b16 a[44:45], v15 offset:18432
v_mfma_f32_16x16x32_bf16 v[112:115], a[28:31], a[64:67], v[112:115]
ds_read_b64_tr_b16 a[46:47], v15 offset:18944
v_mfma_f32_16x16x32_bf16 v[44:47], a[16:19], a[68:71], v[44:47]
ds_read_b64_tr_b16 a[48:49], v14 offset:20480
v_mfma_f32_16x16x32_bf16 v[68:71], a[20:23], a[68:71], v[68:71]
ds_read_b64_tr_b16 a[50:51], v14 offset:20992
v_mfma_f32_16x16x32_bf16 v[92:95], a[24:27], a[68:71], v[92:95]
ds_read_b64_tr_b16 a[52:53], v15 offset:20480
v_mfma_f32_16x16x32_bf16 v[116:119], a[28:31], a[68:71], v[116:119]
ds_read_b64_tr_b16 a[54:55], v15 offset:20992
v_mfma_f32_16x16x32_bf16 v[48:51], a[16:19], a[72:75], v[48:51]
v_mfma_f32_16x16x32_bf16 v[72:75], a[20:23], a[72:75], v[72:75]
v_mfma_f32_16x16x32_bf16 v[96:99], a[24:27], a[72:75], v[96:99]
v_mfma_f32_16x16x32_bf16 v[120:123], a[28:31], a[72:75], v[120:123]
v_mfma_f32_16x16x32_bf16 v[52:55], a[16:19], a[76:79], v[52:55]
v_mfma_f32_16x16x32_bf16 v[76:79], a[20:23], a[76:79], v[76:79]
v_mfma_f32_16x16x32_bf16 v[100:103], a[24:27], a[76:79], v[100:103]
v_mfma_f32_16x16x32_bf16 v[124:127], a[28:31], a[76:79], v[124:127]
s_waitcnt lgkmcnt(0)
v_mfma_f32_16x16x32_bf16 v[32:35], a[32:35], a[0:3], v[32:35]
ds_read_b128 a[16:19], v11 offset:40960
v_mfma_f32_16x16x32_bf16 v[56:59], a[32:35], a[4:7], v[56:59]
ds_read_b64_tr_b16 a[56:57], v14 offset:28672
v_mfma_f32_16x16x32_bf16 v[80:83], a[32:35], a[8:11], v[80:83]
ds_read_b64_tr_b16 a[58:59], v14 offset:29184
v_mfma_f32_16x16x32_bf16 v[104:107], a[32:35], a[12:15], v[104:107]
ds_read_b128 a[20:23], v11 offset:43008
v_mfma_f32_16x16x32_bf16 v[36:39], a[36:39], a[0:3], v[36:39]
ds_read_b128 a[24:27], v11 offset:45056
v_mfma_f32_16x16x32_bf16 v[60:63], a[36:39], a[4:7], v[60:63]
ds_read_b128 a[28:31], v11 offset:47104
v_mfma_f32_16x16x32_bf16 v[84:87], a[36:39], a[8:11], v[84:87]
ds_read_b64_tr_b16 a[60:61], v15 offset:28672
v_mfma_f32_16x16x32_bf16 v[108:111], a[36:39], a[12:15], v[108:111]
ds_read_b64_tr_b16 a[62:63], v15 offset:29184
v_mfma_f32_16x16x32_bf16 v[40:43], a[0:3], a[40:43], v[40:43]
ds_read_b64_tr_b16 a[64:65], v14 offset:30720
v_mfma_f32_16x16x32_bf16 v[64:67], a[4:7], a[40:43], v[64:67]
ds_read_b64_tr_b16 a[66:67], v14 offset:31232
v_mfma_f32_16x16x32_bf16 v[88:91], a[8:11], a[40:43], v[88:91]
ds_read_b64_tr_b16 a[68:69], v15 offset:30720
v_mfma_f32_16x16x32_bf16 v[112:115], a[12:15], a[40:43], v[112:115]
ds_read_b64_tr_b16 a[70:71], v15 offset:31232
v_mfma_f32_16x16x32_bf16 v[44:47], a[0:3], a[44:47], v[44:47]
ds_read_b64_tr_b16 a[72:73], v14 offset:32768
v_mfma_f32_16x16x32_bf16 v[68:71], a[4:7], a[44:47], v[68:71]
ds_read_b64_tr_b16 a[74:75], v14 offset:33280
v_mfma_f32_16x16x32_bf16 v[92:95], a[8:11], a[44:47], v[92:95]
ds_read_b64_tr_b16 a[76:77], v15 offset:32768
v_mfma_f32_16x16x32_bf16 v[116:119], a[12:15], a[44:47], v[116:119]
ds_read_b64_tr_b16 a[78:79], v15 offset:33280
v_mfma_f32_16x16x32_bf16 v[48:51], a[0:3], a[48:51], v[48:51]
v_mfma_f32_16x16x32_bf16 v[72:75], a[4:7], a[48:51], v[72:75]
v_mfma_f32_16x16x32_bf16 v[96:99], a[8:11], a[48:51], v[96:99]
v_mfma_f32_16x16x32_bf16 v[120:123], a[12:15], a[48:51], v[120:123]
v_mfma_f32_16x16x32_bf16 v[52:55], a[0:3], a[52:55], v[52:55]
v_mfma_f32_16x16x32_bf16 v[76:79], a[4:7], a[52:55], v[76:79]
v_mfma_f32_16x16x32_bf16 v[100:103], a[8:11], a[52:55], v[100:103]
v_mfma_f32_16x16x32_bf16 v[124:127], a[12:15], a[52:55], v[124:127]
s_waitcnt lgkmcnt(0)
v_mfma_f32_16x16x32_bf16 v[32:35], a[56:59], a[16:19], v[32:35]
s_barrier
ds_read_b128 a[0:3], v10 offset:0
v_mfma_f32_16x16x32_bf16 v[56:59], a[56:59], a[20:23], v[56:59]
ds_read_b64_tr_b16 a[32:33], v12 offset:40960
v_mfma_f32_16x16x32_bf16 v[80:83], a[56:59], a[24:27], v[80:83]
ds_read_b64_tr_b16 a[34:35], v12 offset:41472
v_mfma_f32_16x16x32_bf16 v[104:107], a[56:59], a[28:31], v[104:107]
ds_read_b128 a[4:7], v10 offset:2048
v_mfma_f32_16x16x32_bf16 v[36:39], a[60:63], a[16:19], v[36:39]
ds_read_b128 a[8:11], v10 offset:4096
v_mfma_f32_16x16x32_bf16 v[60:63], a[60:63], a[20:23], v[60:63]
ds_read_b128 a[12:15], v10 offset:6144
v_mfma_f32_16x16x32_bf16 v[84:87], a[60:63], a[24:27], v[84:87]
ds_read_b64_tr_b16 a[36:37], v13 offset:40960
v_mfma_f32_16x16x32_bf16 v[108:111], a[60:63], a[28:31], v[108:111]
ds_read_b64_tr_b16 a[38:39], v13 offset:41472
v_mfma_f32_16x16x32_bf16 v[40:43], a[16:19], a[64:67], v[40:43]
ds_read_b64_tr_b16 a[40:41], v12 offset:43008
v_mfma_f32_16x16x32_bf16 v[64:67], a[20:23], a[64:67], v[64:67]
ds_read_b64_tr_b16 a[42:43], v12 offset:43520
v_mfma_f32_16x16x32_bf16 v[88:91], a[24:27], a[64:67], v[88:91]
ds_read_b64_tr_b16 a[44:45], v13 offset:43008
v_mfma_f32_16x16x32_bf16 v[112:115], a[28:31], a[64:67], v[112:115]
ds_read_b64_tr_b16 a[46:47], v13 offset:43520
v_mfma_f32_16x16x32_bf16 v[44:47], a[16:19], a[68:71], v[44:47]
ds_read_b64_tr_b16 a[48:49], v12 offset:45056
v_mfma_f32_16x16x32_bf16 v[68:71], a[20:23], a[68:71], v[68:71]
ds_read_b64_tr_b16 a[50:51], v12 offset:45568
v_mfma_f32_16x16x32_bf16 v[92:95], a[24:27], a[68:71], v[92:95]
ds_read_b64_tr_b16 a[52:53], v13 offset:45056
v_mfma_f32_16x16x32_bf16 v[116:119], a[28:31], a[68:71], v[116:119]
ds_read_b64_tr_b16 a[54:55], v13 offset:45568
v_mfma_f32_16x16x32_bf16 v[48:51], a[16:19], a[72:75], v[48:51]
v_mfma_f32_16x16x32_bf16 v[72:75], a[20:23], a[72:75], v[72:75]
v_mfma_f32_16x16x32_bf16 v[96:99], a[24:27], a[72:75], v[96:99]
v_mfma_f32_16x16x32_bf16 v[120:123], a[28:31], a[72:75], v[120:123]
v_mfma_f32_16x16x32_bf16 v[52:55], a[16:19], a[76:79], v[52:55]
v_mfma_f32_16x16x32_bf16 v[76:79], a[20:23], a[76:79], v[76:79]
v_mfma_f32_16x16x32_bf16 v[100:103], a[24:27], a[76:79], v[100:103]
v_mfma_f32_16x16x32_bf16 v[124:127], a[28:31], a[76:79], v[124:127]
s_waitcnt lgkmcnt(0)
v_mfma_f32_16x16x32_bf16 v[32:35], a[32:35], a[0:3], v[32:35]
ds_read_b128 a[16:19], v11 offset:0
v_mfma_f32_16x16x32_bf16 v[56:59], a[32:35], a[4:7], v[56:59]
ds_read_b64_tr_b16 a[56:57], v12 offset:53248
v_mfma_f32_16x16x32_bf16 v[80:83], a[32:35], a[8:11], v[80:83]
ds_read_b64_tr_b16 a[58:59], v12 offset:53760
v_mfma_f32_16x16x32_bf16 v[104:107], a[32:35], a[12:15], v[104:107]
ds_read_b128 a[20:23], v11 offset:2048
v_mfma_f32_16x16x32_bf16 v[36:39], a[36:39], a[0:3], v[36:39]
ds_read_b128 a[24:27], v11 offset:4096
v_mfma_f32_16x16x32_bf16 v[60:63], a[36:39], a[4:7], v[60:63]
ds_read_b128 a[28:31], v11 offset:6144
v_mfma_f32_16x16x32_bf16 v[84:87], a[36:39], a[8:11], v[84:87]
ds_read_b64_tr_b16 a[60:61], v13 offset:53248
v_mfma_f32_16x16x32_bf16 v[108:111], a[36:39], a[12:15], v[108:111]
ds_read_b64_tr_b16 a[62:63], v13 offset:53760
v_mfma_f32_16x16x32_bf16 v[40:43], a[0:3], a[40:43], v[40:43]
ds_read_b64_tr_b16 a[64:65], v12 offset:55296
v_mfma_f32_16x16x32_bf16 v[64:67], a[4:7], a[40:43], v[64:67]
ds_read_b64_tr_b16 a[66:67], v12 offset:55808
v_mfma_f32_16x16x32_bf16 v[88:91], a[8:11], a[40:43], v[88:91]
ds_read_b64_tr_b16 a[68:69], v13 offset:55296
v_mfma_f32_16x16x32_bf16 v[112:115], a[12:15], a[40:43], v[112:115]
ds_read_b64_tr_b16 a[70:71], v13 offset:55808
v_mfma_f32_16x16x32_bf16 v[44:47], a[0:3], a[44:47], v[44:47]
ds_read_b64_tr_b16 a[72:73], v12 offset:57344
v_mfma_f32_16x16x32_bf16 v[68:71], a[4:7], a[44:47], v[68:71]
ds_read_b64_tr_b16 a[74:75], v12 offset:57856
v_mfma_f32_16x16x32_bf16 v[92:95], a[8:11], a[44:47], v[92:95]
ds_read_b64_tr_b16 a[76:77], v13 offset:57344
v_mfma_f32_16x16x32_bf16 v[116:119], a[12:15], a[44:47], v[116:119]
ds_read_b64_tr_b16 a[78:79], v13 offset:57856
v_mfma_f32_16x16x32_bf16 v[48:51], a[0:3], a[48:51], v[48:51]
v_lshrrev_b32 v2, 4, v1
v_lshlrev_b32 v2, 4, v2
s_lshl_b32 s70, s66, 8
s_add_u32 s70, s70, 159744
v_add_u32 v17, s70, v2
v_mfma_f32_16x16x32_bf16 v[72:75], a[4:7], a[48:51], v[72:75]
v_mfma_f32_16x16x32_bf16 v[96:99], a[8:11], a[48:51], v[96:99]
v_and_b32 v2, 15, v1
v_lshlrev_b32 v2, 2, v2
s_lshl_b32 s70, s67, 7
s_add_u32 s70, s70, 160768
v_add_u32 v18, s70, v2
v_mfma_f32_16x16x32_bf16 v[120:123], a[12:15], a[48:51], v[120:123]
v_mfma_f32_16x16x32_bf16 v[52:55], a[0:3], a[52:55], v[52:55]
v_mfma_f32_16x16x32_bf16 v[76:79], a[4:7], a[52:55], v[76:79]
v_mfma_f32_16x16x32_bf16 v[100:103], a[8:11], a[52:55], v[100:103]
v_mfma_f32_16x16x32_bf16 v[124:127], a[12:15], a[52:55], v[124:127]
s_waitcnt lgkmcnt(0)
v_mfma_f32_16x16x32_bf16 v[32:35], a[56:59], a[16:19], v[32:35]
s_barrier
ds_read_b128 a[0:3], v8 offset:24576
v_mfma_f32_16x16x32_bf16 v[56:59], a[56:59], a[20:23], v[56:59]
ds_read_b64_tr_b16 a[32:33], v12 offset:0
v_mfma_f32_16x16x32_bf16 v[80:83], a[56:59], a[24:27], v[80:83]
ds_read_b64_tr_b16 a[34:35], v12 offset:512
v_mfma_f32_16x16x32_bf16 v[104:107], a[56:59], a[28:31], v[104:107]
ds_read_b128 a[4:7], v8 offset:26624
v_mfma_f32_16x16x32_bf16 v[36:39], a[60:63], a[16:19], v[36:39]
ds_read_b128 a[8:11], v8 offset:28672
v_mfma_f32_16x16x32_bf16 v[60:63], a[60:63], a[20:23], v[60:63]
ds_read_b128 a[12:15], v8 offset:30720
v_mfma_f32_16x16x32_bf16 v[84:87], a[60:63], a[24:27], v[84:87]
ds_read_b64_tr_b16 a[36:37], v13 offset:0
v_mfma_f32_16x16x32_bf16 v[108:111], a[60:63], a[28:31], v[108:111]
ds_read_b64_tr_b16 a[38:39], v13 offset:512
v_mfma_f32_16x16x32_bf16 v[40:43], a[16:19], a[64:67], v[40:43]
ds_read_b64_tr_b16 a[40:41], v12 offset:2048
v_mfma_f32_16x16x32_bf16 v[64:67], a[20:23], a[64:67], v[64:67]
ds_read_b64_tr_b16 a[42:43], v12 offset:2560
v_mfma_f32_16x16x32_bf16 v[88:91], a[24:27], a[64:67], v[88:91]
ds_read_b64_tr_b16 a[44:45], v13 offset:2048
v_mfma_f32_16x16x32_bf16 v[112:115], a[28:31], a[64:67], v[112:115]
ds_read_b64_tr_b16 a[46:47], v13 offset:2560
v_mfma_f32_16x16x32_bf16 v[44:47], a[16:19], a[68:71], v[44:47]
ds_read_b64_tr_b16 a[48:49], v12 offset:4096
v_mfma_f32_16x16x32_bf16 v[68:71], a[20:23], a[68:71], v[68:71]
ds_read_b64_tr_b16 a[50:51], v12 offset:4608
v_mfma_f32_16x16x32_bf16 v[92:95], a[24:27], a[68:71], v[92:95]
ds_read_b64_tr_b16 a[52:53], v13 offset:4096
v_mfma_f32_16x16x32_bf16 v[116:119], a[28:31], a[68:71], v[116:119]
ds_read_b64_tr_b16 a[54:55], v13 offset:4608
v_mfma_f32_16x16x32_bf16 v[48:51], a[16:19], a[72:75], v[48:51]
v_mfma_f32_16x16x32_bf16 v[72:75], a[20:23], a[72:75], v[72:75]
v_mfma_f32_16x16x32_bf16 v[96:99], a[24:27], a[72:75], v[96:99]
v_mfma_f32_16x16x32_bf16 v[120:123], a[28:31], a[72:75], v[120:123]
v_mfma_f32_16x16x32_bf16 v[52:55], a[16:19], a[76:79], v[52:55]
v_mfma_f32_16x16x32_bf16 v[76:79], a[20:23], a[76:79], v[76:79]
v_mfma_f32_16x16x32_bf16 v[100:103], a[24:27], a[76:79], v[100:103]
v_mfma_f32_16x16x32_bf16 v[124:127], a[28:31], a[76:79], v[124:127]
s_waitcnt lgkmcnt(0)
v_mfma_f32_16x16x32_bf16 v[32:35], a[32:35], a[0:3], v[32:35]
ds_read_b128 a[16:19], v9 offset:24576
v_mfma_f32_16x16x32_bf16 v[56:59], a[32:35], a[4:7], v[56:59]
ds_read_b64_tr_b16 a[56:57], v12 offset:12288
v_mfma_f32_16x16x32_bf16 v[80:83], a[32:35], a[8:11], v[80:83]
ds_read_b64_tr_b16 a[58:59], v12 offset:12800
v_mfma_f32_16x16x32_bf16 v[104:107], a[32:35], a[12:15], v[104:107]
ds_read_b128 a[20:23], v9 offset:26624
v_mfma_f32_16x16x32_bf16 v[36:39], a[36:39], a[0:3], v[36:39]
ds_read_b128 a[24:27], v9 offset:28672
v_mfma_f32_16x16x32_bf16 v[60:63], a[36:39], a[4:7], v[60:63]
ds_read_b128 a[28:31], v9 offset:30720
v_mfma_f32_16x16x32_bf16 v[84:87], a[36:39], a[8:11], v[84:87]
ds_read_b64_tr_b16 a[60:61], v13 offset:12288
v_mfma_f32_16x16x32_bf16 v[108:111], a[36:39], a[12:15], v[108:111]
ds_read_b64_tr_b16 a[62:63], v13 offset:12800
v_mfma_f32_16x16x32_bf16 v[40:43], a[0:3], a[40:43], v[40:43]
ds_read_b64_tr_b16 a[64:65], v12 offset:14336
v_mfma_f32_16x16x32_bf16 v[64:67], a[4:7], a[40:43], v[64:67]
ds_read_b64_tr_b16 a[66:67], v12 offset:14848
v_mfma_f32_16x16x32_bf16 v[88:91], a[8:11], a[40:43], v[88:91]
ds_read_b64_tr_b16 a[68:69], v13 offset:14336
v_mfma_f32_16x16x32_bf16 v[112:115], a[12:15], a[40:43], v[112:115]
ds_read_b64_tr_b16 a[70:71], v13 offset:14848
v_mfma_f32_16x16x32_bf16 v[44:47], a[0:3], a[44:47], v[44:47]
ds_read_b64_tr_b16 a[72:73], v12 offset:16384
v_mfma_f32_16x16x32_bf16 v[68:71], a[4:7], a[44:47], v[68:71]
ds_read_b64_tr_b16 a[74:75], v12 offset:16896
v_mfma_f32_16x16x32_bf16 v[92:95], a[8:11], a[44:47], v[92:95]
ds_read_b64_tr_b16 a[76:77], v13 offset:16384
v_mfma_f32_16x16x32_bf16 v[116:119], a[12:15], a[44:47], v[116:119]
ds_read_b64_tr_b16 a[78:79], v13 offset:16896
v_mfma_f32_16x16x32_bf16 v[48:51], a[0:3], a[48:51], v[48:51]
v_mfma_f32_16x16x32_bf16 v[72:75], a[4:7], a[48:51], v[72:75]
v_mfma_f32_16x16x32_bf16 v[96:99], a[8:11], a[48:51], v[96:99]
v_mfma_f32_16x16x32_bf16 v[120:123], a[12:15], a[48:51], v[120:123]
v_mfma_f32_16x16x32_bf16 v[52:55], a[0:3], a[52:55], v[52:55]
v_mfma_f32_16x16x32_bf16 v[76:79], a[4:7], a[52:55], v[76:79]
v_mfma_f32_16x16x32_bf16 v[100:103], a[8:11], a[52:55], v[100:103]
v_mfma_f32_16x16x32_bf16 v[124:127], a[12:15], a[52:55], v[124:127]
s_waitcnt lgkmcnt(0)
v_mfma_f32_16x16x32_bf16 v[40:43], a[16:19], a[64:67], v[40:43]
s_barrier
ds_read_b128 v[20:23], v17 offset:0
v_mfma_f32_16x16x32_bf16 v[64:67], a[20:23], a[64:67], v[64:67]
ds_read_b128 v[24:27], v17 offset:512
v_mfma_f32_16x16x32_bf16 v[88:91], a[24:27], a[64:67], v[88:91]
ds_read_b32 v6, v18 offset:256
v_mfma_f32_16x16x32_bf16 v[112:115], a[28:31], a[64:67], v[112:115]
ds_read_b32 v8, v18 offset:320
v_mfma_f32_16x16x32_bf16 v[44:47], a[16:19], a[68:71], v[44:47]
ds_read_b32 v10, v18 offset:512
v_mfma_f32_16x16x32_bf16 v[68:71], a[20:23], a[68:71], v[68:71]
ds_read_b32 v18, v18 offset:576
v_mfma_f32_16x16x32_bf16 v[92:95], a[24:27], a[68:71], v[92:95]
v_mov_b32 v19, 161536
ds_read_b32 v19, v19
v_mfma_f32_16x16x32_bf16 v[116:119], a[28:31], a[68:71], v[116:119]
ds_read_b128 v[128:131], v17 offset:64
v_mfma_f32_16x16x32_bf16 v[48:51], a[16:19], a[72:75], v[48:51]
ds_read_b128 v[132:135], v17 offset:576
v_mfma_f32_16x16x32_bf16 v[72:75], a[20:23], a[72:75], v[72:75]
ds_read_b128 v[136:139], v17 offset:128
v_mfma_f32_16x16x32_bf16 v[96:99], a[24:27], a[72:75], v[96:99]
ds_read_b128 v[140:143], v17 offset:640
v_mfma_f32_16x16x32_bf16 v[120:123], a[28:31], a[72:75], v[120:123]
ds_read_b128 v[144:147], v17 offset:192
s_branch L_over5
L_pad5:
s_branch L_ret4
L_over5:
v_mfma_f32_16x16x32_bf16 v[52:55], a[16:19], a[76:79], v[52:55]
ds_read_b128 v[148:151], v17 offset:704
v_mfma_f32_16x16x32_bf16 v[76:79], a[20:23], a[76:79], v[76:79]
v_mfma_f32_16x16x32_bf16 v[100:103], a[24:27], a[76:79], v[100:103]
v_mfma_f32_16x16x32_bf16 v[124:127], a[28:31], a[76:79], v[124:127]
v_mfma_f32_16x16x32_bf16 v[32:35], a[56:59], a[16:19], v[32:35]
v_mfma_f32_16x16x32_bf16 v[56:59], a[56:59], a[20:23], v[56:59]
v_mfma_f32_16x16x32_bf16 v[80:83], a[56:59], a[24:27], v[80:83]
v_mfma_f32_16x16x32_bf16 v[104:107], a[56:59], a[28:31], v[104:107]
v_mfma_f32_16x16x32_bf16 v[36:39], a[60:63], a[16:19], v[36:39]
v_mfma_f32_16x16x32_bf16 v[60:63], a[60:63], a[20:23], v[60:63]
v_mfma_f32_16x16x32_bf16 v[84:87], a[60:63], a[24:27], v[84:87]
v_mfma_f32_16x16x32_bf16 v[108:111], a[60:63], a[28:31], v[108:111]
s_waitcnt lgkmcnt(0)
v_readfirstlane_b32 s69, v19
s_nop 0
s_and_b32 s61, s69, 0x2000
s_and_b32 s69, s69, 1
s_xor_b32 s88, s88, s61
v_pk_mul_f32 v[28:29], v[24:25], s[90:91]
v_pk_mul_f32 v[30:31], v[26:27], s[90:91]
v_pk_fma_f32 v[40:41], v[20:21], v[6:7], v[40:41] op_sel:[0,0,0] op_sel_hi:[1,0,1]
v_pk_fma_f32 v[44:45], v[20:21], v[8:9], v[44:45] op_sel:[0,0,0] op_sel_hi:[1,0,1]
v_pk_fma_f32 v[42:43], v[22:23], v[6:7], v[42:43] op_sel:[0,0,0] op_sel_hi:[1,0,1]
v_pk_fma_f32 v[46:47], v[22:23], v[8:9], v[46:47] op_sel:[0,0,0] op_sel_hi:[1,0,1]
v_pk_mul_f32 v[2:3], v[40:41], v[28:29]
v_pk_mul_f32 v[12:13], v[44:45], v[28:29]
v_pk_mul_f32 v[4:5], v[42:43], v[30:31]
v_pk_mul_f32 v[14:15], v[46:47], v[30:31]
v_pk_fma_f32 v[40:41], v[40:41], v[24:25], s[82:83]
v_pk_fma_f32 v[44:45], v[44:45], v[24:25], s[82:83]
v_pk_fma_f32 v[42:43], v[42:43], v[26:27], s[82:83]
v_pk_fma_f32 v[46:47], v[46:47], v[26:27], s[82:83]
v_exp_f32_e64 v2, v2 clamp
v_exp_f32_e64 v12, v12 clamp
v_exp_f32_e64 v3, v3 clamp
v_exp_f32_e64 v13, v13 clamp
v_exp_f32_e64 v4, v4 clamp
v_exp_f32_e64 v14, v14 clamp
v_exp_f32_e64 v5, v5 clamp
v_exp_f32_e64 v15, v15 clamp
v_pk_add_f32 v[2:3], v[2:3], s[80:81]
v_pk_add_f32 v[12:13], v[12:13], s[80:81]
v_pk_add_f32 v[4:5], v[4:5], s[80:81]
v_pk_add_f32 v[14:15], v[14:15], s[80:81]
v_max_f32 v40, v40, v2
v_max_f32 v44, v44, v12
v_max_f32 v41, v41, v3
v_max_f32 v45, v45, v13
v_max_f32 v42, v42, v4
v_max_f32 v46, v46, v14
v_max_f32 v43, v43, v5
v_max_f32 v47, v47, v15
v_cvt_pk_bf16_f32 v40, v40, v41
v_cvt_pk_bf16_f32 v44, v44, v45
v_cvt_pk_bf16_f32 v41, v42, v43
v_cvt_pk_bf16_f32 v45, v46, v47
v_pk_fma_f32 v[48:49], v[20:21], v[10:11], v[48:49] op_sel:[0,0,0] op_sel_hi:[1,0,1]
v_pk_fma_f32 v[52:53], v[20:21], v[18:19], v[52:53] op_sel:[0,0,0] op_sel_hi:[1,0,1]
v_pk_fma_f32 v[50:51], v[22:23], v[10:11], v[50:51] op_sel:[0,0,0] op_sel_hi:[1,0,1]
v_pk_fma_f32 v[54:55], v[22:23], v[18:19], v[54:55] op_sel:[0,0,0] op_sel_hi:[1,0,1]
v_pk_mul_f32 v[48:49], v[48:49], v[24:25]
v_pk_mul_f32 v[52:53], v[52:53], v[24:25]
v_pk_mul_f32 v[50:51], v[50:51], v[26:27]
v_pk_mul_f32 v[54:55], v[54:55], v[26:27]
v_cvt_pk_bf16_f32 v48, v48, v49
v_cvt_pk_bf16_f32 v52, v52, v53
v_cvt_pk_bf16_f32 v49, v50, v51
v_cvt_pk_bf16_f32 v53, v54, v55
v_pk_mul_f32 v[28:29], v[132:133], s[90:91]
v_pk_mul_f32 v[30:31], v[134:135], s[90:91]
v_pk_fma_f32 v[64:65], v[128:129], v[6:7], v[64:65] op_sel:[0,0,0] op_sel_hi:[1,0,1]
v_pk_fma_f32 v[68:69], v[128:129], v[8:9], v[68:69] op_sel:[0,0,0] op_sel_hi:[1,0,1]
v_pk_fma_f32 v[66:67], v[130:131], v[6:7], v[66:67] op_sel:[0,0,0] op_sel_hi:[1,0,1]
v_pk_fma_f32 v[70:71], v[130:131], v[8:9], v[70:71] op_sel:[0,0,0] op_sel_hi:[1,0,1]
v_pk_mul_f32 v[2:3], v[64:65], v[28:29]
v_pk_mul_f32 v[12:13], v[68:69], v[28:29]
v_pk_mul_f32 v[4:5], v[66:67], v[30:31]
v_pk_mul_f32 v[14:15], v[70:71], v[30:31]
v_pk_fma_f32 v[64:65], v[64:65], v[132:133], s[82:83]
v_pk_fma_f32 v[68:69], v[68:69], v[132:133], s[82:83]
v_pk_fma_f32 v[66:67], v[66:67], v[134:135], s[82:83]
v_pk_fma_f32 v[70:71], v[70:71], v[134:135], s[82:83]
v_exp_f32_e64 v2, v2 clamp
v_exp_f32_e64 v12, v12 clamp
v_exp_f32_e64 v3, v3 clamp
v_exp_f32_e64 v13, v13 clamp
v_exp_f32_e64 v4, v4 clamp
v_exp_f32_e64 v14, v14 clamp
v_exp_f32_e64 v5, v5 clamp
v_exp_f32_e64 v15, v15 clamp
v_pk_add_f32 v[2:3], v[2:3], s[80:81]
v_pk_add_f32 v[12:13], v[12:13], s[80:81]
v_pk_add_f32 v[4:5], v[4:5], s[80:81]
v_pk_add_f32 v[14:15], v[14:15], s[80:81]
v_max_f32 v64, v64, v2
v_max_f32 v68, v68, v12
v_max_f32 v65, v65, v3
v_max_f32 v69, v69, v13
v_max_f32 v66, v66, v4
v_max_f32 v70, v70, v14
v_max_f32 v67, v67, v5
v_max_f32 v71, v71, v15
v_cvt_pk_bf16_f32 v42, v64, v65
v_cvt_pk_bf16_f32 v46, v68, v69
v_cvt_pk_bf16_f32 v43, v66, v67
v_cvt_pk_bf16_f32 v47, v70, v71
v_pk_fma_f32 v[72:73], v[128:129], v[10:11], v[72:73] op_sel:[0,0,0] op_sel_hi:[1,0,1]
v_pk_fma_f32 v[76:77], v[128:129], v[18:19], v[76:77] op_sel:[0,0,0] op_sel_hi:[1,0,1]
v_pk_fma_f32 v[74:75], v[130:131], v[10:11], v[74:75] op_sel:[0,0,0] op_sel_hi:[1,0,1]
v_pk_fma_f32 v[78:79], v[130:131], v[18:19], v[78:79] op_sel:[0,0,0] op_sel_hi:[1,0,1]
v_pk_mul_f32 v[72:73], v[72:73], v[132:133]
v_pk_mul_f32 v[76:77], v[76:77], v[132:133]
v_pk_mul_f32 v[74:75], v[74:75], v[134:135]
v_pk_mul_f32 v[78:79], v[78:79], v[134:135]
v_cvt_pk_bf16_f32 v50, v72, v73
v_cvt_pk_bf16_f32 v54, v76, v77
v_cvt_pk_bf16_f32 v51, v74, v75
v_cvt_pk_bf16_f32 v55, v78, v79
s_nop 0
v_mfma_f32_16x16x32_bf16 v[64:67], v[40:43], v[48:51], 0
v_mfma_f32_16x16x32_bf16 v[68:71], v[40:43], v[52:55], 0
v_mfma_f32_16x16x32_bf16 v[20:23], v[40:43], a[80:83], 0
v_mfma_f32_16x16x32_bf16 v[72:75], v[44:47], v[48:51], 0
v_mfma_f32_16x16x32_bf16 v[76:79], v[44:47], v[52:55], 0
v_mfma_f32_16x16x32_bf16 v[24:27], v[44:47], a[80:83], 0
v_pk_mul_f32 v[28:29], v[140:141], s[90:91]
v_pk_mul_f32 v[30:31], v[142:143], s[90:91]
v_pk_fma_f32 v[88:89], v[136:137], v[6:7], v[88:89] op_sel:[0,0,0] op_sel_hi:[1,0,1]
v_pk_fma_f32 v[92:93], v[136:137], v[8:9], v[92:93] op_sel:[0,0,0] op_sel_hi:[1,0,1]
v_pk_fma_f32 v[90:91], v[138:139], v[6:7], v[90:91] op_sel:[0,0,0] op_sel_hi:[1,0,1]
v_pk_fma_f32 v[94:95], v[138:139], v[8:9], v[94:95] op_sel:[0,0,0] op_sel_hi:[1,0,1]
v_pk_mul_f32 v[2:3], v[88:89], v[28:29]
v_pk_mul_f32 v[12:13], v[92:93], v[28:29]
v_pk_mul_f32 v[4:5], v[90:91], v[30:31]
v_pk_mul_f32 v[14:15], v[94:95], v[30:31]
v_pk_fma_f32 v[88:89], v[88:89], v[140:141], s[82:83]
v_pk_fma_f32 v[92:93], v[92:93], v[140:141], s[82:83]
v_pk_fma_f32 v[90:91], v[90:91], v[142:143], s[82:83]
v_pk_fma_f32 v[94:95], v[94:95], v[142:143], s[82:83]
v_exp_f32_e64 v2, v2 clamp
v_exp_f32_e64 v12, v12 clamp
v_exp_f32_e64 v3, v3 clamp
v_exp_f32_e64 v13, v13 clamp
v_exp_f32_e64 v4, v4 clamp
v_exp_f32_e64 v14, v14 clamp
v_exp_f32_e64 v5, v5 clamp
v_exp_f32_e64 v15, v15 clamp
v_pk_add_f32 v[2:3], v[2:3], s[80:81]
v_pk_add_f32 v[12:13], v[12:13], s[80:81]
v_pk_add_f32 v[4:5], v[4:5], s[80:81]
v_pk_add_f32 v[14:15], v[14:15], s[80:81]
v_max_f32 v88, v88, v2
v_max_f32 v92, v92, v12
v_max_f32 v89, v89, v3
v_max_f32 v93, v93, v13
v_max_f32 v90, v90, v4
v_max_f32 v94, v94, v14
v_max_f32 v91, v91, v5
v_max_f32 v95, v95, v15
v_cvt_pk_bf16_f32 v88, v88, v89
v_cvt_pk_bf16_f32 v92, v92, v93
v_cvt_pk_bf16_f32 v89, v90, v91
v_cvt_pk_bf16_f32 v93, v94, v95
v_pk_fma_f32 v[96:97], v[136:137], v[10:11], v[96:97] op_sel:[0,0,0] op_sel_hi:[1,0,1]
v_pk_fma_f32 v[100:101], v[136:137], v[18:19], v[100:101] op_sel:[0,0,0] op_sel_hi:[1,0,1]
v_pk_fma_f32 v[98:99], v[138:139], v[10:11], v[98:99] op_sel:[0,0,0] op_sel_hi:[1,0,1]
v_pk_fma_f32 v[102:103], v[138:139], v[18:19], v[102:103] op_sel:[0,0,0] op_sel_hi:[1,0,1]
v_pk_mul_f32 v[96:97], v[96:97], v[140:141]
v_pk_mul_f32 v[100:101], v[100:101], v[140:141]
v_pk_mul_f32 v[98:99], v[98:99], v[142:143]
v_pk_mul_f32 v[102:103], v[102:103], v[142:143]
v_cvt_pk_bf16_f32 v96, v96, v97
v_cvt_pk_bf16_f32 v100, v100, v101
v_cvt_pk_bf16_f32 v97, v98, v99
v_cvt_pk_bf16_f32 v101, v102, v103
v_pk_mul_f32 v[28:29], v[148:149], s[90:91]
v_pk_mul_f32 v[30:31], v[150:151], s[90:91]
v_pk_fma_f32 v[112:113], v[144:145], v[6:7], v[112:113] op_sel:[0,0,0] op_sel_hi:[1,0,1]
v_pk_fma_f32 v[116:117], v[144:145], v[8:9], v[116:117] op_sel:[0,0,0] op_sel_hi:[1,0,1]
v_pk_fma_f32 v[114:115], v[146:147], v[6:7], v[114:115] op_sel:[0,0,0] op_sel_hi:[1,0,1]
v_pk_fma_f32 v[118:119], v[146:147], v[8:9], v[118:119] op_sel:[0,0,0] op_sel_hi:[1,0,1]
v_pk_mul_f32 v[2:3], v[112:113], v[28:29]
v_pk_mul_f32 v[12:13], v[116:117], v[28:29]
v_pk_mul_f32 v[4:5], v[114:115], v[30:31]
v_pk_mul_f32 v[14:15], v[118:119], v[30:31]
v_pk_fma_f32 v[112:113], v[112:113], v[148:149], s[82:83]
v_pk_fma_f32 v[116:117], v[116:117], v[148:149], s[82:83]
v_pk_fma_f32 v[114:115], v[114:115], v[150:151], s[82:83]
v_pk_fma_f32 v[118:119], v[118:119], v[150:151], s[82:83]
v_exp_f32_e64 v2, v2 clamp
v_exp_f32_e64 v12, v12 clamp
v_exp_f32_e64 v3, v3 clamp
v_exp_f32_e64 v13, v13 clamp
v_exp_f32_e64 v4, v4 clamp
v_exp_f32_e64 v14, v14 clamp
v_exp_f32_e64 v5, v5 clamp
v_exp_f32_e64 v15, v15 clamp
v_pk_add_f32 v[2:3], v[2:3], s[80:81]
v_pk_add_f32 v[12:13], v[12:13], s[80:81]
v_pk_add_f32 v[4:5], v[4:5], s[80:81]
v_pk_add_f32 v[14:15], v[14:15], s[80:81]
v_max_f32 v112, v112, v2
v_max_f32 v116, v116, v12
v_max_f32 v113, v113, v3
v_max_f32 v117, v117, v13
v_max_f32 v114, v114, v4
v_max_f32 v118, v118, v14
v_max_f32 v115, v115, v5
v_max_f32 v119, v119, v15
v_cvt_pk_bf16_f32 v90, v112, v113
v_cvt_pk_bf16_f32 v94, v116, v117
v_cvt_pk_bf16_f32 v91, v114, v115
v_cvt_pk_bf16_f32 v95, v118, v119
v_pk_fma_f32 v[120:121], v[144:145], v[10:11], v[120:121] op_sel:[0,0,0] op_sel_hi:[1,0,1]
v_pk_fma_f32 v[124:125], v[144:145], v[18:19], v[124:125] op_sel:[0,0,0] op_sel_hi:[1,0,1]
v_pk_fma_f32 v[122:123], v[146:147], v[10:11], v[122:123] op_sel:[0,0,0] op_sel_hi:[1,0,1]
v_pk_fma_f32 v[126:127], v[146:147], v[18:19], v[126:127] op_sel:[0,0,0] op_sel_hi:[1,0,1]
v_pk_mul_f32 v[120:121], v[120:121], v[148:149]
v_pk_mul_f32 v[124:125], v[124:125], v[148:149]
v_pk_mul_f32 v[122:123], v[122:123], v[150:151]
v_pk_mul_f32 v[126:127], v[126:127], v[150:151]
v_cvt_pk_bf16_f32 v98, v120, v121
v_cvt_pk_bf16_f32 v102, v124, v125
v_cvt_pk_bf16_f32 v99, v122, v123
v_cvt_pk_bf16_f32 v103, v126, v127
s_nop 0
v_mfma_f32_16x16x32_bf16 v[64:67], v[88:91], v[96:99], v[64:67]
v_mfma_f32_16x16x32_bf16 v[68:71], v[88:91], v[100:103], v[68:71]
v_mfma_f32_16x16x32_bf16 v[20:23], v[88:91], a[80:83], v[20:23]
v_mfma_f32_16x16x32_bf16 v[72:75], v[92:95], v[96:99], v[72:75]
v_mfma_f32_16x16x32_bf16 v[76:79], v[92:95], v[100:103], v[76:79]
v_mfma_f32_16x16x32_bf16 v[24:27], v[92:95], a[80:83], v[24:27]
s_lshl_b32 s70, s60, 11
s_add_u32 s70, s70, 16384
v_add_u32 v2, s70, v16
v_xor_b32 v3, 4096, v2
v_lshrrev_b32 v4, 4, v1
v_lshlrev_b32 v5, 4, v4
v_lshlrev_b32 v4, 5, v4
s_lshl_b32 s70, s60, 6
s_add_u32 s70, s70, 163584
v_add_u32 v5, s70, v5
v_xor_b32 v6, 128, v5
s_lshl_b32 s72, s67, 1
s_add_u32 s72, s72, s66
s_lshl_b32 s72, s72, 10
s_add_u32 s72, s72, s87
s_lshl_b32 s73, s67, 7
s_lshl_b32 s70, s66, 4
s_add_u32 s73, s73, s70
s_add_u32 s73, s73, s87
s_add_u32 s73, s73, 4096
s_mov_b32 s92, 0x00010001
s_mov_b32 s93, 0x00010001
v_mov_b32 v15, s68
s_cmp_eq_u32 s66, 0
s_cbranch_scc0 L_ex1
ds_write_b128 v2, v[68:71]
ds_write_b128 v2, v[76:79] offset:1024
ds_write_b128 v5, v[24:27]
s_waitcnt lgkmcnt(0)
s_barrier
ds_read_b128 v[128:131], v3
ds_read_b128 v[132:135], v3 offset:1024
ds_read_b128 v[136:139], v6
s_waitcnt lgkmcnt(1)
v_pk_add_f32 v[128:129], v[128:129], v[64:65]
v_pk_add_f32 v[130:131], v[130:131], v[66:67]
v_pk_add_f32 v[132:133], v[132:133], v[72:73]
v_pk_add_f32 v[134:135], v[134:135], v[74:75]
s_waitcnt lgkmcnt(0)
v_pk_add_f32 v[136:137], v[136:137], v[20:21]
v_pk_add_f32 v[138:139], v[138:139], v[22:23]
s_branch L_ex_d
L_ex1:
ds_write_b128 v2, v[64:67]
ds_write_b128 v2, v[72:75] offset:1024
ds_write_b128 v5, v[20:23]
s_waitcnt lgkmcnt(0)
s_barrier
ds_read_b128 v[128:131], v3
ds_read_b128 v[132:135], v3 offset:1024
ds_read_b128 v[136:139], v6
s_waitcnt lgkmcnt(1)
v_pk_add_f32 v[128:129], v[128:129], v[68:69]
v_pk_add_f32 v[130:131], v[130:131], v[70:71]
v_pk_add_f32 v[132:133], v[132:133], v[76:77]
v_pk_add_f32 v[134:135], v[134:135], v[78:79]
s_waitcnt lgkmcnt(0)
v_pk_add_f32 v[136:137], v[136:137], v[24:25]
v_pk_add_f32 v[138:139], v[138:139], v[26:27]
L_ex_d:
v_cvt_pk_bf16_f32 v140, v128, v129
v_cvt_pk_bf16_f32 v141, v130, v131
v_cvt_pk_bf16_f32 v142, v132, v133
v_cvt_pk_bf16_f32 v143, v134, v135
v_bfi_b32 v136, s85, v15, v136
v_bfi_b32 v137, s85, v15, v137
v_bfi_b32 v138, s85, v15, v138
v_bfi_b32 v139, s85, v15, v139
s_cmp_eq_u32 s69, 0
s_cbranch_scc1 L_kvp_s
buffer_store_dwordx4 v[140:143], v16, s[12:15], s72 offen
s_mov_b64 exec, s[92:93]
buffer_store_dwordx4 v[136:139], v4, s[12:15], s73 offen
s_mov_b64 exec, -1
L_kvp_d:
s_barrier
v_and_b32 v2, 15, v1
v_lshlrev_b32 v2, 2, v2
s_lshl_b32 s70, s66, 8
s_add_u32 s70, s70, 159744
v_add_u32 v2, s70, v2
v_lshrrev_b32 v3, 4, v1
v_lshlrev_b32 v3, 4, v3
s_lshl_b32 s70, s67, 7
s_add_u32 s70, s70, 160768
v_add_u32_e64 v5, s70, v3
ds_read_b32 v8, v2 offset:0
ds_read_b32 v128, v2 offset:512
ds_read_b32 v10, v2 offset:64
ds_read_b32 v130, v2 offset:576
ds_read_b32 v12, v2 offset:128
ds_read_b32 v132, v2 offset:640
ds_read_b32 v14, v2 offset:192
ds_read_b32 v134, v2 offset:704
ds_read_b128 v[144:147], v5 offset:0
ds_read_b128 v[148:151], v5 offset:64
s_lshl_b32 s70, s67, 11
s_add_u32 s70, s70, 24576
v_add_u32_e64 v17, s70, v16
s_lshl_b32 s70, s67, 6
s_add_u32 s70, s70, 161600
v_add_u32 v18, s70, v3
s_waitcnt lgkmcnt(0)
v_mul_f32 v20, s90, v128
v_mul_f32 v22, s90, v130
v_mul_f32 v4, s90, v132
v_mul_f32 v6, s90, v134
v_pk_fma_f32 v[32:33], v[144:145], v[8:9], v[32:33] op_sel:[0,0,0] op_sel_hi:[1,0,1]
v_pk_fma_f32 v[36:37], v[148:149], v[8:9], v[36:37] op_sel:[0,0,0] op_sel_hi:[1,0,1]
v_pk_fma_f32 v[34:35], v[146:147], v[8:9], v[34:35] op_sel:[0,0,0] op_sel_hi:[1,0,1]
v_pk_fma_f32 v[38:39], v[150:151], v[8:9], v[38:39] op_sel:[0,0,0] op_sel_hi:[1,0,1]
v_pk_mul_f32 v[24:25], v[32:33], v[20:21] op_sel:[0,0] op_sel_hi:[1,0]
v_pk_mul_f32 v[28:29], v[36:37], v[20:21] op_sel:[0,0] op_sel_hi:[1,0]
v_pk_mul_f32 v[26:27], v[34:35], v[20:21] op_sel:[0,0] op_sel_hi:[1,0]
v_pk_mul_f32 v[30:31], v[38:39], v[20:21] op_sel:[0,0] op_sel_hi:[1,0]
v_pk_fma_f32 v[32:33], v[32:33], v[128:129], s[82:83] op_sel:[0,0,0] op_sel_hi:[1,0,1]
v_pk_fma_f32 v[36:37], v[36:37], v[128:129], s[82:83] op_sel:[0,0,0] op_sel_hi:[1,0,1]
v_pk_fma_f32 v[34:35], v[34:35], v[128:129], s[82:83] op_sel:[0,0,0] op_sel_hi:[1,0,1]
v_pk_fma_f32 v[38:39], v[38:39], v[128:129], s[82:83] op_sel:[0,0,0] op_sel_hi:[1,0,1]
v_exp_f32_e64 v24, v24 clamp
v_exp_f32_e64 v28, v28 clamp
v_exp_f32_e64 v25, v25 clamp
v_exp_f32_e64 v29, v29 clamp
v_exp_f32_e64 v26, v26 clamp
v_exp_f32_e64 v30, v30 clamp
v_exp_f32_e64 v27, v27 clamp
v_exp_f32_e64 v31, v31 clamp
v_pk_add_f32 v[24:25], v[24:25], s[80:81]
v_pk_add_f32 v[28:29], v[28:29], s[80:81]
v_pk_add_f32 v[26:27], v[26:27], s[80:81]
v_pk_add_f32 v[30:31], v[30:31], s[80:81]
v_max_f32 v32, v32, v24
v_max_f32 v36, v36, v28
v_max_f32 v33, v33, v25
v_max_f32 v37, v37, v29
v_max_f32 v34, v34, v26
v_max_f32 v38, v38, v30
v_max_f32 v35, v35, v27
v_max_f32 v39, v39, v31
v_cvt_pk_bf16_f32 v32, v32, v33
v_cvt_pk_bf16_f32 v33, v34, v35
v_cvt_pk_bf16_f32 v34, v36, v37
v_cvt_pk_bf16_f32 v35, v38, v39
v_pk_fma_f32 v[56:57], v[144:145], v[10:11], v[56:57] op_sel:[0,0,0] op_sel_hi:[1,0,1]
v_pk_fma_f32 v[60:61], v[148:149], v[10:11], v[60:61] op_sel:[0,0,0] op_sel_hi:[1,0,1]
v_pk_fma_f32 v[58:59], v[146:147], v[10:11], v[58:59] op_sel:[0,0,0] op_sel_hi:[1,0,1]
v_pk_fma_f32 v[62:63], v[150:151], v[10:11], v[62:63] op_sel:[0,0,0] op_sel_hi:[1,0,1]
v_pk_mul_f32 v[24:25], v[56:57], v[22:23] op_sel:[0,0] op_sel_hi:[1,0]
v_pk_mul_f32 v[28:29], v[60:61], v[22:23] op_sel:[0,0] op_sel_hi:[1,0]
v_pk_mul_f32 v[26:27], v[58:59], v[22:23] op_sel:[0,0] op_sel_hi:[1,0]
v_pk_mul_f32 v[30:31], v[62:63], v[22:23] op_sel:[0,0] op_sel_hi:[1,0]
v_pk_fma_f32 v[56:57], v[56:57], v[130:131], s[82:83] op_sel:[0,0,0] op_sel_hi:[1,0,1]
v_pk_fma_f32 v[60:61], v[60:61], v[130:131], s[82:83] op_sel:[0,0,0] op_sel_hi:[1,0,1]
v_pk_fma_f32 v[58:59], v[58:59], v[130:131], s[82:83] op_sel:[0,0,0] op_sel_hi:[1,0,1]
v_pk_fma_f32 v[62:63], v[62:63], v[130:131], s[82:83] op_sel:[0,0,0] op_sel_hi:[1,0,1]
v_exp_f32_e64 v24, v24 clamp
v_exp_f32_e64 v28, v28 clamp
v_exp_f32_e64 v25, v25 clamp
v_exp_f32_e64 v29, v29 clamp
v_exp_f32_e64 v26, v26 clamp
v_exp_f32_e64 v30, v30 clamp
v_exp_f32_e64 v27, v27 clamp
v_exp_f32_e64 v31, v31 clamp
v_pk_add_f32 v[24:25], v[24:25], s[80:81]
v_pk_add_f32 v[28:29], v[28:29], s[80:81]
v_pk_add_f32 v[26:27], v[26:27], s[80:81]
v_pk_add_f32 v[30:31], v[30:31], s[80:81]
v_max_f32 v56, v56, v24
v_max_f32 v60, v60, v28
v_max_f32 v57, v57, v25
v_max_f32 v61, v61, v29
v_max_f32 v58, v58, v26
v_max_f32 v62, v62, v30
v_max_f32 v59, v59, v27
v_max_f32 v63, v63, v31
v_cvt_pk_bf16_f32 v56, v56, v57
v_cvt_pk_bf16_f32 v57, v58, v59
v_cvt_pk_bf16_f32 v58, v60, v61
v_cvt_pk_bf16_f32 v59, v62, v63
v_pk_fma_f32 v[80:81], v[144:145], v[12:13], v[80:81] op_sel:[0,0,0] op_sel_hi:[1,0,1]
v_pk_fma_f32 v[84:85], v[148:149], v[12:13], v[84:85] op_sel:[0,0,0] op_sel_hi:[1,0,1]
v_pk_fma_f32 v[82:83], v[146:147], v[12:13], v[82:83] op_sel:[0,0,0] op_sel_hi:[1,0,1]
v_pk_fma_f32 v[86:87], v[150:151], v[12:13], v[86:87] op_sel:[0,0,0] op_sel_hi:[1,0,1]
v_pk_mul_f32 v[24:25], v[80:81], v[4:5] op_sel:[0,0] op_sel_hi:[1,0]
v_pk_mul_f32 v[28:29], v[84:85], v[4:5] op_sel:[0,0] op_sel_hi:[1,0]
v_pk_mul_f32 v[26:27], v[82:83], v[4:5] op_sel:[0,0] op_sel_hi:[1,0]
v_pk_mul_f32 v[30:31], v[86:87], v[4:5] op_sel:[0,0] op_sel_hi:[1,0]
v_pk_fma_f32 v[80:81], v[80:81], v[132:133], s[82:83] op_sel:[0,0,0] op_sel_hi:[1,0,1]
v_pk_fma_f32 v[84:85], v[84:85], v[132:133], s[82:83] op_sel:[0,0,0] op_sel_hi:[1,0,1]
v_pk_fma_f32 v[82:83], v[82:83], v[132:133], s[82:83] op_sel:[0,0,0] op_sel_hi:[1,0,1]
v_pk_fma_f32 v[86:87], v[86:87], v[132:133], s[82:83] op_sel:[0,0,0] op_sel_hi:[1,0,1]
v_exp_f32_e64 v24, v24 clamp
v_exp_f32_e64 v28, v28 clamp
v_exp_f32_e64 v25, v25 clamp
v_exp_f32_e64 v29, v29 clamp
v_exp_f32_e64 v26, v26 clamp
v_exp_f32_e64 v30, v30 clamp
v_exp_f32_e64 v27, v27 clamp
v_exp_f32_e64 v31, v31 clamp
v_pk_add_f32 v[24:25], v[24:25], s[80:81]
v_pk_add_f32 v[28:29], v[28:29], s[80:81]
v_pk_add_f32 v[26:27], v[26:27], s[80:81]
v_pk_add_f32 v[30:31], v[30:31], s[80:81]
v_max_f32 v80, v80, v24
v_max_f32 v84, v84, v28
v_max_f32 v81, v81, v25
v_max_f32 v85, v85, v29
v_max_f32 v82, v82, v26
v_max_f32 v86, v86, v30
v_max_f32 v83, v83, v27
v_max_f32 v87, v87, v31
v_cvt_pk_bf16_f32 v80, v80, v81
v_cvt_pk_bf16_f32 v81, v82, v83
v_cvt_pk_bf16_f32 v82, v84, v85
v_cvt_pk_bf16_f32 v83, v86, v87
v_pk_fma_f32 v[104:105], v[144:145], v[14:15], v[104:105] op_sel:[0,0,0] op_sel_hi:[1,0,1]
v_pk_fma_f32 v[108:109], v[148:149], v[14:15], v[108:109] op_sel:[0,0,0] op_sel_hi:[1,0,1]
v_pk_fma_f32 v[106:107], v[146:147], v[14:15], v[106:107] op_sel:[0,0,0] op_sel_hi:[1,0,1]
v_pk_fma_f32 v[110:111], v[150:151], v[14:15], v[110:111] op_sel:[0,0,0] op_sel_hi:[1,0,1]
v_pk_mul_f32 v[24:25], v[104:105], v[6:7] op_sel:[0,0] op_sel_hi:[1,0]
v_pk_mul_f32 v[28:29], v[108:109], v[6:7] op_sel:[0,0] op_sel_hi:[1,0]
v_pk_mul_f32 v[26:27], v[106:107], v[6:7] op_sel:[0,0] op_sel_hi:[1,0]
v_pk_mul_f32 v[30:31], v[110:111], v[6:7] op_sel:[0,0] op_sel_hi:[1,0]
v_pk_fma_f32 v[104:105], v[104:105], v[134:135], s[82:83] op_sel:[0,0,0] op_sel_hi:[1,0,1]
v_pk_fma_f32 v[108:109], v[108:109], v[134:135], s[82:83] op_sel:[0,0,0] op_sel_hi:[1,0,1]
v_pk_fma_f32 v[106:107], v[106:107], v[134:135], s[82:83] op_sel:[0,0,0] op_sel_hi:[1,0,1]
v_pk_fma_f32 v[110:111], v[110:111], v[134:135], s[82:83] op_sel:[0,0,0] op_sel_hi:[1,0,1]
v_exp_f32_e64 v24, v24 clamp
v_exp_f32_e64 v28, v28 clamp
v_exp_f32_e64 v25, v25 clamp
v_exp_f32_e64 v29, v29 clamp
v_exp_f32_e64 v26, v26 clamp
v_exp_f32_e64 v30, v30 clamp
v_exp_f32_e64 v27, v27 clamp
v_exp_f32_e64 v31, v31 clamp
v_pk_add_f32 v[24:25], v[24:25], s[80:81]
v_pk_add_f32 v[28:29], v[28:29], s[80:81]
v_pk_add_f32 v[26:27], v[26:27], s[80:81]
v_pk_add_f32 v[30:31], v[30:31], s[80:81]
v_max_f32 v104, v104, v24
v_max_f32 v108, v108, v28
v_max_f32 v105, v105, v25
v_max_f32 v109, v109, v29
v_max_f32 v106, v106, v26
v_max_f32 v110, v110, v30
v_max_f32 v107, v107, v27
v_max_f32 v111, v111, v31
v_cvt_pk_bf16_f32 v104, v104, v105
v_cvt_pk_bf16_f32 v105, v106, v107
v_cvt_pk_bf16_f32 v106, v108, v109
v_cvt_pk_bf16_f32 v107, v110, v111
v_lshrrev_b32 v2, 4, v1
v_bfe_u32 v3, v1, 2, 2
v_lshl_add_u32 v4, v2, 2, v3
v_lshlrev_b32 v5, 7, v4
v_bfe_u32 v4, v4, 1, 2
v_lshl_add_u32 v5, v4, 5, v5
v_and_b32_e64 v4, 3, v1
v_lshl_add_u32 v5, v4, 3, v5
v_add_u32 v8, 28672, v5
v_xor_b32 v9, 32, v8
v_xor_b32 v10, 64, v8
v_xor_b32 v11, 96, v8
v_add_u32 v12, 65536, v8
v_add_u32 v13, 65536, v9
v_add_u32 v14, 65536, v10
v_add_u32 v15, 65536, v11
v_and_b32 v3, 15, v1
v_lshrrev_b32 v4, 1, v3
v_lshrrev_b32 v5, 1, v2
v_xor_b32 v4, v4, v5
v_lshlrev_b32 v4, 4, v4
v_lshl_add_u32 v4, v3, 7, v4
v_and_b32 v5, 1, v2
v_lshl_add_u32 v4, v5, 3, v4
s_lshl_b32 s70, s60, 12
v_add_u32 v20, s70, v4
v_xor_b32 v21, 32, v20
v_xor_b32 v22, 64, v20
v_xor_b32 v23, 96, v20
s_and_b32 s74, s64, 7
s_lshl_b32 s74, s74, 19
s_lshr_b32 s70, s64, 1
s_xor_b32 s70, s70, s64
s_and_b32 s70, s70, 4
s_lshl_b32 s70, s70, 11
s_xor_b32 s70, s70, 2105344
s_add_u32 s74, s74, s70
s_mul_i32 s70, s60, 131072
s_add_u32 s74, s74, s70
s_xor_b32 s74, s74, s61
v_add_u32 v6, s74, v16
v_add_u32 v19, 65536, v6
s_and_b32 s70, s89, 12
s_add_u32 s74, s89, s70
s_lshl_b32 s74, s74, 11
s_mov_b32 s24, s74
s_add_u32 s25, s24, 10240
s_bitcmp1_b32 s25, 13
s_cselect_b32 s70, 8192, 0
s_sub_u32 s25, s25, s70
s_and_b32 s25, s25, 65535
s_add_u32 s26, s25, 10240
s_bitcmp1_b32 s26, 13
s_cselect_b32 s70, 8192, 0
s_sub_u32 s26, s26, s70
s_and_b32 s26, s26, 65535
s_add_u32 s27, s26, 10240
s_bitcmp1_b32 s27, 13
s_cselect_b32 s70, 8192, 0
s_sub_u32 s27, s27, s70
s_and_b32 s27, s27, 65535
s_add_u32 s28, s27, 10240
s_bitcmp1_b32 s28, 13
s_cselect_b32 s70, 8192, 0
s_sub_u32 s28, s28, s70
s_and_b32 s28, s28, 65535
s_add_u32 s29, s28, 10240
s_bitcmp1_b32 s29, 13
s_cselect_b32 s70, 8192, 0
s_sub_u32 s29, s29, s70
s_and_b32 s29, s29, 65535
s_add_u32 s30, s29, 10240
s_bitcmp1_b32 s30, 13
s_cselect_b32 s70, 8192, 0
s_sub_u32 s30, s30, s70
s_and_b32 s30, s30, 65535
s_add_u32 s31, s30, 10240
s_bitcmp1_b32 s31, 13
s_cselect_b32 s70, 8192, 0
s_sub_u32 s31, s31, s70
s_and_b32 s31, s31, 65535
s_add_u32 s32, s31, 10240
s_bitcmp1_b32 s32, 13
s_cselect_b32 s70, 8192, 0
s_sub_u32 s32, s32, s70
s_and_b32 s32, s32, 65535
s_add_u32 s33, s32, 10240
s_bitcmp1_b32 s33, 13
s_cselect_b32 s70, 8192, 0
s_sub_u32 s33, s33, s70
s_and_b32 s33, s33, 65535
s_add_u32 s34, s33, 10240
s_bitcmp1_b32 s34, 13
s_cselect_b32 s70, 8192, 0
s_sub_u32 s34, s34, s70
s_and_b32 s34, s34, 65535
s_add_u32 s35, s34, 10240
s_bitcmp1_b32 s35, 13
s_cselect_b32 s70, 8192, 0
s_sub_u32 s35, s35, s70
s_and_b32 s35, s35, 65535
s_add_u32 s36, s35, 10240
s_bitcmp1_b32 s36, 13
s_cselect_b32 s70, 8192, 0
s_sub_u32 s36, s36, s70
s_and_b32 s36, s36, 65535
s_add_u32 s37, s36, 10240
s_bitcmp1_b32 s37, 13
s_cselect_b32 s70, 8192, 0
s_sub_u32 s37, s37, s70
s_and_b32 s37, s37, 65535
s_add_u32 s38, s37, 10240
s_bitcmp1_b32 s38, 13
s_cselect_b32 s70, 8192, 0
s_sub_u32 s38, s38, s70
s_and_b32 s38, s38, 65535
s_add_u32 s39, s38, 10240
s_branch L_over6
L_pad6:
s_branch L_ret9
L_over6:
s_bitcmp1_b32 s39, 13
s_cselect_b32 s70, 8192, 0
s_sub_u32 s39, s39, s70
s_and_b32 s39, s39, 65535
L_E2:
s_barrier
ds_read_b128 a[0:3], v17
ds_read_b128 a[4:7], v17 offset:1024
ds_read_b128 a[8:11], v18
s_waitcnt lgkmcnt(0)
v_mfma_f32_16x16x32_bf16 v[48:51], a[8:11], v[32:35], 0
v_mfma_f32_16x16x32_bf16 v[40:43], a[0:3], v[32:35], 0
v_mfma_f32_16x16x32_bf16 v[44:47], a[4:7], v[32:35], 0
v_mfma_f32_16x16x32_bf16 v[72:75], a[8:11], v[56:59], 0
v_mfma_f32_16x16x32_bf16 v[64:67], a[0:3], v[56:59], 0
v_mfma_f32_16x16x32_bf16 v[68:71], a[4:7], v[56:59], 0
v_mfma_f32_16x16x32_bf16 v[96:99], a[8:11], v[80:83], 0
v_mfma_f32_16x16x32_bf16 v[88:91], a[0:3], v[80:83], 0
v_mfma_f32_16x16x32_bf16 v[92:95], a[4:7], v[80:83], 0
v_mfma_f32_16x16x32_bf16 v[120:123], a[8:11], v[104:107], 0
v_mfma_f32_16x16x32_bf16 v[112:115], a[0:3], v[104:107], 0
v_mfma_f32_16x16x32_bf16 v[116:119], a[4:7], v[104:107], 0
s_lshr_b32 s71, s65, 1
s_xor_b32 s71, s71, s62
s_xor_b32 s70, s69, 1
s_or_b32 s71, s71, s70
v_add_f32_e64 v48, s80, v48
v_rcp_f32 v48, v48
s_nop 0
v_pk_mul_f32 v[40:41], v[40:41], v[48:49] op_sel_hi:[1,0]
v_pk_mul_f32 v[42:43], v[42:43], v[48:49] op_sel_hi:[1,0]
v_pk_mul_f32 v[44:45], v[44:45], v[48:49] op_sel_hi:[1,0]
v_pk_mul_f32 v[46:47], v[46:47], v[48:49] op_sel_hi:[1,0]
v_cvt_pk_bf16_f32 v52, v40, v41
v_cvt_pk_bf16_f32 v53, v42, v43
v_cvt_pk_bf16_f32 v54, v44, v45
v_cvt_pk_bf16_f32 v55, v46, v47
s_add_u32 s70, s88, 0
s_cmp_eq_u32 s71, 0
s_cbranch_scc1 L_oown0
buffer_store_dwordx4 v[52:55], v16, s[12:15], s70 offen sc1
L_ood0:
v_add_f32 v72, s80, v72
v_rcp_f32 v72, v72
s_nop 0
v_pk_mul_f32 v[64:65], v[64:65], v[72:73] op_sel_hi:[1,0]
v_pk_mul_f32 v[66:67], v[66:67], v[72:73] op_sel_hi:[1,0]
v_pk_mul_f32 v[68:69], v[68:69], v[72:73] op_sel_hi:[1,0]
v_pk_mul_f32 v[70:71], v[70:71], v[72:73] op_sel_hi:[1,0]
v_cvt_pk_bf16_f32 v76, v64, v65
v_cvt_pk_bf16_f32 v77, v66, v67
v_cvt_pk_bf16_f32 v78, v68, v69
v_cvt_pk_bf16_f32 v79, v70, v71
s_add_u32 s70, s88, 65536
s_cmp_eq_u32 s71, 0
s_cbranch_scc1 L_oown1
buffer_store_dwordx4 v[76:79], v16, s[12:15], s70 offen sc1
L_ood1:
v_add_f32_e64 v96, s80, v96
v_rcp_f32 v96, v96
s_nop 0
v_pk_mul_f32 v[88:89], v[88:89], v[96:97] op_sel_hi:[1,0]
v_pk_mul_f32 v[90:91], v[90:91], v[96:97] op_sel_hi:[1,0]
v_pk_mul_f32 v[92:93], v[92:93], v[96:97] op_sel_hi:[1,0]
v_pk_mul_f32 v[94:95], v[94:95], v[96:97] op_sel_hi:[1,0]
v_cvt_pk_bf16_f32 v100, v88, v89
v_cvt_pk_bf16_f32 v101, v90, v91
v_cvt_pk_bf16_f32 v102, v92, v93
v_cvt_pk_bf16_f32 v103, v94, v95
s_add_u32 s70, s88, 131072
s_cmp_eq_u32 s71, 0
s_cbranch_scc1 L_oown2
buffer_store_dwordx4 v[100:103], v16, s[12:15], s70 offen sc1
L_ood2:
v_add_f32_e64 v120, s80, v120
v_rcp_f32 v120, v120
s_nop 0
v_pk_mul_f32 v[112:113], v[112:113], v[120:121] op_sel_hi:[1,0]
v_pk_mul_f32 v[114:115], v[114:115], v[120:121] op_sel_hi:[1,0]
v_pk_mul_f32 v[116:117], v[116:117], v[120:121] op_sel_hi:[1,0]
v_pk_mul_f32 v[118:119], v[118:119], v[120:121] op_sel_hi:[1,0]
v_cvt_pk_bf16_f32 v124, v112, v113
v_cvt_pk_bf16_f32 v125, v114, v115
v_cvt_pk_bf16_f32 v126, v116, v117
v_cvt_pk_bf16_f32 v127, v118, v119
s_add_u32 s70, s88, 196608
s_cmp_eq_u32 s71, 0
s_cbranch_scc1 L_oown3
buffer_store_dwordx4 v[124:127], v16, s[12:15], s70 offen sc1
L_ood3:
v_xor_b32 v7, s76, v7
ds_read_b64 v[26:27], v20 offset:0
ds_read_b64 v[30:31], v21 offset:0
ds_read_b64 v[34:35], v22 offset:0
ds_read_b64 v[38:39], v23 offset:0
ds_read_b64 v[42:43], v20 offset:2048
ds_read_b64 v[46:47], v21 offset:2048
ds_read_b64 v[50:51], v22 offset:2048
ds_read_b64 v[54:55], v23 offset:2048
s_waitcnt lgkmcnt(0)
ds_read_b64_tr_b16 a[0:1], v8 offset:0
ds_read_b64_tr_b16 a[2:3], v8 offset:2048
ds_read_b64_tr_b16 a[4:5], v9 offset:0
ds_read_b64_tr_b16 a[6:7], v9 offset:2048
ds_read_b64_tr_b16 a[8:9], v10 offset:0
ds_read_b64_tr_b16 a[10:11], v10 offset:2048
ds_read_b64_tr_b16 a[12:13], v11 offset:0
ds_read_b64_tr_b16 a[14:15], v11 offset:2048
ds_read_b64_tr_b16 a[16:17], v8 offset:4096
ds_read_b64_tr_b16 a[18:19], v8 offset:6144
ds_read_b64_tr_b16 a[20:21], v9 offset:4096
ds_read_b64_tr_b16 a[22:23], v9 offset:6144
ds_read_b64_tr_b16 a[24:25], v10 offset:4096
ds_read_b64_tr_b16 a[26:27], v10 offset:6144
ds_read_b64_tr_b16 a[28:29], v11 offset:4096
ds_read_b64_tr_b16 a[30:31], v11 offset:6144
v_lshlrev_b32 v24, 16, v26
v_and_b32 v25, 0xffff0000, v26
v_lshlrev_b32 v26, 16, v27
v_and_b32 v27, 0xffff0000, v27
v_lshlrev_b32 v28, 16, v30
v_and_b32 v29, 0xffff0000, v30
v_lshlrev_b32 v30, 16, v31
v_and_b32 v31, 0xffff0000, v31
v_lshlrev_b32 v32, 16, v34
v_and_b32 v33, 0xffff0000, v34
v_lshlrev_b32 v34, 16, v35
v_and_b32 v35, 0xffff0000, v35
v_lshlrev_b32 v36, 16, v38
v_and_b32 v37, 0xffff0000, v38
v_lshlrev_b32 v38, 16, v39
v_and_b32 v39, 0xffff0000, v39
v_lshlrev_b32 v40, 16, v42
v_and_b32 v41, 0xffff0000, v42
v_lshlrev_b32 v42, 16, v43
v_and_b32 v43, 0xffff0000, v43
v_lshlrev_b32 v44, 16, v46
v_and_b32 v45, 0xffff0000, v46
v_lshlrev_b32 v46, 16, v47
v_and_b32 v47, 0xffff0000, v47
v_lshlrev_b32 v48, 16, v50
v_and_b32 v49, 0xffff0000, v50
v_lshlrev_b32 v50, 16, v51
v_and_b32 v51, 0xffff0000, v51
v_lshlrev_b32 v52, 16, v54
v_and_b32 v53, 0xffff0000, v54
v_lshlrev_b32 v54, 16, v55
v_and_b32 v55, 0xffff0000, v55
v_lshrrev_b32 v2, 4, v1
v_lshlrev_b32 v2, 3, v2
v_add_u32 v2, 162048, v2
v_mov_b32 v3, 162176
ds_read_b64 v[136:137], v2 offset:0
ds_read_b64 v[138:139], v2 offset:32
ds_read_b64 v[140:141], v2 offset:64
ds_read_b64 v[142:143], v2 offset:96
ds_read_b128 v[148:151], v3
s_waitcnt lgkmcnt(0)
v_add_f32 v148, v148, v149
v_add_f32 v150, v150, v151
v_add_f32 v148, v148, v150
s_nop 0
v_readfirstlane_b32 s84, v148
v_and_b32 v2, 3, v1
v_cmp_eq_u32 vcc, 0, v2
v_mov_b32 v3, 0x3f803f80
s_nop 0
v_cndmask_b32 v3, 0, v3, vcc
v_cmp_eq_u32 vcc, 2, v2
s_nop 1
v_cndmask_b32 v120, v3, v136, vcc
v_cndmask_b32 v121, v3, v137, vcc
v_cndmask_b32 v122, v3, v138, vcc
v_cndmask_b32 v123, v3, v139, vcc
v_cndmask_b32 v124, v3, v140, vcc
v_cndmask_b32 v125, v3, v141, vcc
v_cndmask_b32 v126, v3, v142, vcc
v_cndmask_b32 v127, v3, v143, vcc
v_and_b32 v2, 15, v1
v_lshrrev_b32 v3, 5, v1
v_lshlrev_b32_e64 v4, 4, v2
v_mov_b32 v144, v4
s_lshl_b32 s75, s64, 15
s_lshl_b32 s70, s60, 9
s_add_u32 s75, s75, s70
s_add_u32 s75, s75, 6291456
s_lshl_b32 s70, s65, 11
s_add_u32 s72, s75, s70
s_mov_b32 s92, 0x00f0000f
s_mov_b32 s93, 0xf0000f00
s_mov_b32 s80, 0x22222222
s_mov_b32 s81, 0x22222222
s_mov_b32 s82, 0x44444444
s_mov_b32 s83, 0x44444444
s_mov_b32 s90, 0x88888888
s_mov_b32 s91, 0x88888888
v_and_b32_e64 v2, 31, v1
v_lshlrev_b32 v5, 4, v2
v_lshl_add_u32 v145, v3, 11, v5
s_lshl_b32 s70, s64, 7
s_lshl_b32 s71, s60, 5
s_add_u32 s70, s70, s71
s_add_u32 s87, s70, 6815744
s_lshr_b32 s70, s70, 4
v_lshl_add_u32 v146, v2, 7, s70
s_lshl_b32 s70, s64, 2
s_add_u32 s70, s70, s60
s_lshl_b32 s70, s70, 15
s_lshl_b32 s71, s65, 7
s_add_u32 s70, s70, s71
s_add_u32 s88, s70, 8388608
v_bfe_u32 v2, v1, 3, 1
v_and_b32 v3, 7, v1
v_lshlrev_b32 v147, 14, v2
v_lshl_add_u32 v147, v3, 4, v147
v_bfe_u32 v2, v1, 4, 1
v_lshl_add_u32 v147, v2, 13, v147
buffer_load_dwordx4 v[56:59], v6, s[12:15], s24 offen offset:0 sc1
buffer_load_dwordx4 v[60:63], v19, s[12:15], s24 offen offset:0 sc1
buffer_load_dwordx4 v[64:67], v6, s[12:15], s24 offen offset:1024 sc1
buffer_load_dwordx4 v[68:71], v19, s[12:15], s24 offen offset:1024 sc1
buffer_load_dwordx4 v[72:75], v6, s[12:15], s25 offen offset:0 sc1
buffer_load_dwordx4 v[76:79], v19, s[12:15], s25 offen offset:0 sc1
buffer_load_dwordx4 v[80:83], v6, s[12:15], s25 offen offset:1024 sc1
buffer_load_dwordx4 v[84:87], v19, s[12:15], s25 offen offset:1024 sc1
buffer_load_dwordx4 v[88:91], v6, s[12:15], s26 offen offset:0 sc1
buffer_load_dwordx4 v[92:95], v19, s[12:15], s26 offen offset:0 sc1
buffer_load_dwordx4 v[96:99], v6, s[12:15], s26 offen offset:1024 sc1
buffer_load_dwordx4 v[100:103], v19, s[12:15], s26 offen offset:1024 sc1
s_waitcnt vmcnt(8)
v_max3_u32 v2, v56, v60, v64
v_max_u32 v2, v2, v68
v_cmp_eq_u32_e64 vcc, -1, v2
s_cbranch_vccnz L_o0_rt
L_o0_ok:
s_waitcnt lgkmcnt(8)
v_mfma_f32_16x16x32_bf16 v[24:27], a[0:3], v[56:59], v[24:27]
ds_read_b64_tr_b16 a[32:33], v8 offset:8192
ds_read_b64_tr_b16 a[34:35], v8 offset:10240
v_mfma_f32_16x16x32_bf16 v[40:43], a[0:3], v[60:63], v[40:43]
buffer_load_dwordx4 v[104:107], v6, s[12:15], s27 offen offset:0 sc1
v_mfma_f32_16x16x32_bf16 v[28:31], a[4:7], v[56:59], v[28:31]
ds_read_b64_tr_b16 a[36:37], v9 offset:8192
ds_read_b64_tr_b16 a[38:39], v9 offset:10240
v_mfma_f32_16x16x32_bf16 v[44:47], a[4:7], v[60:63], v[44:47]
buffer_load_dwordx4 v[108:111], v19, s[12:15], s27 offen offset:0 sc1
v_mfma_f32_16x16x32_bf16 v[32:35], a[8:11], v[56:59], v[32:35]
ds_read_b64_tr_b16 a[40:41], v10 offset:8192
ds_read_b64_tr_b16 a[42:43], v10 offset:10240
v_mfma_f32_16x16x32_bf16 v[48:51], a[8:11], v[60:63], v[48:51]
buffer_load_dwordx4 v[112:115], v6, s[12:15], s27 offen offset:1024 sc1
v_mfma_f32_16x16x32_bf16 v[36:39], a[12:15], v[56:59], v[36:39]
ds_read_b64_tr_b16 a[44:45], v11 offset:8192
ds_read_b64_tr_b16 a[46:47], v11 offset:10240
v_mfma_f32_16x16x32_bf16 v[52:55], a[12:15], v[60:63], v[52:55]
buffer_load_dwordx4 v[116:119], v19, s[12:15], s27 offen offset:1024 sc1
s_waitcnt lgkmcnt(8)
v_mfma_f32_16x16x32_bf16 v[24:27], a[16:19], v[64:67], v[24:27]
ds_read_b64_tr_b16 a[0:1], v8 offset:12288
s_waitcnt vmcnt(8)
v_mfma_f32_16x16x32_bf16 v[40:43], a[16:19], v[68:71], v[40:43]
ds_read_b64_tr_b16 a[2:3], v8 offset:14336
v_max3_u32 v2, v72, v76, v80
v_mfma_f32_16x16x32_bf16 v[28:31], a[20:23], v[64:67], v[28:31]
ds_read_b64_tr_b16 a[4:5], v9 offset:12288
v_max_u32 v2, v2, v84
v_mfma_f32_16x16x32_bf16 v[44:47], a[20:23], v[68:71], v[44:47]
ds_read_b64_tr_b16 a[6:7], v9 offset:14336
v_cmp_eq_u32 vcc, -1, v2
v_mfma_f32_16x16x32_bf16 v[32:35], a[24:27], v[64:67], v[32:35]
ds_read_b64_tr_b16 a[8:9], v10 offset:12288
v_mfma_f32_16x16x32_bf16 v[48:51], a[24:27], v[68:71], v[48:51]
ds_read_b64_tr_b16 a[10:11], v10 offset:14336
v_mfma_f32_16x16x32_bf16 v[36:39], a[28:31], v[64:67], v[36:39]
ds_read_b64_tr_b16 a[12:13], v11 offset:12288
ds_read_b64_tr_b16 a[14:15], v11 offset:14336
v_mfma_f32_16x16x32_bf16 v[52:55], a[28:31], v[68:71], v[52:55]
s_cbranch_vccnz L_o1_rt
L_o1_ok:
s_waitcnt lgkmcnt(8)
v_mfma_f32_16x16x32_bf16 v[24:27], a[32:35], v[72:75], v[24:27]
ds_read_b64_tr_b16 a[16:17], v8 offset:16384
ds_read_b64_tr_b16 a[18:19], v8 offset:18432
v_mfma_f32_16x16x32_bf16 v[40:43], a[32:35], v[76:79], v[40:43]
buffer_load_dwordx4 v[56:59], v6, s[12:15], s28 offen offset:0 sc1
v_mfma_f32_16x16x32_bf16 v[28:31], a[36:39], v[72:75], v[28:31]
ds_read_b64_tr_b16 a[20:21], v9 offset:16384
ds_read_b64_tr_b16 a[22:23], v9 offset:18432
v_mfma_f32_16x16x32_bf16 v[44:47], a[36:39], v[76:79], v[44:47]
buffer_load_dwordx4 v[60:63], v19, s[12:15], s28 offen offset:0 sc1
v_mfma_f32_16x16x32_bf16 v[32:35], a[40:43], v[72:75], v[32:35]
ds_read_b64_tr_b16 a[24:25], v10 offset:16384
ds_read_b64_tr_b16 a[26:27], v10 offset:18432
v_mfma_f32_16x16x32_bf16 v[48:51], a[40:43], v[76:79], v[48:51]
buffer_load_dwordx4 v[64:67], v6, s[12:15], s28 offen offset:1024 sc1
v_mfma_f32_16x16x32_bf16 v[36:39], a[44:47], v[72:75], v[36:39]
ds_read_b64_tr_b16 a[28:29], v11 offset:16384
ds_read_b64_tr_b16 a[30:31], v11 offset:18432
v_mfma_f32_16x16x32_bf16 v[52:55], a[44:47], v[76:79], v[52:55]
buffer_load_dwordx4 v[68:71], v19, s[12:15], s28 offen offset:1024 sc1
s_waitcnt lgkmcnt(8)
v_mfma_f32_16x16x32_bf16 v[24:27], a[0:3], v[80:83], v[24:27]
ds_read_b64_tr_b16 a[32:33], v8 offset:20480
s_waitcnt vmcnt(8)
v_mfma_f32_16x16x32_bf16 v[40:43], a[0:3], v[84:87], v[40:43]
ds_read_b64_tr_b16 a[34:35], v8 offset:22528
v_max3_u32 v2, v88, v92, v96
v_mfma_f32_16x16x32_bf16 v[28:31], a[4:7], v[80:83], v[28:31]
ds_read_b64_tr_b16 a[36:37], v9 offset:20480
v_max_u32 v2, v2, v100
v_mfma_f32_16x16x32_bf16 v[44:47], a[4:7], v[84:87], v[44:47]
ds_read_b64_tr_b16 a[38:39], v9 offset:22528
v_cmp_eq_u32 vcc, -1, v2
v_mfma_f32_16x16x32_bf16 v[32:35], a[8:11], v[80:83], v[32:35]
ds_read_b64_tr_b16 a[40:41], v10 offset:20480
v_mfma_f32_16x16x32_bf16 v[48:51], a[8:11], v[84:87], v[48:51]
ds_read_b64_tr_b16 a[42:43], v10 offset:22528
v_mfma_f32_16x16x32_bf16 v[36:39], a[12:15], v[80:83], v[36:39]
ds_read_b64_tr_b16 a[44:45], v11 offset:20480
ds_read_b64_tr_b16 a[46:47], v11 offset:22528
v_mfma_f32_16x16x32_bf16 v[52:55], a[12:15], v[84:87], v[52:55]
s_cbranch_vccnz L_o2_rt
L_o2_ok:
s_waitcnt lgkmcnt(8)
v_mfma_f32_16x16x32_bf16 v[24:27], a[16:19], v[88:91], v[24:27]
ds_read_b64_tr_b16 a[0:1], v8 offset:24576
ds_read_b64_tr_b16 a[2:3], v8 offset:26624
v_mfma_f32_16x16x32_bf16 v[40:43], a[16:19], v[92:95], v[40:43]
buffer_load_dwordx4 v[72:75], v6, s[12:15], s29 offen offset:0 sc1
v_mfma_f32_16x16x32_bf16 v[28:31], a[20:23], v[88:91], v[28:31]
ds_read_b64_tr_b16 a[4:5], v9 offset:24576
ds_read_b64_tr_b16 a[6:7], v9 offset:26624
v_mfma_f32_16x16x32_bf16 v[44:47], a[20:23], v[92:95], v[44:47]
buffer_load_dwordx4 v[76:79], v19, s[12:15], s29 offen offset:0 sc1
v_mfma_f32_16x16x32_bf16 v[32:35], a[24:27], v[88:91], v[32:35]
ds_read_b64_tr_b16 a[8:9], v10 offset:24576
ds_read_b64_tr_b16 a[10:11], v10 offset:26624
v_mfma_f32_16x16x32_bf16 v[48:51], a[24:27], v[92:95], v[48:51]
buffer_load_dwordx4 v[80:83], v6, s[12:15], s29 offen offset:1024 sc1
v_mfma_f32_16x16x32_bf16 v[36:39], a[28:31], v[88:91], v[36:39]
ds_read_b64_tr_b16 a[12:13], v11 offset:24576
ds_read_b64_tr_b16 a[14:15], v11 offset:26624
v_mfma_f32_16x16x32_bf16 v[52:55], a[28:31], v[92:95], v[52:55]
buffer_load_dwordx4 v[84:87], v19, s[12:15], s29 offen offset:1024 sc1
s_waitcnt lgkmcnt(8)
v_mfma_f32_16x16x32_bf16 v[24:27], a[32:35], v[96:99], v[24:27]
ds_read_b64_tr_b16 a[16:17], v8 offset:28672
s_waitcnt vmcnt(8)
v_mfma_f32_16x16x32_bf16 v[40:43], a[32:35], v[100:103], v[40:43]
ds_read_b64_tr_b16 a[18:19], v8 offset:30720
v_max3_u32 v2, v104, v108, v112
v_mfma_f32_16x16x32_bf16 v[28:31], a[36:39], v[96:99], v[28:31]
ds_read_b64_tr_b16 a[20:21], v9 offset:28672
v_max_u32 v2, v2, v116
v_mfma_f32_16x16x32_bf16 v[44:47], a[36:39], v[100:103], v[44:47]
ds_read_b64_tr_b16 a[22:23], v9 offset:30720
v_cmp_eq_u32 vcc, -1, v2
v_mfma_f32_16x16x32_bf16 v[32:35], a[40:43], v[96:99], v[32:35]
ds_read_b64_tr_b16 a[24:25], v10 offset:28672
v_mfma_f32_16x16x32_bf16 v[48:51], a[40:43], v[100:103], v[48:51]
ds_read_b64_tr_b16 a[26:27], v10 offset:30720
v_mfma_f32_16x16x32_bf16 v[36:39], a[44:47], v[96:99], v[36:39]
ds_read_b64_tr_b16 a[28:29], v11 offset:28672
ds_read_b64_tr_b16 a[30:31], v11 offset:30720
v_mfma_f32_16x16x32_bf16 v[52:55], a[44:47], v[100:103], v[52:55]
s_cbranch_vccnz L_o3_rt
L_o3_ok:
s_waitcnt lgkmcnt(8)
v_mfma_f32_16x16x32_bf16 v[24:27], a[0:3], v[104:107], v[24:27]
ds_read_b64_tr_b16 a[32:33], v8 offset:32768
ds_read_b64_tr_b16 a[34:35], v8 offset:34816
v_mfma_f32_16x16x32_bf16 v[40:43], a[0:3], v[108:111], v[40:43]
buffer_load_dwordx4 v[88:91], v6, s[12:15], s30 offen offset:0 sc1
v_mfma_f32_16x16x32_bf16 v[28:31], a[4:7], v[104:107], v[28:31]
ds_read_b64_tr_b16 a[36:37], v9 offset:32768
ds_read_b64_tr_b16 a[38:39], v9 offset:34816
v_mfma_f32_16x16x32_bf16 v[44:47], a[4:7], v[108:111], v[44:47]
buffer_load_dwordx4 v[92:95], v19, s[12:15], s30 offen offset:0 sc1
v_mfma_f32_16x16x32_bf16 v[32:35], a[8:11], v[104:107], v[32:35]
ds_read_b64_tr_b16 a[40:41], v10 offset:32768
ds_read_b64_tr_b16 a[42:43], v10 offset:34816
v_mfma_f32_16x16x32_bf16 v[48:51], a[8:11], v[108:111], v[48:51]
buffer_load_dwordx4 v[96:99], v6, s[12:15], s30 offen offset:1024 sc1
v_mfma_f32_16x16x32_bf16 v[36:39], a[12:15], v[104:107], v[36:39]
ds_read_b64_tr_b16 a[44:45], v11 offset:32768
ds_read_b64_tr_b16 a[46:47], v11 offset:34816
v_mfma_f32_16x16x32_bf16 v[52:55], a[12:15], v[108:111], v[52:55]
buffer_load_dwordx4 v[100:103], v19, s[12:15], s30 offen offset:1024 sc1
s_waitcnt lgkmcnt(8)
v_mfma_f32_16x16x32_bf16 v[24:27], a[16:19], v[112:115], v[24:27]
ds_read_b64_tr_b16 a[0:1], v8 offset:36864
s_waitcnt vmcnt(8)
v_mfma_f32_16x16x32_bf16 v[40:43], a[16:19], v[116:119], v[40:43]
ds_read_b64_tr_b16 a[2:3], v8 offset:38912
v_max3_u32 v2, v56, v60, v64
v_mfma_f32_16x16x32_bf16 v[28:31], a[20:23], v[112:115], v[28:31]
ds_read_b64_tr_b16 a[4:5], v9 offset:36864
v_max_u32 v2, v2, v68
v_mfma_f32_16x16x32_bf16 v[44:47], a[20:23], v[116:119], v[44:47]
ds_read_b64_tr_b16 a[6:7], v9 offset:38912
v_cmp_eq_u32 vcc, -1, v2
v_mfma_f32_16x16x32_bf16 v[32:35], a[24:27], v[112:115], v[32:35]
ds_read_b64_tr_b16 a[8:9], v10 offset:36864
v_mfma_f32_16x16x32_bf16 v[48:51], a[24:27], v[116:119], v[48:51]
ds_read_b64_tr_b16 a[10:11], v10 offset:38912
v_mfma_f32_16x16x32_bf16 v[36:39], a[28:31], v[112:115], v[36:39]
ds_read_b64_tr_b16 a[12:13], v11 offset:36864
ds_read_b64_tr_b16 a[14:15], v11 offset:38912
v_mfma_f32_16x16x32_bf16 v[52:55], a[28:31], v[116:119], v[52:55]
s_cbranch_vccnz L_o4_rt
L_o4_ok:
s_waitcnt lgkmcnt(8)
v_mfma_f32_16x16x32_bf16 v[24:27], a[32:35], v[56:59], v[24:27]
ds_read_b64_tr_b16 a[16:17], v8 offset:40960
ds_read_b64_tr_b16 a[18:19], v8 offset:43008
v_mfma_f32_16x16x32_bf16 v[40:43], a[32:35], v[60:63], v[40:43]
buffer_load_dwordx4 v[104:107], v6, s[12:15], s31 offen offset:0 sc1
v_mfma_f32_16x16x32_bf16 v[28:31], a[36:39], v[56:59], v[28:31]
ds_read_b64_tr_b16 a[20:21], v9 offset:40960
ds_read_b64_tr_b16 a[22:23], v9 offset:43008
v_mfma_f32_16x16x32_bf16 v[44:47], a[36:39], v[60:63], v[44:47]
buffer_load_dwordx4 v[108:111], v19, s[12:15], s31 offen offset:0 sc1
v_mfma_f32_16x16x32_bf16 v[32:35], a[40:43], v[56:59], v[32:35]
ds_read_b64_tr_b16 a[24:25], v10 offset:40960
ds_read_b64_tr_b16 a[26:27], v10 offset:43008
v_mfma_f32_16x16x32_bf16 v[48:51], a[40:43], v[60:63], v[48:51]
buffer_load_dwordx4 v[112:115], v6, s[12:15], s31 offen offset:1024 sc1
v_mfma_f32_16x16x32_bf16 v[36:39], a[44:47], v[56:59], v[36:39]
ds_read_b64_tr_b16 a[28:29], v11 offset:40960
ds_read_b64_tr_b16 a[30:31], v11 offset:43008
v_mfma_f32_16x16x32_bf16 v[52:55], a[44:47], v[60:63], v[52:55]
buffer_load_dwordx4 v[116:119], v19, s[12:15], s31 offen offset:1024 sc1
s_waitcnt lgkmcnt(8)
v_mfma_f32_16x16x32_bf16 v[24:27], a[0:3], v[64:67], v[24:27]
ds_read_b64_tr_b16 a[32:33], v8 offset:45056
s_waitcnt vmcnt(8)
v_mfma_f32_16x16x32_bf16 v[40:43], a[0:3], v[68:71], v[40:43]
ds_read_b64_tr_b16 a[34:35], v8 offset:47104
v_max3_u32 v2, v72, v76, v80
v_mfma_f32_16x16x32_bf16 v[28:31], a[4:7], v[64:67], v[28:31]
ds_read_b64_tr_b16 a[36:37], v9 offset:45056
v_max_u32 v2, v2, v84
v_mfma_f32_16x16x32_bf16 v[44:47], a[4:7], v[68:71], v[44:47]
ds_read_b64_tr_b16 a[38:39], v9 offset:47104
v_cmp_eq_u32 vcc, -1, v2
v_mfma_f32_16x16x32_bf16 v[32:35], a[8:11], v[64:67], v[32:35]
ds_read_b64_tr_b16 a[40:41], v10 offset:45056
v_mfma_f32_16x16x32_bf16 v[48:51], a[8:11], v[68:71], v[48:51]
ds_read_b64_tr_b16 a[42:43], v10 offset:47104
v_mfma_f32_16x16x32_bf16 v[36:39], a[12:15], v[64:67], v[36:39]
ds_read_b64_tr_b16 a[44:45], v11 offset:45056
ds_read_b64_tr_b16 a[46:47], v11 offset:47104
v_mfma_f32_16x16x32_bf16 v[52:55], a[12:15], v[68:71], v[52:55]
s_cbranch_vccnz L_o5_rt
L_o5_ok:
s_waitcnt lgkmcnt(8)
v_mfma_f32_16x16x32_bf16 v[24:27], a[16:19], v[72:75], v[24:27]
ds_read_b64_tr_b16 a[0:1], v8 offset:49152
ds_read_b64_tr_b16 a[2:3], v8 offset:51200
v_mfma_f32_16x16x32_bf16 v[40:43], a[16:19], v[76:79], v[40:43]
buffer_load_dwordx4 v[56:59], v6, s[12:15], s32 offen offset:0 sc1
v_mfma_f32_16x16x32_bf16 v[28:31], a[20:23], v[72:75], v[28:31]
ds_read_b64_tr_b16 a[4:5], v9 offset:49152
ds_read_b64_tr_b16 a[6:7], v9 offset:51200
v_mfma_f32_16x16x32_bf16 v[44:47], a[20:23], v[76:79], v[44:47]
buffer_load_dwordx4 v[60:63], v19, s[12:15], s32 offen offset:0 sc1
v_mfma_f32_16x16x32_bf16 v[32:35], a[24:27], v[72:75], v[32:35]
ds_read_b64_tr_b16 a[8:9], v10 offset:49152
ds_read_b64_tr_b16 a[10:11], v10 offset:51200
v_mfma_f32_16x16x32_bf16 v[48:51], a[24:27], v[76:79], v[48:51]
buffer_load_dwordx4 v[64:67], v6, s[12:15], s32 offen offset:1024 sc1
v_mfma_f32_16x16x32_bf16 v[36:39], a[28:31], v[72:75], v[36:39]
ds_read_b64_tr_b16 a[12:13], v11 offset:49152
ds_read_b64_tr_b16 a[14:15], v11 offset:51200
v_mfma_f32_16x16x32_bf16 v[52:55], a[28:31], v[76:79], v[52:55]
buffer_load_dwordx4 v[68:71], v19, s[12:15], s32 offen offset:1024 sc1
s_waitcnt lgkmcnt(8)
v_mfma_f32_16x16x32_bf16 v[24:27], a[32:35], v[80:83], v[24:27]
ds_read_b64_tr_b16 a[16:17], v8 offset:53248
s_waitcnt vmcnt(8)
v_mfma_f32_16x16x32_bf16 v[40:43], a[32:35], v[84:87], v[40:43]
ds_read_b64_tr_b16 a[18:19], v8 offset:55296
v_max3_u32 v2, v88, v92, v96
v_mfma_f32_16x16x32_bf16 v[28:31], a[36:39], v[80:83], v[28:31]
ds_read_b64_tr_b16 a[20:21], v9 offset:53248
v_max_u32 v2, v2, v100
v_mfma_f32_16x16x32_bf16 v[44:47], a[36:39], v[84:87], v[44:47]
ds_read_b64_tr_b16 a[22:23], v9 offset:55296
v_cmp_eq_u32 vcc, -1, v2
v_mfma_f32_16x16x32_bf16 v[32:35], a[40:43], v[80:83], v[32:35]
ds_read_b64_tr_b16 a[24:25], v10 offset:53248
v_mfma_f32_16x16x32_bf16 v[48:51], a[40:43], v[84:87], v[48:51]
ds_read_b64_tr_b16 a[26:27], v10 offset:55296
v_mfma_f32_16x16x32_bf16 v[36:39], a[44:47], v[80:83], v[36:39]
ds_read_b64_tr_b16 a[28:29], v11 offset:53248
ds_read_b64_tr_b16 a[30:31], v11 offset:55296
v_mfma_f32_16x16x32_bf16 v[52:55], a[44:47], v[84:87], v[52:55]
s_cbranch_vccnz L_o6_rt
L_o6_ok:
s_waitcnt lgkmcnt(8)
v_mfma_f32_16x16x32_bf16 v[24:27], a[0:3], v[88:91], v[24:27]
ds_read_b64_tr_b16 a[32:33], v8 offset:57344
ds_read_b64_tr_b16 a[34:35], v8 offset:59392
v_mfma_f32_16x16x32_bf16 v[40:43], a[0:3], v[92:95], v[40:43]
buffer_load_dwordx4 v[72:75], v6, s[12:15], s33 offen offset:0 sc1
v_mfma_f32_16x16x32_bf16 v[28:31], a[4:7], v[88:91], v[28:31]
ds_read_b64_tr_b16 a[36:37], v9 offset:57344
ds_read_b64_tr_b16 a[38:39], v9 offset:59392
v_mfma_f32_16x16x32_bf16 v[44:47], a[4:7], v[92:95], v[44:47]
buffer_load_dwordx4 v[76:79], v19, s[12:15], s33 offen offset:0 sc1
v_mfma_f32_16x16x32_bf16 v[32:35], a[8:11], v[88:91], v[32:35]
ds_read_b64_tr_b16 a[40:41], v10 offset:57344
ds_read_b64_tr_b16 a[42:43], v10 offset:59392
v_mfma_f32_16x16x32_bf16 v[48:51], a[8:11], v[92:95], v[48:51]
buffer_load_dwordx4 v[80:83], v6, s[12:15], s33 offen offset:1024 sc1
v_mfma_f32_16x16x32_bf16 v[36:39], a[12:15], v[88:91], v[36:39]
ds_read_b64_tr_b16 a[44:45], v11 offset:57344
ds_read_b64_tr_b16 a[46:47], v11 offset:59392
v_mfma_f32_16x16x32_bf16 v[52:55], a[12:15], v[92:95], v[52:55]
buffer_load_dwordx4 v[84:87], v19, s[12:15], s33 offen offset:1024 sc1
s_waitcnt lgkmcnt(8)
v_mfma_f32_16x16x32_bf16 v[24:27], a[16:19], v[96:99], v[24:27]
ds_read_b64_tr_b16 a[0:1], v8 offset:61440
s_waitcnt vmcnt(8)
v_mfma_f32_16x16x32_bf16 v[40:43], a[16:19], v[100:103], v[40:43]
ds_read_b64_tr_b16 a[2:3], v8 offset:63488
v_max3_u32 v2, v104, v108, v112
v_mfma_f32_16x16x32_bf16 v[28:31], a[20:23], v[96:99], v[28:31]
ds_read_b64_tr_b16 a[4:5], v9 offset:61440
v_max_u32_e64 v2, v2, v116
v_mfma_f32_16x16x32_bf16 v[44:47], a[20:23], v[100:103], v[44:47]
ds_read_b64_tr_b16 a[6:7], v9 offset:63488
v_cmp_eq_u32 vcc, -1, v2
v_mfma_f32_16x16x32_bf16 v[32:35], a[24:27], v[96:99], v[32:35]
ds_read_b64_tr_b16 a[8:9], v10 offset:61440
v_mfma_f32_16x16x32_bf16 v[48:51], a[24:27], v[100:103], v[48:51]
ds_read_b64_tr_b16 a[10:11], v10 offset:63488
v_mfma_f32_16x16x32_bf16 v[36:39], a[28:31], v[96:99], v[36:39]
ds_read_b64_tr_b16 a[12:13], v11 offset:61440
ds_read_b64_tr_b16 a[14:15], v11 offset:63488
v_mfma_f32_16x16x32_bf16 v[52:55], a[28:31], v[100:103], v[52:55]
s_cbranch_vccnz L_o7_rt
L_o7_ok:
s_waitcnt lgkmcnt(8)
v_mfma_f32_16x16x32_bf16 v[24:27], a[32:35], v[104:107], v[24:27]
s_barrier
ds_read_b64_tr_b16 a[16:17], v12 offset:0
ds_read_b64_tr_b16 a[18:19], v12 offset:2048
v_mfma_f32_16x16x32_bf16 v[40:43], a[32:35], v[108:111], v[40:43]
buffer_load_dwordx4 v[88:91], v6, s[12:15], s34 offen offset:0 sc1
v_mfma_f32_16x16x32_bf16 v[28:31], a[36:39], v[104:107], v[28:31]
ds_read_b64_tr_b16 a[20:21], v13 offset:0
ds_read_b64_tr_b16 a[22:23], v13 offset:2048
v_mfma_f32_16x16x32_bf16 v[44:47], a[36:39], v[108:111], v[44:47]
buffer_load_dwordx4 v[92:95], v19, s[12:15], s34 offen offset:0 sc1
v_mfma_f32_16x16x32_bf16 v[32:35], a[40:43], v[104:107], v[32:35]
ds_read_b64_tr_b16 a[24:25], v14 offset:0
ds_read_b64_tr_b16 a[26:27], v14 offset:2048
v_mfma_f32_16x16x32_bf16 v[48:51], a[40:43], v[108:111], v[48:51]
buffer_load_dwordx4 v[96:99], v6, s[12:15], s34 offen offset:1024 sc1
v_mfma_f32_16x16x32_bf16 v[36:39], a[44:47], v[104:107], v[36:39]
ds_read_b64_tr_b16 a[28:29], v15 offset:0
ds_read_b64_tr_b16 a[30:31], v15 offset:2048
v_mfma_f32_16x16x32_bf16 v[52:55], a[44:47], v[108:111], v[52:55]
buffer_load_dwordx4 v[100:103], v19, s[12:15], s34 offen offset:1024 sc1
s_waitcnt lgkmcnt(8)
v_mfma_f32_16x16x32_bf16 v[24:27], a[0:3], v[112:115], v[24:27]
ds_read_b64_tr_b16 a[32:33], v12 offset:4096
s_waitcnt vmcnt(8)
v_mfma_f32_16x16x32_bf16 v[40:43], a[0:3], v[116:119], v[40:43]
ds_read_b64_tr_b16 a[34:35], v12 offset:6144
v_max3_u32 v2, v56, v60, v64
v_mfma_f32_16x16x32_bf16 v[28:31], a[4:7], v[112:115], v[28:31]
ds_read_b64_tr_b16 a[36:37], v13 offset:4096
v_max_u32 v2, v2, v68
v_mfma_f32_16x16x32_bf16 v[44:47], a[4:7], v[116:119], v[44:47]
ds_read_b64_tr_b16 a[38:39], v13 offset:6144
v_cmp_eq_u32 vcc, -1, v2
v_mfma_f32_16x16x32_bf16 v[32:35], a[8:11], v[112:115], v[32:35]
ds_read_b64_tr_b16 a[40:41], v14 offset:4096
v_mfma_f32_16x16x32_bf16 v[48:51], a[8:11], v[116:119], v[48:51]
ds_read_b64_tr_b16 a[42:43], v14 offset:6144
v_mfma_f32_16x16x32_bf16 v[36:39], a[12:15], v[112:115], v[36:39]
ds_read_b64_tr_b16 a[44:45], v15 offset:4096
ds_read_b64_tr_b16 a[46:47], v15 offset:6144
v_mfma_f32_16x16x32_bf16 v[52:55], a[12:15], v[116:119], v[52:55]
s_cbranch_vccnz L_o8_rt
L_o8_ok:
s_waitcnt lgkmcnt(8)
v_mfma_f32_16x16x32_bf16 v[24:27], a[16:19], v[56:59], v[24:27]
ds_read_b64_tr_b16 a[0:1], v12 offset:8192
ds_read_b64_tr_b16 a[2:3], v12 offset:10240
v_mfma_f32_16x16x32_bf16 v[40:43], a[16:19], v[60:63], v[40:43]
buffer_load_dwordx4 v[104:107], v6, s[12:15], s35 offen offset:0 sc1
s_branch L_over7
L_pad7:
s_branch L_pad12
L_over7:
v_mfma_f32_16x16x32_bf16 v[28:31], a[20:23], v[56:59], v[28:31]
ds_read_b64_tr_b16 a[4:5], v13 offset:8192
ds_read_b64_tr_b16 a[6:7], v13 offset:10240
v_mfma_f32_16x16x32_bf16 v[44:47], a[20:23], v[60:63], v[44:47]
buffer_load_dwordx4 v[108:111], v19, s[12:15], s35 offen offset:0 sc1
v_mfma_f32_16x16x32_bf16 v[32:35], a[24:27], v[56:59], v[32:35]
ds_read_b64_tr_b16 a[8:9], v14 offset:8192
ds_read_b64_tr_b16 a[10:11], v14 offset:10240
v_mfma_f32_16x16x32_bf16 v[48:51], a[24:27], v[60:63], v[48:51]
buffer_load_dwordx4 v[112:115], v6, s[12:15], s35 offen offset:1024 sc1
v_mfma_f32_16x16x32_bf16 v[36:39], a[28:31], v[56:59], v[36:39]
ds_read_b64_tr_b16 a[12:13], v15 offset:8192
ds_read_b64_tr_b16 a[14:15], v15 offset:10240
v_mfma_f32_16x16x32_bf16 v[52:55], a[28:31], v[60:63], v[52:55]
buffer_load_dwordx4 v[116:119], v19, s[12:15], s35 offen offset:1024 sc1
s_waitcnt lgkmcnt(8)
v_mfma_f32_16x16x32_bf16 v[24:27], a[32:35], v[64:67], v[24:27]
ds_read_b64_tr_b16 a[16:17], v12 offset:12288
s_waitcnt vmcnt(8)
v_mfma_f32_16x16x32_bf16 v[40:43], a[32:35], v[68:71], v[40:43]
ds_read_b64_tr_b16 a[18:19], v12 offset:14336
v_max3_u32 v2, v72, v76, v80
v_mfma_f32_16x16x32_bf16 v[28:31], a[36:39], v[64:67], v[28:31]
ds_read_b64_tr_b16 a[20:21], v13 offset:12288
v_max_u32 v2, v2, v84
v_mfma_f32_16x16x32_bf16 v[44:47], a[36:39], v[68:71], v[44:47]
ds_read_b64_tr_b16 a[22:23], v13 offset:14336
v_cmp_eq_u32 vcc, -1, v2
v_mfma_f32_16x16x32_bf16 v[32:35], a[40:43], v[64:67], v[32:35]
ds_read_b64_tr_b16 a[24:25], v14 offset:12288
v_mfma_f32_16x16x32_bf16 v[48:51], a[40:43], v[68:71], v[48:51]
ds_read_b64_tr_b16 a[26:27], v14 offset:14336
v_mfma_f32_16x16x32_bf16 v[36:39], a[44:47], v[64:67], v[36:39]
ds_read_b64_tr_b16 a[28:29], v15 offset:12288
ds_read_b64_tr_b16 a[30:31], v15 offset:14336
v_mfma_f32_16x16x32_bf16 v[52:55], a[44:47], v[68:71], v[52:55]
s_cbranch_vccnz L_o9_rt
L_o9_ok:
s_waitcnt lgkmcnt(8)
v_mfma_f32_16x16x32_bf16 v[24:27], a[0:3], v[72:75], v[24:27]
ds_read_b64_tr_b16 a[32:33], v12 offset:16384
ds_read_b64_tr_b16 a[34:35], v12 offset:18432
v_mfma_f32_16x16x32_bf16 v[40:43], a[0:3], v[76:79], v[40:43]
buffer_load_dwordx4 v[56:59], v6, s[12:15], s36 offen offset:0 sc1
v_mfma_f32_16x16x32_bf16 v[28:31], a[4:7], v[72:75], v[28:31]
ds_read_b64_tr_b16 a[36:37], v13 offset:16384
ds_read_b64_tr_b16 a[38:39], v13 offset:18432
v_mfma_f32_16x16x32_bf16 v[44:47], a[4:7], v[76:79], v[44:47]
buffer_load_dwordx4 v[60:63], v19, s[12:15], s36 offen offset:0 sc1
v_mfma_f32_16x16x32_bf16 v[32:35], a[8:11], v[72:75], v[32:35]
ds_read_b64_tr_b16 a[40:41], v14 offset:16384
ds_read_b64_tr_b16 a[42:43], v14 offset:18432
v_mfma_f32_16x16x32_bf16 v[48:51], a[8:11], v[76:79], v[48:51]
buffer_load_dwordx4 v[64:67], v6, s[12:15], s36 offen offset:1024 sc1
v_mfma_f32_16x16x32_bf16 v[36:39], a[12:15], v[72:75], v[36:39]
ds_read_b64_tr_b16 a[44:45], v15 offset:16384
ds_read_b64_tr_b16 a[46:47], v15 offset:18432
v_mfma_f32_16x16x32_bf16 v[52:55], a[12:15], v[76:79], v[52:55]
buffer_load_dwordx4 v[68:71], v19, s[12:15], s36 offen offset:1024 sc1
s_waitcnt lgkmcnt(8)
v_mfma_f32_16x16x32_bf16 v[24:27], a[16:19], v[80:83], v[24:27]
ds_read_b64_tr_b16 a[0:1], v12 offset:20480
s_waitcnt vmcnt(8)
v_mfma_f32_16x16x32_bf16 v[40:43], a[16:19], v[84:87], v[40:43]
ds_read_b64_tr_b16 a[2:3], v12 offset:22528
v_max3_u32 v2, v88, v92, v96
v_mfma_f32_16x16x32_bf16 v[28:31], a[20:23], v[80:83], v[28:31]
ds_read_b64_tr_b16 a[4:5], v13 offset:20480
v_max_u32 v2, v2, v100
v_mfma_f32_16x16x32_bf16 v[44:47], a[20:23], v[84:87], v[44:47]
ds_read_b64_tr_b16 a[6:7], v13 offset:22528
v_cmp_eq_u32 vcc, -1, v2
v_mfma_f32_16x16x32_bf16 v[32:35], a[24:27], v[80:83], v[32:35]
ds_read_b64_tr_b16 a[8:9], v14 offset:20480
v_mfma_f32_16x16x32_bf16 v[48:51], a[24:27], v[84:87], v[48:51]
ds_read_b64_tr_b16 a[10:11], v14 offset:22528
v_mfma_f32_16x16x32_bf16 v[36:39], a[28:31], v[80:83], v[36:39]
ds_read_b64_tr_b16 a[12:13], v15 offset:20480
ds_read_b64_tr_b16 a[14:15], v15 offset:22528
v_mfma_f32_16x16x32_bf16 v[52:55], a[28:31], v[84:87], v[52:55]
s_cbranch_vccnz L_o10_rt
L_o10_ok:
s_waitcnt lgkmcnt(8)
v_mfma_f32_16x16x32_bf16 v[24:27], a[32:35], v[88:91], v[24:27]
ds_read_b64_tr_b16 a[16:17], v12 offset:24576
ds_read_b64_tr_b16 a[18:19], v12 offset:26624
v_mfma_f32_16x16x32_bf16 v[40:43], a[32:35], v[92:95], v[40:43]
buffer_load_dwordx4 v[72:75], v6, s[12:15], s37 offen offset:0 sc1
v_mfma_f32_16x16x32_bf16 v[28:31], a[36:39], v[88:91], v[28:31]
ds_read_b64_tr_b16 a[20:21], v13 offset:24576
ds_read_b64_tr_b16 a[22:23], v13 offset:26624
v_mfma_f32_16x16x32_bf16 v[44:47], a[36:39], v[92:95], v[44:47]
buffer_load_dwordx4 v[76:79], v19, s[12:15], s37 offen offset:0 sc1
v_mfma_f32_16x16x32_bf16 v[32:35], a[40:43], v[88:91], v[32:35]
ds_read_b64_tr_b16 a[24:25], v14 offset:24576
ds_read_b64_tr_b16 a[26:27], v14 offset:26624
v_mfma_f32_16x16x32_bf16 v[48:51], a[40:43], v[92:95], v[48:51]
buffer_load_dwordx4 v[80:83], v6, s[12:15], s37 offen offset:1024 sc1
v_mfma_f32_16x16x32_bf16 v[36:39], a[44:47], v[88:91], v[36:39]
ds_read_b64_tr_b16 a[28:29], v15 offset:24576
ds_read_b64_tr_b16 a[30:31], v15 offset:26624
v_mfma_f32_16x16x32_bf16 v[52:55], a[44:47], v[92:95], v[52:55]
buffer_load_dwordx4 v[84:87], v19, s[12:15], s37 offen offset:1024 sc1
s_waitcnt lgkmcnt(8)
v_mfma_f32_16x16x32_bf16 v[24:27], a[0:3], v[96:99], v[24:27]
ds_read_b64_tr_b16 a[32:33], v12 offset:28672
s_waitcnt vmcnt(8)
v_mfma_f32_16x16x32_bf16 v[40:43], a[0:3], v[100:103], v[40:43]
ds_read_b64_tr_b16 a[34:35], v12 offset:30720
v_max3_u32 v2, v104, v108, v112
v_mfma_f32_16x16x32_bf16 v[28:31], a[4:7], v[96:99], v[28:31]
ds_read_b64_tr_b16 a[36:37], v13 offset:28672
v_max_u32 v2, v2, v116
v_mfma_f32_16x16x32_bf16 v[44:47], a[4:7], v[100:103], v[44:47]
ds_read_b64_tr_b16 a[38:39], v13 offset:30720
v_cmp_eq_u32 vcc, -1, v2
v_mfma_f32_16x16x32_bf16 v[32:35], a[8:11], v[96:99], v[32:35]
ds_read_b64_tr_b16 a[40:41], v14 offset:28672
v_mfma_f32_16x16x32_bf16 v[48:51], a[8:11], v[100:103], v[48:51]
ds_read_b64_tr_b16 a[42:43], v14 offset:30720
v_mfma_f32_16x16x32_bf16 v[36:39], a[12:15], v[96:99], v[36:39]
ds_read_b64_tr_b16 a[44:45], v15 offset:28672
ds_read_b64_tr_b16 a[46:47], v15 offset:30720
v_mfma_f32_16x16x32_bf16 v[52:55], a[12:15], v[100:103], v[52:55]
s_cbranch_vccnz L_o11_rt
L_o11_ok:
s_waitcnt lgkmcnt(8)
v_mfma_f32_16x16x32_bf16 v[24:27], a[16:19], v[104:107], v[24:27]
ds_read_b64_tr_b16 a[0:1], v12 offset:32768
ds_read_b64_tr_b16 a[2:3], v12 offset:34816
v_mfma_f32_16x16x32_bf16 v[40:43], a[16:19], v[108:111], v[40:43]
buffer_load_dwordx4 v[88:91], v6, s[12:15], s38 offen offset:0 sc1
v_mfma_f32_16x16x32_bf16 v[28:31], a[20:23], v[104:107], v[28:31]
ds_read_b64_tr_b16 a[4:5], v13 offset:32768
ds_read_b64_tr_b16 a[6:7], v13 offset:34816
v_mfma_f32_16x16x32_bf16 v[44:47], a[20:23], v[108:111], v[44:47]
buffer_load_dwordx4 v[92:95], v19, s[12:15], s38 offen offset:0 sc1
v_mfma_f32_16x16x32_bf16 v[32:35], a[24:27], v[104:107], v[32:35]
ds_read_b64_tr_b16 a[8:9], v14 offset:32768
ds_read_b64_tr_b16 a[10:11], v14 offset:34816
v_mfma_f32_16x16x32_bf16 v[48:51], a[24:27], v[108:111], v[48:51]
buffer_load_dwordx4 v[96:99], v6, s[12:15], s38 offen offset:1024 sc1
v_mfma_f32_16x16x32_bf16 v[36:39], a[28:31], v[104:107], v[36:39]
ds_read_b64_tr_b16 a[12:13], v15 offset:32768
ds_read_b64_tr_b16 a[14:15], v15 offset:34816
v_mfma_f32_16x16x32_bf16 v[52:55], a[28:31], v[108:111], v[52:55]
buffer_load_dwordx4 v[100:103], v19, s[12:15], s38 offen offset:1024 sc1
s_waitcnt lgkmcnt(8)
v_mfma_f32_16x16x32_bf16 v[24:27], a[32:35], v[112:115], v[24:27]
ds_read_b64_tr_b16 a[16:17], v12 offset:36864
s_waitcnt vmcnt(8)
v_mfma_f32_16x16x32_bf16 v[40:43], a[32:35], v[116:119], v[40:43]
ds_read_b64_tr_b16 a[18:19], v12 offset:38912
v_max3_u32 v2, v56, v60, v64
v_mfma_f32_16x16x32_bf16 v[28:31], a[36:39], v[112:115], v[28:31]
ds_read_b64_tr_b16 a[20:21], v13 offset:36864
v_max_u32 v2, v2, v68
v_mfma_f32_16x16x32_bf16 v[44:47], a[36:39], v[116:119], v[44:47]
ds_read_b64_tr_b16 a[22:23], v13 offset:38912
v_cmp_eq_u32 vcc, -1, v2
v_mfma_f32_16x16x32_bf16 v[32:35], a[40:43], v[112:115], v[32:35]
ds_read_b64_tr_b16 a[24:25], v14 offset:36864
v_mfma_f32_16x16x32_bf16 v[48:51], a[40:43], v[116:119], v[48:51]
ds_read_b64_tr_b16 a[26:27], v14 offset:38912
v_mfma_f32_16x16x32_bf16 v[36:39], a[44:47], v[112:115], v[36:39]
ds_read_b64_tr_b16 a[28:29], v15 offset:36864
ds_read_b64_tr_b16 a[30:31], v15 offset:38912
v_mfma_f32_16x16x32_bf16 v[52:55], a[44:47], v[116:119], v[52:55]
s_cbranch_vccnz L_o12_rt
L_o12_ok:
s_waitcnt lgkmcnt(8)
v_mfma_f32_16x16x32_bf16 v[24:27], a[0:3], v[56:59], v[24:27]
ds_read_b64_tr_b16 a[32:33], v12 offset:40960
ds_read_b64_tr_b16 a[34:35], v12 offset:43008
v_mfma_f32_16x16x32_bf16 v[40:43], a[0:3], v[60:63], v[40:43]
buffer_load_dwordx4 v[104:107], v6, s[12:15], s39 offen offset:0 sc1
v_mfma_f32_16x16x32_bf16 v[28:31], a[4:7], v[56:59], v[28:31]
ds_read_b64_tr_b16 a[36:37], v13 offset:40960
ds_read_b64_tr_b16 a[38:39], v13 offset:43008
v_mfma_f32_16x16x32_bf16 v[44:47], a[4:7], v[60:63], v[44:47]
buffer_load_dwordx4 v[108:111], v19, s[12:15], s39 offen offset:0 sc1
v_mfma_f32_16x16x32_bf16 v[32:35], a[8:11], v[56:59], v[32:35]
ds_read_b64_tr_b16 a[40:41], v14 offset:40960
ds_read_b64_tr_b16 a[42:43], v14 offset:43008
v_mfma_f32_16x16x32_bf16 v[48:51], a[8:11], v[60:63], v[48:51]
buffer_load_dwordx4 v[112:115], v6, s[12:15], s39 offen offset:1024 sc1
v_mfma_f32_16x16x32_bf16 v[36:39], a[12:15], v[56:59], v[36:39]
ds_read_b64_tr_b16 a[44:45], v15 offset:40960
ds_read_b64_tr_b16 a[46:47], v15 offset:43008
v_mfma_f32_16x16x32_bf16 v[52:55], a[12:15], v[60:63], v[52:55]
buffer_load_dwordx4 v[116:119], v19, s[12:15], s39 offen offset:1024 sc1
s_waitcnt lgkmcnt(8)
v_mfma_f32_16x16x32_bf16 v[24:27], a[16:19], v[64:67], v[24:27]
ds_read_b64_tr_b16 a[0:1], v12 offset:45056
s_waitcnt vmcnt(8)
v_mfma_f32_16x16x32_bf16 v[40:43], a[16:19], v[68:71], v[40:43]
ds_read_b64_tr_b16 a[2:3], v12 offset:47104
v_max3_u32 v2, v72, v76, v80
v_mfma_f32_16x16x32_bf16 v[28:31], a[20:23], v[64:67], v[28:31]
ds_read_b64_tr_b16 a[4:5], v13 offset:45056
v_max_u32 v2, v2, v84
v_mfma_f32_16x16x32_bf16 v[44:47], a[20:23], v[68:71], v[44:47]
ds_read_b64_tr_b16 a[6:7], v13 offset:47104
v_cmp_eq_u32 vcc, -1, v2
v_mfma_f32_16x16x32_bf16 v[32:35], a[24:27], v[64:67], v[32:35]
ds_read_b64_tr_b16 a[8:9], v14 offset:45056
v_mfma_f32_16x16x32_bf16 v[48:51], a[24:27], v[68:71], v[48:51]
ds_read_b64_tr_b16 a[10:11], v14 offset:47104
v_mfma_f32_16x16x32_bf16 v[36:39], a[28:31], v[64:67], v[36:39]
ds_read_b64_tr_b16 a[12:13], v15 offset:45056
ds_read_b64_tr_b16 a[14:15], v15 offset:47104
v_mfma_f32_16x16x32_bf16 v[52:55], a[28:31], v[68:71], v[52:55]
s_cbranch_vccnz L_o13_rt
L_o13_ok:
s_waitcnt lgkmcnt(8)
v_mfma_f32_16x16x32_bf16 v[24:27], a[32:35], v[72:75], v[24:27]
ds_read_b64_tr_b16 a[16:17], v12 offset:49152
ds_read_b64_tr_b16 a[18:19], v12 offset:51200
v_mfma_f32_16x16x32_bf16 v[40:43], a[32:35], v[76:79], v[40:43]
v_mfma_f32_16x16x32_bf16 v[28:31], a[36:39], v[72:75], v[28:31]
ds_read_b64_tr_b16 a[20:21], v13 offset:49152
ds_read_b64_tr_b16 a[22:23], v13 offset:51200
v_mfma_f32_16x16x32_bf16 v[44:47], a[36:39], v[76:79], v[44:47]
v_mfma_f32_16x16x32_bf16 v[32:35], a[40:43], v[72:75], v[32:35]
ds_read_b64_tr_b16 a[24:25], v14 offset:49152
ds_read_b64_tr_b16 a[26:27], v14 offset:51200
v_mfma_f32_16x16x32_bf16 v[48:51], a[40:43], v[76:79], v[48:51]
v_mfma_f32_16x16x32_bf16 v[36:39], a[44:47], v[72:75], v[36:39]
ds_read_b64_tr_b16 a[28:29], v15 offset:49152
ds_read_b64_tr_b16 a[30:31], v15 offset:51200
v_mfma_f32_16x16x32_bf16 v[52:55], a[44:47], v[76:79], v[52:55]
s_waitcnt lgkmcnt(8)
v_mfma_f32_16x16x32_bf16 v[24:27], a[0:3], v[80:83], v[24:27]
ds_read_b64_tr_b16 a[32:33], v12 offset:53248
s_waitcnt vmcnt(4)
v_mfma_f32_16x16x32_bf16 v[40:43], a[0:3], v[84:87], v[40:43]
ds_read_b64_tr_b16 a[34:35], v12 offset:55296
v_max3_u32 v2, v88, v92, v96
v_mfma_f32_16x16x32_bf16 v[28:31], a[4:7], v[80:83], v[28:31]
ds_read_b64_tr_b16 a[36:37], v13 offset:53248
v_max_u32 v2, v2, v100
v_mfma_f32_16x16x32_bf16 v[44:47], a[4:7], v[84:87], v[44:47]
ds_read_b64_tr_b16 a[38:39], v13 offset:55296
v_cmp_eq_u32 vcc, -1, v2
v_mfma_f32_16x16x32_bf16 v[32:35], a[8:11], v[80:83], v[32:35]
ds_read_b64_tr_b16 a[40:41], v14 offset:53248
v_mfma_f32_16x16x32_bf16 v[48:51], a[8:11], v[84:87], v[48:51]
ds_read_b64_tr_b16 a[42:43], v14 offset:55296
v_mfma_f32_16x16x32_bf16 v[36:39], a[12:15], v[80:83], v[36:39]
ds_read_b64_tr_b16 a[44:45], v15 offset:53248
ds_read_b64_tr_b16 a[46:47], v15 offset:55296
v_mfma_f32_16x16x32_bf16 v[52:55], a[12:15], v[84:87], v[52:55]
s_cbranch_vccnz L_o14_rt
L_o14_ok:
s_waitcnt lgkmcnt(8)
v_mfma_f32_16x16x32_bf16 v[24:27], a[16:19], v[88:91], v[24:27]
ds_read_b64_tr_b16 a[0:1], v12 offset:57344
ds_read_b64_tr_b16 a[2:3], v12 offset:59392
v_mfma_f32_16x16x32_bf16 v[40:43], a[16:19], v[92:95], v[40:43]
v_mfma_f32_16x16x32_bf16 v[28:31], a[20:23], v[88:91], v[28:31]
ds_read_b64_tr_b16 a[4:5], v13 offset:57344
ds_read_b64_tr_b16 a[6:7], v13 offset:59392
v_mfma_f32_16x16x32_bf16 v[44:47], a[20:23], v[92:95], v[44:47]
v_mfma_f32_16x16x32_bf16 v[32:35], a[24:27], v[88:91], v[32:35]
ds_read_b64_tr_b16 a[8:9], v14 offset:57344
ds_read_b64_tr_b16 a[10:11], v14 offset:59392
v_mfma_f32_16x16x32_bf16 v[48:51], a[24:27], v[92:95], v[48:51]
v_mfma_f32_16x16x32_bf16 v[36:39], a[28:31], v[88:91], v[36:39]
ds_read_b64_tr_b16 a[12:13], v15 offset:57344
ds_read_b64_tr_b16 a[14:15], v15 offset:59392
v_mfma_f32_16x16x32_bf16 v[52:55], a[28:31], v[92:95], v[52:55]
s_waitcnt lgkmcnt(8)
v_mfma_f32_16x16x32_bf16 v[24:27], a[32:35], v[96:99], v[24:27]
ds_read_b64_tr_b16 a[16:17], v12 offset:61440
s_waitcnt vmcnt(0)
v_mfma_f32_16x16x32_bf16 v[40:43], a[32:35], v[100:103], v[40:43]
ds_read_b64_tr_b16 a[18:19], v12 offset:63488
v_max3_u32 v2, v104, v108, v112
v_mfma_f32_16x16x32_bf16 v[28:31], a[36:39], v[96:99], v[28:31]
ds_read_b64_tr_b16 a[20:21], v13 offset:61440
v_max_u32 v2, v2, v116
v_mfma_f32_16x16x32_bf16 v[44:47], a[36:39], v[100:103], v[44:47]
ds_read_b64_tr_b16 a[22:23], v13 offset:63488
v_cmp_eq_u32 vcc, -1, v2
v_mfma_f32_16x16x32_bf16 v[32:35], a[40:43], v[96:99], v[32:35]
ds_read_b64_tr_b16 a[24:25], v14 offset:61440
v_mfma_f32_16x16x32_bf16 v[48:51], a[40:43], v[100:103], v[48:51]
ds_read_b64_tr_b16 a[26:27], v14 offset:63488
v_mfma_f32_16x16x32_bf16 v[36:39], a[44:47], v[96:99], v[36:39]
ds_read_b64_tr_b16 a[28:29], v15 offset:61440
ds_read_b64_tr_b16 a[30:31], v15 offset:63488
v_mfma_f32_16x16x32_bf16 v[52:55], a[44:47], v[100:103], v[52:55]
s_cbranch_vccnz L_o15_rt
L_o15_ok:
s_waitcnt lgkmcnt(8)
v_mfma_f32_16x16x32_bf16 v[24:27], a[0:3], v[104:107], v[24:27]
v_mfma_f32_16x16x32_bf16 v[40:43], a[0:3], v[108:111], v[40:43]
v_mfma_f32_16x16x32_bf16 v[28:31], a[4:7], v[104:107], v[28:31]
v_mfma_f32_16x16x32_bf16 v[44:47], a[4:7], v[108:111], v[44:47]
v_mfma_f32_16x16x32_bf16 v[32:35], a[8:11], v[104:107], v[32:35]
v_mfma_f32_16x16x32_bf16 v[48:51], a[8:11], v[108:111], v[48:51]
v_mfma_f32_16x16x32_bf16 v[36:39], a[12:15], v[104:107], v[36:39]
v_mfma_f32_16x16x32_bf16 v[52:55], a[12:15], v[108:111], v[52:55]
s_waitcnt lgkmcnt(0)
v_mfma_f32_16x16x32_bf16 v[24:27], a[16:19], v[112:115], v[24:27]
v_mfma_f32_16x16x32_bf16 v[40:43], a[16:19], v[116:119], v[40:43]
v_mfma_f32_16x16x32_bf16 v[28:31], a[20:23], v[112:115], v[28:31]
v_mfma_f32_16x16x32_bf16 v[44:47], a[20:23], v[116:119], v[44:47]
v_mfma_f32_16x16x32_bf16 v[32:35], a[24:27], v[112:115], v[32:35]
v_mfma_f32_16x16x32_bf16 v[48:51], a[24:27], v[116:119], v[48:51]
v_mfma_f32_16x16x32_bf16 v[36:39], a[28:31], v[112:115], v[36:39]
v_mfma_f32_16x16x32_bf16 v[52:55], a[28:31], v[116:119], v[52:55]
s_nop 0
v_cvt_pk_bf16_f32 v128, v24, v25
v_cvt_pk_bf16_f32 v129, v26, v27
v_cvt_pk_bf16_f32 v130, v28, v29
v_cvt_pk_bf16_f32 v131, v30, v31
v_cvt_pk_bf16_f32 v132, v32, v33
v_cvt_pk_bf16_f32 v133, v34, v35
v_cvt_pk_bf16_f32 v134, v36, v37
v_cvt_pk_bf16_f32 v135, v38, v39
v_cvt_pk_bf16_f32 v136, v40, v41
v_cvt_pk_bf16_f32 v137, v42, v43
v_cvt_pk_bf16_f32 v138, v44, v45
v_cvt_pk_bf16_f32 v139, v46, v47
v_cvt_pk_bf16_f32 v140, v48, v49
v_cvt_pk_bf16_f32 v141, v50, v51
v_cvt_pk_bf16_f32 v142, v52, v53
v_cvt_pk_bf16_f32 v143, v54, v55
v_mfma_f32_16x16x32_bf16 v[80:83], v[128:131], v[128:131], 0
v_mfma_f32_16x16x32_bf16 v[72:75], v[120:123], v[128:131], 0
v_mfma_f32_16x16x32_bf16 v[80:83], v[132:135], v[132:135], v[80:83]
v_mfma_f32_16x16x32_bf16 v[72:75], v[124:127], v[132:135], v[72:75]
v_mfma_f32_16x16x32_bf16 v[84:87], v[136:139], v[136:139], 0
v_mfma_f32_16x16x32_bf16 v[76:79], v[120:123], v[136:139], 0
v_mfma_f32_16x16x32_bf16 v[84:87], v[140:143], v[140:143], v[84:87]
v_mfma_f32_16x16x32_bf16 v[76:79], v[124:127], v[140:143], v[76:79]
s_nop 2
v_cndmask_b32_e64 v80, v80, v81, s[80:81]
v_cndmask_b32_e64 v82, v82, v83, s[90:91]
s_or_b64 vcc, s[82:83], s[90:91]
v_mov_b32 v75, s68
v_cndmask_b32 v73, v80, v82, vcc
v_cndmask_b32_e64 v84, v84, v85, s[80:81]
v_cndmask_b32_e64 v86, v86, v87, s[90:91]
s_or_b64 vcc, s[82:83], s[90:91]
v_mov_b32 v79, s68
v_cndmask_b32_e64 v77, v84, v86, vcc
s_mov_b64 exec, s[92:93]
s_cmp_eq_u32 s69, 0
s_cbranch_scc1 L_stp_s
buffer_store_dwordx4 v[72:75], v144, s[12:15], s72 offen offset:0
buffer_store_dwordx4 v[76:79], v144, s[12:15], s72 offen offset:256
L_stp_d:
s_mov_b64 exec, -1
s_barrier
s_add_u32 s70, s75, 0
buffer_load_dwordx4 v[96:99], v145, s[12:15], s70 offen sc1
s_add_u32 s70, s75, 4096
buffer_load_dwordx4 v[100:103], v145, s[12:15], s70 offen sc1
s_add_u32 s70, s75, 8192
buffer_load_dwordx4 v[104:107], v145, s[12:15], s70 offen sc1
s_add_u32 s70, s75, 12288
buffer_load_dwordx4 v[108:111], v145, s[12:15], s70 offen sc1
s_add_u32 s70, s75, 16384
buffer_load_dwordx4 v[112:115], v145, s[12:15], s70 offen sc1
s_add_u32 s70, s75, 20480
buffer_load_dwordx4 v[116:119], v145, s[12:15], s70 offen sc1
s_add_u32 s70, s75, 24576
buffer_load_dwordx4 v[120:123], v145, s[12:15], s70 offen sc1
s_add_u32 s70, s75, 28672
buffer_load_dwordx4 v[124:127], v145, s[12:15], s70 offen sc1
ds_write_b64 v20, v[128:129] offset:0
ds_write_b64 v21, v[130:131] offset:0
ds_write_b64 v22, v[132:133] offset:0
ds_write_b64 v23, v[134:135] offset:0
ds_write_b64 v20, v[136:137] offset:2048
ds_write_b64 v21, v[138:139] offset:2048
ds_write_b64 v22, v[140:141] offset:2048
ds_write_b64 v23, v[142:143] offset:2048
v_lshrrev_b32 v2, 3, v1
v_lshrrev_b32 v3, 4, v1
v_and_b32 v13, 7, v1
v_xor_b32 v3, v3, v13
v_lshlrev_b32 v3, 4, v3
v_lshl_add_u32 v3, v2, 7, v3
s_lshl_b32 s70, s60, 12
v_add_u32 v9, s70, v3
v_xor_b32 v10, 64, v9
v_lshlrev_b32 v11, 11, v2
v_lshl_add_u32 v11, v13, 4, v11
v_mov_b32 v12, v2
s_lshl_b32 s76, s60, 12
s_lshl_b32 s74, s64, 18
s_lshl_b32 s70, s60, 16
s_add_u32 s74, s74, s70
s_lshl_b32 s70, s65, 7
s_add_u32 s74, s74, s70
s_mov_b32 s80, 0xff00ff00
s_mov_b32 s81, 0xff00ff00
s_lshl_b32 s70, s60, 5
s_add_u32 s70, s70, 161920
v_mov_b32 v14, s70
v_add_u32 v15, 16, v14
v_add_u32 v8, 161920, v16
v_lshlrev_b32 v8, 4, v13
v_add_u32 v8, 161920, v8
v_xor_b32 v17, 8192, v11
v_xor_b32 v17, s61, v17
s_waitcnt vmcnt(0)
L_st_chk:
v_xor_b32 v88, s68, v99
v_xor_b32 v89, s68, v103
v_xor_b32 v90, s68, v107
v_xor_b32 v91, s68, v111
v_xor_b32 v92, s68, v115
v_xor_b32 v93, s68, v119
v_xor_b32 v94, s68, v123
v_xor_b32 v95, s68, v127
v_or3_b32 v88, v88, v89, v90
v_or3_b32 v91, v91, v92, v93
v_or3_b32 v88, v88, v94, v95
v_or_b32_e64 v88, v88, v91
v_cmp_ne_u32 vcc, 0, v88
s_cbranch_vccnz L_st_rt
L_st_ok:
v_pk_add_f32 v[96:97], v[96:97], v[100:101]
v_add_f32 v98, v98, v102
v_pk_add_f32 v[104:105], v[104:105], v[108:109]
v_add_f32 v106, v106, v110
v_pk_add_f32 v[112:113], v[112:113], v[116:117]
v_add_f32 v114, v114, v118
v_pk_add_f32 v[120:121], v[120:121], v[124:125]
v_add_f32 v122, v122, v126
v_pk_add_f32 v[96:97], v[96:97], v[104:105]
v_add_f32 v98, v98, v106
v_pk_add_f32 v[112:113], v[112:113], v[120:121]
v_add_f32 v114, v114, v122
v_pk_add_f32 v[96:97], v[96:97], v[112:113]
v_add_f32 v98, v98, v114
v_mov_b32 v100, v96
v_mov_b32 v101, v97
v_mov_b32 v102, v98
v_permlane32_swap_b32 v96, v100
v_permlane32_swap_b32 v97, v101
v_permlane32_swap_b32 v98, v102
v_add_f32 v96, v96, v100
v_add_f32 v97, v97, v101
v_add_f32 v98, v98, v102
v_mul_f32 v73, 0x3a800000, v96
v_mul_f32 v97, 0x3a800000, v97
v_fma_f32 v97, -v73, v73, v97
v_fma_f32 v98, -v73, s84, v98
v_max_f32 v97, 0, v97
v_add_f32 v97, 0x3727c5ac, v97
v_rsq_f32 v74, v97
v_mov_b32 v75, s68
v_mul_f32 v98, v98, v74
v_ashrrev_i32 v99, 31, v98
v_or_b32 v99, 0x80000000, v99
v_xor_b32 v98, v98, v99
s_mov_b32 s70, 0xfffff000
v_and_or_b32 v72, v98, s70, v146
s_nop 1
v_mov_b32_dpp v78, v72 row_ror:1 row_mask:0xf bank_mask:0xf
v_max_u32 v76, v72, v78
v_min_u32 v77, v72, v78
s_nop 0
v_mov_b32_dpp v78, v76 row_ror:2 row_mask:0xf bank_mask:0xf
v_max_u32_dpp v79, v77, v77 row_ror:2 row_mask:0xf bank_mask:0xf
v_med3_u32 v77, v76, v78, v79
v_max_u32 v76, v76, v78
s_nop 1
v_mov_b32_dpp v78, v76 row_ror:4 row_mask:0xf bank_mask:0xf
v_max_u32_dpp v79, v77, v77 row_ror:4 row_mask:0xf bank_mask:0xf
v_med3_u32 v77, v76, v78, v79
v_max_u32 v76, v76, v78
s_nop 1
v_mov_b32_dpp v78, v76 row_ror:8 row_mask:0xf bank_mask:0xf
v_max_u32_dpp v79, v77, v77 row_ror:8 row_mask:0xf bank_mask:0xf
v_med3_u32 v77, v76, v78, v79
v_max_u32 v76, v76, v78
v_mov_b32 v78, v76
v_mov_b32 v79, v77
s_nop 0
v_permlane16_swap_b32 v76, v78
v_permlane16_swap_b32 v77, v79
v_max_u32_e64 v79, v77, v79
v_med3_u32 v77, v76, v78, v79
v_max_u32 v76, v76, v78
v_cmp_eq_u32 vcc, v72, v77
v_cmp_eq_u32_e64 s[92:93], v72, v76
s_nop 0
v_cndmask_b32 v2, v14, v15, vcc
v_addc_co_u32_e64 v72, s[72:73], 0, v72, vcc
s_or_b64 exec, vcc, s[92:93]
ds_write_b128 v2, v[72:75]
s_mov_b64 exec, -1
v_cndmask_b32_e64 v5, v76, v77, s[80:81]
v_bfe_u32 v6, v5, 8, 3
v_bfe_u32 v5, v5, 7, 5
v_xor_b32_e64 v6, v6, v13
v_lshl_add_u32 v6, v6, 4, s76
v_lshl_add_u32 v6, v5, 7, v6
ds_read_b128 v[88:91], v6
v_readfirstlane_b32 s86, v77
v_readfirstlane_b32 s85, v76
v_add_f32 v80, 1.0, v74
v_mul_f32_e64 v56, -v73, v74
v_mov_b32 v82, v80
v_mov_b32 v58, v56
s_nop 0
v_permlane16_swap_b32 v80, v82
v_permlane16_swap_b32 v56, v58
s_waitcnt lgkmcnt(1)
s_barrier
s_sub_u32 s70, s64, s65
s_or_b32 s70, s70, s60
s_cbranch_scc1 L_norec
ds_read_b128 v[92:95], v8
s_lshl_b32 s70, s62, 3
s_lshl_b64 s[72:73], 0xff, s70
s_cmp_eq_u32 s69, 0
s_cselect_b64 s[72:73], 0, s[72:73]
s_andn2_b64 exec, -1, s[72:73]
s_waitcnt lgkmcnt(0)
buffer_store_dwordx4 v[92:95], v17, s[12:15], s87 offen sc1
s_mov_b64 exec, s[72:73]
buffer_store_dwordx4 v[92:95], v17, s[12:15], s87 offen
s_mov_b64 exec, -1
L_norec:
s_mov_b32 exec_hi, 0
s_waitcnt lgkmcnt(0)
buffer_store_dwordx4 v[88:91], v147, s[12:15], s88 offen sc1
s_mov_b64 exec, -1
s_bfe_u32 s95, s86, 0x50007
s_bfe_u32 s94, s85, 0x50007
s_add_u32 s86, s86, 1
v_pk_fma_f32 v[24:25], v[24:25], v[80:81], v[56:57] op_sel_hi:[1,0,0]
v_pk_fma_f32 v[26:27], v[26:27], v[80:81], v[56:57] op_sel_hi:[1,0,0]
v_cvt_pk_bf16_f32 v128, v24, v25
v_cvt_pk_bf16_f32 v129, v26, v27
ds_write_b64 v20, v[128:129] offset:32768
v_pk_fma_f32 v[28:29], v[28:29], v[80:81], v[56:57] op_sel_hi:[1,0,0]
v_pk_fma_f32 v[30:31], v[30:31], v[80:81], v[56:57] op_sel_hi:[1,0,0]
v_cvt_pk_bf16_f32 v130, v28, v29
v_cvt_pk_bf16_f32 v131, v30, v31
ds_write_b64 v21, v[130:131] offset:32768
v_pk_fma_f32 v[32:33], v[32:33], v[80:81], v[56:57] op_sel_hi:[1,0,0]
v_pk_fma_f32 v[34:35], v[34:35], v[80:81], v[56:57] op_sel_hi:[1,0,0]
v_cvt_pk_bf16_f32 v132, v32, v33
v_cvt_pk_bf16_f32 v133, v34, v35
ds_write_b64 v22, v[132:133] offset:32768
v_pk_fma_f32 v[36:37], v[36:37], v[80:81], v[56:57] op_sel_hi:[1,0,0]
v_pk_fma_f32 v[38:39], v[38:39], v[80:81], v[56:57] op_sel_hi:[1,0,0]
v_cvt_pk_bf16_f32 v134, v36, v37
v_cvt_pk_bf16_f32 v135, v38, v39
ds_write_b64 v23, v[134:135] offset:32768
v_pk_fma_f32 v[40:41], v[40:41], v[82:83], v[58:59] op_sel_hi:[1,0,0]
v_pk_fma_f32 v[42:43], v[42:43], v[82:83], v[58:59] op_sel_hi:[1,0,0]
v_cvt_pk_bf16_f32 v136, v40, v41
v_cvt_pk_bf16_f32 v137, v42, v43
ds_write_b64 v20, v[136:137] offset:34816
v_pk_fma_f32 v[44:45], v[44:45], v[82:83], v[58:59] op_sel_hi:[1,0,0]
v_pk_fma_f32 v[46:47], v[46:47], v[82:83], v[58:59] op_sel_hi:[1,0,0]
v_cvt_pk_bf16_f32 v138, v44, v45
v_cvt_pk_bf16_f32 v139, v46, v47
ds_write_b64 v21, v[138:139] offset:34816
v_pk_fma_f32 v[48:49], v[48:49], v[82:83], v[58:59] op_sel_hi:[1,0,0]
v_pk_fma_f32 v[50:51], v[50:51], v[82:83], v[58:59] op_sel_hi:[1,0,0]
v_cvt_pk_bf16_f32 v140, v48, v49
v_cvt_pk_bf16_f32 v141, v50, v51
ds_write_b64 v22, v[140:141] offset:34816
v_pk_fma_f32 v[52:53], v[52:53], v[82:83], v[58:59] op_sel_hi:[1,0,0]
v_pk_fma_f32 v[54:55], v[54:55], v[82:83], v[58:59] op_sel_hi:[1,0,0]
v_cvt_pk_bf16_f32 v142, v52, v53
v_cvt_pk_bf16_f32 v143, v54, v55
ds_write_b64 v23, v[142:143] offset:34816
s_waitcnt lgkmcnt(0)
ds_read_b128 v[96:99], v9 offset:32768
ds_read_b128 v[100:103], v10 offset:33792
ds_read_b128 v[104:107], v9 offset:34816
ds_read_b128 v[108:111], v10 offset:35840
v_add_u32 v2, 0, v12
v_cmp_ne_u32 vcc, s94, v2
v_cmp_ne_u32_e64 s[92:93], s95, v2
s_add_u32 s70, s74, 0
s_waitcnt lgkmcnt(3)
s_and_b64 exec, vcc, s[92:93]
buffer_store_dwordx4 v[96:99], v11, s[20:23], s70 offen nt
s_mov_b64 exec, -1
v_add_u32 v2, 8, v12
v_cmp_ne_u32 vcc, s94, v2
v_cmp_ne_u32_e64 s[92:93], s95, v2
s_add_u32 s70, s74, 16384
s_waitcnt lgkmcnt(2)
s_and_b64 exec, vcc, s[92:93]
buffer_store_dwordx4 v[100:103], v11, s[20:23], s70 offen nt
s_mov_b64 exec, -1
v_add_u32 v2, 16, v12
v_cmp_ne_u32 vcc, s94, v2
v_cmp_ne_u32_e64 s[92:93], s95, v2
s_add_u32 s70, s74, 32768
s_waitcnt lgkmcnt(1)
s_and_b64 exec, vcc, s[92:93]
buffer_store_dwordx4 v[104:107], v11, s[20:23], s70 offen nt
s_mov_b64 exec, -1
s_branch L_over8
L_pad8:
s_branch L_pad13
L_over8:
v_add_u32 v2, 24, v12
v_cmp_ne_u32_e64 vcc, s94, v2
v_cmp_ne_u32_e64 s[92:93], s95, v2
s_add_u32 s70, s74, 49152
s_waitcnt lgkmcnt(0)
s_and_b64 exec, vcc, s[92:93]
buffer_store_dwordx4 v[108:111], v11, s[20:23], s70 offen nt
s_mov_b64 exec, -1
v_mov_b32 v2, 161792
s_barrier
ds_read_b32 v3, v2
ds_read_b32 v4, v2 offset:16
s_waitcnt lgkmcnt(0)
v_readfirstlane_b32 s72, v3
v_readfirstlane_b32 s73, v4
s_cmp_eq_u32 s85, s72
s_cselect_b32 s94, 255, s94
s_cmp_eq_u32 s85, s73
s_cselect_b32 s94, 255, s94
s_cmp_eq_u32 s86, s72
s_cselect_b32 s95, 255, s95
s_cmp_eq_u32 s86, s73
s_cselect_b32 s95, 255, s95
v_add_u32 v2, 0, v12
v_cmp_eq_u32 vcc, s94, v2
v_cmp_eq_u32_e64 s[92:93], s95, v2
s_add_u32 s70, s74, 0
s_or_b64 exec, vcc, s[92:93]
s_cbranch_execz L_nodef0
buffer_store_dwordx4 v[96:99], v11, s[20:23], s70 offen nt
L_nodef0:
s_mov_b64 exec, -1
v_add_u32 v2, 8, v12
v_cmp_eq_u32 vcc, s94, v2
v_cmp_eq_u32_e64 s[92:93], s95, v2
s_add_u32 s70, s74, 16384
s_or_b64 exec, vcc, s[92:93]
s_cbranch_execz L_nodef1
buffer_store_dwordx4 v[100:103], v11, s[20:23], s70 offen nt
L_nodef1:
s_mov_b64 exec, -1
v_add_u32 v2, 16, v12
v_cmp_eq_u32 vcc, s94, v2
v_cmp_eq_u32_e64 s[92:93], s95, v2
s_add_u32 s70, s74, 32768
s_or_b64 exec, vcc, s[92:93]
s_cbranch_execz L_nodef2
buffer_store_dwordx4 v[104:107], v11, s[20:23], s70 offen nt
L_nodef2:
s_mov_b64 exec, -1
v_add_u32 v2, 24, v12
v_cmp_eq_u32 vcc, s94, v2
v_cmp_eq_u32_e64 s[92:93], s95, v2
s_add_u32 s70, s74, 49152
s_or_b64 exec, vcc, s[92:93]
s_cbranch_execz L_nodef3
buffer_store_dwordx4 v[108:111], v11, s[20:23], s70 offen nt
L_nodef3:
s_mov_b64 exec, -1
L_end:
s_endpgm
L_eg_rt:
s_add_u32 s78, s78, 1
s_cmp_gt_u32 s78, 65536
s_cbranch_scc1 L_eg_ok
s_add_u32 s70, s87, 0
buffer_load_dwordx4 v[20:23], v44, s[12:15], s70 offen sc1
buffer_load_dwordx4 v[36:39], v45, s[12:15], s88 offen sc1
buffer_load_dwordx4 v[40:43], v46, s[12:15], 0 offen offset:0 sc1
buffer_load_dword v47, v48, s[12:15], 0 offen sc1
s_waitcnt vmcnt(0)
s_branch L_eg_chk
L_pad9:
s_branch L_retF
L_kvrt:
s_add_u32 s78, s78, 1
s_cmp_gt_u32 s78, 65536
s_cbranch_scc1 L_kvok
s_bitcmp1_b32 s73, 0
s_cbranch_scc0 L_kvn0
v_cmp_eq_u32 vcc, -1, v84
s_cbranch_vccz L_kv0_p0
s_add_u32 s70, s65, 1
s_and_b32 s70, s70, 15
s_mul_i32 s70, s70, 4352
s_add_u32 s70, s70, s87
buffer_load_dwordx4 v[84:87], v18, s[12:15], s70 offen sc1
L_kv0_p0:
v_cmp_eq_u32 vcc, -1, v88
s_cbranch_vccz L_kv0_p1
s_add_u32 s70, s65, 2
s_and_b32 s70, s70, 15
s_mul_i32 s70, s70, 4352
s_add_u32 s70, s70, s87
buffer_load_dwordx4 v[88:91], v18, s[12:15], s70 offen sc1
L_kv0_p1:
v_cmp_eq_u32 vcc, -1, v92
s_cbranch_vccz L_kv0_p2
s_add_u32 s70, s65, 3
s_and_b32 s70, s70, 15
s_mul_i32 s70, s70, 4352
s_add_u32 s70, s70, s87
buffer_load_dwordx4 v[92:95], v18, s[12:15], s70 offen sc1
L_kv0_p2:
v_cmp_eq_u32 vcc, -1, v96
s_cbranch_vccz L_kv0_p3
s_add_u32 s70, s65, 4
s_and_b32 s70, s70, 15
s_mul_i32 s70, s70, 4352
s_add_u32 s70, s70, s87
buffer_load_dwordx4 v[96:99], v18, s[12:15], s70 offen sc1
L_kv0_p3:
L_kvn0:
s_bitcmp1_b32 s73, 1
s_cbranch_scc0 L_kvn1
v_cmp_eq_u32 vcc, -1, v100
s_cbranch_vccz L_kv1_p0
s_add_u32 s70, s65, 5
s_and_b32 s70, s70, 15
s_mul_i32 s70, s70, 4352
s_add_u32 s70, s70, s87
buffer_load_dwordx4 v[100:103], v18, s[12:15], s70 offen sc1
L_kv1_p0:
v_cmp_eq_u32 vcc, -1, v104
s_cbranch_vccz L_kv1_p1
s_add_u32 s70, s65, 6
s_and_b32 s70, s70, 15
s_mul_i32 s70, s70, 4352
s_add_u32 s70, s70, s87
buffer_load_dwordx4 v[104:107], v18, s[12:15], s70 offen sc1
L_kv1_p1:
v_cmp_eq_u32 vcc, -1, v108
s_cbranch_vccz L_kv1_p2
s_add_u32 s70, s65, 7
s_and_b32 s70, s70, 15
s_mul_i32 s70, s70, 4352
s_add_u32 s70, s70, s87
buffer_load_dwordx4 v[108:111], v18, s[12:15], s70 offen sc1
L_kv1_p2:
v_cmp_eq_u32 vcc, -1, v112
s_cbranch_vccz L_kv1_p3
s_add_u32 s70, s65, 8
s_and_b32 s70, s70, 15
s_mul_i32 s70, s70, 4352
s_add_u32 s70, s70, s87
buffer_load_dwordx4 v[112:115], v18, s[12:15], s70 offen sc1
L_kv1_p3:
L_kvn1:
s_bitcmp1_b32 s73, 2
s_cbranch_scc0 L_kvn2
v_cmp_eq_u32 vcc, -1, v116
s_cbranch_vccz L_kv2_p0
s_add_u32 s70, s65, 9
s_and_b32 s70, s70, 15
s_mul_i32 s70, s70, 4352
s_add_u32 s70, s70, s87
buffer_load_dwordx4 v[116:119], v18, s[12:15], s70 offen sc1
L_kv2_p0:
v_cmp_eq_u32 vcc, -1, v120
s_cbranch_vccz L_kv2_p1
s_add_u32 s70, s65, 10
s_and_b32 s70, s70, 15
s_mul_i32 s70, s70, 4352
s_add_u32 s70, s70, s87
buffer_load_dwordx4 v[120:123], v18, s[12:15], s70 offen sc1
L_kv2_p1:
v_cmp_eq_u32 vcc, -1, v124
s_cbranch_vccz L_kv2_p2
s_add_u32 s70, s65, 11
s_and_b32 s70, s70, 15
s_mul_i32 s70, s70, 4352
s_add_u32 s70, s70, s87
buffer_load_dwordx4 v[124:127], v18, s[12:15], s70 offen sc1
L_kv2_p2:
v_cmp_eq_u32 vcc, -1, v128
s_cbranch_vccz L_kv2_p3
s_add_u32 s70, s65, 12
s_and_b32 s70, s70, 15
s_mul_i32 s70, s70, 4352
s_add_u32 s70, s70, s87
buffer_load_dwordx4 v[128:131], v18, s[12:15], s70 offen sc1
L_kv2_p3:
L_kvn2:
s_bitcmp1_b32 s73, 3
s_cbranch_scc0 L_kvn3
v_cmp_eq_u32 vcc, -1, v132
s_cbranch_vccz L_kv3_p0
s_add_u32 s70, s65, 13
s_and_b32 s70, s70, 15
s_mul_i32 s70, s70, 4352
s_add_u32 s70, s70, s87
buffer_load_dwordx4 v[132:135], v18, s[12:15], s70 offen sc1
L_kv3_p0:
v_cmp_eq_u32 vcc, -1, v136
s_cbranch_vccz L_kv3_p1
s_add_u32 s70, s65, 14
s_and_b32 s70, s70, 15
s_mul_i32 s70, s70, 4352
s_add_u32 s70, s70, s87
buffer_load_dwordx4 v[136:139], v18, s[12:15], s70 offen sc1
L_kv3_p1:
v_cmp_eq_u32 vcc, -1, v140
s_cbranch_vccz L_kv3_p2
s_add_u32 s70, s65, 15
s_and_b32 s70, s70, 15
s_mul_i32 s70, s70, 4352
s_add_u32 s70, s70, s87
buffer_load_dwordx4 v[140:143], v18, s[12:15], s70 offen sc1
L_kv3_p2:
v_cmp_eq_u32 vcc, -1, v144
s_cbranch_vccz L_kv3_p3
s_add_u32 s70, s65, 16
s_and_b32 s70, s70, 15
s_mul_i32 s70, s70, 4352
s_add_u32 s70, s70, s87
buffer_load_dwordx4 v[144:147], v18, s[12:15], s70 offen sc1
L_kv3_p3:
L_kvn3:
s_bitcmp1_b32 s73, 4
s_cbranch_scc0 L_kvn4
buffer_load_dwordx4 v[148:151], v55, s[12:15], s88 offen sc1
L_kvn4:
s_waitcnt vmcnt(0)
s_branch L_kvr
L_pad10:
s_branch L_pad15
L_pksame:
s_cmp_eq_u32 s73, 0
s_cbranch_scc1 L_pkf
s_add_u32 s78, s78, 1
s_cmp_le_u32 s78, 65536
s_cbranch_scc1 L_pk
s_branch L_pkf
L_pkx_rt:
s_add_u32 s78, s78, 1
s_cmp_gt_u32 s78, 65536
s_cbranch_scc1 L_pkx_ok
s_mov_b64 exec, s[92:93]
buffer_load_dwordx4 v[24:27], v58, s[12:15], 0 offen offset:0 sc1
buffer_load_dwordx4 v[28:31], v58, s[12:15], 0 offen offset:64 sc1
buffer_load_dwordx4 v[32:35], v58, s[12:15], 0 offen offset:128 sc1
buffer_load_dwordx4 v[36:39], v58, s[12:15], 0 offen offset:192 sc1
buffer_load_dwordx4 v[40:43], v58, s[12:15], 0 offen offset:256 sc1
buffer_load_dwordx4 v[44:47], v58, s[12:15], 0 offen offset:320 sc1
buffer_load_dwordx4 v[48:51], v58, s[12:15], 0 offen offset:384 sc1
buffer_load_dwordx4 v[52:55], v58, s[12:15], 0 offen offset:448 sc1
s_mov_b64 exec, -1
v_mul_f32_e64 v84, v68, -v21
v_mul_f32_e64 v85, v69, -v21
v_mul_f32_e64 v86, v70, -v21
v_mul_f32_e64 v87, v71, -v21
v_mul_f32_e64 v88, v72, -v21
v_mul_f32_e64 v89, v73, -v21
v_mul_f32_e64 v90, v74, -v21
v_mul_f32_e64 v91, v75, -v21
s_branch L_pkf
L_pxp_s:
buffer_store_dwordx4 v[84:87], v60, s[12:15], s85 offen sc1
s_branch L_pxp_d
L_pad11:
s_branch L_pad16
L_px_rt:
s_add_u32 s78, s78, 1
s_cmp_gt_u32 s78, 65536
s_cbranch_scc1 L_px_ok
v_and_b32 v2, s91, v24
v_cmp_ne_u32_e64 vcc, 0, v2
v_xor_b32 v24, s84, v24
s_cbranch_vccz L_px_p0
buffer_load_dwordx4 v[24:27], v61, s[12:15], s86 offen offset:0 sc1
L_px_p0:
v_and_b32 v2, s91, v28
v_cmp_ne_u32 vcc, 0, v2
v_xor_b32 v28, s84, v28
s_cbranch_vccz L_px_p1
buffer_load_dwordx4 v[28:31], v61, s[12:15], s86 offen offset:1024 sc1
L_px_p1:
v_and_b32 v2, s91, v32
v_cmp_ne_u32 vcc, 0, v2
v_xor_b32 v32, s84, v32
s_cbranch_vccz L_px_p2
buffer_load_dwordx4 v[32:35], v61, s[12:15], s86 offen offset:2048 sc1
L_px_p2:
v_and_b32 v2, s91, v36
v_cmp_ne_u32 vcc, 0, v2
v_xor_b32 v36, s84, v36
s_cbranch_vccz L_px_p3
buffer_load_dwordx4 v[36:39], v61, s[12:15], s86 offen offset:3072 sc1
L_px_p3:
s_waitcnt vmcnt(0)
s_branch L_px_chk
L_pad12:
s_branch L_pad17
L_yown:
v_bfi_b32 v40, s91, v59, v40
buffer_store_dwordx4 v[40:43], v62, s[12:15], s88 offen
s_add_u32 s88, s88, 16384
v_bfi_b32 v44, s91, v59, v44
buffer_store_dwordx4 v[44:47], v62, s[12:15], s88 offen
s_add_u32 s88, s88, 16384
v_bfi_b32 v48, s91, v59, v48
buffer_store_dwordx4 v[48:51], v62, s[12:15], s88 offen
s_add_u32 s88, s88, 16384
v_bfi_b32 v52, s91, v59, v52
buffer_store_dwordx4 v[52:55], v62, s[12:15], s88 offen
s_branch L_yd
L_h_rt:
s_add_u32 s78, s78, 1
s_cmp_gt_u32 s78, 65536
s_cbranch_scc1 L_h_ok
buffer_load_ushort v84, v64, s[12:15], s72 offen sc1
s_waitcnt vmcnt(0)
s_branch L_h_chk
L_pad13:
s_branch L_pad18
L_y_rt:
s_add_u32 s78, s78, 1
s_cmp_gt_u32 s78, 65536
s_cbranch_scc1 L_yf0
buffer_load_dwordx4 v[120:123], v18, s[12:15], s88 offen offset:0 sc1
buffer_load_dwordx4 v[124:127], v18, s[12:15], s88 offen offset:1024 sc1
buffer_load_dwordx4 v[128:131], v18, s[12:15], s88 offen offset:2048 sc1
buffer_load_dwordx4 v[132:135], v18, s[12:15], s88 offen offset:3072 sc1
buffer_load_dwordx4 v[136:139], v18, s[12:15], s71 offen offset:0 sc1
buffer_load_dwordx4 v[140:143], v18, s[12:15], s71 offen offset:1024 sc1
buffer_load_dwordx4 v[144:147], v18, s[12:15], s71 offen offset:2048 sc1
v_mov_b32 v88, s84
s_waitcnt vmcnt(14)
v_xor_b32 v24, s84, v24
v_xor_b32 v28, s84, v28
v_xor_b32 v32, s84, v32
v_xor_b32_e64 v36, s84, v36
v_or3_b32 v2, v24, v28, v32
v_xor_b32 v92, s84, v92
v_xor_b32 v96, s84, v96
v_or3_b32 v2, v2, v36, v92
v_xor_b32 v100, s84, v100
v_xor_b32 v88, s84, v88
v_or3_b32 v2, v2, v96, v100
v_bitop3_b32 v2, v2, v88, s91 bitop3:0xa8
v_cmp_ne_u32 vcc, 0, v2
s_cbranch_vccz L_yf1
buffer_load_dwordx4 v[24:27], v18, s[12:15], s88 offen offset:0 sc1
buffer_load_dwordx4 v[28:31], v18, s[12:15], s88 offen offset:1024 sc1
buffer_load_dwordx4 v[32:35], v18, s[12:15], s88 offen offset:2048 sc1
buffer_load_dwordx4 v[36:39], v18, s[12:15], s88 offen offset:3072 sc1
buffer_load_dwordx4 v[92:95], v18, s[12:15], s71 offen offset:0 sc1
buffer_load_dwordx4 v[96:99], v18, s[12:15], s71 offen offset:1024 sc1
buffer_load_dwordx4 v[100:103], v18, s[12:15], s71 offen offset:2048 sc1
v_mov_b32 v88, s84
s_waitcnt vmcnt(14)
v_xor_b32 v40, s84, v40
v_xor_b32 v44, s84, v44
v_xor_b32 v48, s84, v48
v_xor_b32 v52, s84, v52
v_or3_b32 v2, v40, v44, v48
v_xor_b32 v104, s84, v104
v_xor_b32 v108, s84, v108
v_or3_b32 v2, v2, v52, v104
v_xor_b32 v112, s84, v112
v_xor_b32 v88, s84, v88
v_or3_b32 v2, v2, v108, v112
v_bitop3_b32 v2, v2, v88, s91 bitop3:0xa8
v_cmp_ne_u32 vcc, 0, v2
s_cbranch_vccz L_yf2
buffer_load_dwordx4 v[40:43], v18, s[12:15], s88 offen offset:0 sc1
buffer_load_dwordx4 v[44:47], v18, s[12:15], s88 offen offset:1024 sc1
buffer_load_dwordx4 v[48:51], v18, s[12:15], s88 offen offset:2048 sc1
buffer_load_dwordx4 v[52:55], v18, s[12:15], s88 offen offset:3072 sc1
buffer_load_dwordx4 v[104:107], v18, s[12:15], s71 offen offset:0 sc1
buffer_load_dwordx4 v[108:111], v18, s[12:15], s71 offen offset:1024 sc1
buffer_load_dwordx4 v[112:115], v18, s[12:15], s71 offen offset:2048 sc1
v_mov_b32 v88, s84
s_branch L_yr
L_yf1:
v_pk_add_f32 v[24:25], v[24:25], v[28:29]
v_pk_add_f32 v[26:27], v[26:27], v[30:31]
v_pk_add_f32 v[32:33], v[32:33], v[36:37]
v_pk_add_f32 v[34:35], v[34:35], v[38:39]
v_pk_add_f32 v[92:93], v[92:93], v[96:97]
v_pk_add_f32 v[94:95], v[94:95], v[98:99]
v_pk_add_f32 v[24:25], v[24:25], v[32:33]
v_pk_add_f32 v[26:27], v[26:27], v[34:35]
v_pk_add_f32 v[92:93], v[92:93], v[100:101]
v_pk_add_f32 v[94:95], v[94:95], v[102:103]
v_pk_add_f32 v[24:25], v[24:25], v[92:93]
v_pk_add_f32 v[26:27], v[26:27], v[94:95]
s_nop 1
v_permlane32_swap_b32 v24, v26
v_permlane32_swap_b32 v25, v27
v_add_f32 v68, v24, v26
v_add_f32_e64 v69, v25, v27
s_nop 0
s_branch L_yf
L_yf2:
v_pk_add_f32 v[40:41], v[40:41], v[44:45]
v_pk_add_f32 v[42:43], v[42:43], v[46:47]
v_pk_add_f32 v[48:49], v[48:49], v[52:53]
v_pk_add_f32 v[50:51], v[50:51], v[54:55]
v_pk_add_f32 v[104:105], v[104:105], v[108:109]
v_pk_add_f32 v[106:107], v[106:107], v[110:111]
v_pk_add_f32 v[40:41], v[40:41], v[48:49]
v_pk_add_f32 v[42:43], v[42:43], v[50:51]
v_pk_add_f32 v[104:105], v[104:105], v[112:113]
v_pk_add_f32 v[106:107], v[106:107], v[114:115]
v_pk_add_f32 v[40:41], v[40:41], v[104:105]
v_pk_add_f32 v[42:43], v[42:43], v[106:107]
s_nop 1
v_permlane32_swap_b32 v40, v42
v_permlane32_swap_b32 v41, v43
v_add_f32 v68, v40, v42
v_add_f32_e64 v69, v41, v43
s_nop 0
s_branch L_yf
L_kvp_s:
buffer_store_dwordx4 v[140:143], v16, s[12:15], s72 offen sc1
s_mov_b64 exec, s[92:93]
buffer_store_dwordx4 v[136:139], v4, s[12:15], s73 offen sc1
s_mov_b64 exec, -1
s_branch L_kvp_d
L_pad14:
s_branch L_retF
L_oown0:
buffer_store_dwordx4 v[52:55], v16, s[12:15], s70 offen
s_branch L_ood0
L_oown1:
buffer_store_dwordx4 v[76:79], v16, s[12:15], s70 offen
s_branch L_ood1
L_oown2:
buffer_store_dwordx4 v[100:103], v16, s[12:15], s70 offen
s_branch L_ood2
L_oown3:
buffer_store_dwordx4 v[124:127], v16, s[12:15], s70 offen
s_branch L_ood3
L_pad15:
s_branch L_retG
L_o0_rt:
s_add_u32 s78, s78, 1
s_cmp_gt_u32 s78, 65536
s_cbranch_scc1 L_o0_ok
buffer_load_dwordx4 v[56:59], v6, s[12:15], s24 offen offset:0 sc1
buffer_load_dwordx4 v[60:63], v19, s[12:15], s24 offen offset:0 sc1
buffer_load_dwordx4 v[64:67], v6, s[12:15], s24 offen offset:1024 sc1
buffer_load_dwordx4 v[68:71], v19, s[12:15], s24 offen offset:1024 sc1
s_waitcnt vmcnt(4)
v_max3_u32 v2, v72, v76, v80
v_max3_u32 v2, v2, v84, v88
v_max3_u32 v2, v2, v92, v96
v_max3_u32 v2, v2, v100, v100
v_cmp_eq_u32 vcc, -1, v2
s_cbranch_vccz L_o0_a
buffer_load_dwordx4 v[72:75], v6, s[12:15], s25 offen offset:0 sc1
buffer_load_dwordx4 v[76:79], v19, s[12:15], s25 offen offset:0 sc1
buffer_load_dwordx4 v[80:83], v6, s[12:15], s25 offen offset:1024 sc1
buffer_load_dwordx4 v[84:87], v19, s[12:15], s25 offen offset:1024 sc1
buffer_load_dwordx4 v[88:91], v6, s[12:15], s26 offen offset:0 sc1
buffer_load_dwordx4 v[92:95], v19, s[12:15], s26 offen offset:0 sc1
buffer_load_dwordx4 v[96:99], v6, s[12:15], s26 offen offset:1024 sc1
buffer_load_dwordx4 v[100:103], v19, s[12:15], s26 offen offset:1024 sc1
s_waitcnt vmcnt(8)
s_branch L_o0_b
L_o0_a:
s_waitcnt vmcnt(0)
L_o0_b:
v_max3_u32 v2, v56, v60, v64
v_max_u32 v2, v2, v68
v_cmp_eq_u32 vcc, -1, v2
s_cbranch_vccnz L_o0_rt
s_branch L_o0_ok
L_pad16:
s_branch L_retG
L_o1_rt:
s_add_u32 s78, s78, 1
s_cmp_gt_u32 s78, 65536
s_cbranch_scc1 L_o1_ok
buffer_load_dwordx4 v[72:75], v6, s[12:15], s25 offen offset:0 sc1
buffer_load_dwordx4 v[76:79], v19, s[12:15], s25 offen offset:0 sc1
buffer_load_dwordx4 v[80:83], v6, s[12:15], s25 offen offset:1024 sc1
buffer_load_dwordx4 v[84:87], v19, s[12:15], s25 offen offset:1024 sc1
s_waitcnt vmcnt(4)
v_max3_u32 v2, v88, v92, v96
v_max3_u32 v2, v2, v100, v104
v_max3_u32 v2, v2, v108, v112
v_max3_u32 v2, v2, v116, v116
v_cmp_eq_u32 vcc, -1, v2
s_cbranch_vccz L_o1_a
buffer_load_dwordx4 v[88:91], v6, s[12:15], s26 offen offset:0 sc1
buffer_load_dwordx4 v[92:95], v19, s[12:15], s26 offen offset:0 sc1
buffer_load_dwordx4 v[96:99], v6, s[12:15], s26 offen offset:1024 sc1
buffer_load_dwordx4 v[100:103], v19, s[12:15], s26 offen offset:1024 sc1
buffer_load_dwordx4 v[104:107], v6, s[12:15], s27 offen offset:0 sc1
buffer_load_dwordx4 v[108:111], v19, s[12:15], s27 offen offset:0 sc1
buffer_load_dwordx4 v[112:115], v6, s[12:15], s27 offen offset:1024 sc1
buffer_load_dwordx4 v[116:119], v19, s[12:15], s27 offen offset:1024 sc1
s_waitcnt vmcnt(8)
s_branch L_o1_b
L_o1_a:
s_waitcnt vmcnt(0)
L_o1_b:
v_max3_u32 v2, v72, v76, v80
v_max_u32 v2, v2, v84
v_cmp_eq_u32 vcc, -1, v2
s_cbranch_vccnz L_o1_rt
s_branch L_o1_ok
L_o2_rt:
s_add_u32 s78, s78, 1
s_cmp_gt_u32 s78, 65536
s_cbranch_scc1 L_o2_ok
buffer_load_dwordx4 v[88:91], v6, s[12:15], s26 offen offset:0 sc1
buffer_load_dwordx4 v[92:95], v19, s[12:15], s26 offen offset:0 sc1
buffer_load_dwordx4 v[96:99], v6, s[12:15], s26 offen offset:1024 sc1
buffer_load_dwordx4 v[100:103], v19, s[12:15], s26 offen offset:1024 sc1
s_waitcnt vmcnt(4)
v_max3_u32 v2, v104, v108, v112
v_max3_u32 v2, v2, v116, v56
v_max3_u32 v2, v2, v60, v64
v_max3_u32 v2, v2, v68, v68
v_cmp_eq_u32 vcc, -1, v2
s_cbranch_vccz L_o2_a
buffer_load_dwordx4 v[104:107], v6, s[12:15], s27 offen offset:0 sc1
buffer_load_dwordx4 v[108:111], v19, s[12:15], s27 offen offset:0 sc1
buffer_load_dwordx4 v[112:115], v6, s[12:15], s27 offen offset:1024 sc1
buffer_load_dwordx4 v[116:119], v19, s[12:15], s27 offen offset:1024 sc1
buffer_load_dwordx4 v[56:59], v6, s[12:15], s28 offen offset:0 sc1
buffer_load_dwordx4 v[60:63], v19, s[12:15], s28 offen offset:0 sc1
buffer_load_dwordx4 v[64:67], v6, s[12:15], s28 offen offset:1024 sc1
buffer_load_dwordx4 v[68:71], v19, s[12:15], s28 offen offset:1024 sc1
s_waitcnt vmcnt(8)
s_branch L_o2_b
L_o2_a:
s_waitcnt vmcnt(0)
L_o2_b:
v_max3_u32 v2, v88, v92, v96
v_max_u32 v2, v2, v100
v_cmp_eq_u32 vcc, -1, v2
s_cbranch_vccnz L_o2_rt
s_branch L_o2_ok
L_o3_rt:
s_add_u32 s78, s78, 1
s_cmp_gt_u32 s78, 65536
s_cbranch_scc1 L_o3_ok
buffer_load_dwordx4 v[104:107], v6, s[12:15], s27 offen offset:0 sc1
buffer_load_dwordx4 v[108:111], v19, s[12:15], s27 offen offset:0 sc1
buffer_load_dwordx4 v[112:115], v6, s[12:15], s27 offen offset:1024 sc1
buffer_load_dwordx4 v[116:119], v19, s[12:15], s27 offen offset:1024 sc1
s_waitcnt vmcnt(4)
v_max3_u32 v2, v56, v60, v64
v_max3_u32 v2, v2, v68, v72
v_max3_u32 v2, v2, v76, v80
v_max3_u32 v2, v2, v84, v84
v_cmp_eq_u32 vcc, -1, v2
s_cbranch_vccz L_o3_a
buffer_load_dwordx4 v[56:59], v6, s[12:15], s28 offen offset:0 sc1
buffer_load_dwordx4 v[60:63], v19, s[12:15], s28 offen offset:0 sc1
buffer_load_dwordx4 v[64:67], v6, s[12:15], s28 offen offset:1024 sc1
buffer_load_dwordx4 v[68:71], v19, s[12:15], s28 offen offset:1024 sc1
buffer_load_dwordx4 v[72:75], v6, s[12:15], s29 offen offset:0 sc1
buffer_load_dwordx4 v[76:79], v19, s[12:15], s29 offen offset:0 sc1
buffer_load_dwordx4 v[80:83], v6, s[12:15], s29 offen offset:1024 sc1
buffer_load_dwordx4 v[84:87], v19, s[12:15], s29 offen offset:1024 sc1
s_waitcnt vmcnt(8)
s_branch L_o3_b
L_o3_a:
s_waitcnt vmcnt(0)
L_o3_b:
v_max3_u32 v2, v104, v108, v112
v_max_u32 v2, v2, v116
v_cmp_eq_u32 vcc, -1, v2
s_cbranch_vccnz L_o3_rt
s_branch L_o3_ok
L_o4_rt:
s_add_u32 s78, s78, 1
s_cmp_gt_u32 s78, 65536
s_cbranch_scc1 L_o4_ok
buffer_load_dwordx4 v[56:59], v6, s[12:15], s28 offen offset:0 sc1
buffer_load_dwordx4 v[60:63], v19, s[12:15], s28 offen offset:0 sc1
buffer_load_dwordx4 v[64:67], v6, s[12:15], s28 offen offset:1024 sc1
buffer_load_dwordx4 v[68:71], v19, s[12:15], s28 offen offset:1024 sc1
s_waitcnt vmcnt(4)
v_max3_u32 v2, v72, v76, v80
v_max3_u32 v2, v2, v84, v88
v_max3_u32 v2, v2, v92, v96
v_max3_u32 v2, v2, v100, v100
v_cmp_eq_u32 vcc, -1, v2
s_cbranch_vccz L_o4_a
buffer_load_dwordx4 v[72:75], v6, s[12:15], s29 offen offset:0 sc1
buffer_load_dwordx4 v[76:79], v19, s[12:15], s29 offen offset:0 sc1
buffer_load_dwordx4 v[80:83], v6, s[12:15], s29 offen offset:1024 sc1
buffer_load_dwordx4 v[84:87], v19, s[12:15], s29 offen offset:1024 sc1
buffer_load_dwordx4 v[88:91], v6, s[12:15], s30 offen offset:0 sc1
buffer_load_dwordx4 v[92:95], v19, s[12:15], s30 offen offset:0 sc1
buffer_load_dwordx4 v[96:99], v6, s[12:15], s30 offen offset:1024 sc1
buffer_load_dwordx4 v[100:103], v19, s[12:15], s30 offen offset:1024 sc1
s_waitcnt vmcnt(8)
s_branch L_o4_b
L_o4_a:
s_waitcnt vmcnt(0)
L_o4_b:
v_max3_u32 v2, v56, v60, v64
v_max_u32 v2, v2, v68
v_cmp_eq_u32 vcc, -1, v2
s_cbranch_vccnz L_o4_rt
s_branch L_o4_ok
L_o5_rt:
s_add_u32 s78, s78, 1
s_cmp_gt_u32 s78, 65536
s_cbranch_scc1 L_o5_ok
buffer_load_dwordx4 v[72:75], v6, s[12:15], s29 offen offset:0 sc1
buffer_load_dwordx4 v[76:79], v19, s[12:15], s29 offen offset:0 sc1
buffer_load_dwordx4 v[80:83], v6, s[12:15], s29 offen offset:1024 sc1
buffer_load_dwordx4 v[84:87], v19, s[12:15], s29 offen offset:1024 sc1
s_waitcnt vmcnt(4)
v_max3_u32 v2, v88, v92, v96
v_max3_u32 v2, v2, v100, v104
v_max3_u32 v2, v2, v108, v112
v_max3_u32 v2, v2, v116, v116
v_cmp_eq_u32 vcc, -1, v2
s_cbranch_vccz L_o5_a
buffer_load_dwordx4 v[88:91], v6, s[12:15], s30 offen offset:0 sc1
buffer_load_dwordx4 v[92:95], v19, s[12:15], s30 offen offset:0 sc1
buffer_load_dwordx4 v[96:99], v6, s[12:15], s30 offen offset:1024 sc1
buffer_load_dwordx4 v[100:103], v19, s[12:15], s30 offen offset:1024 sc1
buffer_load_dwordx4 v[104:107], v6, s[12:15], s31 offen offset:0 sc1
buffer_load_dwordx4 v[108:111], v19, s[12:15], s31 offen offset:0 sc1
buffer_load_dwordx4 v[112:115], v6, s[12:15], s31 offen offset:1024 sc1
buffer_load_dwordx4 v[116:119], v19, s[12:15], s31 offen offset:1024 sc1
s_waitcnt vmcnt(8)
s_branch L_o5_b
L_o5_a:
s_waitcnt vmcnt(0)
L_o5_b:
v_max3_u32 v2, v72, v76, v80
v_max_u32 v2, v2, v84
v_cmp_eq_u32 vcc, -1, v2
s_cbranch_vccnz L_o5_rt
s_branch L_o5_ok
L_o6_rt:
s_add_u32 s78, s78, 1
s_cmp_gt_u32 s78, 65536
s_cbranch_scc1 L_o6_ok
buffer_load_dwordx4 v[88:91], v6, s[12:15], s30 offen offset:0 sc1
buffer_load_dwordx4 v[92:95], v19, s[12:15], s30 offen offset:0 sc1
buffer_load_dwordx4 v[96:99], v6, s[12:15], s30 offen offset:1024 sc1
buffer_load_dwordx4 v[100:103], v19, s[12:15], s30 offen offset:1024 sc1
s_waitcnt vmcnt(4)
v_max3_u32 v2, v104, v108, v112
v_max3_u32 v2, v2, v116, v56
v_max3_u32 v2, v2, v60, v64
v_max3_u32 v2, v2, v68, v68
v_cmp_eq_u32 vcc, -1, v2
s_cbranch_vccz L_o6_a
buffer_load_dwordx4 v[104:107], v6, s[12:15], s31 offen offset:0 sc1
buffer_load_dwordx4 v[108:111], v19, s[12:15], s31 offen offset:0 sc1
buffer_load_dwordx4 v[112:115], v6, s[12:15], s31 offen offset:1024 sc1
buffer_load_dwordx4 v[116:119], v19, s[12:15], s31 offen offset:1024 sc1
buffer_load_dwordx4 v[56:59], v6, s[12:15], s32 offen offset:0 sc1
buffer_load_dwordx4 v[60:63], v19, s[12:15], s32 offen offset:0 sc1
buffer_load_dwordx4 v[64:67], v6, s[12:15], s32 offen offset:1024 sc1
buffer_load_dwordx4 v[68:71], v19, s[12:15], s32 offen offset:1024 sc1
s_waitcnt vmcnt(8)
s_branch L_o6_b
L_o6_a:
s_waitcnt vmcnt(0)
L_o6_b:
v_max3_u32 v2, v88, v92, v96
v_max_u32 v2, v2, v100
v_cmp_eq_u32 vcc, -1, v2
s_cbranch_vccnz L_o6_rt
s_branch L_o6_ok
L_o7_rt:
s_add_u32 s78, s78, 1
s_cmp_gt_u32 s78, 65536
s_cbranch_scc1 L_o7_ok
buffer_load_dwordx4 v[104:107], v6, s[12:15], s31 offen offset:0 sc1
buffer_load_dwordx4 v[108:111], v19, s[12:15], s31 offen offset:0 sc1
buffer_load_dwordx4 v[112:115], v6, s[12:15], s31 offen offset:1024 sc1
buffer_load_dwordx4 v[116:119], v19, s[12:15], s31 offen offset:1024 sc1
s_waitcnt vmcnt(4)
v_max3_u32 v2, v56, v60, v64
v_max3_u32 v2, v2, v68, v72
v_max3_u32 v2, v2, v76, v80
v_max3_u32 v2, v2, v84, v84
v_cmp_eq_u32 vcc, -1, v2
s_cbranch_vccz L_o7_a
buffer_load_dwordx4 v[56:59], v6, s[12:15], s32 offen offset:0 sc1
buffer_load_dwordx4 v[60:63], v19, s[12:15], s32 offen offset:0 sc1
buffer_load_dwordx4 v[64:67], v6, s[12:15], s32 offen offset:1024 sc1
buffer_load_dwordx4 v[68:71], v19, s[12:15], s32 offen offset:1024 sc1
buffer_load_dwordx4 v[72:75], v6, s[12:15], s33 offen offset:0 sc1
buffer_load_dwordx4 v[76:79], v19, s[12:15], s33 offen offset:0 sc1
buffer_load_dwordx4 v[80:83], v6, s[12:15], s33 offen offset:1024 sc1
buffer_load_dwordx4 v[84:87], v19, s[12:15], s33 offen offset:1024 sc1
s_waitcnt vmcnt(8)
s_branch L_o7_b
L_o7_a:
s_waitcnt vmcnt(0)
L_o7_b:
v_max3_u32 v2, v104, v108, v112
v_max_u32 v2, v2, v116
v_cmp_eq_u32 vcc, -1, v2
s_cbranch_vccnz L_o7_rt
s_branch L_o7_ok
L_o8_rt:
s_add_u32 s78, s78, 1
s_cmp_gt_u32 s78, 65536
s_cbranch_scc1 L_o8_ok
buffer_load_dwordx4 v[56:59], v6, s[12:15], s32 offen offset:0 sc1
buffer_load_dwordx4 v[60:63], v19, s[12:15], s32 offen offset:0 sc1
buffer_load_dwordx4 v[64:67], v6, s[12:15], s32 offen offset:1024 sc1
buffer_load_dwordx4 v[68:71], v19, s[12:15], s32 offen offset:1024 sc1
s_waitcnt vmcnt(4)
v_max3_u32 v2, v72, v76, v80
v_max3_u32 v2, v2, v84, v88
v_max3_u32 v2, v2, v92, v96
v_max3_u32 v2, v2, v100, v100
v_cmp_eq_u32 vcc, -1, v2
s_cbranch_vccz L_o8_a
buffer_load_dwordx4 v[72:75], v6, s[12:15], s33 offen offset:0 sc1
buffer_load_dwordx4 v[76:79], v19, s[12:15], s33 offen offset:0 sc1
buffer_load_dwordx4 v[80:83], v6, s[12:15], s33 offen offset:1024 sc1
buffer_load_dwordx4 v[84:87], v19, s[12:15], s33 offen offset:1024 sc1
buffer_load_dwordx4 v[88:91], v6, s[12:15], s34 offen offset:0 sc1
buffer_load_dwordx4 v[92:95], v19, s[12:15], s34 offen offset:0 sc1
buffer_load_dwordx4 v[96:99], v6, s[12:15], s34 offen offset:1024 sc1
buffer_load_dwordx4 v[100:103], v19, s[12:15], s34 offen offset:1024 sc1
s_waitcnt vmcnt(8)
s_branch L_o8_b
L_o8_a:
s_waitcnt vmcnt(0)
L_o8_b:
v_max3_u32 v2, v56, v60, v64
v_max_u32 v2, v2, v68
v_cmp_eq_u32 vcc, -1, v2
s_cbranch_vccnz L_o8_rt
s_branch L_o8_ok
L_o9_rt:
s_add_u32 s78, s78, 1
s_cmp_gt_u32 s78, 65536
s_cbranch_scc1 L_o9_ok
buffer_load_dwordx4 v[72:75], v6, s[12:15], s33 offen offset:0 sc1
buffer_load_dwordx4 v[76:79], v19, s[12:15], s33 offen offset:0 sc1
buffer_load_dwordx4 v[80:83], v6, s[12:15], s33 offen offset:1024 sc1
buffer_load_dwordx4 v[84:87], v19, s[12:15], s33 offen offset:1024 sc1
s_waitcnt vmcnt(4)
v_max3_u32 v2, v88, v92, v96
v_max3_u32 v2, v2, v100, v104
v_max3_u32 v2, v2, v108, v112
v_max3_u32 v2, v2, v116, v116
v_cmp_eq_u32 vcc, -1, v2
s_cbranch_vccz L_o9_a
buffer_load_dwordx4 v[88:91], v6, s[12:15], s34 offen offset:0 sc1
buffer_load_dwordx4 v[92:95], v19, s[12:15], s34 offen offset:0 sc1
buffer_load_dwordx4 v[96:99], v6, s[12:15], s34 offen offset:1024 sc1
buffer_load_dwordx4 v[100:103], v19, s[12:15], s34 offen offset:1024 sc1
buffer_load_dwordx4 v[104:107], v6, s[12:15], s35 offen offset:0 sc1
buffer_load_dwordx4 v[108:111], v19, s[12:15], s35 offen offset:0 sc1
buffer_load_dwordx4 v[112:115], v6, s[12:15], s35 offen offset:1024 sc1
buffer_load_dwordx4 v[116:119], v19, s[12:15], s35 offen offset:1024 sc1
s_waitcnt vmcnt(8)
s_branch L_o9_b
L_o9_a:
s_waitcnt vmcnt(0)
L_o9_b:
v_max3_u32 v2, v72, v76, v80
s_branch L_over17
L_pad17:
s_branch L_retG
L_over17:
v_max_u32 v2, v2, v84
v_cmp_eq_u32 vcc, -1, v2
s_cbranch_vccnz L_o9_rt
s_branch L_o9_ok
L_o10_rt:
s_add_u32 s78, s78, 1
s_cmp_gt_u32 s78, 65536
s_cbranch_scc1 L_o10_ok
buffer_load_dwordx4 v[88:91], v6, s[12:15], s34 offen offset:0 sc1
buffer_load_dwordx4 v[92:95], v19, s[12:15], s34 offen offset:0 sc1
buffer_load_dwordx4 v[96:99], v6, s[12:15], s34 offen offset:1024 sc1
buffer_load_dwordx4 v[100:103], v19, s[12:15], s34 offen offset:1024 sc1
s_waitcnt vmcnt(4)
v_max3_u32 v2, v104, v108, v112
v_max3_u32 v2, v2, v116, v56
v_max3_u32 v2, v2, v60, v64
v_max3_u32 v2, v2, v68, v68
v_cmp_eq_u32 vcc, -1, v2
s_cbranch_vccz L_o10_a
buffer_load_dwordx4 v[104:107], v6, s[12:15], s35 offen offset:0 sc1
buffer_load_dwordx4 v[108:111], v19, s[12:15], s35 offen offset:0 sc1
buffer_load_dwordx4 v[112:115], v6, s[12:15], s35 offen offset:1024 sc1
buffer_load_dwordx4 v[116:119], v19, s[12:15], s35 offen offset:1024 sc1
buffer_load_dwordx4 v[56:59], v6, s[12:15], s36 offen offset:0 sc1
buffer_load_dwordx4 v[60:63], v19, s[12:15], s36 offen offset:0 sc1
buffer_load_dwordx4 v[64:67], v6, s[12:15], s36 offen offset:1024 sc1
buffer_load_dwordx4 v[68:71], v19, s[12:15], s36 offen offset:1024 sc1
s_waitcnt vmcnt(8)
s_branch L_o10_b
L_o10_a:
s_waitcnt vmcnt(0)
L_o10_b:
v_max3_u32 v2, v88, v92, v96
v_max_u32 v2, v2, v100
v_cmp_eq_u32 vcc, -1, v2
s_cbranch_vccnz L_o10_rt
s_branch L_o10_ok
L_o11_rt:
s_add_u32 s78, s78, 1
s_cmp_gt_u32 s78, 65536
s_cbranch_scc1 L_o11_ok
buffer_load_dwordx4 v[104:107], v6, s[12:15], s35 offen offset:0 sc1
buffer_load_dwordx4 v[108:111], v19, s[12:15], s35 offen offset:0 sc1
buffer_load_dwordx4 v[112:115], v6, s[12:15], s35 offen offset:1024 sc1
buffer_load_dwordx4 v[116:119], v19, s[12:15], s35 offen offset:1024 sc1
s_waitcnt vmcnt(4)
v_max3_u32 v2, v56, v60, v64
v_max3_u32 v2, v2, v68, v72
v_max3_u32 v2, v2, v76, v80
v_max3_u32 v2, v2, v84, v84
v_cmp_eq_u32 vcc, -1, v2
s_cbranch_vccz L_o11_a
buffer_load_dwordx4 v[56:59], v6, s[12:15], s36 offen offset:0 sc1
buffer_load_dwordx4 v[60:63], v19, s[12:15], s36 offen offset:0 sc1
buffer_load_dwordx4 v[64:67], v6, s[12:15], s36 offen offset:1024 sc1
buffer_load_dwordx4 v[68:71], v19, s[12:15], s36 offen offset:1024 sc1
buffer_load_dwordx4 v[72:75], v6, s[12:15], s37 offen offset:0 sc1
buffer_load_dwordx4 v[76:79], v19, s[12:15], s37 offen offset:0 sc1
buffer_load_dwordx4 v[80:83], v6, s[12:15], s37 offen offset:1024 sc1
buffer_load_dwordx4 v[84:87], v19, s[12:15], s37 offen offset:1024 sc1
s_waitcnt vmcnt(8)
s_branch L_o11_b
L_o11_a:
s_waitcnt vmcnt(0)
L_o11_b:
v_max3_u32 v2, v104, v108, v112
v_max_u32 v2, v2, v116
v_cmp_eq_u32 vcc, -1, v2
s_cbranch_vccnz L_o11_rt
s_branch L_o11_ok
L_o12_rt:
s_add_u32 s78, s78, 1
s_cmp_gt_u32 s78, 65536
s_cbranch_scc1 L_o12_ok
buffer_load_dwordx4 v[56:59], v6, s[12:15], s36 offen offset:0 sc1
buffer_load_dwordx4 v[60:63], v19, s[12:15], s36 offen offset:0 sc1
buffer_load_dwordx4 v[64:67], v6, s[12:15], s36 offen offset:1024 sc1
buffer_load_dwordx4 v[68:71], v19, s[12:15], s36 offen offset:1024 sc1
s_waitcnt vmcnt(4)
v_max3_u32 v2, v72, v76, v80
v_max3_u32 v2, v2, v84, v88
v_max3_u32 v2, v2, v92, v96
v_max3_u32 v2, v2, v100, v100
v_cmp_eq_u32 vcc, -1, v2
s_cbranch_vccz L_o12_a
buffer_load_dwordx4 v[72:75], v6, s[12:15], s37 offen offset:0 sc1
buffer_load_dwordx4 v[76:79], v19, s[12:15], s37 offen offset:0 sc1
buffer_load_dwordx4 v[80:83], v6, s[12:15], s37 offen offset:1024 sc1
buffer_load_dwordx4 v[84:87], v19, s[12:15], s37 offen offset:1024 sc1
buffer_load_dwordx4 v[88:91], v6, s[12:15], s38 offen offset:0 sc1
buffer_load_dwordx4 v[92:95], v19, s[12:15], s38 offen offset:0 sc1
buffer_load_dwordx4 v[96:99], v6, s[12:15], s38 offen offset:1024 sc1
buffer_load_dwordx4 v[100:103], v19, s[12:15], s38 offen offset:1024 sc1
s_waitcnt vmcnt(8)
s_branch L_o12_b
L_o12_a:
s_waitcnt vmcnt(0)
L_o12_b:
v_max3_u32 v2, v56, v60, v64
v_max_u32 v2, v2, v68
v_cmp_eq_u32 vcc, -1, v2
s_cbranch_vccnz L_o12_rt
s_branch L_o12_ok
L_o13_rt:
s_add_u32 s78, s78, 1
s_cmp_gt_u32 s78, 65536
s_cbranch_scc1 L_o13_ok
buffer_load_dwordx4 v[72:75], v6, s[12:15], s37 offen offset:0 sc1
buffer_load_dwordx4 v[76:79], v19, s[12:15], s37 offen offset:0 sc1
buffer_load_dwordx4 v[80:83], v6, s[12:15], s37 offen offset:1024 sc1
buffer_load_dwordx4 v[84:87], v19, s[12:15], s37 offen offset:1024 sc1
s_waitcnt vmcnt(4)
v_max3_u32 v2, v88, v92, v96
v_max3_u32 v2, v2, v100, v104
v_max3_u32 v2, v2, v108, v112
v_max3_u32 v2, v2, v116, v116
v_cmp_eq_u32 vcc, -1, v2
s_cbranch_vccz L_o13_a
buffer_load_dwordx4 v[88:91], v6, s[12:15], s38 offen offset:0 sc1
buffer_load_dwordx4 v[92:95], v19, s[12:15], s38 offen offset:0 sc1
buffer_load_dwordx4 v[96:99], v6, s[12:15], s38 offen offset:1024 sc1
buffer_load_dwordx4 v[100:103], v19, s[12:15], s38 offen offset:1024 sc1
buffer_load_dwordx4 v[104:107], v6, s[12:15], s39 offen offset:0 sc1
buffer_load_dwordx4 v[108:111], v19, s[12:15], s39 offen offset:0 sc1
buffer_load_dwordx4 v[112:115], v6, s[12:15], s39 offen offset:1024 sc1
buffer_load_dwordx4 v[116:119], v19, s[12:15], s39 offen offset:1024 sc1
s_waitcnt vmcnt(8)
s_branch L_o13_b
L_o13_a:
s_waitcnt vmcnt(0)
L_o13_b:
v_max3_u32 v2, v72, v76, v80
v_max_u32 v2, v2, v84
v_cmp_eq_u32 vcc, -1, v2
s_cbranch_vccnz L_o13_rt
s_branch L_o13_ok
L_o14_rt:
s_add_u32 s78, s78, 1
s_cmp_gt_u32 s78, 65536
s_cbranch_scc1 L_o14_ok
buffer_load_dwordx4 v[88:91], v6, s[12:15], s38 offen offset:0 sc1
buffer_load_dwordx4 v[92:95], v19, s[12:15], s38 offen offset:0 sc1
buffer_load_dwordx4 v[96:99], v6, s[12:15], s38 offen offset:1024 sc1
buffer_load_dwordx4 v[100:103], v19, s[12:15], s38 offen offset:1024 sc1
s_waitcnt vmcnt(4)
v_max3_u32 v2, v104, v108, v112
v_max3_u32 v2, v2, v116, v116
v_cmp_eq_u32 vcc, -1, v2
s_cbranch_vccz L_o14_a
buffer_load_dwordx4 v[104:107], v6, s[12:15], s39 offen offset:0 sc1
buffer_load_dwordx4 v[108:111], v19, s[12:15], s39 offen offset:0 sc1
buffer_load_dwordx4 v[112:115], v6, s[12:15], s39 offen offset:1024 sc1
buffer_load_dwordx4 v[116:119], v19, s[12:15], s39 offen offset:1024 sc1
s_waitcnt vmcnt(4)
s_branch L_o14_b
L_o14_a:
s_waitcnt vmcnt(0)
L_o14_b:
v_max3_u32 v2, v88, v92, v96
v_max_u32 v2, v2, v100
v_cmp_eq_u32 vcc, -1, v2
s_cbranch_vccnz L_o14_rt
s_branch L_o14_ok
L_o15_rt:
s_add_u32 s78, s78, 1
s_cmp_gt_u32 s78, 65536
s_cbranch_scc1 L_o15_ok
buffer_load_dwordx4 v[104:107], v6, s[12:15], s39 offen offset:0 sc1
buffer_load_dwordx4 v[108:111], v19, s[12:15], s39 offen offset:0 sc1
buffer_load_dwordx4 v[112:115], v6, s[12:15], s39 offen offset:1024 sc1
buffer_load_dwordx4 v[116:119], v19, s[12:15], s39 offen offset:1024 sc1
s_waitcnt vmcnt(0)
L_o15_b:
v_max3_u32 v2, v104, v108, v112
v_max_u32 v2, v2, v116
v_cmp_eq_u32 vcc, -1, v2
s_cbranch_vccnz L_o15_rt
s_branch L_o15_ok
L_stp_s:
buffer_store_dwordx4 v[72:75], v144, s[12:15], s72 offen offset:0 sc1
buffer_store_dwordx4 v[76:79], v144, s[12:15], s72 offen offset:256 sc1
s_branch L_stp_d
L_pad18:
s_branch L_retG
L_st_rt:
s_add_u32 s78, s78, 1
s_cmp_gt_u32 s78, 65536
s_cbranch_scc1 L_st_ok
v_cmp_ne_u32 vcc, s68, v99
s_cbranch_vccz L_st_p0
s_add_u32 s70, s75, 0
buffer_load_dwordx4 v[96:99], v145, s[12:15], s70 offen sc1
L_st_p0:
v_cmp_ne_u32 vcc, s68, v103
s_cbranch_vccz L_st_p1
s_add_u32 s70, s75, 4096
buffer_load_dwordx4 v[100:103], v145, s[12:15], s70 offen sc1
L_st_p1:
v_cmp_ne_u32 vcc, s68, v107
s_cbranch_vccz L_st_p2
s_add_u32 s70, s75, 8192
buffer_load_dwordx4 v[104:107], v145, s[12:15], s70 offen sc1
L_st_p2:
v_cmp_ne_u32 vcc, s68, v111
s_cbranch_vccz L_st_p3
s_add_u32 s70, s75, 12288
buffer_load_dwordx4 v[108:111], v145, s[12:15], s70 offen sc1
L_st_p3:
v_cmp_ne_u32 vcc, s68, v115
s_cbranch_vccz L_st_p4
s_add_u32 s70, s75, 16384
buffer_load_dwordx4 v[112:115], v145, s[12:15], s70 offen sc1
L_st_p4:
v_cmp_ne_u32 vcc, s68, v119
s_cbranch_vccz L_st_p5
s_add_u32 s70, s75, 20480
buffer_load_dwordx4 v[116:119], v145, s[12:15], s70 offen sc1
L_st_p5:
v_cmp_ne_u32 vcc, s68, v123
s_cbranch_vccz L_st_p6
s_add_u32 s70, s75, 24576
buffer_load_dwordx4 v[120:123], v145, s[12:15], s70 offen sc1
L_st_p6:
v_cmp_ne_u32 vcc, s68, v127
s_cbranch_vccz L_st_p7
s_add_u32 s70, s75, 28672
buffer_load_dwordx4 v[124:127], v145, s[12:15], s70 offen sc1
L_st_p7:
s_waitcnt vmcnt(0)
s_branch L_st_chk
L_fin:
.section .rodata,"a"
.p2align 6
.amdhsa_kernel sequential_preLN__linear_attn_block__moe_arch_mod__prompt_kernel
  .amdhsa_next_free_vgpr 256
  .amdhsa_next_free_sgpr 102
  .amdhsa_accum_offset 152
  .amdhsa_group_segment_fixed_size 0
  .amdhsa_kernarg_size 88
  .amdhsa_user_sgpr_count 2
  .amdhsa_user_sgpr_kernarg_segment_ptr 1
  .amdhsa_system_sgpr_workgroup_id_x 1
  .amdhsa_float_denorm_mode_32 3
.end_amdhsa_kernel
```

```asm
; @launch grid=(256,1,1) block=(512,1,1) lds=163840
.amdgcn_target "amdgcn-amd-amdhsa--gfx950"
.text
.p2alignl 12, 0xbf810000
.fill 832, 4, 0xbf810000
.globl sequential_preLN__linear_attn_block__moe_arch_mod__prompt_kernel
.p2align 8
.type sequential_preLN__linear_attn_block__moe_arch_mod__prompt_kernel,@function
sequential_preLN__linear_attn_block__moe_arch_mod__prompt_kernel:
s_cmp_ge_u32 s2, 256
s_cbranch_scc1 L_end
s_load_dwordx16 s[40:55], s[0:1], 0
s_load_dwordx2 s[56:57], s[0:1], 64
s_load_dwordx2 s[58:59], s[0:1], 80
s_getpc_b64 s[20:21]
L_pc:
s_sub_u32 s20, s20, L_pc-sequential_preLN__linear_attn_block__moe_arch_mod__prompt_kernel
s_subb_u32 s21, s21, 0
s_and_b32 s21, s21, 0xffff
s_mov_b32 s22, L_fin-sequential_preLN__linear_attn_block__moe_arch_mod__prompt_kernel
s_mov_b32 s23, 0x20000
s_lshr_b32 s70, s2, 3
s_mul_i32 s70, s70, 1536
v_lshlrev_b32 v81, 7, v0
v_cmp_gt_u32 vcc, 12, v0
s_nop 0
s_mov_b64 exec, vcc
buffer_load_dword v81, v81, s[20:23], s70 offen
s_mov_b64 exec, -1
v_lshrrev_b32 v2, 6, v0
v_and_b32 v1, 63, v0
v_readfirstlane_b32 s60, v2
s_and_b32 s62, s2, 7
s_lshr_b32 s63, s2, 3
s_lshl_b32 s64, s62, 1
s_and_b32 s70, s63, 1
s_add_u32 s64, s64, s70
s_lshr_b32 s65, s63, 1
s_lshl_b32 s79, s64, 4
s_add_u32 s79, s79, s65
s_mov_b32 s78, 0
s_mul_i32 s70, s62, 2
s_add_u32 s89, s65, s70
s_and_b32 s89, s89, 15
s_lshr_b32 s61, s60, 2
s_and_b32 s60, s60, 3
s_lshr_b32 s66, s60, 1
s_and_b32 s67, s60, 1
v_lshlrev_b32 v16, 4, v1
s_cmp_eq_u32 s61, 0
s_cbranch_scc1 L_compute
s_setprio 1
v_mov_b32 v18, v16
s_lshl_b32 s70, s65, 2
s_add_u32 s70, s70, s60
s_lshl_b32 s70, s70, 16
v_lshrrev_b32 v2, 3, v1
v_lshlrev_b32 v5, 11, v2
v_add_u32 v5, s70, v5
v_lshrrev_b32 v3, 4, v1
v_and_b32 v4, 7, v1
v_xor_b32 v3, v3, v4
v_xor_b32_e64 v6, 0, v3
v_lshl_add_u32 v6, v6, 4, v5
v_add_u32 v8, 0, v6
v_xor_b32 v6, 4, v3
v_lshl_add_u32 v6, v6, 4, v5
v_add_u32 v9, 15360, v6
v_xor_b32 v6, 0, v3
v_lshl_add_u32 v6, v6, 4, v5
v_add_u32 v10, 30720, v6
v_xor_b32 v6, 4, v3
v_lshl_add_u32 v6, v6, 4, v5
v_add_u32 v11, 46080, v6
s_lshl_b32 s70, s60, 4
v_add_u32 v5, s70, v2
v_mul_u32_u24 v5, 6144, v5
s_lshl_b32 s70, s64, 7
v_add_u32 v5, s70, v5
v_bfe_u32 v3, v1, 4, 1
v_lshlrev_b32 v3, 1, v3
v_xor_b32 v3, v3, v4
v_xor_b32 v6, 0, v3
v_lshl_add_u32 v6, v6, 4, v5
v_add_u32 v12, 0, v6
v_xor_b32 v6, 4, v3
v_lshl_add_u32 v6, v6, 4, v5
v_add_u32 v13, 48128, v6
v_xor_b32 v6, 0, v3
v_lshl_add_u32 v6, v6, 4, v5
v_add_u32 v14, 0, v6
v_xor_b32 v6, 4, v3
v_lshl_add_u32 v6, v6, 4, v5
v_add_u32 v15, 48128, v6
v_xor_b32 v6, 0, v3
v_lshl_add_u32 v6, v6, 4, v5
v_add_u32 v16, 4096, v6
v_xor_b32 v6, 4, v3
v_lshl_add_u32 v6, v6, 4, v5
v_add_u32 v17, 52224, v6
s_lshl_b32 s76, s60, 12
s_mul_i32 s77, s60, 6144
s_and_b32 s70, s64, 1
s_lshl_b32 s70, s70, 3
s_mov_b32 s70, 0
s_andn2_b32 s71, s65, 1
s_add_u32 s70, s70, s71
s_and_b32 s70, s70, 15
s_mul_i32 s75, s70, 393216
s_lshl_b32 s74, s70, 7
s_waitcnt lgkmcnt(0)
s_load_dword s68, s[58:59], 0
s_mov_b32 s4, s40
s_and_b32 s5, s41, 0xffff
s_mov_b32 s6, 4194304
s_mov_b32 s7, 0x20000
s_mov_b32 s8, s42
s_and_b32 s9, s43, 0xffff
s_mov_b32 s10, 6291456
s_mov_b32 s11, 0x20000
s_add_u32 m0, s76, 122880
s_nop 0
buffer_load_dwordx4 v8, s[4:7], s74 offen offset:0 lds
buffer_load_dwordx4 v9, s[4:7], s74 offen offset:1024 lds
buffer_load_dwordx4 v10, s[4:7], s74 offen offset:2048 lds
buffer_load_dwordx4 v11, s[4:7], s74 offen offset:3072 lds
s_add_u32 s74, s74, 128
s_and_b32 s74, s74, 2047
s_add_u32 m0, s77, 0
s_nop 0
buffer_load_dwordx4 v12, s[8:11], s75 offen offset:0 lds
buffer_load_dwordx4 v13, s[8:11], s75 offen offset:1024 lds
buffer_load_dwordx4 v14, s[8:11], s75 offen offset:2048 lds
buffer_load_dwordx4 v15, s[8:11], s75 offen offset:3072 lds
s_add_u32 m0, s77, 4096
s_nop 0
buffer_load_dwordx4 v16, s[8:11], s75 offen offset:0 lds
buffer_load_dwordx4 v17, s[8:11], s75 offen offset:1024 lds
s_add_u32 s75, s75, 393216
s_cmp_eq_u32 s75, 6291456
s_cselect_b32 s75, 0, s75
s_mov_b32 s12, s58
s_and_b32 s13, s59, 0xffff
s_mov_b32 s14, 268435456
s_mov_b32 s15, 0x20000
s_mov_b32 s16, s44
s_and_b32 s17, s45, 0xffff
s_mov_b32 s18, 2097152
s_mov_b32 s19, 0x20000
s_mov_b32 s20, s56
s_and_b32 s21, s57, 0xffff
s_mov_b32 s22, 4194304
s_mov_b32 s23, 0x20000
s_mov_b32 s24, s50
s_and_b32 s25, s51, 0xffff
s_mov_b32 s26, 7340032
s_mov_b32 s27, 0x20000
s_mov_b32 s28, s52
s_and_b32 s29, s53, 0xffff
s_mov_b32 s30, 7340032
s_mov_b32 s31, 0x20000
s_mov_b32 s32, s54
s_and_b32 s33, s55, 0xffff
s_mov_b32 s34, 7340032
s_mov_b32 s35, 0x20000
s_mov_b32 s36, s48
s_and_b32 s37, s49, 0xffff
s_mov_b32 s38, 2048
s_mov_b32 s39, 0x20000
s_lshl_b32 s70, s65, 7
s_lshl_b32 s71, s64, 3
s_add_u32 s70, s70, s71
s_lshl_b32 s71, s60, 1
s_add_u32 s87, s70, s71
v_lshrrev_b32 v2, 3, v1
v_lshlrev_b32 v3, 11, v2
v_bfe_u32 v5, v1, 4, 2
v_lshlrev_b32 v5, 1, v5
v_and_b32 v4, 7, v1
v_xor_b32 v5, v5, v4
v_lshl_add_u32 v3, v5, 4, v3
s_lshl_b32 s70, s65, 7
v_add_u32 v80, s70, v3
v_mov_b32 v72, -1
v_mov_b32 v73, -1
v_mov_b32 v74, -1
v_mov_b32 v75, -1
s_mul_i32 s80, s79, 4352
s_add_u32 s80, s80, 524288
s_and_b32 s81, s65, 7
s_lshl_b32 s81, s81, 19
s_lshr_b32 s70, s65, 1
s_xor_b32 s70, s70, s65
s_and_b32 s70, s70, 4
s_lshl_b32 s70, s70, 11
s_xor_b32 s70, s70, 2105344
s_add_u32 s81, s81, s70
s_mul_i32 s70, s66, 262144
s_add_u32 s81, s81, s70
s_lshr_b32 s70, s64, 2
s_lshl_b32 s70, s70, 14
s_add_u32 s81, s81, s70
s_and_b32 s70, s64, 3
s_lshl_b32 s70, s70, 11
s_add_u32 s81, s81, s70
s_lshl_b32 s70, s67, 10
s_add_u32 s81, s81, s70
s_mov_b32 s72, 0x6543e210
s_mov_b32 s73, 0xdcbaf987
s_lshl_b32 s70, s64, 2
s_lshr_b64 s[72:73], s[72:73], s70
s_and_b32 s3, s72, 15
v_mul_u32_u24 v76, 7168, v2
v_lshl_add_u32 v76, v4, 4, v76
v_lshlrev_b32 v77, 11, v2
v_lshl_add_u32 v77, v4, 4, v77
s_and_b32 s70, s65, 3
s_lshl_b32 s70, s70, 2
s_add_u32 s70, s70, s60
s_mul_i32 s85, s70, 458752
s_lshl_b32 s70, s3, 9
s_add_u32 s85, s85, s70
s_lshr_b32 s70, s65, 2
s_lshl_b32 s70, s70, 7
s_xor_b32 s71, s70, 128
v_add_u32 v78, s71, v76
v_add_u32 v76, s70, v76
s_and_b32 s70, s65, 3
s_lshl2_add_u32 s70, s3, s70
s_and_b32 s71, s65, 12
s_add_u32 s71, s71, s60
s_lshl_b32 s86, s70, 17
s_lshl_b32 s70, s71, 7
s_add_u32 s86, s86, s70
s_cmp_lt_u32 s3, 14
s_cselect_b32 s26, s26, 0
s_cselect_b32 s30, s30, 0
s_cselect_b32 s34, s34, 0
s_mov_b32 s90, 0x10001
s_movk_i32 s91, 0xff
v_mov_b32 v79, 0
s_lshl_b32 s70, s87, 4
s_add_u32 s70, s70, 8192
v_writelane_b32 v79, s70, 0
s_lshl_b32 s70, s79, 4
s_add_u32 s70, s70, 4096
v_writelane_b32 v79, s70, 1
s_lshl_b32 s70, s64, 7
s_add_u32 s70, s70, 6815744
v_writelane_b32 v79, s70, 2
s_lshl_b32 s70, s79, 10
s_add_u32 s70, s70, 65536
v_writelane_b32 v79, s70, 3
s_lshl_b32 s70, s60, 10
s_add_u32 s70, s70, s80
v_writelane_b32 v79, s70, 4
s_lshl_b32 s70, s67, 7
s_add_u32 s70, s70, s80
s_add_u32 s70, s70, 4096
v_writelane_b32 v79, s70, 5
s_and_b32 s71, s65, 3
s_lshl2_add_u32 s71, s3, s71
s_and_b32 s70, s65, 12
s_add_u32 s70, s70, s60
s_lshl_b32 s71, s71, 7
s_bitcmp1_b32 s70, 3
s_cselect_b32 s72, 0, 8192
s_add_u32 s71, s71, s72
s_and_b32 s70, s70, 7
s_lshl_b32 s70, s70, 16
s_add_u32 s70, s70, s71
s_add_u32 s70, s70, 7340032
v_writelane_b32 v79, s70, 6
s_lshl_b32 s71, s79, 2
s_add_u32 s71, s71, s60
s_lshl_b32 s70, s71, 9
s_add_u32 s70, s70, 6291456
v_writelane_b32 v79, s70, 7
s_lshl_b32 s71, s79, 2
s_add_u32 s71, s71, s60
s_lshl_b32 s70, s71, 8
s_add_u32 s70, s70, 6946816
v_writelane_b32 v79, s70, 8
s_add_u32 s70, s81, 0
v_writelane_b32 v79, s70, 9
s_add_u32 s70, s81, 65536
v_writelane_b32 v79, s70, 10
s_add_u32 s70, s81, 131072
v_writelane_b32 v79, s70, 11
s_add_u32 s70, s81, 196608
v_writelane_b32 v79, s70, 12
s_and_b32 s70, s65, 7
s_min_u32 s71, s60, 0
s_lshl_b32 s71, s71, 3
s_add_u32 s70, s70, s71
s_lshl_b32 s70, s70, 4
s_add_u32 s70, s70, s64
s_lshl_b32 s70, s70, 7
s_add_u32 s70, s70, 6815744
v_writelane_b32 v79, s70, 2
v_and_b32 v2, 7, v1
v_lshlrev_b32 v2, 7, v2
v_lshrrev_b32 v3, 3, v1
v_lshl_add_u32 v83, v3, 16, v2
v_add_u32 v83, s81, v83
s_mov_b32 exec_lo, 0
s_and_b32 s71, s65, 3
s_lshl2_add_u32 s71, s3, s71
s_and_b32 s70, s65, 12
s_add_u32 s70, s70, s60
s_lshl_b32 s71, s71, 7
s_bitcmp1_b32 s70, 3
s_cselect_b32 s72, 0, 8192
s_add_u32 s71, s71, s72
s_and_b32 s70, s70, 7
s_lshl_b32 s70, s70, 16
s_add_u32 s70, s70, s71
s_add_u32 s70, s70, 7340032
s_mov_b32 exec_hi, 0xff
v_and_b32 v2, 3, v1
v_lshl_add_u32 v83, v2, 14, s70
s_lshl_b32 s70, s60, 10
s_add_u32 s70, s70, s80
s_mov_b32 exec_hi, 0xff0000
v_and_b32 v2, 7, v1
v_lshl_add_u32 v83, v2, 7, s70
s_lshl_b32 s71, s79, 2
s_add_u32 s71, s71, s60
s_lshl_b32 s70, s71, 9
s_add_u32 s70, s70, 6291456
s_mov_b32 exec_hi, 0xf000000
v_and_b32 v2, 3, v1
v_lshl_add_u32 v83, v2, 7, s70
s_lshl_b32 s71, s79, 2
s_add_u32 s71, s71, s60
s_lshl_b32 s70, s71, 8
s_add_u32 s70, s70, 6946816
s_mov_b32 exec_hi, 0x30000000
v_and_b32 v2, 1, v1
v_lshl_add_u32 v83, v2, 7, s70
s_lshl_b32 s70, s67, 7
s_add_u32 s70, s70, s80
s_add_u32 s70, s70, 4096
s_mov_b32 exec_hi, 0xc0000000
v_and_b32 v2, 0, v1
v_lshl_add_u32 v83, v2, 7, s70
s_lshl4_add_u32 s70, s64, s65
s_lshl2_add_u32 s70, s70, s60
s_lshl_b32 s70, s70, 6
s_add_u32 s70, s70, 1638400
s_mov_b32 exec_hi, 0x100
v_and_b32 v2, 0, v1
v_lshl_add_u32 v83, v2, 7, s70
s_mov_b64 exec, -1
s_add_u32 m0, s76, 106496
s_nop 0
buffer_load_dwordx4 v8, s[4:7], s74 offen offset:0 lds
buffer_load_dwordx4 v9, s[4:7], s74 offen offset:1024 lds
buffer_load_dwordx4 v10, s[4:7], s74 offen offset:2048 lds
buffer_load_dwordx4 v11, s[4:7], s74 offen offset:3072 lds
s_add_u32 s74, s74, 128
s_and_b32 s74, s74, 2047
s_add_u32 m0, s77, 81920
s_nop 0
buffer_load_dwordx4 v12, s[8:11], s75 offen offset:0 lds
buffer_load_dwordx4 v13, s[8:11], s75 offen offset:1024 lds
buffer_load_dwordx4 v14, s[8:11], s75 offen offset:2048 lds
buffer_load_dwordx4 v15, s[8:11], s75 offen offset:3072 lds
s_add_u32 m0, s77, 86016
s_nop 0
buffer_load_dwordx4 v16, s[8:11], s75 offen offset:0 lds
buffer_load_dwordx4 v17, s[8:11], s75 offen offset:1024 lds
s_add_u32 s75, s75, 393216
s_cmp_eq_u32 s75, 6291456
s_cselect_b32 s75, 0, s75
s_cmp_lt_u32 s3, 14
s_cbranch_scc1 L_norace
s_cmp_ge_u32 s60, 2
s_cbranch_scc1 L_norace
s_and_b32 s70, s3, 1
s_lshl4_add_u32 s70, s70, s65
s_lshl1_add_u32 s73, s70, s60
s_lshl_b32 s70, s73, 7
s_lshl_b32 s71, s60, 13
s_add_u32 s70, s70, s71
s_xor_b32 s70, s70, 401408
s_xor_b32 s71, s70, 0x2000
s_mov_b32 s69, 0x5bd1e995
s_waitcnt lgkmcnt(0)
s_load_dword s61, s[12:13], s70
s_load_dword s69, s[12:13], s71
s_lshr_b32 s70, s62, 2
s_xor_b32 s70, s70, s60
s_sub_u32 s70, 2, s70
s_add_u32 s71, s68, 1
s_lshl_b32 s71, s71, 2
s_lshl_b32 s73, s73, 2
s_add_u32 s73, s73, 7225600
s_waitcnt lgkmcnt(1)
s_cmp_eq_u32 s69, 0x5bd1e995
s_cselect_b32 s70, s70, 0
s_or_b32 s70, s70, s71
v_mov_b32_e64 v19, s70
s_mov_b64 exec, 1
buffer_store_dword v19, off, s[12:15], s73 sc1
s_mov_b64 exec, -1
L_norace:
s_waitcnt vmcnt(10)
s_barrier
s_add_u32 m0, s76, 65536
s_nop 0
buffer_load_dwordx4 v8, s[4:7], s74 offen offset:0 lds
buffer_load_dwordx4 v9, s[4:7], s74 offen offset:1024 lds
buffer_load_dwordx4 v10, s[4:7], s74 offen offset:2048 lds
buffer_load_dwordx4 v11, s[4:7], s74 offen offset:3072 lds
s_add_u32 s74, s74, 128
s_and_b32 s74, s74, 2047
s_add_u32 m0, s77, 40960
s_nop 0
buffer_load_dwordx4 v12, s[8:11], s75 offen offset:0 lds
buffer_load_dwordx4 v13, s[8:11], s75 offen offset:1024 lds
buffer_load_dwordx4 v14, s[8:11], s75 offen offset:2048 lds
buffer_load_dwordx4 v15, s[8:11], s75 offen offset:3072 lds
s_add_u32 m0, s77, 45056
s_nop 0
buffer_load_dwordx4 v16, s[8:11], s75 offen offset:0 lds
buffer_load_dwordx4 v17, s[8:11], s75 offen offset:1024 lds
s_add_u32 s75, s75, 393216
s_cmp_eq_u32 s75, 6291456
s_cselect_b32 s75, 0, s75
s_waitcnt vmcnt(10)
s_barrier
s_add_u32 m0, s76, 24576
s_nop 0
buffer_load_dwordx4 v8, s[4:7], s74 offen offset:0 lds
buffer_load_dwordx4 v9, s[4:7], s74 offen offset:1024 lds
buffer_load_dwordx4 v10, s[4:7], s74 offen offset:2048 lds
buffer_load_dwordx4 v11, s[4:7], s74 offen offset:3072 lds
s_add_u32 s74, s74, 128
s_and_b32 s74, s74, 2047
s_add_u32 m0, s77, 0
s_nop 0
buffer_load_dwordx4 v12, s[8:11], s75 offen offset:0 lds
buffer_load_dwordx4 v13, s[8:11], s75 offen offset:1024 lds
buffer_load_dwordx4 v14, s[8:11], s75 offen offset:2048 lds
buffer_load_dwordx4 v15, s[8:11], s75 offen offset:3072 lds
s_add_u32 m0, s77, 4096
s_nop 0
buffer_load_dwordx4 v16, s[8:11], s75 offen offset:0 lds
buffer_load_dwordx4 v17, s[8:11], s75 offen offset:1024 lds
s_add_u32 s75, s75, 393216
s_cmp_eq_u32 s75, 6291456
s_cselect_b32 s75, 0, s75
s_add_u32 m0, s76, 122880
s_nop 0
buffer_load_dwordx4 v8, s[4:7], s74 offen offset:0 lds
buffer_load_dwordx4 v9, s[4:7], s74 offen offset:1024 lds
buffer_load_dwordx4 v10, s[4:7], s74 offen offset:2048 lds
buffer_load_dwordx4 v11, s[4:7], s74 offen offset:3072 lds
s_add_u32 s74, s74, 128
s_and_b32 s74, s74, 2047
v_lshlrev_b32 v2, 3, v1
s_lshl_b32 s70, s60, 9
buffer_load_dwordx2 v[88:89], v2, s[36:39], s70 offen
s_lshl_b32 s70, s87, 11
buffer_load_dwordx4 v[20:23], v18, s[4:7], s70 offen offset:0
s_lshl_b32 s70, s87, 11
buffer_load_dwordx4 v[24:27], v18, s[4:7], s70 offen offset:1024
s_lshl_b32 s70, s87, 11
buffer_load_dwordx4 v[28:31], v18, s[4:7], s70 offen offset:2048
s_lshl_b32 s70, s87, 11
buffer_load_dwordx4 v[32:35], v18, s[4:7], s70 offen offset:3072
s_mov_b64 exec, 0x1ef
buffer_load_dword v81, v79, s[12:15], 0 offen
s_mov_b64 exec, -1
s_lshl_b32 s70, s64, 2
s_add_u32 s70, s70, s60
s_lshl_b32 s70, s70, 15
s_lshl_b32 s71, s65, 7
s_add_u32 s70, s70, s71
s_add_u32 s70, s70, 8388608
v_and_b32 v19, 0xf800, v77
v_mad_u32_u24 v19, v19, 3, v77
s_mov_b32 exec_hi, 0
buffer_store_dwordx4 v[72:75], v19, s[12:15], s70 offen sc1
s_mov_b64 exec, -1
s_lshl4_add_u32 s70, s64, s65
s_lshl2_add_u32 s70, s70, s60
s_lshl_b32 s70, s70, 6
s_add_u32 s70, s70, 1638400
s_mov_b64 exec, 15
buffer_store_dwordx4 v[72:75], v18, s[12:15], s70 offen sc1
s_mov_b64 exec, -1
s_waitcnt vmcnt(22)
s_barrier
s_add_u32 m0, s77, 81920
s_nop 0
buffer_load_dwordx4 v12, s[8:11], s75 offen offset:0 lds
buffer_load_dwordx4 v13, s[8:11], s75 offen offset:1024 lds
buffer_load_dwordx4 v14, s[8:11], s75 offen offset:2048 lds
buffer_load_dwordx4 v15, s[8:11], s75 offen offset:3072 lds
s_add_u32 m0, s77, 86016
s_nop 0
buffer_load_dwordx4 v16, s[8:11], s75 offen offset:0 lds
buffer_load_dwordx4 v17, s[8:11], s75 offen offset:1024 lds
s_add_u32 s75, s75, 393216
s_cmp_eq_u32 s75, 6291456
s_cselect_b32 s75, 0, s75
s_add_u32 m0, s76, 106496
s_nop 0
buffer_load_dwordx4 v8, s[4:7], s74 offen offset:0 lds
buffer_load_dwordx4 v9, s[4:7], s74 offen offset:1024 lds
buffer_load_dwordx4 v10, s[4:7], s74 offen offset:2048 lds
buffer_load_dwordx4 v11, s[4:7], s74 offen offset:3072 lds
s_add_u32 s74, s74, 128
s_and_b32 s74, s74, 2047
s_waitcnt vmcnt(22)
s_barrier
s_add_u32 m0, s77, 40960
s_nop 0
buffer_load_dwordx4 v12, s[8:11], s75 offen offset:0 lds
s_waitcnt vmcnt(14)
s_waitcnt lgkmcnt(0)
s_add_u32 s68, s68, 1
s_and_b32 s84, s68, 0xff
s_not_b32 s70, s68
v_and_b32 v82, 3, v1
v_lshrrev_b32_e64 v82, v82, s70
v_and_b32 v82, 1, v82
v_mul_u32_u24 v82, 0x10001, v82
buffer_load_dwordx4 v13, s[8:11], s75 offen offset:1024 lds
v_lshlrev_b32 v36, 16, v20
v_and_b32 v37, 0xffff0000, v20
v_lshlrev_b32 v38, 16, v21
v_and_b32 v39, 0xffff0000, v21
v_lshlrev_b32 v40, 16, v22
buffer_load_dwordx4 v14, s[8:11], s75 offen offset:2048 lds
v_and_b32 v41, 0xffff0000, v22
v_lshlrev_b32 v42, 16, v23
v_and_b32 v43, 0xffff0000, v23
v_lshlrev_b32 v44, 16, v24
v_and_b32 v45, 0xffff0000, v24
buffer_load_dwordx4 v15, s[8:11], s75 offen offset:3072 lds
v_lshlrev_b32 v46, 16, v25
v_and_b32 v47, 0xffff0000, v25
v_lshlrev_b32 v48, 16, v26
v_and_b32 v49, 0xffff0000, v26
v_lshlrev_b32 v50, 16, v27
s_add_u32 m0, s77, 45056
s_nop 0
buffer_load_dwordx4 v16, s[8:11], s75 offen offset:0 lds
v_and_b32 v51, 0xffff0000, v27
v_lshlrev_b32 v52, 16, v28
v_and_b32 v53, 0xffff0000, v28
v_lshlrev_b32 v54, 16, v29
v_and_b32 v55, 0xffff0000, v29
buffer_load_dwordx4 v17, s[8:11], s75 offen offset:1024 lds
s_add_u32 s75, s75, 393216
s_cmp_eq_u32 s75, 6291456
s_cselect_b32 s75, 0, s75
v_lshlrev_b32 v56, 16, v30
v_and_b32 v57, 0xffff0000, v30
v_lshlrev_b32 v58, 16, v31
v_and_b32 v59, 0xffff0000, v31
v_lshlrev_b32 v60, 16, v32
s_add_u32 m0, s76, 65536
s_nop 0
buffer_load_dwordx4 v8, s[4:7], s74 offen offset:0 lds
v_and_b32 v61, 0xffff0000, v32
v_lshlrev_b32 v62, 16, v33
v_and_b32 v63, 0xffff0000, v33
v_lshlrev_b32 v64, 16, v34
v_and_b32 v65, 0xffff0000, v34
buffer_load_dwordx4 v9, s[4:7], s74 offen offset:1024 lds
v_lshlrev_b32 v66, 16, v35
v_and_b32 v67, 0xffff0000, v35
v_add_f32 v20, v36, v40
v_add_f32 v28, v52, v56
v_add_f32 v21, v37, v41
buffer_load_dwordx4 v10, s[4:7], s74 offen offset:2048 lds
v_add_f32 v29, v53, v57
v_add_f32 v22, v38, v42
v_add_f32 v30, v54, v58
v_add_f32 v23, v39, v43
v_add_f32 v31, v55, v59
buffer_load_dwordx4 v11, s[4:7], s74 offen offset:3072 lds
s_add_u32 s74, s74, 128
s_and_b32 s74, s74, 2047
v_add_f32 v20, v20, v44
v_add_f32 v28, v28, v60
s_waitcnt vmcnt(14)
s_barrier
s_add_u32 m0, s77, 0
s_nop 0
buffer_load_dwordx4 v12, s[8:11], s75 offen offset:0 lds
v_add_f32 v21, v21, v45
v_add_f32 v29, v29, v61
v_add_f32 v22, v22, v46
v_add_f32 v30, v30, v62
v_add_f32 v23, v23, v47
buffer_load_dwordx4 v13, s[8:11], s75 offen offset:1024 lds
v_add_f32 v31, v31, v63
v_add_f32 v20, v20, v48
v_add_f32 v28, v28, v64
v_add_f32 v21, v21, v49
v_add_f32 v29, v29, v65
buffer_load_dwordx4 v14, s[8:11], s75 offen offset:2048 lds
v_add_f32 v22, v22, v50
v_add_f32 v30, v30, v66
v_add_f32 v23, v23, v51
v_add_f32 v31, v31, v67
v_add_f32_e64 v20, v20, v21
buffer_load_dwordx4 v15, s[8:11], s75 offen offset:3072 lds
v_add_f32 v22, v22, v23
v_add_f32 v28, v28, v29
v_add_f32 v30, v30, v31
v_add_f32 v2, v20, v22
v_add_f32 v4, v28, v30
s_add_u32 m0, s77, 4096
s_nop 0
buffer_load_dwordx4 v16, s[8:11], s75 offen offset:0 lds
v_add_f32_dpp v2, v2, v2 row_ror:1 row_mask:0xf bank_mask:0xf
v_add_f32_dpp v4, v4, v4 row_ror:1 row_mask:0xf bank_mask:0xf
s_nop 0
v_add_f32_dpp v2, v2, v2 row_ror:2 row_mask:0xf bank_mask:0xf
v_add_f32_dpp v4, v4, v4 row_ror:2 row_mask:0xf bank_mask:0xf
s_nop 0
v_add_f32_dpp v2, v2, v2 row_ror:4 row_mask:0xf bank_mask:0xf
buffer_load_dwordx4 v17, s[8:11], s75 offen offset:1024 lds
s_add_u32 s75, s75, 393216
s_cmp_eq_u32 s75, 6291456
s_cselect_b32 s75, 0, s75
v_add_f32_dpp v4, v4, v4 row_ror:4 row_mask:0xf bank_mask:0xf
v_add_f32_dpp v2, v2, v2 row_ror:8 row_mask:0xf bank_mask:0xf
s_nop 0
v_add_f32_dpp v4, v4, v4 row_ror:8 row_mask:0xf bank_mask:0xf
v_mov_b32 v6, v2
v_mov_b32 v7, v4
s_add_u32 m0, s76, 24576
s_nop 0
buffer_load_dwordx4 v8, s[4:7], s74 offen offset:0 lds
v_permlane16_swap_b32 v2, v6
v_permlane16_swap_b32 v4, v7
v_add_f32 v2, v2, v6
v_add_f32 v4, v4, v7
v_mov_b32 v6, v2
buffer_load_dwordx4 v9, s[4:7], s74 offen offset:1024 lds
v_mov_b32 v7, v4
v_permlane32_swap_b32 v2, v6
s_nop 0
v_permlane32_swap_b32 v4, v7
v_add_f32 v2, v2, v6
v_add_f32 v4, v4, v7
buffer_load_dwordx4 v10, s[4:7], s74 offen offset:2048 lds
v_mul_f32 v2, 0xba800000, v2
v_mul_f32 v4, 0xba800000, v4
v_add_f32_e64 v36, v36, v2
v_add_f32 v52, v52, v4
v_add_f32 v37, v37, v2
buffer_load_dwordx4 v11, s[4:7], s74 offen offset:3072 lds
s_add_u32 s74, s74, 128
s_and_b32 s74, s74, 2047
v_add_f32 v53, v53, v4
v_add_f32 v38, v38, v2
s_cmp_eq_u32 s60, 0
s_cbranch_scc1 L_pad0
s_cmp_eq_u32 s60, 1
s_cbranch_scc1 L_pad3
s_cmp_eq_u32 s60, 2
s_cbranch_scc1 L_pad4
s_branch L_ret4
L_ret4:
s_waitcnt vmcnt(14)
s_barrier
s_add_u32 m0, s77, 81920
s_nop 0
buffer_load_dwordx4 v12, s[8:11], s75 offen offset:0 lds
v_add_f32 v54, v54, v4
v_add_f32 v39, v39, v2
v_add_f32 v55, v55, v4
v_add_f32 v40, v40, v2
v_add_f32 v56, v56, v4
buffer_load_dwordx4 v13, s[8:11], s75 offen offset:1024 lds
v_add_f32 v41, v41, v2
v_add_f32 v57, v57, v4
v_add_f32 v42, v42, v2
v_add_f32 v58, v58, v4
v_add_f32 v43, v43, v2
buffer_load_dwordx4 v14, s[8:11], s75 offen offset:2048 lds
v_add_f32 v59, v59, v4
v_add_f32 v44, v44, v2
v_add_f32 v60, v60, v4
v_add_f32 v45, v45, v2
v_add_f32 v61, v61, v4
buffer_load_dwordx4 v15, s[8:11], s75 offen offset:3072 lds
v_add_f32 v46, v46, v2
v_add_f32 v62, v62, v4
v_add_f32 v47, v47, v2
v_add_f32 v63, v63, v4
v_add_f32 v48, v48, v2
s_add_u32 m0, s77, 86016
s_nop 0
buffer_load_dwordx4 v16, s[8:11], s75 offen offset:0 lds
v_add_f32 v64, v64, v4
v_add_f32 v49, v49, v2
v_add_f32 v65, v65, v4
v_add_f32 v50, v50, v2
v_add_f32 v66, v66, v4
buffer_load_dwordx4 v17, s[8:11], s75 offen offset:1024 lds
s_add_u32 s75, s75, 393216
s_cmp_eq_u32 s75, 6291456
s_cselect_b32 s75, 0, s75
v_add_f32 v51, v51, v2
v_add_f32 v67, v67, v4
v_mul_f32 v20, v36, v36
v_mul_f32 v28, v52, v52
v_mul_f32 v21, v37, v37
s_add_u32 m0, s76, 122880
s_nop 0
buffer_load_dwordx4 v8, s[4:7], s74 offen offset:0 lds
v_mul_f32 v29, v53, v53
v_fmac_f32 v20, v38, v38
v_fmac_f32 v28, v54, v54
v_fmac_f32 v21, v39, v39
v_fmac_f32 v29, v55, v55
buffer_load_dwordx4 v9, s[4:7], s74 offen offset:1024 lds
v_fmac_f32 v20, v40, v40
s_branch L_over0
L_pad0:
s_branch L_ret4
L_over0:
v_fmac_f32 v28, v56, v56
v_fmac_f32 v21, v41, v41
v_fmac_f32 v29, v57, v57
v_fmac_f32 v20, v42, v42
buffer_load_dwordx4 v10, s[4:7], s74 offen offset:2048 lds
v_fmac_f32 v28, v58, v58
v_fmac_f32 v21, v43, v43
v_fmac_f32 v29, v59, v59
v_fmac_f32 v20, v44, v44
v_fmac_f32 v28, v60, v60
buffer_load_dwordx4 v11, s[4:7], s74 offen offset:3072 lds
s_add_u32 s74, s74, 128
s_and_b32 s74, s74, 2047
v_fmac_f32 v21, v45, v45
v_fmac_f32 v29, v61, v61
s_waitcnt vmcnt(14)
s_barrier
s_add_u32 m0, s77, 40960
s_nop 0
buffer_load_dwordx4 v12, s[8:11], s75 offen offset:0 lds
v_fmac_f32 v20, v46, v46
v_fmac_f32 v28, v62, v62
v_fmac_f32 v21, v47, v47
v_fmac_f32 v29, v63, v63
v_fmac_f32 v20, v48, v48
buffer_load_dwordx4 v13, s[8:11], s75 offen offset:1024 lds
v_fmac_f32 v28, v64, v64
v_fmac_f32 v21, v49, v49
v_fmac_f32 v29, v65, v65
v_fmac_f32 v20, v50, v50
v_fmac_f32 v28, v66, v66
buffer_load_dwordx4 v14, s[8:11], s75 offen offset:2048 lds
v_fmac_f32 v21, v51, v51
v_fmac_f32 v29, v67, v67
v_add_f32 v3, v20, v21
v_add_f32 v5, v28, v29
s_nop 0
v_add_f32_dpp v3, v3, v3 row_ror:1 row_mask:0xf bank_mask:0xf
buffer_load_dwordx4 v15, s[8:11], s75 offen offset:3072 lds
v_add_f32_dpp v5, v5, v5 row_ror:1 row_mask:0xf bank_mask:0xf
v_add_f32_dpp v3, v3, v3 row_ror:2 row_mask:0xf bank_mask:0xf
s_nop 0
v_add_f32_dpp v5, v5, v5 row_ror:2 row_mask:0xf bank_mask:0xf
v_add_f32_dpp v3, v3, v3 row_ror:4 row_mask:0xf bank_mask:0xf
s_nop 0
v_add_f32_dpp v5, v5, v5 row_ror:4 row_mask:0xf bank_mask:0xf
s_add_u32 m0, s77, 45056
s_nop 0
buffer_load_dwordx4 v16, s[8:11], s75 offen offset:0 lds
v_add_f32_dpp v3, v3, v3 row_ror:8 row_mask:0xf bank_mask:0xf
v_add_f32_dpp v5, v5, v5 row_ror:8 row_mask:0xf bank_mask:0xf
v_mov_b32 v6, v3
v_mov_b32 v7, v5
s_nop 0
v_permlane16_swap_b32 v3, v6
buffer_load_dwordx4 v17, s[8:11], s75 offen offset:1024 lds
s_add_u32 s75, s75, 393216
s_cmp_eq_u32 s75, 6291456
s_cselect_b32 s75, 0, s75
v_permlane16_swap_b32 v5, v7
v_add_f32 v3, v3, v6
v_add_f32 v5, v5, v7
v_mov_b32 v6, v3
v_mov_b32 v7, v5
s_add_u32 m0, s76, 106496
s_nop 0
buffer_load_dwordx4 v8, s[4:7], s74 offen offset:0 lds
v_permlane32_swap_b32 v3, v6
v_permlane32_swap_b32 v5, v7
v_add_f32 v3, v3, v6
v_add_f32 v5, v5, v7
v_mov_b32 v6, 0x3727c5ac
buffer_load_dwordx4 v9, s[4:7], s74 offen offset:1024 lds
v_fmac_f32 v6, 0x3a800000, v3
v_rsq_f32 v3, v6
v_mov_b32 v6, 0x3727c5ac
v_fmac_f32 v6, 0x3a800000, v5
v_rsq_f32 v5, v6
buffer_load_dwordx4 v10, s[4:7], s74 offen offset:2048 lds
v_cmp_eq_u32 vcc, 1, v1
s_nop 1
v_cndmask_b32 v20, v2, v4, vcc
v_cndmask_b32 v21, v3, v5, vcc
v_mov_b32 v22, 0
v_mov_b32 v23, s68
buffer_load_dwordx4 v11, s[4:7], s74 offen offset:3072 lds
s_add_u32 s74, s74, 128
s_and_b32 s74, s74, 2047
buffer_load_dwordx4 a[0:3], v76, s[24:27], s85 offen nt
buffer_load_dwordx4 a[32:35], v78, s[28:31], s85 offen nt
s_add_u32 s85, s85, 57344
buffer_load_dwordx4 a[4:7], v76, s[24:27], s85 offen nt
buffer_load_dwordx4 a[36:39], v78, s[28:31], s85 offen nt
s_add_u32 s85, s85, 57344
buffer_load_dwordx4 a[8:11], v76, s[24:27], s85 offen nt
buffer_load_dwordx4 a[40:43], v78, s[28:31], s85 offen nt
s_add_u32 s85, s85, 57344
s_lshl_b32 s70, s87, 4
s_add_u32 s70, s70, 8192
s_mov_b64 exec, 3
buffer_store_dwordx4 v[20:23], v18, s[12:15], s70 offen sc1
s_mov_b64 exec, -1
s_waitcnt vmcnt(21)
s_barrier
s_add_u32 m0, s77, 0
s_nop 0
buffer_load_dwordx4 v12, s[8:11], s75 offen offset:0 lds
v_lshlrev_b32 v2, 16, v88
v_and_b32 v3, 0xffff0000, v88
v_lshlrev_b32_e64 v4, 16, v89
buffer_load_dwordx4 v13, s[8:11], s75 offen offset:1024 lds
v_and_b32 v5, 0xffff0000, v89
v_add_f32 v2, v2, v3
v_add_f32 v4, v4, v5
buffer_load_dwordx4 v14, s[8:11], s75 offen offset:2048 lds
v_add_f32 v2, v2, v4
s_nop 1
v_add_f32_dpp v2, v2, v2 row_ror:1 row_mask:0xf bank_mask:0xf
s_nop 1
v_add_f32_dpp v2, v2, v2 row_ror:2 row_mask:0xf bank_mask:0xf
buffer_load_dwordx4 v15, s[8:11], s75 offen offset:3072 lds
s_nop 0
v_add_f32_dpp v2, v2, v2 row_ror:4 row_mask:0xf bank_mask:0xf
s_nop 1
v_add_f32_dpp v2, v2, v2 row_ror:8 row_mask:0xf bank_mask:0xf
v_mov_b32 v3, v2
s_add_u32 m0, s77, 4096
s_nop 0
buffer_load_dwordx4 v16, s[8:11], s75 offen offset:0 lds
v_permlane16_swap_b32 v2, v3
v_add_f32 v2, v2, v3
v_mov_b32 v3, v2
buffer_load_dwordx4 v17, s[8:11], s75 offen offset:1024 lds
s_add_u32 s75, s75, 393216
s_cmp_eq_u32 s75, 6291456
s_cselect_b32 s75, 0, s75
v_permlane32_swap_b32 v2, v3
v_add_f32 v2, v2, v3
s_lshl_b32 s70, s60, 2
s_add_u32 s70, s70, 162176
v_mov_b32 v3, s70
s_add_u32 m0, s76, 65536
s_nop 0
buffer_load_dwordx4 v8, s[4:7], s74 offen offset:0 lds
ds_write_b32 v3, v2
s_lshl_b32 s70, s60, 2
s_sub_u32 s70, s70, s65
s_lshl_b32 s70, s70, 4
v_add_u32 v4, s70, v1
v_min_u32_e64 v4, 18, v4
buffer_load_dwordx4 v9, s[4:7], s74 offen offset:1024 lds
v_cmp_gt_u32 vcc, 16, v4
s_nop 1
v_cndmask_b32 v4, 18, v4, vcc
v_lshlrev_b32 v4, 3, v4
buffer_load_dwordx4 v10, s[4:7], s74 offen offset:2048 lds
v_add_u32 v4, 162048, v4
ds_write_b64 v4, v[88:89]
buffer_load_dwordx4 v11, s[4:7], s74 offen offset:3072 lds
s_add_u32 s74, s74, 128
s_and_b32 s74, s74, 2047
s_waitcnt vmcnt(21)
s_barrier
s_add_u32 m0, s77, 81920
s_nop 0
buffer_load_dwordx4 v12, s[8:11], s75 offen offset:0 lds
s_getreg_b32 s71, hwreg(HW_REG_XCC_ID, 0, 4)
v_mov_b32 v84, s71
buffer_load_dwordx4 v13, s[8:11], s75 offen offset:1024 lds
v_mov_b32 v85, 0
buffer_load_dwordx4 v14, s[8:11], s75 offen offset:2048 lds
v_mov_b32 v86, 0
buffer_load_dwordx4 v15, s[8:11], s75 offen offset:3072 lds
v_mov_b32 v87, s68
s_add_u32 m0, s77, 86016
s_nop 0
buffer_load_dwordx4 v16, s[8:11], s75 offen offset:0 lds
s_lshl_b32 s70, s79, 4
s_add_u32 s70, s70, 4096
v_mov_b32 v19, s70
buffer_load_dwordx4 v17, s[8:11], s75 offen offset:1024 lds
s_add_u32 s75, s75, 393216
s_cmp_eq_u32 s75, 6291456
s_cselect_b32 s75, 0, s75
s_lshl_b32 s70, s65, 4
s_add_u32 s70, s70, s64
s_lshl_b32 s70, s70, 4
s_add_u32 s70, s70, 40960
v_writelane_b32 v19, s70, 1
s_add_u32 m0, s76, 24576
s_nop 0
buffer_load_dwordx4 v8, s[4:7], s74 offen offset:0 lds
buffer_load_dwordx4 v9, s[4:7], s74 offen offset:1024 lds
buffer_load_dwordx4 v10, s[4:7], s74 offen offset:2048 lds
buffer_load_dwordx4 v11, s[4:7], s74 offen offset:3072 lds
s_add_u32 s74, s74, 128
s_and_b32 s74, s74, 2047
buffer_load_dwordx4 a[12:15], v76, s[24:27], s85 offen nt
buffer_load_dwordx4 a[44:47], v78, s[28:31], s85 offen nt
s_add_u32 s85, s85, 57344
buffer_load_dwordx4 a[16:19], v76, s[24:27], s85 offen nt
buffer_load_dwordx4 a[48:51], v78, s[28:31], s85 offen nt
s_add_u32 s85, s85, 57344
buffer_load_dwordx4 a[20:23], v76, s[24:27], s85 offen nt
buffer_load_dwordx4 a[52:55], v78, s[28:31], s85 offen nt
s_add_u32 s85, s85, 57344
s_mov_b64 exec, 3
buffer_store_dwordx4 v[84:87], v19, s[12:15], 0 offen sc1
s_mov_b64 exec, -1
s_waitcnt vmcnt(21)
s_barrier
s_add_u32 m0, s77, 40960
s_nop 0
buffer_load_dwordx4 v12, s[8:11], s75 offen offset:0 lds
buffer_load_dwordx4 v13, s[8:11], s75 offen offset:1024 lds
buffer_load_dwordx4 v14, s[8:11], s75 offen offset:2048 lds
buffer_load_dwordx4 v15, s[8:11], s75 offen offset:3072 lds
s_add_u32 m0, s77, 45056
s_nop 0
buffer_load_dwordx4 v16, s[8:11], s75 offen offset:0 lds
buffer_load_dwordx4 v17, s[8:11], s75 offen offset:1024 lds
s_add_u32 s75, s75, 393216
s_cmp_eq_u32 s75, 6291456
s_cselect_b32 s75, 0, s75
s_add_u32 m0, s76, 122880
s_nop 0
buffer_load_dwordx4 v8, s[4:7], s74 offen offset:0 lds
buffer_load_dwordx4 v9, s[4:7], s74 offen offset:1024 lds
buffer_load_dwordx4 v10, s[4:7], s74 offen offset:2048 lds
buffer_load_dwordx4 v11, s[4:7], s74 offen offset:3072 lds
s_add_u32 s74, s74, 128
s_and_b32 s74, s74, 2047
s_cmp_eq_u32 s60, 0
s_cbranch_scc1 L_pad5
s_cmp_eq_u32 s60, 1
s_cbranch_scc1 L_ret9
s_cmp_eq_u32 s60, 2
s_cbranch_scc1 L_ret9
s_branch L_ret9
L_ret9:
s_waitcnt vmcnt(21)
s_barrier
s_add_u32 m0, s77, 0
s_nop 0
buffer_load_dwordx4 v12, s[8:11], s75 offen offset:0 lds
buffer_load_dwordx4 v13, s[8:11], s75 offen offset:1024 lds
buffer_load_dwordx4 v14, s[8:11], s75 offen offset:2048 lds
buffer_load_dwordx4 v15, s[8:11], s75 offen offset:3072 lds
s_add_u32 m0, s77, 4096
s_nop 0
buffer_load_dwordx4 v16, s[8:11], s75 offen offset:0 lds
buffer_load_dwordx4 v17, s[8:11], s75 offen offset:1024 lds
s_add_u32 s75, s75, 393216
s_cmp_eq_u32 s75, 6291456
s_cselect_b32 s75, 0, s75
s_add_u32 m0, s76, 106496
s_nop 0
buffer_load_dwordx4 v8, s[4:7], s74 offen offset:0 lds
buffer_load_dwordx4 v9, s[4:7], s74 offen offset:1024 lds
buffer_load_dwordx4 v10, s[4:7], s74 offen offset:2048 lds
buffer_load_dwordx4 v11, s[4:7], s74 offen offset:3072 lds
s_add_u32 s74, s74, 128
s_and_b32 s74, s74, 2047
buffer_load_dwordx4 a[24:27], v76, s[24:27], s85 offen nt
buffer_load_dwordx4 a[56:59], v78, s[28:31], s85 offen nt
s_add_u32 s85, s85, 57344
buffer_load_dwordx4 a[28:31], v76, s[24:27], s85 offen nt
buffer_load_dwordx4 a[60:63], v78, s[28:31], s85 offen nt
s_add_u32 s85, s85, 57344
buffer_load_dwordx4 a[64:67], v77, s[32:35], s86 offen nt
s_add_u32 s86, s86, 16384
buffer_load_dwordx4 a[68:71], v77, s[32:35], s86 offen nt
s_add_u32 s86, s86, 16384
s_waitcnt vmcnt(20)
s_barrier
s_add_u32 m0, s77, 81920
s_nop 0
buffer_load_dwordx4 v12, s[8:11], s75 offen offset:0 lds
v_lshrrev_b32 v2, 4, v1
v_and_b32 v3, 15, v1
v_lshlrev_b32 v44, 10, v2
buffer_load_dwordx4 v13, s[8:11], s75 offen offset:1024 lds
v_lshl_add_u32 v44, v3, 4, v44
s_lshl_b32 s70, s60, 8
v_add_u32 v44, s70, v44
s_lshl_b32 s87, s64, 14
s_add_u32 s87, s87, 65536
buffer_load_dwordx4 v14, s[8:11], s75 offen offset:2048 lds
v_and_b32 v45, 31, v1
v_lshlrev_b32 v45, 4, v45
s_lshl_b32 s88, s65, 11
s_lshl_b32 s70, s60, 9
s_add_u32 s88, s88, s70
s_add_u32 s88, s88, 8192
buffer_load_dwordx4 v15, s[8:11], s75 offen offset:3072 lds
s_lshl_b32 s70, s64, 8
s_add_u32 s70, s70, 4096
v_lshlrev_b32 v4, 4, v3
v_add_u32 v4, s70, v4
v_add_u32 v5, 36864, v4
v_lshrrev_b32 v6, 5, v1
s_add_u32 m0, s77, 86016
s_nop 0
buffer_load_dwordx4 v16, s[8:11], s75 offen offset:0 lds
v_lshlrev_b32 v6, 11, v6
v_xor_b32 v5, v5, v6
v_lshrrev_b32 v6, 5, v1
buffer_load_dwordx4 v17, s[8:11], s75 offen offset:1024 lds
s_add_u32 s75, s75, 393216
s_cmp_eq_u32 s75, 6291456
s_cselect_b32 s75, 0, s75
v_lshlrev_b32 v6, 8, v6
v_xor_b32 v4, v4, v6
v_and_b32 v6, 1, v2
s_add_u32 m0, s76, 65536
s_nop 0
buffer_load_dwordx4 v8, s[4:7], s74 offen offset:0 lds
v_cmp_eq_u32 vcc, 1, v6
s_nop 1
v_cndmask_b32 v46, v4, v5, vcc
v_lshlrev_b32_e64 v48, 2, v1
buffer_load_dwordx4 v9, s[4:7], s74 offen offset:1024 lds
v_add_u32 v48, 7225600, v48
buffer_load_dwordx4 v10, s[4:7], s74 offen offset:2048 lds
buffer_load_dwordx4 v11, s[4:7], s74 offen offset:3072 lds
s_add_u32 s74, s74, 128
s_and_b32 s74, s74, 2047
s_add_u32 s70, s87, 0
buffer_load_dwordx4 v[20:23], v44, s[12:15], s70 offen sc1
buffer_load_dwordx4 v[36:39], v45, s[12:15], s88 offen sc1
buffer_load_dwordx4 v[40:43], v46, s[12:15], 0 offen offset:0 sc1
buffer_load_dword v47, v48, s[12:15], 0 offen sc1
s_waitcnt vmcnt(24)
s_barrier
s_add_u32 m0, s77, 40960
s_nop 0
buffer_load_dwordx4 v12, s[8:11], s75 offen offset:0 lds
s_mul_i32 s70, s62, 5
s_add_u32 s70, s70, s65
s_mul_i32 s71, s70, 86
s_lshr_b32 s71, s71, 10
s_mul_i32 s71, s71, 12
s_sub_u32 s70, s70, s71
s_lshl_b32 s70, s70, 2
s_mov_b32 s0, 0x98765410
s_mov_b32 s1, 0xfedc
s_sub_u32 s71, 48, s70
s_lshl_b64 s[72:73], s[0:1], s71
s_lshr_b64 s[0:1], s[0:1], s70
s_or_b64 s[0:1], s[0:1], s[72:73]
s_lshl_b64 s[0:1], s[0:1], 16
s_or_b32 s0, s0, 0x2ab3
buffer_load_dwordx4 v13, s[8:11], s75 offen offset:1024 lds
buffer_load_dwordx4 v14, s[8:11], s75 offen offset:2048 lds
buffer_load_dwordx4 v15, s[8:11], s75 offen offset:3072 lds
s_add_u32 m0, s77, 45056
s_nop 0
buffer_load_dwordx4 v16, s[8:11], s75 offen offset:0 lds
buffer_load_dwordx4 v17, s[8:11], s75 offen offset:1024 lds
s_add_u32 s75, s75, 393216
s_cmp_eq_u32 s75, 6291456
s_cselect_b32 s75, 0, s75
s_add_u32 m0, s76, 24576
s_nop 0
buffer_load_dwordx4 v8, s[4:7], s74 offen offset:0 lds
buffer_load_dwordx4 v9, s[4:7], s74 offen offset:1024 lds
buffer_load_dwordx4 v10, s[4:7], s74 offen offset:2048 lds
buffer_load_dwordx4 v11, s[4:7], s74 offen offset:3072 lds
s_add_u32 s74, s74, 128
s_and_b32 s74, s74, 2047
buffer_load_dwordx4 a[72:75], v77, s[32:35], s86 offen nt
s_add_u32 s86, s86, 16384
buffer_load_dwordx4 a[76:79], v77, s[32:35], s86 offen nt
s_add_u32 s86, s86, 16384
buffer_load_dwordx4 a[80:83], v77, s[32:35], s86 offen nt
s_add_u32 s86, s86, 16384
s_waitcnt vmcnt(21)
s_barrier
s_add_u32 m0, s77, 0
s_nop 0
buffer_load_dwordx4 v12, s[8:11], s75 offen offset:0 lds
s_waitcnt vmcnt(14) lgkmcnt(0)
L_eg_chk:
v_xor_b32 v2, s68, v23
v_xor_b32 v3, s68, v39
v_xor_b32 v4, s68, v43
v_or3_b32 v2, v2, v3, v4
s_lshl_b32 s70, s68, 2
v_xor_b32 v3, s70, v47
v_lshrrev_b32 v3, 2, v3
v_or_b32 v2, v2, v3
v_cmp_ne_u32 vcc, 0, v2
s_cbranch_vccnz L_eg_rt
L_eg_ok:

v_mov_b32 v24, v20
v_mov_b32 v25, v21
buffer_load_dwordx4 v13, s[8:11], s75 offen offset:1024 lds
v_mov_b32_e64 v26, v22
v_permlane16_swap_b32 v20, v24
v_permlane16_swap_b32 v21, v25
buffer_load_dwordx4 v14, s[8:11], s75 offen offset:2048 lds
v_permlane16_swap_b32 v22, v26
v_add_f32 v20, v20, v24
v_add_f32 v21, v21, v25
buffer_load_dwordx4 v15, s[8:11], s75 offen offset:3072 lds
v_add_f32 v22, v22, v26
v_mov_b32 v24, v20
v_mov_b32 v25, v21
s_add_u32 m0, s77, 4096
s_nop 0
buffer_load_dwordx4 v16, s[8:11], s75 offen offset:0 lds
v_mov_b32 v26, v22
v_permlane32_swap_b32 v20, v24
v_permlane32_swap_b32 v21, v25
buffer_load_dwordx4 v17, s[8:11], s75 offen offset:1024 lds
s_add_u32 s75, s75, 393216
s_cmp_eq_u32 s75, 6291456
s_cselect_b32 s75, 0, s75
v_permlane32_swap_b32 v22, v26
v_add_f32 v20, v20, v24
v_add_f32 v21, v21, v25
s_cmp_gt_u32 s65, 3
s_subb_u32 s70, s65, 0
s_cmp_gt_u32 s65, 11
s_subb_u32 s70, s70, 0
s_mov_b32 s71, 22181
s_bitcmp1_b32 s71, s64
s_cselect_b32 s71, 14, 0
s_cselect_b32 s72, 0, 0xf700
s_or_b32 s72, s72, 0xf7
s_add_u32 s70, s70, s71
s_lshl2_add_u32 s70, s70, s60
s_mul_i32 s70, s70, 25600
v_lshlrev_b32 v19, 10, v1
s_bitcmp1_b32 s72, s65
s_cselect_b32 exec_lo, 33554431, 0
s_mov_b32 exec_hi, 0
buffer_load_dword v81, v19, s[16:19], s70 offen offset:384
s_mov_b64 exec, -1
buffer_load_dwordx4 a[84:87], v77, s[32:35], s86 offen nt
s_add_u32 s86, s86, 16384
buffer_load_dwordx4 a[88:91], v77, s[32:35], s86 offen nt
s_add_u32 s86, s86, 16384
buffer_load_dwordx4 a[92:95], v77, s[32:35], s86 offen nt
s_add_u32 s86, s86, 16384
s_waitcnt vmcnt(17)
s_barrier
s_mul_i32 s95, s60, 2
s_add_u32 s95, s95, 120
s_lshl_b32 s70, s95, 10
s_add_u32 m0, s70, 28672
s_lshr_b32 s70, s95, 3
s_lshl_b32 s70, s70, 2
s_lshr_b64 s[82:83], s[0:1], s70
s_and_b32 s82, s82, 15
s_and_b32 s70, s95, 7
s_lshl3_add_u32 s82, s82, s70
s_lshl_b32 s82, s82, 14
buffer_load_dwordx4 v80, s[16:19], s82 offen lds
v_add_f32 v22, v22, v26
v_and_b32 v3, 15, v1
v_lshlrev_b32 v3, 2, v3
s_lshl_b32 s70, s60, 6
s_add_u32 s70, s70, 160768
v_add_u32 v3, s70, v3
ds_write_b32 v3, v20 offset:0
ds_write_b32 v3, v21 offset:256
ds_write_b32 v3, v22 offset:512
v_lshrrev_b32 v4, 2, v45
s_lshl_b32 s70, s60, 7
s_add_u32 s70, s70, 159744
v_add_u32_e64 v4, s70, v4
ds_write_b32 v4, v36
ds_write_b32 v4, v37 offset:512
s_getreg_b32 s71, hwreg(HW_REG_XCC_ID, 0, 4)
v_cmp_ne_u32 vcc, s71, v40
s_nop 0
s_or_b32 s70, vcc_lo, vcc_hi
s_and_b32 s70, s70, 0xffff
s_cselect_b32 s69, 0, 1
v_and_b32 v5, 3, v47
v_cmp_eq_u32 vcc, 1, v5
s_nop 0
s_bcnt1_i32_b64 s70, vcc
v_cmp_eq_u32 vcc, 2, v5
s_nop 0
s_bcnt1_i32_b64 s71, vcc
s_cmp_gt_u32 s71, s70
s_cselect_b32 s61, 8192, 0
s_or_b32 s70, s69, s61
v_mov_b32 v5, s70
v_mov_b32 v6, 161536
ds_write_b32 v6, v5
s_mov_b32 exec_lo, 0
s_mov_b32 exec_hi, 0xff
v_xor_b32 v83, s61, v83
s_mov_b64 exec, -1
v_and_b32 v3, 15, v1
v_lshrrev_b32 v2, 4, v1
v_and_b32 v4, 1, v1
v_lshlrev_b32 v4, 4, v4
v_mov_b32 v5, 0x3f80
s_add_u32 m0, m0, 1024
s_add_u32 s95, s95, 1
s_lshr_b32 s70, s95, 3
s_lshl_b32 s70, s70, 2
s_lshr_b64 s[82:83], s[0:1], s70
s_and_b32 s82, s82, 15
s_and_b32 s70, s95, 7
s_lshl3_add_u32 s82, s82, s70
s_lshl_b32 s82, s82, 14
buffer_load_dwordx4 v80, s[16:19], s82 offen lds
v_lshlrev_b32 v4, v4, v5
v_lshrrev_b32 v5, 1, v3
v_cmp_eq_u32 vcc, 0, v5
s_nop 1
v_cndmask_b32 v56, 0, v4, vcc
v_cmp_eq_u32 vcc, 1, v5
s_nop 1
v_cndmask_b32 v57, 0, v4, vcc
v_cmp_eq_u32 vcc, 2, v5
s_nop 1
v_cndmask_b32 v58, 0, v4, vcc
v_cmp_eq_u32 vcc, 3, v5
s_nop 1
v_cndmask_b32 v59, 0, v4, vcc
v_mul_u32_u24 v55, 4352, v3
v_lshl_add_u32 v55, v2, 5, v55
v_and_b32 v4, 12, v1
v_add_u32 v4, v4, v2
v_mul_u32_u24 v54, 4352, v4
v_and_b32 v4, 3, v1
v_lshl_add_u32 v54, v4, 4, v54
v_lshlrev_b32 v53, 4, v4
v_lshl_add_u32 v53, v2, 3, v53
s_mul_i32 s87, s64, 69632
s_add_u32 s87, s87, 524288
s_lshl_b32 s70, s66, 7
s_lshl_b32 s71, s67, 4
s_add_u32 s88, s70, s71
s_add_u32 s88, s88, s87
s_add_u32 s88, s88, 4096
s_lshl2_add_u32 s70, s65, s60
s_lshl_b32 s70, s70, 6
s_add_u32 s87, s87, s70
s_lshl4_add_u32 s70, s64, s65
s_lshl2_add_u32 s70, s70, s60
s_lshl_b32 s70, s70, 6
s_add_u32 s70, s70, 1638400
s_mov_b32 s94, s70
s_lshl_b32 s70, s66, 6
s_lshl_b32 s71, s67, 3
s_add_u32 s70, s70, s71
s_add_u32 s70, s70, 161600
v_lshlrev_b32 v60, 4, v2
v_add_u32 v60, s70, v60
s_mov_b32 s92, 0x000f000f
s_mov_b32 s93, 0
s_sub_i32 s70, s64, s65
s_lshl_b32 s70, s70, 18
v_add_u32 v8, s70, v8
v_add_u32 v9, s70, v9
v_add_u32 v10, s70, v10
v_add_u32 v11, s70, v11
s_waitcnt vmcnt(6)
s_barrier
s_mul_i32 s95, s60, 10
s_add_u32 s95, s95, 12
s_lshl_b32 s70, s95, 10
s_add_u32 m0, s70, 28672
s_lshr_b32 s70, s95, 3
s_lshl_b32 s70, s70, 2
s_lshr_b64 s[82:83], s[0:1], s70
s_and_b32 s82, s82, 15
s_and_b32 s70, s95, 7
s_lshl3_add_u32 s82, s82, s70
s_lshl_b32 s82, s82, 14
buffer_load_dwordx4 v80, s[16:19], s82 offen lds
s_add_u32 m0, m0, 1024
s_add_u32 s95, s95, 1
s_lshr_b32 s70, s95, 3
s_lshl_b32 s70, s70, 2
s_lshr_b64 s[82:83], s[0:1], s70
s_and_b32 s82, s82, 15
s_and_b32 s70, s95, 7
s_lshl3_add_u32 s82, s82, s70
s_lshl_b32 s82, s82, 14
buffer_load_dwordx4 v80, s[16:19], s82 offen lds
s_add_u32 m0, m0, 1024
s_add_u32 s95, s95, 1
s_lshr_b32 s70, s95, 3
s_lshl_b32 s70, s70, 2
s_lshr_b64 s[82:83], s[0:1], s70
s_and_b32 s82, s82, 15
s_and_b32 s70, s95, 7
s_lshl3_add_u32 s82, s82, s70
s_lshl_b32 s82, s82, 14
buffer_load_dwordx4 v80, s[16:19], s82 offen lds
s_add_u32 m0, m0, 1024
s_add_u32 s95, s95, 1
s_lshr_b32 s70, s95, 3
s_lshl_b32 s70, s70, 2
s_lshr_b64 s[82:83], s[0:1], s70
s_and_b32 s82, s82, 15
s_and_b32 s70, s95, 7
s_lshl3_add_u32 s82, s82, s70
s_lshl_b32 s82, s82, 14
buffer_load_dwordx4 v80, s[16:19], s82 offen lds
s_add_u32 m0, m0, 1024
s_add_u32 s95, s95, 1
s_lshr_b32 s70, s95, 3
s_lshl_b32 s70, s70, 2
s_lshr_b64 s[82:83], s[0:1], s70
s_and_b32 s82, s82, 15
s_and_b32 s70, s95, 7
s_lshl3_add_u32 s82, s82, s70
s_lshl_b32 s82, s82, 14
buffer_load_dwordx4 v80, s[16:19], s82 offen lds
s_add_u32 m0, m0, 1024
s_add_u32 s95, s95, 1
s_lshr_b32 s70, s95, 3
s_lshl_b32 s70, s70, 2
s_lshr_b64 s[82:83], s[0:1], s70
s_and_b32 s82, s82, 15
s_and_b32 s70, s95, 7
s_lshl3_add_u32 s82, s82, s70
s_lshl_b32 s82, s82, 14
buffer_load_dwordx4 v80, s[16:19], s82 offen lds
s_add_u32 m0, m0, 1024
s_add_u32 s95, s95, 1
s_lshr_b32 s70, s95, 3
s_lshl_b32 s70, s70, 2
s_lshr_b64 s[82:83], s[0:1], s70
s_and_b32 s82, s82, 15
s_and_b32 s70, s95, 7
s_lshl3_add_u32 s82, s82, s70
s_lshl_b32 s82, s82, 14
buffer_load_dwordx4 v80, s[16:19], s82 offen lds
s_add_u32 m0, m0, 1024
s_add_u32 s95, s95, 1
s_lshr_b32 s70, s95, 3
s_lshl_b32 s70, s70, 2
s_lshr_b64 s[82:83], s[0:1], s70
s_and_b32 s82, s82, 15
s_and_b32 s70, s95, 7
s_lshl3_add_u32 s82, s82, s70
s_lshl_b32 s82, s82, 14
buffer_load_dwordx4 v80, s[16:19], s82 offen lds
s_add_u32 m0, m0, 1024
s_add_u32 s95, s95, 1
s_lshr_b32 s70, s95, 3
s_lshl_b32 s70, s70, 2
s_lshr_b64 s[82:83], s[0:1], s70
s_and_b32 s82, s82, 15
s_and_b32 s70, s95, 7
s_lshl3_add_u32 s82, s82, s70
s_lshl_b32 s82, s82, 14
buffer_load_dwordx4 v80, s[16:19], s82 offen lds
s_add_u32 m0, m0, 1024
s_add_u32 s95, s95, 1
s_lshr_b32 s70, s95, 3
s_lshl_b32 s70, s70, 2
s_lshr_b64 s[82:83], s[0:1], s70
s_and_b32 s82, s82, 15
s_and_b32 s70, s95, 7
s_lshl3_add_u32 s82, s82, s70
s_lshl_b32 s82, s82, 14
buffer_load_dwordx4 v80, s[16:19], s82 offen lds
s_setprio 0
s_waitcnt lgkmcnt(0)
s_barrier
s_mov_b32 exec_lo, 0x0
s_mov_b32 exec_hi, 0x3f00000f
buffer_load_dword v81, v83, s[12:15], 0 offen
s_mov_b64 exec, -1
s_mul_i32 s95, s60, 3
s_add_u32 s95, s95, 0
s_lshl_b32 s70, s95, 10
s_add_u32 m0, s70, 28672
s_lshr_b32 s70, s95, 3
s_lshl_b32 s70, s70, 2
s_lshr_b64 s[82:83], s[0:1], s70
s_and_b32 s82, s82, 15
s_and_b32 s70, s95, 7
s_lshl3_add_u32 s82, s82, s70
s_lshl_b32 s82, s82, 14
buffer_load_dwordx4 v80, s[16:19], s82 offen lds
s_add_u32 m0, m0, 1024
s_add_u32 s95, s95, 1
s_lshr_b32 s70, s95, 3
s_lshl_b32 s70, s70, 2
s_lshr_b64 s[82:83], s[0:1], s70
s_and_b32 s82, s82, 15
s_and_b32 s70, s95, 7
s_lshl3_add_u32 s82, s82, s70
s_lshl_b32 s82, s82, 14
buffer_load_dwordx4 v80, s[16:19], s82 offen lds
s_add_u32 m0, m0, 1024
s_add_u32 s95, s95, 1
s_lshr_b32 s70, s95, 3
s_lshl_b32 s70, s70, 2
s_lshr_b64 s[82:83], s[0:1], s70
s_and_b32 s82, s82, 15
s_and_b32 s70, s95, 7
s_lshl3_add_u32 s82, s82, s70
s_lshl_b32 s82, s82, 14
buffer_load_dwordx4 v80, s[16:19], s82 offen lds
s_mul_i32 s95, s60, 7
s_add_u32 s95, s95, 52
s_lshl_b32 s70, s95, 10
s_add_u32 m0, s70, 28672
s_lshr_b32 s70, s95, 3
s_lshl_b32 s70, s70, 2
s_lshr_b64 s[82:83], s[0:1], s70
s_and_b32 s82, s82, 15
s_and_b32 s70, s95, 7
s_lshl3_add_u32 s82, s82, s70
s_lshl_b32 s82, s82, 14
buffer_load_dwordx4 v80, s[16:19], s82 offen lds
s_add_u32 m0, m0, 1024
s_add_u32 s95, s95, 1
s_lshr_b32 s70, s95, 3
s_lshl_b32 s70, s70, 2
s_lshr_b64 s[82:83], s[0:1], s70
s_and_b32 s82, s82, 15
s_and_b32 s70, s95, 7
s_lshl3_add_u32 s82, s82, s70
s_lshl_b32 s82, s82, 14
buffer_load_dwordx4 v80, s[16:19], s82 offen lds
s_add_u32 m0, m0, 1024
s_add_u32 s95, s95, 1
s_lshr_b32 s70, s95, 3
s_lshl_b32 s70, s70, 2
s_lshr_b64 s[82:83], s[0:1], s70
s_and_b32 s82, s82, 15
s_and_b32 s70, s95, 7
s_lshl3_add_u32 s82, s82, s70
s_lshl_b32 s82, s82, 14
buffer_load_dwordx4 v80, s[16:19], s82 offen lds
s_branch L_over1
L_pad1:
s_branch L_pad15
L_over1:
s_add_u32 m0, m0, 1024
s_add_u32 s95, s95, 1
s_lshr_b32 s70, s95, 3
s_lshl_b32 s70, s70, 2
s_lshr_b64 s[82:83], s[0:1], s70
s_and_b32 s82, s82, 15
s_and_b32 s70, s95, 7
s_lshl3_add_u32 s82, s82, s70
s_lshl_b32 s82, s82, 14
buffer_load_dwordx4 v80, s[16:19], s82 offen lds
s_add_u32 m0, m0, 1024
s_add_u32 s95, s95, 1
s_lshr_b32 s70, s95, 3
s_lshl_b32 s70, s70, 2
s_lshr_b64 s[82:83], s[0:1], s70
s_and_b32 s82, s82, 15
s_and_b32 s70, s95, 7
s_lshl3_add_u32 s82, s82, s70
s_lshl_b32 s82, s82, 14
buffer_load_dwordx4 v80, s[16:19], s82 offen lds
s_add_u32 m0, m0, 1024
s_add_u32 s95, s95, 1
s_lshr_b32 s70, s95, 3
s_lshl_b32 s70, s70, 2
s_lshr_b64 s[82:83], s[0:1], s70
s_and_b32 s82, s82, 15
s_and_b32 s70, s95, 7
s_lshl3_add_u32 s82, s82, s70
s_lshl_b32 s82, s82, 14
buffer_load_dwordx4 v80, s[16:19], s82 offen lds
s_add_u32 m0, m0, 1024
s_add_u32 s95, s95, 1
s_lshr_b32 s70, s95, 3
s_lshl_b32 s70, s70, 2
s_lshr_b64 s[82:83], s[0:1], s70
s_and_b32 s82, s82, 15
s_and_b32 s70, s95, 7
s_lshl3_add_u32 s82, s82, s70
s_lshl_b32 s82, s82, 14
buffer_load_dwordx4 v80, s[16:19], s82 offen lds
s_mov_b32 s73, 3
s_cmp_eq_u32 s60, 0
s_cbranch_scc1 L_pad1
s_cmp_eq_u32 s60, 1
s_cbranch_scc1 L_pad6
s_cmp_eq_u32 s60, 2
s_cbranch_scc1 L_pad9
s_branch L_pad14
L_retF:
s_barrier
s_barrier
s_setprio 2
s_mul_i32 s95, s60, 4
s_add_u32 s95, s95, 80
s_lshl_b32 s70, s95, 10
s_add_u32 m0, s70, 28672
s_lshr_b32 s70, s95, 3
s_lshl_b32 s70, s70, 2
s_lshr_b64 s[82:83], s[0:1], s70
s_and_b32 s82, s82, 15
s_and_b32 s70, s95, 7
s_lshl3_add_u32 s82, s82, s70
s_lshl_b32 s82, s82, 14
buffer_load_dwordx4 v80, s[16:19], s82 offen lds
s_add_u32 m0, m0, 1024
s_add_u32 s95, s95, 1
s_lshr_b32 s70, s95, 3
s_lshl_b32 s70, s70, 2
s_lshr_b64 s[82:83], s[0:1], s70
s_and_b32 s82, s82, 15
s_and_b32 s70, s95, 7
s_lshl3_add_u32 s82, s82, s70
s_lshl_b32 s82, s82, 14
buffer_load_dwordx4 v80, s[16:19], s82 offen lds
s_add_u32 m0, m0, 1024
s_add_u32 s95, s95, 1
s_lshr_b32 s70, s95, 3
s_lshl_b32 s70, s70, 2
s_lshr_b64 s[82:83], s[0:1], s70
s_and_b32 s82, s82, 15
s_and_b32 s70, s95, 7
s_lshl3_add_u32 s82, s82, s70
s_lshl_b32 s82, s82, 14
buffer_load_dwordx4 v80, s[16:19], s82 offen lds
s_add_u32 m0, m0, 1024
s_add_u32 s95, s95, 1
s_lshr_b32 s70, s95, 3
s_lshl_b32 s70, s70, 2
s_lshr_b64 s[82:83], s[0:1], s70
s_and_b32 s82, s82, 15
s_and_b32 s70, s95, 7
s_lshl3_add_u32 s82, s82, s70
s_lshl_b32 s82, s82, 14
buffer_load_dwordx4 v80, s[16:19], s82 offen lds
s_lshl_b32 s70, s65, 7
s_mov_b32 m0, s76
s_nop 0
buffer_load_dwordx4 v8, s[4:7], s70 offen offset:0 lds
buffer_load_dwordx4 v9, s[4:7], s70 offen offset:1024 lds
buffer_load_dwordx4 v10, s[4:7], s70 offen offset:2048 lds
buffer_load_dwordx4 v11, s[4:7], s70 offen offset:3072 lds
buffer_load_dwordx4 v[84:87], v54, s[12:15], s87 offen sc1
buffer_load_dwordx4 v[148:151], v55, s[12:15], s88 offen sc1
s_mul_i32 s95, s60, 6
s_add_u32 s95, s95, 96
s_lshl_b32 s70, s95, 10
s_add_u32 m0, s70, 28672
s_lshr_b32 s70, s95, 3
s_lshl_b32 s70, s70, 2
s_lshr_b64 s[82:83], s[0:1], s70
s_and_b32 s82, s82, 15
s_and_b32 s70, s95, 7
s_lshl3_add_u32 s82, s82, s70
s_lshl_b32 s82, s82, 14
buffer_load_dwordx4 v80, s[16:19], s82 offen lds
s_add_u32 m0, m0, 1024
s_add_u32 s95, s95, 1
s_lshr_b32 s70, s95, 3
s_lshl_b32 s70, s70, 2
s_lshr_b64 s[82:83], s[0:1], s70
s_and_b32 s82, s82, 15
s_and_b32 s70, s95, 7
s_lshl3_add_u32 s82, s82, s70
s_lshl_b32 s82, s82, 14
buffer_load_dwordx4 v80, s[16:19], s82 offen lds
s_add_u32 m0, m0, 1024
s_add_u32 s95, s95, 1
s_lshr_b32 s70, s95, 3
s_lshl_b32 s70, s70, 2
s_lshr_b64 s[82:83], s[0:1], s70
s_and_b32 s82, s82, 15
s_and_b32 s70, s95, 7
s_lshl3_add_u32 s82, s82, s70
s_lshl_b32 s82, s82, 14
buffer_load_dwordx4 v80, s[16:19], s82 offen lds
s_add_u32 m0, m0, 1024
s_add_u32 s95, s95, 1
s_lshr_b32 s70, s95, 3
s_lshl_b32 s70, s70, 2
s_lshr_b64 s[82:83], s[0:1], s70
s_and_b32 s82, s82, 15
s_and_b32 s70, s95, 7
s_lshl3_add_u32 s82, s82, s70
s_lshl_b32 s82, s82, 14
buffer_load_dwordx4 v80, s[16:19], s82 offen lds
s_add_u32 m0, m0, 1024
s_add_u32 s95, s95, 1
s_lshr_b32 s70, s95, 3
s_lshl_b32 s70, s70, 2
s_lshr_b64 s[82:83], s[0:1], s70
s_and_b32 s82, s82, 15
s_and_b32 s70, s95, 7
s_lshl3_add_u32 s82, s82, s70
s_lshl_b32 s82, s82, 14
buffer_load_dwordx4 v80, s[16:19], s82 offen lds
s_add_u32 m0, m0, 1024
s_add_u32 s95, s95, 1
s_lshr_b32 s70, s95, 3
s_lshl_b32 s70, s70, 2
s_lshr_b64 s[82:83], s[0:1], s70
s_and_b32 s82, s82, 15
s_and_b32 s70, s95, 7
s_lshl3_add_u32 s82, s82, s70
s_lshl_b32 s82, s82, 14
buffer_load_dwordx4 v80, s[16:19], s82 offen lds
L_kvr:
s_bitcmp1_b32 s73, 0
s_cbranch_scc0 L_kvs0
s_waitcnt vmcnt(6)
v_cmp_eq_u32_e64 vcc, -1, v84
s_cbranch_vccnz L_kvs0
s_bitset0_b32 s73, 0
v_mfma_f32_16x16x32_bf16 v[20:23], v[56:59], v[84:87], 0
s_nop 7
v_add_f32_dpp v20, v20, v20 row_ror:4 row_mask:0xf bank_mask:0xf
v_add_f32_dpp v21, v21, v21 row_ror:4 row_mask:0xf bank_mask:0xf
v_add_f32_dpp v22, v22, v22 row_ror:4 row_mask:0xf bank_mask:0xf
v_add_f32_dpp v23, v23, v23 row_ror:4 row_mask:0xf bank_mask:0xf
v_add_f32_dpp v20, v20, v20 row_ror:8 row_mask:0xf bank_mask:0xf
v_add_f32_dpp v21, v21, v21 row_ror:8 row_mask:0xf bank_mask:0xf
v_add_f32_dpp v22, v22, v22 row_ror:8 row_mask:0xf bank_mask:0xf
v_add_f32_dpp v23, v23, v23 row_ror:8 row_mask:0xf bank_mask:0xf
v_cvt_pk_bf16_f32 v20, v20, v21
v_cvt_pk_bf16_f32 v21, v22, v23
s_mov_b64 exec, s[92:93]
s_cmp_eq_u32 s69, 0
s_cbranch_scc1 L_kv2_s
buffer_store_dwordx2 v[20:21], v53, s[12:15], s94 offen
L_kv2_d:
s_mov_b64 exec, -1
L_kvs0:
s_bitcmp1_b32 s73, 1
s_cbranch_scc0 L_kvs1
v_xor_b32 v148, s84, v148
v_xor_b32 v149, s84, v149
v_xor_b32 v150, s84, v150
v_xor_b32 v151, s84, v151
v_or3_b32 v2, v148, v149, v150
v_bitop3_b32 v2, v2, v151, s91 bitop3:0xa8
v_cmp_ne_u32_e64 vcc, 0, v2
s_cbranch_vccnz L_kvs1
s_bitset0_b32 s73, 1
v_add_f32_dpp v148, v148, v148 row_ror:1 row_mask:0xf bank_mask:0xf
v_add_f32_dpp v149, v149, v149 row_ror:1 row_mask:0xf bank_mask:0xf
v_add_f32_dpp v150, v150, v150 row_ror:1 row_mask:0xf bank_mask:0xf
v_add_f32_dpp v151, v151, v151 row_ror:1 row_mask:0xf bank_mask:0xf
v_add_f32_dpp v148, v148, v148 row_ror:2 row_mask:0xf bank_mask:0xf
v_add_f32_dpp v149, v149, v149 row_ror:2 row_mask:0xf bank_mask:0xf
v_add_f32_dpp v150, v150, v150 row_ror:2 row_mask:0xf bank_mask:0xf
v_add_f32_dpp v151, v151, v151 row_ror:2 row_mask:0xf bank_mask:0xf
v_add_f32_dpp v148, v148, v148 row_ror:4 row_mask:0xf bank_mask:0xf
v_add_f32_dpp v149, v149, v149 row_ror:4 row_mask:0xf bank_mask:0xf
v_add_f32_dpp v150, v150, v150 row_ror:4 row_mask:0xf bank_mask:0xf
v_add_f32_dpp v151, v151, v151 row_ror:4 row_mask:0xf bank_mask:0xf
v_add_f32_dpp v148, v148, v148 row_ror:8 row_mask:0xf bank_mask:0xf
v_add_f32_dpp v149, v149, v149 row_ror:8 row_mask:0xf bank_mask:0xf
v_add_f32_dpp v150, v150, v150 row_ror:8 row_mask:0xf bank_mask:0xf
v_add_f32_dpp v151, v151, v151 row_ror:8 row_mask:0xf bank_mask:0xf
v_cvt_pk_bf16_f32 v148, v148, v149
v_cvt_pk_bf16_f32 v149, v150, v151
ds_write_b64 v60, v[148:149]
L_kvs1:
s_cmp_lg_u32 s73, 0
s_cbranch_scc1 L_kvrt
L_kvok:
s_setprio 0
s_waitcnt lgkmcnt(0)
s_barrier
s_waitcnt vmcnt(0)
s_barrier
s_not_b32 s70, s68
v_mov_b32 v81, -1
v_writelane_b32 v81, s70, 62
v_writelane_b32 v81, s70, 63
s_mov_b32 exec_lo, 0
s_cmp_eq_u32 s69, 0
s_cselect_b32 exec_hi, 0, 0x3f000000
buffer_store_dword v81, v83, s[12:15], 0 offen offset:4
s_mov_b64 exec, -1
s_cmp_eq_u32 s60, 0
s_cbranch_scc1 L_pad2
s_cmp_eq_u32 s60, 1
s_cbranch_scc1 L_pad7
s_cmp_eq_u32 s60, 2
s_cbranch_scc1 L_pad8
s_branch L_pad10
L_retG:
v_lshrrev_b32 v2, 5, v1
v_lshlrev_b32 v2, 11, v2
v_bfe_u32 v3, v1, 3, 2
v_lshl_add_u32 v2, v3, 7, v2
v_bfe_u32 v3, v1, 4, 1
v_bfe_u32 v4, v1, 1, 2
v_xor_b32 v3, v3, v4
v_lshl_add_u32 v2, v3, 5, v2
v_and_b32 v3, 1, v1
v_lshl_add_u32 v2, v3, 4, v2
s_lshl_b32 s70, s60, 13
s_add_u32 s71, s70, 65536
v_add_u32 v100, s71, v2
v_xor_b32 v101, 64, v100
v_lshrrev_b32 v2, 2, v1
v_bfe_u32 v5, v1, 3, 2
v_xor_b32 v6, s60, v5
v_lshlrev_b32 v6, 5, v6
v_lshl_add_u32 v6, v2, 7, v6
v_and_b32_e64 v7, 3, v1
v_lshl_add_u32 v6, v7, 3, v6
v_add_u32 v102, 65536, v6
s_lshl_b32 s71, s66, 16
s_add_u32 s70, s70, s71
s_add_u32 s70, s70, 49152
v_lshlrev_b32 v6, 5, v5
v_lshl_add_u32 v6, v2, 7, v6
v_lshl_add_u32 v6, v7, 3, v6
v_add_u32 v104, s70, v6
v_xor_b32 v105, 32, v104
v_xor_b32 v106, 64, v104
v_xor_b32 v107, 96, v104
v_lshrrev_b32 v5, 4, v1
v_xor_b32 v4, v4, v5
v_lshlrev_b32 v4, 5, v4
v_lshrrev_b32 v6, 3, v1
v_lshl_add_u32 v4, v6, 7, v4
v_lshl_add_u32 v4, v3, 4, v4
v_add_u32 v103, s70, v4
s_lshl_b32 s70, s60, 5
s_add_u32 s70, s70, 161792
v_mov_b32 v63, s70
v_add_u32 v114, 16, v63
v_lshl_add_u32 v56, v3, 4, v63
s_and_b32 s70, s65, 3
s_lshl_b32 s70, s70, 9
s_lshr_b32 s71, s62, 2
s_xor_b32 s71, s71, 0
s_lshl_b32 s71, s71, 13
s_add_u32 s71, s71, 8388608
s_xor_b32 s71, s71, s61
s_add_u32 s70, s70, s71
v_lshl_add_u32 v57, v5, 4, s70
v_lshlrev_b32 v60, 5, v5
v_lshl_add_u32 v60, v3, 4, v60
v_bfe_u32 v7, v1, 1, 1
v_lshl_add_u32 v60, v7, 7, v60
v_and_b32 v2, 3, v2
v_lshl_add_u32 v61, v2, 8, v60
v_lshlrev_b32 v62, 4, v3
v_lshl_add_u32 v62, v5, 5, v62
v_mov_b32 v59, s68
s_lshl_b32 s71, s79, 2
s_add_u32 s71, s71, s60
s_lshl_b32 s70, s71, 8
s_add_u32 s70, s70, 6946816
s_mov_b32 s85, s70
s_and_b32 s71, s65, 3
s_lshl2_add_u32 s71, s3, s71
s_and_b32 s70, s65, 12
s_add_u32 s70, s70, s60
s_lshl_b32 s71, s71, 7
s_bitcmp1_b32 s70, 3
s_cselect_b32 s72, 0, 8192
s_add_u32 s71, s71, s72
s_and_b32 s70, s70, 7
s_lshl_b32 s70, s70, 16
s_add_u32 s70, s70, s71
s_add_u32 s70, s70, 7340032
s_mov_b32 s88, s70
s_xor_b32 s88, s88, s61
s_lshl_b32 s70, s64, 14
s_add_u32 s86, s70, 6946816
s_and_b32 s70, s65, 3
v_mul_u32_u24 v2, 1, v7
v_xor_b32 v2, s70, v2
v_lshl_add_u32 v61, v2, 12, v61
s_lshl_b32 s87, s62, 11
s_xor_b32 s87, s87, 8192
s_add_u32 s87, s87, 6815744
s_xor_b32 s87, s87, s61
s_mov_b32 s94, 0
s_mov_b32 s95, 0
s_mov_b32 s92, 0x000f000f
s_mov_b32 s93, 0x000f000f
s_and_b32 s70, s65, 12
s_add_u32 s70, s70, s60
s_lshr_b32 s70, s70, 1
s_xor_b32 s24, s70, s62
s_xor_b32 s70, s69, 1
s_or_b32 s24, s24, s70
s_mov_b32 s32, 0xaaaaaaaa
s_mov_b32 s33, 0xaaaaaaaa
s_mov_b32 s38, 0
v_mov_b32 v64, 0x3f803f80
v_mov_b32 v65, 0x3f803f80
v_mov_b32 v66, 0x3f803f80
v_mov_b32 v67, 0x3f803f80
v_add_u32 v115, 64, v1
v_mov_b32 v2, 0
v_mov_b32 v95, 0
v_mov_b32 v99, 0
s_waitcnt vmcnt(0) lgkmcnt(0)
s_barrier
ds_write_b128 v100, a[0:3] offset:0
ds_write_b128 v101, a[4:7] offset:512
ds_write_b128 v100, a[8:11] offset:1024
ds_write_b128 v101, a[12:15] offset:1536
ds_write_b128 v100, a[16:19] offset:4096
ds_write_b128 v101, a[20:23] offset:4608
ds_write_b128 v100, a[24:27] offset:5120
ds_write_b128 v101, a[28:31] offset:5632
ds_write_b128 v100, a[32:35] offset:32768
ds_write_b128 v101, a[36:39] offset:33280
ds_write_b128 v100, a[40:43] offset:33792
ds_write_b128 v101, a[44:47] offset:34304
ds_write_b128 v100, a[48:51] offset:36864
ds_write_b128 v101, a[52:55] offset:37376
ds_write_b128 v100, a[56:59] offset:37888
ds_write_b128 v101, a[60:63] offset:38400
ds_write_b128 v103, a[64:67] offset:0
ds_write_b128 v103, a[68:71] offset:1024
ds_write_b128 v103, a[72:75] offset:2048
ds_write_b128 v103, a[76:79] offset:3072
ds_write_b128 v103, a[80:83] offset:4096
ds_write_b128 v103, a[84:87] offset:5120
ds_write_b128 v103, a[88:91] offset:6144
ds_write_b128 v103, a[92:95] offset:7168
s_waitcnt lgkmcnt(0)
ds_read_b64_tr_b16 a[64:65], v104 offset:0
ds_read_b64_tr_b16 a[66:67], v104 offset:2048
ds_read_b64_tr_b16 a[68:69], v104 offset:4096
ds_read_b64_tr_b16 a[70:71], v104 offset:6144
ds_read_b64_tr_b16 a[72:73], v105 offset:0
ds_read_b64_tr_b16 a[74:75], v105 offset:2048
ds_read_b64_tr_b16 a[76:77], v105 offset:4096
ds_read_b64_tr_b16 a[78:79], v105 offset:6144
ds_read_b64_tr_b16 a[80:81], v106 offset:0
ds_read_b64_tr_b16 a[82:83], v106 offset:2048
ds_read_b64_tr_b16 a[84:85], v106 offset:4096
ds_read_b64_tr_b16 a[86:87], v106 offset:6144
ds_read_b64_tr_b16 a[88:89], v107 offset:0
ds_read_b64_tr_b16 a[90:91], v107 offset:2048
ds_read_b64_tr_b16 a[92:93], v107 offset:4096
ds_read_b64_tr_b16 a[94:95], v107 offset:6144
s_barrier
ds_read_b64_tr_b16 a[0:1], v102 offset:0
ds_read_b64_tr_b16 a[2:3], v102 offset:2048
ds_read_b64_tr_b16 a[32:33], v102 offset:32768
ds_read_b64_tr_b16 a[34:35], v102 offset:34816
ds_read_b64_tr_b16 a[4:5], v102 offset:4096
ds_read_b64_tr_b16 a[6:7], v102 offset:6144
ds_read_b64_tr_b16 a[36:37], v102 offset:36864
ds_read_b64_tr_b16 a[38:39], v102 offset:38912
ds_read_b64_tr_b16 a[8:9], v102 offset:8192
ds_read_b64_tr_b16 a[10:11], v102 offset:10240
ds_read_b64_tr_b16 a[40:41], v102 offset:40960
ds_read_b64_tr_b16 a[42:43], v102 offset:43008
ds_read_b64_tr_b16 a[12:13], v102 offset:12288
ds_read_b64_tr_b16 a[14:15], v102 offset:14336
ds_read_b64_tr_b16 a[44:45], v102 offset:45056
ds_read_b64_tr_b16 a[46:47], v102 offset:47104
ds_read_b64_tr_b16 a[16:17], v102 offset:16384
ds_read_b64_tr_b16 a[18:19], v102 offset:18432
ds_read_b64_tr_b16 a[48:49], v102 offset:49152
ds_read_b64_tr_b16 a[50:51], v102 offset:51200
ds_read_b64_tr_b16 a[20:21], v102 offset:20480
ds_read_b64_tr_b16 a[22:23], v102 offset:22528
ds_read_b64_tr_b16 a[52:53], v102 offset:53248
ds_read_b64_tr_b16 a[54:55], v102 offset:55296
ds_read_b64_tr_b16 a[24:25], v102 offset:24576
ds_read_b64_tr_b16 a[26:27], v102 offset:26624
ds_read_b64_tr_b16 a[56:57], v102 offset:57344
ds_read_b64_tr_b16 a[58:59], v102 offset:59392
ds_read_b64_tr_b16 a[28:29], v102 offset:28672
ds_read_b64_tr_b16 a[30:31], v102 offset:30720
ds_read_b64_tr_b16 a[60:61], v102 offset:61440
ds_read_b64_tr_b16 a[62:63], v102 offset:63488
s_waitcnt lgkmcnt(0)
buffer_load_dwordx4 v[92:95], v18, s[12:15], s87 offen offset:0 sc1
buffer_load_dwordx4 v[96:99], v18, s[12:15], s87 offen offset:1024 sc1
v_mfma_f32_16x16x32_bf16 v[68:71], a[0:3], v[64:67], 0
v_mfma_f32_16x16x32_bf16 v[72:75], a[32:35], v[64:67], 0
v_mfma_f32_16x16x32_bf16 v[68:71], a[4:7], v[64:67], v[68:71]
v_mfma_f32_16x16x32_bf16 v[72:75], a[36:39], v[64:67], v[72:75]
v_mfma_f32_16x16x32_bf16 v[68:71], a[8:11], v[64:67], v[68:71]
v_mfma_f32_16x16x32_bf16 v[72:75], a[40:43], v[64:67], v[72:75]
v_mfma_f32_16x16x32_bf16 v[68:71], a[12:15], v[64:67], v[68:71]
v_mfma_f32_16x16x32_bf16 v[72:75], a[44:47], v[64:67], v[72:75]
v_mfma_f32_16x16x32_bf16 v[68:71], a[16:19], v[64:67], v[68:71]
v_mfma_f32_16x16x32_bf16 v[72:75], a[48:51], v[64:67], v[72:75]
v_mfma_f32_16x16x32_bf16 v[68:71], a[20:23], v[64:67], v[68:71]
v_mfma_f32_16x16x32_bf16 v[72:75], a[52:55], v[64:67], v[72:75]
v_mfma_f32_16x16x32_bf16 v[68:71], a[24:27], v[64:67], v[68:71]
v_mfma_f32_16x16x32_bf16 v[72:75], a[56:59], v[64:67], v[72:75]
v_mfma_f32_16x16x32_bf16 v[68:71], a[28:31], v[64:67], v[68:71]
v_mfma_f32_16x16x32_bf16 v[72:75], a[60:63], v[64:67], v[72:75]
L_pk:
s_waitcnt vmcnt(0)
L_pk2:
v_cmp_eq_u32_e64 s[80:81], s68, v95
v_cmp_eq_u32_e64 s[82:83], s68, v99
s_nop 0
v_cndmask_b32_e64 v108, 0, v92, s[80:81]
v_cndmask_b32_e64 v109, 0, v96, s[82:83]
s_and_b64 s[76:77], s[80:81], s[82:83]
v_max_u32 v110, v108, v109
v_min_u32 v111, v108, v109
s_cmp_eq_u64 s[76:77], -1
s_cselect_b32 s73, 0, 1
s_cbranch_scc1 L_pkc
s_not_b64 exec, s[80:81]
s_cselect_b64 exec, exec, 1
buffer_load_dwordx4 v[92:95], v18, s[12:15], s87 offen offset:0 sc1
s_not_b64 exec, s[82:83]
s_cselect_b64 exec, exec, 1
buffer_load_dwordx4 v[96:99], v18, s[12:15], s87 offen offset:1024 sc1
s_mov_b64 exec, -1
L_pkc:
v_cmp_le_u32 vcc, s95, v110
v_cmp_le_u32_e64 s[76:77], s95, v111
s_bcnt1_i32_b64 s70, vcc
s_bcnt1_i32_b64 s71, s[76:77]
s_add_u32 s70, s70, s71
s_cmp_eq_u32 s70, 2
s_cbranch_scc1 L_pksame
v_mov_b32_dpp v112, v110 row_ror:1 row_mask:0xf bank_mask:0xf
v_max_u32_dpp v113, v111, v111 row_ror:1 row_mask:0xf bank_mask:0xf
v_med3_u32 v111, v110, v112, v113
v_max_u32 v110, v110, v112
s_nop 1
v_mov_b32_dpp v112, v110 row_ror:2 row_mask:0xf bank_mask:0xf
v_max_u32_dpp v113, v111, v111 row_ror:2 row_mask:0xf bank_mask:0xf
v_med3_u32 v111, v110, v112, v113
v_max_u32 v110, v110, v112
s_nop 1
v_mov_b32_dpp v112, v110 row_ror:4 row_mask:0xf bank_mask:0xf
v_max_u32_dpp v113, v111, v111 row_ror:4 row_mask:0xf bank_mask:0xf
v_med3_u32 v111, v110, v112, v113
v_max_u32 v110, v110, v112
s_nop 1
v_mov_b32_dpp v112, v110 row_ror:8 row_mask:0xf bank_mask:0xf
v_max_u32_dpp v113, v111, v111 row_ror:8 row_mask:0xf bank_mask:0xf
v_med3_u32 v111, v110, v112, v113
v_max_u32 v110, v110, v112
v_mov_b32 v112, v110
v_mov_b32 v113, v111
s_nop 0
v_permlane16_swap_b32 v110, v112
v_permlane16_swap_b32 v111, v113
v_max_u32 v113, v111, v113
v_med3_u32 v111, v110, v112, v113
v_max_u32 v110, v110, v112
v_mov_b32 v112, v110
v_mov_b32 v113, v111
s_nop 0
v_permlane32_swap_b32 v110, v112
v_permlane32_swap_b32 v111, v113
v_max_u32 v113, v111, v113
v_med3_u32 v111, v110, v112, v113
v_max_u32 v110, v110, v112
v_readfirstlane_b32 s95, v111
s_nop 0
s_cmp_eq_u32 s95, 0
s_cbranch_scc1 L_pksame
v_cndmask_b32_e64 v58, v110, v111, s[32:33]
v_and_b32 v58, 127, v58
v_lshl_add_u32 v58, v58, 14, v57
s_mov_b64 exec, s[92:93]
buffer_load_dwordx4 v[24:27], v58, s[12:15], 0 offen offset:0 sc1
buffer_load_dwordx4 v[28:31], v58, s[12:15], 0 offen offset:64 sc1
buffer_load_dwordx4 v[32:35], v58, s[12:15], 0 offen offset:128 sc1
buffer_load_dwordx4 v[36:39], v58, s[12:15], 0 offen offset:192 sc1
buffer_load_dwordx4 v[40:43], v58, s[12:15], 0 offen offset:256 sc1
buffer_load_dwordx4 v[44:47], v58, s[12:15], 0 offen offset:320 sc1
buffer_load_dwordx4 v[48:51], v58, s[12:15], 0 offen offset:384 sc1
buffer_load_dwordx4 v[52:55], v58, s[12:15], 0 offen offset:448 sc1
s_mov_b64 exec, -1
v_cmp_eq_u32 vcc, v108, v111
v_cmp_eq_u32_e64 s[76:77], v108, v110
s_nop 0
v_cndmask_b32 v112, v63, v114, vcc
s_or_b64 exec, vcc, s[76:77]
ds_write_b96 v112, v[92:94]
s_mov_b64 exec, -1
v_cmp_eq_u32 vcc, v109, v111
v_cmp_eq_u32_e64 s[76:77], v109, v110
s_nop 0
v_cndmask_b32 v113, v63, v114, vcc
s_or_b64 exec, vcc, s[76:77]
ds_write_b96 v113, v[96:98]
s_mov_b64 exec, -1
ds_read_b96 v[20:22], v56
s_waitcnt lgkmcnt(0)
v_mul_f32_e64 v84, v68, -v21
v_mul_f32_e64 v85, v69, -v21
v_mul_f32_e64 v86, v70, -v21
v_mul_f32_e64 v87, v71, -v21
v_mul_f32_e64 v88, v72, -v21
v_mul_f32_e64 v89, v73, -v21
v_mul_f32_e64 v90, v74, -v21
v_mul_f32_e64 v91, v75, -v21
s_cmp_eq_u32 s73, 0
s_cbranch_scc1 L_pkf
s_waitcnt vmcnt(8)
s_add_u32 s78, s78, 1
s_cmp_le_u32 s78, 65536
s_cbranch_scc1 L_pk2
L_pkf:
s_waitcnt vmcnt(7)
v_mfma_f32_16x16x32_bf16 v[84:87], a[0:3], v[24:27], v[84:87]
v_mfma_f32_16x16x32_bf16 v[88:91], a[32:35], v[24:27], v[88:91]
s_waitcnt vmcnt(6)
v_mfma_f32_16x16x32_bf16 v[84:87], a[4:7], v[28:31], v[84:87]
v_mfma_f32_16x16x32_bf16 v[88:91], a[36:39], v[28:31], v[88:91]
s_waitcnt vmcnt(5)
v_mfma_f32_16x16x32_bf16 v[84:87], a[8:11], v[32:35], v[84:87]
v_max3_u32 v2, v24, v28, v32
v_mfma_f32_16x16x32_bf16 v[88:91], a[40:43], v[32:35], v[88:91]
s_waitcnt vmcnt(4)
v_mfma_f32_16x16x32_bf16 v[84:87], a[12:15], v[36:39], v[84:87]
v_mfma_f32_16x16x32_bf16 v[88:91], a[44:47], v[36:39], v[88:91]
s_waitcnt vmcnt(3)
v_mfma_f32_16x16x32_bf16 v[84:87], a[16:19], v[40:43], v[84:87]
v_mfma_f32_16x16x32_bf16 v[88:91], a[48:51], v[40:43], v[88:91]
s_waitcnt vmcnt(2)
v_mfma_f32_16x16x32_bf16 v[84:87], a[20:23], v[44:47], v[84:87]
v_max3_u32 v3, v36, v40, v44
v_mfma_f32_16x16x32_bf16 v[88:91], a[52:55], v[44:47], v[88:91]
s_waitcnt vmcnt(1)
v_mfma_f32_16x16x32_bf16 v[84:87], a[24:27], v[48:51], v[84:87]
v_mfma_f32_16x16x32_bf16 v[88:91], a[56:59], v[48:51], v[88:91]
s_waitcnt vmcnt(0)
v_mfma_f32_16x16x32_bf16 v[84:87], a[28:31], v[52:55], v[84:87]
v_max3_u32 v2, v2, v48, v52
v_max_u32 v2, v2, v3
v_cmp_eq_u32 vcc, -1, v2
v_mfma_f32_16x16x32_bf16 v[88:91], a[60:63], v[52:55], v[88:91]
s_and_b64 vcc, vcc, s[92:93]
s_cbranch_vccnz L_pkx_rt
L_pkx_ok:
s_mov_b32 s76, 0xcccccccc
s_mov_b32 s77, 0xcccccccc
s_nop 3
v_cndmask_b32_e64 v84, v84, v88, s[76:77]
v_cndmask_b32_e64 v85, v85, v89, s[76:77]
v_cndmask_b32_e64 v86, v86, v90, s[76:77]
v_cndmask_b32_e64 v87, v87, v91, s[76:77]
v_bfi_b32 v84, s91, v59, v84
s_mov_b64 exec, s[92:93]
s_cmp_eq_u32 s69, 0
s_cbranch_scc1 L_pxp_s
buffer_store_dwordx4 v[84:87], v60, s[12:15], s85 offen
L_pxp_d:
s_mov_b64 exec, -1
s_barrier
s_load_dword s70, s[12:13], 41152
s_waitcnt lgkmcnt(0)
buffer_load_dwordx4 v[24:27], v61, s[12:15], s86 offen offset:0 sc1
buffer_load_dwordx4 v[28:31], v61, s[12:15], s86 offen offset:1024 sc1
buffer_load_dwordx4 v[32:35], v61, s[12:15], s86 offen offset:2048 sc1
buffer_load_dwordx4 v[36:39], v61, s[12:15], s86 offen offset:3072 sc1
s_mov_b32 s92, 0x00030003
s_mov_b32 s93, 0x00030003
s_waitcnt vmcnt(0)
L_px_chk:
v_xor_b32 v24, s84, v24
v_xor_b32 v28, s84, v28
v_xor_b32 v32, s84, v32
v_xor_b32_e64 v36, s84, v36
v_or3_b32 v2, v24, v28, v32
v_bitop3_b32 v2, v2, v36, s91 bitop3:0xa8
v_cmp_ne_u32 vcc, 0, v2
s_cbranch_vccnz L_px_rt
L_px_ok:
v_pk_add_f32 v[24:25], v[24:25], v[28:29]
v_pk_add_f32 v[32:33], v[32:33], v[36:37]
v_pk_add_f32 v[26:27], v[26:27], v[30:31]
v_pk_add_f32 v[34:35], v[34:35], v[38:39]
v_pk_add_f32 v[24:25], v[24:25], v[32:33]
v_pk_add_f32 v[26:27], v[26:27], v[34:35]
v_pk_mul_f32 v[24:25], v[24:25], v[22:23] op_sel_hi:[1,0]
v_pk_mul_f32 v[26:27], v[26:27], v[22:23] op_sel_hi:[1,0]
s_not_b64 vcc, s[76:77]
v_mul_f32_dpp v32, v24, v24 quad_perm:[2,3,0,1] row_mask:0xf bank_mask:0xf
v_mul_f32_dpp v33, v25, v25 quad_perm:[2,3,0,1] row_mask:0xf bank_mask:0xf
v_mul_f32_dpp v34, v26, v26 quad_perm:[2,3,0,1] row_mask:0xf bank_mask:0xf
v_mul_f32_dpp v35, v27, v27 quad_perm:[2,3,0,1] row_mask:0xf bank_mask:0xf
v_cndmask_b32_dpp v28, v26, v24, vcc quad_perm:[2,3,0,1] row_mask:0xf bank_mask:0xf
v_cndmask_b32_dpp v29, v27, v25, vcc quad_perm:[2,3,0,1] row_mask:0xf bank_mask:0xf
v_mul_f32 v28, 0xbfb8aa3b, v28
v_mul_f32 v29, 0xbfb8aa3b, v29
v_exp_f32 v28, v28
v_exp_f32 v29, v29
v_cndmask_b32 v32, v34, v32, vcc
v_cndmask_b32 v33, v35, v33, vcc
v_add_f32 v28, 1.0, v28
v_add_f32 v29, 1.0, v29
v_rcp_f32 v28, v28
v_rcp_f32 v29, v29
v_mul_f32 v24, v32, v28
v_mul_f32 v25, v33, v29
v_cvt_pk_bf16_f32 v28, v24, v25
s_nop 1
v_mov_b32_dpp v30, v28 row_shl:4 row_mask:0xf bank_mask:0xf
v_mov_b32_dpp v32, v28 row_shl:8 row_mask:0xf bank_mask:0xf
v_mov_b32_dpp v34, v28 row_shl:12 row_mask:0xf bank_mask:0xf
v_mov_b32_dpp v29, v28 row_shl:2 row_mask:0xf bank_mask:0xf
v_mov_b32_dpp v31, v28 row_shl:6 row_mask:0xf bank_mask:0xf
v_mov_b32_dpp v33, v28 row_shl:10 row_mask:0xf bank_mask:0xf
v_mov_b32_dpp v35, v28 row_shl:14 row_mask:0xf bank_mask:0xf
v_mfma_f32_16x16x32_bf16 v[40:43], a[64:67], v[28:31], 0
v_mfma_f32_16x16x32_bf16 v[44:47], a[72:75], v[28:31], 0
v_mfma_f32_16x16x32_bf16 v[40:43], a[68:71], v[32:35], v[40:43]
v_mfma_f32_16x16x32_bf16 v[44:47], a[76:79], v[32:35], v[44:47]
v_mfma_f32_16x16x32_bf16 v[48:51], a[80:83], v[28:31], 0
v_mfma_f32_16x16x32_bf16 v[52:55], a[88:91], v[28:31], 0
v_mfma_f32_16x16x32_bf16 v[48:51], a[84:87], v[32:35], v[48:51]
v_mfma_f32_16x16x32_bf16 v[52:55], a[92:95], v[32:35], v[52:55]
s_cmp_ge_u32 s3, 14
s_cbranch_scc1 L_noy
s_mov_b64 exec, s[92:93]
s_cmp_eq_u32 s24, 0
s_cbranch_scc1 L_yown
v_bfi_b32 v40, s91, v59, v40
buffer_store_dwordx4 v[40:43], v62, s[12:15], s88 offen sc1
s_add_u32 s88, s88, 16384
v_bfi_b32 v44, s91, v59, v44
buffer_store_dwordx4 v[44:47], v62, s[12:15], s88 offen sc1
s_add_u32 s88, s88, 16384
v_bfi_b32 v48, s91, v59, v48
buffer_store_dwordx4 v[48:51], v62, s[12:15], s88 offen sc1
s_add_u32 s88, s88, 16384
v_bfi_b32 v52, s91, v59, v52
buffer_store_dwordx4 v[52:55], v62, s[12:15], s88 offen sc1
L_yd:
s_mov_b64 exec, -1
L_noy:
s_or_b32 s70, s2, s60
s_cbranch_scc1 L_noep
v_mov_b32 v3, 0
s_mov_b64 exec, 1
buffer_store_dword v59, v3, s[12:15], 0 offen sc1
s_mov_b64 exec, -1
L_noep:
s_cmp_lt_u32 s63, 24
s_cbranch_scc1 L_ldone
s_cmp_lg_u32 s60, 1
s_cbranch_scc1 L_ldone
s_branch L_over2
L_pad2:
s_branch L_pad11
L_over2:
s_lshl_b32 s87, s62, 3
s_add_u32 s87, s87, s63
s_sub_u32 s87, s87, 24
s_and_b32 s88, s87, 31
s_lshl_b32 s88, s88, 14
s_bitcmp1_b32 s87, 5
s_cselect_b32 s70, 0, 8192
s_add_u32 s88, s88, s70
s_add_u32 s88, s88, 7340032
s_xor_b32 s88, s88, s61
s_add_u32 s71, s88, 4096
s_lshl_b32 s70, s87, 5
v_bfe_u32 v3, v1, 1, 2
v_lshl_add_u32 v7, v3, 3, s70
s_lshr_b32 s72, s62, 2
s_xor_b32 s72, s72, 0
s_lshl_b32 s72, s72, 13
s_add_u32 s72, s72, 8388608
s_xor_b32 s72, s72, s61
v_lshrrev_b32_e64 v3, 4, v1
v_lshl_add_u32 v7, v3, 1, v7
v_and_b32 v64, 127, v20
v_lshl_add_u32 v64, v64, 14, v7
buffer_load_ushort v84, v64, s[12:15], s72 offen sc1
buffer_load_dwordx4 v[120:123], v18, s[12:15], s88 offen offset:0 sc1
buffer_load_dwordx4 v[124:127], v18, s[12:15], s88 offen offset:1024 sc1
buffer_load_dwordx4 v[128:131], v18, s[12:15], s88 offen offset:2048 sc1
buffer_load_dwordx4 v[132:135], v18, s[12:15], s88 offen offset:3072 sc1
buffer_load_dwordx4 v[136:139], v18, s[12:15], s71 offen offset:0 sc1
buffer_load_dwordx4 v[140:143], v18, s[12:15], s71 offen offset:1024 sc1
buffer_load_dwordx4 v[144:147], v18, s[12:15], s71 offen offset:2048 sc1
v_mov_b32 v88, s84
v_and_b32 v65, 0xfffff000, v20
v_not_b32 v4, v65
v_ashrrev_i32 v4, 31, v4
v_or_b32 v4, 0x80000000, v4
v_xor_b32 v65, v65, v4
v_mul_f32 v65, 0xbfb8aa3b, v65
v_exp_f32 v65, v65
s_nop 0
v_add_f32 v65, 1.0, v65
v_rcp_f32 v65, v65
v_bfe_u32 v66, v20, 1, 6
v_lshl_add_u32 v66, v66, 16, v7
v_bfe_u32 v4, v20, 7, 5
v_lshl_add_u32 v66, v4, 11, v66
v_add_f32 v67, 1.0, v22
v_mul_f32_e64 v21, -v21, v22
s_load_dword s94, s[12:13], 4096
s_waitcnt lgkmcnt(0)
buffer_load_dwordx4 v[24:27], v18, s[12:15], s88 offen offset:0 sc1
buffer_load_dwordx4 v[28:31], v18, s[12:15], s88 offen offset:1024 sc1
buffer_load_dwordx4 v[32:35], v18, s[12:15], s88 offen offset:2048 sc1
buffer_load_dwordx4 v[36:39], v18, s[12:15], s88 offen offset:3072 sc1
buffer_load_dwordx4 v[92:95], v18, s[12:15], s71 offen offset:0 sc1
buffer_load_dwordx4 v[96:99], v18, s[12:15], s71 offen offset:1024 sc1
buffer_load_dwordx4 v[100:103], v18, s[12:15], s71 offen offset:2048 sc1
s_load_dword s94, s[12:13], 4160
s_waitcnt lgkmcnt(0)
buffer_load_dwordx4 v[40:43], v18, s[12:15], s88 offen offset:0 sc1
buffer_load_dwordx4 v[44:47], v18, s[12:15], s88 offen offset:1024 sc1
buffer_load_dwordx4 v[48:51], v18, s[12:15], s88 offen offset:2048 sc1
buffer_load_dwordx4 v[52:55], v18, s[12:15], s88 offen offset:3072 sc1
buffer_load_dwordx4 v[104:107], v18, s[12:15], s71 offen offset:0 sc1
buffer_load_dwordx4 v[108:111], v18, s[12:15], s71 offen offset:1024 sc1
buffer_load_dwordx4 v[112:115], v18, s[12:15], s71 offen offset:2048 sc1
s_waitcnt vmcnt(21)
L_h_chk:
v_cmp_eq_u32 vcc, 0xffff, v84
s_cbranch_vccnz L_h_rt
L_h_ok:
v_lshlrev_b32 v84, 16, v84
v_fma_f32 v84, v84, v67, v21
L_yr:
s_waitcnt vmcnt(14)
v_xor_b32 v120, s84, v120
v_xor_b32 v124, s84, v124
v_xor_b32 v128, s84, v128
v_xor_b32_e64 v132, s84, v132
v_or3_b32 v2, v120, v124, v128
v_xor_b32 v136, s84, v136
v_xor_b32 v140, s84, v140
v_or3_b32 v2, v2, v132, v136
v_xor_b32 v144, s84, v144
v_xor_b32 v88, s84, v88
v_or3_b32 v2, v2, v140, v144
v_bitop3_b32 v2, v2, v88, s91 bitop3:0xa8
v_cmp_ne_u32 vcc, 0, v2
s_cbranch_vccnz L_y_rt
L_yf0:
v_pk_add_f32 v[120:121], v[120:121], v[124:125]
v_pk_add_f32 v[122:123], v[122:123], v[126:127]
v_pk_add_f32 v[128:129], v[128:129], v[132:133]
v_pk_add_f32 v[130:131], v[130:131], v[134:135]
v_pk_add_f32 v[136:137], v[136:137], v[140:141]
v_pk_add_f32 v[138:139], v[138:139], v[142:143]
v_pk_add_f32 v[120:121], v[120:121], v[128:129]
v_pk_add_f32 v[122:123], v[122:123], v[130:131]
v_pk_add_f32 v[136:137], v[136:137], v[144:145]
v_pk_add_f32 v[138:139], v[138:139], v[146:147]
v_pk_add_f32 v[120:121], v[120:121], v[136:137]
v_pk_add_f32 v[122:123], v[122:123], v[138:139]
s_nop 1
v_permlane32_swap_b32 v120, v122
v_permlane32_swap_b32 v121, v123
v_add_f32 v68, v120, v122
v_add_f32 v69, v121, v123
L_yf:
s_nop 1
v_permlane16_swap_b32 v68, v69
v_add_f32 v68, v68, v69
s_mov_b32 s72, 0x00ff00ff
s_mov_b32 s73, 0x00ff00ff
v_add_f32_dpp v68, v68, v68 row_ror:8 row_mask:0xf bank_mask:0xf
v_fmac_f32 v84, v68, v65
v_cvt_pk_bf16_f32 v84, v84, v84
s_mov_b64 exec, s[72:73]
buffer_store_short v84, v66, s[20:23], 0 offen sc1
L_ldone:
s_endpgm
.p2alignl 12, 0xbf810000
.fill 160, 4, 0xbf810000
L_compute:
v_and_b32 v2, 15, v1
v_lshrrev_b32 v4, 4, v1
v_lshrrev_b32 v3, 1, v2
v_xor_b32 v3, v3, v4
v_lshlrev_b32 v2, 7, v2
s_lshl_b32 s70, s66, 13
v_add_u32 v2, s70, v2
v_xor_b32 v5, 0, v3
v_lshl_add_u32 v8, v5, 4, v2
v_add_u32 v10, 65536, v8
v_xor_b32 v5, 4, v3
v_lshl_add_u32 v9, v5, 4, v2
v_add_u32 v11, 65536, v9
v_lshrrev_b32 v2, 5, v1
v_mul_u32_u24 v2, 6144, v2
v_bfe_u32 v3, v1, 4, 1
v_lshl_add_u32 v2, v3, 10, v2
v_bfe_u32 v4, v1, 2, 2
v_lshl_add_u32 v2, v4, 7, v2
v_lshlrev_b32 v3, 1, v3
v_bfe_u32 v4, v1, 3, 1
v_or_b32 v3, v3, v4
s_lshl_b32 s70, s67, 1
v_xor_b32 v3, s70, v3
v_and_b32 v4, 3, v1
v_lshl_add_u32 v2, v4, 3, v2
v_xor_b32 v4, 0, v3
v_lshl_add_u32 v12, v4, 5, v2
v_add_u32 v14, 65536, v12
v_xor_b32 v4, 1, v3
v_lshl_add_u32 v13, v4, 5, v2
v_add_u32 v15, 65536, v13
s_waitcnt lgkmcnt(0)
s_mov_b32 s12, s58
s_and_b32 s13, s59, 0xffff
s_mov_b32 s14, 268435456
s_mov_b32 s15, 0x20000
s_load_dword s68, s[58:59], 0
s_mov_b32 s20, s56
s_and_b32 s21, s57, 0xffff
s_mov_b32 s22, 4194304
s_mov_b32 s23, 0x20000
s_lshl_b32 s87, s64, 4
s_add_u32 s87, s87, s65
s_mul_i32 s87, s87, 4352
s_add_u32 s87, s87, 524288
s_and_b32 s88, s65, 7
s_lshl_b32 s88, s88, 19
s_lshr_b32 s70, s65, 1
s_xor_b32 s70, s70, s65
s_and_b32 s70, s70, 4
s_lshl_b32 s70, s70, 11
s_xor_b32 s70, s70, 2105344
s_add_u32 s88, s88, s70
s_mul_i32 s70, s66, 262144
s_add_u32 s88, s88, s70
s_lshr_b32 s70, s64, 2
s_lshl_b32 s70, s70, 14
s_add_u32 s88, s88, s70
s_and_b32 s70, s64, 3
s_lshl_b32 s70, s70, 11
s_add_u32 s88, s88, s70
s_lshl_b32 s70, s67, 10
s_add_u32 s88, s88, s70
s_mov_b32 s70, 0x3f803f80
v_accvgpr_write_b32 a80, s70
v_accvgpr_write_b32 a81, s70
v_accvgpr_write_b32 a82, s70
v_accvgpr_write_b32 a83, s70
s_mov_b32 s80, 0x358637bd
s_mov_b32 s81, 0x358637bd
s_mov_b32 s82, 0x3f800008
s_mov_b32 s83, 0x3f800008
s_mov_b32 s90, 0x3fb8aa3b
s_mov_b32 s91, 0x3fb8aa3b
s_waitcnt lgkmcnt(0)
s_add_u32 s68, s68, 1
v_and_b32 v7, 3, v1
v_lshrrev_b32_e64 v7, v7, s68
v_and_b32 v7, 1, v7
v_mul_u32_u24 v7, 0x10001, v7
s_mov_b32 s76, 0x10001
s_mov_b32 s77, 0x07060302
s_movk_i32 s85, 0xff
v_mov_b32 v28, -1
v_mov_b32 v29, -1
v_mov_b32 v30, -1
v_mov_b32 v31, -1
s_and_b32 s94, s65, 3
s_or_b32 s94, s94, s66
s_barrier
ds_read_b128 a[0:3], v10 offset:57344
ds_read_b64_tr_b16 a[32:33], v12 offset:0
ds_read_b64_tr_b16 a[34:35], v12 offset:512
ds_read_b128 a[4:7], v10 offset:59392
ds_read_b128 a[8:11], v10 offset:61440
ds_read_b128 a[12:15], v10 offset:63488
ds_read_b64_tr_b16 a[36:37], v13 offset:0
ds_read_b64_tr_b16 a[38:39], v13 offset:512
ds_read_b64_tr_b16 a[40:41], v12 offset:2048
ds_read_b64_tr_b16 a[42:43], v12 offset:2560
ds_read_b64_tr_b16 a[44:45], v13 offset:2048
ds_read_b64_tr_b16 a[46:47], v13 offset:2560
ds_read_b64_tr_b16 a[48:49], v12 offset:4096
ds_read_b64_tr_b16 a[50:51], v12 offset:4608
ds_read_b64_tr_b16 a[52:53], v13 offset:4096
ds_read_b64_tr_b16 a[54:55], v13 offset:4608
s_waitcnt lgkmcnt(0)
s_cmp_lg_u32 s94, 0
s_cbranch_scc1 L_nocs0_0
v_mfma_f32_16x16x32_bf16 v[128:131], a[80:83], a[32:35], 0
v_mfma_f32_16x16x32_bf16 v[132:135], a[80:83], a[36:39], 0
v_mfma_f32_16x16x32_bf16 v[136:139], a[80:83], a[40:43], 0
v_mfma_f32_16x16x32_bf16 v[140:143], a[80:83], a[44:47], 0
v_mfma_f32_16x16x32_bf16 v[144:147], a[80:83], a[48:51], 0
v_mfma_f32_16x16x32_bf16 v[148:151], a[80:83], a[52:55], 0
L_nocs0_0:
v_mfma_f32_16x16x32_bf16 v[32:35], a[32:35], a[0:3], 0
ds_read_b128 a[16:19], v11 offset:57344
v_mfma_f32_16x16x32_bf16 v[56:59], a[32:35], a[4:7], 0
ds_read_b64_tr_b16 a[56:57], v12 offset:12288
v_mfma_f32_16x16x32_bf16 v[80:83], a[32:35], a[8:11], 0
ds_read_b64_tr_b16 a[58:59], v12 offset:12800
v_mfma_f32_16x16x32_bf16 v[104:107], a[32:35], a[12:15], 0
ds_read_b128 a[20:23], v11 offset:59392
v_mfma_f32_16x16x32_bf16 v[36:39], a[36:39], a[0:3], 0
ds_read_b128 a[24:27], v11 offset:61440
v_mfma_f32_16x16x32_bf16 v[60:63], a[36:39], a[4:7], 0
ds_read_b128 a[28:31], v11 offset:63488
v_mfma_f32_16x16x32_bf16 v[84:87], a[36:39], a[8:11], 0
ds_read_b64_tr_b16 a[60:61], v13 offset:12288
v_mfma_f32_16x16x32_bf16 v[108:111], a[36:39], a[12:15], 0
ds_read_b64_tr_b16 a[62:63], v13 offset:12800
v_mfma_f32_16x16x32_bf16 v[40:43], a[0:3], a[40:43], 0
ds_read_b64_tr_b16 a[64:65], v12 offset:14336
v_mfma_f32_16x16x32_bf16 v[64:67], a[4:7], a[40:43], 0
ds_read_b64_tr_b16 a[66:67], v12 offset:14848
v_mfma_f32_16x16x32_bf16 v[88:91], a[8:11], a[40:43], 0
ds_read_b64_tr_b16 a[68:69], v13 offset:14336
v_mfma_f32_16x16x32_bf16 v[112:115], a[12:15], a[40:43], 0
ds_read_b64_tr_b16 a[70:71], v13 offset:14848
v_mfma_f32_16x16x32_bf16 v[44:47], a[0:3], a[44:47], 0
ds_read_b64_tr_b16 a[72:73], v12 offset:16384
v_mfma_f32_16x16x32_bf16 v[68:71], a[4:7], a[44:47], 0
ds_read_b64_tr_b16 a[74:75], v12 offset:16896
v_mfma_f32_16x16x32_bf16 v[92:95], a[8:11], a[44:47], 0
ds_read_b64_tr_b16 a[76:77], v13 offset:16384
v_mfma_f32_16x16x32_bf16 v[116:119], a[12:15], a[44:47], 0
ds_read_b64_tr_b16 a[78:79], v13 offset:16896
v_mfma_f32_16x16x32_bf16 v[48:51], a[0:3], a[48:51], 0
v_mfma_f32_16x16x32_bf16 v[72:75], a[4:7], a[48:51], 0
v_mfma_f32_16x16x32_bf16 v[96:99], a[8:11], a[48:51], 0
v_mfma_f32_16x16x32_bf16 v[120:123], a[12:15], a[48:51], 0
v_mfma_f32_16x16x32_bf16 v[52:55], a[0:3], a[52:55], 0
v_mfma_f32_16x16x32_bf16 v[76:79], a[4:7], a[52:55], 0
v_mfma_f32_16x16x32_bf16 v[100:103], a[8:11], a[52:55], 0
v_mfma_f32_16x16x32_bf16 v[124:127], a[12:15], a[52:55], 0
s_waitcnt lgkmcnt(0)
s_cmp_lg_u32 s94, 0
s_cbranch_scc1 L_nocs0_1
v_mfma_f32_16x16x32_bf16 v[128:131], a[80:83], a[56:59], v[128:131]
v_mfma_f32_16x16x32_bf16 v[132:135], a[80:83], a[60:63], v[132:135]
v_mfma_f32_16x16x32_bf16 v[136:139], a[80:83], a[64:67], v[136:139]
v_mfma_f32_16x16x32_bf16 v[140:143], a[80:83], a[68:71], v[140:143]
v_mfma_f32_16x16x32_bf16 v[144:147], a[80:83], a[72:75], v[144:147]
v_mfma_f32_16x16x32_bf16 v[148:151], a[80:83], a[76:79], v[148:151]
L_nocs0_1:
v_mfma_f32_16x16x32_bf16 v[32:35], a[56:59], a[16:19], v[32:35]
s_barrier
ds_read_b128 a[0:3], v10 offset:40960
v_mfma_f32_16x16x32_bf16 v[56:59], a[56:59], a[20:23], v[56:59]
ds_read_b64_tr_b16 a[32:33], v14 offset:16384
v_mfma_f32_16x16x32_bf16 v[80:83], a[56:59], a[24:27], v[80:83]
ds_read_b64_tr_b16 a[34:35], v14 offset:16896
v_mfma_f32_16x16x32_bf16 v[104:107], a[56:59], a[28:31], v[104:107]
ds_read_b128 a[4:7], v10 offset:43008
v_mfma_f32_16x16x32_bf16 v[36:39], a[60:63], a[16:19], v[36:39]
ds_read_b128 a[8:11], v10 offset:45056
v_mfma_f32_16x16x32_bf16 v[60:63], a[60:63], a[20:23], v[60:63]
ds_read_b128 a[12:15], v10 offset:47104
v_mfma_f32_16x16x32_bf16 v[84:87], a[60:63], a[24:27], v[84:87]
ds_read_b64_tr_b16 a[36:37], v15 offset:16384
v_mfma_f32_16x16x32_bf16 v[108:111], a[60:63], a[28:31], v[108:111]
ds_read_b64_tr_b16 a[38:39], v15 offset:16896
v_mfma_f32_16x16x32_bf16 v[40:43], a[16:19], a[64:67], v[40:43]
ds_read_b64_tr_b16 a[40:41], v14 offset:18432
v_mfma_f32_16x16x32_bf16 v[64:67], a[20:23], a[64:67], v[64:67]
ds_read_b64_tr_b16 a[42:43], v14 offset:18944
v_mfma_f32_16x16x32_bf16 v[88:91], a[24:27], a[64:67], v[88:91]
ds_read_b64_tr_b16 a[44:45], v15 offset:18432
v_mfma_f32_16x16x32_bf16 v[112:115], a[28:31], a[64:67], v[112:115]
ds_read_b64_tr_b16 a[46:47], v15 offset:18944
v_mfma_f32_16x16x32_bf16 v[44:47], a[16:19], a[68:71], v[44:47]
ds_read_b64_tr_b16 a[48:49], v14 offset:20480
v_mfma_f32_16x16x32_bf16 v[68:71], a[20:23], a[68:71], v[68:71]
ds_read_b64_tr_b16 a[50:51], v14 offset:20992
v_mfma_f32_16x16x32_bf16 v[92:95], a[24:27], a[68:71], v[92:95]
ds_read_b64_tr_b16 a[52:53], v15 offset:20480
v_mfma_f32_16x16x32_bf16 v[116:119], a[28:31], a[68:71], v[116:119]
ds_read_b64_tr_b16 a[54:55], v15 offset:20992
v_mfma_f32_16x16x32_bf16 v[48:51], a[16:19], a[72:75], v[48:51]
v_mfma_f32_16x16x32_bf16 v[72:75], a[20:23], a[72:75], v[72:75]
v_mfma_f32_16x16x32_bf16 v[96:99], a[24:27], a[72:75], v[96:99]
v_mfma_f32_16x16x32_bf16 v[120:123], a[28:31], a[72:75], v[120:123]
v_mfma_f32_16x16x32_bf16 v[52:55], a[16:19], a[76:79], v[52:55]
v_mfma_f32_16x16x32_bf16 v[76:79], a[20:23], a[76:79], v[76:79]
v_mfma_f32_16x16x32_bf16 v[100:103], a[24:27], a[76:79], v[100:103]
v_mfma_f32_16x16x32_bf16 v[124:127], a[28:31], a[76:79], v[124:127]
s_waitcnt lgkmcnt(0)
s_cmp_lg_u32 s94, 0
s_cbranch_scc1 L_nocs1_0
v_mfma_f32_16x16x32_bf16 v[128:131], a[80:83], a[32:35], v[128:131]
v_mfma_f32_16x16x32_bf16 v[132:135], a[80:83], a[36:39], v[132:135]
v_mfma_f32_16x16x32_bf16 v[136:139], a[80:83], a[40:43], v[136:139]
v_mfma_f32_16x16x32_bf16 v[140:143], a[80:83], a[44:47], v[140:143]
v_mfma_f32_16x16x32_bf16 v[144:147], a[80:83], a[48:51], v[144:147]
v_mfma_f32_16x16x32_bf16 v[148:151], a[80:83], a[52:55], v[148:151]
L_nocs1_0:
v_mfma_f32_16x16x32_bf16 v[32:35], a[32:35], a[0:3], v[32:35]
ds_read_b128 a[16:19], v11 offset:40960
v_mfma_f32_16x16x32_bf16 v[56:59], a[32:35], a[4:7], v[56:59]
ds_read_b64_tr_b16 a[56:57], v14 offset:28672
v_mfma_f32_16x16x32_bf16 v[80:83], a[32:35], a[8:11], v[80:83]
ds_read_b64_tr_b16 a[58:59], v14 offset:29184
v_mfma_f32_16x16x32_bf16 v[104:107], a[32:35], a[12:15], v[104:107]
ds_read_b128 a[20:23], v11 offset:43008
v_mfma_f32_16x16x32_bf16 v[36:39], a[36:39], a[0:3], v[36:39]
ds_read_b128 a[24:27], v11 offset:45056
v_mfma_f32_16x16x32_bf16 v[60:63], a[36:39], a[4:7], v[60:63]
ds_read_b128 a[28:31], v11 offset:47104
v_mfma_f32_16x16x32_bf16 v[84:87], a[36:39], a[8:11], v[84:87]
ds_read_b64_tr_b16 a[60:61], v15 offset:28672
v_mfma_f32_16x16x32_bf16 v[108:111], a[36:39], a[12:15], v[108:111]
ds_read_b64_tr_b16 a[62:63], v15 offset:29184
v_mfma_f32_16x16x32_bf16 v[40:43], a[0:3], a[40:43], v[40:43]
ds_read_b64_tr_b16 a[64:65], v14 offset:30720
v_mfma_f32_16x16x32_bf16 v[64:67], a[4:7], a[40:43], v[64:67]
ds_read_b64_tr_b16 a[66:67], v14 offset:31232
v_mfma_f32_16x16x32_bf16 v[88:91], a[8:11], a[40:43], v[88:91]
ds_read_b64_tr_b16 a[68:69], v15 offset:30720
v_mfma_f32_16x16x32_bf16 v[112:115], a[12:15], a[40:43], v[112:115]
ds_read_b64_tr_b16 a[70:71], v15 offset:31232
v_mfma_f32_16x16x32_bf16 v[44:47], a[0:3], a[44:47], v[44:47]
ds_read_b64_tr_b16 a[72:73], v14 offset:32768
v_mfma_f32_16x16x32_bf16 v[68:71], a[4:7], a[44:47], v[68:71]
ds_read_b64_tr_b16 a[74:75], v14 offset:33280
v_mfma_f32_16x16x32_bf16 v[92:95], a[8:11], a[44:47], v[92:95]
ds_read_b64_tr_b16 a[76:77], v15 offset:32768
v_mfma_f32_16x16x32_bf16 v[116:119], a[12:15], a[44:47], v[116:119]
ds_read_b64_tr_b16 a[78:79], v15 offset:33280
v_mfma_f32_16x16x32_bf16 v[48:51], a[0:3], a[48:51], v[48:51]
v_mfma_f32_16x16x32_bf16 v[72:75], a[4:7], a[48:51], v[72:75]
v_mfma_f32_16x16x32_bf16 v[96:99], a[8:11], a[48:51], v[96:99]
v_mfma_f32_16x16x32_bf16 v[120:123], a[12:15], a[48:51], v[120:123]
v_mfma_f32_16x16x32_bf16 v[52:55], a[0:3], a[52:55], v[52:55]
v_mfma_f32_16x16x32_bf16 v[76:79], a[4:7], a[52:55], v[76:79]
v_mfma_f32_16x16x32_bf16 v[100:103], a[8:11], a[52:55], v[100:103]
v_mfma_f32_16x16x32_bf16 v[124:127], a[12:15], a[52:55], v[124:127]
s_waitcnt lgkmcnt(0)
s_cmp_lg_u32 s94, 0
s_cbranch_scc1 L_nocs1_1
v_mfma_f32_16x16x32_bf16 v[128:131], a[80:83], a[56:59], v[128:131]
v_mfma_f32_16x16x32_bf16 v[132:135], a[80:83], a[60:63], v[132:135]
v_mfma_f32_16x16x32_bf16 v[136:139], a[80:83], a[64:67], v[136:139]
v_mfma_f32_16x16x32_bf16 v[140:143], a[80:83], a[68:71], v[140:143]
v_mfma_f32_16x16x32_bf16 v[144:147], a[80:83], a[72:75], v[144:147]
v_mfma_f32_16x16x32_bf16 v[148:151], a[80:83], a[76:79], v[148:151]
L_nocs1_1:
v_mfma_f32_16x16x32_bf16 v[32:35], a[56:59], a[16:19], v[32:35]
s_barrier
ds_read_b128 a[0:3], v10 offset:0
v_mfma_f32_16x16x32_bf16 v[56:59], a[56:59], a[20:23], v[56:59]
ds_read_b64_tr_b16 a[32:33], v12 offset:40960
v_mfma_f32_16x16x32_bf16 v[80:83], a[56:59], a[24:27], v[80:83]
ds_read_b64_tr_b16 a[34:35], v12 offset:41472
v_mfma_f32_16x16x32_bf16 v[104:107], a[56:59], a[28:31], v[104:107]
ds_read_b128 a[4:7], v10 offset:2048
v_mfma_f32_16x16x32_bf16 v[36:39], a[60:63], a[16:19], v[36:39]
ds_read_b128 a[8:11], v10 offset:4096
v_mfma_f32_16x16x32_bf16 v[60:63], a[60:63], a[20:23], v[60:63]
ds_read_b128 a[12:15], v10 offset:6144
v_mfma_f32_16x16x32_bf16 v[84:87], a[60:63], a[24:27], v[84:87]
ds_read_b64_tr_b16 a[36:37], v13 offset:40960
v_mfma_f32_16x16x32_bf16 v[108:111], a[60:63], a[28:31], v[108:111]
ds_read_b64_tr_b16 a[38:39], v13 offset:41472
v_mfma_f32_16x16x32_bf16 v[40:43], a[16:19], a[64:67], v[40:43]
ds_read_b64_tr_b16 a[40:41], v12 offset:43008
v_mfma_f32_16x16x32_bf16 v[64:67], a[20:23], a[64:67], v[64:67]
ds_read_b64_tr_b16 a[42:43], v12 offset:43520
v_mfma_f32_16x16x32_bf16 v[88:91], a[24:27], a[64:67], v[88:91]
ds_read_b64_tr_b16 a[44:45], v13 offset:43008
v_mfma_f32_16x16x32_bf16 v[112:115], a[28:31], a[64:67], v[112:115]
ds_read_b64_tr_b16 a[46:47], v13 offset:43520
v_mfma_f32_16x16x32_bf16 v[44:47], a[16:19], a[68:71], v[44:47]
ds_read_b64_tr_b16 a[48:49], v12 offset:45056
v_mfma_f32_16x16x32_bf16 v[68:71], a[20:23], a[68:71], v[68:71]
ds_read_b64_tr_b16 a[50:51], v12 offset:45568
v_mfma_f32_16x16x32_bf16 v[92:95], a[24:27], a[68:71], v[92:95]
ds_read_b64_tr_b16 a[52:53], v13 offset:45056
v_mfma_f32_16x16x32_bf16 v[116:119], a[28:31], a[68:71], v[116:119]
ds_read_b64_tr_b16 a[54:55], v13 offset:45568
v_mfma_f32_16x16x32_bf16 v[48:51], a[16:19], a[72:75], v[48:51]
v_mfma_f32_16x16x32_bf16 v[72:75], a[20:23], a[72:75], v[72:75]
v_mfma_f32_16x16x32_bf16 v[96:99], a[24:27], a[72:75], v[96:99]
v_mfma_f32_16x16x32_bf16 v[120:123], a[28:31], a[72:75], v[120:123]
v_mfma_f32_16x16x32_bf16 v[52:55], a[16:19], a[76:79], v[52:55]
v_mfma_f32_16x16x32_bf16 v[76:79], a[20:23], a[76:79], v[76:79]
v_mfma_f32_16x16x32_bf16 v[100:103], a[24:27], a[76:79], v[100:103]
v_mfma_f32_16x16x32_bf16 v[124:127], a[28:31], a[76:79], v[124:127]
s_waitcnt lgkmcnt(0)
s_cmp_lg_u32 s94, 0
s_cbranch_scc1 L_nocs2_0
v_mfma_f32_16x16x32_bf16 v[128:131], a[80:83], a[32:35], v[128:131]
v_mfma_f32_16x16x32_bf16 v[132:135], a[80:83], a[36:39], v[132:135]
v_mfma_f32_16x16x32_bf16 v[136:139], a[80:83], a[40:43], v[136:139]
v_mfma_f32_16x16x32_bf16 v[140:143], a[80:83], a[44:47], v[140:143]
v_mfma_f32_16x16x32_bf16 v[144:147], a[80:83], a[48:51], v[144:147]
v_mfma_f32_16x16x32_bf16 v[148:151], a[80:83], a[52:55], v[148:151]
L_nocs2_0:
v_mfma_f32_16x16x32_bf16 v[32:35], a[32:35], a[0:3], v[32:35]
ds_read_b128 a[16:19], v11 offset:0
v_mfma_f32_16x16x32_bf16 v[56:59], a[32:35], a[4:7], v[56:59]
ds_read_b64_tr_b16 a[56:57], v12 offset:53248
v_mfma_f32_16x16x32_bf16 v[80:83], a[32:35], a[8:11], v[80:83]
ds_read_b64_tr_b16 a[58:59], v12 offset:53760
v_mfma_f32_16x16x32_bf16 v[104:107], a[32:35], a[12:15], v[104:107]
ds_read_b128 a[20:23], v11 offset:2048
v_mfma_f32_16x16x32_bf16 v[36:39], a[36:39], a[0:3], v[36:39]
ds_read_b128 a[24:27], v11 offset:4096
v_mfma_f32_16x16x32_bf16 v[60:63], a[36:39], a[4:7], v[60:63]
ds_read_b128 a[28:31], v11 offset:6144
v_mfma_f32_16x16x32_bf16 v[84:87], a[36:39], a[8:11], v[84:87]
ds_read_b64_tr_b16 a[60:61], v13 offset:53248
v_mfma_f32_16x16x32_bf16 v[108:111], a[36:39], a[12:15], v[108:111]
ds_read_b64_tr_b16 a[62:63], v13 offset:53760
v_mfma_f32_16x16x32_bf16 v[40:43], a[0:3], a[40:43], v[40:43]
ds_read_b64_tr_b16 a[64:65], v12 offset:55296
v_mfma_f32_16x16x32_bf16 v[64:67], a[4:7], a[40:43], v[64:67]
ds_read_b64_tr_b16 a[66:67], v12 offset:55808
v_mfma_f32_16x16x32_bf16 v[88:91], a[8:11], a[40:43], v[88:91]
ds_read_b64_tr_b16 a[68:69], v13 offset:55296
v_mfma_f32_16x16x32_bf16 v[112:115], a[12:15], a[40:43], v[112:115]
ds_read_b64_tr_b16 a[70:71], v13 offset:55808
v_mfma_f32_16x16x32_bf16 v[44:47], a[0:3], a[44:47], v[44:47]
ds_read_b64_tr_b16 a[72:73], v12 offset:57344
v_mfma_f32_16x16x32_bf16 v[68:71], a[4:7], a[44:47], v[68:71]
ds_read_b64_tr_b16 a[74:75], v12 offset:57856
v_mfma_f32_16x16x32_bf16 v[92:95], a[8:11], a[44:47], v[92:95]
ds_read_b64_tr_b16 a[76:77], v13 offset:57344
v_mfma_f32_16x16x32_bf16 v[116:119], a[12:15], a[44:47], v[116:119]
ds_read_b64_tr_b16 a[78:79], v13 offset:57856
v_mfma_f32_16x16x32_bf16 v[48:51], a[0:3], a[48:51], v[48:51]
s_lshl_b32 s70, s60, 10
s_add_u32 s70, s70, s87
buffer_store_dwordx4 v[28:31], v16, s[12:15], s70 offen sc1
v_mfma_f32_16x16x32_bf16 v[72:75], a[4:7], a[48:51], v[72:75]
v_mfma_f32_16x16x32_bf16 v[96:99], a[8:11], a[48:51], v[96:99]
v_mfma_f32_16x16x32_bf16 v[120:123], a[12:15], a[48:51], v[120:123]
v_mfma_f32_16x16x32_bf16 v[52:55], a[0:3], a[52:55], v[52:55]
v_mfma_f32_16x16x32_bf16 v[76:79], a[4:7], a[52:55], v[76:79]
v_mfma_f32_16x16x32_bf16 v[100:103], a[8:11], a[52:55], v[100:103]
v_mfma_f32_16x16x32_bf16 v[124:127], a[12:15], a[52:55], v[124:127]
s_waitcnt lgkmcnt(0)
s_cmp_lg_u32 s94, 0
s_cbranch_scc1 L_nocs2_1
v_mfma_f32_16x16x32_bf16 v[128:131], a[80:83], a[56:59], v[128:131]
v_mfma_f32_16x16x32_bf16 v[132:135], a[80:83], a[60:63], v[132:135]
v_mfma_f32_16x16x32_bf16 v[136:139], a[80:83], a[64:67], v[136:139]
v_mfma_f32_16x16x32_bf16 v[140:143], a[80:83], a[68:71], v[140:143]
v_mfma_f32_16x16x32_bf16 v[144:147], a[80:83], a[72:75], v[144:147]
v_mfma_f32_16x16x32_bf16 v[148:151], a[80:83], a[76:79], v[148:151]
L_nocs2_1:
v_mfma_f32_16x16x32_bf16 v[32:35], a[56:59], a[16:19], v[32:35]
s_barrier
ds_read_b128 a[0:3], v8 offset:24576
v_mfma_f32_16x16x32_bf16 v[56:59], a[56:59], a[20:23], v[56:59]
ds_read_b64_tr_b16 a[32:33], v12 offset:0
v_mfma_f32_16x16x32_bf16 v[80:83], a[56:59], a[24:27], v[80:83]
ds_read_b64_tr_b16 a[34:35], v12 offset:512
v_mfma_f32_16x16x32_bf16 v[104:107], a[56:59], a[28:31], v[104:107]
ds_read_b128 a[4:7], v8 offset:26624
v_mfma_f32_16x16x32_bf16 v[36:39], a[60:63], a[16:19], v[36:39]
ds_read_b128 a[8:11], v8 offset:28672
v_mfma_f32_16x16x32_bf16 v[60:63], a[60:63], a[20:23], v[60:63]
ds_read_b128 a[12:15], v8 offset:30720
v_mfma_f32_16x16x32_bf16 v[84:87], a[60:63], a[24:27], v[84:87]
ds_read_b64_tr_b16 a[36:37], v13 offset:0
v_mfma_f32_16x16x32_bf16 v[108:111], a[60:63], a[28:31], v[108:111]
ds_read_b64_tr_b16 a[38:39], v13 offset:512
v_mfma_f32_16x16x32_bf16 v[40:43], a[16:19], a[64:67], v[40:43]
ds_read_b64_tr_b16 a[40:41], v12 offset:2048
v_mfma_f32_16x16x32_bf16 v[64:67], a[20:23], a[64:67], v[64:67]
ds_read_b64_tr_b16 a[42:43], v12 offset:2560
v_mfma_f32_16x16x32_bf16 v[88:91], a[24:27], a[64:67], v[88:91]
ds_read_b64_tr_b16 a[44:45], v13 offset:2048
v_mfma_f32_16x16x32_bf16 v[112:115], a[28:31], a[64:67], v[112:115]
ds_read_b64_tr_b16 a[46:47], v13 offset:2560
v_mfma_f32_16x16x32_bf16 v[44:47], a[16:19], a[68:71], v[44:47]
ds_read_b64_tr_b16 a[48:49], v12 offset:4096
v_mfma_f32_16x16x32_bf16 v[68:71], a[20:23], a[68:71], v[68:71]
ds_read_b64_tr_b16 a[50:51], v12 offset:4608
v_mfma_f32_16x16x32_bf16 v[92:95], a[24:27], a[68:71], v[92:95]
ds_read_b64_tr_b16 a[52:53], v13 offset:4096
v_mfma_f32_16x16x32_bf16 v[116:119], a[28:31], a[68:71], v[116:119]
ds_read_b64_tr_b16 a[54:55], v13 offset:4608
v_mfma_f32_16x16x32_bf16 v[48:51], a[16:19], a[72:75], v[48:51]
v_mfma_f32_16x16x32_bf16 v[72:75], a[20:23], a[72:75], v[72:75]
v_mfma_f32_16x16x32_bf16 v[96:99], a[24:27], a[72:75], v[96:99]
v_mfma_f32_16x16x32_bf16 v[120:123], a[28:31], a[72:75], v[120:123]
v_mfma_f32_16x16x32_bf16 v[52:55], a[16:19], a[76:79], v[52:55]
v_mfma_f32_16x16x32_bf16 v[76:79], a[20:23], a[76:79], v[76:79]
v_mfma_f32_16x16x32_bf16 v[100:103], a[24:27], a[76:79], v[100:103]
v_mfma_f32_16x16x32_bf16 v[124:127], a[28:31], a[76:79], v[124:127]
s_waitcnt lgkmcnt(0)
s_cmp_lg_u32 s94, 0
s_cbranch_scc1 L_nocs3_0
v_mfma_f32_16x16x32_bf16 v[128:131], a[80:83], a[32:35], v[128:131]
v_mfma_f32_16x16x32_bf16 v[132:135], a[80:83], a[36:39], v[132:135]
v_mfma_f32_16x16x32_bf16 v[136:139], a[80:83], a[40:43], v[136:139]
v_mfma_f32_16x16x32_bf16 v[140:143], a[80:83], a[44:47], v[140:143]
v_mfma_f32_16x16x32_bf16 v[144:147], a[80:83], a[48:51], v[144:147]
v_mfma_f32_16x16x32_bf16 v[148:151], a[80:83], a[52:55], v[148:151]
L_nocs3_0:
v_mfma_f32_16x16x32_bf16 v[32:35], a[32:35], a[0:3], v[32:35]
ds_read_b128 a[16:19], v9 offset:24576
v_mfma_f32_16x16x32_bf16 v[56:59], a[32:35], a[4:7], v[56:59]
ds_read_b64_tr_b16 a[56:57], v12 offset:12288
v_mfma_f32_16x16x32_bf16 v[80:83], a[32:35], a[8:11], v[80:83]
ds_read_b64_tr_b16 a[58:59], v12 offset:12800
v_mfma_f32_16x16x32_bf16 v[104:107], a[32:35], a[12:15], v[104:107]
ds_read_b128 a[20:23], v9 offset:26624
v_mfma_f32_16x16x32_bf16 v[36:39], a[36:39], a[0:3], v[36:39]
ds_read_b128 a[24:27], v9 offset:28672
v_mfma_f32_16x16x32_bf16 v[60:63], a[36:39], a[4:7], v[60:63]
ds_read_b128 a[28:31], v9 offset:30720
v_mfma_f32_16x16x32_bf16 v[84:87], a[36:39], a[8:11], v[84:87]
ds_read_b64_tr_b16 a[60:61], v13 offset:12288
v_mfma_f32_16x16x32_bf16 v[108:111], a[36:39], a[12:15], v[108:111]
ds_read_b64_tr_b16 a[62:63], v13 offset:12800
v_mfma_f32_16x16x32_bf16 v[40:43], a[0:3], a[40:43], v[40:43]
ds_read_b64_tr_b16 a[64:65], v12 offset:14336
v_mfma_f32_16x16x32_bf16 v[64:67], a[4:7], a[40:43], v[64:67]
ds_read_b64_tr_b16 a[66:67], v12 offset:14848
v_mfma_f32_16x16x32_bf16 v[88:91], a[8:11], a[40:43], v[88:91]
ds_read_b64_tr_b16 a[68:69], v13 offset:14336
v_mfma_f32_16x16x32_bf16 v[112:115], a[12:15], a[40:43], v[112:115]
ds_read_b64_tr_b16 a[70:71], v13 offset:14848
v_mfma_f32_16x16x32_bf16 v[44:47], a[0:3], a[44:47], v[44:47]
ds_read_b64_tr_b16 a[72:73], v12 offset:16384
v_mfma_f32_16x16x32_bf16 v[68:71], a[4:7], a[44:47], v[68:71]
ds_read_b64_tr_b16 a[74:75], v12 offset:16896
v_mfma_f32_16x16x32_bf16 v[92:95], a[8:11], a[44:47], v[92:95]
ds_read_b64_tr_b16 a[76:77], v13 offset:16384
v_mfma_f32_16x16x32_bf16 v[116:119], a[12:15], a[44:47], v[116:119]
ds_read_b64_tr_b16 a[78:79], v13 offset:16896
v_mfma_f32_16x16x32_bf16 v[48:51], a[0:3], a[48:51], v[48:51]
v_mfma_f32_16x16x32_bf16 v[72:75], a[4:7], a[48:51], v[72:75]
v_mfma_f32_16x16x32_bf16 v[96:99], a[8:11], a[48:51], v[96:99]
v_mfma_f32_16x16x32_bf16 v[120:123], a[12:15], a[48:51], v[120:123]
v_mfma_f32_16x16x32_bf16 v[52:55], a[0:3], a[52:55], v[52:55]
v_mfma_f32_16x16x32_bf16 v[76:79], a[4:7], a[52:55], v[76:79]
v_mfma_f32_16x16x32_bf16 v[100:103], a[8:11], a[52:55], v[100:103]
v_mfma_f32_16x16x32_bf16 v[124:127], a[12:15], a[52:55], v[124:127]
s_waitcnt lgkmcnt(0)
s_cmp_lg_u32 s94, 0
s_cbranch_scc1 L_nocs3_1
v_mfma_f32_16x16x32_bf16 v[128:131], a[80:83], a[56:59], v[128:131]
v_mfma_f32_16x16x32_bf16 v[132:135], a[80:83], a[60:63], v[132:135]
v_mfma_f32_16x16x32_bf16 v[136:139], a[80:83], a[64:67], v[136:139]
v_mfma_f32_16x16x32_bf16 v[140:143], a[80:83], a[68:71], v[140:143]
v_mfma_f32_16x16x32_bf16 v[144:147], a[80:83], a[72:75], v[144:147]
v_mfma_f32_16x16x32_bf16 v[148:151], a[80:83], a[76:79], v[148:151]
L_nocs3_1:
v_mfma_f32_16x16x32_bf16 v[32:35], a[56:59], a[16:19], v[32:35]
s_barrier
ds_read_b128 a[0:3], v10 offset:57344
v_mfma_f32_16x16x32_bf16 v[56:59], a[56:59], a[20:23], v[56:59]
ds_read_b64_tr_b16 a[32:33], v14 offset:16384
v_mfma_f32_16x16x32_bf16 v[80:83], a[56:59], a[24:27], v[80:83]
ds_read_b64_tr_b16 a[34:35], v14 offset:16896
s_branch L_over3
L_pad3:
s_branch L_ret4
L_over3:
v_mfma_f32_16x16x32_bf16 v[104:107], a[56:59], a[28:31], v[104:107]
ds_read_b128 a[4:7], v10 offset:59392
v_mfma_f32_16x16x32_bf16 v[36:39], a[60:63], a[16:19], v[36:39]
ds_read_b128 a[8:11], v10 offset:61440
v_mfma_f32_16x16x32_bf16 v[60:63], a[60:63], a[20:23], v[60:63]
ds_read_b128 a[12:15], v10 offset:63488
v_mfma_f32_16x16x32_bf16 v[84:87], a[60:63], a[24:27], v[84:87]
ds_read_b64_tr_b16 a[36:37], v15 offset:16384
v_mfma_f32_16x16x32_bf16 v[108:111], a[60:63], a[28:31], v[108:111]
ds_read_b64_tr_b16 a[38:39], v15 offset:16896
v_mfma_f32_16x16x32_bf16 v[40:43], a[16:19], a[64:67], v[40:43]
ds_read_b64_tr_b16 a[40:41], v14 offset:18432
v_mfma_f32_16x16x32_bf16 v[64:67], a[20:23], a[64:67], v[64:67]
ds_read_b64_tr_b16 a[42:43], v14 offset:18944
v_mfma_f32_16x16x32_bf16 v[88:91], a[24:27], a[64:67], v[88:91]
ds_read_b64_tr_b16 a[44:45], v15 offset:18432
v_mfma_f32_16x16x32_bf16 v[112:115], a[28:31], a[64:67], v[112:115]
ds_read_b64_tr_b16 a[46:47], v15 offset:18944
v_mfma_f32_16x16x32_bf16 v[44:47], a[16:19], a[68:71], v[44:47]
ds_read_b64_tr_b16 a[48:49], v14 offset:20480
v_mfma_f32_16x16x32_bf16 v[68:71], a[20:23], a[68:71], v[68:71]
ds_read_b64_tr_b16 a[50:51], v14 offset:20992
v_mfma_f32_16x16x32_bf16 v[92:95], a[24:27], a[68:71], v[92:95]
ds_read_b64_tr_b16 a[52:53], v15 offset:20480
v_mfma_f32_16x16x32_bf16 v[116:119], a[28:31], a[68:71], v[116:119]
ds_read_b64_tr_b16 a[54:55], v15 offset:20992
v_mfma_f32_16x16x32_bf16 v[48:51], a[16:19], a[72:75], v[48:51]
v_mfma_f32_16x16x32_bf16 v[72:75], a[20:23], a[72:75], v[72:75]
v_mfma_f32_16x16x32_bf16 v[96:99], a[24:27], a[72:75], v[96:99]
v_mfma_f32_16x16x32_bf16 v[120:123], a[28:31], a[72:75], v[120:123]
v_mfma_f32_16x16x32_bf16 v[52:55], a[16:19], a[76:79], v[52:55]
v_mfma_f32_16x16x32_bf16 v[76:79], a[20:23], a[76:79], v[76:79]
v_mfma_f32_16x16x32_bf16 v[100:103], a[24:27], a[76:79], v[100:103]
v_mfma_f32_16x16x32_bf16 v[124:127], a[28:31], a[76:79], v[124:127]
s_waitcnt lgkmcnt(0)
v_mfma_f32_16x16x32_bf16 v[32:35], a[32:35], a[0:3], v[32:35]
ds_read_b128 a[16:19], v11 offset:57344
v_mfma_f32_16x16x32_bf16 v[56:59], a[32:35], a[4:7], v[56:59]
ds_read_b64_tr_b16 a[56:57], v14 offset:28672
v_mfma_f32_16x16x32_bf16 v[80:83], a[32:35], a[8:11], v[80:83]
ds_read_b64_tr_b16 a[58:59], v14 offset:29184
v_mfma_f32_16x16x32_bf16 v[104:107], a[32:35], a[12:15], v[104:107]
ds_read_b128 a[20:23], v11 offset:59392
v_mfma_f32_16x16x32_bf16 v[36:39], a[36:39], a[0:3], v[36:39]
ds_read_b128 a[24:27], v11 offset:61440
v_mfma_f32_16x16x32_bf16 v[60:63], a[36:39], a[4:7], v[60:63]
ds_read_b128 a[28:31], v11 offset:63488
v_mfma_f32_16x16x32_bf16 v[84:87], a[36:39], a[8:11], v[84:87]
ds_read_b64_tr_b16 a[60:61], v15 offset:28672
v_mfma_f32_16x16x32_bf16 v[108:111], a[36:39], a[12:15], v[108:111]
ds_read_b64_tr_b16 a[62:63], v15 offset:29184
v_mfma_f32_16x16x32_bf16 v[40:43], a[0:3], a[40:43], v[40:43]
ds_read_b64_tr_b16 a[64:65], v14 offset:30720
v_mfma_f32_16x16x32_bf16 v[64:67], a[4:7], a[40:43], v[64:67]
ds_read_b64_tr_b16 a[66:67], v14 offset:31232
v_mfma_f32_16x16x32_bf16 v[88:91], a[8:11], a[40:43], v[88:91]
ds_read_b64_tr_b16 a[68:69], v15 offset:30720
v_mfma_f32_16x16x32_bf16 v[112:115], a[12:15], a[40:43], v[112:115]
ds_read_b64_tr_b16 a[70:71], v15 offset:31232
v_mfma_f32_16x16x32_bf16 v[44:47], a[0:3], a[44:47], v[44:47]
ds_read_b64_tr_b16 a[72:73], v14 offset:32768
v_mfma_f32_16x16x32_bf16 v[68:71], a[4:7], a[44:47], v[68:71]
ds_read_b64_tr_b16 a[74:75], v14 offset:33280
v_mfma_f32_16x16x32_bf16 v[92:95], a[8:11], a[44:47], v[92:95]
ds_read_b64_tr_b16 a[76:77], v15 offset:32768
v_mfma_f32_16x16x32_bf16 v[116:119], a[12:15], a[44:47], v[116:119]
ds_read_b64_tr_b16 a[78:79], v15 offset:33280
v_mfma_f32_16x16x32_bf16 v[48:51], a[0:3], a[48:51], v[48:51]
s_add_u32 s70, s88, 0
buffer_store_dwordx4 v[28:31], v16, s[12:15], s70 offen sc1
v_mfma_f32_16x16x32_bf16 v[72:75], a[4:7], a[48:51], v[72:75]
v_mfma_f32_16x16x32_bf16 v[96:99], a[8:11], a[48:51], v[96:99]
s_add_u32 s70, s88, 65536
buffer_store_dwordx4 v[28:31], v16, s[12:15], s70 offen sc1
v_mfma_f32_16x16x32_bf16 v[120:123], a[12:15], a[48:51], v[120:123]
v_mfma_f32_16x16x32_bf16 v[52:55], a[0:3], a[52:55], v[52:55]
v_mfma_f32_16x16x32_bf16 v[76:79], a[4:7], a[52:55], v[76:79]
v_mfma_f32_16x16x32_bf16 v[100:103], a[8:11], a[52:55], v[100:103]
v_mfma_f32_16x16x32_bf16 v[124:127], a[12:15], a[52:55], v[124:127]
s_waitcnt lgkmcnt(0)
v_mfma_f32_16x16x32_bf16 v[32:35], a[56:59], a[16:19], v[32:35]
s_barrier
ds_read_b128 a[0:3], v10 offset:40960
v_mfma_f32_16x16x32_bf16 v[56:59], a[56:59], a[20:23], v[56:59]
ds_read_b64_tr_b16 a[32:33], v12 offset:40960
v_mfma_f32_16x16x32_bf16 v[80:83], a[56:59], a[24:27], v[80:83]
ds_read_b64_tr_b16 a[34:35], v12 offset:41472
v_mfma_f32_16x16x32_bf16 v[104:107], a[56:59], a[28:31], v[104:107]
ds_read_b128 a[4:7], v10 offset:43008
v_mfma_f32_16x16x32_bf16 v[36:39], a[60:63], a[16:19], v[36:39]
ds_read_b128 a[8:11], v10 offset:45056
v_mfma_f32_16x16x32_bf16 v[60:63], a[60:63], a[20:23], v[60:63]
ds_read_b128 a[12:15], v10 offset:47104
v_mfma_f32_16x16x32_bf16 v[84:87], a[60:63], a[24:27], v[84:87]
ds_read_b64_tr_b16 a[36:37], v13 offset:40960
v_mfma_f32_16x16x32_bf16 v[108:111], a[60:63], a[28:31], v[108:111]
ds_read_b64_tr_b16 a[38:39], v13 offset:41472
v_mfma_f32_16x16x32_bf16 v[40:43], a[16:19], a[64:67], v[40:43]
ds_read_b64_tr_b16 a[40:41], v12 offset:43008
v_mfma_f32_16x16x32_bf16 v[64:67], a[20:23], a[64:67], v[64:67]
ds_read_b64_tr_b16 a[42:43], v12 offset:43520
v_mfma_f32_16x16x32_bf16 v[88:91], a[24:27], a[64:67], v[88:91]
ds_read_b64_tr_b16 a[44:45], v13 offset:43008
v_mfma_f32_16x16x32_bf16 v[112:115], a[28:31], a[64:67], v[112:115]
ds_read_b64_tr_b16 a[46:47], v13 offset:43520
v_mfma_f32_16x16x32_bf16 v[44:47], a[16:19], a[68:71], v[44:47]
ds_read_b64_tr_b16 a[48:49], v12 offset:45056
v_mfma_f32_16x16x32_bf16 v[68:71], a[20:23], a[68:71], v[68:71]
ds_read_b64_tr_b16 a[50:51], v12 offset:45568
v_mfma_f32_16x16x32_bf16 v[92:95], a[24:27], a[68:71], v[92:95]
ds_read_b64_tr_b16 a[52:53], v13 offset:45056
v_mfma_f32_16x16x32_bf16 v[116:119], a[28:31], a[68:71], v[116:119]
ds_read_b64_tr_b16 a[54:55], v13 offset:45568
v_mfma_f32_16x16x32_bf16 v[48:51], a[16:19], a[72:75], v[48:51]
v_mfma_f32_16x16x32_bf16 v[72:75], a[20:23], a[72:75], v[72:75]
v_mfma_f32_16x16x32_bf16 v[96:99], a[24:27], a[72:75], v[96:99]
v_mfma_f32_16x16x32_bf16 v[120:123], a[28:31], a[72:75], v[120:123]
v_mfma_f32_16x16x32_bf16 v[52:55], a[16:19], a[76:79], v[52:55]
v_mfma_f32_16x16x32_bf16 v[76:79], a[20:23], a[76:79], v[76:79]
v_mfma_f32_16x16x32_bf16 v[100:103], a[24:27], a[76:79], v[100:103]
v_mfma_f32_16x16x32_bf16 v[124:127], a[28:31], a[76:79], v[124:127]
s_waitcnt lgkmcnt(0)
v_mfma_f32_16x16x32_bf16 v[32:35], a[32:35], a[0:3], v[32:35]
ds_read_b128 a[16:19], v11 offset:40960
v_mfma_f32_16x16x32_bf16 v[56:59], a[32:35], a[4:7], v[56:59]
ds_read_b64_tr_b16 a[56:57], v12 offset:53248
v_mfma_f32_16x16x32_bf16 v[80:83], a[32:35], a[8:11], v[80:83]
ds_read_b64_tr_b16 a[58:59], v12 offset:53760
v_mfma_f32_16x16x32_bf16 v[104:107], a[32:35], a[12:15], v[104:107]
ds_read_b128 a[20:23], v11 offset:43008
v_mfma_f32_16x16x32_bf16 v[36:39], a[36:39], a[0:3], v[36:39]
ds_read_b128 a[24:27], v11 offset:45056
v_mfma_f32_16x16x32_bf16 v[60:63], a[36:39], a[4:7], v[60:63]
ds_read_b128 a[28:31], v11 offset:47104
v_mfma_f32_16x16x32_bf16 v[84:87], a[36:39], a[8:11], v[84:87]
ds_read_b64_tr_b16 a[60:61], v13 offset:53248
v_mfma_f32_16x16x32_bf16 v[108:111], a[36:39], a[12:15], v[108:111]
ds_read_b64_tr_b16 a[62:63], v13 offset:53760
v_mfma_f32_16x16x32_bf16 v[40:43], a[0:3], a[40:43], v[40:43]
ds_read_b64_tr_b16 a[64:65], v12 offset:55296
v_mfma_f32_16x16x32_bf16 v[64:67], a[4:7], a[40:43], v[64:67]
ds_read_b64_tr_b16 a[66:67], v12 offset:55808
v_mfma_f32_16x16x32_bf16 v[88:91], a[8:11], a[40:43], v[88:91]
ds_read_b64_tr_b16 a[68:69], v13 offset:55296
v_mfma_f32_16x16x32_bf16 v[112:115], a[12:15], a[40:43], v[112:115]
ds_read_b64_tr_b16 a[70:71], v13 offset:55808
v_mfma_f32_16x16x32_bf16 v[44:47], a[0:3], a[44:47], v[44:47]
ds_read_b64_tr_b16 a[72:73], v12 offset:57344
v_mfma_f32_16x16x32_bf16 v[68:71], a[4:7], a[44:47], v[68:71]
ds_read_b64_tr_b16 a[74:75], v12 offset:57856
v_mfma_f32_16x16x32_bf16 v[92:95], a[8:11], a[44:47], v[92:95]
ds_read_b64_tr_b16 a[76:77], v13 offset:57344
v_mfma_f32_16x16x32_bf16 v[116:119], a[12:15], a[44:47], v[116:119]
ds_read_b64_tr_b16 a[78:79], v13 offset:57856
v_mfma_f32_16x16x32_bf16 v[48:51], a[0:3], a[48:51], v[48:51]
s_cmp_lg_u32 s94, 0
s_cbranch_scc1 L_nocsp
v_and_b32 v2, 16, v1
v_cmp_ne_u32 vcc, 0, v2
s_nop 1
v_cndmask_b32 v24, v128, v132, vcc
v_cndmask_b32 v25, v136, v140, vcc
v_cndmask_b32 v26, v144, v148, vcc
v_mov_b32 v27, s68
s_lshl_b32 s70, s64, 4
s_lshr_b32 s71, s65, 2
s_add_u32 s70, s70, s71
s_lshl_b32 s70, s70, 10
s_lshl_b32 s71, s67, 9
s_add_u32 s70, s70, s71
s_add_u32 s70, s70, 65536
s_mov_b64 exec, 0xffffffff
buffer_store_dwordx4 v[24:27], v16, s[12:15], s70 offen sc1
s_mov_b64 exec, -1
L_nocsp:
v_mfma_f32_16x16x32_bf16 v[72:75], a[4:7], a[48:51], v[72:75]
v_mfma_f32_16x16x32_bf16 v[96:99], a[8:11], a[48:51], v[96:99]
s_add_u32 s70, s88, 131072
buffer_store_dwordx4 v[28:31], v16, s[12:15], s70 offen sc1
v_mfma_f32_16x16x32_bf16 v[120:123], a[12:15], a[48:51], v[120:123]
v_mfma_f32_16x16x32_bf16 v[52:55], a[0:3], a[52:55], v[52:55]
s_add_u32 s70, s88, 196608
buffer_store_dwordx4 v[28:31], v16, s[12:15], s70 offen sc1
v_mfma_f32_16x16x32_bf16 v[76:79], a[4:7], a[52:55], v[76:79]
v_mfma_f32_16x16x32_bf16 v[100:103], a[8:11], a[52:55], v[100:103]
v_mfma_f32_16x16x32_bf16 v[124:127], a[12:15], a[52:55], v[124:127]
s_waitcnt lgkmcnt(0)
v_mfma_f32_16x16x32_bf16 v[32:35], a[56:59], a[16:19], v[32:35]
s_barrier
ds_read_b128 a[0:3], v10 offset:0
v_mfma_f32_16x16x32_bf16 v[56:59], a[56:59], a[20:23], v[56:59]
ds_read_b64_tr_b16 a[32:33], v12 offset:0
v_mfma_f32_16x16x32_bf16 v[80:83], a[56:59], a[24:27], v[80:83]
ds_read_b64_tr_b16 a[34:35], v12 offset:512
v_mfma_f32_16x16x32_bf16 v[104:107], a[56:59], a[28:31], v[104:107]
ds_read_b128 a[4:7], v10 offset:2048
v_mfma_f32_16x16x32_bf16 v[36:39], a[60:63], a[16:19], v[36:39]
ds_read_b128 a[8:11], v10 offset:4096
v_mfma_f32_16x16x32_bf16 v[60:63], a[60:63], a[20:23], v[60:63]
ds_read_b128 a[12:15], v10 offset:6144
v_mfma_f32_16x16x32_bf16 v[84:87], a[60:63], a[24:27], v[84:87]
ds_read_b64_tr_b16 a[36:37], v13 offset:0
v_mfma_f32_16x16x32_bf16 v[108:111], a[60:63], a[28:31], v[108:111]
ds_read_b64_tr_b16 a[38:39], v13 offset:512
v_mfma_f32_16x16x32_bf16 v[40:43], a[16:19], a[64:67], v[40:43]
ds_read_b64_tr_b16 a[40:41], v12 offset:2048
v_mfma_f32_16x16x32_bf16 v[64:67], a[20:23], a[64:67], v[64:67]
ds_read_b64_tr_b16 a[42:43], v12 offset:2560
v_mfma_f32_16x16x32_bf16 v[88:91], a[24:27], a[64:67], v[88:91]
ds_read_b64_tr_b16 a[44:45], v13 offset:2048
v_mfma_f32_16x16x32_bf16 v[112:115], a[28:31], a[64:67], v[112:115]
ds_read_b64_tr_b16 a[46:47], v13 offset:2560
v_mfma_f32_16x16x32_bf16 v[44:47], a[16:19], a[68:71], v[44:47]
ds_read_b64_tr_b16 a[48:49], v12 offset:4096
v_mfma_f32_16x16x32_bf16 v[68:71], a[20:23], a[68:71], v[68:71]
ds_read_b64_tr_b16 a[50:51], v12 offset:4608
v_mfma_f32_16x16x32_bf16 v[92:95], a[24:27], a[68:71], v[92:95]
ds_read_b64_tr_b16 a[52:53], v13 offset:4096
v_mfma_f32_16x16x32_bf16 v[116:119], a[28:31], a[68:71], v[116:119]
ds_read_b64_tr_b16 a[54:55], v13 offset:4608
v_mfma_f32_16x16x32_bf16 v[48:51], a[16:19], a[72:75], v[48:51]
v_mfma_f32_16x16x32_bf16 v[72:75], a[20:23], a[72:75], v[72:75]
v_mfma_f32_16x16x32_bf16 v[96:99], a[24:27], a[72:75], v[96:99]
v_mfma_f32_16x16x32_bf16 v[120:123], a[28:31], a[72:75], v[120:123]
v_mfma_f32_16x16x32_bf16 v[52:55], a[16:19], a[76:79], v[52:55]
v_mfma_f32_16x16x32_bf16 v[76:79], a[20:23], a[76:79], v[76:79]
v_mfma_f32_16x16x32_bf16 v[100:103], a[24:27], a[76:79], v[100:103]
v_mfma_f32_16x16x32_bf16 v[124:127], a[28:31], a[76:79], v[124:127]
s_waitcnt lgkmcnt(0)
v_mfma_f32_16x16x32_bf16 v[32:35], a[32:35], a[0:3], v[32:35]
ds_read_b128 a[16:19], v11 offset:0
v_mfma_f32_16x16x32_bf16 v[56:59], a[32:35], a[4:7], v[56:59]
ds_read_b64_tr_b16 a[56:57], v12 offset:12288
v_mfma_f32_16x16x32_bf16 v[80:83], a[32:35], a[8:11], v[80:83]
ds_read_b64_tr_b16 a[58:59], v12 offset:12800
v_mfma_f32_16x16x32_bf16 v[104:107], a[32:35], a[12:15], v[104:107]
ds_read_b128 a[20:23], v11 offset:2048
v_mfma_f32_16x16x32_bf16 v[36:39], a[36:39], a[0:3], v[36:39]
ds_read_b128 a[24:27], v11 offset:4096
v_mfma_f32_16x16x32_bf16 v[60:63], a[36:39], a[4:7], v[60:63]
ds_read_b128 a[28:31], v11 offset:6144
v_mfma_f32_16x16x32_bf16 v[84:87], a[36:39], a[8:11], v[84:87]
ds_read_b64_tr_b16 a[60:61], v13 offset:12288
v_mfma_f32_16x16x32_bf16 v[108:111], a[36:39], a[12:15], v[108:111]
ds_read_b64_tr_b16 a[62:63], v13 offset:12800
v_mfma_f32_16x16x32_bf16 v[40:43], a[0:3], a[40:43], v[40:43]
ds_read_b64_tr_b16 a[64:65], v12 offset:14336
v_mfma_f32_16x16x32_bf16 v[64:67], a[4:7], a[40:43], v[64:67]
ds_read_b64_tr_b16 a[66:67], v12 offset:14848
v_mfma_f32_16x16x32_bf16 v[88:91], a[8:11], a[40:43], v[88:91]
ds_read_b64_tr_b16 a[68:69], v13 offset:14336
v_mfma_f32_16x16x32_bf16 v[112:115], a[12:15], a[40:43], v[112:115]
ds_read_b64_tr_b16 a[70:71], v13 offset:14848
v_mfma_f32_16x16x32_bf16 v[44:47], a[0:3], a[44:47], v[44:47]
ds_read_b64_tr_b16 a[72:73], v12 offset:16384
v_mfma_f32_16x16x32_bf16 v[68:71], a[4:7], a[44:47], v[68:71]
ds_read_b64_tr_b16 a[74:75], v12 offset:16896
v_mfma_f32_16x16x32_bf16 v[92:95], a[8:11], a[44:47], v[92:95]
ds_read_b64_tr_b16 a[76:77], v13 offset:16384
v_mfma_f32_16x16x32_bf16 v[116:119], a[12:15], a[44:47], v[116:119]
ds_read_b64_tr_b16 a[78:79], v13 offset:16896
v_mfma_f32_16x16x32_bf16 v[48:51], a[0:3], a[48:51], v[48:51]
v_mfma_f32_16x16x32_bf16 v[72:75], a[4:7], a[48:51], v[72:75]
v_mfma_f32_16x16x32_bf16 v[96:99], a[8:11], a[48:51], v[96:99]
v_mfma_f32_16x16x32_bf16 v[120:123], a[12:15], a[48:51], v[120:123]
v_mfma_f32_16x16x32_bf16 v[52:55], a[0:3], a[52:55], v[52:55]
v_mfma_f32_16x16x32_bf16 v[76:79], a[4:7], a[52:55], v[76:79]
v_mfma_f32_16x16x32_bf16 v[100:103], a[8:11], a[52:55], v[100:103]
v_mfma_f32_16x16x32_bf16 v[124:127], a[12:15], a[52:55], v[124:127]
s_waitcnt lgkmcnt(0)
v_mfma_f32_16x16x32_bf16 v[32:35], a[56:59], a[16:19], v[32:35]
s_barrier
ds_read_b128 a[0:3], v8 offset:24576
v_mfma_f32_16x16x32_bf16 v[56:59], a[56:59], a[20:23], v[56:59]
ds_read_b64_tr_b16 a[32:33], v14 offset:16384
v_mfma_f32_16x16x32_bf16 v[80:83], a[56:59], a[24:27], v[80:83]
ds_read_b64_tr_b16 a[34:35], v14 offset:16896
v_mfma_f32_16x16x32_bf16 v[104:107], a[56:59], a[28:31], v[104:107]
ds_read_b128 a[4:7], v8 offset:26624
v_mfma_f32_16x16x32_bf16 v[36:39], a[60:63], a[16:19], v[36:39]
ds_read_b128 a[8:11], v8 offset:28672
v_mfma_f32_16x16x32_bf16 v[60:63], a[60:63], a[20:23], v[60:63]
ds_read_b128 a[12:15], v8 offset:30720
v_mfma_f32_16x16x32_bf16 v[84:87], a[60:63], a[24:27], v[84:87]
ds_read_b64_tr_b16 a[36:37], v15 offset:16384
v_mfma_f32_16x16x32_bf16 v[108:111], a[60:63], a[28:31], v[108:111]
ds_read_b64_tr_b16 a[38:39], v15 offset:16896
v_mfma_f32_16x16x32_bf16 v[40:43], a[16:19], a[64:67], v[40:43]
ds_read_b64_tr_b16 a[40:41], v14 offset:18432
v_mfma_f32_16x16x32_bf16 v[64:67], a[20:23], a[64:67], v[64:67]
ds_read_b64_tr_b16 a[42:43], v14 offset:18944
v_mfma_f32_16x16x32_bf16 v[88:91], a[24:27], a[64:67], v[88:91]
ds_read_b64_tr_b16 a[44:45], v15 offset:18432
v_mfma_f32_16x16x32_bf16 v[112:115], a[28:31], a[64:67], v[112:115]
ds_read_b64_tr_b16 a[46:47], v15 offset:18944
v_mfma_f32_16x16x32_bf16 v[44:47], a[16:19], a[68:71], v[44:47]
ds_read_b64_tr_b16 a[48:49], v14 offset:20480
v_mfma_f32_16x16x32_bf16 v[68:71], a[20:23], a[68:71], v[68:71]
ds_read_b64_tr_b16 a[50:51], v14 offset:20992
v_mfma_f32_16x16x32_bf16 v[92:95], a[24:27], a[68:71], v[92:95]
ds_read_b64_tr_b16 a[52:53], v15 offset:20480
v_mfma_f32_16x16x32_bf16 v[116:119], a[28:31], a[68:71], v[116:119]
ds_read_b64_tr_b16 a[54:55], v15 offset:20992
v_mfma_f32_16x16x32_bf16 v[48:51], a[16:19], a[72:75], v[48:51]
v_mfma_f32_16x16x32_bf16 v[72:75], a[20:23], a[72:75], v[72:75]
v_mfma_f32_16x16x32_bf16 v[96:99], a[24:27], a[72:75], v[96:99]
v_mfma_f32_16x16x32_bf16 v[120:123], a[28:31], a[72:75], v[120:123]
v_mfma_f32_16x16x32_bf16 v[52:55], a[16:19], a[76:79], v[52:55]
v_mfma_f32_16x16x32_bf16 v[76:79], a[20:23], a[76:79], v[76:79]
v_mfma_f32_16x16x32_bf16 v[100:103], a[24:27], a[76:79], v[100:103]
v_mfma_f32_16x16x32_bf16 v[124:127], a[28:31], a[76:79], v[124:127]
s_waitcnt lgkmcnt(0)
v_mfma_f32_16x16x32_bf16 v[32:35], a[32:35], a[0:3], v[32:35]
ds_read_b128 a[16:19], v9 offset:24576
v_mfma_f32_16x16x32_bf16 v[56:59], a[32:35], a[4:7], v[56:59]
ds_read_b64_tr_b16 a[56:57], v14 offset:28672
v_mfma_f32_16x16x32_bf16 v[80:83], a[32:35], a[8:11], v[80:83]
ds_read_b64_tr_b16 a[58:59], v14 offset:29184
v_mfma_f32_16x16x32_bf16 v[104:107], a[32:35], a[12:15], v[104:107]
ds_read_b128 a[20:23], v9 offset:26624
v_mfma_f32_16x16x32_bf16 v[36:39], a[36:39], a[0:3], v[36:39]
ds_read_b128 a[24:27], v9 offset:28672
v_mfma_f32_16x16x32_bf16 v[60:63], a[36:39], a[4:7], v[60:63]
ds_read_b128 a[28:31], v9 offset:30720
v_mfma_f32_16x16x32_bf16 v[84:87], a[36:39], a[8:11], v[84:87]
ds_read_b64_tr_b16 a[60:61], v15 offset:28672
v_mfma_f32_16x16x32_bf16 v[108:111], a[36:39], a[12:15], v[108:111]
ds_read_b64_tr_b16 a[62:63], v15 offset:29184
v_mfma_f32_16x16x32_bf16 v[40:43], a[0:3], a[40:43], v[40:43]
ds_read_b64_tr_b16 a[64:65], v14 offset:30720
v_mfma_f32_16x16x32_bf16 v[64:67], a[4:7], a[40:43], v[64:67]
ds_read_b64_tr_b16 a[66:67], v14 offset:31232
v_mfma_f32_16x16x32_bf16 v[88:91], a[8:11], a[40:43], v[88:91]
ds_read_b64_tr_b16 a[68:69], v15 offset:30720
v_mfma_f32_16x16x32_bf16 v[112:115], a[12:15], a[40:43], v[112:115]
ds_read_b64_tr_b16 a[70:71], v15 offset:31232
v_mfma_f32_16x16x32_bf16 v[44:47], a[0:3], a[44:47], v[44:47]
ds_read_b64_tr_b16 a[72:73], v14 offset:32768
v_mfma_f32_16x16x32_bf16 v[68:71], a[4:7], a[44:47], v[68:71]
ds_read_b64_tr_b16 a[74:75], v14 offset:33280
v_mfma_f32_16x16x32_bf16 v[92:95], a[8:11], a[44:47], v[92:95]
ds_read_b64_tr_b16 a[76:77], v15 offset:32768
v_mfma_f32_16x16x32_bf16 v[116:119], a[12:15], a[44:47], v[116:119]
ds_read_b64_tr_b16 a[78:79], v15 offset:33280
v_mfma_f32_16x16x32_bf16 v[48:51], a[0:3], a[48:51], v[48:51]
s_waitcnt vmcnt(0)
v_mfma_f32_16x16x32_bf16 v[72:75], a[4:7], a[48:51], v[72:75]
v_mfma_f32_16x16x32_bf16 v[96:99], a[8:11], a[48:51], v[96:99]
v_mfma_f32_16x16x32_bf16 v[120:123], a[12:15], a[48:51], v[120:123]
v_mfma_f32_16x16x32_bf16 v[52:55], a[0:3], a[52:55], v[52:55]
v_mfma_f32_16x16x32_bf16 v[76:79], a[4:7], a[52:55], v[76:79]
v_mfma_f32_16x16x32_bf16 v[100:103], a[8:11], a[52:55], v[100:103]
v_mfma_f32_16x16x32_bf16 v[124:127], a[12:15], a[52:55], v[124:127]
s_waitcnt lgkmcnt(0)
v_mfma_f32_16x16x32_bf16 v[32:35], a[56:59], a[16:19], v[32:35]
s_barrier
ds_read_b128 a[0:3], v10 offset:57344
v_mfma_f32_16x16x32_bf16 v[56:59], a[56:59], a[20:23], v[56:59]
ds_read_b64_tr_b16 a[32:33], v12 offset:40960
v_mfma_f32_16x16x32_bf16 v[80:83], a[56:59], a[24:27], v[80:83]
ds_read_b64_tr_b16 a[34:35], v12 offset:41472
v_mfma_f32_16x16x32_bf16 v[104:107], a[56:59], a[28:31], v[104:107]
ds_read_b128 a[4:7], v10 offset:59392
v_mfma_f32_16x16x32_bf16 v[36:39], a[60:63], a[16:19], v[36:39]
ds_read_b128 a[8:11], v10 offset:61440
v_mfma_f32_16x16x32_bf16 v[60:63], a[60:63], a[20:23], v[60:63]
ds_read_b128 a[12:15], v10 offset:63488
v_mfma_f32_16x16x32_bf16 v[84:87], a[60:63], a[24:27], v[84:87]
ds_read_b64_tr_b16 a[36:37], v13 offset:40960
v_mfma_f32_16x16x32_bf16 v[108:111], a[60:63], a[28:31], v[108:111]
ds_read_b64_tr_b16 a[38:39], v13 offset:41472
v_mfma_f32_16x16x32_bf16 v[40:43], a[16:19], a[64:67], v[40:43]
ds_read_b64_tr_b16 a[40:41], v12 offset:43008
v_mfma_f32_16x16x32_bf16 v[64:67], a[20:23], a[64:67], v[64:67]
ds_read_b64_tr_b16 a[42:43], v12 offset:43520
v_mfma_f32_16x16x32_bf16 v[88:91], a[24:27], a[64:67], v[88:91]
ds_read_b64_tr_b16 a[44:45], v13 offset:43008
v_mfma_f32_16x16x32_bf16 v[112:115], a[28:31], a[64:67], v[112:115]
ds_read_b64_tr_b16 a[46:47], v13 offset:43520
v_mfma_f32_16x16x32_bf16 v[44:47], a[16:19], a[68:71], v[44:47]
ds_read_b64_tr_b16 a[48:49], v12 offset:45056
v_mfma_f32_16x16x32_bf16 v[68:71], a[20:23], a[68:71], v[68:71]
ds_read_b64_tr_b16 a[50:51], v12 offset:45568
v_mfma_f32_16x16x32_bf16 v[92:95], a[24:27], a[68:71], v[92:95]
ds_read_b64_tr_b16 a[52:53], v13 offset:45056
v_mfma_f32_16x16x32_bf16 v[116:119], a[28:31], a[68:71], v[116:119]
ds_read_b64_tr_b16 a[54:55], v13 offset:45568
v_mfma_f32_16x16x32_bf16 v[48:51], a[16:19], a[72:75], v[48:51]
v_mfma_f32_16x16x32_bf16 v[72:75], a[20:23], a[72:75], v[72:75]
v_mfma_f32_16x16x32_bf16 v[96:99], a[24:27], a[72:75], v[96:99]
v_mfma_f32_16x16x32_bf16 v[120:123], a[28:31], a[72:75], v[120:123]
v_mfma_f32_16x16x32_bf16 v[52:55], a[16:19], a[76:79], v[52:55]
v_mfma_f32_16x16x32_bf16 v[76:79], a[20:23], a[76:79], v[76:79]
v_mfma_f32_16x16x32_bf16 v[100:103], a[24:27], a[76:79], v[100:103]
v_mfma_f32_16x16x32_bf16 v[124:127], a[28:31], a[76:79], v[124:127]
s_waitcnt lgkmcnt(0)
v_mfma_f32_16x16x32_bf16 v[32:35], a[32:35], a[0:3], v[32:35]
ds_read_b128 a[16:19], v11 offset:57344
v_mfma_f32_16x16x32_bf16 v[56:59], a[32:35], a[4:7], v[56:59]
ds_read_b64_tr_b16 a[56:57], v12 offset:53248
v_mfma_f32_16x16x32_bf16 v[80:83], a[32:35], a[8:11], v[80:83]
ds_read_b64_tr_b16 a[58:59], v12 offset:53760
v_mfma_f32_16x16x32_bf16 v[104:107], a[32:35], a[12:15], v[104:107]
ds_read_b128 a[20:23], v11 offset:59392
v_mfma_f32_16x16x32_bf16 v[36:39], a[36:39], a[0:3], v[36:39]
ds_read_b128 a[24:27], v11 offset:61440
v_mfma_f32_16x16x32_bf16 v[60:63], a[36:39], a[4:7], v[60:63]
ds_read_b128 a[28:31], v11 offset:63488
v_mfma_f32_16x16x32_bf16 v[84:87], a[36:39], a[8:11], v[84:87]
ds_read_b64_tr_b16 a[60:61], v13 offset:53248
v_mfma_f32_16x16x32_bf16 v[108:111], a[36:39], a[12:15], v[108:111]
ds_read_b64_tr_b16 a[62:63], v13 offset:53760
v_mfma_f32_16x16x32_bf16 v[40:43], a[0:3], a[40:43], v[40:43]
ds_read_b64_tr_b16 a[64:65], v12 offset:55296
v_mfma_f32_16x16x32_bf16 v[64:67], a[4:7], a[40:43], v[64:67]
ds_read_b64_tr_b16 a[66:67], v12 offset:55808
v_mfma_f32_16x16x32_bf16 v[88:91], a[8:11], a[40:43], v[88:91]
ds_read_b64_tr_b16 a[68:69], v13 offset:55296
v_mfma_f32_16x16x32_bf16 v[112:115], a[12:15], a[40:43], v[112:115]
ds_read_b64_tr_b16 a[70:71], v13 offset:55808
v_mfma_f32_16x16x32_bf16 v[44:47], a[0:3], a[44:47], v[44:47]
ds_read_b64_tr_b16 a[72:73], v12 offset:57344
v_mfma_f32_16x16x32_bf16 v[68:71], a[4:7], a[44:47], v[68:71]
ds_read_b64_tr_b16 a[74:75], v12 offset:57856
v_mfma_f32_16x16x32_bf16 v[92:95], a[8:11], a[44:47], v[92:95]
ds_read_b64_tr_b16 a[76:77], v13 offset:57344
v_mfma_f32_16x16x32_bf16 v[116:119], a[12:15], a[44:47], v[116:119]
ds_read_b64_tr_b16 a[78:79], v13 offset:57856
v_mfma_f32_16x16x32_bf16 v[48:51], a[0:3], a[48:51], v[48:51]
v_mfma_f32_16x16x32_bf16 v[72:75], a[4:7], a[48:51], v[72:75]
v_mfma_f32_16x16x32_bf16 v[96:99], a[8:11], a[48:51], v[96:99]
v_mfma_f32_16x16x32_bf16 v[120:123], a[12:15], a[48:51], v[120:123]
v_mfma_f32_16x16x32_bf16 v[52:55], a[0:3], a[52:55], v[52:55]
v_mfma_f32_16x16x32_bf16 v[76:79], a[4:7], a[52:55], v[76:79]
v_mfma_f32_16x16x32_bf16 v[100:103], a[8:11], a[52:55], v[100:103]
v_mfma_f32_16x16x32_bf16 v[124:127], a[12:15], a[52:55], v[124:127]
s_waitcnt lgkmcnt(0)
v_mfma_f32_16x16x32_bf16 v[32:35], a[56:59], a[16:19], v[32:35]
s_barrier
ds_read_b128 a[0:3], v10 offset:40960
v_mfma_f32_16x16x32_bf16 v[56:59], a[56:59], a[20:23], v[56:59]
ds_read_b64_tr_b16 a[32:33], v12 offset:0
v_mfma_f32_16x16x32_bf16 v[80:83], a[56:59], a[24:27], v[80:83]
ds_read_b64_tr_b16 a[34:35], v12 offset:512
v_mfma_f32_16x16x32_bf16 v[104:107], a[56:59], a[28:31], v[104:107]
ds_read_b128 a[4:7], v10 offset:43008
v_mfma_f32_16x16x32_bf16 v[36:39], a[60:63], a[16:19], v[36:39]
ds_read_b128 a[8:11], v10 offset:45056
v_mfma_f32_16x16x32_bf16 v[60:63], a[60:63], a[20:23], v[60:63]
ds_read_b128 a[12:15], v10 offset:47104
v_mfma_f32_16x16x32_bf16 v[84:87], a[60:63], a[24:27], v[84:87]
ds_read_b64_tr_b16 a[36:37], v13 offset:0
v_mfma_f32_16x16x32_bf16 v[108:111], a[60:63], a[28:31], v[108:111]
ds_read_b64_tr_b16 a[38:39], v13 offset:512
v_mfma_f32_16x16x32_bf16 v[40:43], a[16:19], a[64:67], v[40:43]
ds_read_b64_tr_b16 a[40:41], v12 offset:2048
v_mfma_f32_16x16x32_bf16 v[64:67], a[20:23], a[64:67], v[64:67]
ds_read_b64_tr_b16 a[42:43], v12 offset:2560
v_mfma_f32_16x16x32_bf16 v[88:91], a[24:27], a[64:67], v[88:91]
ds_read_b64_tr_b16 a[44:45], v13 offset:2048
v_mfma_f32_16x16x32_bf16 v[112:115], a[28:31], a[64:67], v[112:115]
ds_read_b64_tr_b16 a[46:47], v13 offset:2560
v_mfma_f32_16x16x32_bf16 v[44:47], a[16:19], a[68:71], v[44:47]
ds_read_b64_tr_b16 a[48:49], v12 offset:4096
v_mfma_f32_16x16x32_bf16 v[68:71], a[20:23], a[68:71], v[68:71]
ds_read_b64_tr_b16 a[50:51], v12 offset:4608
v_mfma_f32_16x16x32_bf16 v[92:95], a[24:27], a[68:71], v[92:95]
ds_read_b64_tr_b16 a[52:53], v13 offset:4096
v_mfma_f32_16x16x32_bf16 v[116:119], a[28:31], a[68:71], v[116:119]
ds_read_b64_tr_b16 a[54:55], v13 offset:4608
v_mfma_f32_16x16x32_bf16 v[48:51], a[16:19], a[72:75], v[48:51]
v_mfma_f32_16x16x32_bf16 v[72:75], a[20:23], a[72:75], v[72:75]
v_mfma_f32_16x16x32_bf16 v[96:99], a[24:27], a[72:75], v[96:99]
v_mfma_f32_16x16x32_bf16 v[120:123], a[28:31], a[72:75], v[120:123]
v_mfma_f32_16x16x32_bf16 v[52:55], a[16:19], a[76:79], v[52:55]
v_mfma_f32_16x16x32_bf16 v[76:79], a[20:23], a[76:79], v[76:79]
v_mfma_f32_16x16x32_bf16 v[100:103], a[24:27], a[76:79], v[100:103]
v_mfma_f32_16x16x32_bf16 v[124:127], a[28:31], a[76:79], v[124:127]
s_waitcnt lgkmcnt(0)
v_mfma_f32_16x16x32_bf16 v[32:35], a[32:35], a[0:3], v[32:35]
ds_read_b128 a[16:19], v11 offset:40960
v_mfma_f32_16x16x32_bf16 v[56:59], a[32:35], a[4:7], v[56:59]
ds_read_b64_tr_b16 a[56:57], v12 offset:12288
v_mfma_f32_16x16x32_bf16 v[80:83], a[32:35], a[8:11], v[80:83]
ds_read_b64_tr_b16 a[58:59], v12 offset:12800
v_mfma_f32_16x16x32_bf16 v[104:107], a[32:35], a[12:15], v[104:107]
ds_read_b128 a[20:23], v11 offset:43008
v_mfma_f32_16x16x32_bf16 v[36:39], a[36:39], a[0:3], v[36:39]
ds_read_b128 a[24:27], v11 offset:45056
v_mfma_f32_16x16x32_bf16 v[60:63], a[36:39], a[4:7], v[60:63]
ds_read_b128 a[28:31], v11 offset:47104
v_mfma_f32_16x16x32_bf16 v[84:87], a[36:39], a[8:11], v[84:87]
ds_read_b64_tr_b16 a[60:61], v13 offset:12288
v_mfma_f32_16x16x32_bf16 v[108:111], a[36:39], a[12:15], v[108:111]
ds_read_b64_tr_b16 a[62:63], v13 offset:12800
v_mfma_f32_16x16x32_bf16 v[40:43], a[0:3], a[40:43], v[40:43]
ds_read_b64_tr_b16 a[64:65], v12 offset:14336
v_mfma_f32_16x16x32_bf16 v[64:67], a[4:7], a[40:43], v[64:67]
ds_read_b64_tr_b16 a[66:67], v12 offset:14848
v_mfma_f32_16x16x32_bf16 v[88:91], a[8:11], a[40:43], v[88:91]
ds_read_b64_tr_b16 a[68:69], v13 offset:14336
v_mfma_f32_16x16x32_bf16 v[112:115], a[12:15], a[40:43], v[112:115]
ds_read_b64_tr_b16 a[70:71], v13 offset:14848
v_mfma_f32_16x16x32_bf16 v[44:47], a[0:3], a[44:47], v[44:47]
ds_read_b64_tr_b16 a[72:73], v12 offset:16384
v_mfma_f32_16x16x32_bf16 v[68:71], a[4:7], a[44:47], v[68:71]
ds_read_b64_tr_b16 a[74:75], v12 offset:16896
v_mfma_f32_16x16x32_bf16 v[92:95], a[8:11], a[44:47], v[92:95]
ds_read_b64_tr_b16 a[76:77], v13 offset:16384
v_mfma_f32_16x16x32_bf16 v[116:119], a[12:15], a[44:47], v[116:119]
ds_read_b64_tr_b16 a[78:79], v13 offset:16896
v_mfma_f32_16x16x32_bf16 v[48:51], a[0:3], a[48:51], v[48:51]
v_mfma_f32_16x16x32_bf16 v[72:75], a[4:7], a[48:51], v[72:75]
v_mfma_f32_16x16x32_bf16 v[96:99], a[8:11], a[48:51], v[96:99]
v_mfma_f32_16x16x32_bf16 v[120:123], a[12:15], a[48:51], v[120:123]
v_mfma_f32_16x16x32_bf16 v[52:55], a[0:3], a[52:55], v[52:55]
v_mfma_f32_16x16x32_bf16 v[76:79], a[4:7], a[52:55], v[76:79]
v_mfma_f32_16x16x32_bf16 v[100:103], a[8:11], a[52:55], v[100:103]
v_mfma_f32_16x16x32_bf16 v[124:127], a[12:15], a[52:55], v[124:127]
s_waitcnt lgkmcnt(0)
v_mfma_f32_16x16x32_bf16 v[32:35], a[56:59], a[16:19], v[32:35]
s_barrier
ds_read_b128 a[0:3], v10 offset:0
v_mfma_f32_16x16x32_bf16 v[56:59], a[56:59], a[20:23], v[56:59]
ds_read_b64_tr_b16 a[32:33], v14 offset:16384
v_mfma_f32_16x16x32_bf16 v[80:83], a[56:59], a[24:27], v[80:83]
ds_read_b64_tr_b16 a[34:35], v14 offset:16896
v_mfma_f32_16x16x32_bf16 v[104:107], a[56:59], a[28:31], v[104:107]
ds_read_b128 a[4:7], v10 offset:2048
v_mfma_f32_16x16x32_bf16 v[36:39], a[60:63], a[16:19], v[36:39]
s_branch L_over4
L_pad4:
s_branch L_ret4
L_over4:
ds_read_b128 a[8:11], v10 offset:4096
v_mfma_f32_16x16x32_bf16 v[60:63], a[60:63], a[20:23], v[60:63]
ds_read_b128 a[12:15], v10 offset:6144
v_mfma_f32_16x16x32_bf16 v[84:87], a[60:63], a[24:27], v[84:87]
ds_read_b64_tr_b16 a[36:37], v15 offset:16384
v_mfma_f32_16x16x32_bf16 v[108:111], a[60:63], a[28:31], v[108:111]
ds_read_b64_tr_b16 a[38:39], v15 offset:16896
v_mfma_f32_16x16x32_bf16 v[40:43], a[16:19], a[64:67], v[40:43]
ds_read_b64_tr_b16 a[40:41], v14 offset:18432
v_mfma_f32_16x16x32_bf16 v[64:67], a[20:23], a[64:67], v[64:67]
ds_read_b64_tr_b16 a[42:43], v14 offset:18944
v_mfma_f32_16x16x32_bf16 v[88:91], a[24:27], a[64:67], v[88:91]
ds_read_b64_tr_b16 a[44:45], v15 offset:18432
v_mfma_f32_16x16x32_bf16 v[112:115], a[28:31], a[64:67], v[112:115]
ds_read_b64_tr_b16 a[46:47], v15 offset:18944
v_mfma_f32_16x16x32_bf16 v[44:47], a[16:19], a[68:71], v[44:47]
ds_read_b64_tr_b16 a[48:49], v14 offset:20480
v_mfma_f32_16x16x32_bf16 v[68:71], a[20:23], a[68:71], v[68:71]
ds_read_b64_tr_b16 a[50:51], v14 offset:20992
v_mfma_f32_16x16x32_bf16 v[92:95], a[24:27], a[68:71], v[92:95]
ds_read_b64_tr_b16 a[52:53], v15 offset:20480
v_mfma_f32_16x16x32_bf16 v[116:119], a[28:31], a[68:71], v[116:119]
ds_read_b64_tr_b16 a[54:55], v15 offset:20992
v_mfma_f32_16x16x32_bf16 v[48:51], a[16:19], a[72:75], v[48:51]
v_mfma_f32_16x16x32_bf16 v[72:75], a[20:23], a[72:75], v[72:75]
v_mfma_f32_16x16x32_bf16 v[96:99], a[24:27], a[72:75], v[96:99]
v_mfma_f32_16x16x32_bf16 v[120:123], a[28:31], a[72:75], v[120:123]
v_mfma_f32_16x16x32_bf16 v[52:55], a[16:19], a[76:79], v[52:55]
v_mfma_f32_16x16x32_bf16 v[76:79], a[20:23], a[76:79], v[76:79]
v_mfma_f32_16x16x32_bf16 v[100:103], a[24:27], a[76:79], v[100:103]
v_mfma_f32_16x16x32_bf16 v[124:127], a[28:31], a[76:79], v[124:127]
s_waitcnt lgkmcnt(0)
v_mfma_f32_16x16x32_bf16 v[32:35], a[32:35], a[0:3], v[32:35]
ds_read_b128 a[16:19], v11 offset:0
v_mfma_f32_16x16x32_bf16 v[56:59], a[32:35], a[4:7], v[56:59]
ds_read_b64_tr_b16 a[56:57], v14 offset:28672
v_mfma_f32_16x16x32_bf16 v[80:83], a[32:35], a[8:11], v[80:83]
ds_read_b64_tr_b16 a[58:59], v14 offset:29184
v_mfma_f32_16x16x32_bf16 v[104:107], a[32:35], a[12:15], v[104:107]
ds_read_b128 a[20:23], v11 offset:2048
v_mfma_f32_16x16x32_bf16 v[36:39], a[36:39], a[0:3], v[36:39]
ds_read_b128 a[24:27], v11 offset:4096
v_mfma_f32_16x16x32_bf16 v[60:63], a[36:39], a[4:7], v[60:63]
ds_read_b128 a[28:31], v11 offset:6144
v_mfma_f32_16x16x32_bf16 v[84:87], a[36:39], a[8:11], v[84:87]
ds_read_b64_tr_b16 a[60:61], v15 offset:28672
v_mfma_f32_16x16x32_bf16 v[108:111], a[36:39], a[12:15], v[108:111]
ds_read_b64_tr_b16 a[62:63], v15 offset:29184
v_mfma_f32_16x16x32_bf16 v[40:43], a[0:3], a[40:43], v[40:43]
ds_read_b64_tr_b16 a[64:65], v14 offset:30720
v_mfma_f32_16x16x32_bf16 v[64:67], a[4:7], a[40:43], v[64:67]
ds_read_b64_tr_b16 a[66:67], v14 offset:31232
v_mfma_f32_16x16x32_bf16 v[88:91], a[8:11], a[40:43], v[88:91]
ds_read_b64_tr_b16 a[68:69], v15 offset:30720
v_mfma_f32_16x16x32_bf16 v[112:115], a[12:15], a[40:43], v[112:115]
ds_read_b64_tr_b16 a[70:71], v15 offset:31232
v_mfma_f32_16x16x32_bf16 v[44:47], a[0:3], a[44:47], v[44:47]
ds_read_b64_tr_b16 a[72:73], v14 offset:32768
v_mfma_f32_16x16x32_bf16 v[68:71], a[4:7], a[44:47], v[68:71]
ds_read_b64_tr_b16 a[74:75], v14 offset:33280
v_mfma_f32_16x16x32_bf16 v[92:95], a[8:11], a[44:47], v[92:95]
ds_read_b64_tr_b16 a[76:77], v15 offset:32768
v_mfma_f32_16x16x32_bf16 v[116:119], a[12:15], a[44:47], v[116:119]
ds_read_b64_tr_b16 a[78:79], v15 offset:33280
v_mfma_f32_16x16x32_bf16 v[48:51], a[0:3], a[48:51], v[48:51]
v_mfma_f32_16x16x32_bf16 v[72:75], a[4:7], a[48:51], v[72:75]
v_mfma_f32_16x16x32_bf16 v[96:99], a[8:11], a[48:51], v[96:99]
v_mfma_f32_16x16x32_bf16 v[120:123], a[12:15], a[48:51], v[120:123]
v_mfma_f32_16x16x32_bf16 v[52:55], a[0:3], a[52:55], v[52:55]
v_mfma_f32_16x16x32_bf16 v[76:79], a[4:7], a[52:55], v[76:79]
v_mfma_f32_16x16x32_bf16 v[100:103], a[8:11], a[52:55], v[100:103]
v_mfma_f32_16x16x32_bf16 v[124:127], a[12:15], a[52:55], v[124:127]
s_waitcnt lgkmcnt(0)
v_mfma_f32_16x16x32_bf16 v[32:35], a[56:59], a[16:19], v[32:35]
s_barrier
ds_read_b128 a[0:3], v8 offset:24576
v_mfma_f32_16x16x32_bf16 v[56:59], a[56:59], a[20:23], v[56:59]
ds_read_b64_tr_b16 a[32:33], v12 offset:40960
v_mfma_f32_16x16x32_bf16 v[80:83], a[56:59], a[24:27], v[80:83]
ds_read_b64_tr_b16 a[34:35], v12 offset:41472
v_mfma_f32_16x16x32_bf16 v[104:107], a[56:59], a[28:31], v[104:107]
ds_read_b128 a[4:7], v8 offset:26624
v_mfma_f32_16x16x32_bf16 v[36:39], a[60:63], a[16:19], v[36:39]
ds_read_b128 a[8:11], v8 offset:28672
v_mfma_f32_16x16x32_bf16 v[60:63], a[60:63], a[20:23], v[60:63]
ds_read_b128 a[12:15], v8 offset:30720
v_mfma_f32_16x16x32_bf16 v[84:87], a[60:63], a[24:27], v[84:87]
ds_read_b64_tr_b16 a[36:37], v13 offset:40960
v_mfma_f32_16x16x32_bf16 v[108:111], a[60:63], a[28:31], v[108:111]
ds_read_b64_tr_b16 a[38:39], v13 offset:41472
v_mfma_f32_16x16x32_bf16 v[40:43], a[16:19], a[64:67], v[40:43]
ds_read_b64_tr_b16 a[40:41], v12 offset:43008
v_mfma_f32_16x16x32_bf16 v[64:67], a[20:23], a[64:67], v[64:67]
ds_read_b64_tr_b16 a[42:43], v12 offset:43520
v_mfma_f32_16x16x32_bf16 v[88:91], a[24:27], a[64:67], v[88:91]
ds_read_b64_tr_b16 a[44:45], v13 offset:43008
v_mfma_f32_16x16x32_bf16 v[112:115], a[28:31], a[64:67], v[112:115]
ds_read_b64_tr_b16 a[46:47], v13 offset:43520
v_mfma_f32_16x16x32_bf16 v[44:47], a[16:19], a[68:71], v[44:47]
ds_read_b64_tr_b16 a[48:49], v12 offset:45056
v_mfma_f32_16x16x32_bf16 v[68:71], a[20:23], a[68:71], v[68:71]
ds_read_b64_tr_b16 a[50:51], v12 offset:45568
v_mfma_f32_16x16x32_bf16 v[92:95], a[24:27], a[68:71], v[92:95]
ds_read_b64_tr_b16 a[52:53], v13 offset:45056
v_mfma_f32_16x16x32_bf16 v[116:119], a[28:31], a[68:71], v[116:119]
ds_read_b64_tr_b16 a[54:55], v13 offset:45568
v_mfma_f32_16x16x32_bf16 v[48:51], a[16:19], a[72:75], v[48:51]
v_mfma_f32_16x16x32_bf16 v[72:75], a[20:23], a[72:75], v[72:75]
v_mfma_f32_16x16x32_bf16 v[96:99], a[24:27], a[72:75], v[96:99]
v_mfma_f32_16x16x32_bf16 v[120:123], a[28:31], a[72:75], v[120:123]
v_mfma_f32_16x16x32_bf16 v[52:55], a[16:19], a[76:79], v[52:55]
v_mfma_f32_16x16x32_bf16 v[76:79], a[20:23], a[76:79], v[76:79]
v_mfma_f32_16x16x32_bf16 v[100:103], a[24:27], a[76:79], v[100:103]
v_mfma_f32_16x16x32_bf16 v[124:127], a[28:31], a[76:79], v[124:127]
s_waitcnt lgkmcnt(0)
v_mfma_f32_16x16x32_bf16 v[32:35], a[32:35], a[0:3], v[32:35]
ds_read_b128 a[16:19], v9 offset:24576
v_mfma_f32_16x16x32_bf16 v[56:59], a[32:35], a[4:7], v[56:59]
ds_read_b64_tr_b16 a[56:57], v12 offset:53248
v_mfma_f32_16x16x32_bf16 v[80:83], a[32:35], a[8:11], v[80:83]
ds_read_b64_tr_b16 a[58:59], v12 offset:53760
v_mfma_f32_16x16x32_bf16 v[104:107], a[32:35], a[12:15], v[104:107]
ds_read_b128 a[20:23], v9 offset:26624
v_mfma_f32_16x16x32_bf16 v[36:39], a[36:39], a[0:3], v[36:39]
ds_read_b128 a[24:27], v9 offset:28672
v_mfma_f32_16x16x32_bf16 v[60:63], a[36:39], a[4:7], v[60:63]
ds_read_b128 a[28:31], v9 offset:30720
v_mfma_f32_16x16x32_bf16 v[84:87], a[36:39], a[8:11], v[84:87]
ds_read_b64_tr_b16 a[60:61], v13 offset:53248
v_mfma_f32_16x16x32_bf16 v[108:111], a[36:39], a[12:15], v[108:111]
ds_read_b64_tr_b16 a[62:63], v13 offset:53760
v_mfma_f32_16x16x32_bf16 v[40:43], a[0:3], a[40:43], v[40:43]
ds_read_b64_tr_b16 a[64:65], v12 offset:55296
v_mfma_f32_16x16x32_bf16 v[64:67], a[4:7], a[40:43], v[64:67]
ds_read_b64_tr_b16 a[66:67], v12 offset:55808
v_mfma_f32_16x16x32_bf16 v[88:91], a[8:11], a[40:43], v[88:91]
ds_read_b64_tr_b16 a[68:69], v13 offset:55296
v_mfma_f32_16x16x32_bf16 v[112:115], a[12:15], a[40:43], v[112:115]
ds_read_b64_tr_b16 a[70:71], v13 offset:55808
v_mfma_f32_16x16x32_bf16 v[44:47], a[0:3], a[44:47], v[44:47]
ds_read_b64_tr_b16 a[72:73], v12 offset:57344
v_mfma_f32_16x16x32_bf16 v[68:71], a[4:7], a[44:47], v[68:71]
ds_read_b64_tr_b16 a[74:75], v12 offset:57856
v_mfma_f32_16x16x32_bf16 v[92:95], a[8:11], a[44:47], v[92:95]
ds_read_b64_tr_b16 a[76:77], v13 offset:57344
v_mfma_f32_16x16x32_bf16 v[116:119], a[12:15], a[44:47], v[116:119]
ds_read_b64_tr_b16 a[78:79], v13 offset:57856
v_mfma_f32_16x16x32_bf16 v[48:51], a[0:3], a[48:51], v[48:51]
v_mfma_f32_16x16x32_bf16 v[72:75], a[4:7], a[48:51], v[72:75]
v_mfma_f32_16x16x32_bf16 v[96:99], a[8:11], a[48:51], v[96:99]
v_mfma_f32_16x16x32_bf16 v[120:123], a[12:15], a[48:51], v[120:123]
v_mfma_f32_16x16x32_bf16 v[52:55], a[0:3], a[52:55], v[52:55]
v_mfma_f32_16x16x32_bf16 v[76:79], a[4:7], a[52:55], v[76:79]
v_mfma_f32_16x16x32_bf16 v[100:103], a[8:11], a[52:55], v[100:103]
v_mfma_f32_16x16x32_bf16 v[124:127], a[12:15], a[52:55], v[124:127]
s_waitcnt lgkmcnt(0)
v_mfma_f32_16x16x32_bf16 v[32:35], a[56:59], a[16:19], v[32:35]
s_barrier
ds_read_b128 a[0:3], v10 offset:57344
v_mfma_f32_16x16x32_bf16 v[56:59], a[56:59], a[20:23], v[56:59]
ds_read_b64_tr_b16 a[32:33], v12 offset:0
v_mfma_f32_16x16x32_bf16 v[80:83], a[56:59], a[24:27], v[80:83]
ds_read_b64_tr_b16 a[34:35], v12 offset:512
v_mfma_f32_16x16x32_bf16 v[104:107], a[56:59], a[28:31], v[104:107]
ds_read_b128 a[4:7], v10 offset:59392
v_mfma_f32_16x16x32_bf16 v[36:39], a[60:63], a[16:19], v[36:39]
ds_read_b128 a[8:11], v10 offset:61440
v_mfma_f32_16x16x32_bf16 v[60:63], a[60:63], a[20:23], v[60:63]
ds_read_b128 a[12:15], v10 offset:63488
v_mfma_f32_16x16x32_bf16 v[84:87], a[60:63], a[24:27], v[84:87]
ds_read_b64_tr_b16 a[36:37], v13 offset:0
v_mfma_f32_16x16x32_bf16 v[108:111], a[60:63], a[28:31], v[108:111]
ds_read_b64_tr_b16 a[38:39], v13 offset:512
v_mfma_f32_16x16x32_bf16 v[40:43], a[16:19], a[64:67], v[40:43]
ds_read_b64_tr_b16 a[40:41], v12 offset:2048
v_mfma_f32_16x16x32_bf16 v[64:67], a[20:23], a[64:67], v[64:67]
ds_read_b64_tr_b16 a[42:43], v12 offset:2560
v_mfma_f32_16x16x32_bf16 v[88:91], a[24:27], a[64:67], v[88:91]
ds_read_b64_tr_b16 a[44:45], v13 offset:2048
v_mfma_f32_16x16x32_bf16 v[112:115], a[28:31], a[64:67], v[112:115]
ds_read_b64_tr_b16 a[46:47], v13 offset:2560
v_mfma_f32_16x16x32_bf16 v[44:47], a[16:19], a[68:71], v[44:47]
ds_read_b64_tr_b16 a[48:49], v12 offset:4096
v_mfma_f32_16x16x32_bf16 v[68:71], a[20:23], a[68:71], v[68:71]
ds_read_b64_tr_b16 a[50:51], v12 offset:4608
v_mfma_f32_16x16x32_bf16 v[92:95], a[24:27], a[68:71], v[92:95]
ds_read_b64_tr_b16 a[52:53], v13 offset:4096
v_mfma_f32_16x16x32_bf16 v[116:119], a[28:31], a[68:71], v[116:119]
ds_read_b64_tr_b16 a[54:55], v13 offset:4608
v_mfma_f32_16x16x32_bf16 v[48:51], a[16:19], a[72:75], v[48:51]
v_mfma_f32_16x16x32_bf16 v[72:75], a[20:23], a[72:75], v[72:75]
v_mfma_f32_16x16x32_bf16 v[96:99], a[24:27], a[72:75], v[96:99]
v_mfma_f32_16x16x32_bf16 v[120:123], a[28:31], a[72:75], v[120:123]
v_mfma_f32_16x16x32_bf16 v[52:55], a[16:19], a[76:79], v[52:55]
v_mfma_f32_16x16x32_bf16 v[76:79], a[20:23], a[76:79], v[76:79]
v_mfma_f32_16x16x32_bf16 v[100:103], a[24:27], a[76:79], v[100:103]
v_mfma_f32_16x16x32_bf16 v[124:127], a[28:31], a[76:79], v[124:127]
s_waitcnt lgkmcnt(0)
v_mfma_f32_16x16x32_bf16 v[32:35], a[32:35], a[0:3], v[32:35]
ds_read_b128 a[16:19], v11 offset:57344
v_mfma_f32_16x16x32_bf16 v[56:59], a[32:35], a[4:7], v[56:59]
ds_read_b64_tr_b16 a[56:57], v12 offset:12288
v_mfma_f32_16x16x32_bf16 v[80:83], a[32:35], a[8:11], v[80:83]
ds_read_b64_tr_b16 a[58:59], v12 offset:12800
v_mfma_f32_16x16x32_bf16 v[104:107], a[32:35], a[12:15], v[104:107]
ds_read_b128 a[20:23], v11 offset:59392
v_mfma_f32_16x16x32_bf16 v[36:39], a[36:39], a[0:3], v[36:39]
ds_read_b128 a[24:27], v11 offset:61440
v_mfma_f32_16x16x32_bf16 v[60:63], a[36:39], a[4:7], v[60:63]
ds_read_b128 a[28:31], v11 offset:63488
v_mfma_f32_16x16x32_bf16 v[84:87], a[36:39], a[8:11], v[84:87]
ds_read_b64_tr_b16 a[60:61], v13 offset:12288
v_mfma_f32_16x16x32_bf16 v[108:111], a[36:39], a[12:15], v[108:111]
ds_read_b64_tr_b16 a[62:63], v13 offset:12800
v_mfma_f32_16x16x32_bf16 v[40:43], a[0:3], a[40:43], v[40:43]
ds_read_b64_tr_b16 a[64:65], v12 offset:14336
v_mfma_f32_16x16x32_bf16 v[64:67], a[4:7], a[40:43], v[64:67]
ds_read_b64_tr_b16 a[66:67], v12 offset:14848
v_mfma_f32_16x16x32_bf16 v[88:91], a[8:11], a[40:43], v[88:91]
ds_read_b64_tr_b16 a[68:69], v13 offset:14336
v_mfma_f32_16x16x32_bf16 v[112:115], a[12:15], a[40:43], v[112:115]
ds_read_b64_tr_b16 a[70:71], v13 offset:14848
v_mfma_f32_16x16x32_bf16 v[44:47], a[0:3], a[44:47], v[44:47]
ds_read_b64_tr_b16 a[72:73], v12 offset:16384
v_mfma_f32_16x16x32_bf16 v[68:71], a[4:7], a[44:47], v[68:71]
ds_read_b64_tr_b16 a[74:75], v12 offset:16896
v_mfma_f32_16x16x32_bf16 v[92:95], a[8:11], a[44:47], v[92:95]
ds_read_b64_tr_b16 a[76:77], v13 offset:16384
v_mfma_f32_16x16x32_bf16 v[116:119], a[12:15], a[44:47], v[116:119]
ds_read_b64_tr_b16 a[78:79], v13 offset:16896
v_mfma_f32_16x16x32_bf16 v[48:51], a[0:3], a[48:51], v[48:51]
v_mfma_f32_16x16x32_bf16 v[72:75], a[4:7], a[48:51], v[72:75]
v_mfma_f32_16x16x32_bf16 v[96:99], a[8:11], a[48:51], v[96:99]
v_mfma_f32_16x16x32_bf16 v[120:123], a[12:15], a[48:51], v[120:123]
v_mfma_f32_16x16x32_bf16 v[52:55], a[0:3], a[52:55], v[52:55]
v_mfma_f32_16x16x32_bf16 v[76:79], a[4:7], a[52:55], v[76:79]
v_mfma_f32_16x16x32_bf16 v[100:103], a[8:11], a[52:55], v[100:103]
v_mfma_f32_16x16x32_bf16 v[124:127], a[12:15], a[52:55], v[124:127]
s_waitcnt lgkmcnt(0)
v_mfma_f32_16x16x32_bf16 v[32:35], a[56:59], a[16:19], v[32:35]
s_barrier
ds_read_b128 a[0:3], v10 offset:40960
v_mfma_f32_16x16x32_bf16 v[56:59], a[56:59], a[20:23], v[56:59]
ds_read_b64_tr_b16 a[32:33], v14 offset:16384
v_mfma_f32_16x16x32_bf16 v[80:83], a[56:59], a[24:27], v[80:83]
ds_read_b64_tr_b16 a[34:35], v14 offset:16896
v_mfma_f32_16x16x32_bf16 v[104:107], a[56:59], a[28:31], v[104:107]
ds_read_b128 a[4:7], v10 offset:43008
v_mfma_f32_16x16x32_bf16 v[36:39], a[60:63], a[16:19], v[36:39]
ds_read_b128 a[8:11], v10 offset:45056
v_mfma_f32_16x16x32_bf16 v[60:63], a[60:63], a[20:23], v[60:63]
ds_read_b128 a[12:15], v10 offset:47104
v_mfma_f32_16x16x32_bf16 v[84:87], a[60:63], a[24:27], v[84:87]
ds_read_b64_tr_b16 a[36:37], v15 offset:16384
v_mfma_f32_16x16x32_bf16 v[108:111], a[60:63], a[28:31], v[108:111]
ds_read_b64_tr_b16 a[38:39], v15 offset:16896
v_mfma_f32_16x16x32_bf16 v[40:43], a[16:19], a[64:67], v[40:43]
ds_read_b64_tr_b16 a[40:41], v14 offset:18432
v_mfma_f32_16x16x32_bf16 v[64:67], a[20:23], a[64:67], v[64:67]
ds_read_b64_tr_b16 a[42:43], v14 offset:18944
v_mfma_f32_16x16x32_bf16 v[88:91], a[24:27], a[64:67], v[88:91]
ds_read_b64_tr_b16 a[44:45], v15 offset:18432
v_mfma_f32_16x16x32_bf16 v[112:115], a[28:31], a[64:67], v[112:115]
ds_read_b64_tr_b16 a[46:47], v15 offset:18944
v_mfma_f32_16x16x32_bf16 v[44:47], a[16:19], a[68:71], v[44:47]
ds_read_b64_tr_b16 a[48:49], v14 offset:20480
v_mfma_f32_16x16x32_bf16 v[68:71], a[20:23], a[68:71], v[68:71]
ds_read_b64_tr_b16 a[50:51], v14 offset:20992
v_mfma_f32_16x16x32_bf16 v[92:95], a[24:27], a[68:71], v[92:95]
ds_read_b64_tr_b16 a[52:53], v15 offset:20480
v_mfma_f32_16x16x32_bf16 v[116:119], a[28:31], a[68:71], v[116:119]
ds_read_b64_tr_b16 a[54:55], v15 offset:20992
v_mfma_f32_16x16x32_bf16 v[48:51], a[16:19], a[72:75], v[48:51]
v_mfma_f32_16x16x32_bf16 v[72:75], a[20:23], a[72:75], v[72:75]
v_mfma_f32_16x16x32_bf16 v[96:99], a[24:27], a[72:75], v[96:99]
v_mfma_f32_16x16x32_bf16 v[120:123], a[28:31], a[72:75], v[120:123]
v_mfma_f32_16x16x32_bf16 v[52:55], a[16:19], a[76:79], v[52:55]
v_mfma_f32_16x16x32_bf16 v[76:79], a[20:23], a[76:79], v[76:79]
v_mfma_f32_16x16x32_bf16 v[100:103], a[24:27], a[76:79], v[100:103]
v_mfma_f32_16x16x32_bf16 v[124:127], a[28:31], a[76:79], v[124:127]
s_waitcnt lgkmcnt(0)
v_mfma_f32_16x16x32_bf16 v[32:35], a[32:35], a[0:3], v[32:35]
ds_read_b128 a[16:19], v11 offset:40960
v_mfma_f32_16x16x32_bf16 v[56:59], a[32:35], a[4:7], v[56:59]
ds_read_b64_tr_b16 a[56:57], v14 offset:28672
v_mfma_f32_16x16x32_bf16 v[80:83], a[32:35], a[8:11], v[80:83]
ds_read_b64_tr_b16 a[58:59], v14 offset:29184
v_mfma_f32_16x16x32_bf16 v[104:107], a[32:35], a[12:15], v[104:107]
ds_read_b128 a[20:23], v11 offset:43008
v_mfma_f32_16x16x32_bf16 v[36:39], a[36:39], a[0:3], v[36:39]
ds_read_b128 a[24:27], v11 offset:45056
v_mfma_f32_16x16x32_bf16 v[60:63], a[36:39], a[4:7], v[60:63]
ds_read_b128 a[28:31], v11 offset:47104
v_mfma_f32_16x16x32_bf16 v[84:87], a[36:39], a[8:11], v[84:87]
ds_read_b64_tr_b16 a[60:61], v15 offset:28672
v_mfma_f32_16x16x32_bf16 v[108:111], a[36:39], a[12:15], v[108:111]
ds_read_b64_tr_b16 a[62:63], v15 offset:29184
v_mfma_f32_16x16x32_bf16 v[40:43], a[0:3], a[40:43], v[40:43]
ds_read_b64_tr_b16 a[64:65], v14 offset:30720
v_mfma_f32_16x16x32_bf16 v[64:67], a[4:7], a[40:43], v[64:67]
ds_read_b64_tr_b16 a[66:67], v14 offset:31232
v_mfma_f32_16x16x32_bf16 v[88:91], a[8:11], a[40:43], v[88:91]
ds_read_b64_tr_b16 a[68:69], v15 offset:30720
v_mfma_f32_16x16x32_bf16 v[112:115], a[12:15], a[40:43], v[112:115]
ds_read_b64_tr_b16 a[70:71], v15 offset:31232
v_mfma_f32_16x16x32_bf16 v[44:47], a[0:3], a[44:47], v[44:47]
ds_read_b64_tr_b16 a[72:73], v14 offset:32768
v_mfma_f32_16x16x32_bf16 v[68:71], a[4:7], a[44:47], v[68:71]
ds_read_b64_tr_b16 a[74:75], v14 offset:33280
v_mfma_f32_16x16x32_bf16 v[92:95], a[8:11], a[44:47], v[92:95]
ds_read_b64_tr_b16 a[76:77], v15 offset:32768
v_mfma_f32_16x16x32_bf16 v[116:119], a[12:15], a[44:47], v[116:119]
ds_read_b64_tr_b16 a[78:79], v15 offset:33280
v_mfma_f32_16x16x32_bf16 v[48:51], a[0:3], a[48:51], v[48:51]
v_mfma_f32_16x16x32_bf16 v[72:75], a[4:7], a[48:51], v[72:75]
v_mfma_f32_16x16x32_bf16 v[96:99], a[8:11], a[48:51], v[96:99]
v_mfma_f32_16x16x32_bf16 v[120:123], a[12:15], a[48:51], v[120:123]
v_mfma_f32_16x16x32_bf16 v[52:55], a[0:3], a[52:55], v[52:55]
v_mfma_f32_16x16x32_bf16 v[76:79], a[4:7], a[52:55], v[76:79]
v_mfma_f32_16x16x32_bf16 v[100:103], a[8:11], a[52:55], v[100:103]
v_mfma_f32_16x16x32_bf16 v[124:127], a[12:15], a[52:55], v[124:127]
s_waitcnt lgkmcnt(0)
v_mfma_f32_16x16x32_bf16 v[32:35], a[56:59], a[16:19], v[32:35]
s_barrier
ds_read_b128 a[0:3], v10 offset:0
v_mfma_f32_16x16x32_bf16 v[56:59], a[56:59], a[20:23], v[56:59]
ds_read_b64_tr_b16 a[32:33], v12 offset:40960
v_mfma_f32_16x16x32_bf16 v[80:83], a[56:59], a[24:27], v[80:83]
ds_read_b64_tr_b16 a[34:35], v12 offset:41472
v_mfma_f32_16x16x32_bf16 v[104:107], a[56:59], a[28:31], v[104:107]
ds_read_b128 a[4:7], v10 offset:2048
v_mfma_f32_16x16x32_bf16 v[36:39], a[60:63], a[16:19], v[36:39]
ds_read_b128 a[8:11], v10 offset:4096
v_mfma_f32_16x16x32_bf16 v[60:63], a[60:63], a[20:23], v[60:63]
ds_read_b128 a[12:15], v10 offset:6144
v_mfma_f32_16x16x32_bf16 v[84:87], a[60:63], a[24:27], v[84:87]
ds_read_b64_tr_b16 a[36:37], v13 offset:40960
v_mfma_f32_16x16x32_bf16 v[108:111], a[60:63], a[28:31], v[108:111]
ds_read_b64_tr_b16 a[38:39], v13 offset:41472
v_mfma_f32_16x16x32_bf16 v[40:43], a[16:19], a[64:67], v[40:43]
ds_read_b64_tr_b16 a[40:41], v12 offset:43008
v_mfma_f32_16x16x32_bf16 v[64:67], a[20:23], a[64:67], v[64:67]
ds_read_b64_tr_b16 a[42:43], v12 offset:43520
v_mfma_f32_16x16x32_bf16 v[88:91], a[24:27], a[64:67], v[88:91]
ds_read_b64_tr_b16 a[44:45], v13 offset:43008
v_mfma_f32_16x16x32_bf16 v[112:115], a[28:31], a[64:67], v[112:115]
ds_read_b64_tr_b16 a[46:47], v13 offset:43520
v_mfma_f32_16x16x32_bf16 v[44:47], a[16:19], a[68:71], v[44:47]
ds_read_b64_tr_b16 a[48:49], v12 offset:45056
v_mfma_f32_16x16x32_bf16 v[68:71], a[20:23], a[68:71], v[68:71]
ds_read_b64_tr_b16 a[50:51], v12 offset:45568
v_mfma_f32_16x16x32_bf16 v[92:95], a[24:27], a[68:71], v[92:95]
ds_read_b64_tr_b16 a[52:53], v13 offset:45056
v_mfma_f32_16x16x32_bf16 v[116:119], a[28:31], a[68:71], v[116:119]
ds_read_b64_tr_b16 a[54:55], v13 offset:45568
v_mfma_f32_16x16x32_bf16 v[48:51], a[16:19], a[72:75], v[48:51]
v_mfma_f32_16x16x32_bf16 v[72:75], a[20:23], a[72:75], v[72:75]
v_mfma_f32_16x16x32_bf16 v[96:99], a[24:27], a[72:75], v[96:99]
v_mfma_f32_16x16x32_bf16 v[120:123], a[28:31], a[72:75], v[120:123]
v_mfma_f32_16x16x32_bf16 v[52:55], a[16:19], a[76:79], v[52:55]
v_mfma_f32_16x16x32_bf16 v[76:79], a[20:23], a[76:79], v[76:79]
v_mfma_f32_16x16x32_bf16 v[100:103], a[24:27], a[76:79], v[100:103]
v_mfma_f32_16x16x32_bf16 v[124:127], a[28:31], a[76:79], v[124:127]
s_waitcnt lgkmcnt(0)
v_mfma_f32_16x16x32_bf16 v[32:35], a[32:35], a[0:3], v[32:35]
ds_read_b128 a[16:19], v11 offset:0
v_mfma_f32_16x16x32_bf16 v[56:59], a[32:35], a[4:7], v[56:59]
ds_read_b64_tr_b16 a[56:57], v12 offset:53248
v_mfma_f32_16x16x32_bf16 v[80:83], a[32:35], a[8:11], v[80:83]
ds_read_b64_tr_b16 a[58:59], v12 offset:53760
v_mfma_f32_16x16x32_bf16 v[104:107], a[32:35], a[12:15], v[104:107]
ds_read_b128 a[20:23], v11 offset:2048
v_mfma_f32_16x16x32_bf16 v[36:39], a[36:39], a[0:3], v[36:39]
ds_read_b128 a[24:27], v11 offset:4096
v_mfma_f32_16x16x32_bf16 v[60:63], a[36:39], a[4:7], v[60:63]
ds_read_b128 a[28:31], v11 offset:6144
v_mfma_f32_16x16x32_bf16 v[84:87], a[36:39], a[8:11], v[84:87]
ds_read_b64_tr_b16 a[60:61], v13 offset:53248
v_mfma_f32_16x16x32_bf16 v[108:111], a[36:39], a[12:15], v[108:111]
ds_read_b64_tr_b16 a[62:63], v13 offset:53760
v_mfma_f32_16x16x32_bf16 v[40:43], a[0:3], a[40:43], v[40:43]
ds_read_b64_tr_b16 a[64:65], v12 offset:55296
v_mfma_f32_16x16x32_bf16 v[64:67], a[4:7], a[40:43], v[64:67]
ds_read_b64_tr_b16 a[66:67], v12 offset:55808
v_mfma_f32_16x16x32_bf16 v[88:91], a[8:11], a[40:43], v[88:91]
ds_read_b64_tr_b16 a[68:69], v13 offset:55296
v_mfma_f32_16x16x32_bf16 v[112:115], a[12:15], a[40:43], v[112:115]
ds_read_b64_tr_b16 a[70:71], v13 offset:55808
v_mfma_f32_16x16x32_bf16 v[44:47], a[0:3], a[44:47], v[44:47]
ds_read_b64_tr_b16 a[72:73], v12 offset:57344
v_mfma_f32_16x16x32_bf16 v[68:71], a[4:7], a[44:47], v[68:71]
ds_read_b64_tr_b16 a[74:75], v12 offset:57856
v_mfma_f32_16x16x32_bf16 v[92:95], a[8:11], a[44:47], v[92:95]
ds_read_b64_tr_b16 a[76:77], v13 offset:57344
v_mfma_f32_16x16x32_bf16 v[116:119], a[12:15], a[44:47], v[116:119]
ds_read_b64_tr_b16 a[78:79], v13 offset:57856
v_mfma_f32_16x16x32_bf16 v[48:51], a[0:3], a[48:51], v[48:51]
v_lshrrev_b32 v2, 4, v1
v_lshlrev_b32 v2, 4, v2
s_lshl_b32 s70, s66, 8
s_add_u32 s70, s70, 159744
v_add_u32 v17, s70, v2
v_mfma_f32_16x16x32_bf16 v[72:75], a[4:7], a[48:51], v[72:75]
v_mfma_f32_16x16x32_bf16 v[96:99], a[8:11], a[48:51], v[96:99]
v_and_b32 v2, 15, v1
v_lshlrev_b32 v2, 2, v2
s_lshl_b32 s70, s67, 7
s_add_u32 s70, s70, 160768
v_add_u32 v18, s70, v2
v_mfma_f32_16x16x32_bf16 v[120:123], a[12:15], a[48:51], v[120:123]
v_mfma_f32_16x16x32_bf16 v[52:55], a[0:3], a[52:55], v[52:55]
v_mfma_f32_16x16x32_bf16 v[76:79], a[4:7], a[52:55], v[76:79]
v_mfma_f32_16x16x32_bf16 v[100:103], a[8:11], a[52:55], v[100:103]
v_mfma_f32_16x16x32_bf16 v[124:127], a[12:15], a[52:55], v[124:127]
s_waitcnt lgkmcnt(0)
v_mfma_f32_16x16x32_bf16 v[32:35], a[56:59], a[16:19], v[32:35]
s_barrier
ds_read_b128 a[0:3], v8 offset:24576
v_mfma_f32_16x16x32_bf16 v[56:59], a[56:59], a[20:23], v[56:59]
ds_read_b64_tr_b16 a[40:41], v12 offset:2048
v_mfma_f32_16x16x32_bf16 v[80:83], a[56:59], a[24:27], v[80:83]
ds_read_b64_tr_b16 a[42:43], v12 offset:2560
v_mfma_f32_16x16x32_bf16 v[104:107], a[56:59], a[28:31], v[104:107]
ds_read_b128 a[4:7], v8 offset:26624
v_mfma_f32_16x16x32_bf16 v[36:39], a[60:63], a[16:19], v[36:39]
ds_read_b128 a[8:11], v8 offset:28672
v_mfma_f32_16x16x32_bf16 v[60:63], a[60:63], a[20:23], v[60:63]
ds_read_b128 a[12:15], v8 offset:30720
v_mfma_f32_16x16x32_bf16 v[84:87], a[60:63], a[24:27], v[84:87]
ds_read_b64_tr_b16 a[44:45], v13 offset:2048
v_mfma_f32_16x16x32_bf16 v[108:111], a[60:63], a[28:31], v[108:111]
ds_read_b64_tr_b16 a[46:47], v13 offset:2560
v_mfma_f32_16x16x32_bf16 v[40:43], a[16:19], a[64:67], v[40:43]
ds_read_b64_tr_b16 a[48:49], v12 offset:4096
v_mfma_f32_16x16x32_bf16 v[64:67], a[20:23], a[64:67], v[64:67]
ds_read_b64_tr_b16 a[50:51], v12 offset:4608
v_mfma_f32_16x16x32_bf16 v[88:91], a[24:27], a[64:67], v[88:91]
ds_read_b64_tr_b16 a[52:53], v13 offset:4096
v_mfma_f32_16x16x32_bf16 v[112:115], a[28:31], a[64:67], v[112:115]
ds_read_b64_tr_b16 a[54:55], v13 offset:4608
v_mfma_f32_16x16x32_bf16 v[44:47], a[16:19], a[68:71], v[44:47]
ds_read_b64_tr_b16 a[32:33], v12 offset:0
v_mfma_f32_16x16x32_bf16 v[68:71], a[20:23], a[68:71], v[68:71]
ds_read_b64_tr_b16 a[34:35], v12 offset:512
v_mfma_f32_16x16x32_bf16 v[92:95], a[24:27], a[68:71], v[92:95]
ds_read_b64_tr_b16 a[36:37], v13 offset:0
v_mfma_f32_16x16x32_bf16 v[116:119], a[28:31], a[68:71], v[116:119]
ds_read_b64_tr_b16 a[38:39], v13 offset:512
v_mfma_f32_16x16x32_bf16 v[48:51], a[16:19], a[72:75], v[48:51]
v_mfma_f32_16x16x32_bf16 v[72:75], a[20:23], a[72:75], v[72:75]
v_mfma_f32_16x16x32_bf16 v[96:99], a[24:27], a[72:75], v[96:99]
v_mfma_f32_16x16x32_bf16 v[120:123], a[28:31], a[72:75], v[120:123]
v_mfma_f32_16x16x32_bf16 v[52:55], a[16:19], a[76:79], v[52:55]
v_mfma_f32_16x16x32_bf16 v[76:79], a[20:23], a[76:79], v[76:79]
v_mfma_f32_16x16x32_bf16 v[100:103], a[24:27], a[76:79], v[100:103]
v_mfma_f32_16x16x32_bf16 v[124:127], a[28:31], a[76:79], v[124:127]
s_waitcnt lgkmcnt(0)
v_mfma_f32_16x16x32_bf16 v[40:43], a[0:3], a[40:43], v[40:43]
ds_read_b128 a[16:19], v9 offset:24576
ds_read_b64_tr_b16 a[64:65], v12 offset:14336
v_mfma_f32_16x16x32_bf16 v[64:67], a[4:7], a[40:43], v[64:67]
ds_read_b64_tr_b16 a[66:67], v12 offset:14848
ds_read_b128 a[20:23], v9 offset:26624
v_mfma_f32_16x16x32_bf16 v[88:91], a[8:11], a[40:43], v[88:91]
ds_read_b128 a[24:27], v9 offset:28672
ds_read_b128 a[28:31], v9 offset:30720
v_mfma_f32_16x16x32_bf16 v[112:115], a[12:15], a[40:43], v[112:115]
ds_read_b64_tr_b16 a[68:69], v13 offset:14336
ds_read_b64_tr_b16 a[70:71], v13 offset:14848
v_mfma_f32_16x16x32_bf16 v[44:47], a[0:3], a[44:47], v[44:47]
ds_read_b64_tr_b16 a[72:73], v12 offset:16384
ds_read_b64_tr_b16 a[74:75], v12 offset:16896
v_mfma_f32_16x16x32_bf16 v[68:71], a[4:7], a[44:47], v[68:71]
ds_read_b64_tr_b16 a[76:77], v13 offset:16384
ds_read_b64_tr_b16 a[78:79], v13 offset:16896
v_mfma_f32_16x16x32_bf16 v[92:95], a[8:11], a[44:47], v[92:95]
ds_read_b64_tr_b16 a[56:57], v12 offset:12288
v_mfma_f32_16x16x32_bf16 v[116:119], a[12:15], a[44:47], v[116:119]
ds_read_b64_tr_b16 a[58:59], v12 offset:12800
v_mfma_f32_16x16x32_bf16 v[48:51], a[0:3], a[48:51], v[48:51]
ds_read_b64_tr_b16 a[60:61], v13 offset:12288
v_mfma_f32_16x16x32_bf16 v[72:75], a[4:7], a[48:51], v[72:75]
ds_read_b64_tr_b16 a[62:63], v13 offset:12800
v_mfma_f32_16x16x32_bf16 v[96:99], a[8:11], a[48:51], v[96:99]
v_mfma_f32_16x16x32_bf16 v[120:123], a[12:15], a[48:51], v[120:123]
v_mfma_f32_16x16x32_bf16 v[52:55], a[0:3], a[52:55], v[52:55]
v_mfma_f32_16x16x32_bf16 v[76:79], a[4:7], a[52:55], v[76:79]
v_mfma_f32_16x16x32_bf16 v[100:103], a[8:11], a[52:55], v[100:103]
v_mfma_f32_16x16x32_bf16 v[124:127], a[12:15], a[52:55], v[124:127]
s_waitcnt lgkmcnt(0)
v_mfma_f32_16x16x32_bf16 v[40:43], a[16:19], a[64:67], v[40:43]
s_barrier
ds_read_b128 v[20:23], v17 offset:0
ds_read_b128 v[24:27], v17 offset:512
v_mfma_f32_16x16x32_bf16 v[64:67], a[20:23], a[64:67], v[64:67]
ds_read_b32 v6, v18 offset:256
ds_read_b32 v8, v18 offset:320
v_mfma_f32_16x16x32_bf16 v[88:91], a[24:27], a[64:67], v[88:91]
ds_read_b32 v10, v18 offset:512
ds_read_b32 v18, v18 offset:576
v_mfma_f32_16x16x32_bf16 v[112:115], a[28:31], a[64:67], v[112:115]
v_mov_b32 v19, 161536
ds_read_b32 v19, v19
ds_read_b128 v[128:131], v17 offset:64
v_mfma_f32_16x16x32_bf16 v[44:47], a[16:19], a[68:71], v[44:47]
ds_read_b128 v[132:135], v17 offset:576
ds_read_b128 v[136:139], v17 offset:128
v_mfma_f32_16x16x32_bf16 v[68:71], a[20:23], a[68:71], v[68:71]
ds_read_b128 v[140:143], v17 offset:640
ds_read_b128 v[144:147], v17 offset:192
v_mfma_f32_16x16x32_bf16 v[92:95], a[24:27], a[68:71], v[92:95]
ds_read_b128 v[148:151], v17 offset:704
v_mfma_f32_16x16x32_bf16 v[116:119], a[28:31], a[68:71], v[116:119]
v_mfma_f32_16x16x32_bf16 v[48:51], a[16:19], a[72:75], v[48:51]
v_mfma_f32_16x16x32_bf16 v[72:75], a[20:23], a[72:75], v[72:75]
v_mfma_f32_16x16x32_bf16 v[96:99], a[24:27], a[72:75], v[96:99]
v_mfma_f32_16x16x32_bf16 v[120:123], a[28:31], a[72:75], v[120:123]
v_mfma_f32_16x16x32_bf16 v[52:55], a[16:19], a[76:79], v[52:55]
v_mfma_f32_16x16x32_bf16 v[76:79], a[20:23], a[76:79], v[76:79]
v_mfma_f32_16x16x32_bf16 v[100:103], a[24:27], a[76:79], v[100:103]
v_mfma_f32_16x16x32_bf16 v[124:127], a[28:31], a[76:79], v[124:127]
s_waitcnt lgkmcnt(0)
v_readfirstlane_b32 s69, v19
s_nop 0
s_and_b32 s61, s69, 0x2000
s_branch L_over5
L_pad5:
s_branch L_ret9
L_over5:
s_and_b32 s69, s69, 1
s_xor_b32 s88, s88, s61
v_pk_mul_f32 v[28:29], v[24:25], s[90:91]
v_pk_mul_f32 v[30:31], v[26:27], s[90:91]
v_pk_fma_f32 v[40:41], v[20:21], v[6:7], v[40:41] op_sel:[0,0,0] op_sel_hi:[1,0,1]
v_pk_fma_f32 v[44:45], v[20:21], v[8:9], v[44:45] op_sel:[0,0,0] op_sel_hi:[1,0,1]
v_pk_fma_f32 v[42:43], v[22:23], v[6:7], v[42:43] op_sel:[0,0,0] op_sel_hi:[1,0,1]
v_pk_fma_f32 v[46:47], v[22:23], v[8:9], v[46:47] op_sel:[0,0,0] op_sel_hi:[1,0,1]
v_pk_mul_f32 v[2:3], v[40:41], v[28:29]
v_pk_mul_f32 v[12:13], v[44:45], v[28:29]
v_pk_mul_f32 v[4:5], v[42:43], v[30:31]
v_pk_mul_f32 v[14:15], v[46:47], v[30:31]
v_pk_fma_f32 v[40:41], v[40:41], v[24:25], s[82:83]
v_pk_fma_f32 v[44:45], v[44:45], v[24:25], s[82:83]
v_pk_fma_f32 v[42:43], v[42:43], v[26:27], s[82:83]
v_pk_fma_f32 v[46:47], v[46:47], v[26:27], s[82:83]
v_exp_f32_e64 v2, v2 clamp
v_exp_f32_e64 v12, v12 clamp
v_exp_f32_e64 v3, v3 clamp
v_exp_f32_e64 v13, v13 clamp
v_exp_f32_e64 v4, v4 clamp
v_exp_f32_e64 v14, v14 clamp
v_exp_f32_e64 v5, v5 clamp
v_exp_f32_e64 v15, v15 clamp
v_pk_add_f32 v[2:3], v[2:3], s[80:81]
v_pk_add_f32 v[12:13], v[12:13], s[80:81]
v_pk_add_f32 v[4:5], v[4:5], s[80:81]
v_pk_add_f32 v[14:15], v[14:15], s[80:81]
v_max_f32 v40, v40, v2
v_max_f32 v44, v44, v12
v_max_f32 v41, v41, v3
v_max_f32 v45, v45, v13
v_max_f32 v42, v42, v4
v_max_f32 v46, v46, v14
v_max_f32 v43, v43, v5
v_max_f32 v47, v47, v15
v_cvt_pk_bf16_f32 v40, v40, v41
v_cvt_pk_bf16_f32 v44, v44, v45
v_cvt_pk_bf16_f32 v41, v42, v43
v_cvt_pk_bf16_f32 v45, v46, v47
v_pk_fma_f32 v[48:49], v[20:21], v[10:11], v[48:49] op_sel:[0,0,0] op_sel_hi:[1,0,1]
v_pk_fma_f32 v[52:53], v[20:21], v[18:19], v[52:53] op_sel:[0,0,0] op_sel_hi:[1,0,1]
v_pk_fma_f32 v[50:51], v[22:23], v[10:11], v[50:51] op_sel:[0,0,0] op_sel_hi:[1,0,1]
v_pk_fma_f32 v[54:55], v[22:23], v[18:19], v[54:55] op_sel:[0,0,0] op_sel_hi:[1,0,1]
v_pk_mul_f32 v[48:49], v[48:49], v[24:25]
v_pk_mul_f32 v[52:53], v[52:53], v[24:25]
v_pk_mul_f32 v[50:51], v[50:51], v[26:27]
v_pk_mul_f32 v[54:55], v[54:55], v[26:27]
v_cvt_pk_bf16_f32 v48, v48, v49
v_cvt_pk_bf16_f32 v52, v52, v53
v_cvt_pk_bf16_f32 v49, v50, v51
v_cvt_pk_bf16_f32 v53, v54, v55
v_pk_mul_f32 v[28:29], v[132:133], s[90:91]
v_pk_mul_f32 v[30:31], v[134:135], s[90:91]
v_pk_fma_f32 v[64:65], v[128:129], v[6:7], v[64:65] op_sel:[0,0,0] op_sel_hi:[1,0,1]
v_pk_fma_f32 v[68:69], v[128:129], v[8:9], v[68:69] op_sel:[0,0,0] op_sel_hi:[1,0,1]
v_pk_fma_f32 v[66:67], v[130:131], v[6:7], v[66:67] op_sel:[0,0,0] op_sel_hi:[1,0,1]
v_pk_fma_f32 v[70:71], v[130:131], v[8:9], v[70:71] op_sel:[0,0,0] op_sel_hi:[1,0,1]
v_pk_mul_f32 v[2:3], v[64:65], v[28:29]
v_pk_mul_f32 v[12:13], v[68:69], v[28:29]
v_pk_mul_f32 v[4:5], v[66:67], v[30:31]
v_pk_mul_f32 v[14:15], v[70:71], v[30:31]
v_pk_fma_f32 v[64:65], v[64:65], v[132:133], s[82:83]
v_pk_fma_f32 v[68:69], v[68:69], v[132:133], s[82:83]
v_pk_fma_f32 v[66:67], v[66:67], v[134:135], s[82:83]
v_pk_fma_f32 v[70:71], v[70:71], v[134:135], s[82:83]
v_exp_f32_e64 v2, v2 clamp
v_exp_f32_e64 v12, v12 clamp
v_exp_f32_e64 v3, v3 clamp
v_exp_f32_e64 v13, v13 clamp
v_exp_f32_e64 v4, v4 clamp
v_exp_f32_e64 v14, v14 clamp
v_exp_f32_e64 v5, v5 clamp
v_exp_f32_e64 v15, v15 clamp
v_pk_add_f32 v[2:3], v[2:3], s[80:81]
v_pk_add_f32 v[12:13], v[12:13], s[80:81]
v_pk_add_f32 v[4:5], v[4:5], s[80:81]
v_pk_add_f32 v[14:15], v[14:15], s[80:81]
v_max_f32 v64, v64, v2
v_max_f32 v68, v68, v12
v_max_f32 v65, v65, v3
v_max_f32 v69, v69, v13
v_max_f32 v66, v66, v4
v_max_f32 v70, v70, v14
v_max_f32 v67, v67, v5
v_max_f32 v71, v71, v15
v_cvt_pk_bf16_f32 v42, v64, v65
v_cvt_pk_bf16_f32 v46, v68, v69
v_cvt_pk_bf16_f32 v43, v66, v67
v_cvt_pk_bf16_f32 v47, v70, v71
v_pk_fma_f32 v[72:73], v[128:129], v[10:11], v[72:73] op_sel:[0,0,0] op_sel_hi:[1,0,1]
v_pk_fma_f32 v[76:77], v[128:129], v[18:19], v[76:77] op_sel:[0,0,0] op_sel_hi:[1,0,1]
v_pk_fma_f32 v[74:75], v[130:131], v[10:11], v[74:75] op_sel:[0,0,0] op_sel_hi:[1,0,1]
v_pk_fma_f32 v[78:79], v[130:131], v[18:19], v[78:79] op_sel:[0,0,0] op_sel_hi:[1,0,1]
v_pk_mul_f32 v[72:73], v[72:73], v[132:133]
v_pk_mul_f32 v[76:77], v[76:77], v[132:133]
v_pk_mul_f32 v[74:75], v[74:75], v[134:135]
v_pk_mul_f32 v[78:79], v[78:79], v[134:135]
v_cvt_pk_bf16_f32 v50, v72, v73
v_cvt_pk_bf16_f32 v54, v76, v77
v_cvt_pk_bf16_f32 v51, v74, v75
v_cvt_pk_bf16_f32 v55, v78, v79
s_nop 0
v_mfma_f32_16x16x32_bf16 v[64:67], v[40:43], v[48:51], 0
v_mfma_f32_16x16x32_bf16 v[68:71], v[40:43], v[52:55], 0
v_mfma_f32_16x16x32_bf16 v[20:23], v[40:43], a[80:83], 0
v_mfma_f32_16x16x32_bf16 v[72:75], v[44:47], v[48:51], 0
v_mfma_f32_16x16x32_bf16 v[76:79], v[44:47], v[52:55], 0
v_mfma_f32_16x16x32_bf16 v[24:27], v[44:47], a[80:83], 0
v_pk_mul_f32 v[28:29], v[140:141], s[90:91]
v_pk_mul_f32 v[30:31], v[142:143], s[90:91]
v_pk_fma_f32 v[88:89], v[136:137], v[6:7], v[88:89] op_sel:[0,0,0] op_sel_hi:[1,0,1]
v_pk_fma_f32 v[92:93], v[136:137], v[8:9], v[92:93] op_sel:[0,0,0] op_sel_hi:[1,0,1]
v_pk_fma_f32 v[90:91], v[138:139], v[6:7], v[90:91] op_sel:[0,0,0] op_sel_hi:[1,0,1]
v_pk_fma_f32 v[94:95], v[138:139], v[8:9], v[94:95] op_sel:[0,0,0] op_sel_hi:[1,0,1]
v_pk_mul_f32 v[2:3], v[88:89], v[28:29]
v_pk_mul_f32 v[12:13], v[92:93], v[28:29]
v_pk_mul_f32 v[4:5], v[90:91], v[30:31]
v_pk_mul_f32 v[14:15], v[94:95], v[30:31]
v_pk_fma_f32 v[88:89], v[88:89], v[140:141], s[82:83]
v_pk_fma_f32 v[92:93], v[92:93], v[140:141], s[82:83]
v_pk_fma_f32 v[90:91], v[90:91], v[142:143], s[82:83]
v_pk_fma_f32 v[94:95], v[94:95], v[142:143], s[82:83]
v_exp_f32_e64 v2, v2 clamp
v_exp_f32_e64 v12, v12 clamp
v_exp_f32_e64 v3, v3 clamp
v_exp_f32_e64 v13, v13 clamp
v_exp_f32_e64 v4, v4 clamp
v_exp_f32_e64 v14, v14 clamp
v_exp_f32_e64 v5, v5 clamp
v_exp_f32_e64 v15, v15 clamp
v_pk_add_f32 v[2:3], v[2:3], s[80:81]
v_pk_add_f32 v[12:13], v[12:13], s[80:81]
v_pk_add_f32 v[4:5], v[4:5], s[80:81]
v_pk_add_f32 v[14:15], v[14:15], s[80:81]
v_max_f32 v88, v88, v2
v_max_f32 v92, v92, v12
v_max_f32 v89, v89, v3
v_max_f32 v93, v93, v13
v_max_f32 v90, v90, v4
v_max_f32 v94, v94, v14
v_max_f32 v91, v91, v5
v_max_f32 v95, v95, v15
v_cvt_pk_bf16_f32 v88, v88, v89
v_cvt_pk_bf16_f32 v92, v92, v93
v_cvt_pk_bf16_f32 v89, v90, v91
v_cvt_pk_bf16_f32 v93, v94, v95
v_pk_fma_f32 v[96:97], v[136:137], v[10:11], v[96:97] op_sel:[0,0,0] op_sel_hi:[1,0,1]
v_pk_fma_f32 v[100:101], v[136:137], v[18:19], v[100:101] op_sel:[0,0,0] op_sel_hi:[1,0,1]
v_pk_fma_f32 v[98:99], v[138:139], v[10:11], v[98:99] op_sel:[0,0,0] op_sel_hi:[1,0,1]
v_pk_fma_f32 v[102:103], v[138:139], v[18:19], v[102:103] op_sel:[0,0,0] op_sel_hi:[1,0,1]
v_pk_mul_f32 v[96:97], v[96:97], v[140:141]
v_pk_mul_f32 v[100:101], v[100:101], v[140:141]
v_pk_mul_f32 v[98:99], v[98:99], v[142:143]
v_pk_mul_f32 v[102:103], v[102:103], v[142:143]
v_cvt_pk_bf16_f32 v96, v96, v97
v_cvt_pk_bf16_f32 v100, v100, v101
v_cvt_pk_bf16_f32 v97, v98, v99
v_cvt_pk_bf16_f32 v101, v102, v103
v_pk_mul_f32 v[28:29], v[148:149], s[90:91]
v_pk_mul_f32 v[30:31], v[150:151], s[90:91]
v_pk_fma_f32 v[112:113], v[144:145], v[6:7], v[112:113] op_sel:[0,0,0] op_sel_hi:[1,0,1]
v_pk_fma_f32 v[116:117], v[144:145], v[8:9], v[116:117] op_sel:[0,0,0] op_sel_hi:[1,0,1]
v_pk_fma_f32 v[114:115], v[146:147], v[6:7], v[114:115] op_sel:[0,0,0] op_sel_hi:[1,0,1]
v_pk_fma_f32 v[118:119], v[146:147], v[8:9], v[118:119] op_sel:[0,0,0] op_sel_hi:[1,0,1]
v_pk_mul_f32 v[2:3], v[112:113], v[28:29]
v_pk_mul_f32 v[12:13], v[116:117], v[28:29]
v_pk_mul_f32 v[4:5], v[114:115], v[30:31]
v_pk_mul_f32 v[14:15], v[118:119], v[30:31]
v_pk_fma_f32 v[112:113], v[112:113], v[148:149], s[82:83]
v_pk_fma_f32 v[116:117], v[116:117], v[148:149], s[82:83]
v_pk_fma_f32 v[114:115], v[114:115], v[150:151], s[82:83]
v_pk_fma_f32 v[118:119], v[118:119], v[150:151], s[82:83]
v_exp_f32_e64 v2, v2 clamp
v_exp_f32_e64 v12, v12 clamp
v_exp_f32_e64 v3, v3 clamp
v_exp_f32_e64 v13, v13 clamp
v_exp_f32_e64 v4, v4 clamp
v_exp_f32_e64 v14, v14 clamp
v_exp_f32_e64 v5, v5 clamp
v_exp_f32_e64 v15, v15 clamp
v_pk_add_f32 v[2:3], v[2:3], s[80:81]
v_pk_add_f32 v[12:13], v[12:13], s[80:81]
v_pk_add_f32 v[4:5], v[4:5], s[80:81]
v_pk_add_f32 v[14:15], v[14:15], s[80:81]
v_max_f32 v112, v112, v2
v_max_f32 v116, v116, v12
v_max_f32 v113, v113, v3
v_max_f32 v117, v117, v13
v_max_f32 v114, v114, v4
v_max_f32 v118, v118, v14
v_max_f32 v115, v115, v5
v_max_f32 v119, v119, v15
v_cvt_pk_bf16_f32 v90, v112, v113
v_cvt_pk_bf16_f32 v94, v116, v117
v_cvt_pk_bf16_f32 v91, v114, v115
v_cvt_pk_bf16_f32 v95, v118, v119
v_pk_fma_f32 v[120:121], v[144:145], v[10:11], v[120:121] op_sel:[0,0,0] op_sel_hi:[1,0,1]
v_pk_fma_f32 v[124:125], v[144:145], v[18:19], v[124:125] op_sel:[0,0,0] op_sel_hi:[1,0,1]
v_pk_fma_f32 v[122:123], v[146:147], v[10:11], v[122:123] op_sel:[0,0,0] op_sel_hi:[1,0,1]
v_pk_fma_f32 v[126:127], v[146:147], v[18:19], v[126:127] op_sel:[0,0,0] op_sel_hi:[1,0,1]
v_pk_mul_f32 v[120:121], v[120:121], v[148:149]
v_pk_mul_f32 v[124:125], v[124:125], v[148:149]
v_pk_mul_f32 v[122:123], v[122:123], v[150:151]
v_pk_mul_f32 v[126:127], v[126:127], v[150:151]
v_cvt_pk_bf16_f32 v98, v120, v121
v_cvt_pk_bf16_f32 v102, v124, v125
v_cvt_pk_bf16_f32 v99, v122, v123
v_cvt_pk_bf16_f32 v103, v126, v127
s_nop 0
v_mfma_f32_16x16x32_bf16 v[64:67], v[88:91], v[96:99], v[64:67]
v_mfma_f32_16x16x32_bf16 v[68:71], v[88:91], v[100:103], v[68:71]
v_mfma_f32_16x16x32_bf16 v[20:23], v[88:91], a[80:83], v[20:23]
v_mfma_f32_16x16x32_bf16 v[72:75], v[92:95], v[96:99], v[72:75]
v_mfma_f32_16x16x32_bf16 v[76:79], v[92:95], v[100:103], v[76:79]
v_mfma_f32_16x16x32_bf16 v[24:27], v[92:95], a[80:83], v[24:27]
s_lshl_b32 s70, s60, 11
s_add_u32 s70, s70, 16384
v_add_u32 v2, s70, v16
v_xor_b32 v3, 4096, v2
v_lshrrev_b32 v4, 4, v1
v_lshlrev_b32 v5, 4, v4
v_lshlrev_b32 v4, 5, v4
s_lshl_b32 s70, s60, 6
s_add_u32 s70, s70, 163584
v_add_u32 v5, s70, v5
v_xor_b32 v6, 128, v5
s_lshl_b32 s72, s67, 1
s_add_u32 s72, s72, s66
s_lshl_b32 s72, s72, 10
s_add_u32 s72, s72, s87
s_lshl_b32 s73, s67, 7
s_lshl_b32 s70, s66, 4
s_add_u32 s73, s73, s70
s_add_u32 s73, s73, s87
s_add_u32 s73, s73, 4096
s_mov_b32 s92, 0x00010001
s_mov_b32 s93, 0x00010001
v_mov_b32 v15, s68
s_cmp_eq_u32 s66, 0
s_cbranch_scc0 L_ex1
ds_write_b128 v2, v[68:71]
ds_write_b128 v2, v[76:79] offset:1024
ds_write_b128 v5, v[24:27]
s_waitcnt lgkmcnt(0)
s_barrier
ds_read_b128 v[128:131], v3
ds_read_b128 v[132:135], v3 offset:1024
ds_read_b128 v[136:139], v6
s_waitcnt lgkmcnt(1)
v_pk_add_f32 v[128:129], v[128:129], v[64:65]
v_pk_add_f32 v[130:131], v[130:131], v[66:67]
v_pk_add_f32 v[132:133], v[132:133], v[72:73]
v_pk_add_f32 v[134:135], v[134:135], v[74:75]
s_waitcnt lgkmcnt(0)
v_pk_add_f32 v[136:137], v[136:137], v[20:21]
v_pk_add_f32 v[138:139], v[138:139], v[22:23]
s_branch L_ex_d
L_ex1:
ds_write_b128 v2, v[64:67]
ds_write_b128 v2, v[72:75] offset:1024
ds_write_b128 v5, v[20:23]
s_waitcnt lgkmcnt(0)
s_barrier
ds_read_b128 v[128:131], v3
ds_read_b128 v[132:135], v3 offset:1024
ds_read_b128 v[136:139], v6
s_waitcnt lgkmcnt(1)
v_pk_add_f32 v[128:129], v[128:129], v[68:69]
v_pk_add_f32 v[130:131], v[130:131], v[70:71]
v_pk_add_f32 v[132:133], v[132:133], v[76:77]
v_pk_add_f32 v[134:135], v[134:135], v[78:79]
s_waitcnt lgkmcnt(0)
v_pk_add_f32 v[136:137], v[136:137], v[24:25]
v_pk_add_f32 v[138:139], v[138:139], v[26:27]
L_ex_d:
v_cvt_pk_bf16_f32 v140, v128, v129
v_cvt_pk_bf16_f32 v141, v130, v131
v_cvt_pk_bf16_f32 v142, v132, v133
v_cvt_pk_bf16_f32 v143, v134, v135
v_bfi_b32 v136, s85, v15, v136
v_bfi_b32 v137, s85, v15, v137
v_bfi_b32 v138, s85, v15, v138
v_bfi_b32 v139, s85, v15, v139
s_cmp_eq_u32 s69, 0
s_cbranch_scc1 L_kvp_s
buffer_store_dwordx4 v[140:143], v16, s[12:15], s72 offen
s_mov_b64 exec, s[92:93]
buffer_store_dwordx4 v[136:139], v4, s[12:15], s73 offen
s_mov_b64 exec, -1
L_kvp_d:
s_barrier
v_and_b32 v2, 15, v1
v_lshlrev_b32 v2, 2, v2
s_lshl_b32 s70, s66, 8
s_add_u32 s70, s70, 159744
v_add_u32 v2, s70, v2
v_lshrrev_b32 v3, 4, v1
v_lshlrev_b32 v3, 4, v3
s_lshl_b32 s70, s67, 7
s_add_u32 s70, s70, 160768
v_add_u32_e64 v5, s70, v3
ds_read_b32 v8, v2 offset:0
ds_read_b32 v128, v2 offset:512
ds_read_b32 v10, v2 offset:64
ds_read_b32 v130, v2 offset:576
ds_read_b32 v12, v2 offset:128
ds_read_b32 v132, v2 offset:640
ds_read_b32 v14, v2 offset:192
ds_read_b32 v134, v2 offset:704
ds_read_b128 v[144:147], v5 offset:0
ds_read_b128 v[148:151], v5 offset:64
v_mfma_f32_16x16x32_bf16 v[32:35], a[32:35], a[0:3], v[32:35]
v_mfma_f32_16x16x32_bf16 v[56:59], a[32:35], a[4:7], v[56:59]
v_mfma_f32_16x16x32_bf16 v[80:83], a[32:35], a[8:11], v[80:83]
v_mfma_f32_16x16x32_bf16 v[104:107], a[32:35], a[12:15], v[104:107]
v_mfma_f32_16x16x32_bf16 v[36:39], a[36:39], a[0:3], v[36:39]
v_mfma_f32_16x16x32_bf16 v[60:63], a[36:39], a[4:7], v[60:63]
v_mfma_f32_16x16x32_bf16 v[84:87], a[36:39], a[8:11], v[84:87]
v_mfma_f32_16x16x32_bf16 v[108:111], a[36:39], a[12:15], v[108:111]
v_mfma_f32_16x16x32_bf16 v[32:35], a[56:59], a[16:19], v[32:35]
v_mfma_f32_16x16x32_bf16 v[56:59], a[56:59], a[20:23], v[56:59]
v_mfma_f32_16x16x32_bf16 v[80:83], a[56:59], a[24:27], v[80:83]
v_mfma_f32_16x16x32_bf16 v[104:107], a[56:59], a[28:31], v[104:107]
v_mfma_f32_16x16x32_bf16 v[36:39], a[60:63], a[16:19], v[36:39]
v_mfma_f32_16x16x32_bf16 v[60:63], a[60:63], a[20:23], v[60:63]
v_mfma_f32_16x16x32_bf16 v[84:87], a[60:63], a[24:27], v[84:87]
v_mfma_f32_16x16x32_bf16 v[108:111], a[60:63], a[28:31], v[108:111]
s_lshl1_add_u32 s70, s64, s67
s_lshl_b32 s70, s70, 11
s_add_u32 s70, s70, 1638400
v_add_u32 v17, s70, v16
s_lshl_b32 s70, s67, 6
s_add_u32 s70, s70, 161600
v_add_u32 v18, s70, v3
s_waitcnt lgkmcnt(0)
v_mul_f32 v20, s90, v128
v_mul_f32 v22, s90, v130
v_mul_f32 v4, s90, v132
v_mul_f32 v6, s90, v134
v_pk_fma_f32 v[32:33], v[144:145], v[8:9], v[32:33] op_sel:[0,0,0] op_sel_hi:[1,0,1]
v_pk_fma_f32 v[36:37], v[148:149], v[8:9], v[36:37] op_sel:[0,0,0] op_sel_hi:[1,0,1]
v_pk_fma_f32 v[34:35], v[146:147], v[8:9], v[34:35] op_sel:[0,0,0] op_sel_hi:[1,0,1]
v_pk_fma_f32 v[38:39], v[150:151], v[8:9], v[38:39] op_sel:[0,0,0] op_sel_hi:[1,0,1]
v_pk_mul_f32 v[24:25], v[32:33], v[20:21] op_sel:[0,0] op_sel_hi:[1,0]
v_pk_mul_f32 v[28:29], v[36:37], v[20:21] op_sel:[0,0] op_sel_hi:[1,0]
v_pk_mul_f32 v[26:27], v[34:35], v[20:21] op_sel:[0,0] op_sel_hi:[1,0]
v_pk_mul_f32 v[30:31], v[38:39], v[20:21] op_sel:[0,0] op_sel_hi:[1,0]
v_pk_fma_f32 v[32:33], v[32:33], v[128:129], s[82:83] op_sel:[0,0,0] op_sel_hi:[1,0,1]
v_pk_fma_f32 v[36:37], v[36:37], v[128:129], s[82:83] op_sel:[0,0,0] op_sel_hi:[1,0,1]
v_pk_fma_f32 v[34:35], v[34:35], v[128:129], s[82:83] op_sel:[0,0,0] op_sel_hi:[1,0,1]
v_pk_fma_f32 v[38:39], v[38:39], v[128:129], s[82:83] op_sel:[0,0,0] op_sel_hi:[1,0,1]
v_exp_f32_e64 v24, v24 clamp
v_exp_f32_e64 v28, v28 clamp
v_exp_f32_e64 v25, v25 clamp
v_exp_f32_e64 v29, v29 clamp
v_exp_f32_e64 v26, v26 clamp
v_exp_f32_e64 v30, v30 clamp
v_exp_f32_e64 v27, v27 clamp
v_exp_f32_e64 v31, v31 clamp
v_pk_add_f32 v[24:25], v[24:25], s[80:81]
v_pk_add_f32 v[28:29], v[28:29], s[80:81]
v_pk_add_f32 v[26:27], v[26:27], s[80:81]
v_pk_add_f32 v[30:31], v[30:31], s[80:81]
v_max_f32 v32, v32, v24
v_max_f32 v36, v36, v28
v_max_f32 v33, v33, v25
v_max_f32 v37, v37, v29
v_max_f32 v34, v34, v26
v_max_f32 v38, v38, v30
v_max_f32 v35, v35, v27
v_max_f32 v39, v39, v31
v_cvt_pk_bf16_f32 v32, v32, v33
v_cvt_pk_bf16_f32 v33, v34, v35
v_cvt_pk_bf16_f32 v34, v36, v37
v_cvt_pk_bf16_f32 v35, v38, v39
v_pk_fma_f32 v[56:57], v[144:145], v[10:11], v[56:57] op_sel:[0,0,0] op_sel_hi:[1,0,1]
v_pk_fma_f32 v[60:61], v[148:149], v[10:11], v[60:61] op_sel:[0,0,0] op_sel_hi:[1,0,1]
v_pk_fma_f32 v[58:59], v[146:147], v[10:11], v[58:59] op_sel:[0,0,0] op_sel_hi:[1,0,1]
v_pk_fma_f32 v[62:63], v[150:151], v[10:11], v[62:63] op_sel:[0,0,0] op_sel_hi:[1,0,1]
v_pk_mul_f32 v[24:25], v[56:57], v[22:23] op_sel:[0,0] op_sel_hi:[1,0]
v_pk_mul_f32 v[28:29], v[60:61], v[22:23] op_sel:[0,0] op_sel_hi:[1,0]
v_pk_mul_f32 v[26:27], v[58:59], v[22:23] op_sel:[0,0] op_sel_hi:[1,0]
v_pk_mul_f32 v[30:31], v[62:63], v[22:23] op_sel:[0,0] op_sel_hi:[1,0]
v_pk_fma_f32 v[56:57], v[56:57], v[130:131], s[82:83] op_sel:[0,0,0] op_sel_hi:[1,0,1]
v_pk_fma_f32 v[60:61], v[60:61], v[130:131], s[82:83] op_sel:[0,0,0] op_sel_hi:[1,0,1]
v_pk_fma_f32 v[58:59], v[58:59], v[130:131], s[82:83] op_sel:[0,0,0] op_sel_hi:[1,0,1]
v_pk_fma_f32 v[62:63], v[62:63], v[130:131], s[82:83] op_sel:[0,0,0] op_sel_hi:[1,0,1]
v_exp_f32_e64 v24, v24 clamp
v_exp_f32_e64 v28, v28 clamp
v_exp_f32_e64 v25, v25 clamp
v_exp_f32_e64 v29, v29 clamp
v_exp_f32_e64 v26, v26 clamp
v_exp_f32_e64 v30, v30 clamp
v_exp_f32_e64 v27, v27 clamp
v_exp_f32_e64 v31, v31 clamp
v_pk_add_f32 v[24:25], v[24:25], s[80:81]
v_pk_add_f32 v[28:29], v[28:29], s[80:81]
v_pk_add_f32 v[26:27], v[26:27], s[80:81]
v_pk_add_f32 v[30:31], v[30:31], s[80:81]
v_max_f32 v56, v56, v24
v_max_f32 v60, v60, v28
v_max_f32 v57, v57, v25
v_max_f32 v61, v61, v29
v_max_f32 v58, v58, v26
v_max_f32 v62, v62, v30
v_max_f32 v59, v59, v27
v_max_f32 v63, v63, v31
v_cvt_pk_bf16_f32 v56, v56, v57
v_cvt_pk_bf16_f32 v57, v58, v59
v_cvt_pk_bf16_f32 v58, v60, v61
v_cvt_pk_bf16_f32 v59, v62, v63
v_pk_fma_f32 v[80:81], v[144:145], v[12:13], v[80:81] op_sel:[0,0,0] op_sel_hi:[1,0,1]
v_pk_fma_f32 v[84:85], v[148:149], v[12:13], v[84:85] op_sel:[0,0,0] op_sel_hi:[1,0,1]
v_pk_fma_f32 v[82:83], v[146:147], v[12:13], v[82:83] op_sel:[0,0,0] op_sel_hi:[1,0,1]
v_pk_fma_f32 v[86:87], v[150:151], v[12:13], v[86:87] op_sel:[0,0,0] op_sel_hi:[1,0,1]
v_pk_mul_f32 v[24:25], v[80:81], v[4:5] op_sel:[0,0] op_sel_hi:[1,0]
v_pk_mul_f32 v[28:29], v[84:85], v[4:5] op_sel:[0,0] op_sel_hi:[1,0]
v_pk_mul_f32 v[26:27], v[82:83], v[4:5] op_sel:[0,0] op_sel_hi:[1,0]
v_pk_mul_f32 v[30:31], v[86:87], v[4:5] op_sel:[0,0] op_sel_hi:[1,0]
v_pk_fma_f32 v[80:81], v[80:81], v[132:133], s[82:83] op_sel:[0,0,0] op_sel_hi:[1,0,1]
v_pk_fma_f32 v[84:85], v[84:85], v[132:133], s[82:83] op_sel:[0,0,0] op_sel_hi:[1,0,1]
v_pk_fma_f32 v[82:83], v[82:83], v[132:133], s[82:83] op_sel:[0,0,0] op_sel_hi:[1,0,1]
v_pk_fma_f32 v[86:87], v[86:87], v[132:133], s[82:83] op_sel:[0,0,0] op_sel_hi:[1,0,1]
v_exp_f32_e64 v24, v24 clamp
v_exp_f32_e64 v28, v28 clamp
v_exp_f32_e64 v25, v25 clamp
v_exp_f32_e64 v29, v29 clamp
v_exp_f32_e64 v26, v26 clamp
v_exp_f32_e64 v30, v30 clamp
v_exp_f32_e64 v27, v27 clamp
v_exp_f32_e64 v31, v31 clamp
v_pk_add_f32 v[24:25], v[24:25], s[80:81]
v_pk_add_f32 v[28:29], v[28:29], s[80:81]
v_pk_add_f32 v[26:27], v[26:27], s[80:81]
v_pk_add_f32 v[30:31], v[30:31], s[80:81]
v_max_f32 v80, v80, v24
v_max_f32 v84, v84, v28
v_max_f32 v81, v81, v25
v_max_f32 v85, v85, v29
v_max_f32 v82, v82, v26
v_max_f32 v86, v86, v30
v_max_f32 v83, v83, v27
v_max_f32 v87, v87, v31
v_cvt_pk_bf16_f32 v80, v80, v81
v_cvt_pk_bf16_f32 v81, v82, v83
v_cvt_pk_bf16_f32 v82, v84, v85
v_cvt_pk_bf16_f32 v83, v86, v87
v_pk_fma_f32 v[104:105], v[144:145], v[14:15], v[104:105] op_sel:[0,0,0] op_sel_hi:[1,0,1]
v_pk_fma_f32 v[108:109], v[148:149], v[14:15], v[108:109] op_sel:[0,0,0] op_sel_hi:[1,0,1]
v_pk_fma_f32 v[106:107], v[146:147], v[14:15], v[106:107] op_sel:[0,0,0] op_sel_hi:[1,0,1]
v_pk_fma_f32 v[110:111], v[150:151], v[14:15], v[110:111] op_sel:[0,0,0] op_sel_hi:[1,0,1]
v_pk_mul_f32 v[24:25], v[104:105], v[6:7] op_sel:[0,0] op_sel_hi:[1,0]
v_pk_mul_f32 v[28:29], v[108:109], v[6:7] op_sel:[0,0] op_sel_hi:[1,0]
v_pk_mul_f32 v[26:27], v[106:107], v[6:7] op_sel:[0,0] op_sel_hi:[1,0]
v_pk_mul_f32 v[30:31], v[110:111], v[6:7] op_sel:[0,0] op_sel_hi:[1,0]
v_pk_fma_f32 v[104:105], v[104:105], v[134:135], s[82:83] op_sel:[0,0,0] op_sel_hi:[1,0,1]
v_pk_fma_f32 v[108:109], v[108:109], v[134:135], s[82:83] op_sel:[0,0,0] op_sel_hi:[1,0,1]
v_pk_fma_f32 v[106:107], v[106:107], v[134:135], s[82:83] op_sel:[0,0,0] op_sel_hi:[1,0,1]
v_pk_fma_f32 v[110:111], v[110:111], v[134:135], s[82:83] op_sel:[0,0,0] op_sel_hi:[1,0,1]
v_exp_f32_e64 v24, v24 clamp
v_exp_f32_e64 v28, v28 clamp
v_exp_f32_e64 v25, v25 clamp
v_exp_f32_e64 v29, v29 clamp
v_exp_f32_e64 v26, v26 clamp
v_exp_f32_e64 v30, v30 clamp
v_exp_f32_e64 v27, v27 clamp
v_exp_f32_e64 v31, v31 clamp
v_pk_add_f32 v[24:25], v[24:25], s[80:81]
v_pk_add_f32 v[28:29], v[28:29], s[80:81]
v_pk_add_f32 v[26:27], v[26:27], s[80:81]
v_pk_add_f32 v[30:31], v[30:31], s[80:81]
v_max_f32 v104, v104, v24
v_max_f32 v108, v108, v28
v_max_f32 v105, v105, v25
v_max_f32 v109, v109, v29
v_max_f32 v106, v106, v26
v_max_f32 v110, v110, v30
v_max_f32 v107, v107, v27
v_max_f32 v111, v111, v31
v_cvt_pk_bf16_f32 v104, v104, v105
v_cvt_pk_bf16_f32 v105, v106, v107
v_cvt_pk_bf16_f32 v106, v108, v109
v_cvt_pk_bf16_f32 v107, v110, v111
v_lshrrev_b32_e64 v2, 4, v1
v_bfe_u32 v3, v1, 2, 2
v_lshl_add_u32 v4, v2, 2, v3
v_lshlrev_b32 v5, 7, v4
v_bfe_u32 v4, v4, 1, 2
v_lshl_add_u32 v5, v4, 5, v5
v_and_b32 v4, 3, v1
v_lshl_add_u32 v5, v4, 3, v5
v_add_u32 v8, 28672, v5
v_xor_b32 v9, 32, v8
v_xor_b32 v10, 64, v8
v_xor_b32 v11, 96, v8
v_add_u32 v12, 65536, v8
v_add_u32 v13, 65536, v9
v_add_u32 v14, 65536, v10
v_add_u32 v15, 65536, v11
v_and_b32 v3, 15, v1
v_lshrrev_b32 v4, 1, v3
v_lshrrev_b32 v5, 1, v2
v_xor_b32 v4, v4, v5
v_lshlrev_b32 v4, 4, v4
v_lshl_add_u32 v4, v3, 7, v4
v_and_b32 v5, 1, v2
v_lshl_add_u32 v4, v5, 3, v4
s_lshl_b32 s70, s60, 12
v_add_u32 v20, s70, v4
v_xor_b32 v21, 32, v20
v_xor_b32 v22, 64, v20
v_xor_b32 v23, 96, v20
s_and_b32 s74, s64, 7
s_lshl_b32 s74, s74, 19
s_lshr_b32 s70, s64, 1
s_xor_b32 s70, s70, s64
s_and_b32 s70, s70, 4
s_lshl_b32 s70, s70, 11
s_xor_b32 s70, s70, 2105344
s_add_u32 s74, s74, s70
s_mul_i32 s70, s60, 131072
s_add_u32 s74, s74, s70
s_xor_b32 s74, s74, s61
v_add_u32 v6, s74, v16
v_add_u32 v19, 65536, v6
s_and_b32 s70, s89, 12
s_add_u32 s74, s89, s70
s_lshl_b32 s74, s74, 11
s_mul_i32 s70, s62, 5
s_add_u32 s70, s70, s65
s_mul_i32 s71, s70, 86
s_lshr_b32 s71, s71, 10
s_mul_i32 s71, s71, 12
s_sub_u32 s70, s70, s71
s_lshl_b32 s70, s70, 2
s_mov_b32 s0, 0x98765410
s_mov_b32 s1, 0xfedc
s_sub_u32 s71, 48, s70
s_lshl_b64 s[72:73], s[0:1], s71
s_lshr_b64 s[0:1], s[0:1], s70
s_or_b64 s[0:1], s[0:1], s[72:73]
s_lshl_b64 s[0:1], s[0:1], 16
s_or_b32 s0, s0, 0x2ab3
s_bfe_u32 s70, s0, 0x40000
s_and_b32 s71, s70, 12
s_add_u32 s70, s70, s71
s_lshl_b32 s24, s70, 11
s_bfe_u32 s70, s0, 0x40004
s_and_b32 s71, s70, 12
s_add_u32 s70, s70, s71
s_lshl_b32 s25, s70, 11
s_bfe_u32 s70, s0, 0x40008
s_and_b32 s71, s70, 12
s_add_u32 s70, s70, s71
s_lshl_b32 s26, s70, 11
s_bfe_u32 s70, s0, 0x4000c
s_and_b32 s71, s70, 12
s_add_u32 s70, s70, s71
s_lshl_b32 s27, s70, 11
s_bfe_u32 s70, s0, 0x40010
s_and_b32 s71, s70, 12
s_add_u32 s70, s70, s71
s_lshl_b32 s28, s70, 11
s_bfe_u32 s70, s0, 0x40014
s_and_b32 s71, s70, 12
s_add_u32 s70, s70, s71
s_lshl_b32 s29, s70, 11
s_bfe_u32 s70, s0, 0x40018
s_and_b32 s71, s70, 12
s_add_u32 s70, s70, s71
s_lshl_b32 s30, s70, 11
s_bfe_u32 s70, s0, 0x4001c
s_and_b32 s71, s70, 12
s_add_u32 s70, s70, s71
s_lshl_b32 s31, s70, 11
s_bfe_u32 s70, s1, 0x40000
s_and_b32 s71, s70, 12
s_add_u32 s70, s70, s71
s_lshl_b32 s32, s70, 11
s_bfe_u32 s70, s1, 0x40004
s_and_b32 s71, s70, 12
s_add_u32 s70, s70, s71
s_lshl_b32 s33, s70, 11
s_bfe_u32 s70, s1, 0x40008
s_and_b32 s71, s70, 12
s_add_u32 s70, s70, s71
s_lshl_b32 s34, s70, 11
s_bfe_u32 s70, s1, 0x4000c
s_and_b32 s71, s70, 12
s_add_u32 s70, s70, s71
s_lshl_b32 s35, s70, 11
s_bfe_u32 s70, s1, 0x40010
s_and_b32 s71, s70, 12
s_add_u32 s70, s70, s71
s_lshl_b32 s36, s70, 11
s_bfe_u32 s70, s1, 0x40014
s_and_b32 s71, s70, 12
s_add_u32 s70, s70, s71
s_lshl_b32 s37, s70, 11
s_bfe_u32 s70, s1, 0x40018
s_and_b32 s71, s70, 12
s_add_u32 s70, s70, s71
s_lshl_b32 s38, s70, 11
s_bfe_u32 s70, s1, 0x4001c
s_and_b32 s71, s70, 12
s_add_u32 s70, s70, s71
s_lshl_b32 s39, s70, 11
L_E2:
s_barrier
ds_read_b128 a[8:11], v18
buffer_load_dwordx4 v[136:139], v17, s[12:15], 0 offen sc1
buffer_load_dwordx4 v[140:143], v17, s[12:15], 0 offen offset:1024 sc1
s_waitcnt lgkmcnt(0)
v_mfma_f32_16x16x32_bf16 v[48:51], a[8:11], v[32:35], 0
v_mfma_f32_16x16x32_bf16 v[72:75], a[8:11], v[56:59], 0
v_mfma_f32_16x16x32_bf16 v[96:99], a[8:11], v[80:83], 0
v_mfma_f32_16x16x32_bf16 v[120:123], a[8:11], v[104:107], 0
s_branch L_over6
L_pad6:
s_branch L_retF
L_over6:
s_nop 4
v_add_f32 v48, s80, v48
v_rcp_f32 v48, v48
v_add_f32 v72, s80, v72
v_rcp_f32 v72, v72
v_add_f32 v96, s80, v96
v_rcp_f32 v96, v96
v_add_f32 v120, s80, v120
v_rcp_f32 v120, v120
s_waitcnt vmcnt(0)
L_k2_chk:
v_max_u32_e64 v2, v136, v140
v_cmp_eq_u32 vcc, -1, v2
s_cbranch_vccnz L_k2_rt
L_k2_ok:
s_barrier
v_mfma_f32_16x16x32_bf16 v[40:43], v[136:139], v[32:35], 0
v_mfma_f32_16x16x32_bf16 v[44:47], v[140:143], v[32:35], 0
v_mfma_f32_16x16x32_bf16 v[64:67], v[136:139], v[56:59], 0
v_mfma_f32_16x16x32_bf16 v[68:71], v[140:143], v[56:59], 0
v_mfma_f32_16x16x32_bf16 v[88:91], v[136:139], v[80:83], 0
v_mfma_f32_16x16x32_bf16 v[92:95], v[140:143], v[80:83], 0
v_mfma_f32_16x16x32_bf16 v[112:115], v[136:139], v[104:107], 0
v_mfma_f32_16x16x32_bf16 v[116:119], v[140:143], v[104:107], 0
s_lshr_b32 s71, s65, 1
s_xor_b32 s71, s71, s62
s_xor_b32 s70, s69, 1
s_or_b32 s71, s71, s70
v_pk_mul_f32 v[40:41], v[40:41], v[48:49] op_sel_hi:[1,0]
v_pk_mul_f32 v[42:43], v[42:43], v[48:49] op_sel_hi:[1,0]
v_pk_mul_f32 v[44:45], v[44:45], v[48:49] op_sel_hi:[1,0]
v_pk_mul_f32 v[46:47], v[46:47], v[48:49] op_sel_hi:[1,0]
v_cvt_pk_bf16_f32 v52, v40, v41
v_cvt_pk_bf16_f32 v53, v42, v43
v_cvt_pk_bf16_f32 v54, v44, v45
v_cvt_pk_bf16_f32 v55, v46, v47
s_add_u32 s70, s88, 0
s_cmp_eq_u32 s71, 0
s_cbranch_scc1 L_oown0
buffer_store_dwordx4 v[52:55], v16, s[12:15], s70 offen sc1
L_ood0:
v_pk_mul_f32 v[64:65], v[64:65], v[72:73] op_sel_hi:[1,0]
v_pk_mul_f32 v[66:67], v[66:67], v[72:73] op_sel_hi:[1,0]
v_pk_mul_f32 v[68:69], v[68:69], v[72:73] op_sel_hi:[1,0]
v_pk_mul_f32 v[70:71], v[70:71], v[72:73] op_sel_hi:[1,0]
v_cvt_pk_bf16_f32 v76, v64, v65
v_cvt_pk_bf16_f32 v77, v66, v67
v_cvt_pk_bf16_f32 v78, v68, v69
v_cvt_pk_bf16_f32 v79, v70, v71
s_add_u32 s70, s88, 65536
s_cmp_eq_u32 s71, 0
s_cbranch_scc1 L_oown1
buffer_store_dwordx4 v[76:79], v16, s[12:15], s70 offen sc1
L_ood1:
v_pk_mul_f32 v[88:89], v[88:89], v[96:97] op_sel_hi:[1,0]
v_pk_mul_f32 v[90:91], v[90:91], v[96:97] op_sel_hi:[1,0]
v_pk_mul_f32 v[92:93], v[92:93], v[96:97] op_sel_hi:[1,0]
v_pk_mul_f32 v[94:95], v[94:95], v[96:97] op_sel_hi:[1,0]
v_cvt_pk_bf16_f32 v100, v88, v89
v_cvt_pk_bf16_f32 v101, v90, v91
v_cvt_pk_bf16_f32 v102, v92, v93
v_cvt_pk_bf16_f32 v103, v94, v95
s_add_u32 s70, s88, 131072
s_cmp_eq_u32 s71, 0
s_cbranch_scc1 L_oown2
buffer_store_dwordx4 v[100:103], v16, s[12:15], s70 offen sc1
L_ood2:
v_pk_mul_f32 v[112:113], v[112:113], v[120:121] op_sel_hi:[1,0]
v_pk_mul_f32 v[114:115], v[114:115], v[120:121] op_sel_hi:[1,0]
v_pk_mul_f32 v[116:117], v[116:117], v[120:121] op_sel_hi:[1,0]
v_pk_mul_f32 v[118:119], v[118:119], v[120:121] op_sel_hi:[1,0]
v_cvt_pk_bf16_f32 v124, v112, v113
v_cvt_pk_bf16_f32 v125, v114, v115
v_cvt_pk_bf16_f32 v126, v116, v117
v_cvt_pk_bf16_f32 v127, v118, v119
s_add_u32 s70, s88, 196608
s_cmp_eq_u32 s71, 0
s_cbranch_scc1 L_oown3
buffer_store_dwordx4 v[124:127], v16, s[12:15], s70 offen sc1
L_ood3:
v_xor_b32 v7, s76, v7
buffer_load_dwordx4 v[56:59], v6, s[12:15], s24 offen offset:0 sc1
buffer_load_dwordx4 v[60:63], v19, s[12:15], s24 offen offset:0 sc1
buffer_load_dwordx4 v[64:67], v6, s[12:15], s24 offen offset:1024 sc1
buffer_load_dwordx4 v[68:71], v19, s[12:15], s24 offen offset:1024 sc1
ds_read_b64 v[26:27], v20 offset:0
ds_read_b64 v[30:31], v21 offset:0
ds_read_b64 v[34:35], v22 offset:0
ds_read_b64 v[38:39], v23 offset:0
ds_read_b64 v[42:43], v20 offset:2048
ds_read_b64 v[46:47], v21 offset:2048
ds_read_b64 v[50:51], v22 offset:2048
ds_read_b64 v[54:55], v23 offset:2048
s_waitcnt lgkmcnt(0)
ds_read_b64_tr_b16 a[0:1], v8 offset:0
ds_read_b64_tr_b16 a[2:3], v8 offset:2048
ds_read_b64_tr_b16 a[4:5], v9 offset:0
ds_read_b64_tr_b16 a[6:7], v9 offset:2048
ds_read_b64_tr_b16 a[8:9], v10 offset:0
ds_read_b64_tr_b16 a[10:11], v10 offset:2048
ds_read_b64_tr_b16 a[12:13], v11 offset:0
ds_read_b64_tr_b16 a[14:15], v11 offset:2048
ds_read_b64_tr_b16 a[16:17], v8 offset:4096
ds_read_b64_tr_b16 a[18:19], v8 offset:6144
ds_read_b64_tr_b16 a[20:21], v9 offset:4096
ds_read_b64_tr_b16 a[22:23], v9 offset:6144
ds_read_b64_tr_b16 a[24:25], v10 offset:4096
ds_read_b64_tr_b16 a[26:27], v10 offset:6144
ds_read_b64_tr_b16 a[28:29], v11 offset:4096
ds_read_b64_tr_b16 a[30:31], v11 offset:6144
v_lshlrev_b32 v24, 16, v26
v_and_b32 v25, 0xffff0000, v26
v_lshlrev_b32 v26, 16, v27
v_and_b32 v27, 0xffff0000, v27
v_lshlrev_b32 v28, 16, v30
v_and_b32 v29, 0xffff0000, v30
v_lshlrev_b32 v30, 16, v31
v_and_b32 v31, 0xffff0000, v31
v_lshlrev_b32 v32, 16, v34
v_and_b32 v33, 0xffff0000, v34
v_lshlrev_b32 v34, 16, v35
v_and_b32 v35, 0xffff0000, v35
v_lshlrev_b32 v36, 16, v38
v_and_b32 v37, 0xffff0000, v38
v_lshlrev_b32 v38, 16, v39
v_and_b32 v39, 0xffff0000, v39
v_lshlrev_b32 v40, 16, v42
v_and_b32 v41, 0xffff0000, v42
v_lshlrev_b32 v42, 16, v43
v_and_b32 v43, 0xffff0000, v43
v_lshlrev_b32 v44, 16, v46
v_and_b32 v45, 0xffff0000, v46
v_lshlrev_b32 v46, 16, v47
v_and_b32 v47, 0xffff0000, v47
v_lshlrev_b32 v48, 16, v50
v_and_b32 v49, 0xffff0000, v50
v_lshlrev_b32 v50, 16, v51
v_and_b32 v51, 0xffff0000, v51
v_lshlrev_b32 v52, 16, v54
v_and_b32 v53, 0xffff0000, v54
v_lshlrev_b32 v54, 16, v55
v_and_b32 v55, 0xffff0000, v55
v_lshrrev_b32 v2, 4, v1
v_lshlrev_b32 v2, 3, v2
v_add_u32 v2, 162048, v2
v_mov_b32 v3, 162176
ds_read_b64 v[136:137], v2 offset:0
ds_read_b64 v[138:139], v2 offset:32
ds_read_b64 v[140:141], v2 offset:64
ds_read_b64 v[142:143], v2 offset:96
ds_read_b128 v[148:151], v3
s_waitcnt lgkmcnt(0)
v_add_f32 v148, v148, v149
v_add_f32 v150, v150, v151
v_add_f32 v148, v148, v150
s_nop 0
v_readfirstlane_b32 s84, v148
v_and_b32 v2, 3, v1
v_cmp_eq_u32 vcc, 0, v2
v_mov_b32 v3, 0x3f803f80
s_nop 0
v_cndmask_b32 v3, 0, v3, vcc
v_cmp_eq_u32_e64 vcc, 2, v2
s_nop 1
v_cndmask_b32 v120, v3, v136, vcc
v_cndmask_b32 v121, v3, v137, vcc
v_cndmask_b32 v122, v3, v138, vcc
v_cndmask_b32 v123, v3, v139, vcc
v_cndmask_b32 v124, v3, v140, vcc
v_cndmask_b32 v125, v3, v141, vcc
v_cndmask_b32 v126, v3, v142, vcc
v_cndmask_b32 v127, v3, v143, vcc
v_and_b32 v2, 15, v1
v_lshrrev_b32 v3, 5, v1
v_lshlrev_b32 v4, 4, v2
v_mov_b32 v144, v4
s_lshl_b32 s75, s64, 15
s_lshl_b32 s70, s60, 9
s_add_u32 s75, s75, s70
s_add_u32 s75, s75, 6291456
s_lshl_b32 s70, s65, 11
s_add_u32 s72, s75, s70
s_mov_b32 s92, 0x00f0000f
s_mov_b32 s93, 0xf0000f00
s_mov_b32 s80, 0x22222222
s_mov_b32 s81, 0x22222222
s_mov_b32 s82, 0x44444444
s_mov_b32 s83, 0x44444444
s_mov_b32 s90, 0x88888888
s_mov_b32 s91, 0x88888888
v_and_b32_e64 v2, 31, v1
v_lshlrev_b32 v5, 4, v2
v_lshl_add_u32 v145, v3, 11, v5
s_lshl_b32 s70, s64, 7
s_lshl_b32 s71, s60, 5
s_add_u32 s70, s70, s71
s_add_u32 s87, s70, 6815744
s_lshr_b32 s70, s70, 4
v_lshl_add_u32 v146, v2, 7, s70
s_lshl_b32 s70, s64, 2
s_add_u32 s70, s70, s60
s_lshl_b32 s70, s70, 15
s_lshl_b32 s71, s65, 7
s_add_u32 s70, s70, s71
s_add_u32 s88, s70, 8388608
v_bfe_u32 v2, v1, 3, 1
v_and_b32 v3, 7, v1
v_lshlrev_b32 v147, 14, v2
v_lshl_add_u32 v147, v3, 4, v147
v_bfe_u32 v2, v1, 4, 1
v_lshl_add_u32 v147, v2, 13, v147
buffer_load_dwordx4 v[72:75], v6, s[12:15], s25 offen offset:0 sc1
buffer_load_dwordx4 v[76:79], v19, s[12:15], s25 offen offset:0 sc1
buffer_load_dwordx4 v[80:83], v6, s[12:15], s25 offen offset:1024 sc1
buffer_load_dwordx4 v[84:87], v19, s[12:15], s25 offen offset:1024 sc1
buffer_load_dwordx4 v[88:91], v6, s[12:15], s26 offen offset:0 sc1
buffer_load_dwordx4 v[92:95], v19, s[12:15], s26 offen offset:0 sc1
buffer_load_dwordx4 v[96:99], v6, s[12:15], s26 offen offset:1024 sc1
buffer_load_dwordx4 v[100:103], v19, s[12:15], s26 offen offset:1024 sc1
s_waitcnt vmcnt(8)
v_max3_u32 v2, v56, v60, v64
v_max_u32 v2, v2, v68
v_cmp_eq_u32_e64 vcc, -1, v2
s_cbranch_vccnz L_o0_rt
L_o0_ok:
s_waitcnt lgkmcnt(8)
v_mfma_f32_16x16x32_bf16 v[24:27], a[0:3], v[56:59], v[24:27]
ds_read_b64_tr_b16 a[32:33], v8 offset:8192
ds_read_b64_tr_b16 a[34:35], v8 offset:10240
v_mfma_f32_16x16x32_bf16 v[40:43], a[0:3], v[60:63], v[40:43]
buffer_load_dwordx4 v[104:107], v6, s[12:15], s27 offen offset:0 sc1
v_mfma_f32_16x16x32_bf16 v[28:31], a[4:7], v[56:59], v[28:31]
ds_read_b64_tr_b16 a[36:37], v9 offset:8192
ds_read_b64_tr_b16 a[38:39], v9 offset:10240
v_mfma_f32_16x16x32_bf16 v[44:47], a[4:7], v[60:63], v[44:47]
buffer_load_dwordx4 v[108:111], v19, s[12:15], s27 offen offset:0 sc1
v_mfma_f32_16x16x32_bf16 v[32:35], a[8:11], v[56:59], v[32:35]
ds_read_b64_tr_b16 a[40:41], v10 offset:8192
ds_read_b64_tr_b16 a[42:43], v10 offset:10240
v_mfma_f32_16x16x32_bf16 v[48:51], a[8:11], v[60:63], v[48:51]
buffer_load_dwordx4 v[112:115], v6, s[12:15], s27 offen offset:1024 sc1
v_mfma_f32_16x16x32_bf16 v[36:39], a[12:15], v[56:59], v[36:39]
ds_read_b64_tr_b16 a[44:45], v11 offset:8192
ds_read_b64_tr_b16 a[46:47], v11 offset:10240
v_mfma_f32_16x16x32_bf16 v[52:55], a[12:15], v[60:63], v[52:55]
buffer_load_dwordx4 v[116:119], v19, s[12:15], s27 offen offset:1024 sc1
s_waitcnt lgkmcnt(8)
v_mfma_f32_16x16x32_bf16 v[24:27], a[16:19], v[64:67], v[24:27]
ds_read_b64_tr_b16 a[0:1], v8 offset:12288
s_waitcnt vmcnt(8)
v_mfma_f32_16x16x32_bf16 v[40:43], a[16:19], v[68:71], v[40:43]
ds_read_b64_tr_b16 a[2:3], v8 offset:14336
v_max3_u32 v2, v72, v76, v80
v_mfma_f32_16x16x32_bf16 v[28:31], a[20:23], v[64:67], v[28:31]
ds_read_b64_tr_b16 a[4:5], v9 offset:12288
v_max_u32 v2, v2, v84
v_mfma_f32_16x16x32_bf16 v[44:47], a[20:23], v[68:71], v[44:47]
ds_read_b64_tr_b16 a[6:7], v9 offset:14336
v_cmp_eq_u32 vcc, -1, v2
v_mfma_f32_16x16x32_bf16 v[32:35], a[24:27], v[64:67], v[32:35]
ds_read_b64_tr_b16 a[8:9], v10 offset:12288
v_mfma_f32_16x16x32_bf16 v[48:51], a[24:27], v[68:71], v[48:51]
ds_read_b64_tr_b16 a[10:11], v10 offset:14336
v_mfma_f32_16x16x32_bf16 v[36:39], a[28:31], v[64:67], v[36:39]
ds_read_b64_tr_b16 a[12:13], v11 offset:12288
ds_read_b64_tr_b16 a[14:15], v11 offset:14336
v_mfma_f32_16x16x32_bf16 v[52:55], a[28:31], v[68:71], v[52:55]
s_cbranch_vccnz L_o1_rt
L_o1_ok:
s_waitcnt lgkmcnt(8)
v_mfma_f32_16x16x32_bf16 v[24:27], a[32:35], v[72:75], v[24:27]
ds_read_b64_tr_b16 a[16:17], v8 offset:16384
ds_read_b64_tr_b16 a[18:19], v8 offset:18432
v_mfma_f32_16x16x32_bf16 v[40:43], a[32:35], v[76:79], v[40:43]
buffer_load_dwordx4 v[56:59], v6, s[12:15], s28 offen offset:0 sc1
v_mfma_f32_16x16x32_bf16 v[28:31], a[36:39], v[72:75], v[28:31]
ds_read_b64_tr_b16 a[20:21], v9 offset:16384
ds_read_b64_tr_b16 a[22:23], v9 offset:18432
v_mfma_f32_16x16x32_bf16 v[44:47], a[36:39], v[76:79], v[44:47]
buffer_load_dwordx4 v[60:63], v19, s[12:15], s28 offen offset:0 sc1
v_mfma_f32_16x16x32_bf16 v[32:35], a[40:43], v[72:75], v[32:35]
ds_read_b64_tr_b16 a[24:25], v10 offset:16384
ds_read_b64_tr_b16 a[26:27], v10 offset:18432
v_mfma_f32_16x16x32_bf16 v[48:51], a[40:43], v[76:79], v[48:51]
buffer_load_dwordx4 v[64:67], v6, s[12:15], s28 offen offset:1024 sc1
v_mfma_f32_16x16x32_bf16 v[36:39], a[44:47], v[72:75], v[36:39]
ds_read_b64_tr_b16 a[28:29], v11 offset:16384
ds_read_b64_tr_b16 a[30:31], v11 offset:18432
v_mfma_f32_16x16x32_bf16 v[52:55], a[44:47], v[76:79], v[52:55]
buffer_load_dwordx4 v[68:71], v19, s[12:15], s28 offen offset:1024 sc1
s_waitcnt lgkmcnt(8)
v_mfma_f32_16x16x32_bf16 v[24:27], a[0:3], v[80:83], v[24:27]
ds_read_b64_tr_b16 a[32:33], v8 offset:20480
s_waitcnt vmcnt(8)
v_mfma_f32_16x16x32_bf16 v[40:43], a[0:3], v[84:87], v[40:43]
ds_read_b64_tr_b16 a[34:35], v8 offset:22528
v_max3_u32 v2, v88, v92, v96
v_mfma_f32_16x16x32_bf16 v[28:31], a[4:7], v[80:83], v[28:31]
ds_read_b64_tr_b16 a[36:37], v9 offset:20480
v_max_u32 v2, v2, v100
v_mfma_f32_16x16x32_bf16 v[44:47], a[4:7], v[84:87], v[44:47]
ds_read_b64_tr_b16 a[38:39], v9 offset:22528
v_cmp_eq_u32 vcc, -1, v2
v_mfma_f32_16x16x32_bf16 v[32:35], a[8:11], v[80:83], v[32:35]
ds_read_b64_tr_b16 a[40:41], v10 offset:20480
v_mfma_f32_16x16x32_bf16 v[48:51], a[8:11], v[84:87], v[48:51]
ds_read_b64_tr_b16 a[42:43], v10 offset:22528
v_mfma_f32_16x16x32_bf16 v[36:39], a[12:15], v[80:83], v[36:39]
ds_read_b64_tr_b16 a[44:45], v11 offset:20480
ds_read_b64_tr_b16 a[46:47], v11 offset:22528
v_mfma_f32_16x16x32_bf16 v[52:55], a[12:15], v[84:87], v[52:55]
s_cbranch_vccnz L_o2_rt
L_o2_ok:
s_waitcnt lgkmcnt(8)
v_mfma_f32_16x16x32_bf16 v[24:27], a[16:19], v[88:91], v[24:27]
ds_read_b64_tr_b16 a[0:1], v8 offset:24576
ds_read_b64_tr_b16 a[2:3], v8 offset:26624
v_mfma_f32_16x16x32_bf16 v[40:43], a[16:19], v[92:95], v[40:43]
buffer_load_dwordx4 v[72:75], v6, s[12:15], s29 offen offset:0 sc1
v_mfma_f32_16x16x32_bf16 v[28:31], a[20:23], v[88:91], v[28:31]
ds_read_b64_tr_b16 a[4:5], v9 offset:24576
ds_read_b64_tr_b16 a[6:7], v9 offset:26624
v_mfma_f32_16x16x32_bf16 v[44:47], a[20:23], v[92:95], v[44:47]
buffer_load_dwordx4 v[76:79], v19, s[12:15], s29 offen offset:0 sc1
v_mfma_f32_16x16x32_bf16 v[32:35], a[24:27], v[88:91], v[32:35]
ds_read_b64_tr_b16 a[8:9], v10 offset:24576
ds_read_b64_tr_b16 a[10:11], v10 offset:26624
v_mfma_f32_16x16x32_bf16 v[48:51], a[24:27], v[92:95], v[48:51]
buffer_load_dwordx4 v[80:83], v6, s[12:15], s29 offen offset:1024 sc1
v_mfma_f32_16x16x32_bf16 v[36:39], a[28:31], v[88:91], v[36:39]
ds_read_b64_tr_b16 a[12:13], v11 offset:24576
ds_read_b64_tr_b16 a[14:15], v11 offset:26624
v_mfma_f32_16x16x32_bf16 v[52:55], a[28:31], v[92:95], v[52:55]
buffer_load_dwordx4 v[84:87], v19, s[12:15], s29 offen offset:1024 sc1
s_waitcnt lgkmcnt(8)
v_mfma_f32_16x16x32_bf16 v[24:27], a[32:35], v[96:99], v[24:27]
ds_read_b64_tr_b16 a[16:17], v8 offset:28672
s_waitcnt vmcnt(8)
v_mfma_f32_16x16x32_bf16 v[40:43], a[32:35], v[100:103], v[40:43]
ds_read_b64_tr_b16 a[18:19], v8 offset:30720
v_max3_u32 v2, v104, v108, v112
v_mfma_f32_16x16x32_bf16 v[28:31], a[36:39], v[96:99], v[28:31]
ds_read_b64_tr_b16 a[20:21], v9 offset:28672
v_max_u32 v2, v2, v116
v_mfma_f32_16x16x32_bf16 v[44:47], a[36:39], v[100:103], v[44:47]
ds_read_b64_tr_b16 a[22:23], v9 offset:30720
v_cmp_eq_u32 vcc, -1, v2
v_mfma_f32_16x16x32_bf16 v[32:35], a[40:43], v[96:99], v[32:35]
ds_read_b64_tr_b16 a[24:25], v10 offset:28672
v_mfma_f32_16x16x32_bf16 v[48:51], a[40:43], v[100:103], v[48:51]
ds_read_b64_tr_b16 a[26:27], v10 offset:30720
v_mfma_f32_16x16x32_bf16 v[36:39], a[44:47], v[96:99], v[36:39]
ds_read_b64_tr_b16 a[28:29], v11 offset:28672
ds_read_b64_tr_b16 a[30:31], v11 offset:30720
v_mfma_f32_16x16x32_bf16 v[52:55], a[44:47], v[100:103], v[52:55]
s_cbranch_vccnz L_o3_rt
L_o3_ok:
s_waitcnt lgkmcnt(8)
v_mfma_f32_16x16x32_bf16 v[24:27], a[0:3], v[104:107], v[24:27]
ds_read_b64_tr_b16 a[32:33], v8 offset:32768
ds_read_b64_tr_b16 a[34:35], v8 offset:34816
v_mfma_f32_16x16x32_bf16 v[40:43], a[0:3], v[108:111], v[40:43]
buffer_load_dwordx4 v[88:91], v6, s[12:15], s30 offen offset:0 sc1
v_mfma_f32_16x16x32_bf16 v[28:31], a[4:7], v[104:107], v[28:31]
ds_read_b64_tr_b16 a[36:37], v9 offset:32768
ds_read_b64_tr_b16 a[38:39], v9 offset:34816
v_mfma_f32_16x16x32_bf16 v[44:47], a[4:7], v[108:111], v[44:47]
buffer_load_dwordx4 v[92:95], v19, s[12:15], s30 offen offset:0 sc1
v_mfma_f32_16x16x32_bf16 v[32:35], a[8:11], v[104:107], v[32:35]
ds_read_b64_tr_b16 a[40:41], v10 offset:32768
ds_read_b64_tr_b16 a[42:43], v10 offset:34816
v_mfma_f32_16x16x32_bf16 v[48:51], a[8:11], v[108:111], v[48:51]
buffer_load_dwordx4 v[96:99], v6, s[12:15], s30 offen offset:1024 sc1
v_mfma_f32_16x16x32_bf16 v[36:39], a[12:15], v[104:107], v[36:39]
ds_read_b64_tr_b16 a[44:45], v11 offset:32768
ds_read_b64_tr_b16 a[46:47], v11 offset:34816
v_mfma_f32_16x16x32_bf16 v[52:55], a[12:15], v[108:111], v[52:55]
buffer_load_dwordx4 v[100:103], v19, s[12:15], s30 offen offset:1024 sc1
s_waitcnt lgkmcnt(8)
v_mfma_f32_16x16x32_bf16 v[24:27], a[16:19], v[112:115], v[24:27]
ds_read_b64_tr_b16 a[0:1], v8 offset:36864
s_waitcnt vmcnt(8)
v_mfma_f32_16x16x32_bf16 v[40:43], a[16:19], v[116:119], v[40:43]
ds_read_b64_tr_b16 a[2:3], v8 offset:38912
v_max3_u32 v2, v56, v60, v64
v_mfma_f32_16x16x32_bf16 v[28:31], a[20:23], v[112:115], v[28:31]
ds_read_b64_tr_b16 a[4:5], v9 offset:36864
v_max_u32 v2, v2, v68
v_mfma_f32_16x16x32_bf16 v[44:47], a[20:23], v[116:119], v[44:47]
ds_read_b64_tr_b16 a[6:7], v9 offset:38912
v_cmp_eq_u32 vcc, -1, v2
v_mfma_f32_16x16x32_bf16 v[32:35], a[24:27], v[112:115], v[32:35]
ds_read_b64_tr_b16 a[8:9], v10 offset:36864
v_mfma_f32_16x16x32_bf16 v[48:51], a[24:27], v[116:119], v[48:51]
ds_read_b64_tr_b16 a[10:11], v10 offset:38912
v_mfma_f32_16x16x32_bf16 v[36:39], a[28:31], v[112:115], v[36:39]
ds_read_b64_tr_b16 a[12:13], v11 offset:36864
ds_read_b64_tr_b16 a[14:15], v11 offset:38912
v_mfma_f32_16x16x32_bf16 v[52:55], a[28:31], v[116:119], v[52:55]
s_cbranch_vccnz L_o4_rt
L_o4_ok:
s_waitcnt lgkmcnt(8)
v_mfma_f32_16x16x32_bf16 v[24:27], a[32:35], v[56:59], v[24:27]
ds_read_b64_tr_b16 a[16:17], v8 offset:40960
ds_read_b64_tr_b16 a[18:19], v8 offset:43008
v_mfma_f32_16x16x32_bf16 v[40:43], a[32:35], v[60:63], v[40:43]
buffer_load_dwordx4 v[104:107], v6, s[12:15], s31 offen offset:0 sc1
v_mfma_f32_16x16x32_bf16 v[28:31], a[36:39], v[56:59], v[28:31]
ds_read_b64_tr_b16 a[20:21], v9 offset:40960
ds_read_b64_tr_b16 a[22:23], v9 offset:43008
v_mfma_f32_16x16x32_bf16 v[44:47], a[36:39], v[60:63], v[44:47]
buffer_load_dwordx4 v[108:111], v19, s[12:15], s31 offen offset:0 sc1
v_mfma_f32_16x16x32_bf16 v[32:35], a[40:43], v[56:59], v[32:35]
ds_read_b64_tr_b16 a[24:25], v10 offset:40960
ds_read_b64_tr_b16 a[26:27], v10 offset:43008
v_mfma_f32_16x16x32_bf16 v[48:51], a[40:43], v[60:63], v[48:51]
buffer_load_dwordx4 v[112:115], v6, s[12:15], s31 offen offset:1024 sc1
v_mfma_f32_16x16x32_bf16 v[36:39], a[44:47], v[56:59], v[36:39]
ds_read_b64_tr_b16 a[28:29], v11 offset:40960
ds_read_b64_tr_b16 a[30:31], v11 offset:43008
v_mfma_f32_16x16x32_bf16 v[52:55], a[44:47], v[60:63], v[52:55]
buffer_load_dwordx4 v[116:119], v19, s[12:15], s31 offen offset:1024 sc1
s_waitcnt lgkmcnt(8)
v_mfma_f32_16x16x32_bf16 v[24:27], a[0:3], v[64:67], v[24:27]
ds_read_b64_tr_b16 a[32:33], v8 offset:45056
s_waitcnt vmcnt(8)
v_mfma_f32_16x16x32_bf16 v[40:43], a[0:3], v[68:71], v[40:43]
ds_read_b64_tr_b16 a[34:35], v8 offset:47104
v_max3_u32 v2, v72, v76, v80
v_mfma_f32_16x16x32_bf16 v[28:31], a[4:7], v[64:67], v[28:31]
ds_read_b64_tr_b16 a[36:37], v9 offset:45056
v_max_u32 v2, v2, v84
v_mfma_f32_16x16x32_bf16 v[44:47], a[4:7], v[68:71], v[44:47]
ds_read_b64_tr_b16 a[38:39], v9 offset:47104
v_cmp_eq_u32 vcc, -1, v2
v_mfma_f32_16x16x32_bf16 v[32:35], a[8:11], v[64:67], v[32:35]
ds_read_b64_tr_b16 a[40:41], v10 offset:45056
v_mfma_f32_16x16x32_bf16 v[48:51], a[8:11], v[68:71], v[48:51]
ds_read_b64_tr_b16 a[42:43], v10 offset:47104
v_mfma_f32_16x16x32_bf16 v[36:39], a[12:15], v[64:67], v[36:39]
ds_read_b64_tr_b16 a[44:45], v11 offset:45056
ds_read_b64_tr_b16 a[46:47], v11 offset:47104
v_mfma_f32_16x16x32_bf16 v[52:55], a[12:15], v[68:71], v[52:55]
s_cbranch_vccnz L_o5_rt
L_o5_ok:
s_waitcnt lgkmcnt(8)
v_mfma_f32_16x16x32_bf16 v[24:27], a[16:19], v[72:75], v[24:27]
ds_read_b64_tr_b16 a[0:1], v8 offset:49152
ds_read_b64_tr_b16 a[2:3], v8 offset:51200
v_mfma_f32_16x16x32_bf16 v[40:43], a[16:19], v[76:79], v[40:43]
buffer_load_dwordx4 v[56:59], v6, s[12:15], s32 offen offset:0 sc1
v_mfma_f32_16x16x32_bf16 v[28:31], a[20:23], v[72:75], v[28:31]
ds_read_b64_tr_b16 a[4:5], v9 offset:49152
ds_read_b64_tr_b16 a[6:7], v9 offset:51200
v_mfma_f32_16x16x32_bf16 v[44:47], a[20:23], v[76:79], v[44:47]
buffer_load_dwordx4 v[60:63], v19, s[12:15], s32 offen offset:0 sc1
v_mfma_f32_16x16x32_bf16 v[32:35], a[24:27], v[72:75], v[32:35]
ds_read_b64_tr_b16 a[8:9], v10 offset:49152
ds_read_b64_tr_b16 a[10:11], v10 offset:51200
v_mfma_f32_16x16x32_bf16 v[48:51], a[24:27], v[76:79], v[48:51]
buffer_load_dwordx4 v[64:67], v6, s[12:15], s32 offen offset:1024 sc1
v_mfma_f32_16x16x32_bf16 v[36:39], a[28:31], v[72:75], v[36:39]
ds_read_b64_tr_b16 a[12:13], v11 offset:49152
ds_read_b64_tr_b16 a[14:15], v11 offset:51200
v_mfma_f32_16x16x32_bf16 v[52:55], a[28:31], v[76:79], v[52:55]
buffer_load_dwordx4 v[68:71], v19, s[12:15], s32 offen offset:1024 sc1
s_waitcnt lgkmcnt(8)
v_mfma_f32_16x16x32_bf16 v[24:27], a[32:35], v[80:83], v[24:27]
ds_read_b64_tr_b16 a[16:17], v8 offset:53248
s_waitcnt vmcnt(8)
v_mfma_f32_16x16x32_bf16 v[40:43], a[32:35], v[84:87], v[40:43]
ds_read_b64_tr_b16 a[18:19], v8 offset:55296
v_max3_u32 v2, v88, v92, v96
v_mfma_f32_16x16x32_bf16 v[28:31], a[36:39], v[80:83], v[28:31]
ds_read_b64_tr_b16 a[20:21], v9 offset:53248
v_max_u32 v2, v2, v100
v_mfma_f32_16x16x32_bf16 v[44:47], a[36:39], v[84:87], v[44:47]
ds_read_b64_tr_b16 a[22:23], v9 offset:55296
v_cmp_eq_u32 vcc, -1, v2
v_mfma_f32_16x16x32_bf16 v[32:35], a[40:43], v[80:83], v[32:35]
ds_read_b64_tr_b16 a[24:25], v10 offset:53248
v_mfma_f32_16x16x32_bf16 v[48:51], a[40:43], v[84:87], v[48:51]
ds_read_b64_tr_b16 a[26:27], v10 offset:55296
v_mfma_f32_16x16x32_bf16 v[36:39], a[44:47], v[80:83], v[36:39]
ds_read_b64_tr_b16 a[28:29], v11 offset:53248
ds_read_b64_tr_b16 a[30:31], v11 offset:55296
v_mfma_f32_16x16x32_bf16 v[52:55], a[44:47], v[84:87], v[52:55]
s_cbranch_vccnz L_o6_rt
L_o6_ok:
s_waitcnt lgkmcnt(8)
v_mfma_f32_16x16x32_bf16 v[24:27], a[0:3], v[88:91], v[24:27]
ds_read_b64_tr_b16 a[32:33], v8 offset:57344
ds_read_b64_tr_b16 a[34:35], v8 offset:59392
v_mfma_f32_16x16x32_bf16 v[40:43], a[0:3], v[92:95], v[40:43]
buffer_load_dwordx4 v[72:75], v6, s[12:15], s33 offen offset:0 sc1
v_mfma_f32_16x16x32_bf16 v[28:31], a[4:7], v[88:91], v[28:31]
ds_read_b64_tr_b16 a[36:37], v9 offset:57344
ds_read_b64_tr_b16 a[38:39], v9 offset:59392
v_mfma_f32_16x16x32_bf16 v[44:47], a[4:7], v[92:95], v[44:47]
buffer_load_dwordx4 v[76:79], v19, s[12:15], s33 offen offset:0 sc1
v_mfma_f32_16x16x32_bf16 v[32:35], a[8:11], v[88:91], v[32:35]
ds_read_b64_tr_b16 a[40:41], v10 offset:57344
ds_read_b64_tr_b16 a[42:43], v10 offset:59392
v_mfma_f32_16x16x32_bf16 v[48:51], a[8:11], v[92:95], v[48:51]
buffer_load_dwordx4 v[80:83], v6, s[12:15], s33 offen offset:1024 sc1
v_mfma_f32_16x16x32_bf16 v[36:39], a[12:15], v[88:91], v[36:39]
ds_read_b64_tr_b16 a[44:45], v11 offset:57344
ds_read_b64_tr_b16 a[46:47], v11 offset:59392
v_mfma_f32_16x16x32_bf16 v[52:55], a[12:15], v[92:95], v[52:55]
buffer_load_dwordx4 v[84:87], v19, s[12:15], s33 offen offset:1024 sc1
s_waitcnt lgkmcnt(8)
v_mfma_f32_16x16x32_bf16 v[24:27], a[16:19], v[96:99], v[24:27]
ds_read_b64_tr_b16 a[0:1], v8 offset:61440
s_waitcnt vmcnt(8)
v_mfma_f32_16x16x32_bf16 v[40:43], a[16:19], v[100:103], v[40:43]
ds_read_b64_tr_b16 a[2:3], v8 offset:63488
v_max3_u32 v2, v104, v108, v112
v_mfma_f32_16x16x32_bf16 v[28:31], a[20:23], v[96:99], v[28:31]
ds_read_b64_tr_b16 a[4:5], v9 offset:61440
v_max_u32 v2, v2, v116
v_mfma_f32_16x16x32_bf16 v[44:47], a[20:23], v[100:103], v[44:47]
ds_read_b64_tr_b16 a[6:7], v9 offset:63488
v_cmp_eq_u32 vcc, -1, v2
v_mfma_f32_16x16x32_bf16 v[32:35], a[24:27], v[96:99], v[32:35]
ds_read_b64_tr_b16 a[8:9], v10 offset:61440
v_mfma_f32_16x16x32_bf16 v[48:51], a[24:27], v[100:103], v[48:51]
ds_read_b64_tr_b16 a[10:11], v10 offset:63488
v_mfma_f32_16x16x32_bf16 v[36:39], a[28:31], v[96:99], v[36:39]
ds_read_b64_tr_b16 a[12:13], v11 offset:61440
ds_read_b64_tr_b16 a[14:15], v11 offset:63488
v_mfma_f32_16x16x32_bf16 v[52:55], a[28:31], v[100:103], v[52:55]
s_cbranch_vccnz L_o7_rt
L_o7_ok:
s_waitcnt lgkmcnt(8)
v_mfma_f32_16x16x32_bf16 v[24:27], a[32:35], v[104:107], v[24:27]
ds_read_b64_tr_b16 a[16:17], v12 offset:0
ds_read_b64_tr_b16 a[18:19], v12 offset:2048
v_mfma_f32_16x16x32_bf16 v[40:43], a[32:35], v[108:111], v[40:43]
buffer_load_dwordx4 v[88:91], v6, s[12:15], s34 offen offset:0 sc1
v_mfma_f32_16x16x32_bf16 v[28:31], a[36:39], v[104:107], v[28:31]
ds_read_b64_tr_b16 a[20:21], v13 offset:0
ds_read_b64_tr_b16 a[22:23], v13 offset:2048
v_mfma_f32_16x16x32_bf16 v[44:47], a[36:39], v[108:111], v[44:47]
buffer_load_dwordx4 v[92:95], v19, s[12:15], s34 offen offset:0 sc1
v_mfma_f32_16x16x32_bf16 v[32:35], a[40:43], v[104:107], v[32:35]
ds_read_b64_tr_b16 a[24:25], v14 offset:0
ds_read_b64_tr_b16 a[26:27], v14 offset:2048
v_mfma_f32_16x16x32_bf16 v[48:51], a[40:43], v[108:111], v[48:51]
buffer_load_dwordx4 v[96:99], v6, s[12:15], s34 offen offset:1024 sc1
v_mfma_f32_16x16x32_bf16 v[36:39], a[44:47], v[104:107], v[36:39]
ds_read_b64_tr_b16 a[28:29], v15 offset:0
ds_read_b64_tr_b16 a[30:31], v15 offset:2048
v_mfma_f32_16x16x32_bf16 v[52:55], a[44:47], v[108:111], v[52:55]
buffer_load_dwordx4 v[100:103], v19, s[12:15], s34 offen offset:1024 sc1
s_waitcnt lgkmcnt(8)
v_mfma_f32_16x16x32_bf16 v[24:27], a[0:3], v[112:115], v[24:27]
ds_read_b64_tr_b16 a[32:33], v12 offset:4096
s_waitcnt vmcnt(8)
v_mfma_f32_16x16x32_bf16 v[40:43], a[0:3], v[116:119], v[40:43]
ds_read_b64_tr_b16 a[34:35], v12 offset:6144
v_max3_u32 v2, v56, v60, v64
v_mfma_f32_16x16x32_bf16 v[28:31], a[4:7], v[112:115], v[28:31]
ds_read_b64_tr_b16 a[36:37], v13 offset:4096
v_max_u32 v2, v2, v68
v_mfma_f32_16x16x32_bf16 v[44:47], a[4:7], v[116:119], v[44:47]
ds_read_b64_tr_b16 a[38:39], v13 offset:6144
v_cmp_eq_u32 vcc, -1, v2
v_mfma_f32_16x16x32_bf16 v[32:35], a[8:11], v[112:115], v[32:35]
ds_read_b64_tr_b16 a[40:41], v14 offset:4096
v_mfma_f32_16x16x32_bf16 v[48:51], a[8:11], v[116:119], v[48:51]
ds_read_b64_tr_b16 a[42:43], v14 offset:6144
v_mfma_f32_16x16x32_bf16 v[36:39], a[12:15], v[112:115], v[36:39]
ds_read_b64_tr_b16 a[44:45], v15 offset:4096
ds_read_b64_tr_b16 a[46:47], v15 offset:6144
v_mfma_f32_16x16x32_bf16 v[52:55], a[12:15], v[116:119], v[52:55]
s_cbranch_vccnz L_o8_rt
L_o8_ok:
s_waitcnt lgkmcnt(8)
v_mfma_f32_16x16x32_bf16 v[24:27], a[16:19], v[56:59], v[24:27]
ds_read_b64_tr_b16 a[0:1], v12 offset:8192
ds_read_b64_tr_b16 a[2:3], v12 offset:10240
v_mfma_f32_16x16x32_bf16 v[40:43], a[16:19], v[60:63], v[40:43]
buffer_load_dwordx4 v[104:107], v6, s[12:15], s35 offen offset:0 sc1
v_mfma_f32_16x16x32_bf16 v[28:31], a[20:23], v[56:59], v[28:31]
ds_read_b64_tr_b16 a[4:5], v13 offset:8192
ds_read_b64_tr_b16 a[6:7], v13 offset:10240
v_mfma_f32_16x16x32_bf16 v[44:47], a[20:23], v[60:63], v[44:47]
buffer_load_dwordx4 v[108:111], v19, s[12:15], s35 offen offset:0 sc1
v_mfma_f32_16x16x32_bf16 v[32:35], a[24:27], v[56:59], v[32:35]
ds_read_b64_tr_b16 a[8:9], v14 offset:8192
ds_read_b64_tr_b16 a[10:11], v14 offset:10240
v_mfma_f32_16x16x32_bf16 v[48:51], a[24:27], v[60:63], v[48:51]
buffer_load_dwordx4 v[112:115], v6, s[12:15], s35 offen offset:1024 sc1
v_mfma_f32_16x16x32_bf16 v[36:39], a[28:31], v[56:59], v[36:39]
ds_read_b64_tr_b16 a[12:13], v15 offset:8192
s_branch L_over7
L_pad7:
s_branch L_pad12
L_over7:
ds_read_b64_tr_b16 a[14:15], v15 offset:10240
v_mfma_f32_16x16x32_bf16 v[52:55], a[28:31], v[60:63], v[52:55]
buffer_load_dwordx4 v[116:119], v19, s[12:15], s35 offen offset:1024 sc1
s_waitcnt lgkmcnt(8)
v_mfma_f32_16x16x32_bf16 v[24:27], a[32:35], v[64:67], v[24:27]
ds_read_b64_tr_b16 a[16:17], v12 offset:12288
s_waitcnt vmcnt(8)
v_mfma_f32_16x16x32_bf16 v[40:43], a[32:35], v[68:71], v[40:43]
ds_read_b64_tr_b16 a[18:19], v12 offset:14336
v_max3_u32 v2, v72, v76, v80
v_mfma_f32_16x16x32_bf16 v[28:31], a[36:39], v[64:67], v[28:31]
ds_read_b64_tr_b16 a[20:21], v13 offset:12288
v_max_u32 v2, v2, v84
v_mfma_f32_16x16x32_bf16 v[44:47], a[36:39], v[68:71], v[44:47]
ds_read_b64_tr_b16 a[22:23], v13 offset:14336
v_cmp_eq_u32 vcc, -1, v2
v_mfma_f32_16x16x32_bf16 v[32:35], a[40:43], v[64:67], v[32:35]
ds_read_b64_tr_b16 a[24:25], v14 offset:12288
v_mfma_f32_16x16x32_bf16 v[48:51], a[40:43], v[68:71], v[48:51]
ds_read_b64_tr_b16 a[26:27], v14 offset:14336
v_mfma_f32_16x16x32_bf16 v[36:39], a[44:47], v[64:67], v[36:39]
ds_read_b64_tr_b16 a[28:29], v15 offset:12288
ds_read_b64_tr_b16 a[30:31], v15 offset:14336
v_mfma_f32_16x16x32_bf16 v[52:55], a[44:47], v[68:71], v[52:55]
s_cbranch_vccnz L_o9_rt
L_o9_ok:
s_waitcnt lgkmcnt(8)
v_mfma_f32_16x16x32_bf16 v[24:27], a[0:3], v[72:75], v[24:27]
ds_read_b64_tr_b16 a[32:33], v12 offset:16384
ds_read_b64_tr_b16 a[34:35], v12 offset:18432
v_mfma_f32_16x16x32_bf16 v[40:43], a[0:3], v[76:79], v[40:43]
buffer_load_dwordx4 v[56:59], v6, s[12:15], s36 offen offset:0 sc1
v_mfma_f32_16x16x32_bf16 v[28:31], a[4:7], v[72:75], v[28:31]
ds_read_b64_tr_b16 a[36:37], v13 offset:16384
ds_read_b64_tr_b16 a[38:39], v13 offset:18432
v_mfma_f32_16x16x32_bf16 v[44:47], a[4:7], v[76:79], v[44:47]
buffer_load_dwordx4 v[60:63], v19, s[12:15], s36 offen offset:0 sc1
v_mfma_f32_16x16x32_bf16 v[32:35], a[8:11], v[72:75], v[32:35]
ds_read_b64_tr_b16 a[40:41], v14 offset:16384
ds_read_b64_tr_b16 a[42:43], v14 offset:18432
v_mfma_f32_16x16x32_bf16 v[48:51], a[8:11], v[76:79], v[48:51]
buffer_load_dwordx4 v[64:67], v6, s[12:15], s36 offen offset:1024 sc1
v_mfma_f32_16x16x32_bf16 v[36:39], a[12:15], v[72:75], v[36:39]
ds_read_b64_tr_b16 a[44:45], v15 offset:16384
ds_read_b64_tr_b16 a[46:47], v15 offset:18432
v_mfma_f32_16x16x32_bf16 v[52:55], a[12:15], v[76:79], v[52:55]
buffer_load_dwordx4 v[68:71], v19, s[12:15], s36 offen offset:1024 sc1
s_waitcnt lgkmcnt(8)
v_mfma_f32_16x16x32_bf16 v[24:27], a[16:19], v[80:83], v[24:27]
ds_read_b64_tr_b16 a[0:1], v12 offset:20480
s_waitcnt vmcnt(8)
v_mfma_f32_16x16x32_bf16 v[40:43], a[16:19], v[84:87], v[40:43]
ds_read_b64_tr_b16 a[2:3], v12 offset:22528
v_max3_u32 v2, v88, v92, v96
v_mfma_f32_16x16x32_bf16 v[28:31], a[20:23], v[80:83], v[28:31]
ds_read_b64_tr_b16 a[4:5], v13 offset:20480
v_max_u32 v2, v2, v100
v_mfma_f32_16x16x32_bf16 v[44:47], a[20:23], v[84:87], v[44:47]
ds_read_b64_tr_b16 a[6:7], v13 offset:22528
v_cmp_eq_u32 vcc, -1, v2
v_mfma_f32_16x16x32_bf16 v[32:35], a[24:27], v[80:83], v[32:35]
ds_read_b64_tr_b16 a[8:9], v14 offset:20480
v_mfma_f32_16x16x32_bf16 v[48:51], a[24:27], v[84:87], v[48:51]
ds_read_b64_tr_b16 a[10:11], v14 offset:22528
v_mfma_f32_16x16x32_bf16 v[36:39], a[28:31], v[80:83], v[36:39]
ds_read_b64_tr_b16 a[12:13], v15 offset:20480
ds_read_b64_tr_b16 a[14:15], v15 offset:22528
v_mfma_f32_16x16x32_bf16 v[52:55], a[28:31], v[84:87], v[52:55]
s_cbranch_vccnz L_o10_rt
L_o10_ok:
s_waitcnt lgkmcnt(8)
v_mfma_f32_16x16x32_bf16 v[24:27], a[32:35], v[88:91], v[24:27]
ds_read_b64_tr_b16 a[16:17], v12 offset:24576
ds_read_b64_tr_b16 a[18:19], v12 offset:26624
v_mfma_f32_16x16x32_bf16 v[40:43], a[32:35], v[92:95], v[40:43]
buffer_load_dwordx4 v[72:75], v6, s[12:15], s37 offen offset:0 sc1
v_mfma_f32_16x16x32_bf16 v[28:31], a[36:39], v[88:91], v[28:31]
ds_read_b64_tr_b16 a[20:21], v13 offset:24576
ds_read_b64_tr_b16 a[22:23], v13 offset:26624
v_mfma_f32_16x16x32_bf16 v[44:47], a[36:39], v[92:95], v[44:47]
buffer_load_dwordx4 v[76:79], v19, s[12:15], s37 offen offset:0 sc1
v_mfma_f32_16x16x32_bf16 v[32:35], a[40:43], v[88:91], v[32:35]
ds_read_b64_tr_b16 a[24:25], v14 offset:24576
ds_read_b64_tr_b16 a[26:27], v14 offset:26624
v_mfma_f32_16x16x32_bf16 v[48:51], a[40:43], v[92:95], v[48:51]
buffer_load_dwordx4 v[80:83], v6, s[12:15], s37 offen offset:1024 sc1
v_mfma_f32_16x16x32_bf16 v[36:39], a[44:47], v[88:91], v[36:39]
ds_read_b64_tr_b16 a[28:29], v15 offset:24576
ds_read_b64_tr_b16 a[30:31], v15 offset:26624
v_mfma_f32_16x16x32_bf16 v[52:55], a[44:47], v[92:95], v[52:55]
buffer_load_dwordx4 v[84:87], v19, s[12:15], s37 offen offset:1024 sc1
s_waitcnt lgkmcnt(8)
v_mfma_f32_16x16x32_bf16 v[24:27], a[0:3], v[96:99], v[24:27]
ds_read_b64_tr_b16 a[32:33], v12 offset:28672
s_waitcnt vmcnt(8)
v_mfma_f32_16x16x32_bf16 v[40:43], a[0:3], v[100:103], v[40:43]
ds_read_b64_tr_b16 a[34:35], v12 offset:30720
v_max3_u32 v2, v104, v108, v112
v_mfma_f32_16x16x32_bf16 v[28:31], a[4:7], v[96:99], v[28:31]
ds_read_b64_tr_b16 a[36:37], v13 offset:28672
v_max_u32 v2, v2, v116
v_mfma_f32_16x16x32_bf16 v[44:47], a[4:7], v[100:103], v[44:47]
ds_read_b64_tr_b16 a[38:39], v13 offset:30720
v_cmp_eq_u32 vcc, -1, v2
v_mfma_f32_16x16x32_bf16 v[32:35], a[8:11], v[96:99], v[32:35]
ds_read_b64_tr_b16 a[40:41], v14 offset:28672
v_mfma_f32_16x16x32_bf16 v[48:51], a[8:11], v[100:103], v[48:51]
ds_read_b64_tr_b16 a[42:43], v14 offset:30720
v_mfma_f32_16x16x32_bf16 v[36:39], a[12:15], v[96:99], v[36:39]
ds_read_b64_tr_b16 a[44:45], v15 offset:28672
ds_read_b64_tr_b16 a[46:47], v15 offset:30720
v_mfma_f32_16x16x32_bf16 v[52:55], a[12:15], v[100:103], v[52:55]
s_cbranch_vccnz L_o11_rt
L_o11_ok:
s_waitcnt lgkmcnt(8)
v_mfma_f32_16x16x32_bf16 v[24:27], a[16:19], v[104:107], v[24:27]
ds_read_b64_tr_b16 a[0:1], v12 offset:32768
ds_read_b64_tr_b16 a[2:3], v12 offset:34816
v_mfma_f32_16x16x32_bf16 v[40:43], a[16:19], v[108:111], v[40:43]
buffer_load_dwordx4 v[88:91], v6, s[12:15], s38 offen offset:0 sc1
v_mfma_f32_16x16x32_bf16 v[28:31], a[20:23], v[104:107], v[28:31]
ds_read_b64_tr_b16 a[4:5], v13 offset:32768
ds_read_b64_tr_b16 a[6:7], v13 offset:34816
v_mfma_f32_16x16x32_bf16 v[44:47], a[20:23], v[108:111], v[44:47]
buffer_load_dwordx4 v[92:95], v19, s[12:15], s38 offen offset:0 sc1
v_mfma_f32_16x16x32_bf16 v[32:35], a[24:27], v[104:107], v[32:35]
ds_read_b64_tr_b16 a[8:9], v14 offset:32768
ds_read_b64_tr_b16 a[10:11], v14 offset:34816
v_mfma_f32_16x16x32_bf16 v[48:51], a[24:27], v[108:111], v[48:51]
buffer_load_dwordx4 v[96:99], v6, s[12:15], s38 offen offset:1024 sc1
v_mfma_f32_16x16x32_bf16 v[36:39], a[28:31], v[104:107], v[36:39]
ds_read_b64_tr_b16 a[12:13], v15 offset:32768
ds_read_b64_tr_b16 a[14:15], v15 offset:34816
v_mfma_f32_16x16x32_bf16 v[52:55], a[28:31], v[108:111], v[52:55]
buffer_load_dwordx4 v[100:103], v19, s[12:15], s38 offen offset:1024 sc1
s_waitcnt lgkmcnt(8)
v_mfma_f32_16x16x32_bf16 v[24:27], a[32:35], v[112:115], v[24:27]
ds_read_b64_tr_b16 a[16:17], v12 offset:36864
s_waitcnt vmcnt(8)
v_mfma_f32_16x16x32_bf16 v[40:43], a[32:35], v[116:119], v[40:43]
ds_read_b64_tr_b16 a[18:19], v12 offset:38912
v_max3_u32 v2, v56, v60, v64
v_mfma_f32_16x16x32_bf16 v[28:31], a[36:39], v[112:115], v[28:31]
ds_read_b64_tr_b16 a[20:21], v13 offset:36864
v_max_u32 v2, v2, v68
v_mfma_f32_16x16x32_bf16 v[44:47], a[36:39], v[116:119], v[44:47]
ds_read_b64_tr_b16 a[22:23], v13 offset:38912
v_cmp_eq_u32 vcc, -1, v2
v_mfma_f32_16x16x32_bf16 v[32:35], a[40:43], v[112:115], v[32:35]
ds_read_b64_tr_b16 a[24:25], v14 offset:36864
v_mfma_f32_16x16x32_bf16 v[48:51], a[40:43], v[116:119], v[48:51]
ds_read_b64_tr_b16 a[26:27], v14 offset:38912
v_mfma_f32_16x16x32_bf16 v[36:39], a[44:47], v[112:115], v[36:39]
ds_read_b64_tr_b16 a[28:29], v15 offset:36864
ds_read_b64_tr_b16 a[30:31], v15 offset:38912
v_mfma_f32_16x16x32_bf16 v[52:55], a[44:47], v[116:119], v[52:55]
s_cbranch_vccnz L_o12_rt
L_o12_ok:
s_waitcnt lgkmcnt(8)
v_mfma_f32_16x16x32_bf16 v[24:27], a[0:3], v[56:59], v[24:27]
ds_read_b64_tr_b16 a[32:33], v12 offset:40960
ds_read_b64_tr_b16 a[34:35], v12 offset:43008
v_mfma_f32_16x16x32_bf16 v[40:43], a[0:3], v[60:63], v[40:43]
buffer_load_dwordx4 v[104:107], v6, s[12:15], s39 offen offset:0 sc1
v_mfma_f32_16x16x32_bf16 v[28:31], a[4:7], v[56:59], v[28:31]
ds_read_b64_tr_b16 a[36:37], v13 offset:40960
ds_read_b64_tr_b16 a[38:39], v13 offset:43008
v_mfma_f32_16x16x32_bf16 v[44:47], a[4:7], v[60:63], v[44:47]
buffer_load_dwordx4 v[108:111], v19, s[12:15], s39 offen offset:0 sc1
v_mfma_f32_16x16x32_bf16 v[32:35], a[8:11], v[56:59], v[32:35]
ds_read_b64_tr_b16 a[40:41], v14 offset:40960
ds_read_b64_tr_b16 a[42:43], v14 offset:43008
v_mfma_f32_16x16x32_bf16 v[48:51], a[8:11], v[60:63], v[48:51]
buffer_load_dwordx4 v[112:115], v6, s[12:15], s39 offen offset:1024 sc1
v_mfma_f32_16x16x32_bf16 v[36:39], a[12:15], v[56:59], v[36:39]
ds_read_b64_tr_b16 a[44:45], v15 offset:40960
ds_read_b64_tr_b16 a[46:47], v15 offset:43008
v_mfma_f32_16x16x32_bf16 v[52:55], a[12:15], v[60:63], v[52:55]
buffer_load_dwordx4 v[116:119], v19, s[12:15], s39 offen offset:1024 sc1
s_waitcnt lgkmcnt(8)
v_mfma_f32_16x16x32_bf16 v[24:27], a[16:19], v[64:67], v[24:27]
ds_read_b64_tr_b16 a[0:1], v12 offset:45056
s_waitcnt vmcnt(8)
v_mfma_f32_16x16x32_bf16 v[40:43], a[16:19], v[68:71], v[40:43]
ds_read_b64_tr_b16 a[2:3], v12 offset:47104
v_max3_u32 v2, v72, v76, v80
v_mfma_f32_16x16x32_bf16 v[28:31], a[20:23], v[64:67], v[28:31]
ds_read_b64_tr_b16 a[4:5], v13 offset:45056
v_max_u32 v2, v2, v84
v_mfma_f32_16x16x32_bf16 v[44:47], a[20:23], v[68:71], v[44:47]
ds_read_b64_tr_b16 a[6:7], v13 offset:47104
v_cmp_eq_u32 vcc, -1, v2
v_mfma_f32_16x16x32_bf16 v[32:35], a[24:27], v[64:67], v[32:35]
ds_read_b64_tr_b16 a[8:9], v14 offset:45056
v_mfma_f32_16x16x32_bf16 v[48:51], a[24:27], v[68:71], v[48:51]
ds_read_b64_tr_b16 a[10:11], v14 offset:47104
v_mfma_f32_16x16x32_bf16 v[36:39], a[28:31], v[64:67], v[36:39]
ds_read_b64_tr_b16 a[12:13], v15 offset:45056
ds_read_b64_tr_b16 a[14:15], v15 offset:47104
v_mfma_f32_16x16x32_bf16 v[52:55], a[28:31], v[68:71], v[52:55]
s_cbranch_vccnz L_o13_rt
L_o13_ok:
s_waitcnt lgkmcnt(8)
v_mfma_f32_16x16x32_bf16 v[24:27], a[32:35], v[72:75], v[24:27]
ds_read_b64_tr_b16 a[16:17], v12 offset:49152
ds_read_b64_tr_b16 a[18:19], v12 offset:51200
v_mfma_f32_16x16x32_bf16 v[40:43], a[32:35], v[76:79], v[40:43]
v_mfma_f32_16x16x32_bf16 v[28:31], a[36:39], v[72:75], v[28:31]
ds_read_b64_tr_b16 a[20:21], v13 offset:49152
ds_read_b64_tr_b16 a[22:23], v13 offset:51200
v_mfma_f32_16x16x32_bf16 v[44:47], a[36:39], v[76:79], v[44:47]
v_mfma_f32_16x16x32_bf16 v[32:35], a[40:43], v[72:75], v[32:35]
ds_read_b64_tr_b16 a[24:25], v14 offset:49152
ds_read_b64_tr_b16 a[26:27], v14 offset:51200
v_mfma_f32_16x16x32_bf16 v[48:51], a[40:43], v[76:79], v[48:51]
v_mfma_f32_16x16x32_bf16 v[36:39], a[44:47], v[72:75], v[36:39]
ds_read_b64_tr_b16 a[28:29], v15 offset:49152
ds_read_b64_tr_b16 a[30:31], v15 offset:51200
v_mfma_f32_16x16x32_bf16 v[52:55], a[44:47], v[76:79], v[52:55]
s_waitcnt lgkmcnt(8)
v_mfma_f32_16x16x32_bf16 v[24:27], a[0:3], v[80:83], v[24:27]
ds_read_b64_tr_b16 a[32:33], v12 offset:53248
s_waitcnt vmcnt(4)
v_mfma_f32_16x16x32_bf16 v[40:43], a[0:3], v[84:87], v[40:43]
ds_read_b64_tr_b16 a[34:35], v12 offset:55296
v_max3_u32 v2, v88, v92, v96
v_mfma_f32_16x16x32_bf16 v[28:31], a[4:7], v[80:83], v[28:31]
ds_read_b64_tr_b16 a[36:37], v13 offset:53248
v_max_u32 v2, v2, v100
v_mfma_f32_16x16x32_bf16 v[44:47], a[4:7], v[84:87], v[44:47]
ds_read_b64_tr_b16 a[38:39], v13 offset:55296
v_cmp_eq_u32 vcc, -1, v2
v_mfma_f32_16x16x32_bf16 v[32:35], a[8:11], v[80:83], v[32:35]
ds_read_b64_tr_b16 a[40:41], v14 offset:53248
v_mfma_f32_16x16x32_bf16 v[48:51], a[8:11], v[84:87], v[48:51]
ds_read_b64_tr_b16 a[42:43], v14 offset:55296
v_mfma_f32_16x16x32_bf16 v[36:39], a[12:15], v[80:83], v[36:39]
ds_read_b64_tr_b16 a[44:45], v15 offset:53248
ds_read_b64_tr_b16 a[46:47], v15 offset:55296
v_mfma_f32_16x16x32_bf16 v[52:55], a[12:15], v[84:87], v[52:55]
s_cbranch_vccnz L_o14_rt
L_o14_ok:
s_waitcnt lgkmcnt(8)
v_mfma_f32_16x16x32_bf16 v[24:27], a[16:19], v[88:91], v[24:27]
ds_read_b64_tr_b16 a[0:1], v12 offset:57344
ds_read_b64_tr_b16 a[2:3], v12 offset:59392
v_mfma_f32_16x16x32_bf16 v[40:43], a[16:19], v[92:95], v[40:43]
v_mfma_f32_16x16x32_bf16 v[28:31], a[20:23], v[88:91], v[28:31]
ds_read_b64_tr_b16 a[4:5], v13 offset:57344
ds_read_b64_tr_b16 a[6:7], v13 offset:59392
v_mfma_f32_16x16x32_bf16 v[44:47], a[20:23], v[92:95], v[44:47]
v_mfma_f32_16x16x32_bf16 v[32:35], a[24:27], v[88:91], v[32:35]
ds_read_b64_tr_b16 a[8:9], v14 offset:57344
ds_read_b64_tr_b16 a[10:11], v14 offset:59392
v_mfma_f32_16x16x32_bf16 v[48:51], a[24:27], v[92:95], v[48:51]
v_mfma_f32_16x16x32_bf16 v[36:39], a[28:31], v[88:91], v[36:39]
ds_read_b64_tr_b16 a[12:13], v15 offset:57344
ds_read_b64_tr_b16 a[14:15], v15 offset:59392
v_mfma_f32_16x16x32_bf16 v[52:55], a[28:31], v[92:95], v[52:55]
s_waitcnt lgkmcnt(8)
v_mfma_f32_16x16x32_bf16 v[24:27], a[32:35], v[96:99], v[24:27]
ds_read_b64_tr_b16 a[16:17], v12 offset:61440
s_waitcnt vmcnt(0)
v_mfma_f32_16x16x32_bf16 v[40:43], a[32:35], v[100:103], v[40:43]
ds_read_b64_tr_b16 a[18:19], v12 offset:63488
v_max3_u32 v2, v104, v108, v112
v_mfma_f32_16x16x32_bf16 v[28:31], a[36:39], v[96:99], v[28:31]
ds_read_b64_tr_b16 a[20:21], v13 offset:61440
v_max_u32 v2, v2, v116
v_mfma_f32_16x16x32_bf16 v[44:47], a[36:39], v[100:103], v[44:47]
ds_read_b64_tr_b16 a[22:23], v13 offset:63488
v_cmp_eq_u32 vcc, -1, v2
v_mfma_f32_16x16x32_bf16 v[32:35], a[40:43], v[96:99], v[32:35]
ds_read_b64_tr_b16 a[24:25], v14 offset:61440
v_mfma_f32_16x16x32_bf16 v[48:51], a[40:43], v[100:103], v[48:51]
ds_read_b64_tr_b16 a[26:27], v14 offset:63488
v_mfma_f32_16x16x32_bf16 v[36:39], a[44:47], v[96:99], v[36:39]
ds_read_b64_tr_b16 a[28:29], v15 offset:61440
ds_read_b64_tr_b16 a[30:31], v15 offset:63488
v_mfma_f32_16x16x32_bf16 v[52:55], a[44:47], v[100:103], v[52:55]
s_cbranch_vccnz L_o15_rt
L_o15_ok:
s_waitcnt lgkmcnt(8)
v_mfma_f32_16x16x32_bf16 v[24:27], a[0:3], v[104:107], v[24:27]
v_mfma_f32_16x16x32_bf16 v[40:43], a[0:3], v[108:111], v[40:43]
v_mfma_f32_16x16x32_bf16 v[28:31], a[4:7], v[104:107], v[28:31]
v_mfma_f32_16x16x32_bf16 v[44:47], a[4:7], v[108:111], v[44:47]
v_mfma_f32_16x16x32_bf16 v[32:35], a[8:11], v[104:107], v[32:35]
v_mfma_f32_16x16x32_bf16 v[48:51], a[8:11], v[108:111], v[48:51]
v_mfma_f32_16x16x32_bf16 v[36:39], a[12:15], v[104:107], v[36:39]
v_mfma_f32_16x16x32_bf16 v[52:55], a[12:15], v[108:111], v[52:55]
s_waitcnt lgkmcnt(0)
v_mfma_f32_16x16x32_bf16 v[24:27], a[16:19], v[112:115], v[24:27]
v_mfma_f32_16x16x32_bf16 v[40:43], a[16:19], v[116:119], v[40:43]
v_mfma_f32_16x16x32_bf16 v[28:31], a[20:23], v[112:115], v[28:31]
v_mfma_f32_16x16x32_bf16 v[44:47], a[20:23], v[116:119], v[44:47]
v_mfma_f32_16x16x32_bf16 v[32:35], a[24:27], v[112:115], v[32:35]
v_mfma_f32_16x16x32_bf16 v[48:51], a[24:27], v[116:119], v[48:51]
v_mfma_f32_16x16x32_bf16 v[36:39], a[28:31], v[112:115], v[36:39]
v_mfma_f32_16x16x32_bf16 v[52:55], a[28:31], v[116:119], v[52:55]
s_nop 0
v_cvt_pk_bf16_f32 v128, v24, v25
v_cvt_pk_bf16_f32 v129, v26, v27
v_cvt_pk_bf16_f32 v130, v28, v29
v_cvt_pk_bf16_f32 v131, v30, v31
v_cvt_pk_bf16_f32 v132, v32, v33
v_cvt_pk_bf16_f32 v133, v34, v35
v_cvt_pk_bf16_f32 v134, v36, v37
v_cvt_pk_bf16_f32 v135, v38, v39
v_cvt_pk_bf16_f32 v136, v40, v41
v_cvt_pk_bf16_f32 v137, v42, v43
v_cvt_pk_bf16_f32 v138, v44, v45
v_cvt_pk_bf16_f32 v139, v46, v47
v_cvt_pk_bf16_f32 v140, v48, v49
v_cvt_pk_bf16_f32 v141, v50, v51
v_cvt_pk_bf16_f32 v142, v52, v53
v_cvt_pk_bf16_f32 v143, v54, v55
v_mfma_f32_16x16x32_bf16 v[80:83], v[128:131], v[128:131], 0
v_mfma_f32_16x16x32_bf16 v[72:75], v[120:123], v[128:131], 0
v_mfma_f32_16x16x32_bf16 v[80:83], v[132:135], v[132:135], v[80:83]
v_mfma_f32_16x16x32_bf16 v[72:75], v[124:127], v[132:135], v[72:75]
v_mfma_f32_16x16x32_bf16 v[84:87], v[136:139], v[136:139], 0
v_mfma_f32_16x16x32_bf16 v[76:79], v[120:123], v[136:139], 0
v_mfma_f32_16x16x32_bf16 v[84:87], v[140:143], v[140:143], v[84:87]
v_mfma_f32_16x16x32_bf16 v[76:79], v[124:127], v[140:143], v[76:79]
s_nop 2
v_cndmask_b32_e64 v80, v80, v81, s[80:81]
v_cndmask_b32_e64 v82, v82, v83, s[90:91]
s_or_b64 vcc, s[82:83], s[90:91]
v_mov_b32 v75, s68
v_cndmask_b32 v73, v80, v82, vcc
v_cndmask_b32_e64 v84, v84, v85, s[80:81]
v_cndmask_b32_e64 v86, v86, v87, s[90:91]
s_or_b64 vcc, s[82:83], s[90:91]
v_mov_b32 v79, s68
v_cndmask_b32_e64 v77, v84, v86, vcc
s_mov_b64 exec, s[92:93]
s_cmp_eq_u32 s69, 0
s_cbranch_scc1 L_stp_s
buffer_store_dwordx4 v[72:75], v144, s[12:15], s72 offen offset:0
buffer_store_dwordx4 v[76:79], v144, s[12:15], s72 offen offset:256
L_stp_d:
s_mov_b64 exec, -1
s_barrier
s_add_u32 s70, s75, 0
buffer_load_dwordx4 v[96:99], v145, s[12:15], s70 offen sc1
s_add_u32 s70, s75, 4096
buffer_load_dwordx4 v[100:103], v145, s[12:15], s70 offen sc1
s_add_u32 s70, s75, 8192
buffer_load_dwordx4 v[104:107], v145, s[12:15], s70 offen sc1
s_add_u32 s70, s75, 12288
buffer_load_dwordx4 v[108:111], v145, s[12:15], s70 offen sc1
s_add_u32 s70, s75, 16384
buffer_load_dwordx4 v[112:115], v145, s[12:15], s70 offen sc1
s_add_u32 s70, s75, 20480
buffer_load_dwordx4 v[116:119], v145, s[12:15], s70 offen sc1
s_add_u32 s70, s75, 24576
buffer_load_dwordx4 v[120:123], v145, s[12:15], s70 offen sc1
s_add_u32 s70, s75, 28672
buffer_load_dwordx4 v[124:127], v145, s[12:15], s70 offen sc1
ds_write_b64 v20, v[128:129] offset:0
ds_write_b64 v21, v[130:131] offset:0
ds_write_b64 v22, v[132:133] offset:0
ds_write_b64 v23, v[134:135] offset:0
ds_write_b64 v20, v[136:137] offset:2048
ds_write_b64 v21, v[138:139] offset:2048
ds_write_b64 v22, v[140:141] offset:2048
ds_write_b64 v23, v[142:143] offset:2048
v_lshrrev_b32 v2, 3, v1
v_lshrrev_b32 v3, 4, v1
v_and_b32 v13, 7, v1
v_xor_b32 v3, v3, v13
v_lshlrev_b32 v3, 4, v3
v_lshl_add_u32 v3, v2, 7, v3
s_lshl_b32 s70, s60, 12
v_add_u32 v9, s70, v3
v_xor_b32 v10, 64, v9
v_lshlrev_b32 v11, 11, v2
v_lshl_add_u32 v11, v13, 4, v11
v_mov_b32 v12, v2
s_lshl_b32 s76, s60, 12
s_lshl_b32 s74, s64, 18
s_lshl_b32 s70, s60, 16
s_add_u32 s74, s74, s70
s_lshl_b32 s70, s65, 7
s_add_u32 s74, s74, s70
s_mov_b32 s80, 0xff00ff00
s_mov_b32 s81, 0xff00ff00
s_lshl_b32 s70, s60, 5
s_add_u32 s70, s70, 161920
v_mov_b32 v14, s70
v_add_u32 v15, 16, v14
v_add_u32 v8, 161920, v16
v_lshlrev_b32 v8, 4, v13
v_add_u32 v8, 161920, v8
v_xor_b32 v17, 8192, v11
v_xor_b32 v17, s61, v17
s_waitcnt vmcnt(0)
L_st_chk:
v_xor_b32 v88, s68, v99
v_xor_b32 v89, s68, v103
v_xor_b32 v90, s68, v107
v_xor_b32 v91, s68, v111
v_xor_b32 v92, s68, v115
v_xor_b32 v93, s68, v119
v_xor_b32 v94, s68, v123
v_xor_b32 v95, s68, v127
v_or3_b32 v88, v88, v89, v90
v_or3_b32 v91, v91, v92, v93
v_or3_b32 v88, v88, v94, v95
v_or_b32_e64 v88, v88, v91
v_cmp_ne_u32 vcc, 0, v88
s_cbranch_vccnz L_st_rt
L_st_ok:
v_pk_add_f32 v[96:97], v[96:97], v[100:101]
v_add_f32 v98, v98, v102
v_pk_add_f32 v[104:105], v[104:105], v[108:109]
v_add_f32 v106, v106, v110
v_pk_add_f32 v[112:113], v[112:113], v[116:117]
v_add_f32 v114, v114, v118
v_pk_add_f32 v[120:121], v[120:121], v[124:125]
v_add_f32 v122, v122, v126
v_pk_add_f32 v[96:97], v[96:97], v[104:105]
v_add_f32 v98, v98, v106
v_pk_add_f32 v[112:113], v[112:113], v[120:121]
v_add_f32 v114, v114, v122
v_pk_add_f32 v[96:97], v[96:97], v[112:113]
v_add_f32 v98, v98, v114
v_mov_b32 v100, v96
v_mov_b32 v101, v97
v_mov_b32 v102, v98
v_permlane32_swap_b32 v96, v100
v_permlane32_swap_b32 v97, v101
v_permlane32_swap_b32 v98, v102
v_add_f32 v96, v96, v100
v_add_f32 v97, v97, v101
v_add_f32 v98, v98, v102
v_mul_f32 v73, 0x3a800000, v96
v_mul_f32 v97, 0x3a800000, v97
v_fma_f32 v97, -v73, v73, v97
v_fma_f32 v98, -v73, s84, v98
v_max_f32 v97, 0, v97
v_add_f32 v97, 0x3727c5ac, v97
v_rsq_f32 v74, v97
v_mov_b32 v75, s68
v_mul_f32 v98, v98, v74
v_ashrrev_i32 v99, 31, v98
v_or_b32 v99, 0x80000000, v99
v_xor_b32 v98, v98, v99
s_mov_b32 s70, 0xfffff000
v_and_or_b32 v72, v98, s70, v146
s_nop 1
v_mov_b32_dpp v78, v72 row_ror:1 row_mask:0xf bank_mask:0xf
v_max_u32 v76, v72, v78
v_min_u32 v77, v72, v78
s_nop 0
v_mov_b32_dpp v78, v76 row_ror:2 row_mask:0xf bank_mask:0xf
v_max_u32_dpp v79, v77, v77 row_ror:2 row_mask:0xf bank_mask:0xf
v_med3_u32 v77, v76, v78, v79
v_max_u32 v76, v76, v78
s_nop 1
v_mov_b32_dpp v78, v76 row_ror:4 row_mask:0xf bank_mask:0xf
v_max_u32_dpp v79, v77, v77 row_ror:4 row_mask:0xf bank_mask:0xf
v_med3_u32 v77, v76, v78, v79
v_max_u32 v76, v76, v78
s_nop 1
v_mov_b32_dpp v78, v76 row_ror:8 row_mask:0xf bank_mask:0xf
v_max_u32_dpp v79, v77, v77 row_ror:8 row_mask:0xf bank_mask:0xf
v_med3_u32 v77, v76, v78, v79
v_max_u32 v76, v76, v78
v_mov_b32 v78, v76
v_mov_b32 v79, v77
s_nop 0
v_permlane16_swap_b32 v76, v78
v_permlane16_swap_b32 v77, v79
v_max_u32_e64 v79, v77, v79
v_med3_u32 v77, v76, v78, v79
v_max_u32 v76, v76, v78
v_cmp_eq_u32 vcc, v72, v77
v_cmp_eq_u32_e64 s[92:93], v72, v76
s_nop 0
v_cndmask_b32 v2, v14, v15, vcc
v_addc_co_u32_e64 v72, s[72:73], 0, v72, vcc
s_or_b64 exec, vcc, s[92:93]
ds_write_b128 v2, v[72:75]
s_mov_b64 exec, -1
v_cndmask_b32_e64 v5, v76, v77, s[80:81]
v_bfe_u32 v6, v5, 8, 3
v_bfe_u32 v5, v5, 7, 5
v_xor_b32_e64 v6, v6, v13
v_lshl_add_u32 v6, v6, 4, s76
v_lshl_add_u32 v6, v5, 7, v6
ds_read_b128 v[88:91], v6
v_readfirstlane_b32 s86, v77
v_readfirstlane_b32 s85, v76
v_add_f32 v80, 1.0, v74
v_mul_f32_e64 v56, -v73, v74
v_mov_b32 v82, v80
v_mov_b32 v58, v56
s_nop 0
v_permlane16_swap_b32 v80, v82
v_permlane16_swap_b32 v56, v58
s_waitcnt lgkmcnt(1)
s_barrier
s_sub_u32 s70, s64, s65
s_or_b32 s70, s70, s60
s_cbranch_scc1 L_norec
ds_read_b128 v[92:95], v8
s_lshl_b32 s70, s62, 3
s_lshl_b64 s[72:73], 0xff, s70
s_cmp_eq_u32 s69, 0
s_cselect_b64 s[72:73], 0, s[72:73]
s_andn2_b64 exec, -1, s[72:73]
s_waitcnt lgkmcnt(0)
buffer_store_dwordx4 v[92:95], v17, s[12:15], s87 offen sc1
s_mov_b64 exec, s[72:73]
buffer_store_dwordx4 v[92:95], v17, s[12:15], s87 offen
s_mov_b64 exec, -1
L_norec:
s_mov_b32 exec_hi, 0
s_waitcnt lgkmcnt(0)
buffer_store_dwordx4 v[88:91], v147, s[12:15], s88 offen sc1
s_mov_b64 exec, -1
s_bfe_u32 s95, s86, 0x50007
s_bfe_u32 s94, s85, 0x50007
s_add_u32 s86, s86, 1
v_pk_fma_f32 v[24:25], v[24:25], v[80:81], v[56:57] op_sel_hi:[1,0,0]
v_pk_fma_f32 v[26:27], v[26:27], v[80:81], v[56:57] op_sel_hi:[1,0,0]
v_cvt_pk_bf16_f32 v128, v24, v25
v_cvt_pk_bf16_f32 v129, v26, v27
ds_write_b64 v20, v[128:129] offset:32768
v_pk_fma_f32 v[28:29], v[28:29], v[80:81], v[56:57] op_sel_hi:[1,0,0]
v_pk_fma_f32 v[30:31], v[30:31], v[80:81], v[56:57] op_sel_hi:[1,0,0]
v_cvt_pk_bf16_f32 v130, v28, v29
v_cvt_pk_bf16_f32 v131, v30, v31
ds_write_b64 v21, v[130:131] offset:32768
v_pk_fma_f32 v[32:33], v[32:33], v[80:81], v[56:57] op_sel_hi:[1,0,0]
v_pk_fma_f32 v[34:35], v[34:35], v[80:81], v[56:57] op_sel_hi:[1,0,0]
v_cvt_pk_bf16_f32 v132, v32, v33
v_cvt_pk_bf16_f32 v133, v34, v35
ds_write_b64 v22, v[132:133] offset:32768
v_pk_fma_f32 v[36:37], v[36:37], v[80:81], v[56:57] op_sel_hi:[1,0,0]
v_pk_fma_f32 v[38:39], v[38:39], v[80:81], v[56:57] op_sel_hi:[1,0,0]
v_cvt_pk_bf16_f32 v134, v36, v37
v_cvt_pk_bf16_f32 v135, v38, v39
ds_write_b64 v23, v[134:135] offset:32768
v_pk_fma_f32 v[40:41], v[40:41], v[82:83], v[58:59] op_sel_hi:[1,0,0]
v_pk_fma_f32 v[42:43], v[42:43], v[82:83], v[58:59] op_sel_hi:[1,0,0]
v_cvt_pk_bf16_f32 v136, v40, v41
v_cvt_pk_bf16_f32 v137, v42, v43
ds_write_b64 v20, v[136:137] offset:34816
v_pk_fma_f32 v[44:45], v[44:45], v[82:83], v[58:59] op_sel_hi:[1,0,0]
v_pk_fma_f32 v[46:47], v[46:47], v[82:83], v[58:59] op_sel_hi:[1,0,0]
v_cvt_pk_bf16_f32 v138, v44, v45
v_cvt_pk_bf16_f32 v139, v46, v47
ds_write_b64 v21, v[138:139] offset:34816
v_pk_fma_f32 v[48:49], v[48:49], v[82:83], v[58:59] op_sel_hi:[1,0,0]
v_pk_fma_f32 v[50:51], v[50:51], v[82:83], v[58:59] op_sel_hi:[1,0,0]
v_cvt_pk_bf16_f32 v140, v48, v49
v_cvt_pk_bf16_f32 v141, v50, v51
ds_write_b64 v22, v[140:141] offset:34816
v_pk_fma_f32 v[52:53], v[52:53], v[82:83], v[58:59] op_sel_hi:[1,0,0]
v_pk_fma_f32 v[54:55], v[54:55], v[82:83], v[58:59] op_sel_hi:[1,0,0]
v_cvt_pk_bf16_f32 v142, v52, v53
v_cvt_pk_bf16_f32 v143, v54, v55
ds_write_b64 v23, v[142:143] offset:34816
s_waitcnt lgkmcnt(0)
ds_read_b128 v[96:99], v9 offset:32768
ds_read_b128 v[100:103], v10 offset:33792
ds_read_b128 v[104:107], v9 offset:34816
ds_read_b128 v[108:111], v10 offset:35840
v_add_u32 v2, 0, v12
v_cmp_ne_u32 vcc, s94, v2
v_cmp_ne_u32_e64 s[92:93], s95, v2
s_add_u32 s70, s74, 0
s_waitcnt lgkmcnt(3)
s_and_b64 exec, vcc, s[92:93]
buffer_store_dwordx4 v[96:99], v11, s[20:23], s70 offen nt
s_mov_b64 exec, -1
v_add_u32 v2, 8, v12
v_cmp_ne_u32 vcc, s94, v2
v_cmp_ne_u32_e64 s[92:93], s95, v2
s_add_u32 s70, s74, 16384
s_waitcnt lgkmcnt(2)
s_and_b64 exec, vcc, s[92:93]
buffer_store_dwordx4 v[100:103], v11, s[20:23], s70 offen nt
s_mov_b64 exec, -1
v_add_u32 v2, 16, v12
v_cmp_ne_u32 vcc, s94, v2
v_cmp_ne_u32_e64 s[92:93], s95, v2
s_add_u32 s70, s74, 32768
s_waitcnt lgkmcnt(1)
s_and_b64 exec, vcc, s[92:93]
buffer_store_dwordx4 v[104:107], v11, s[20:23], s70 offen nt
s_mov_b64 exec, -1
v_add_u32 v2, 24, v12
v_cmp_ne_u32_e64 vcc, s94, v2
v_cmp_ne_u32_e64 s[92:93], s95, v2
s_add_u32 s70, s74, 49152
s_waitcnt lgkmcnt(0)
s_and_b64 exec, vcc, s[92:93]
buffer_store_dwordx4 v[108:111], v11, s[20:23], s70 offen nt
s_mov_b64 exec, -1
v_mov_b32 v2, 161792
s_barrier
ds_read_b32 v3, v2
ds_read_b32 v4, v2 offset:16
s_waitcnt lgkmcnt(0)
v_readfirstlane_b32 s72, v3
v_readfirstlane_b32 s73, v4
s_cmp_eq_u32 s85, s72
s_cselect_b32 s94, 255, s94
s_branch L_over8
L_pad8:
s_branch L_pad13
L_over8:
s_cmp_eq_u32 s85, s73
s_cselect_b32 s94, 255, s94
s_cmp_eq_u32 s86, s72
s_cselect_b32 s95, 255, s95
s_cmp_eq_u32 s86, s73
s_cselect_b32 s95, 255, s95
v_add_u32 v2, 0, v12
v_cmp_eq_u32 vcc, s94, v2
v_cmp_eq_u32_e64 s[92:93], s95, v2
s_add_u32 s70, s74, 0
s_or_b64 exec, vcc, s[92:93]
s_cbranch_execz L_nodef0
buffer_store_dwordx4 v[96:99], v11, s[20:23], s70 offen nt
L_nodef0:
s_mov_b64 exec, -1
v_add_u32 v2, 8, v12
v_cmp_eq_u32 vcc, s94, v2
v_cmp_eq_u32_e64 s[92:93], s95, v2
s_add_u32 s70, s74, 16384
s_or_b64 exec, vcc, s[92:93]
s_cbranch_execz L_nodef1
buffer_store_dwordx4 v[100:103], v11, s[20:23], s70 offen nt
L_nodef1:
s_mov_b64 exec, -1
v_add_u32 v2, 16, v12
v_cmp_eq_u32 vcc, s94, v2
v_cmp_eq_u32_e64 s[92:93], s95, v2
s_add_u32 s70, s74, 32768
s_or_b64 exec, vcc, s[92:93]
s_cbranch_execz L_nodef2
buffer_store_dwordx4 v[104:107], v11, s[20:23], s70 offen nt
L_nodef2:
s_mov_b64 exec, -1
v_add_u32 v2, 24, v12
v_cmp_eq_u32 vcc, s94, v2
v_cmp_eq_u32_e64 s[92:93], s95, v2
s_add_u32 s70, s74, 49152
s_or_b64 exec, vcc, s[92:93]
s_cbranch_execz L_nodef3
buffer_store_dwordx4 v[108:111], v11, s[20:23], s70 offen nt
L_nodef3:
s_mov_b64 exec, -1
L_end:
s_endpgm
L_eg_rt:
s_add_u32 s78, s78, 1
s_cmp_gt_u32 s78, 65536
s_cbranch_scc1 L_eg_ok
s_add_u32 s70, s87, 0
buffer_load_dwordx4 v[20:23], v44, s[12:15], s70 offen sc1
buffer_load_dwordx4 v[36:39], v45, s[12:15], s88 offen sc1
buffer_load_dwordx4 v[40:43], v46, s[12:15], 0 offen offset:0 sc1
buffer_load_dword v47, v48, s[12:15], 0 offen sc1
s_waitcnt vmcnt(0)
s_branch L_eg_chk
L_kv2_s:
buffer_store_dwordx2 v[20:21], v53, s[12:15], s94 offen sc1
s_branch L_kv2_d
L_pad9:
s_branch L_retF
L_kvrt:
s_add_u32 s78, s78, 1
s_cmp_gt_u32 s78, 65536
s_cbranch_scc1 L_kvok
s_bitcmp1_b32 s73, 0
s_cbranch_scc0 L_kvn0
buffer_load_dwordx4 v[84:87], v54, s[12:15], s87 offen sc1
L_kvn0:
s_bitcmp1_b32 s73, 1
s_cbranch_scc0 L_kvn1
buffer_load_dwordx4 v[148:151], v55, s[12:15], s88 offen sc1
L_kvn1:
s_waitcnt vmcnt(0)
s_branch L_kvr
L_pad10:
s_branch L_pad16
L_pksame:
s_cmp_eq_u32 s73, 0
s_cbranch_scc1 L_pkf
s_add_u32 s78, s78, 1
s_cmp_le_u32 s78, 65536
s_cbranch_scc1 L_pk
s_branch L_pkf
L_pkx_rt:
s_add_u32 s78, s78, 1
s_cmp_gt_u32 s78, 65536
s_cbranch_scc1 L_pkx_ok
s_mov_b64 exec, s[92:93]
buffer_load_dwordx4 v[24:27], v58, s[12:15], 0 offen offset:0 sc1
buffer_load_dwordx4 v[28:31], v58, s[12:15], 0 offen offset:64 sc1
buffer_load_dwordx4 v[32:35], v58, s[12:15], 0 offen offset:128 sc1
buffer_load_dwordx4 v[36:39], v58, s[12:15], 0 offen offset:192 sc1
buffer_load_dwordx4 v[40:43], v58, s[12:15], 0 offen offset:256 sc1
buffer_load_dwordx4 v[44:47], v58, s[12:15], 0 offen offset:320 sc1
buffer_load_dwordx4 v[48:51], v58, s[12:15], 0 offen offset:384 sc1
buffer_load_dwordx4 v[52:55], v58, s[12:15], 0 offen offset:448 sc1
s_mov_b64 exec, -1
v_mul_f32_e64 v84, v68, -v21
v_mul_f32_e64 v85, v69, -v21
v_mul_f32_e64 v86, v70, -v21
v_mul_f32_e64 v87, v71, -v21
v_mul_f32_e64 v88, v72, -v21
v_mul_f32_e64 v89, v73, -v21
v_mul_f32_e64 v90, v74, -v21
v_mul_f32_e64 v91, v75, -v21
s_branch L_pkf
L_pxp_s:
buffer_store_dwordx4 v[84:87], v60, s[12:15], s85 offen sc1
s_branch L_pxp_d
L_pad11:
s_branch L_pad17
L_px_rt:
s_add_u32 s78, s78, 1
s_cmp_gt_u32 s78, 65536
s_cbranch_scc1 L_px_ok
v_and_b32 v2, s91, v24
v_cmp_ne_u32 vcc, 0, v2
v_xor_b32 v24, s84, v24
s_cbranch_vccz L_px_p0
buffer_load_dwordx4 v[24:27], v61, s[12:15], s86 offen offset:0 sc1
L_px_p0:
v_and_b32 v2, s91, v28
v_cmp_ne_u32 vcc, 0, v2
v_xor_b32 v28, s84, v28
s_cbranch_vccz L_px_p1
buffer_load_dwordx4 v[28:31], v61, s[12:15], s86 offen offset:1024 sc1
L_px_p1:
v_and_b32 v2, s91, v32
v_cmp_ne_u32 vcc, 0, v2
v_xor_b32 v32, s84, v32
s_cbranch_vccz L_px_p2
buffer_load_dwordx4 v[32:35], v61, s[12:15], s86 offen offset:2048 sc1
L_px_p2:
v_and_b32 v2, s91, v36
v_cmp_ne_u32 vcc, 0, v2
v_xor_b32 v36, s84, v36
s_cbranch_vccz L_px_p3
buffer_load_dwordx4 v[36:39], v61, s[12:15], s86 offen offset:3072 sc1
L_px_p3:
s_waitcnt vmcnt(0)
s_branch L_px_chk
L_pad12:
s_branch L_pad18
L_yown:
v_bfi_b32 v40, s91, v59, v40
buffer_store_dwordx4 v[40:43], v62, s[12:15], s88 offen
s_add_u32 s88, s88, 16384
v_bfi_b32 v44, s91, v59, v44
buffer_store_dwordx4 v[44:47], v62, s[12:15], s88 offen
s_add_u32 s88, s88, 16384
v_bfi_b32 v48, s91, v59, v48
buffer_store_dwordx4 v[48:51], v62, s[12:15], s88 offen
s_add_u32 s88, s88, 16384
v_bfi_b32 v52, s91, v59, v52
buffer_store_dwordx4 v[52:55], v62, s[12:15], s88 offen
s_branch L_yd
L_h_rt:
s_add_u32 s78, s78, 1
s_cmp_gt_u32 s78, 65536
s_cbranch_scc1 L_h_ok
buffer_load_ushort v84, v64, s[12:15], s72 offen sc1
s_waitcnt vmcnt(0)
s_branch L_h_chk
L_pad13:
s_branch L_pad19
L_y_rt:
s_add_u32 s78, s78, 1
s_cmp_gt_u32 s78, 65536
s_cbranch_scc1 L_yf0
buffer_load_dwordx4 v[120:123], v18, s[12:15], s88 offen offset:0 sc1
buffer_load_dwordx4 v[124:127], v18, s[12:15], s88 offen offset:1024 sc1
buffer_load_dwordx4 v[128:131], v18, s[12:15], s88 offen offset:2048 sc1
buffer_load_dwordx4 v[132:135], v18, s[12:15], s88 offen offset:3072 sc1
buffer_load_dwordx4 v[136:139], v18, s[12:15], s71 offen offset:0 sc1
buffer_load_dwordx4 v[140:143], v18, s[12:15], s71 offen offset:1024 sc1
buffer_load_dwordx4 v[144:147], v18, s[12:15], s71 offen offset:2048 sc1
v_mov_b32 v88, s84
s_waitcnt vmcnt(14)
v_xor_b32 v24, s84, v24
v_xor_b32_e64 v28, s84, v28
v_xor_b32 v32, s84, v32
v_xor_b32 v36, s84, v36
v_or3_b32 v2, v24, v28, v32
v_xor_b32 v92, s84, v92
v_xor_b32 v96, s84, v96
v_or3_b32 v2, v2, v36, v92
v_xor_b32 v100, s84, v100
v_xor_b32 v88, s84, v88
v_or3_b32 v2, v2, v96, v100
v_bitop3_b32 v2, v2, v88, s91 bitop3:0xa8
v_cmp_ne_u32 vcc, 0, v2
s_cbranch_vccz L_yf1
buffer_load_dwordx4 v[24:27], v18, s[12:15], s88 offen offset:0 sc1
buffer_load_dwordx4 v[28:31], v18, s[12:15], s88 offen offset:1024 sc1
buffer_load_dwordx4 v[32:35], v18, s[12:15], s88 offen offset:2048 sc1
buffer_load_dwordx4 v[36:39], v18, s[12:15], s88 offen offset:3072 sc1
buffer_load_dwordx4 v[92:95], v18, s[12:15], s71 offen offset:0 sc1
buffer_load_dwordx4 v[96:99], v18, s[12:15], s71 offen offset:1024 sc1
buffer_load_dwordx4 v[100:103], v18, s[12:15], s71 offen offset:2048 sc1
v_mov_b32 v88, s84
s_waitcnt vmcnt(14)
v_xor_b32 v40, s84, v40
v_xor_b32 v44, s84, v44
v_xor_b32 v48, s84, v48
v_xor_b32 v52, s84, v52
v_or3_b32 v2, v40, v44, v48
v_xor_b32 v104, s84, v104
v_xor_b32 v108, s84, v108
v_or3_b32 v2, v2, v52, v104
v_xor_b32 v112, s84, v112
v_xor_b32 v88, s84, v88
v_or3_b32 v2, v2, v108, v112
v_bitop3_b32 v2, v2, v88, s91 bitop3:0xa8
v_cmp_ne_u32 vcc, 0, v2
s_cbranch_vccz L_yf2
buffer_load_dwordx4 v[40:43], v18, s[12:15], s88 offen offset:0 sc1
buffer_load_dwordx4 v[44:47], v18, s[12:15], s88 offen offset:1024 sc1
buffer_load_dwordx4 v[48:51], v18, s[12:15], s88 offen offset:2048 sc1
buffer_load_dwordx4 v[52:55], v18, s[12:15], s88 offen offset:3072 sc1
buffer_load_dwordx4 v[104:107], v18, s[12:15], s71 offen offset:0 sc1
buffer_load_dwordx4 v[108:111], v18, s[12:15], s71 offen offset:1024 sc1
buffer_load_dwordx4 v[112:115], v18, s[12:15], s71 offen offset:2048 sc1
v_mov_b32 v88, s84
s_branch L_yr
L_yf1:
v_pk_add_f32 v[24:25], v[24:25], v[28:29]
v_pk_add_f32 v[26:27], v[26:27], v[30:31]
v_pk_add_f32 v[32:33], v[32:33], v[36:37]
v_pk_add_f32 v[34:35], v[34:35], v[38:39]
v_pk_add_f32 v[92:93], v[92:93], v[96:97]
v_pk_add_f32 v[94:95], v[94:95], v[98:99]
v_pk_add_f32 v[24:25], v[24:25], v[32:33]
v_pk_add_f32 v[26:27], v[26:27], v[34:35]
v_pk_add_f32 v[92:93], v[92:93], v[100:101]
v_pk_add_f32 v[94:95], v[94:95], v[102:103]
v_pk_add_f32 v[24:25], v[24:25], v[92:93]
v_pk_add_f32 v[26:27], v[26:27], v[94:95]
s_nop 1
v_permlane32_swap_b32 v24, v26
v_permlane32_swap_b32 v25, v27
v_add_f32 v68, v24, v26
v_add_f32_e64 v69, v25, v27
s_nop 0
s_branch L_yf
L_yf2:
v_pk_add_f32 v[40:41], v[40:41], v[44:45]
v_pk_add_f32 v[42:43], v[42:43], v[46:47]
v_pk_add_f32 v[48:49], v[48:49], v[52:53]
v_pk_add_f32 v[50:51], v[50:51], v[54:55]
v_pk_add_f32 v[104:105], v[104:105], v[108:109]
v_pk_add_f32 v[106:107], v[106:107], v[110:111]
v_pk_add_f32 v[40:41], v[40:41], v[48:49]
v_pk_add_f32 v[42:43], v[42:43], v[50:51]
v_pk_add_f32 v[104:105], v[104:105], v[112:113]
v_pk_add_f32 v[106:107], v[106:107], v[114:115]
v_pk_add_f32 v[40:41], v[40:41], v[104:105]
v_pk_add_f32 v[42:43], v[42:43], v[106:107]
s_nop 1
v_permlane32_swap_b32 v40, v42
v_permlane32_swap_b32 v41, v43
v_add_f32 v68, v40, v42
v_add_f32_e64 v69, v41, v43
s_nop 0
s_branch L_yf
L_kvp_s:
buffer_store_dwordx4 v[140:143], v16, s[12:15], s72 offen sc1
s_mov_b64 exec, s[92:93]
buffer_store_dwordx4 v[136:139], v4, s[12:15], s73 offen sc1
s_mov_b64 exec, -1
s_branch L_kvp_d
L_pad14:
s_branch L_retF
L_k2_rt:
s_add_u32 s78, s78, 1
s_cmp_gt_u32 s78, 65536
s_cbranch_scc1 L_k2_ok
buffer_load_dwordx4 v[136:139], v17, s[12:15], 0 offen sc1
buffer_load_dwordx4 v[140:143], v17, s[12:15], 0 offen offset:1024 sc1
s_waitcnt vmcnt(0)
s_branch L_k2_chk
L_pad15:
s_branch L_retF
L_oown0:
buffer_store_dwordx4 v[52:55], v16, s[12:15], s70 offen
s_branch L_ood0
L_oown1:
buffer_store_dwordx4 v[76:79], v16, s[12:15], s70 offen
s_branch L_ood1
L_oown2:
buffer_store_dwordx4 v[100:103], v16, s[12:15], s70 offen
s_branch L_ood2
L_oown3:
buffer_store_dwordx4 v[124:127], v16, s[12:15], s70 offen
s_branch L_ood3
L_pad16:
s_branch L_retG
L_o0_rt:
s_add_u32 s78, s78, 1
s_cmp_gt_u32 s78, 65536
s_cbranch_scc1 L_o0_ok
buffer_load_dwordx4 v[56:59], v6, s[12:15], s24 offen offset:0 sc1
buffer_load_dwordx4 v[60:63], v19, s[12:15], s24 offen offset:0 sc1
buffer_load_dwordx4 v[64:67], v6, s[12:15], s24 offen offset:1024 sc1
buffer_load_dwordx4 v[68:71], v19, s[12:15], s24 offen offset:1024 sc1
s_waitcnt vmcnt(4)
v_max3_u32 v2, v72, v76, v80
v_max3_u32 v2, v2, v84, v88
v_max3_u32 v2, v2, v92, v96
v_max3_u32 v2, v2, v100, v100
v_cmp_eq_u32 vcc, -1, v2
s_cbranch_vccz L_o0_a
buffer_load_dwordx4 v[72:75], v6, s[12:15], s25 offen offset:0 sc1
buffer_load_dwordx4 v[76:79], v19, s[12:15], s25 offen offset:0 sc1
buffer_load_dwordx4 v[80:83], v6, s[12:15], s25 offen offset:1024 sc1
buffer_load_dwordx4 v[84:87], v19, s[12:15], s25 offen offset:1024 sc1
buffer_load_dwordx4 v[88:91], v6, s[12:15], s26 offen offset:0 sc1
buffer_load_dwordx4 v[92:95], v19, s[12:15], s26 offen offset:0 sc1
buffer_load_dwordx4 v[96:99], v6, s[12:15], s26 offen offset:1024 sc1
buffer_load_dwordx4 v[100:103], v19, s[12:15], s26 offen offset:1024 sc1
s_waitcnt vmcnt(8)
s_branch L_o0_b
L_o0_a:
s_waitcnt vmcnt(0)
L_o0_b:
v_max3_u32 v2, v56, v60, v64
v_max_u32 v2, v2, v68
v_cmp_eq_u32 vcc, -1, v2
s_cbranch_vccnz L_o0_rt
s_branch L_o0_ok
L_pad17:
s_branch L_retG
L_o1_rt:
s_add_u32 s78, s78, 1
s_cmp_gt_u32 s78, 65536
s_cbranch_scc1 L_o1_ok
buffer_load_dwordx4 v[72:75], v6, s[12:15], s25 offen offset:0 sc1
buffer_load_dwordx4 v[76:79], v19, s[12:15], s25 offen offset:0 sc1
buffer_load_dwordx4 v[80:83], v6, s[12:15], s25 offen offset:1024 sc1
buffer_load_dwordx4 v[84:87], v19, s[12:15], s25 offen offset:1024 sc1
s_waitcnt vmcnt(4)
v_max3_u32 v2, v88, v92, v96
v_max3_u32 v2, v2, v100, v104
v_max3_u32 v2, v2, v108, v112
v_max3_u32 v2, v2, v116, v116
v_cmp_eq_u32 vcc, -1, v2
s_cbranch_vccz L_o1_a
buffer_load_dwordx4 v[88:91], v6, s[12:15], s26 offen offset:0 sc1
buffer_load_dwordx4 v[92:95], v19, s[12:15], s26 offen offset:0 sc1
buffer_load_dwordx4 v[96:99], v6, s[12:15], s26 offen offset:1024 sc1
buffer_load_dwordx4 v[100:103], v19, s[12:15], s26 offen offset:1024 sc1
buffer_load_dwordx4 v[104:107], v6, s[12:15], s27 offen offset:0 sc1
buffer_load_dwordx4 v[108:111], v19, s[12:15], s27 offen offset:0 sc1
buffer_load_dwordx4 v[112:115], v6, s[12:15], s27 offen offset:1024 sc1
buffer_load_dwordx4 v[116:119], v19, s[12:15], s27 offen offset:1024 sc1
s_waitcnt vmcnt(8)
s_branch L_o1_b
L_o1_a:
s_waitcnt vmcnt(0)
L_o1_b:
v_max3_u32 v2, v72, v76, v80
v_max_u32 v2, v2, v84
v_cmp_eq_u32 vcc, -1, v2
s_cbranch_vccnz L_o1_rt
s_branch L_o1_ok
L_o2_rt:
s_add_u32 s78, s78, 1
s_cmp_gt_u32 s78, 65536
s_cbranch_scc1 L_o2_ok
buffer_load_dwordx4 v[88:91], v6, s[12:15], s26 offen offset:0 sc1
buffer_load_dwordx4 v[92:95], v19, s[12:15], s26 offen offset:0 sc1
buffer_load_dwordx4 v[96:99], v6, s[12:15], s26 offen offset:1024 sc1
buffer_load_dwordx4 v[100:103], v19, s[12:15], s26 offen offset:1024 sc1
s_waitcnt vmcnt(4)
v_max3_u32 v2, v104, v108, v112
v_max3_u32 v2, v2, v116, v56
v_max3_u32 v2, v2, v60, v64
v_max3_u32 v2, v2, v68, v68
v_cmp_eq_u32 vcc, -1, v2
s_cbranch_vccz L_o2_a
buffer_load_dwordx4 v[104:107], v6, s[12:15], s27 offen offset:0 sc1
buffer_load_dwordx4 v[108:111], v19, s[12:15], s27 offen offset:0 sc1
buffer_load_dwordx4 v[112:115], v6, s[12:15], s27 offen offset:1024 sc1
buffer_load_dwordx4 v[116:119], v19, s[12:15], s27 offen offset:1024 sc1
buffer_load_dwordx4 v[56:59], v6, s[12:15], s28 offen offset:0 sc1
buffer_load_dwordx4 v[60:63], v19, s[12:15], s28 offen offset:0 sc1
buffer_load_dwordx4 v[64:67], v6, s[12:15], s28 offen offset:1024 sc1
buffer_load_dwordx4 v[68:71], v19, s[12:15], s28 offen offset:1024 sc1
s_waitcnt vmcnt(8)
s_branch L_o2_b
L_o2_a:
s_waitcnt vmcnt(0)
L_o2_b:
v_max3_u32 v2, v88, v92, v96
v_max_u32 v2, v2, v100
v_cmp_eq_u32 vcc, -1, v2
s_cbranch_vccnz L_o2_rt
s_branch L_o2_ok
L_o3_rt:
s_add_u32 s78, s78, 1
s_cmp_gt_u32 s78, 65536
s_cbranch_scc1 L_o3_ok
buffer_load_dwordx4 v[104:107], v6, s[12:15], s27 offen offset:0 sc1
buffer_load_dwordx4 v[108:111], v19, s[12:15], s27 offen offset:0 sc1
buffer_load_dwordx4 v[112:115], v6, s[12:15], s27 offen offset:1024 sc1
buffer_load_dwordx4 v[116:119], v19, s[12:15], s27 offen offset:1024 sc1
s_waitcnt vmcnt(4)
v_max3_u32 v2, v56, v60, v64
v_max3_u32 v2, v2, v68, v72
v_max3_u32 v2, v2, v76, v80
v_max3_u32 v2, v2, v84, v84
v_cmp_eq_u32 vcc, -1, v2
s_cbranch_vccz L_o3_a
buffer_load_dwordx4 v[56:59], v6, s[12:15], s28 offen offset:0 sc1
buffer_load_dwordx4 v[60:63], v19, s[12:15], s28 offen offset:0 sc1
buffer_load_dwordx4 v[64:67], v6, s[12:15], s28 offen offset:1024 sc1
buffer_load_dwordx4 v[68:71], v19, s[12:15], s28 offen offset:1024 sc1
buffer_load_dwordx4 v[72:75], v6, s[12:15], s29 offen offset:0 sc1
buffer_load_dwordx4 v[76:79], v19, s[12:15], s29 offen offset:0 sc1
buffer_load_dwordx4 v[80:83], v6, s[12:15], s29 offen offset:1024 sc1
buffer_load_dwordx4 v[84:87], v19, s[12:15], s29 offen offset:1024 sc1
s_waitcnt vmcnt(8)
s_branch L_o3_b
L_o3_a:
s_waitcnt vmcnt(0)
L_o3_b:
v_max3_u32 v2, v104, v108, v112
v_max_u32 v2, v2, v116
v_cmp_eq_u32 vcc, -1, v2
s_cbranch_vccnz L_o3_rt
s_branch L_o3_ok
L_o4_rt:
s_add_u32 s78, s78, 1
s_cmp_gt_u32 s78, 65536
s_cbranch_scc1 L_o4_ok
buffer_load_dwordx4 v[56:59], v6, s[12:15], s28 offen offset:0 sc1
buffer_load_dwordx4 v[60:63], v19, s[12:15], s28 offen offset:0 sc1
buffer_load_dwordx4 v[64:67], v6, s[12:15], s28 offen offset:1024 sc1
buffer_load_dwordx4 v[68:71], v19, s[12:15], s28 offen offset:1024 sc1
s_waitcnt vmcnt(4)
v_max3_u32 v2, v72, v76, v80
v_max3_u32 v2, v2, v84, v88
v_max3_u32 v2, v2, v92, v96
v_max3_u32 v2, v2, v100, v100
v_cmp_eq_u32 vcc, -1, v2
s_cbranch_vccz L_o4_a
buffer_load_dwordx4 v[72:75], v6, s[12:15], s29 offen offset:0 sc1
buffer_load_dwordx4 v[76:79], v19, s[12:15], s29 offen offset:0 sc1
buffer_load_dwordx4 v[80:83], v6, s[12:15], s29 offen offset:1024 sc1
buffer_load_dwordx4 v[84:87], v19, s[12:15], s29 offen offset:1024 sc1
buffer_load_dwordx4 v[88:91], v6, s[12:15], s30 offen offset:0 sc1
buffer_load_dwordx4 v[92:95], v19, s[12:15], s30 offen offset:0 sc1
buffer_load_dwordx4 v[96:99], v6, s[12:15], s30 offen offset:1024 sc1
buffer_load_dwordx4 v[100:103], v19, s[12:15], s30 offen offset:1024 sc1
s_waitcnt vmcnt(8)
s_branch L_o4_b
L_o4_a:
s_waitcnt vmcnt(0)
L_o4_b:
v_max3_u32 v2, v56, v60, v64
v_max_u32 v2, v2, v68
v_cmp_eq_u32 vcc, -1, v2
s_cbranch_vccnz L_o4_rt
s_branch L_o4_ok
L_o5_rt:
s_add_u32 s78, s78, 1
s_cmp_gt_u32 s78, 65536
s_cbranch_scc1 L_o5_ok
buffer_load_dwordx4 v[72:75], v6, s[12:15], s29 offen offset:0 sc1
buffer_load_dwordx4 v[76:79], v19, s[12:15], s29 offen offset:0 sc1
buffer_load_dwordx4 v[80:83], v6, s[12:15], s29 offen offset:1024 sc1
buffer_load_dwordx4 v[84:87], v19, s[12:15], s29 offen offset:1024 sc1
s_waitcnt vmcnt(4)
v_max3_u32 v2, v88, v92, v96
v_max3_u32 v2, v2, v100, v104
v_max3_u32 v2, v2, v108, v112
v_max3_u32 v2, v2, v116, v116
v_cmp_eq_u32 vcc, -1, v2
s_cbranch_vccz L_o5_a
buffer_load_dwordx4 v[88:91], v6, s[12:15], s30 offen offset:0 sc1
buffer_load_dwordx4 v[92:95], v19, s[12:15], s30 offen offset:0 sc1
buffer_load_dwordx4 v[96:99], v6, s[12:15], s30 offen offset:1024 sc1
buffer_load_dwordx4 v[100:103], v19, s[12:15], s30 offen offset:1024 sc1
buffer_load_dwordx4 v[104:107], v6, s[12:15], s31 offen offset:0 sc1
buffer_load_dwordx4 v[108:111], v19, s[12:15], s31 offen offset:0 sc1
buffer_load_dwordx4 v[112:115], v6, s[12:15], s31 offen offset:1024 sc1
buffer_load_dwordx4 v[116:119], v19, s[12:15], s31 offen offset:1024 sc1
s_waitcnt vmcnt(8)
s_branch L_o5_b
L_o5_a:
s_waitcnt vmcnt(0)
L_o5_b:
v_max3_u32 v2, v72, v76, v80
v_max_u32 v2, v2, v84
v_cmp_eq_u32 vcc, -1, v2
s_cbranch_vccnz L_o5_rt
s_branch L_o5_ok
L_o6_rt:
s_add_u32 s78, s78, 1
s_cmp_gt_u32 s78, 65536
s_cbranch_scc1 L_o6_ok
buffer_load_dwordx4 v[88:91], v6, s[12:15], s30 offen offset:0 sc1
buffer_load_dwordx4 v[92:95], v19, s[12:15], s30 offen offset:0 sc1
buffer_load_dwordx4 v[96:99], v6, s[12:15], s30 offen offset:1024 sc1
buffer_load_dwordx4 v[100:103], v19, s[12:15], s30 offen offset:1024 sc1
s_waitcnt vmcnt(4)
v_max3_u32 v2, v104, v108, v112
v_max3_u32 v2, v2, v116, v56
v_max3_u32 v2, v2, v60, v64
v_max3_u32 v2, v2, v68, v68
v_cmp_eq_u32 vcc, -1, v2
s_cbranch_vccz L_o6_a
buffer_load_dwordx4 v[104:107], v6, s[12:15], s31 offen offset:0 sc1
buffer_load_dwordx4 v[108:111], v19, s[12:15], s31 offen offset:0 sc1
buffer_load_dwordx4 v[112:115], v6, s[12:15], s31 offen offset:1024 sc1
buffer_load_dwordx4 v[116:119], v19, s[12:15], s31 offen offset:1024 sc1
buffer_load_dwordx4 v[56:59], v6, s[12:15], s32 offen offset:0 sc1
buffer_load_dwordx4 v[60:63], v19, s[12:15], s32 offen offset:0 sc1
buffer_load_dwordx4 v[64:67], v6, s[12:15], s32 offen offset:1024 sc1
buffer_load_dwordx4 v[68:71], v19, s[12:15], s32 offen offset:1024 sc1
s_waitcnt vmcnt(8)
s_branch L_o6_b
L_o6_a:
s_waitcnt vmcnt(0)
L_o6_b:
v_max3_u32 v2, v88, v92, v96
v_max_u32 v2, v2, v100
v_cmp_eq_u32 vcc, -1, v2
s_cbranch_vccnz L_o6_rt
s_branch L_o6_ok
L_o7_rt:
s_add_u32 s78, s78, 1
s_cmp_gt_u32 s78, 65536
s_cbranch_scc1 L_o7_ok
buffer_load_dwordx4 v[104:107], v6, s[12:15], s31 offen offset:0 sc1
buffer_load_dwordx4 v[108:111], v19, s[12:15], s31 offen offset:0 sc1
buffer_load_dwordx4 v[112:115], v6, s[12:15], s31 offen offset:1024 sc1
buffer_load_dwordx4 v[116:119], v19, s[12:15], s31 offen offset:1024 sc1
s_waitcnt vmcnt(4)
v_max3_u32 v2, v56, v60, v64
v_max3_u32 v2, v2, v68, v72
v_max3_u32 v2, v2, v76, v80
v_max3_u32 v2, v2, v84, v84
v_cmp_eq_u32 vcc, -1, v2
s_cbranch_vccz L_o7_a
buffer_load_dwordx4 v[56:59], v6, s[12:15], s32 offen offset:0 sc1
buffer_load_dwordx4 v[60:63], v19, s[12:15], s32 offen offset:0 sc1
buffer_load_dwordx4 v[64:67], v6, s[12:15], s32 offen offset:1024 sc1
buffer_load_dwordx4 v[68:71], v19, s[12:15], s32 offen offset:1024 sc1
buffer_load_dwordx4 v[72:75], v6, s[12:15], s33 offen offset:0 sc1
buffer_load_dwordx4 v[76:79], v19, s[12:15], s33 offen offset:0 sc1
buffer_load_dwordx4 v[80:83], v6, s[12:15], s33 offen offset:1024 sc1
buffer_load_dwordx4 v[84:87], v19, s[12:15], s33 offen offset:1024 sc1
s_waitcnt vmcnt(8)
s_branch L_o7_b
L_o7_a:
s_waitcnt vmcnt(0)
L_o7_b:
v_max3_u32 v2, v104, v108, v112
v_max_u32 v2, v2, v116
v_cmp_eq_u32 vcc, -1, v2
s_cbranch_vccnz L_o7_rt
s_branch L_o7_ok
L_o8_rt:
s_add_u32 s78, s78, 1
s_cmp_gt_u32 s78, 65536
s_cbranch_scc1 L_o8_ok
buffer_load_dwordx4 v[56:59], v6, s[12:15], s32 offen offset:0 sc1
buffer_load_dwordx4 v[60:63], v19, s[12:15], s32 offen offset:0 sc1
buffer_load_dwordx4 v[64:67], v6, s[12:15], s32 offen offset:1024 sc1
buffer_load_dwordx4 v[68:71], v19, s[12:15], s32 offen offset:1024 sc1
s_waitcnt vmcnt(4)
v_max3_u32 v2, v72, v76, v80
v_max3_u32 v2, v2, v84, v88
v_max3_u32 v2, v2, v92, v96
v_max3_u32 v2, v2, v100, v100
v_cmp_eq_u32 vcc, -1, v2
s_cbranch_vccz L_o8_a
buffer_load_dwordx4 v[72:75], v6, s[12:15], s33 offen offset:0 sc1
buffer_load_dwordx4 v[76:79], v19, s[12:15], s33 offen offset:0 sc1
buffer_load_dwordx4 v[80:83], v6, s[12:15], s33 offen offset:1024 sc1
buffer_load_dwordx4 v[84:87], v19, s[12:15], s33 offen offset:1024 sc1
buffer_load_dwordx4 v[88:91], v6, s[12:15], s34 offen offset:0 sc1
buffer_load_dwordx4 v[92:95], v19, s[12:15], s34 offen offset:0 sc1
buffer_load_dwordx4 v[96:99], v6, s[12:15], s34 offen offset:1024 sc1
buffer_load_dwordx4 v[100:103], v19, s[12:15], s34 offen offset:1024 sc1
s_waitcnt vmcnt(8)
s_branch L_o8_b
L_o8_a:
s_waitcnt vmcnt(0)
L_o8_b:
v_max3_u32 v2, v56, v60, v64
v_max_u32 v2, v2, v68
v_cmp_eq_u32 vcc, -1, v2
s_cbranch_vccnz L_o8_rt
s_branch L_o8_ok
L_o9_rt:
s_add_u32 s78, s78, 1
s_cmp_gt_u32 s78, 65536
s_cbranch_scc1 L_o9_ok
buffer_load_dwordx4 v[72:75], v6, s[12:15], s33 offen offset:0 sc1
buffer_load_dwordx4 v[76:79], v19, s[12:15], s33 offen offset:0 sc1
buffer_load_dwordx4 v[80:83], v6, s[12:15], s33 offen offset:1024 sc1
buffer_load_dwordx4 v[84:87], v19, s[12:15], s33 offen offset:1024 sc1
s_waitcnt vmcnt(4)
v_max3_u32 v2, v88, v92, v96
v_max3_u32 v2, v2, v100, v104
v_max3_u32 v2, v2, v108, v112
v_max3_u32 v2, v2, v116, v116
v_cmp_eq_u32 vcc, -1, v2
s_cbranch_vccz L_o9_a
buffer_load_dwordx4 v[88:91], v6, s[12:15], s34 offen offset:0 sc1
buffer_load_dwordx4 v[92:95], v19, s[12:15], s34 offen offset:0 sc1
buffer_load_dwordx4 v[96:99], v6, s[12:15], s34 offen offset:1024 sc1
buffer_load_dwordx4 v[100:103], v19, s[12:15], s34 offen offset:1024 sc1
buffer_load_dwordx4 v[104:107], v6, s[12:15], s35 offen offset:0 sc1
buffer_load_dwordx4 v[108:111], v19, s[12:15], s35 offen offset:0 sc1
buffer_load_dwordx4 v[112:115], v6, s[12:15], s35 offen offset:1024 sc1
buffer_load_dwordx4 v[116:119], v19, s[12:15], s35 offen offset:1024 sc1
s_waitcnt vmcnt(8)
s_branch L_o9_b
L_o9_a:
s_waitcnt vmcnt(0)
L_o9_b:
v_max3_u32 v2, v72, v76, v80
v_max_u32 v2, v2, v84
v_cmp_eq_u32 vcc, -1, v2
s_cbranch_vccnz L_o9_rt
s_branch L_o9_ok
L_o10_rt:
s_add_u32 s78, s78, 1
s_cmp_gt_u32 s78, 65536
s_cbranch_scc1 L_o10_ok
buffer_load_dwordx4 v[88:91], v6, s[12:15], s34 offen offset:0 sc1
buffer_load_dwordx4 v[92:95], v19, s[12:15], s34 offen offset:0 sc1
buffer_load_dwordx4 v[96:99], v6, s[12:15], s34 offen offset:1024 sc1
buffer_load_dwordx4 v[100:103], v19, s[12:15], s34 offen offset:1024 sc1
s_waitcnt vmcnt(4)
v_max3_u32 v2, v104, v108, v112
v_max3_u32 v2, v2, v116, v56
v_max3_u32 v2, v2, v60, v64
v_max3_u32 v2, v2, v68, v68
v_cmp_eq_u32 vcc, -1, v2
s_cbranch_vccz L_o10_a
buffer_load_dwordx4 v[104:107], v6, s[12:15], s35 offen offset:0 sc1
buffer_load_dwordx4 v[108:111], v19, s[12:15], s35 offen offset:0 sc1
buffer_load_dwordx4 v[112:115], v6, s[12:15], s35 offen offset:1024 sc1
buffer_load_dwordx4 v[116:119], v19, s[12:15], s35 offen offset:1024 sc1
buffer_load_dwordx4 v[56:59], v6, s[12:15], s36 offen offset:0 sc1
buffer_load_dwordx4 v[60:63], v19, s[12:15], s36 offen offset:0 sc1
buffer_load_dwordx4 v[64:67], v6, s[12:15], s36 offen offset:1024 sc1
buffer_load_dwordx4 v[68:71], v19, s[12:15], s36 offen offset:1024 sc1
s_waitcnt vmcnt(8)
s_branch L_o10_b
L_o10_a:
s_waitcnt vmcnt(0)
L_o10_b:
v_max3_u32 v2, v88, v92, v96
v_max_u32 v2, v2, v100
v_cmp_eq_u32 vcc, -1, v2
s_cbranch_vccnz L_o10_rt
s_branch L_o10_ok
L_o11_rt:
s_add_u32 s78, s78, 1
s_cmp_gt_u32 s78, 65536
s_cbranch_scc1 L_o11_ok
buffer_load_dwordx4 v[104:107], v6, s[12:15], s35 offen offset:0 sc1
buffer_load_dwordx4 v[108:111], v19, s[12:15], s35 offen offset:0 sc1
buffer_load_dwordx4 v[112:115], v6, s[12:15], s35 offen offset:1024 sc1
buffer_load_dwordx4 v[116:119], v19, s[12:15], s35 offen offset:1024 sc1
s_waitcnt vmcnt(4)
v_max3_u32 v2, v56, v60, v64
v_max3_u32 v2, v2, v68, v72
v_max3_u32 v2, v2, v76, v80
v_max3_u32 v2, v2, v84, v84
v_cmp_eq_u32 vcc, -1, v2
s_cbranch_vccz L_o11_a
buffer_load_dwordx4 v[56:59], v6, s[12:15], s36 offen offset:0 sc1
buffer_load_dwordx4 v[60:63], v19, s[12:15], s36 offen offset:0 sc1
buffer_load_dwordx4 v[64:67], v6, s[12:15], s36 offen offset:1024 sc1
buffer_load_dwordx4 v[68:71], v19, s[12:15], s36 offen offset:1024 sc1
buffer_load_dwordx4 v[72:75], v6, s[12:15], s37 offen offset:0 sc1
buffer_load_dwordx4 v[76:79], v19, s[12:15], s37 offen offset:0 sc1
buffer_load_dwordx4 v[80:83], v6, s[12:15], s37 offen offset:1024 sc1
buffer_load_dwordx4 v[84:87], v19, s[12:15], s37 offen offset:1024 sc1
s_waitcnt vmcnt(8)
s_branch L_o11_b
L_o11_a:
s_waitcnt vmcnt(0)
L_o11_b:
v_max3_u32 v2, v104, v108, v112
v_max_u32 v2, v2, v116
v_cmp_eq_u32 vcc, -1, v2
s_cbranch_vccnz L_o11_rt
s_branch L_o11_ok
L_o12_rt:
s_add_u32 s78, s78, 1
s_cmp_gt_u32 s78, 65536
s_cbranch_scc1 L_o12_ok
buffer_load_dwordx4 v[56:59], v6, s[12:15], s36 offen offset:0 sc1
buffer_load_dwordx4 v[60:63], v19, s[12:15], s36 offen offset:0 sc1
buffer_load_dwordx4 v[64:67], v6, s[12:15], s36 offen offset:1024 sc1
buffer_load_dwordx4 v[68:71], v19, s[12:15], s36 offen offset:1024 sc1
s_waitcnt vmcnt(4)
v_max3_u32 v2, v72, v76, v80
v_max3_u32 v2, v2, v84, v88
v_max3_u32 v2, v2, v92, v96
v_max3_u32 v2, v2, v100, v100
v_cmp_eq_u32 vcc, -1, v2
s_cbranch_vccz L_o12_a
buffer_load_dwordx4 v[72:75], v6, s[12:15], s37 offen offset:0 sc1
buffer_load_dwordx4 v[76:79], v19, s[12:15], s37 offen offset:0 sc1
buffer_load_dwordx4 v[80:83], v6, s[12:15], s37 offen offset:1024 sc1
buffer_load_dwordx4 v[84:87], v19, s[12:15], s37 offen offset:1024 sc1
buffer_load_dwordx4 v[88:91], v6, s[12:15], s38 offen offset:0 sc1
buffer_load_dwordx4 v[92:95], v19, s[12:15], s38 offen offset:0 sc1
buffer_load_dwordx4 v[96:99], v6, s[12:15], s38 offen offset:1024 sc1
buffer_load_dwordx4 v[100:103], v19, s[12:15], s38 offen offset:1024 sc1
s_waitcnt vmcnt(8)
s_branch L_o12_b
L_o12_a:
s_waitcnt vmcnt(0)
L_o12_b:
v_max3_u32 v2, v56, v60, v64
v_max_u32 v2, v2, v68
v_cmp_eq_u32 vcc, -1, v2
s_cbranch_vccnz L_o12_rt
s_branch L_o12_ok
L_o13_rt:
s_add_u32 s78, s78, 1
s_cmp_gt_u32 s78, 65536
s_cbranch_scc1 L_o13_ok
buffer_load_dwordx4 v[72:75], v6, s[12:15], s37 offen offset:0 sc1
buffer_load_dwordx4 v[76:79], v19, s[12:15], s37 offen offset:0 sc1
buffer_load_dwordx4 v[80:83], v6, s[12:15], s37 offen offset:1024 sc1
buffer_load_dwordx4 v[84:87], v19, s[12:15], s37 offen offset:1024 sc1
s_branch L_over18
L_pad18:
s_branch L_retG
L_over18:
s_waitcnt vmcnt(4)
v_max3_u32 v2, v88, v92, v96
v_max3_u32 v2, v2, v100, v104
v_max3_u32 v2, v2, v108, v112
v_max3_u32 v2, v2, v116, v116
v_cmp_eq_u32 vcc, -1, v2
s_cbranch_vccz L_o13_a
buffer_load_dwordx4 v[88:91], v6, s[12:15], s38 offen offset:0 sc1
buffer_load_dwordx4 v[92:95], v19, s[12:15], s38 offen offset:0 sc1
buffer_load_dwordx4 v[96:99], v6, s[12:15], s38 offen offset:1024 sc1
buffer_load_dwordx4 v[100:103], v19, s[12:15], s38 offen offset:1024 sc1
buffer_load_dwordx4 v[104:107], v6, s[12:15], s39 offen offset:0 sc1
buffer_load_dwordx4 v[108:111], v19, s[12:15], s39 offen offset:0 sc1
buffer_load_dwordx4 v[112:115], v6, s[12:15], s39 offen offset:1024 sc1
buffer_load_dwordx4 v[116:119], v19, s[12:15], s39 offen offset:1024 sc1
s_waitcnt vmcnt(8)
s_branch L_o13_b
L_o13_a:
s_waitcnt vmcnt(0)
L_o13_b:
v_max3_u32 v2, v72, v76, v80
v_max_u32 v2, v2, v84
v_cmp_eq_u32 vcc, -1, v2
s_cbranch_vccnz L_o13_rt
s_branch L_o13_ok
L_o14_rt:
s_add_u32 s78, s78, 1
s_cmp_gt_u32 s78, 65536
s_cbranch_scc1 L_o14_ok
buffer_load_dwordx4 v[88:91], v6, s[12:15], s38 offen offset:0 sc1
buffer_load_dwordx4 v[92:95], v19, s[12:15], s38 offen offset:0 sc1
buffer_load_dwordx4 v[96:99], v6, s[12:15], s38 offen offset:1024 sc1
buffer_load_dwordx4 v[100:103], v19, s[12:15], s38 offen offset:1024 sc1
s_waitcnt vmcnt(4)
v_max3_u32 v2, v104, v108, v112
v_max3_u32 v2, v2, v116, v116
v_cmp_eq_u32 vcc, -1, v2
s_cbranch_vccz L_o14_a
buffer_load_dwordx4 v[104:107], v6, s[12:15], s39 offen offset:0 sc1
buffer_load_dwordx4 v[108:111], v19, s[12:15], s39 offen offset:0 sc1
buffer_load_dwordx4 v[112:115], v6, s[12:15], s39 offen offset:1024 sc1
buffer_load_dwordx4 v[116:119], v19, s[12:15], s39 offen offset:1024 sc1
s_waitcnt vmcnt(4)
s_branch L_o14_b
L_o14_a:
s_waitcnt vmcnt(0)
L_o14_b:
v_max3_u32 v2, v88, v92, v96
v_max_u32 v2, v2, v100
v_cmp_eq_u32 vcc, -1, v2
s_cbranch_vccnz L_o14_rt
s_branch L_o14_ok
L_o15_rt:
s_add_u32 s78, s78, 1
s_cmp_gt_u32 s78, 65536
s_cbranch_scc1 L_o15_ok
buffer_load_dwordx4 v[104:107], v6, s[12:15], s39 offen offset:0 sc1
buffer_load_dwordx4 v[108:111], v19, s[12:15], s39 offen offset:0 sc1
buffer_load_dwordx4 v[112:115], v6, s[12:15], s39 offen offset:1024 sc1
buffer_load_dwordx4 v[116:119], v19, s[12:15], s39 offen offset:1024 sc1
s_waitcnt vmcnt(0)
L_o15_b:
v_max3_u32 v2, v104, v108, v112
v_max_u32 v2, v2, v116
v_cmp_eq_u32 vcc, -1, v2
s_cbranch_vccnz L_o15_rt
s_branch L_o15_ok
L_stp_s:
buffer_store_dwordx4 v[72:75], v144, s[12:15], s72 offen offset:0 sc1
buffer_store_dwordx4 v[76:79], v144, s[12:15], s72 offen offset:256 sc1
s_branch L_stp_d
L_pad19:
s_branch L_retG
L_st_rt:
s_add_u32 s78, s78, 1
s_cmp_gt_u32 s78, 65536
s_cbranch_scc1 L_st_ok
v_cmp_ne_u32 vcc, s68, v99
s_cbranch_vccz L_st_p0
s_add_u32 s70, s75, 0
buffer_load_dwordx4 v[96:99], v145, s[12:15], s70 offen sc1
L_st_p0:
v_cmp_ne_u32 vcc, s68, v103
s_cbranch_vccz L_st_p1
s_add_u32 s70, s75, 4096
buffer_load_dwordx4 v[100:103], v145, s[12:15], s70 offen sc1
L_st_p1:
v_cmp_ne_u32 vcc, s68, v107
s_cbranch_vccz L_st_p2
s_add_u32 s70, s75, 8192
buffer_load_dwordx4 v[104:107], v145, s[12:15], s70 offen sc1
L_st_p2:
v_cmp_ne_u32 vcc, s68, v111
s_cbranch_vccz L_st_p3
s_add_u32 s70, s75, 12288
buffer_load_dwordx4 v[108:111], v145, s[12:15], s70 offen sc1
L_st_p3:
v_cmp_ne_u32 vcc, s68, v115
s_cbranch_vccz L_st_p4
s_add_u32 s70, s75, 16384
buffer_load_dwordx4 v[112:115], v145, s[12:15], s70 offen sc1
L_st_p4:
v_cmp_ne_u32 vcc, s68, v119
s_cbranch_vccz L_st_p5
s_add_u32 s70, s75, 20480
buffer_load_dwordx4 v[116:119], v145, s[12:15], s70 offen sc1
L_st_p5:
v_cmp_ne_u32 vcc, s68, v123
s_cbranch_vccz L_st_p6
s_add_u32 s70, s75, 24576
buffer_load_dwordx4 v[120:123], v145, s[12:15], s70 offen sc1
L_st_p6:
v_cmp_ne_u32 vcc, s68, v127
s_cbranch_vccz L_st_p7
s_add_u32 s70, s75, 28672
buffer_load_dwordx4 v[124:127], v145, s[12:15], s70 offen sc1
L_st_p7:
s_waitcnt vmcnt(0)
s_branch L_st_chk
L_fin:
.section .rodata,"a"
.p2align 6
.amdhsa_kernel sequential_preLN__linear_attn_block__moe_arch_mod__prompt_kernel
  .amdhsa_next_free_vgpr 256
  .amdhsa_next_free_sgpr 102
  .amdhsa_accum_offset 152
  .amdhsa_group_segment_fixed_size 0
  .amdhsa_kernarg_size 88
  .amdhsa_user_sgpr_count 2
  .amdhsa_user_sgpr_kernarg_segment_ptr 1
  .amdhsa_system_sgpr_workgroup_id_x 1
  .amdhsa_float_denorm_mode_32 3
.end_amdhsa_kernel
```

```asm
; @launch grid=(256,1,1) block=(512,1,1) lds=163840
.amdgcn_target "amdgcn-amd-amdhsa--gfx950"
.text
.p2alignl 12, 0xbf810000
.fill 832, 4, 0xbf810000
.globl sequential_preLN__linear_attn_block__moe_arch_mod__prompt_kernel
.p2align 8
.type sequential_preLN__linear_attn_block__moe_arch_mod__prompt_kernel,@function
sequential_preLN__linear_attn_block__moe_arch_mod__prompt_kernel:
s_cmp_ge_u32 s2, 256
s_cbranch_scc1 L_end
s_load_dwordx16 s[40:55], s[0:1], 0
s_load_dwordx2 s[56:57], s[0:1], 64
s_load_dwordx2 s[58:59], s[0:1], 80
s_getpc_b64 s[20:21]
L_pc:
s_sub_u32 s20, s20, L_pc-sequential_preLN__linear_attn_block__moe_arch_mod__prompt_kernel
s_subb_u32 s21, s21, 0
s_and_b32 s21, s21, 0xffff
s_mov_b32 s22, L_fin-sequential_preLN__linear_attn_block__moe_arch_mod__prompt_kernel
s_mov_b32 s23, 0x20000
s_lshr_b32 s70, s2, 3
s_mul_i32 s70, s70, 1536
v_lshlrev_b32 v81, 7, v0
v_cmp_gt_u32 vcc, 12, v0
s_nop 0
s_mov_b64 exec, vcc
buffer_load_dword v81, v81, s[20:23], s70 offen
s_mov_b64 exec, -1
v_lshrrev_b32 v2, 6, v0
v_and_b32 v1, 63, v0
v_readfirstlane_b32 s60, v2
s_and_b32 s62, s2, 7
s_lshr_b32 s63, s2, 3
s_lshl_b32 s64, s62, 1
s_and_b32 s70, s63, 1
s_add_u32 s64, s64, s70
s_lshr_b32 s65, s63, 1
s_lshl_b32 s79, s64, 4
s_add_u32 s79, s79, s65
s_mov_b32 s78, 0
s_mul_i32 s70, s62, 2
s_add_u32 s89, s65, s70
s_and_b32 s89, s89, 15
s_lshr_b32 s61, s60, 2
s_and_b32 s60, s60, 3
s_lshr_b32 s66, s60, 1
s_and_b32 s67, s60, 1
v_lshlrev_b32 v16, 4, v1
s_cmp_eq_u32 s61, 0
s_cbranch_scc1 L_compute
s_setprio 1
v_mov_b32 v18, v16
s_lshl_b32 s70, s65, 2
s_add_u32 s70, s70, s60
s_lshl_b32 s70, s70, 16
v_lshrrev_b32 v2, 3, v1
v_lshlrev_b32 v5, 11, v2
v_add_u32 v5, s70, v5
v_lshrrev_b32 v3, 4, v1
v_and_b32 v4, 7, v1
v_xor_b32 v3, v3, v4
v_xor_b32_e64 v6, 0, v3
v_lshl_add_u32 v6, v6, 4, v5
v_add_u32 v8, 0, v6
v_xor_b32 v6, 4, v3
v_lshl_add_u32 v6, v6, 4, v5
v_add_u32 v9, 15360, v6
v_xor_b32 v6, 0, v3
v_lshl_add_u32 v6, v6, 4, v5
v_add_u32 v10, 30720, v6
v_xor_b32 v6, 4, v3
v_lshl_add_u32 v6, v6, 4, v5
v_add_u32 v11, 46080, v6
s_lshl_b32 s70, s60, 4
v_add_u32 v5, s70, v2
v_mul_u32_u24 v5, 6144, v5
s_lshl_b32 s70, s64, 7
v_add_u32 v5, s70, v5
v_bfe_u32 v3, v1, 4, 1
v_lshlrev_b32 v3, 1, v3
v_xor_b32 v3, v3, v4
v_xor_b32 v6, 0, v3
v_lshl_add_u32 v6, v6, 4, v5
v_add_u32 v12, 0, v6
v_xor_b32 v6, 4, v3
v_lshl_add_u32 v6, v6, 4, v5
v_add_u32 v13, 48128, v6
v_xor_b32 v6, 0, v3
v_lshl_add_u32 v6, v6, 4, v5
v_add_u32 v14, 0, v6
v_xor_b32 v6, 4, v3
v_lshl_add_u32 v6, v6, 4, v5
v_add_u32 v15, 48128, v6
v_xor_b32 v6, 0, v3
v_lshl_add_u32 v6, v6, 4, v5
v_add_u32 v16, 4096, v6
v_xor_b32 v6, 4, v3
v_lshl_add_u32 v6, v6, 4, v5
v_add_u32 v17, 52224, v6
s_lshl_b32 s76, s60, 12
s_mul_i32 s77, s60, 6144
s_and_b32 s70, s64, 1
s_lshl_b32 s70, s70, 3
s_mov_b32 s70, 0
s_andn2_b32 s71, s65, 1
s_add_u32 s70, s70, s71
s_and_b32 s70, s70, 15
s_mul_i32 s75, s70, 393216
s_lshl_b32 s74, s70, 7
s_waitcnt lgkmcnt(0)
s_load_dword s68, s[58:59], 0
s_mov_b32 s4, s40
s_and_b32 s5, s41, 0xffff
s_mov_b32 s6, 4194304
s_mov_b32 s7, 0x20000
s_mov_b32 s8, s42
s_and_b32 s9, s43, 0xffff
s_mov_b32 s10, 6291456
s_mov_b32 s11, 0x20000
s_add_u32 m0, s76, 122880
s_nop 0
buffer_load_dwordx4 v8, s[4:7], s74 offen offset:0 lds
buffer_load_dwordx4 v9, s[4:7], s74 offen offset:1024 lds
buffer_load_dwordx4 v10, s[4:7], s74 offen offset:2048 lds
buffer_load_dwordx4 v11, s[4:7], s74 offen offset:3072 lds
s_add_u32 s74, s74, 128
s_and_b32 s74, s74, 2047
s_add_u32 m0, s77, 0
s_nop 0
buffer_load_dwordx4 v12, s[8:11], s75 offen offset:0 lds
buffer_load_dwordx4 v13, s[8:11], s75 offen offset:1024 lds
buffer_load_dwordx4 v14, s[8:11], s75 offen offset:2048 lds
buffer_load_dwordx4 v15, s[8:11], s75 offen offset:3072 lds
s_add_u32 m0, s77, 4096
s_nop 0
buffer_load_dwordx4 v16, s[8:11], s75 offen offset:0 lds
buffer_load_dwordx4 v17, s[8:11], s75 offen offset:1024 lds
s_add_u32 s75, s75, 393216
s_cmp_eq_u32 s75, 6291456
s_cselect_b32 s75, 0, s75
s_mov_b32 s12, s58
s_and_b32 s13, s59, 0xffff
s_mov_b32 s14, 268435456
s_mov_b32 s15, 0x20000
s_mov_b32 s16, s44
s_and_b32 s17, s45, 0xffff
s_mov_b32 s18, 2097152
s_mov_b32 s19, 0x20000
s_mov_b32 s20, s56
s_and_b32 s21, s57, 0xffff
s_mov_b32 s22, 4194304
s_mov_b32 s23, 0x20000
s_mov_b32 s24, s50
s_and_b32 s25, s51, 0xffff
s_mov_b32 s26, 7340032
s_mov_b32 s27, 0x20000
s_mov_b32 s28, s52
s_and_b32 s29, s53, 0xffff
s_mov_b32 s30, 7340032
s_mov_b32 s31, 0x20000
s_mov_b32 s32, s54
s_and_b32 s33, s55, 0xffff
s_mov_b32 s34, 7340032
s_mov_b32 s35, 0x20000
s_mov_b32 s36, s48
s_and_b32 s37, s49, 0xffff
s_mov_b32 s38, 2048
s_mov_b32 s39, 0x20000
s_lshl_b32 s70, s65, 7
s_lshl_b32 s71, s64, 3
s_add_u32 s70, s70, s71
s_lshl_b32 s71, s60, 1
s_add_u32 s87, s70, s71
v_lshrrev_b32 v2, 3, v1
v_lshlrev_b32 v3, 11, v2
v_bfe_u32 v5, v1, 4, 2
v_lshlrev_b32 v5, 1, v5
v_and_b32 v4, 7, v1
v_xor_b32 v5, v5, v4
v_lshl_add_u32 v3, v5, 4, v3
s_lshl_b32 s70, s65, 7
v_add_u32 v80, s70, v3
v_mov_b32 v72, -1
v_mov_b32 v73, -1
v_mov_b32 v74, -1
v_mov_b32 v75, -1
s_mul_i32 s80, s79, 4352
s_add_u32 s80, s80, 524288
s_and_b32 s81, s65, 7
s_lshl_b32 s81, s81, 19
s_lshr_b32 s70, s65, 1
s_xor_b32 s70, s70, s65
s_and_b32 s70, s70, 4
s_lshl_b32 s70, s70, 11
s_xor_b32 s70, s70, 2105344
s_add_u32 s81, s81, s70
s_mul_i32 s70, s66, 262144
s_add_u32 s81, s81, s70
s_lshr_b32 s70, s64, 2
s_lshl_b32 s70, s70, 14
s_add_u32 s81, s81, s70
s_and_b32 s70, s64, 3
s_lshl_b32 s70, s70, 11
s_add_u32 s81, s81, s70
s_lshl_b32 s70, s67, 10
s_add_u32 s81, s81, s70
s_mov_b32 s72, 0x6543e210
s_mov_b32 s73, 0xdcbaf987
s_lshl_b32 s70, s64, 2
s_lshr_b64 s[72:73], s[72:73], s70
s_and_b32 s3, s72, 15
v_mul_u32_u24 v76, 7168, v2
v_lshl_add_u32 v76, v4, 4, v76
v_lshlrev_b32 v77, 11, v2
v_lshl_add_u32 v77, v4, 4, v77
s_and_b32 s70, s65, 3
s_lshl_b32 s70, s70, 2
s_add_u32 s70, s70, s60
s_mul_i32 s85, s70, 458752
s_lshl_b32 s70, s3, 9
s_add_u32 s85, s85, s70
s_lshr_b32 s70, s65, 2
s_lshl_b32 s70, s70, 7
s_xor_b32 s71, s70, 128
v_add_u32 v78, s71, v76
v_add_u32 v76, s70, v76
s_and_b32 s70, s65, 3
s_lshl2_add_u32 s70, s3, s70
s_and_b32 s71, s65, 12
s_add_u32 s71, s71, s60
s_lshl_b32 s86, s70, 17
s_lshl_b32 s70, s71, 7
s_add_u32 s86, s86, s70
s_cmp_lt_u32 s3, 14
s_cselect_b32 s26, s26, 0
s_cselect_b32 s30, s30, 0
s_cselect_b32 s34, s34, 0
s_mov_b32 s90, 0x10001
s_movk_i32 s91, 0xff
v_mov_b32 v79, 0
s_lshl_b32 s70, s87, 4
s_add_u32 s70, s70, 8192
v_writelane_b32 v79, s70, 0
s_lshl_b32 s70, s79, 4
s_add_u32 s70, s70, 4096
v_writelane_b32 v79, s70, 1
s_lshl_b32 s70, s64, 7
s_add_u32 s70, s70, 6815744
v_writelane_b32 v79, s70, 2
s_lshl_b32 s70, s79, 10
s_add_u32 s70, s70, 65536
v_writelane_b32 v79, s70, 3
s_lshl_b32 s70, s60, 10
s_add_u32 s70, s70, s80
v_writelane_b32 v79, s70, 4
s_lshl_b32 s70, s67, 7
s_add_u32 s70, s70, s80
s_add_u32 s70, s70, 4096
v_writelane_b32 v79, s70, 5
s_and_b32 s71, s65, 3
s_lshl2_add_u32 s71, s3, s71
s_and_b32 s70, s65, 12
s_add_u32 s70, s70, s60
s_lshl_b32 s71, s71, 7
s_bitcmp1_b32 s70, 3
s_cselect_b32 s72, 0, 8192
s_add_u32 s71, s71, s72
s_and_b32 s70, s70, 7
s_lshl_b32 s70, s70, 16
s_add_u32 s70, s70, s71
s_add_u32 s70, s70, 7340032
v_writelane_b32 v79, s70, 6
s_lshl_b32 s71, s79, 2
s_add_u32 s71, s71, s60
s_lshl_b32 s70, s71, 9
s_add_u32 s70, s70, 6291456
v_writelane_b32 v79, s70, 7
s_lshl_b32 s71, s79, 2
s_add_u32 s71, s71, s60
s_lshl_b32 s70, s71, 8
s_add_u32 s70, s70, 6946816
v_writelane_b32 v79, s70, 8
s_add_u32 s70, s81, 0
v_writelane_b32 v79, s70, 9
s_add_u32 s70, s81, 65536
v_writelane_b32 v79, s70, 10
s_add_u32 s70, s81, 131072
v_writelane_b32 v79, s70, 11
s_add_u32 s70, s81, 196608
v_writelane_b32 v79, s70, 12
s_and_b32 s70, s65, 7
s_min_u32 s71, s60, 0
s_lshl_b32 s71, s71, 3
s_add_u32 s70, s70, s71
s_lshl_b32 s70, s70, 4
s_add_u32 s70, s70, s64
s_lshl_b32 s70, s70, 7
s_add_u32 s70, s70, 6815744
v_writelane_b32 v79, s70, 2
v_and_b32 v2, 7, v1
v_lshlrev_b32 v2, 7, v2
v_lshrrev_b32 v3, 3, v1
v_lshl_add_u32 v83, v3, 16, v2
v_add_u32 v83, s81, v83
s_mov_b32 exec_lo, 0
s_and_b32 s71, s65, 3
s_lshl2_add_u32 s71, s3, s71
s_and_b32 s70, s65, 12
s_add_u32 s70, s70, s60
s_lshl_b32 s71, s71, 7
s_bitcmp1_b32 s70, 3
s_cselect_b32 s72, 0, 8192
s_add_u32 s71, s71, s72
s_and_b32 s70, s70, 7
s_lshl_b32 s70, s70, 16
s_add_u32 s70, s70, s71
s_add_u32 s70, s70, 7340032
s_mov_b32 exec_hi, 0xff
v_and_b32 v2, 3, v1
v_lshl_add_u32 v83, v2, 14, s70
s_lshl_b32 s70, s60, 10
s_add_u32 s70, s70, s80
s_mov_b32 exec_hi, 0xff0000
v_and_b32 v2, 7, v1
v_lshl_add_u32 v83, v2, 7, s70
s_lshl_b32 s71, s79, 2
s_add_u32 s71, s71, s60
s_lshl_b32 s70, s71, 9
s_add_u32 s70, s70, 6291456
s_mov_b32 exec_hi, 0xf000000
v_and_b32 v2, 3, v1
v_lshl_add_u32 v83, v2, 7, s70
s_lshl_b32 s71, s79, 2
s_add_u32 s71, s71, s60
s_lshl_b32 s70, s71, 8
s_add_u32 s70, s70, 6946816
s_mov_b32 exec_hi, 0x30000000
v_and_b32 v2, 1, v1
v_lshl_add_u32 v83, v2, 7, s70
s_lshl_b32 s70, s67, 7
s_add_u32 s70, s70, s80
s_add_u32 s70, s70, 4096
s_mov_b32 exec_hi, 0xc0000000
v_and_b32 v2, 0, v1
v_lshl_add_u32 v83, v2, 7, s70
s_lshl4_add_u32 s70, s64, s65
s_lshl2_add_u32 s70, s70, s60
s_lshl_b32 s70, s70, 6
s_add_u32 s70, s70, 1638400
s_mov_b32 exec_hi, 0x100
v_and_b32 v2, 0, v1
v_lshl_add_u32 v83, v2, 7, s70
s_mov_b64 exec, -1
s_add_u32 m0, s76, 106496
s_nop 0
buffer_load_dwordx4 v8, s[4:7], s74 offen offset:0 lds
buffer_load_dwordx4 v9, s[4:7], s74 offen offset:1024 lds
buffer_load_dwordx4 v10, s[4:7], s74 offen offset:2048 lds
buffer_load_dwordx4 v11, s[4:7], s74 offen offset:3072 lds
s_add_u32 s74, s74, 128
s_and_b32 s74, s74, 2047
s_add_u32 m0, s77, 81920
s_nop 0
buffer_load_dwordx4 v12, s[8:11], s75 offen offset:0 lds
buffer_load_dwordx4 v13, s[8:11], s75 offen offset:1024 lds
buffer_load_dwordx4 v14, s[8:11], s75 offen offset:2048 lds
buffer_load_dwordx4 v15, s[8:11], s75 offen offset:3072 lds
s_add_u32 m0, s77, 86016
s_nop 0
buffer_load_dwordx4 v16, s[8:11], s75 offen offset:0 lds
buffer_load_dwordx4 v17, s[8:11], s75 offen offset:1024 lds
s_add_u32 s75, s75, 393216
s_cmp_eq_u32 s75, 6291456
s_cselect_b32 s75, 0, s75
s_cmp_lt_u32 s3, 14
s_cbranch_scc1 L_norace
s_cmp_ge_u32 s60, 2
s_cbranch_scc1 L_norace
s_and_b32 s70, s3, 1
s_lshl4_add_u32 s70, s70, s65
s_lshl1_add_u32 s73, s70, s60
s_lshl_b32 s70, s73, 7
s_lshl_b32 s71, s60, 13
s_add_u32 s70, s70, s71
s_xor_b32 s70, s70, 401408
s_xor_b32 s71, s70, 0x2000
s_mov_b32 s69, 0x5bd1e995
s_waitcnt lgkmcnt(0)
s_load_dword s61, s[12:13], s70
s_load_dword s69, s[12:13], s71
s_lshr_b32 s70, s62, 2
s_xor_b32 s70, s70, s60
s_sub_u32 s70, 2, s70
s_add_u32 s71, s68, 1
s_lshl_b32 s71, s71, 2
s_lshl_b32 s73, s73, 2
s_add_u32 s73, s73, 7225600
s_waitcnt lgkmcnt(1)
s_cmp_eq_u32 s69, 0x5bd1e995
s_cselect_b32 s70, s70, 0
s_or_b32 s70, s70, s71
v_mov_b32_e64 v19, s70
s_mov_b64 exec, 1
buffer_store_dword v19, off, s[12:15], s73 sc1
s_mov_b64 exec, -1
L_norace:
s_waitcnt vmcnt(10)
s_barrier
s_add_u32 m0, s76, 65536
s_nop 0
buffer_load_dwordx4 v8, s[4:7], s74 offen offset:0 lds
buffer_load_dwordx4 v9, s[4:7], s74 offen offset:1024 lds
buffer_load_dwordx4 v10, s[4:7], s74 offen offset:2048 lds
buffer_load_dwordx4 v11, s[4:7], s74 offen offset:3072 lds
s_add_u32 s74, s74, 128
s_and_b32 s74, s74, 2047
s_add_u32 m0, s77, 40960
s_nop 0
buffer_load_dwordx4 v12, s[8:11], s75 offen offset:0 lds
buffer_load_dwordx4 v13, s[8:11], s75 offen offset:1024 lds
buffer_load_dwordx4 v14, s[8:11], s75 offen offset:2048 lds
buffer_load_dwordx4 v15, s[8:11], s75 offen offset:3072 lds
s_add_u32 m0, s77, 45056
s_nop 0
buffer_load_dwordx4 v16, s[8:11], s75 offen offset:0 lds
buffer_load_dwordx4 v17, s[8:11], s75 offen offset:1024 lds
s_add_u32 s75, s75, 393216
s_cmp_eq_u32 s75, 6291456
s_cselect_b32 s75, 0, s75
s_waitcnt vmcnt(10)
s_barrier
s_add_u32 m0, s76, 24576
s_nop 0
buffer_load_dwordx4 v8, s[4:7], s74 offen offset:0 lds
buffer_load_dwordx4 v9, s[4:7], s74 offen offset:1024 lds
buffer_load_dwordx4 v10, s[4:7], s74 offen offset:2048 lds
buffer_load_dwordx4 v11, s[4:7], s74 offen offset:3072 lds
s_add_u32 s74, s74, 128
s_and_b32 s74, s74, 2047
s_add_u32 m0, s77, 0
s_nop 0
buffer_load_dwordx4 v12, s[8:11], s75 offen offset:0 lds
buffer_load_dwordx4 v13, s[8:11], s75 offen offset:1024 lds
buffer_load_dwordx4 v14, s[8:11], s75 offen offset:2048 lds
buffer_load_dwordx4 v15, s[8:11], s75 offen offset:3072 lds
s_add_u32 m0, s77, 4096
s_nop 0
buffer_load_dwordx4 v16, s[8:11], s75 offen offset:0 lds
buffer_load_dwordx4 v17, s[8:11], s75 offen offset:1024 lds
s_add_u32 s75, s75, 393216
s_cmp_eq_u32 s75, 6291456
s_cselect_b32 s75, 0, s75
s_add_u32 m0, s76, 122880
s_nop 0
buffer_load_dwordx4 v8, s[4:7], s74 offen offset:0 lds
buffer_load_dwordx4 v9, s[4:7], s74 offen offset:1024 lds
buffer_load_dwordx4 v10, s[4:7], s74 offen offset:2048 lds
buffer_load_dwordx4 v11, s[4:7], s74 offen offset:3072 lds
s_add_u32 s74, s74, 128
s_and_b32 s74, s74, 2047
v_lshlrev_b32 v2, 3, v1
s_lshl_b32 s70, s60, 9
buffer_load_dwordx2 v[88:89], v2, s[36:39], s70 offen
s_lshl_b32 s70, s87, 11
buffer_load_dwordx4 v[20:23], v18, s[4:7], s70 offen offset:0
s_lshl_b32 s70, s87, 11
buffer_load_dwordx4 v[24:27], v18, s[4:7], s70 offen offset:1024
s_lshl_b32 s70, s87, 11
buffer_load_dwordx4 v[28:31], v18, s[4:7], s70 offen offset:2048
s_lshl_b32 s70, s87, 11
buffer_load_dwordx4 v[32:35], v18, s[4:7], s70 offen offset:3072
s_mov_b64 exec, 0x1ef
buffer_load_dword v81, v79, s[12:15], 0 offen
s_mov_b64 exec, -1
s_lshl_b32 s70, s64, 2
s_add_u32 s70, s70, s60
s_lshl_b32 s70, s70, 15
s_lshl_b32 s71, s65, 7
s_add_u32 s70, s70, s71
s_add_u32 s70, s70, 8388608
v_and_b32 v19, 0xf800, v77
v_mad_u32_u24 v19, v19, 3, v77
s_mov_b32 exec_hi, 0
buffer_store_dwordx4 v[72:75], v19, s[12:15], s70 offen sc1
s_mov_b64 exec, -1
s_lshl4_add_u32 s70, s64, s65
s_lshl2_add_u32 s70, s70, s60
s_lshl_b32 s70, s70, 6
s_add_u32 s70, s70, 1638400
s_mov_b64 exec, 15
buffer_store_dwordx4 v[72:75], v18, s[12:15], s70 offen sc1
s_mov_b64 exec, -1
s_waitcnt vmcnt(22)
s_barrier
s_add_u32 m0, s77, 81920
s_nop 0
buffer_load_dwordx4 v12, s[8:11], s75 offen offset:0 lds
buffer_load_dwordx4 v13, s[8:11], s75 offen offset:1024 lds
buffer_load_dwordx4 v14, s[8:11], s75 offen offset:2048 lds
buffer_load_dwordx4 v15, s[8:11], s75 offen offset:3072 lds
s_add_u32 m0, s77, 86016
s_nop 0
buffer_load_dwordx4 v16, s[8:11], s75 offen offset:0 lds
buffer_load_dwordx4 v17, s[8:11], s75 offen offset:1024 lds
s_add_u32 s75, s75, 393216
s_cmp_eq_u32 s75, 6291456
s_cselect_b32 s75, 0, s75
s_add_u32 m0, s76, 106496
s_nop 0
buffer_load_dwordx4 v8, s[4:7], s74 offen offset:0 lds
buffer_load_dwordx4 v9, s[4:7], s74 offen offset:1024 lds
buffer_load_dwordx4 v10, s[4:7], s74 offen offset:2048 lds
buffer_load_dwordx4 v11, s[4:7], s74 offen offset:3072 lds
s_add_u32 s74, s74, 128
s_and_b32 s74, s74, 2047
s_waitcnt vmcnt(22)
s_barrier
s_add_u32 m0, s77, 40960
s_nop 0
buffer_load_dwordx4 v12, s[8:11], s75 offen offset:0 lds
s_waitcnt vmcnt(14)
s_waitcnt lgkmcnt(0)
s_add_u32 s68, s68, 1
s_and_b32 s84, s68, 0xff
s_not_b32 s70, s68
v_and_b32 v82, 3, v1
v_lshrrev_b32_e64 v82, v82, s70
v_and_b32 v82, 1, v82
v_mul_u32_u24 v82, 0x10001, v82
buffer_load_dwordx4 v13, s[8:11], s75 offen offset:1024 lds
v_lshlrev_b32 v36, 16, v20
v_and_b32 v37, 0xffff0000, v20
v_lshlrev_b32 v38, 16, v21
v_and_b32 v39, 0xffff0000, v21
v_lshlrev_b32 v40, 16, v22
buffer_load_dwordx4 v14, s[8:11], s75 offen offset:2048 lds
v_and_b32 v41, 0xffff0000, v22
v_lshlrev_b32 v42, 16, v23
v_and_b32 v43, 0xffff0000, v23
v_lshlrev_b32 v44, 16, v24
v_and_b32 v45, 0xffff0000, v24
buffer_load_dwordx4 v15, s[8:11], s75 offen offset:3072 lds
v_lshlrev_b32 v46, 16, v25
v_and_b32 v47, 0xffff0000, v25
v_lshlrev_b32 v48, 16, v26
v_and_b32 v49, 0xffff0000, v26
v_lshlrev_b32 v50, 16, v27
s_add_u32 m0, s77, 45056
s_nop 0
buffer_load_dwordx4 v16, s[8:11], s75 offen offset:0 lds
v_and_b32 v51, 0xffff0000, v27
v_lshlrev_b32 v52, 16, v28
v_and_b32 v53, 0xffff0000, v28
v_lshlrev_b32 v54, 16, v29
v_and_b32 v55, 0xffff0000, v29
buffer_load_dwordx4 v17, s[8:11], s75 offen offset:1024 lds
s_add_u32 s75, s75, 393216
s_cmp_eq_u32 s75, 6291456
s_cselect_b32 s75, 0, s75
v_lshlrev_b32 v56, 16, v30
v_and_b32 v57, 0xffff0000, v30
v_lshlrev_b32 v58, 16, v31
v_and_b32 v59, 0xffff0000, v31
v_lshlrev_b32 v60, 16, v32
s_add_u32 m0, s76, 65536
s_nop 0
buffer_load_dwordx4 v8, s[4:7], s74 offen offset:0 lds
v_and_b32 v61, 0xffff0000, v32
v_lshlrev_b32 v62, 16, v33
v_and_b32 v63, 0xffff0000, v33
v_lshlrev_b32 v64, 16, v34
v_and_b32 v65, 0xffff0000, v34
buffer_load_dwordx4 v9, s[4:7], s74 offen offset:1024 lds
v_lshlrev_b32 v66, 16, v35
v_and_b32 v67, 0xffff0000, v35
v_add_f32 v20, v36, v40
v_add_f32 v28, v52, v56
v_add_f32 v21, v37, v41
buffer_load_dwordx4 v10, s[4:7], s74 offen offset:2048 lds
v_add_f32 v29, v53, v57
v_add_f32 v22, v38, v42
v_add_f32 v30, v54, v58
v_add_f32 v23, v39, v43
v_add_f32 v31, v55, v59
buffer_load_dwordx4 v11, s[4:7], s74 offen offset:3072 lds
s_add_u32 s74, s74, 128
s_and_b32 s74, s74, 2047
v_add_f32 v20, v20, v44
v_add_f32 v28, v28, v60
s_waitcnt vmcnt(14)
s_barrier
s_add_u32 m0, s77, 0
s_nop 0
buffer_load_dwordx4 v12, s[8:11], s75 offen offset:0 lds
v_add_f32 v21, v21, v45
v_add_f32 v29, v29, v61
v_add_f32 v22, v22, v46
v_add_f32 v30, v30, v62
v_add_f32 v23, v23, v47
buffer_load_dwordx4 v13, s[8:11], s75 offen offset:1024 lds
v_add_f32 v31, v31, v63
v_add_f32 v20, v20, v48
v_add_f32 v28, v28, v64
v_add_f32 v21, v21, v49
v_add_f32 v29, v29, v65
buffer_load_dwordx4 v14, s[8:11], s75 offen offset:2048 lds
v_add_f32 v22, v22, v50
v_add_f32 v30, v30, v66
v_add_f32 v23, v23, v51
v_add_f32 v31, v31, v67
v_add_f32_e64 v20, v20, v21
buffer_load_dwordx4 v15, s[8:11], s75 offen offset:3072 lds
v_add_f32 v22, v22, v23
v_add_f32 v28, v28, v29
v_add_f32 v30, v30, v31
v_add_f32 v2, v20, v22
v_add_f32 v4, v28, v30
s_add_u32 m0, s77, 4096
s_nop 0
buffer_load_dwordx4 v16, s[8:11], s75 offen offset:0 lds
v_add_f32_dpp v2, v2, v2 row_ror:1 row_mask:0xf bank_mask:0xf
v_add_f32_dpp v4, v4, v4 row_ror:1 row_mask:0xf bank_mask:0xf
s_nop 0
v_add_f32_dpp v2, v2, v2 row_ror:2 row_mask:0xf bank_mask:0xf
v_add_f32_dpp v4, v4, v4 row_ror:2 row_mask:0xf bank_mask:0xf
s_nop 0
v_add_f32_dpp v2, v2, v2 row_ror:4 row_mask:0xf bank_mask:0xf
buffer_load_dwordx4 v17, s[8:11], s75 offen offset:1024 lds
s_add_u32 s75, s75, 393216
s_cmp_eq_u32 s75, 6291456
s_cselect_b32 s75, 0, s75
v_add_f32_dpp v4, v4, v4 row_ror:4 row_mask:0xf bank_mask:0xf
v_add_f32_dpp v2, v2, v2 row_ror:8 row_mask:0xf bank_mask:0xf
s_nop 0
v_add_f32_dpp v4, v4, v4 row_ror:8 row_mask:0xf bank_mask:0xf
v_mov_b32 v6, v2
v_mov_b32 v7, v4
s_add_u32 m0, s76, 24576
s_nop 0
buffer_load_dwordx4 v8, s[4:7], s74 offen offset:0 lds
v_permlane16_swap_b32 v2, v6
v_permlane16_swap_b32 v4, v7
v_add_f32 v2, v2, v6
v_add_f32 v4, v4, v7
v_mov_b32 v6, v2
buffer_load_dwordx4 v9, s[4:7], s74 offen offset:1024 lds
v_mov_b32 v7, v4
v_permlane32_swap_b32 v2, v6
s_nop 0
v_permlane32_swap_b32 v4, v7
v_add_f32 v2, v2, v6
v_add_f32 v4, v4, v7
buffer_load_dwordx4 v10, s[4:7], s74 offen offset:2048 lds
v_mul_f32 v2, 0xba800000, v2
v_mul_f32 v4, 0xba800000, v4
v_add_f32_e64 v36, v36, v2
v_add_f32 v52, v52, v4
v_add_f32 v37, v37, v2
buffer_load_dwordx4 v11, s[4:7], s74 offen offset:3072 lds
s_add_u32 s74, s74, 128
s_and_b32 s74, s74, 2047
v_add_f32 v53, v53, v4
v_add_f32 v38, v38, v2
s_cmp_eq_u32 s60, 0
s_cbranch_scc1 L_pad0
s_cmp_eq_u32 s60, 1
s_cbranch_scc1 L_pad3
s_cmp_eq_u32 s60, 2
s_cbranch_scc1 L_pad4
s_branch L_ret4
L_ret4:
s_waitcnt vmcnt(14)
s_barrier
s_add_u32 m0, s77, 81920
s_nop 0
buffer_load_dwordx4 v12, s[8:11], s75 offen offset:0 lds
v_add_f32 v54, v54, v4
v_add_f32 v39, v39, v2
v_add_f32 v55, v55, v4
v_add_f32 v40, v40, v2
v_add_f32 v56, v56, v4
buffer_load_dwordx4 v13, s[8:11], s75 offen offset:1024 lds
v_add_f32 v41, v41, v2
v_add_f32 v57, v57, v4
v_add_f32 v42, v42, v2
v_add_f32 v58, v58, v4
v_add_f32 v43, v43, v2
buffer_load_dwordx4 v14, s[8:11], s75 offen offset:2048 lds
v_add_f32 v59, v59, v4
v_add_f32 v44, v44, v2
v_add_f32 v60, v60, v4
v_add_f32 v45, v45, v2
v_add_f32 v61, v61, v4
buffer_load_dwordx4 v15, s[8:11], s75 offen offset:3072 lds
v_add_f32 v46, v46, v2
v_add_f32 v62, v62, v4
v_add_f32 v47, v47, v2
v_add_f32 v63, v63, v4
v_add_f32 v48, v48, v2
s_add_u32 m0, s77, 86016
s_nop 0
buffer_load_dwordx4 v16, s[8:11], s75 offen offset:0 lds
v_add_f32 v64, v64, v4
v_add_f32 v49, v49, v2
v_add_f32 v65, v65, v4
v_add_f32 v50, v50, v2
v_add_f32 v66, v66, v4
buffer_load_dwordx4 v17, s[8:11], s75 offen offset:1024 lds
s_add_u32 s75, s75, 393216
s_cmp_eq_u32 s75, 6291456
s_cselect_b32 s75, 0, s75
v_add_f32 v51, v51, v2
v_add_f32 v67, v67, v4
v_mul_f32 v20, v36, v36
v_mul_f32 v28, v52, v52
v_mul_f32 v21, v37, v37
s_add_u32 m0, s76, 122880
s_nop 0
buffer_load_dwordx4 v8, s[4:7], s74 offen offset:0 lds
v_mul_f32 v29, v53, v53
v_fmac_f32 v20, v38, v38
v_fmac_f32 v28, v54, v54
v_fmac_f32 v21, v39, v39
v_fmac_f32 v29, v55, v55
buffer_load_dwordx4 v9, s[4:7], s74 offen offset:1024 lds
v_fmac_f32 v20, v40, v40
s_branch L_over0
L_pad0:
s_branch L_ret4
L_over0:
v_fmac_f32 v28, v56, v56
v_fmac_f32 v21, v41, v41
v_fmac_f32 v29, v57, v57
v_fmac_f32 v20, v42, v42
buffer_load_dwordx4 v10, s[4:7], s74 offen offset:2048 lds
v_fmac_f32 v28, v58, v58
v_fmac_f32 v21, v43, v43
v_fmac_f32 v29, v59, v59
v_fmac_f32 v20, v44, v44
v_fmac_f32 v28, v60, v60
buffer_load_dwordx4 v11, s[4:7], s74 offen offset:3072 lds
s_add_u32 s74, s74, 128
s_and_b32 s74, s74, 2047
v_fmac_f32 v21, v45, v45
v_fmac_f32 v29, v61, v61
s_waitcnt vmcnt(14)
s_barrier
s_add_u32 m0, s77, 40960
s_nop 0
buffer_load_dwordx4 v12, s[8:11], s75 offen offset:0 lds
v_fmac_f32 v20, v46, v46
v_fmac_f32 v28, v62, v62
v_fmac_f32 v21, v47, v47
v_fmac_f32 v29, v63, v63
v_fmac_f32 v20, v48, v48
buffer_load_dwordx4 v13, s[8:11], s75 offen offset:1024 lds
v_fmac_f32 v28, v64, v64
v_fmac_f32 v21, v49, v49
v_fmac_f32 v29, v65, v65
v_fmac_f32 v20, v50, v50
v_fmac_f32 v28, v66, v66
buffer_load_dwordx4 v14, s[8:11], s75 offen offset:2048 lds
v_fmac_f32 v21, v51, v51
v_fmac_f32 v29, v67, v67
v_add_f32 v3, v20, v21
v_add_f32 v5, v28, v29
s_nop 0
v_add_f32_dpp v3, v3, v3 row_ror:1 row_mask:0xf bank_mask:0xf
buffer_load_dwordx4 v15, s[8:11], s75 offen offset:3072 lds
v_add_f32_dpp v5, v5, v5 row_ror:1 row_mask:0xf bank_mask:0xf
v_add_f32_dpp v3, v3, v3 row_ror:2 row_mask:0xf bank_mask:0xf
s_nop 0
v_add_f32_dpp v5, v5, v5 row_ror:2 row_mask:0xf bank_mask:0xf
v_add_f32_dpp v3, v3, v3 row_ror:4 row_mask:0xf bank_mask:0xf
s_nop 0
v_add_f32_dpp v5, v5, v5 row_ror:4 row_mask:0xf bank_mask:0xf
s_add_u32 m0, s77, 45056
s_nop 0
buffer_load_dwordx4 v16, s[8:11], s75 offen offset:0 lds
v_add_f32_dpp v3, v3, v3 row_ror:8 row_mask:0xf bank_mask:0xf
v_add_f32_dpp v5, v5, v5 row_ror:8 row_mask:0xf bank_mask:0xf
v_mov_b32 v6, v3
v_mov_b32 v7, v5
s_nop 0
v_permlane16_swap_b32 v3, v6
buffer_load_dwordx4 v17, s[8:11], s75 offen offset:1024 lds
s_add_u32 s75, s75, 393216
s_cmp_eq_u32 s75, 6291456
s_cselect_b32 s75, 0, s75
v_permlane16_swap_b32 v5, v7
v_add_f32 v3, v3, v6
v_add_f32 v5, v5, v7
v_mov_b32 v6, v3
v_mov_b32 v7, v5
s_add_u32 m0, s76, 106496
s_nop 0
buffer_load_dwordx4 v8, s[4:7], s74 offen offset:0 lds
v_permlane32_swap_b32 v3, v6
v_permlane32_swap_b32 v5, v7
v_add_f32 v3, v3, v6
v_add_f32 v5, v5, v7
v_mov_b32 v6, 0x3727c5ac
buffer_load_dwordx4 v9, s[4:7], s74 offen offset:1024 lds
v_fmac_f32 v6, 0x3a800000, v3
v_rsq_f32 v3, v6
v_mov_b32 v6, 0x3727c5ac
v_fmac_f32 v6, 0x3a800000, v5
v_rsq_f32 v5, v6
buffer_load_dwordx4 v10, s[4:7], s74 offen offset:2048 lds
v_cmp_eq_u32 vcc, 1, v1
s_nop 1
v_cndmask_b32 v20, v2, v4, vcc
v_cndmask_b32 v21, v3, v5, vcc
v_mov_b32 v22, 0
v_mov_b32 v23, s68
buffer_load_dwordx4 v11, s[4:7], s74 offen offset:3072 lds
s_add_u32 s74, s74, 128
s_and_b32 s74, s74, 2047
buffer_load_dwordx4 a[0:3], v76, s[24:27], s85 offen nt
buffer_load_dwordx4 a[32:35], v78, s[28:31], s85 offen nt
s_add_u32 s85, s85, 57344
buffer_load_dwordx4 a[4:7], v76, s[24:27], s85 offen nt
buffer_load_dwordx4 a[36:39], v78, s[28:31], s85 offen nt
s_add_u32 s85, s85, 57344
buffer_load_dwordx4 a[8:11], v76, s[24:27], s85 offen nt
buffer_load_dwordx4 a[40:43], v78, s[28:31], s85 offen nt
s_add_u32 s85, s85, 57344
s_lshl_b32 s70, s87, 4
s_add_u32 s70, s70, 8192
s_mov_b64 exec, 3
buffer_store_dwordx4 v[20:23], v18, s[12:15], s70 offen sc1
s_mov_b64 exec, -1
s_waitcnt vmcnt(21)
s_barrier
s_add_u32 m0, s77, 0
s_nop 0
buffer_load_dwordx4 v12, s[8:11], s75 offen offset:0 lds
v_lshlrev_b32 v2, 16, v88
v_and_b32 v3, 0xffff0000, v88
v_lshlrev_b32_e64 v4, 16, v89
buffer_load_dwordx4 v13, s[8:11], s75 offen offset:1024 lds
v_and_b32 v5, 0xffff0000, v89
v_add_f32 v2, v2, v3
v_add_f32 v4, v4, v5
buffer_load_dwordx4 v14, s[8:11], s75 offen offset:2048 lds
v_add_f32 v2, v2, v4
s_nop 1
v_add_f32_dpp v2, v2, v2 row_ror:1 row_mask:0xf bank_mask:0xf
s_nop 1
v_add_f32_dpp v2, v2, v2 row_ror:2 row_mask:0xf bank_mask:0xf
buffer_load_dwordx4 v15, s[8:11], s75 offen offset:3072 lds
s_nop 0
v_add_f32_dpp v2, v2, v2 row_ror:4 row_mask:0xf bank_mask:0xf
s_nop 1
v_add_f32_dpp v2, v2, v2 row_ror:8 row_mask:0xf bank_mask:0xf
v_mov_b32 v3, v2
s_add_u32 m0, s77, 4096
s_nop 0
buffer_load_dwordx4 v16, s[8:11], s75 offen offset:0 lds
v_permlane16_swap_b32 v2, v3
v_add_f32 v2, v2, v3
v_mov_b32 v3, v2
buffer_load_dwordx4 v17, s[8:11], s75 offen offset:1024 lds
s_add_u32 s75, s75, 393216
s_cmp_eq_u32 s75, 6291456
s_cselect_b32 s75, 0, s75
v_permlane32_swap_b32 v2, v3
v_add_f32 v2, v2, v3
s_lshl_b32 s70, s60, 2
s_add_u32 s70, s70, 162176
v_mov_b32 v3, s70
s_add_u32 m0, s76, 65536
s_nop 0
buffer_load_dwordx4 v8, s[4:7], s74 offen offset:0 lds
ds_write_b32 v3, v2
s_lshl_b32 s70, s60, 2
s_sub_u32 s70, s70, s65
s_lshl_b32 s70, s70, 4
v_add_u32 v4, s70, v1
v_min_u32_e64 v4, 18, v4
buffer_load_dwordx4 v9, s[4:7], s74 offen offset:1024 lds
v_cmp_gt_u32 vcc, 16, v4
s_nop 1
v_cndmask_b32 v4, 18, v4, vcc
v_lshlrev_b32 v4, 3, v4
buffer_load_dwordx4 v10, s[4:7], s74 offen offset:2048 lds
v_add_u32 v4, 162048, v4
ds_write_b64 v4, v[88:89]
buffer_load_dwordx4 v11, s[4:7], s74 offen offset:3072 lds
s_add_u32 s74, s74, 128
s_and_b32 s74, s74, 2047
s_waitcnt vmcnt(21)
s_barrier
s_add_u32 m0, s77, 81920
s_nop 0
buffer_load_dwordx4 v12, s[8:11], s75 offen offset:0 lds
s_getreg_b32 s71, hwreg(HW_REG_XCC_ID, 0, 4)
v_mov_b32 v84, s71
buffer_load_dwordx4 v13, s[8:11], s75 offen offset:1024 lds
v_mov_b32 v85, 0
buffer_load_dwordx4 v14, s[8:11], s75 offen offset:2048 lds
v_mov_b32 v86, 0
buffer_load_dwordx4 v15, s[8:11], s75 offen offset:3072 lds
v_mov_b32 v87, s68
s_add_u32 m0, s77, 86016
s_nop 0
buffer_load_dwordx4 v16, s[8:11], s75 offen offset:0 lds
s_lshl_b32 s70, s79, 4
s_add_u32 s70, s70, 4096
v_mov_b32 v19, s70
buffer_load_dwordx4 v17, s[8:11], s75 offen offset:1024 lds
s_add_u32 s75, s75, 393216
s_cmp_eq_u32 s75, 6291456
s_cselect_b32 s75, 0, s75
s_lshl_b32 s70, s65, 4
s_add_u32 s70, s70, s64
s_lshl_b32 s70, s70, 4
s_add_u32 s70, s70, 40960
v_writelane_b32 v19, s70, 1
s_add_u32 m0, s76, 24576
s_nop 0
buffer_load_dwordx4 v8, s[4:7], s74 offen offset:0 lds
buffer_load_dwordx4 v9, s[4:7], s74 offen offset:1024 lds
buffer_load_dwordx4 v10, s[4:7], s74 offen offset:2048 lds
buffer_load_dwordx4 v11, s[4:7], s74 offen offset:3072 lds
s_add_u32 s74, s74, 128
s_and_b32 s74, s74, 2047
buffer_load_dwordx4 a[12:15], v76, s[24:27], s85 offen nt
buffer_load_dwordx4 a[44:47], v78, s[28:31], s85 offen nt
s_add_u32 s85, s85, 57344
buffer_load_dwordx4 a[16:19], v76, s[24:27], s85 offen nt
buffer_load_dwordx4 a[48:51], v78, s[28:31], s85 offen nt
s_add_u32 s85, s85, 57344
buffer_load_dwordx4 a[20:23], v76, s[24:27], s85 offen nt
buffer_load_dwordx4 a[52:55], v78, s[28:31], s85 offen nt
s_add_u32 s85, s85, 57344
s_mov_b64 exec, 3
buffer_store_dwordx4 v[84:87], v19, s[12:15], 0 offen sc1
s_mov_b64 exec, -1
s_waitcnt vmcnt(21)
s_barrier
s_add_u32 m0, s77, 40960
s_nop 0
buffer_load_dwordx4 v12, s[8:11], s75 offen offset:0 lds
buffer_load_dwordx4 v13, s[8:11], s75 offen offset:1024 lds
buffer_load_dwordx4 v14, s[8:11], s75 offen offset:2048 lds
buffer_load_dwordx4 v15, s[8:11], s75 offen offset:3072 lds
s_add_u32 m0, s77, 45056
s_nop 0
buffer_load_dwordx4 v16, s[8:11], s75 offen offset:0 lds
buffer_load_dwordx4 v17, s[8:11], s75 offen offset:1024 lds
s_add_u32 s75, s75, 393216
s_cmp_eq_u32 s75, 6291456
s_cselect_b32 s75, 0, s75
s_add_u32 m0, s76, 122880
s_nop 0
buffer_load_dwordx4 v8, s[4:7], s74 offen offset:0 lds
buffer_load_dwordx4 v9, s[4:7], s74 offen offset:1024 lds
buffer_load_dwordx4 v10, s[4:7], s74 offen offset:2048 lds
buffer_load_dwordx4 v11, s[4:7], s74 offen offset:3072 lds
s_add_u32 s74, s74, 128
s_and_b32 s74, s74, 2047
s_cmp_eq_u32 s60, 0
s_cbranch_scc1 L_pad5
s_cmp_eq_u32 s60, 1
s_cbranch_scc1 L_ret9
s_cmp_eq_u32 s60, 2
s_cbranch_scc1 L_ret9
s_branch L_ret9
L_ret9:
s_waitcnt vmcnt(21)
s_barrier
s_add_u32 m0, s77, 0
s_nop 0
buffer_load_dwordx4 v12, s[8:11], s75 offen offset:0 lds
buffer_load_dwordx4 v13, s[8:11], s75 offen offset:1024 lds
buffer_load_dwordx4 v14, s[8:11], s75 offen offset:2048 lds
buffer_load_dwordx4 v15, s[8:11], s75 offen offset:3072 lds
s_add_u32 m0, s77, 4096
s_nop 0
buffer_load_dwordx4 v16, s[8:11], s75 offen offset:0 lds
buffer_load_dwordx4 v17, s[8:11], s75 offen offset:1024 lds
s_add_u32 s75, s75, 393216
s_cmp_eq_u32 s75, 6291456
s_cselect_b32 s75, 0, s75
s_add_u32 m0, s76, 106496
s_nop 0
buffer_load_dwordx4 v8, s[4:7], s74 offen offset:0 lds
buffer_load_dwordx4 v9, s[4:7], s74 offen offset:1024 lds
buffer_load_dwordx4 v10, s[4:7], s74 offen offset:2048 lds
buffer_load_dwordx4 v11, s[4:7], s74 offen offset:3072 lds
s_add_u32 s74, s74, 128
s_and_b32 s74, s74, 2047
buffer_load_dwordx4 a[24:27], v76, s[24:27], s85 offen nt
buffer_load_dwordx4 a[56:59], v78, s[28:31], s85 offen nt
s_add_u32 s85, s85, 57344
buffer_load_dwordx4 a[28:31], v76, s[24:27], s85 offen nt
buffer_load_dwordx4 a[60:63], v78, s[28:31], s85 offen nt
s_add_u32 s85, s85, 57344
buffer_load_dwordx4 a[64:67], v77, s[32:35], s86 offen nt
s_add_u32 s86, s86, 16384
buffer_load_dwordx4 a[68:71], v77, s[32:35], s86 offen nt
s_add_u32 s86, s86, 16384
s_waitcnt vmcnt(20)
s_barrier
s_add_u32 m0, s77, 81920
s_nop 0
buffer_load_dwordx4 v12, s[8:11], s75 offen offset:0 lds
v_lshrrev_b32 v2, 4, v1
v_and_b32 v3, 15, v1
v_lshlrev_b32 v44, 10, v2
buffer_load_dwordx4 v13, s[8:11], s75 offen offset:1024 lds
v_lshl_add_u32 v44, v3, 4, v44
s_lshl_b32 s70, s60, 8
v_add_u32 v44, s70, v44
s_lshl_b32 s87, s64, 14
s_add_u32 s87, s87, 65536
buffer_load_dwordx4 v14, s[8:11], s75 offen offset:2048 lds
v_and_b32 v45, 31, v1
v_lshlrev_b32 v45, 4, v45
s_lshl_b32 s88, s65, 11
s_lshl_b32 s70, s60, 9
s_add_u32 s88, s88, s70
s_add_u32 s88, s88, 8192
buffer_load_dwordx4 v15, s[8:11], s75 offen offset:3072 lds
s_lshl_b32 s70, s64, 8
s_add_u32 s70, s70, 4096
v_lshlrev_b32 v4, 4, v3
v_add_u32 v4, s70, v4
v_add_u32 v5, 36864, v4
v_lshrrev_b32 v6, 5, v1
s_add_u32 m0, s77, 86016
s_nop 0
buffer_load_dwordx4 v16, s[8:11], s75 offen offset:0 lds
v_lshlrev_b32 v6, 11, v6
v_xor_b32 v5, v5, v6
v_lshrrev_b32 v6, 5, v1
buffer_load_dwordx4 v17, s[8:11], s75 offen offset:1024 lds
s_add_u32 s75, s75, 393216
s_cmp_eq_u32 s75, 6291456
s_cselect_b32 s75, 0, s75
v_lshlrev_b32 v6, 8, v6
v_xor_b32 v4, v4, v6
v_and_b32 v6, 1, v2
s_add_u32 m0, s76, 65536
s_nop 0
buffer_load_dwordx4 v8, s[4:7], s74 offen offset:0 lds
v_cmp_eq_u32 vcc, 1, v6
s_nop 1
v_cndmask_b32 v46, v4, v5, vcc
v_lshlrev_b32_e64 v48, 2, v1
buffer_load_dwordx4 v9, s[4:7], s74 offen offset:1024 lds
v_add_u32 v48, 7225600, v48
buffer_load_dwordx4 v10, s[4:7], s74 offen offset:2048 lds
buffer_load_dwordx4 v11, s[4:7], s74 offen offset:3072 lds
s_add_u32 s74, s74, 128
s_and_b32 s74, s74, 2047
s_add_u32 s70, s87, 0
buffer_load_dwordx4 v[20:23], v44, s[12:15], s70 offen sc1
buffer_load_dwordx4 v[36:39], v45, s[12:15], s88 offen sc1
buffer_load_dwordx4 v[40:43], v46, s[12:15], 0 offen offset:0 sc1
buffer_load_dword v47, v48, s[12:15], 0 offen sc1
s_waitcnt vmcnt(24)
s_barrier
s_add_u32 m0, s77, 40960
s_nop 0
buffer_load_dwordx4 v12, s[8:11], s75 offen offset:0 lds
s_mul_i32 s70, s62, 5
s_add_u32 s70, s70, s65
s_mul_i32 s71, s70, 86
s_lshr_b32 s71, s71, 10
s_mul_i32 s71, s71, 12
s_sub_u32 s70, s70, s71
s_lshl_b32 s70, s70, 2
s_mov_b32 s0, 0x98765410
s_mov_b32 s1, 0xfedc
s_sub_u32 s71, 48, s70
s_lshl_b64 s[72:73], s[0:1], s71
s_lshr_b64 s[0:1], s[0:1], s70
s_or_b64 s[0:1], s[0:1], s[72:73]
s_lshl_b64 s[0:1], s[0:1], 16
s_or_b32 s0, s0, 0x2ab3
buffer_load_dwordx4 v13, s[8:11], s75 offen offset:1024 lds
buffer_load_dwordx4 v14, s[8:11], s75 offen offset:2048 lds
buffer_load_dwordx4 v15, s[8:11], s75 offen offset:3072 lds
s_add_u32 m0, s77, 45056
s_nop 0
buffer_load_dwordx4 v16, s[8:11], s75 offen offset:0 lds
buffer_load_dwordx4 v17, s[8:11], s75 offen offset:1024 lds
s_add_u32 s75, s75, 393216
s_cmp_eq_u32 s75, 6291456
s_cselect_b32 s75, 0, s75
s_add_u32 m0, s76, 24576
s_nop 0
buffer_load_dwordx4 v8, s[4:7], s74 offen offset:0 lds
buffer_load_dwordx4 v9, s[4:7], s74 offen offset:1024 lds
buffer_load_dwordx4 v10, s[4:7], s74 offen offset:2048 lds
buffer_load_dwordx4 v11, s[4:7], s74 offen offset:3072 lds
s_add_u32 s74, s74, 128
s_and_b32 s74, s74, 2047
buffer_load_dwordx4 a[72:75], v77, s[32:35], s86 offen nt
s_add_u32 s86, s86, 16384
buffer_load_dwordx4 a[76:79], v77, s[32:35], s86 offen nt
s_add_u32 s86, s86, 16384
buffer_load_dwordx4 a[80:83], v77, s[32:35], s86 offen nt
s_add_u32 s86, s86, 16384
s_waitcnt vmcnt(21)
s_barrier
s_add_u32 m0, s77, 0
s_nop 0
buffer_load_dwordx4 v12, s[8:11], s75 offen offset:0 lds
s_waitcnt vmcnt(14) lgkmcnt(0)
L_eg_chk:
v_xor_b32 v2, s68, v23
v_xor_b32 v3, s68, v39
v_xor_b32 v4, s68, v43
v_or3_b32 v2, v2, v3, v4
s_lshl_b32 s70, s68, 2
v_xor_b32 v3, s70, v47
v_lshrrev_b32 v3, 2, v3
v_or_b32 v2, v2, v3
v_cmp_ne_u32 vcc, 0, v2
s_cbranch_vccnz L_eg_rt
L_eg_ok:

v_mov_b32 v24, v20
v_mov_b32 v25, v21
buffer_load_dwordx4 v13, s[8:11], s75 offen offset:1024 lds
v_mov_b32_e64 v26, v22
v_permlane16_swap_b32 v20, v24
v_permlane16_swap_b32 v21, v25
buffer_load_dwordx4 v14, s[8:11], s75 offen offset:2048 lds
v_permlane16_swap_b32 v22, v26
v_add_f32 v20, v20, v24
v_add_f32 v21, v21, v25
buffer_load_dwordx4 v15, s[8:11], s75 offen offset:3072 lds
v_add_f32 v22, v22, v26
v_mov_b32 v24, v20
v_mov_b32 v25, v21
s_add_u32 m0, s77, 4096
s_nop 0
buffer_load_dwordx4 v16, s[8:11], s75 offen offset:0 lds
v_mov_b32 v26, v22
v_permlane32_swap_b32 v20, v24
v_permlane32_swap_b32 v21, v25
buffer_load_dwordx4 v17, s[8:11], s75 offen offset:1024 lds
s_add_u32 s75, s75, 393216
s_cmp_eq_u32 s75, 6291456
s_cselect_b32 s75, 0, s75
v_permlane32_swap_b32 v22, v26
v_add_f32 v20, v20, v24
v_add_f32 v21, v21, v25
s_cmp_gt_u32 s65, 3
s_subb_u32 s70, s65, 0
s_cmp_gt_u32 s65, 11
s_subb_u32 s70, s70, 0
s_mov_b32 s71, 22181
s_bitcmp1_b32 s71, s64
s_cselect_b32 s71, 14, 0
s_cselect_b32 s72, 0, 0xf700
s_or_b32 s72, s72, 0xf7
s_add_u32 s70, s70, s71
s_lshl2_add_u32 s70, s70, s60
s_mul_i32 s70, s70, 25600
v_lshlrev_b32 v19, 10, v1
s_bitcmp1_b32 s72, s65
s_cselect_b32 exec_lo, 33554431, 0
s_mov_b32 exec_hi, 0
buffer_load_dword v81, v19, s[16:19], s70 offen offset:384
s_mov_b64 exec, -1
buffer_load_dwordx4 a[84:87], v77, s[32:35], s86 offen nt
s_add_u32 s86, s86, 16384
buffer_load_dwordx4 a[88:91], v77, s[32:35], s86 offen nt
s_add_u32 s86, s86, 16384
buffer_load_dwordx4 a[92:95], v77, s[32:35], s86 offen nt
s_add_u32 s86, s86, 16384
s_waitcnt vmcnt(17)
s_barrier
s_mul_i32 s95, s60, 2
s_add_u32 s95, s95, 120
s_lshl_b32 s70, s95, 10
s_add_u32 m0, s70, 28672
s_lshr_b32 s70, s95, 3
s_lshl_b32 s70, s70, 2
s_lshr_b64 s[82:83], s[0:1], s70
s_and_b32 s82, s82, 15
s_and_b32 s70, s95, 7
s_lshl3_add_u32 s82, s82, s70
s_lshl_b32 s82, s82, 14
buffer_load_dwordx4 v80, s[16:19], s82 offen lds
v_add_f32 v22, v22, v26
v_and_b32 v3, 15, v1
v_lshlrev_b32 v3, 2, v3
s_lshl_b32 s70, s60, 6
s_add_u32 s70, s70, 160768
v_add_u32 v3, s70, v3
ds_write_b32 v3, v20 offset:0
ds_write_b32 v3, v21 offset:256
ds_write_b32 v3, v22 offset:512
v_lshrrev_b32 v4, 2, v45
s_lshl_b32 s70, s60, 7
s_add_u32 s70, s70, 159744
v_add_u32_e64 v4, s70, v4
ds_write_b32 v4, v36
ds_write_b32 v4, v37 offset:512
s_getreg_b32 s71, hwreg(HW_REG_XCC_ID, 0, 4)
v_cmp_ne_u32 vcc, s71, v40
s_nop 0
s_or_b32 s70, vcc_lo, vcc_hi
s_and_b32 s70, s70, 0xffff
s_cselect_b32 s69, 0, 1
v_and_b32 v5, 3, v47
v_cmp_eq_u32 vcc, 1, v5
s_nop 0
s_bcnt1_i32_b64 s70, vcc
v_cmp_eq_u32 vcc, 2, v5
s_nop 0
s_bcnt1_i32_b64 s71, vcc
s_cmp_gt_u32 s71, s70
s_cselect_b32 s61, 8192, 0
s_or_b32 s70, s69, s61
v_mov_b32 v5, s70
v_mov_b32 v6, 161536
ds_write_b32 v6, v5
s_mov_b32 exec_lo, 0
s_mov_b32 exec_hi, 0xff
v_xor_b32 v83, s61, v83
s_mov_b64 exec, -1
v_and_b32 v3, 15, v1
v_lshrrev_b32 v2, 4, v1
v_and_b32 v4, 1, v1
v_lshlrev_b32 v4, 4, v4
v_mov_b32 v5, 0x3f80
s_add_u32 m0, m0, 1024
s_add_u32 s95, s95, 1
s_lshr_b32 s70, s95, 3
s_lshl_b32 s70, s70, 2
s_lshr_b64 s[82:83], s[0:1], s70
s_and_b32 s82, s82, 15
s_and_b32 s70, s95, 7
s_lshl3_add_u32 s82, s82, s70
s_lshl_b32 s82, s82, 14
buffer_load_dwordx4 v80, s[16:19], s82 offen lds
v_lshlrev_b32 v4, v4, v5
v_lshrrev_b32 v5, 1, v3
v_cmp_eq_u32 vcc, 0, v5
s_nop 1
v_cndmask_b32 v56, 0, v4, vcc
v_cmp_eq_u32 vcc, 1, v5
s_nop 1
v_cndmask_b32 v57, 0, v4, vcc
v_cmp_eq_u32 vcc, 2, v5
s_nop 1
v_cndmask_b32 v58, 0, v4, vcc
v_cmp_eq_u32 vcc, 3, v5
s_nop 1
v_cndmask_b32 v59, 0, v4, vcc
v_mul_u32_u24 v55, 4352, v3
v_lshl_add_u32 v55, v2, 5, v55
v_and_b32 v4, 12, v1
v_add_u32 v4, v4, v2
v_mul_u32_u24 v54, 4352, v4
v_and_b32 v4, 3, v1
v_lshl_add_u32 v54, v4, 4, v54
v_lshlrev_b32 v53, 4, v4
v_lshl_add_u32 v53, v2, 3, v53
s_mul_i32 s87, s64, 69632
s_add_u32 s87, s87, 524288
s_lshl_b32 s70, s66, 7
s_lshl_b32 s71, s67, 4
s_add_u32 s88, s70, s71
s_add_u32 s88, s88, s87
s_add_u32 s88, s88, 4096
s_lshl2_add_u32 s70, s65, s60
s_lshl_b32 s70, s70, 6
s_add_u32 s87, s87, s70
s_lshl4_add_u32 s70, s64, s65
s_lshl2_add_u32 s70, s70, s60
s_lshl_b32 s70, s70, 6
s_add_u32 s70, s70, 1638400
s_mov_b32 s94, s70
s_lshl_b32 s70, s66, 6
s_lshl_b32 s71, s67, 3
s_add_u32 s70, s70, s71
s_add_u32 s70, s70, 161600
v_lshlrev_b32 v60, 4, v2
v_add_u32 v60, s70, v60
s_mov_b32 s92, 0x000f000f
s_mov_b32 s93, 0
s_sub_i32 s70, s64, s65
s_lshl_b32 s70, s70, 18
v_add_u32 v8, s70, v8
v_add_u32 v9, s70, v9
v_add_u32 v10, s70, v10
v_add_u32 v11, s70, v11
s_waitcnt vmcnt(6)
s_barrier
s_mul_i32 s95, s60, 10
s_add_u32 s95, s95, 12
s_lshl_b32 s70, s95, 10
s_add_u32 m0, s70, 28672
s_lshr_b32 s70, s95, 3
s_lshl_b32 s70, s70, 2
s_lshr_b64 s[82:83], s[0:1], s70
s_and_b32 s82, s82, 15
s_and_b32 s70, s95, 7
s_lshl3_add_u32 s82, s82, s70
s_lshl_b32 s82, s82, 14
buffer_load_dwordx4 v80, s[16:19], s82 offen lds
s_add_u32 m0, m0, 1024
s_add_u32 s95, s95, 1
s_lshr_b32 s70, s95, 3
s_lshl_b32 s70, s70, 2
s_lshr_b64 s[82:83], s[0:1], s70
s_and_b32 s82, s82, 15
s_and_b32 s70, s95, 7
s_lshl3_add_u32 s82, s82, s70
s_lshl_b32 s82, s82, 14
buffer_load_dwordx4 v80, s[16:19], s82 offen lds
s_add_u32 m0, m0, 1024
s_add_u32 s95, s95, 1
s_lshr_b32 s70, s95, 3
s_lshl_b32 s70, s70, 2
s_lshr_b64 s[82:83], s[0:1], s70
s_and_b32 s82, s82, 15
s_and_b32 s70, s95, 7
s_lshl3_add_u32 s82, s82, s70
s_lshl_b32 s82, s82, 14
buffer_load_dwordx4 v80, s[16:19], s82 offen lds
s_add_u32 m0, m0, 1024
s_add_u32 s95, s95, 1
s_lshr_b32 s70, s95, 3
s_lshl_b32 s70, s70, 2
s_lshr_b64 s[82:83], s[0:1], s70
s_and_b32 s82, s82, 15
s_and_b32 s70, s95, 7
s_lshl3_add_u32 s82, s82, s70
s_lshl_b32 s82, s82, 14
buffer_load_dwordx4 v80, s[16:19], s82 offen lds
s_add_u32 m0, m0, 1024
s_add_u32 s95, s95, 1
s_lshr_b32 s70, s95, 3
s_lshl_b32 s70, s70, 2
s_lshr_b64 s[82:83], s[0:1], s70
s_and_b32 s82, s82, 15
s_and_b32 s70, s95, 7
s_lshl3_add_u32 s82, s82, s70
s_lshl_b32 s82, s82, 14
buffer_load_dwordx4 v80, s[16:19], s82 offen lds
s_add_u32 m0, m0, 1024
s_add_u32 s95, s95, 1
s_lshr_b32 s70, s95, 3
s_lshl_b32 s70, s70, 2
s_lshr_b64 s[82:83], s[0:1], s70
s_and_b32 s82, s82, 15
s_and_b32 s70, s95, 7
s_lshl3_add_u32 s82, s82, s70
s_lshl_b32 s82, s82, 14
buffer_load_dwordx4 v80, s[16:19], s82 offen lds
s_add_u32 m0, m0, 1024
s_add_u32 s95, s95, 1
s_lshr_b32 s70, s95, 3
s_lshl_b32 s70, s70, 2
s_lshr_b64 s[82:83], s[0:1], s70
s_and_b32 s82, s82, 15
s_and_b32 s70, s95, 7
s_lshl3_add_u32 s82, s82, s70
s_lshl_b32 s82, s82, 14
buffer_load_dwordx4 v80, s[16:19], s82 offen lds
s_add_u32 m0, m0, 1024
s_add_u32 s95, s95, 1
s_lshr_b32 s70, s95, 3
s_lshl_b32 s70, s70, 2
s_lshr_b64 s[82:83], s[0:1], s70
s_and_b32 s82, s82, 15
s_and_b32 s70, s95, 7
s_lshl3_add_u32 s82, s82, s70
s_lshl_b32 s82, s82, 14
buffer_load_dwordx4 v80, s[16:19], s82 offen lds
s_add_u32 m0, m0, 1024
s_add_u32 s95, s95, 1
s_lshr_b32 s70, s95, 3
s_lshl_b32 s70, s70, 2
s_lshr_b64 s[82:83], s[0:1], s70
s_and_b32 s82, s82, 15
s_and_b32 s70, s95, 7
s_lshl3_add_u32 s82, s82, s70
s_lshl_b32 s82, s82, 14
buffer_load_dwordx4 v80, s[16:19], s82 offen lds
s_add_u32 m0, m0, 1024
s_add_u32 s95, s95, 1
s_lshr_b32 s70, s95, 3
s_lshl_b32 s70, s70, 2
s_lshr_b64 s[82:83], s[0:1], s70
s_and_b32 s82, s82, 15
s_and_b32 s70, s95, 7
s_lshl3_add_u32 s82, s82, s70
s_lshl_b32 s82, s82, 14
buffer_load_dwordx4 v80, s[16:19], s82 offen lds
s_setprio 0
s_waitcnt lgkmcnt(0)
s_barrier
s_mov_b32 exec_lo, 0x0
s_mov_b32 exec_hi, 0x3f00000f
buffer_load_dword v81, v83, s[12:15], 0 offen
s_mov_b64 exec, -1
s_mul_i32 s95, s60, 3
s_add_u32 s95, s95, 0
s_lshl_b32 s70, s95, 10
s_add_u32 m0, s70, 28672
s_lshr_b32 s70, s95, 3
s_lshl_b32 s70, s70, 2
s_lshr_b64 s[82:83], s[0:1], s70
s_and_b32 s82, s82, 15
s_and_b32 s70, s95, 7
s_lshl3_add_u32 s82, s82, s70
s_lshl_b32 s82, s82, 14
buffer_load_dwordx4 v80, s[16:19], s82 offen lds
s_add_u32 m0, m0, 1024
s_add_u32 s95, s95, 1
s_lshr_b32 s70, s95, 3
s_lshl_b32 s70, s70, 2
s_lshr_b64 s[82:83], s[0:1], s70
s_and_b32 s82, s82, 15
s_and_b32 s70, s95, 7
s_lshl3_add_u32 s82, s82, s70
s_lshl_b32 s82, s82, 14
buffer_load_dwordx4 v80, s[16:19], s82 offen lds
s_add_u32 m0, m0, 1024
s_add_u32 s95, s95, 1
s_lshr_b32 s70, s95, 3
s_lshl_b32 s70, s70, 2
s_lshr_b64 s[82:83], s[0:1], s70
s_and_b32 s82, s82, 15
s_and_b32 s70, s95, 7
s_lshl3_add_u32 s82, s82, s70
s_lshl_b32 s82, s82, 14
buffer_load_dwordx4 v80, s[16:19], s82 offen lds
s_mul_i32 s95, s60, 7
s_add_u32 s95, s95, 52
s_lshl_b32 s70, s95, 10
s_add_u32 m0, s70, 28672
s_lshr_b32 s70, s95, 3
s_lshl_b32 s70, s70, 2
s_lshr_b64 s[82:83], s[0:1], s70
s_and_b32 s82, s82, 15
s_and_b32 s70, s95, 7
s_lshl3_add_u32 s82, s82, s70
s_lshl_b32 s82, s82, 14
buffer_load_dwordx4 v80, s[16:19], s82 offen lds
s_add_u32 m0, m0, 1024
s_add_u32 s95, s95, 1
s_lshr_b32 s70, s95, 3
s_lshl_b32 s70, s70, 2
s_lshr_b64 s[82:83], s[0:1], s70
s_and_b32 s82, s82, 15
s_and_b32 s70, s95, 7
s_lshl3_add_u32 s82, s82, s70
s_lshl_b32 s82, s82, 14
buffer_load_dwordx4 v80, s[16:19], s82 offen lds
s_add_u32 m0, m0, 1024
s_add_u32 s95, s95, 1
s_lshr_b32 s70, s95, 3
s_lshl_b32 s70, s70, 2
s_lshr_b64 s[82:83], s[0:1], s70
s_and_b32 s82, s82, 15
s_and_b32 s70, s95, 7
s_lshl3_add_u32 s82, s82, s70
s_lshl_b32 s82, s82, 14
buffer_load_dwordx4 v80, s[16:19], s82 offen lds
s_branch L_over1
L_pad1:
s_branch L_pad15
L_over1:
s_add_u32 m0, m0, 1024
s_add_u32 s95, s95, 1
s_lshr_b32 s70, s95, 3
s_lshl_b32 s70, s70, 2
s_lshr_b64 s[82:83], s[0:1], s70
s_and_b32 s82, s82, 15
s_and_b32 s70, s95, 7
s_lshl3_add_u32 s82, s82, s70
s_lshl_b32 s82, s82, 14
buffer_load_dwordx4 v80, s[16:19], s82 offen lds
s_add_u32 m0, m0, 1024
s_add_u32 s95, s95, 1
s_lshr_b32 s70, s95, 3
s_lshl_b32 s70, s70, 2
s_lshr_b64 s[82:83], s[0:1], s70
s_and_b32 s82, s82, 15
s_and_b32 s70, s95, 7
s_lshl3_add_u32 s82, s82, s70
s_lshl_b32 s82, s82, 14
buffer_load_dwordx4 v80, s[16:19], s82 offen lds
s_add_u32 m0, m0, 1024
s_add_u32 s95, s95, 1
s_lshr_b32 s70, s95, 3
s_lshl_b32 s70, s70, 2
s_lshr_b64 s[82:83], s[0:1], s70
s_and_b32 s82, s82, 15
s_and_b32 s70, s95, 7
s_lshl3_add_u32 s82, s82, s70
s_lshl_b32 s82, s82, 14
buffer_load_dwordx4 v80, s[16:19], s82 offen lds
s_add_u32 m0, m0, 1024
s_add_u32 s95, s95, 1
s_lshr_b32 s70, s95, 3
s_lshl_b32 s70, s70, 2
s_lshr_b64 s[82:83], s[0:1], s70
s_and_b32 s82, s82, 15
s_and_b32 s70, s95, 7
s_lshl3_add_u32 s82, s82, s70
s_lshl_b32 s82, s82, 14
buffer_load_dwordx4 v80, s[16:19], s82 offen lds
s_mov_b32 s73, 3
s_cmp_eq_u32 s60, 0
s_cbranch_scc1 L_pad1
s_cmp_eq_u32 s60, 1
s_cbranch_scc1 L_pad6
s_cmp_eq_u32 s60, 2
s_cbranch_scc1 L_pad9
s_branch L_pad14
L_retF:
s_barrier
s_barrier
s_setprio 2
s_mul_i32 s95, s60, 4
s_add_u32 s95, s95, 80
s_lshl_b32 s70, s95, 10
s_add_u32 m0, s70, 28672
s_lshr_b32 s70, s95, 3
s_lshl_b32 s70, s70, 2
s_lshr_b64 s[82:83], s[0:1], s70
s_and_b32 s82, s82, 15
s_and_b32 s70, s95, 7
s_lshl3_add_u32 s82, s82, s70
s_lshl_b32 s82, s82, 14
buffer_load_dwordx4 v80, s[16:19], s82 offen lds
s_add_u32 m0, m0, 1024
s_add_u32 s95, s95, 1
s_lshr_b32 s70, s95, 3
s_lshl_b32 s70, s70, 2
s_lshr_b64 s[82:83], s[0:1], s70
s_and_b32 s82, s82, 15
s_and_b32 s70, s95, 7
s_lshl3_add_u32 s82, s82, s70
s_lshl_b32 s82, s82, 14
buffer_load_dwordx4 v80, s[16:19], s82 offen lds
s_add_u32 m0, m0, 1024
s_add_u32 s95, s95, 1
s_lshr_b32 s70, s95, 3
s_lshl_b32 s70, s70, 2
s_lshr_b64 s[82:83], s[0:1], s70
s_and_b32 s82, s82, 15
s_and_b32 s70, s95, 7
s_lshl3_add_u32 s82, s82, s70
s_lshl_b32 s82, s82, 14
buffer_load_dwordx4 v80, s[16:19], s82 offen lds
s_add_u32 m0, m0, 1024
s_add_u32 s95, s95, 1
s_lshr_b32 s70, s95, 3
s_lshl_b32 s70, s70, 2
s_lshr_b64 s[82:83], s[0:1], s70
s_and_b32 s82, s82, 15
s_and_b32 s70, s95, 7
s_lshl3_add_u32 s82, s82, s70
s_lshl_b32 s82, s82, 14
buffer_load_dwordx4 v80, s[16:19], s82 offen lds
s_lshl_b32 s70, s65, 7
s_mov_b32 m0, s76
s_nop 0
buffer_load_dwordx4 v8, s[4:7], s70 offen offset:0 lds
buffer_load_dwordx4 v9, s[4:7], s70 offen offset:1024 lds
buffer_load_dwordx4 v10, s[4:7], s70 offen offset:2048 lds
buffer_load_dwordx4 v11, s[4:7], s70 offen offset:3072 lds
buffer_load_dwordx4 v[84:87], v54, s[12:15], s87 offen sc1
buffer_load_dwordx4 v[148:151], v55, s[12:15], s88 offen sc1
s_mul_i32 s95, s60, 6
s_add_u32 s95, s95, 96
s_lshl_b32 s70, s95, 10
s_add_u32 m0, s70, 28672
s_lshr_b32 s70, s95, 3
s_lshl_b32 s70, s70, 2
s_lshr_b64 s[82:83], s[0:1], s70
s_and_b32 s82, s82, 15
s_and_b32 s70, s95, 7
s_lshl3_add_u32 s82, s82, s70
s_lshl_b32 s82, s82, 14
buffer_load_dwordx4 v80, s[16:19], s82 offen lds
s_add_u32 m0, m0, 1024
s_add_u32 s95, s95, 1
s_lshr_b32 s70, s95, 3
s_lshl_b32 s70, s70, 2
s_lshr_b64 s[82:83], s[0:1], s70
s_and_b32 s82, s82, 15
s_and_b32 s70, s95, 7
s_lshl3_add_u32 s82, s82, s70
s_lshl_b32 s82, s82, 14
buffer_load_dwordx4 v80, s[16:19], s82 offen lds
s_add_u32 m0, m0, 1024
s_add_u32 s95, s95, 1
s_lshr_b32 s70, s95, 3
s_lshl_b32 s70, s70, 2
s_lshr_b64 s[82:83], s[0:1], s70
s_and_b32 s82, s82, 15
s_and_b32 s70, s95, 7
s_lshl3_add_u32 s82, s82, s70
s_lshl_b32 s82, s82, 14
buffer_load_dwordx4 v80, s[16:19], s82 offen lds
s_add_u32 m0, m0, 1024
s_add_u32 s95, s95, 1
s_lshr_b32 s70, s95, 3
s_lshl_b32 s70, s70, 2
s_lshr_b64 s[82:83], s[0:1], s70
s_and_b32 s82, s82, 15
s_and_b32 s70, s95, 7
s_lshl3_add_u32 s82, s82, s70
s_lshl_b32 s82, s82, 14
buffer_load_dwordx4 v80, s[16:19], s82 offen lds
s_add_u32 m0, m0, 1024
s_add_u32 s95, s95, 1
s_lshr_b32 s70, s95, 3
s_lshl_b32 s70, s70, 2
s_lshr_b64 s[82:83], s[0:1], s70
s_and_b32 s82, s82, 15
s_and_b32 s70, s95, 7
s_lshl3_add_u32 s82, s82, s70
s_lshl_b32 s82, s82, 14
buffer_load_dwordx4 v80, s[16:19], s82 offen lds
s_add_u32 m0, m0, 1024
s_add_u32 s95, s95, 1
s_lshr_b32 s70, s95, 3
s_lshl_b32 s70, s70, 2
s_lshr_b64 s[82:83], s[0:1], s70
s_and_b32 s82, s82, 15
s_and_b32 s70, s95, 7
s_lshl3_add_u32 s82, s82, s70
s_lshl_b32 s82, s82, 14
buffer_load_dwordx4 v80, s[16:19], s82 offen lds
L_kvr:
s_bitcmp1_b32 s73, 0
s_cbranch_scc0 L_kvs0
s_waitcnt vmcnt(6)
v_cmp_eq_u32_e64 vcc, -1, v84
s_cbranch_vccnz L_kvs0
s_bitset0_b32 s73, 0
v_mfma_f32_16x16x32_bf16 v[20:23], v[56:59], v[84:87], 0
s_nop 7
v_add_f32_dpp v20, v20, v20 row_ror:4 row_mask:0xf bank_mask:0xf
v_add_f32_dpp v21, v21, v21 row_ror:4 row_mask:0xf bank_mask:0xf
v_add_f32_dpp v22, v22, v22 row_ror:4 row_mask:0xf bank_mask:0xf
v_add_f32_dpp v23, v23, v23 row_ror:4 row_mask:0xf bank_mask:0xf
v_add_f32_dpp v20, v20, v20 row_ror:8 row_mask:0xf bank_mask:0xf
v_add_f32_dpp v21, v21, v21 row_ror:8 row_mask:0xf bank_mask:0xf
v_add_f32_dpp v22, v22, v22 row_ror:8 row_mask:0xf bank_mask:0xf
v_add_f32_dpp v23, v23, v23 row_ror:8 row_mask:0xf bank_mask:0xf
v_cvt_pk_bf16_f32 v20, v20, v21
v_cvt_pk_bf16_f32 v21, v22, v23
s_mov_b64 exec, s[92:93]
s_cmp_eq_u32 s69, 0
s_cbranch_scc1 L_kv2_s
buffer_store_dwordx2 v[20:21], v53, s[12:15], s94 offen
L_kv2_d:
s_mov_b64 exec, -1
L_kvs0:
s_bitcmp1_b32 s73, 1
s_cbranch_scc0 L_kvs1
v_xor_b32 v148, s84, v148
v_xor_b32 v149, s84, v149
v_xor_b32 v150, s84, v150
v_xor_b32 v151, s84, v151
v_or3_b32 v2, v148, v149, v150
v_bitop3_b32 v2, v2, v151, s91 bitop3:0xa8
v_cmp_ne_u32_e64 vcc, 0, v2
s_cbranch_vccnz L_kvs1
s_bitset0_b32 s73, 1
v_add_f32_dpp v148, v148, v148 row_ror:1 row_mask:0xf bank_mask:0xf
v_add_f32_dpp v149, v149, v149 row_ror:1 row_mask:0xf bank_mask:0xf
v_add_f32_dpp v150, v150, v150 row_ror:1 row_mask:0xf bank_mask:0xf
v_add_f32_dpp v151, v151, v151 row_ror:1 row_mask:0xf bank_mask:0xf
v_add_f32_dpp v148, v148, v148 row_ror:2 row_mask:0xf bank_mask:0xf
v_add_f32_dpp v149, v149, v149 row_ror:2 row_mask:0xf bank_mask:0xf
v_add_f32_dpp v150, v150, v150 row_ror:2 row_mask:0xf bank_mask:0xf
v_add_f32_dpp v151, v151, v151 row_ror:2 row_mask:0xf bank_mask:0xf
v_add_f32_dpp v148, v148, v148 row_ror:4 row_mask:0xf bank_mask:0xf
v_add_f32_dpp v149, v149, v149 row_ror:4 row_mask:0xf bank_mask:0xf
v_add_f32_dpp v150, v150, v150 row_ror:4 row_mask:0xf bank_mask:0xf
v_add_f32_dpp v151, v151, v151 row_ror:4 row_mask:0xf bank_mask:0xf
v_add_f32_dpp v148, v148, v148 row_ror:8 row_mask:0xf bank_mask:0xf
v_add_f32_dpp v149, v149, v149 row_ror:8 row_mask:0xf bank_mask:0xf
v_add_f32_dpp v150, v150, v150 row_ror:8 row_mask:0xf bank_mask:0xf
v_add_f32_dpp v151, v151, v151 row_ror:8 row_mask:0xf bank_mask:0xf
v_cvt_pk_bf16_f32 v148, v148, v149
v_cvt_pk_bf16_f32 v149, v150, v151
ds_write_b64 v60, v[148:149]
L_kvs1:
s_cmp_lg_u32 s73, 0
s_cbranch_scc1 L_kvrt
L_kvok:
s_setprio 0
s_waitcnt lgkmcnt(0)
s_barrier
s_waitcnt vmcnt(0)
s_barrier
s_not_b32 s70, s68
v_mov_b32 v81, -1
v_writelane_b32 v81, s70, 62
v_writelane_b32 v81, s70, 63
s_mov_b32 exec_lo, 0
s_cmp_eq_u32 s69, 0
s_cselect_b32 exec_hi, 0, 0x3f000000
buffer_store_dword v81, v83, s[12:15], 0 offen offset:4
s_mov_b64 exec, -1
s_cmp_eq_u32 s60, 0
s_cbranch_scc1 L_pad2
s_cmp_eq_u32 s60, 1
s_cbranch_scc1 L_pad7
s_cmp_eq_u32 s60, 2
s_cbranch_scc1 L_pad8
s_branch L_pad10
L_retG:
v_lshrrev_b32 v2, 5, v1
v_lshlrev_b32 v2, 11, v2
v_bfe_u32 v3, v1, 3, 2
v_lshl_add_u32 v2, v3, 7, v2
v_bfe_u32 v3, v1, 4, 1
v_bfe_u32 v4, v1, 1, 2
v_xor_b32 v3, v3, v4
v_lshl_add_u32 v2, v3, 5, v2
v_and_b32 v3, 1, v1
v_lshl_add_u32 v2, v3, 4, v2
s_lshl_b32 s70, s60, 13
s_add_u32 s71, s70, 65536
v_add_u32 v100, s71, v2
v_xor_b32 v101, 64, v100
v_lshrrev_b32 v2, 2, v1
v_bfe_u32 v5, v1, 3, 2
v_xor_b32 v6, s60, v5
v_lshlrev_b32 v6, 5, v6
v_lshl_add_u32 v6, v2, 7, v6
v_and_b32_e64 v7, 3, v1
v_lshl_add_u32 v6, v7, 3, v6
v_add_u32 v102, 65536, v6
s_lshl_b32 s71, s66, 16
s_add_u32 s70, s70, s71
s_add_u32 s70, s70, 49152
v_lshlrev_b32 v6, 5, v5
v_lshl_add_u32 v6, v2, 7, v6
v_lshl_add_u32 v6, v7, 3, v6
v_add_u32 v104, s70, v6
v_xor_b32 v105, 32, v104
v_xor_b32 v106, 64, v104
v_xor_b32 v107, 96, v104
v_lshrrev_b32 v5, 4, v1
v_xor_b32 v4, v4, v5
v_lshlrev_b32 v4, 5, v4
v_lshrrev_b32 v6, 3, v1
v_lshl_add_u32 v4, v6, 7, v4
v_lshl_add_u32 v4, v3, 4, v4
v_add_u32 v103, s70, v4
s_lshl_b32 s70, s60, 5
s_add_u32 s70, s70, 161792
v_mov_b32 v63, s70
v_add_u32 v114, 16, v63
v_lshl_add_u32 v56, v3, 4, v63
s_and_b32 s70, s65, 3
s_lshl_b32 s70, s70, 9
s_lshr_b32 s71, s62, 2
s_xor_b32 s71, s71, 0
s_lshl_b32 s71, s71, 13
s_add_u32 s71, s71, 8388608
s_xor_b32 s71, s71, s61
s_add_u32 s70, s70, s71
v_lshl_add_u32 v57, v5, 4, s70
v_lshlrev_b32 v60, 5, v5
v_lshl_add_u32 v60, v3, 4, v60
v_bfe_u32 v7, v1, 1, 1
v_lshl_add_u32 v60, v7, 7, v60
v_and_b32 v2, 3, v2
v_lshl_add_u32 v61, v2, 8, v60
v_lshlrev_b32 v62, 4, v3
v_lshl_add_u32 v62, v5, 5, v62
v_mov_b32 v59, s68
s_lshl_b32 s71, s79, 2
s_add_u32 s71, s71, s60
s_lshl_b32 s70, s71, 8
s_add_u32 s70, s70, 6946816
s_mov_b32 s85, s70
s_and_b32 s71, s65, 3
s_lshl2_add_u32 s71, s3, s71
s_and_b32 s70, s65, 12
s_add_u32 s70, s70, s60
s_lshl_b32 s71, s71, 7
s_bitcmp1_b32 s70, 3
s_cselect_b32 s72, 0, 8192
s_add_u32 s71, s71, s72
s_and_b32 s70, s70, 7
s_lshl_b32 s70, s70, 16
s_add_u32 s70, s70, s71
s_add_u32 s70, s70, 7340032
s_mov_b32 s88, s70
s_xor_b32 s88, s88, s61
s_lshl_b32 s70, s64, 14
s_add_u32 s86, s70, 6946816
s_and_b32 s70, s65, 3
v_mul_u32_u24 v2, 1, v7
v_xor_b32 v2, s70, v2
v_lshl_add_u32 v61, v2, 12, v61
s_lshl_b32 s87, s62, 11
s_xor_b32 s87, s87, 8192
s_add_u32 s87, s87, 6815744
s_xor_b32 s87, s87, s61
s_mov_b32 s94, 0
s_mov_b32 s95, 0
s_mov_b32 s92, 0x000f000f
s_mov_b32 s93, 0x000f000f
s_and_b32 s70, s65, 12
s_add_u32 s70, s70, s60
s_lshr_b32 s70, s70, 1
s_xor_b32 s24, s70, s62
s_xor_b32 s70, s69, 1
s_or_b32 s24, s24, s70
s_mov_b32 s32, 0xaaaaaaaa
s_mov_b32 s33, 0xaaaaaaaa
s_mov_b32 s38, 0
v_mov_b32 v64, 0x3f803f80
v_mov_b32 v65, 0x3f803f80
v_mov_b32 v66, 0x3f803f80
v_mov_b32 v67, 0x3f803f80
v_add_u32 v115, 64, v1
v_mov_b32 v2, 0
v_mov_b32 v95, 0
v_mov_b32 v99, 0
s_waitcnt vmcnt(0) lgkmcnt(0)
s_barrier
ds_write_b128 v100, a[0:3] offset:0
ds_write_b128 v101, a[4:7] offset:512
ds_write_b128 v100, a[8:11] offset:1024
ds_write_b128 v101, a[12:15] offset:1536
ds_write_b128 v100, a[16:19] offset:4096
ds_write_b128 v101, a[20:23] offset:4608
ds_write_b128 v100, a[24:27] offset:5120
ds_write_b128 v101, a[28:31] offset:5632
ds_write_b128 v100, a[32:35] offset:32768
ds_write_b128 v101, a[36:39] offset:33280
ds_write_b128 v100, a[40:43] offset:33792
ds_write_b128 v101, a[44:47] offset:34304
ds_write_b128 v100, a[48:51] offset:36864
ds_write_b128 v101, a[52:55] offset:37376
ds_write_b128 v100, a[56:59] offset:37888
ds_write_b128 v101, a[60:63] offset:38400
ds_write_b128 v103, a[64:67] offset:0
ds_write_b128 v103, a[68:71] offset:1024
ds_write_b128 v103, a[72:75] offset:2048
ds_write_b128 v103, a[76:79] offset:3072
ds_write_b128 v103, a[80:83] offset:4096
ds_write_b128 v103, a[84:87] offset:5120
ds_write_b128 v103, a[88:91] offset:6144
ds_write_b128 v103, a[92:95] offset:7168
s_waitcnt lgkmcnt(0)
ds_read_b64_tr_b16 a[64:65], v104 offset:0
ds_read_b64_tr_b16 a[66:67], v104 offset:2048
ds_read_b64_tr_b16 a[68:69], v104 offset:4096
ds_read_b64_tr_b16 a[70:71], v104 offset:6144
ds_read_b64_tr_b16 a[72:73], v105 offset:0
ds_read_b64_tr_b16 a[74:75], v105 offset:2048
ds_read_b64_tr_b16 a[76:77], v105 offset:4096
ds_read_b64_tr_b16 a[78:79], v105 offset:6144
ds_read_b64_tr_b16 a[80:81], v106 offset:0
ds_read_b64_tr_b16 a[82:83], v106 offset:2048
ds_read_b64_tr_b16 a[84:85], v106 offset:4096
ds_read_b64_tr_b16 a[86:87], v106 offset:6144
ds_read_b64_tr_b16 a[88:89], v107 offset:0
ds_read_b64_tr_b16 a[90:91], v107 offset:2048
ds_read_b64_tr_b16 a[92:93], v107 offset:4096
ds_read_b64_tr_b16 a[94:95], v107 offset:6144
s_barrier
ds_read_b64_tr_b16 a[0:1], v102 offset:0
ds_read_b64_tr_b16 a[2:3], v102 offset:2048
ds_read_b64_tr_b16 a[32:33], v102 offset:32768
ds_read_b64_tr_b16 a[34:35], v102 offset:34816
ds_read_b64_tr_b16 a[4:5], v102 offset:4096
ds_read_b64_tr_b16 a[6:7], v102 offset:6144
ds_read_b64_tr_b16 a[36:37], v102 offset:36864
ds_read_b64_tr_b16 a[38:39], v102 offset:38912
ds_read_b64_tr_b16 a[8:9], v102 offset:8192
ds_read_b64_tr_b16 a[10:11], v102 offset:10240
ds_read_b64_tr_b16 a[40:41], v102 offset:40960
ds_read_b64_tr_b16 a[42:43], v102 offset:43008
ds_read_b64_tr_b16 a[12:13], v102 offset:12288
ds_read_b64_tr_b16 a[14:15], v102 offset:14336
ds_read_b64_tr_b16 a[44:45], v102 offset:45056
ds_read_b64_tr_b16 a[46:47], v102 offset:47104
ds_read_b64_tr_b16 a[16:17], v102 offset:16384
ds_read_b64_tr_b16 a[18:19], v102 offset:18432
ds_read_b64_tr_b16 a[48:49], v102 offset:49152
ds_read_b64_tr_b16 a[50:51], v102 offset:51200
ds_read_b64_tr_b16 a[20:21], v102 offset:20480
ds_read_b64_tr_b16 a[22:23], v102 offset:22528
ds_read_b64_tr_b16 a[52:53], v102 offset:53248
ds_read_b64_tr_b16 a[54:55], v102 offset:55296
ds_read_b64_tr_b16 a[24:25], v102 offset:24576
ds_read_b64_tr_b16 a[26:27], v102 offset:26624
ds_read_b64_tr_b16 a[56:57], v102 offset:57344
ds_read_b64_tr_b16 a[58:59], v102 offset:59392
ds_read_b64_tr_b16 a[28:29], v102 offset:28672
ds_read_b64_tr_b16 a[30:31], v102 offset:30720
ds_read_b64_tr_b16 a[60:61], v102 offset:61440
ds_read_b64_tr_b16 a[62:63], v102 offset:63488
s_waitcnt lgkmcnt(0)
buffer_load_dwordx4 v[92:95], v18, s[12:15], s87 offen offset:0 sc1
buffer_load_dwordx4 v[96:99], v18, s[12:15], s87 offen offset:1024 sc1
v_mfma_f32_16x16x32_bf16 v[68:71], a[0:3], v[64:67], 0
v_mfma_f32_16x16x32_bf16 v[72:75], a[32:35], v[64:67], 0
v_mfma_f32_16x16x32_bf16 v[68:71], a[4:7], v[64:67], v[68:71]
v_mfma_f32_16x16x32_bf16 v[72:75], a[36:39], v[64:67], v[72:75]
v_mfma_f32_16x16x32_bf16 v[68:71], a[8:11], v[64:67], v[68:71]
v_mfma_f32_16x16x32_bf16 v[72:75], a[40:43], v[64:67], v[72:75]
v_mfma_f32_16x16x32_bf16 v[68:71], a[12:15], v[64:67], v[68:71]
v_mfma_f32_16x16x32_bf16 v[72:75], a[44:47], v[64:67], v[72:75]
v_mfma_f32_16x16x32_bf16 v[68:71], a[16:19], v[64:67], v[68:71]
v_mfma_f32_16x16x32_bf16 v[72:75], a[48:51], v[64:67], v[72:75]
v_mfma_f32_16x16x32_bf16 v[68:71], a[20:23], v[64:67], v[68:71]
v_mfma_f32_16x16x32_bf16 v[72:75], a[52:55], v[64:67], v[72:75]
v_mfma_f32_16x16x32_bf16 v[68:71], a[24:27], v[64:67], v[68:71]
v_mfma_f32_16x16x32_bf16 v[72:75], a[56:59], v[64:67], v[72:75]
v_mfma_f32_16x16x32_bf16 v[68:71], a[28:31], v[64:67], v[68:71]
v_mfma_f32_16x16x32_bf16 v[72:75], a[60:63], v[64:67], v[72:75]
L_pk:
s_waitcnt vmcnt(0)
L_pk2:
v_cmp_eq_u32_e64 s[80:81], s68, v95
v_cmp_eq_u32_e64 s[82:83], s68, v99
s_nop 0
v_cndmask_b32_e64 v108, 0, v92, s[80:81]
v_cndmask_b32_e64 v109, 0, v96, s[82:83]
s_and_b64 s[76:77], s[80:81], s[82:83]
v_max_u32 v110, v108, v109
v_min_u32 v111, v108, v109
s_cmp_eq_u64 s[76:77], -1
s_cselect_b32 s73, 0, 1
s_cbranch_scc1 L_pkc
s_not_b64 exec, s[80:81]
s_cselect_b64 exec, exec, 1
buffer_load_dwordx4 v[92:95], v18, s[12:15], s87 offen offset:0 sc1
s_not_b64 exec, s[82:83]
s_cselect_b64 exec, exec, 1
buffer_load_dwordx4 v[96:99], v18, s[12:15], s87 offen offset:1024 sc1
s_mov_b64 exec, -1
L_pkc:
v_cmp_le_u32 vcc, s95, v110
v_cmp_le_u32_e64 s[76:77], s95, v111
s_bcnt1_i32_b64 s70, vcc
s_bcnt1_i32_b64 s71, s[76:77]
s_add_u32 s70, s70, s71
s_cmp_eq_u32 s70, 2
s_cbranch_scc1 L_pksame
v_mov_b32_dpp v112, v110 row_ror:1 row_mask:0xf bank_mask:0xf
v_max_u32_dpp v113, v111, v111 row_ror:1 row_mask:0xf bank_mask:0xf
v_med3_u32 v111, v110, v112, v113
v_max_u32 v110, v110, v112
s_nop 1
v_mov_b32_dpp v112, v110 row_ror:2 row_mask:0xf bank_mask:0xf
v_max_u32_dpp v113, v111, v111 row_ror:2 row_mask:0xf bank_mask:0xf
v_med3_u32 v111, v110, v112, v113
v_max_u32 v110, v110, v112
s_nop 1
v_mov_b32_dpp v112, v110 row_ror:4 row_mask:0xf bank_mask:0xf
v_max_u32_dpp v113, v111, v111 row_ror:4 row_mask:0xf bank_mask:0xf
v_med3_u32 v111, v110, v112, v113
v_max_u32 v110, v110, v112
s_nop 1
v_mov_b32_dpp v112, v110 row_ror:8 row_mask:0xf bank_mask:0xf
v_max_u32_dpp v113, v111, v111 row_ror:8 row_mask:0xf bank_mask:0xf
v_med3_u32 v111, v110, v112, v113
v_max_u32 v110, v110, v112
v_mov_b32 v112, v110
v_mov_b32 v113, v111
s_nop 0
v_permlane16_swap_b32 v110, v112
v_permlane16_swap_b32 v111, v113
v_max_u32 v113, v111, v113
v_med3_u32 v111, v110, v112, v113
v_max_u32 v110, v110, v112
v_mov_b32 v112, v110
v_mov_b32 v113, v111
s_nop 0
v_permlane32_swap_b32 v110, v112
v_permlane32_swap_b32 v111, v113
v_max_u32 v113, v111, v113
v_med3_u32 v111, v110, v112, v113
v_max_u32 v110, v110, v112
v_readfirstlane_b32 s95, v111
s_nop 0
s_cmp_eq_u32 s95, 0
s_cbranch_scc1 L_pksame
v_cndmask_b32_e64 v58, v110, v111, s[32:33]
v_and_b32 v58, 127, v58
v_lshl_add_u32 v58, v58, 14, v57
s_mov_b64 exec, s[92:93]
buffer_load_dwordx4 v[24:27], v58, s[12:15], 0 offen offset:0 sc1
buffer_load_dwordx4 v[28:31], v58, s[12:15], 0 offen offset:64 sc1
buffer_load_dwordx4 v[32:35], v58, s[12:15], 0 offen offset:128 sc1
buffer_load_dwordx4 v[36:39], v58, s[12:15], 0 offen offset:192 sc1
buffer_load_dwordx4 v[40:43], v58, s[12:15], 0 offen offset:256 sc1
buffer_load_dwordx4 v[44:47], v58, s[12:15], 0 offen offset:320 sc1
buffer_load_dwordx4 v[48:51], v58, s[12:15], 0 offen offset:384 sc1
buffer_load_dwordx4 v[52:55], v58, s[12:15], 0 offen offset:448 sc1
s_mov_b64 exec, -1
v_cmp_eq_u32 vcc, v108, v111
v_cmp_eq_u32_e64 s[76:77], v108, v110
s_nop 0
v_cndmask_b32 v112, v63, v114, vcc
s_or_b64 exec, vcc, s[76:77]
ds_write_b96 v112, v[92:94]
s_mov_b64 exec, -1
v_cmp_eq_u32 vcc, v109, v111
v_cmp_eq_u32_e64 s[76:77], v109, v110
s_nop 0
v_cndmask_b32 v113, v63, v114, vcc
s_or_b64 exec, vcc, s[76:77]
ds_write_b96 v113, v[96:98]
s_mov_b64 exec, -1
ds_read_b96 v[20:22], v56
s_waitcnt lgkmcnt(0)
v_mul_f32_e64 v84, v68, -v21
v_mul_f32_e64 v85, v69, -v21
v_mul_f32_e64 v86, v70, -v21
v_mul_f32_e64 v87, v71, -v21
v_mul_f32_e64 v88, v72, -v21
v_mul_f32_e64 v89, v73, -v21
v_mul_f32_e64 v90, v74, -v21
v_mul_f32_e64 v91, v75, -v21
s_cmp_eq_u32 s73, 0
s_cbranch_scc1 L_pkf
s_waitcnt vmcnt(8)
s_add_u32 s78, s78, 1
s_cmp_le_u32 s78, 65536
s_cbranch_scc1 L_pk2
L_pkf:
s_waitcnt vmcnt(7)
v_mfma_f32_16x16x32_bf16 v[84:87], a[0:3], v[24:27], v[84:87]
v_mfma_f32_16x16x32_bf16 v[88:91], a[32:35], v[24:27], v[88:91]
s_waitcnt vmcnt(6)
v_mfma_f32_16x16x32_bf16 v[84:87], a[4:7], v[28:31], v[84:87]
v_mfma_f32_16x16x32_bf16 v[88:91], a[36:39], v[28:31], v[88:91]
s_waitcnt vmcnt(5)
v_mfma_f32_16x16x32_bf16 v[84:87], a[8:11], v[32:35], v[84:87]
v_max3_u32 v2, v24, v28, v32
v_mfma_f32_16x16x32_bf16 v[88:91], a[40:43], v[32:35], v[88:91]
s_waitcnt vmcnt(4)
v_mfma_f32_16x16x32_bf16 v[84:87], a[12:15], v[36:39], v[84:87]
v_mfma_f32_16x16x32_bf16 v[88:91], a[44:47], v[36:39], v[88:91]
s_waitcnt vmcnt(3)
v_mfma_f32_16x16x32_bf16 v[84:87], a[16:19], v[40:43], v[84:87]
v_mfma_f32_16x16x32_bf16 v[88:91], a[48:51], v[40:43], v[88:91]
s_waitcnt vmcnt(2)
v_mfma_f32_16x16x32_bf16 v[84:87], a[20:23], v[44:47], v[84:87]
v_max3_u32 v3, v36, v40, v44
v_mfma_f32_16x16x32_bf16 v[88:91], a[52:55], v[44:47], v[88:91]
s_waitcnt vmcnt(1)
v_mfma_f32_16x16x32_bf16 v[84:87], a[24:27], v[48:51], v[84:87]
v_mfma_f32_16x16x32_bf16 v[88:91], a[56:59], v[48:51], v[88:91]
s_waitcnt vmcnt(0)
v_mfma_f32_16x16x32_bf16 v[84:87], a[28:31], v[52:55], v[84:87]
v_max3_u32 v2, v2, v48, v52
v_max_u32 v2, v2, v3
v_cmp_eq_u32 vcc, -1, v2
v_mfma_f32_16x16x32_bf16 v[88:91], a[60:63], v[52:55], v[88:91]
s_and_b64 vcc, vcc, s[92:93]
s_cbranch_vccnz L_pkx_rt
L_pkx_ok:
s_mov_b32 s76, 0xcccccccc
s_mov_b32 s77, 0xcccccccc
s_nop 3
v_cndmask_b32_e64 v84, v84, v88, s[76:77]
v_cndmask_b32_e64 v85, v85, v89, s[76:77]
v_cndmask_b32_e64 v86, v86, v90, s[76:77]
v_cndmask_b32_e64 v87, v87, v91, s[76:77]
v_bfi_b32 v84, s91, v59, v84
s_mov_b64 exec, s[92:93]
s_cmp_eq_u32 s69, 0
s_cbranch_scc1 L_pxp_s
buffer_store_dwordx4 v[84:87], v60, s[12:15], s85 offen
L_pxp_d:
s_mov_b64 exec, -1
s_barrier
s_load_dword s70, s[12:13], 41152
s_waitcnt lgkmcnt(0)
buffer_load_dwordx4 v[24:27], v61, s[12:15], s86 offen offset:0 sc1
buffer_load_dwordx4 v[28:31], v61, s[12:15], s86 offen offset:1024 sc1
buffer_load_dwordx4 v[32:35], v61, s[12:15], s86 offen offset:2048 sc1
buffer_load_dwordx4 v[36:39], v61, s[12:15], s86 offen offset:3072 sc1
s_mov_b32 s92, 0x00030003
s_mov_b32 s93, 0x00030003
s_waitcnt vmcnt(0)
L_px_chk:
v_xor_b32 v24, s84, v24
v_xor_b32 v28, s84, v28
v_xor_b32 v32, s84, v32
v_xor_b32_e64 v36, s84, v36
v_or3_b32 v2, v24, v28, v32
v_bitop3_b32 v2, v2, v36, s91 bitop3:0xa8
v_cmp_ne_u32 vcc, 0, v2
s_cbranch_vccnz L_px_rt
L_px_ok:
v_pk_add_f32 v[24:25], v[24:25], v[28:29]
v_pk_add_f32 v[32:33], v[32:33], v[36:37]
v_pk_add_f32 v[26:27], v[26:27], v[30:31]
v_pk_add_f32 v[34:35], v[34:35], v[38:39]
v_pk_add_f32 v[24:25], v[24:25], v[32:33]
v_pk_add_f32 v[26:27], v[26:27], v[34:35]
v_pk_mul_f32 v[24:25], v[24:25], v[22:23] op_sel_hi:[1,0]
v_pk_mul_f32 v[26:27], v[26:27], v[22:23] op_sel_hi:[1,0]
s_not_b64 vcc, s[76:77]
v_mul_f32_dpp v32, v24, v24 quad_perm:[2,3,0,1] row_mask:0xf bank_mask:0xf
v_mul_f32_dpp v33, v25, v25 quad_perm:[2,3,0,1] row_mask:0xf bank_mask:0xf
v_mul_f32_dpp v34, v26, v26 quad_perm:[2,3,0,1] row_mask:0xf bank_mask:0xf
v_mul_f32_dpp v35, v27, v27 quad_perm:[2,3,0,1] row_mask:0xf bank_mask:0xf
v_cndmask_b32_dpp v28, v26, v24, vcc quad_perm:[2,3,0,1] row_mask:0xf bank_mask:0xf
v_cndmask_b32_dpp v29, v27, v25, vcc quad_perm:[2,3,0,1] row_mask:0xf bank_mask:0xf
v_mul_f32 v28, 0xbfb8aa3b, v28
v_mul_f32 v29, 0xbfb8aa3b, v29
v_exp_f32 v28, v28
v_exp_f32 v29, v29
v_cndmask_b32 v32, v34, v32, vcc
v_cndmask_b32 v33, v35, v33, vcc
v_add_f32 v28, 1.0, v28
v_add_f32 v29, 1.0, v29
v_rcp_f32 v28, v28
v_rcp_f32 v29, v29
v_mul_f32 v24, v32, v28
v_mul_f32 v25, v33, v29
v_cvt_pk_bf16_f32 v28, v24, v25
s_nop 1
v_mov_b32_dpp v30, v28 row_shl:4 row_mask:0xf bank_mask:0xf
v_mov_b32_dpp v32, v28 row_shl:8 row_mask:0xf bank_mask:0xf
v_mov_b32_dpp v34, v28 row_shl:12 row_mask:0xf bank_mask:0xf
v_mov_b32_dpp v29, v28 row_shl:2 row_mask:0xf bank_mask:0xf
v_mov_b32_dpp v31, v28 row_shl:6 row_mask:0xf bank_mask:0xf
v_mov_b32_dpp v33, v28 row_shl:10 row_mask:0xf bank_mask:0xf
v_mov_b32_dpp v35, v28 row_shl:14 row_mask:0xf bank_mask:0xf
v_mfma_f32_16x16x32_bf16 v[40:43], a[64:67], v[28:31], 0
v_mfma_f32_16x16x32_bf16 v[44:47], a[72:75], v[28:31], 0
v_mfma_f32_16x16x32_bf16 v[40:43], a[68:71], v[32:35], v[40:43]
v_mfma_f32_16x16x32_bf16 v[44:47], a[76:79], v[32:35], v[44:47]
v_mfma_f32_16x16x32_bf16 v[48:51], a[80:83], v[28:31], 0
v_mfma_f32_16x16x32_bf16 v[52:55], a[88:91], v[28:31], 0
v_mfma_f32_16x16x32_bf16 v[48:51], a[84:87], v[32:35], v[48:51]
v_mfma_f32_16x16x32_bf16 v[52:55], a[92:95], v[32:35], v[52:55]
s_cmp_ge_u32 s3, 14
s_cbranch_scc1 L_noy
s_mov_b64 exec, s[92:93]
s_cmp_eq_u32 s24, 0
s_cbranch_scc1 L_yown
v_bfi_b32 v40, s91, v59, v40
buffer_store_dwordx4 v[40:43], v62, s[12:15], s88 offen sc1
s_add_u32 s88, s88, 16384
v_bfi_b32 v44, s91, v59, v44
buffer_store_dwordx4 v[44:47], v62, s[12:15], s88 offen sc1
s_add_u32 s88, s88, 16384
v_bfi_b32 v48, s91, v59, v48
buffer_store_dwordx4 v[48:51], v62, s[12:15], s88 offen sc1
s_add_u32 s88, s88, 16384
v_bfi_b32 v52, s91, v59, v52
buffer_store_dwordx4 v[52:55], v62, s[12:15], s88 offen sc1
L_yd:
s_mov_b64 exec, -1
L_noy:
s_barrier
s_or_b32 s70, s2, s60
s_cbranch_scc1 L_noep
v_mov_b32 v3, 0
s_mov_b64 exec, 1
buffer_store_dword v59, v3, s[12:15], 0 offen sc1
s_mov_b64 exec, -1
L_noep:
s_cmp_lt_u32 s63, 24
s_cbranch_scc1 L_ldone
s_cmp_lg_u32 s60, 1
s_branch L_over2
L_pad2:
s_branch L_pad11
L_over2:
s_cbranch_scc1 L_ldone
s_lshl_b32 s87, s62, 3
s_add_u32 s87, s87, s63
s_sub_u32 s87, s87, 24
s_and_b32 s88, s87, 31
s_lshl_b32 s88, s88, 14
s_bitcmp1_b32 s87, 5
s_cselect_b32 s70, 0, 8192
s_add_u32 s88, s88, s70
s_add_u32 s88, s88, 7340032
s_xor_b32 s88, s88, s61
s_add_u32 s71, s88, 4096
s_lshl_b32 s70, s87, 5
v_bfe_u32 v3, v1, 1, 2
v_lshl_add_u32 v7, v3, 3, s70
s_lshr_b32 s72, s62, 2
s_xor_b32 s72, s72, 0
s_lshl_b32 s72, s72, 13
s_add_u32 s72, s72, 8388608
s_xor_b32 s72, s72, s61
v_lshrrev_b32 v3, 4, v1
v_lshl_add_u32 v7, v3, 1, v7
v_and_b32 v64, 127, v20
v_lshl_add_u32 v64, v64, 14, v7
buffer_load_ushort v84, v64, s[12:15], s72 offen sc1
buffer_load_dwordx4 v[120:123], v18, s[12:15], s88 offen offset:0 sc1
buffer_load_dwordx4 v[124:127], v18, s[12:15], s88 offen offset:1024 sc1
buffer_load_dwordx4 v[128:131], v18, s[12:15], s88 offen offset:2048 sc1
buffer_load_dwordx4 v[132:135], v18, s[12:15], s88 offen offset:3072 sc1
buffer_load_dwordx4 v[136:139], v18, s[12:15], s71 offen offset:0 sc1
buffer_load_dwordx4 v[140:143], v18, s[12:15], s71 offen offset:1024 sc1
buffer_load_dwordx4 v[144:147], v18, s[12:15], s71 offen offset:2048 sc1
v_mov_b32 v88, s84
v_and_b32 v65, 0xfffff000, v20
v_not_b32 v4, v65
v_ashrrev_i32 v4, 31, v4
v_or_b32 v4, 0x80000000, v4
v_xor_b32 v65, v65, v4
v_mul_f32 v65, 0xbfb8aa3b, v65
v_exp_f32 v65, v65
s_nop 0
v_add_f32 v65, 1.0, v65
v_rcp_f32 v65, v65
v_bfe_u32 v66, v20, 1, 6
v_lshl_add_u32 v66, v66, 16, v7
v_bfe_u32 v4, v20, 7, 5
v_lshl_add_u32 v66, v4, 11, v66
v_add_f32 v67, 1.0, v22
v_mul_f32_e64 v21, -v21, v22
s_load_dword s94, s[12:13], 4096
s_waitcnt lgkmcnt(0)
buffer_load_dwordx4 v[24:27], v18, s[12:15], s88 offen offset:0 sc1
buffer_load_dwordx4 v[28:31], v18, s[12:15], s88 offen offset:1024 sc1
buffer_load_dwordx4 v[32:35], v18, s[12:15], s88 offen offset:2048 sc1
buffer_load_dwordx4 v[36:39], v18, s[12:15], s88 offen offset:3072 sc1
buffer_load_dwordx4 v[92:95], v18, s[12:15], s71 offen offset:0 sc1
buffer_load_dwordx4 v[96:99], v18, s[12:15], s71 offen offset:1024 sc1
buffer_load_dwordx4 v[100:103], v18, s[12:15], s71 offen offset:2048 sc1
s_load_dword s94, s[12:13], 4160
s_waitcnt lgkmcnt(0)
buffer_load_dwordx4 v[40:43], v18, s[12:15], s88 offen offset:0 sc1
buffer_load_dwordx4 v[44:47], v18, s[12:15], s88 offen offset:1024 sc1
buffer_load_dwordx4 v[48:51], v18, s[12:15], s88 offen offset:2048 sc1
buffer_load_dwordx4 v[52:55], v18, s[12:15], s88 offen offset:3072 sc1
buffer_load_dwordx4 v[104:107], v18, s[12:15], s71 offen offset:0 sc1
buffer_load_dwordx4 v[108:111], v18, s[12:15], s71 offen offset:1024 sc1
buffer_load_dwordx4 v[112:115], v18, s[12:15], s71 offen offset:2048 sc1
s_waitcnt vmcnt(21)
L_h_chk:
v_cmp_eq_u32 vcc, 0xffff, v84
s_cbranch_vccnz L_h_rt
L_h_ok:
v_lshlrev_b32 v84, 16, v84
v_fma_f32 v84, v84, v67, v21
L_yr:
s_waitcnt vmcnt(14)
v_xor_b32 v120, s84, v120
v_xor_b32_e64 v124, s84, v124
v_xor_b32 v128, s84, v128
v_xor_b32 v132, s84, v132
v_or3_b32 v2, v120, v124, v128
v_xor_b32 v136, s84, v136
v_xor_b32 v140, s84, v140
v_or3_b32 v2, v2, v132, v136
v_xor_b32 v144, s84, v144
v_xor_b32 v88, s84, v88
v_or3_b32 v2, v2, v140, v144
v_bitop3_b32 v2, v2, v88, s91 bitop3:0xa8
v_cmp_ne_u32 vcc, 0, v2
s_cbranch_vccnz L_y_rt
L_yf0:
v_pk_add_f32 v[120:121], v[120:121], v[124:125]
v_pk_add_f32 v[122:123], v[122:123], v[126:127]
v_pk_add_f32 v[128:129], v[128:129], v[132:133]
v_pk_add_f32 v[130:131], v[130:131], v[134:135]
v_pk_add_f32 v[136:137], v[136:137], v[140:141]
v_pk_add_f32 v[138:139], v[138:139], v[142:143]
v_pk_add_f32 v[120:121], v[120:121], v[128:129]
v_pk_add_f32 v[122:123], v[122:123], v[130:131]
v_pk_add_f32 v[136:137], v[136:137], v[144:145]
v_pk_add_f32 v[138:139], v[138:139], v[146:147]
v_pk_add_f32 v[120:121], v[120:121], v[136:137]
v_pk_add_f32 v[122:123], v[122:123], v[138:139]
s_nop 1
v_permlane32_swap_b32 v120, v122
v_permlane32_swap_b32 v121, v123
v_add_f32 v68, v120, v122
v_add_f32 v69, v121, v123
L_yf:
s_nop 1
v_permlane16_swap_b32 v68, v69
v_add_f32 v68, v68, v69
s_mov_b32 s72, 0x00ff00ff
s_mov_b32 s73, 0x00ff00ff
v_add_f32_dpp v68, v68, v68 row_ror:8 row_mask:0xf bank_mask:0xf
v_fmac_f32 v84, v68, v65
v_cvt_pk_bf16_f32 v84, v84, v84
s_mov_b64 exec, s[72:73]
buffer_store_short v84, v66, s[20:23], 0 offen nt
L_ldone:
s_endpgm
.p2alignl 12, 0xbf810000
.fill 160, 4, 0xbf810000
L_compute:
v_and_b32 v2, 15, v1
v_lshrrev_b32 v4, 4, v1
v_lshrrev_b32 v3, 1, v2
v_xor_b32 v3, v3, v4
v_lshlrev_b32 v2, 7, v2
s_lshl_b32 s70, s66, 13
v_add_u32 v2, s70, v2
v_xor_b32 v5, 0, v3
v_lshl_add_u32 v8, v5, 4, v2
v_add_u32 v10, 65536, v8
v_xor_b32 v5, 4, v3
v_lshl_add_u32 v9, v5, 4, v2
v_add_u32 v11, 65536, v9
v_lshrrev_b32 v2, 5, v1
v_mul_u32_u24 v2, 6144, v2
v_bfe_u32 v3, v1, 4, 1
v_lshl_add_u32 v2, v3, 10, v2
v_bfe_u32 v4, v1, 2, 2
v_lshl_add_u32 v2, v4, 7, v2
v_lshlrev_b32 v3, 1, v3
v_bfe_u32 v4, v1, 3, 1
v_or_b32 v3, v3, v4
s_lshl_b32 s70, s67, 1
v_xor_b32 v3, s70, v3
v_and_b32 v4, 3, v1
v_lshl_add_u32 v2, v4, 3, v2
v_xor_b32 v4, 0, v3
v_lshl_add_u32 v12, v4, 5, v2
v_add_u32 v14, 65536, v12
v_xor_b32 v4, 1, v3
v_lshl_add_u32 v13, v4, 5, v2
v_add_u32 v15, 65536, v13
s_waitcnt lgkmcnt(0)
s_mov_b32 s12, s58
s_and_b32 s13, s59, 0xffff
s_mov_b32 s14, 268435456
s_mov_b32 s15, 0x20000
s_load_dword s68, s[58:59], 0
s_mov_b32 s20, s56
s_and_b32 s21, s57, 0xffff
s_mov_b32 s22, 4194304
s_mov_b32 s23, 0x20000
s_lshl_b32 s87, s64, 4
s_add_u32 s87, s87, s65
s_mul_i32 s87, s87, 4352
s_add_u32 s87, s87, 524288
s_and_b32 s88, s65, 7
s_lshl_b32 s88, s88, 19
s_lshr_b32 s70, s65, 1
s_xor_b32 s70, s70, s65
s_and_b32 s70, s70, 4
s_lshl_b32 s70, s70, 11
s_xor_b32 s70, s70, 2105344
s_add_u32 s88, s88, s70
s_mul_i32 s70, s66, 262144
s_add_u32 s88, s88, s70
s_lshr_b32 s70, s64, 2
s_lshl_b32 s70, s70, 14
s_add_u32 s88, s88, s70
s_and_b32 s70, s64, 3
s_lshl_b32 s70, s70, 11
s_add_u32 s88, s88, s70
s_lshl_b32 s70, s67, 10
s_add_u32 s88, s88, s70
s_mov_b32 s70, 0x3f803f80
v_accvgpr_write_b32 a80, s70
v_accvgpr_write_b32 a81, s70
v_accvgpr_write_b32 a82, s70
v_accvgpr_write_b32 a83, s70
s_mov_b32 s80, 0x358637bd
s_mov_b32 s81, 0x358637bd
s_mov_b32 s82, 0x3f800008
s_mov_b32 s83, 0x3f800008
s_mov_b32 s90, 0x3fb8aa3b
s_mov_b32 s91, 0x3fb8aa3b
s_waitcnt lgkmcnt(0)
s_add_u32 s68, s68, 1
v_and_b32 v7, 3, v1
v_lshrrev_b32_e64 v7, v7, s68
v_and_b32 v7, 1, v7
v_mul_u32_u24 v7, 0x10001, v7
s_mov_b32 s76, 0x10001
s_mov_b32 s77, 0x07060302
s_movk_i32 s85, 0xff
v_mov_b32 v28, -1
v_mov_b32 v29, -1
v_mov_b32 v30, -1
v_mov_b32 v31, -1
s_and_b32 s94, s65, 3
s_or_b32 s94, s94, s66
s_barrier
ds_read_b128 a[0:3], v10 offset:57344
ds_read_b64_tr_b16 a[32:33], v12 offset:0
ds_read_b64_tr_b16 a[34:35], v12 offset:512
ds_read_b128 a[4:7], v10 offset:59392
ds_read_b128 a[8:11], v10 offset:61440
ds_read_b128 a[12:15], v10 offset:63488
ds_read_b64_tr_b16 a[36:37], v13 offset:0
ds_read_b64_tr_b16 a[38:39], v13 offset:512
ds_read_b64_tr_b16 a[40:41], v12 offset:2048
ds_read_b64_tr_b16 a[42:43], v12 offset:2560
ds_read_b64_tr_b16 a[44:45], v13 offset:2048
ds_read_b64_tr_b16 a[46:47], v13 offset:2560
ds_read_b64_tr_b16 a[48:49], v12 offset:4096
ds_read_b64_tr_b16 a[50:51], v12 offset:4608
ds_read_b64_tr_b16 a[52:53], v13 offset:4096
ds_read_b64_tr_b16 a[54:55], v13 offset:4608
s_waitcnt lgkmcnt(0)
s_cmp_lg_u32 s94, 0
s_cbranch_scc1 L_nocs0_0
v_mfma_f32_16x16x32_bf16 v[128:131], a[80:83], a[32:35], 0
v_mfma_f32_16x16x32_bf16 v[132:135], a[80:83], a[36:39], 0
v_mfma_f32_16x16x32_bf16 v[136:139], a[80:83], a[40:43], 0
v_mfma_f32_16x16x32_bf16 v[140:143], a[80:83], a[44:47], 0
v_mfma_f32_16x16x32_bf16 v[144:147], a[80:83], a[48:51], 0
v_mfma_f32_16x16x32_bf16 v[148:151], a[80:83], a[52:55], 0
L_nocs0_0:
v_mfma_f32_16x16x32_bf16 v[32:35], a[32:35], a[0:3], 0
ds_read_b128 a[16:19], v11 offset:57344
v_mfma_f32_16x16x32_bf16 v[56:59], a[32:35], a[4:7], 0
ds_read_b64_tr_b16 a[56:57], v12 offset:12288
v_mfma_f32_16x16x32_bf16 v[80:83], a[32:35], a[8:11], 0
ds_read_b64_tr_b16 a[58:59], v12 offset:12800
v_mfma_f32_16x16x32_bf16 v[104:107], a[32:35], a[12:15], 0
ds_read_b128 a[20:23], v11 offset:59392
v_mfma_f32_16x16x32_bf16 v[36:39], a[36:39], a[0:3], 0
ds_read_b128 a[24:27], v11 offset:61440
v_mfma_f32_16x16x32_bf16 v[60:63], a[36:39], a[4:7], 0
ds_read_b128 a[28:31], v11 offset:63488
v_mfma_f32_16x16x32_bf16 v[84:87], a[36:39], a[8:11], 0
ds_read_b64_tr_b16 a[60:61], v13 offset:12288
v_mfma_f32_16x16x32_bf16 v[108:111], a[36:39], a[12:15], 0
ds_read_b64_tr_b16 a[62:63], v13 offset:12800
v_mfma_f32_16x16x32_bf16 v[40:43], a[0:3], a[40:43], 0
ds_read_b64_tr_b16 a[64:65], v12 offset:14336
v_mfma_f32_16x16x32_bf16 v[64:67], a[4:7], a[40:43], 0
ds_read_b64_tr_b16 a[66:67], v12 offset:14848
v_mfma_f32_16x16x32_bf16 v[88:91], a[8:11], a[40:43], 0
ds_read_b64_tr_b16 a[68:69], v13 offset:14336
v_mfma_f32_16x16x32_bf16 v[112:115], a[12:15], a[40:43], 0
ds_read_b64_tr_b16 a[70:71], v13 offset:14848
v_mfma_f32_16x16x32_bf16 v[44:47], a[0:3], a[44:47], 0
ds_read_b64_tr_b16 a[72:73], v12 offset:16384
v_mfma_f32_16x16x32_bf16 v[68:71], a[4:7], a[44:47], 0
ds_read_b64_tr_b16 a[74:75], v12 offset:16896
v_mfma_f32_16x16x32_bf16 v[92:95], a[8:11], a[44:47], 0
ds_read_b64_tr_b16 a[76:77], v13 offset:16384
v_mfma_f32_16x16x32_bf16 v[116:119], a[12:15], a[44:47], 0
ds_read_b64_tr_b16 a[78:79], v13 offset:16896
v_mfma_f32_16x16x32_bf16 v[48:51], a[0:3], a[48:51], 0
v_mfma_f32_16x16x32_bf16 v[72:75], a[4:7], a[48:51], 0
v_mfma_f32_16x16x32_bf16 v[96:99], a[8:11], a[48:51], 0
v_mfma_f32_16x16x32_bf16 v[120:123], a[12:15], a[48:51], 0
v_mfma_f32_16x16x32_bf16 v[52:55], a[0:3], a[52:55], 0
v_mfma_f32_16x16x32_bf16 v[76:79], a[4:7], a[52:55], 0
v_mfma_f32_16x16x32_bf16 v[100:103], a[8:11], a[52:55], 0
v_mfma_f32_16x16x32_bf16 v[124:127], a[12:15], a[52:55], 0
s_waitcnt lgkmcnt(0)
s_cmp_lg_u32 s94, 0
s_cbranch_scc1 L_nocs0_1
v_mfma_f32_16x16x32_bf16 v[128:131], a[80:83], a[56:59], v[128:131]
v_mfma_f32_16x16x32_bf16 v[132:135], a[80:83], a[60:63], v[132:135]
v_mfma_f32_16x16x32_bf16 v[136:139], a[80:83], a[64:67], v[136:139]
v_mfma_f32_16x16x32_bf16 v[140:143], a[80:83], a[68:71], v[140:143]
v_mfma_f32_16x16x32_bf16 v[144:147], a[80:83], a[72:75], v[144:147]
v_mfma_f32_16x16x32_bf16 v[148:151], a[80:83], a[76:79], v[148:151]
L_nocs0_1:
v_mfma_f32_16x16x32_bf16 v[32:35], a[56:59], a[16:19], v[32:35]
s_barrier
ds_read_b128 a[0:3], v10 offset:40960
v_mfma_f32_16x16x32_bf16 v[56:59], a[56:59], a[20:23], v[56:59]
ds_read_b64_tr_b16 a[32:33], v14 offset:16384
v_mfma_f32_16x16x32_bf16 v[80:83], a[56:59], a[24:27], v[80:83]
ds_read_b64_tr_b16 a[34:35], v14 offset:16896
v_mfma_f32_16x16x32_bf16 v[104:107], a[56:59], a[28:31], v[104:107]
ds_read_b128 a[4:7], v10 offset:43008
v_mfma_f32_16x16x32_bf16 v[36:39], a[60:63], a[16:19], v[36:39]
ds_read_b128 a[8:11], v10 offset:45056
v_mfma_f32_16x16x32_bf16 v[60:63], a[60:63], a[20:23], v[60:63]
ds_read_b128 a[12:15], v10 offset:47104
v_mfma_f32_16x16x32_bf16 v[84:87], a[60:63], a[24:27], v[84:87]
ds_read_b64_tr_b16 a[36:37], v15 offset:16384
v_mfma_f32_16x16x32_bf16 v[108:111], a[60:63], a[28:31], v[108:111]
ds_read_b64_tr_b16 a[38:39], v15 offset:16896
v_mfma_f32_16x16x32_bf16 v[40:43], a[16:19], a[64:67], v[40:43]
ds_read_b64_tr_b16 a[40:41], v14 offset:18432
v_mfma_f32_16x16x32_bf16 v[64:67], a[20:23], a[64:67], v[64:67]
ds_read_b64_tr_b16 a[42:43], v14 offset:18944
v_mfma_f32_16x16x32_bf16 v[88:91], a[24:27], a[64:67], v[88:91]
ds_read_b64_tr_b16 a[44:45], v15 offset:18432
v_mfma_f32_16x16x32_bf16 v[112:115], a[28:31], a[64:67], v[112:115]
ds_read_b64_tr_b16 a[46:47], v15 offset:18944
v_mfma_f32_16x16x32_bf16 v[44:47], a[16:19], a[68:71], v[44:47]
ds_read_b64_tr_b16 a[48:49], v14 offset:20480
v_mfma_f32_16x16x32_bf16 v[68:71], a[20:23], a[68:71], v[68:71]
ds_read_b64_tr_b16 a[50:51], v14 offset:20992
v_mfma_f32_16x16x32_bf16 v[92:95], a[24:27], a[68:71], v[92:95]
ds_read_b64_tr_b16 a[52:53], v15 offset:20480
v_mfma_f32_16x16x32_bf16 v[116:119], a[28:31], a[68:71], v[116:119]
ds_read_b64_tr_b16 a[54:55], v15 offset:20992
v_mfma_f32_16x16x32_bf16 v[48:51], a[16:19], a[72:75], v[48:51]
v_mfma_f32_16x16x32_bf16 v[72:75], a[20:23], a[72:75], v[72:75]
v_mfma_f32_16x16x32_bf16 v[96:99], a[24:27], a[72:75], v[96:99]
v_mfma_f32_16x16x32_bf16 v[120:123], a[28:31], a[72:75], v[120:123]
v_mfma_f32_16x16x32_bf16 v[52:55], a[16:19], a[76:79], v[52:55]
v_mfma_f32_16x16x32_bf16 v[76:79], a[20:23], a[76:79], v[76:79]
v_mfma_f32_16x16x32_bf16 v[100:103], a[24:27], a[76:79], v[100:103]
v_mfma_f32_16x16x32_bf16 v[124:127], a[28:31], a[76:79], v[124:127]
s_waitcnt lgkmcnt(0)
s_cmp_lg_u32 s94, 0
s_cbranch_scc1 L_nocs1_0
v_mfma_f32_16x16x32_bf16 v[128:131], a[80:83], a[32:35], v[128:131]
v_mfma_f32_16x16x32_bf16 v[132:135], a[80:83], a[36:39], v[132:135]
v_mfma_f32_16x16x32_bf16 v[136:139], a[80:83], a[40:43], v[136:139]
v_mfma_f32_16x16x32_bf16 v[140:143], a[80:83], a[44:47], v[140:143]
v_mfma_f32_16x16x32_bf16 v[144:147], a[80:83], a[48:51], v[144:147]
v_mfma_f32_16x16x32_bf16 v[148:151], a[80:83], a[52:55], v[148:151]
L_nocs1_0:
v_mfma_f32_16x16x32_bf16 v[32:35], a[32:35], a[0:3], v[32:35]
ds_read_b128 a[16:19], v11 offset:40960
v_mfma_f32_16x16x32_bf16 v[56:59], a[32:35], a[4:7], v[56:59]
ds_read_b64_tr_b16 a[56:57], v14 offset:28672
v_mfma_f32_16x16x32_bf16 v[80:83], a[32:35], a[8:11], v[80:83]
ds_read_b64_tr_b16 a[58:59], v14 offset:29184
v_mfma_f32_16x16x32_bf16 v[104:107], a[32:35], a[12:15], v[104:107]
ds_read_b128 a[20:23], v11 offset:43008
v_mfma_f32_16x16x32_bf16 v[36:39], a[36:39], a[0:3], v[36:39]
ds_read_b128 a[24:27], v11 offset:45056
v_mfma_f32_16x16x32_bf16 v[60:63], a[36:39], a[4:7], v[60:63]
ds_read_b128 a[28:31], v11 offset:47104
v_mfma_f32_16x16x32_bf16 v[84:87], a[36:39], a[8:11], v[84:87]
ds_read_b64_tr_b16 a[60:61], v15 offset:28672
v_mfma_f32_16x16x32_bf16 v[108:111], a[36:39], a[12:15], v[108:111]
ds_read_b64_tr_b16 a[62:63], v15 offset:29184
v_mfma_f32_16x16x32_bf16 v[40:43], a[0:3], a[40:43], v[40:43]
ds_read_b64_tr_b16 a[64:65], v14 offset:30720
v_mfma_f32_16x16x32_bf16 v[64:67], a[4:7], a[40:43], v[64:67]
ds_read_b64_tr_b16 a[66:67], v14 offset:31232
v_mfma_f32_16x16x32_bf16 v[88:91], a[8:11], a[40:43], v[88:91]
ds_read_b64_tr_b16 a[68:69], v15 offset:30720
v_mfma_f32_16x16x32_bf16 v[112:115], a[12:15], a[40:43], v[112:115]
ds_read_b64_tr_b16 a[70:71], v15 offset:31232
v_mfma_f32_16x16x32_bf16 v[44:47], a[0:3], a[44:47], v[44:47]
ds_read_b64_tr_b16 a[72:73], v14 offset:32768
v_mfma_f32_16x16x32_bf16 v[68:71], a[4:7], a[44:47], v[68:71]
ds_read_b64_tr_b16 a[74:75], v14 offset:33280
v_mfma_f32_16x16x32_bf16 v[92:95], a[8:11], a[44:47], v[92:95]
ds_read_b64_tr_b16 a[76:77], v15 offset:32768
v_mfma_f32_16x16x32_bf16 v[116:119], a[12:15], a[44:47], v[116:119]
ds_read_b64_tr_b16 a[78:79], v15 offset:33280
v_mfma_f32_16x16x32_bf16 v[48:51], a[0:3], a[48:51], v[48:51]
v_mfma_f32_16x16x32_bf16 v[72:75], a[4:7], a[48:51], v[72:75]
v_mfma_f32_16x16x32_bf16 v[96:99], a[8:11], a[48:51], v[96:99]
v_mfma_f32_16x16x32_bf16 v[120:123], a[12:15], a[48:51], v[120:123]
v_mfma_f32_16x16x32_bf16 v[52:55], a[0:3], a[52:55], v[52:55]
v_mfma_f32_16x16x32_bf16 v[76:79], a[4:7], a[52:55], v[76:79]
v_mfma_f32_16x16x32_bf16 v[100:103], a[8:11], a[52:55], v[100:103]
v_mfma_f32_16x16x32_bf16 v[124:127], a[12:15], a[52:55], v[124:127]
s_waitcnt lgkmcnt(0)
s_cmp_lg_u32 s94, 0
s_cbranch_scc1 L_nocs1_1
v_mfma_f32_16x16x32_bf16 v[128:131], a[80:83], a[56:59], v[128:131]
v_mfma_f32_16x16x32_bf16 v[132:135], a[80:83], a[60:63], v[132:135]
v_mfma_f32_16x16x32_bf16 v[136:139], a[80:83], a[64:67], v[136:139]
v_mfma_f32_16x16x32_bf16 v[140:143], a[80:83], a[68:71], v[140:143]
v_mfma_f32_16x16x32_bf16 v[144:147], a[80:83], a[72:75], v[144:147]
v_mfma_f32_16x16x32_bf16 v[148:151], a[80:83], a[76:79], v[148:151]
L_nocs1_1:
v_mfma_f32_16x16x32_bf16 v[32:35], a[56:59], a[16:19], v[32:35]
s_barrier
ds_read_b128 a[0:3], v10 offset:0
v_mfma_f32_16x16x32_bf16 v[56:59], a[56:59], a[20:23], v[56:59]
ds_read_b64_tr_b16 a[32:33], v12 offset:40960
v_mfma_f32_16x16x32_bf16 v[80:83], a[56:59], a[24:27], v[80:83]
ds_read_b64_tr_b16 a[34:35], v12 offset:41472
v_mfma_f32_16x16x32_bf16 v[104:107], a[56:59], a[28:31], v[104:107]
ds_read_b128 a[4:7], v10 offset:2048
v_mfma_f32_16x16x32_bf16 v[36:39], a[60:63], a[16:19], v[36:39]
ds_read_b128 a[8:11], v10 offset:4096
v_mfma_f32_16x16x32_bf16 v[60:63], a[60:63], a[20:23], v[60:63]
ds_read_b128 a[12:15], v10 offset:6144
v_mfma_f32_16x16x32_bf16 v[84:87], a[60:63], a[24:27], v[84:87]
ds_read_b64_tr_b16 a[36:37], v13 offset:40960
v_mfma_f32_16x16x32_bf16 v[108:111], a[60:63], a[28:31], v[108:111]
ds_read_b64_tr_b16 a[38:39], v13 offset:41472
v_mfma_f32_16x16x32_bf16 v[40:43], a[16:19], a[64:67], v[40:43]
ds_read_b64_tr_b16 a[40:41], v12 offset:43008
v_mfma_f32_16x16x32_bf16 v[64:67], a[20:23], a[64:67], v[64:67]
ds_read_b64_tr_b16 a[42:43], v12 offset:43520
v_mfma_f32_16x16x32_bf16 v[88:91], a[24:27], a[64:67], v[88:91]
ds_read_b64_tr_b16 a[44:45], v13 offset:43008
v_mfma_f32_16x16x32_bf16 v[112:115], a[28:31], a[64:67], v[112:115]
ds_read_b64_tr_b16 a[46:47], v13 offset:43520
v_mfma_f32_16x16x32_bf16 v[44:47], a[16:19], a[68:71], v[44:47]
ds_read_b64_tr_b16 a[48:49], v12 offset:45056
v_mfma_f32_16x16x32_bf16 v[68:71], a[20:23], a[68:71], v[68:71]
ds_read_b64_tr_b16 a[50:51], v12 offset:45568
v_mfma_f32_16x16x32_bf16 v[92:95], a[24:27], a[68:71], v[92:95]
ds_read_b64_tr_b16 a[52:53], v13 offset:45056
v_mfma_f32_16x16x32_bf16 v[116:119], a[28:31], a[68:71], v[116:119]
ds_read_b64_tr_b16 a[54:55], v13 offset:45568
v_mfma_f32_16x16x32_bf16 v[48:51], a[16:19], a[72:75], v[48:51]
v_mfma_f32_16x16x32_bf16 v[72:75], a[20:23], a[72:75], v[72:75]
v_mfma_f32_16x16x32_bf16 v[96:99], a[24:27], a[72:75], v[96:99]
v_mfma_f32_16x16x32_bf16 v[120:123], a[28:31], a[72:75], v[120:123]
v_mfma_f32_16x16x32_bf16 v[52:55], a[16:19], a[76:79], v[52:55]
v_mfma_f32_16x16x32_bf16 v[76:79], a[20:23], a[76:79], v[76:79]
v_mfma_f32_16x16x32_bf16 v[100:103], a[24:27], a[76:79], v[100:103]
v_mfma_f32_16x16x32_bf16 v[124:127], a[28:31], a[76:79], v[124:127]
s_waitcnt lgkmcnt(0)
s_cmp_lg_u32 s94, 0
s_cbranch_scc1 L_nocs2_0
v_mfma_f32_16x16x32_bf16 v[128:131], a[80:83], a[32:35], v[128:131]
v_mfma_f32_16x16x32_bf16 v[132:135], a[80:83], a[36:39], v[132:135]
v_mfma_f32_16x16x32_bf16 v[136:139], a[80:83], a[40:43], v[136:139]
v_mfma_f32_16x16x32_bf16 v[140:143], a[80:83], a[44:47], v[140:143]
v_mfma_f32_16x16x32_bf16 v[144:147], a[80:83], a[48:51], v[144:147]
v_mfma_f32_16x16x32_bf16 v[148:151], a[80:83], a[52:55], v[148:151]
L_nocs2_0:
v_mfma_f32_16x16x32_bf16 v[32:35], a[32:35], a[0:3], v[32:35]
ds_read_b128 a[16:19], v11 offset:0
v_mfma_f32_16x16x32_bf16 v[56:59], a[32:35], a[4:7], v[56:59]
ds_read_b64_tr_b16 a[56:57], v12 offset:53248
v_mfma_f32_16x16x32_bf16 v[80:83], a[32:35], a[8:11], v[80:83]
ds_read_b64_tr_b16 a[58:59], v12 offset:53760
v_mfma_f32_16x16x32_bf16 v[104:107], a[32:35], a[12:15], v[104:107]
ds_read_b128 a[20:23], v11 offset:2048
v_mfma_f32_16x16x32_bf16 v[36:39], a[36:39], a[0:3], v[36:39]
ds_read_b128 a[24:27], v11 offset:4096
v_mfma_f32_16x16x32_bf16 v[60:63], a[36:39], a[4:7], v[60:63]
ds_read_b128 a[28:31], v11 offset:6144
v_mfma_f32_16x16x32_bf16 v[84:87], a[36:39], a[8:11], v[84:87]
ds_read_b64_tr_b16 a[60:61], v13 offset:53248
v_mfma_f32_16x16x32_bf16 v[108:111], a[36:39], a[12:15], v[108:111]
ds_read_b64_tr_b16 a[62:63], v13 offset:53760
v_mfma_f32_16x16x32_bf16 v[40:43], a[0:3], a[40:43], v[40:43]
ds_read_b64_tr_b16 a[64:65], v12 offset:55296
v_mfma_f32_16x16x32_bf16 v[64:67], a[4:7], a[40:43], v[64:67]
ds_read_b64_tr_b16 a[66:67], v12 offset:55808
v_mfma_f32_16x16x32_bf16 v[88:91], a[8:11], a[40:43], v[88:91]
ds_read_b64_tr_b16 a[68:69], v13 offset:55296
v_mfma_f32_16x16x32_bf16 v[112:115], a[12:15], a[40:43], v[112:115]
ds_read_b64_tr_b16 a[70:71], v13 offset:55808
v_mfma_f32_16x16x32_bf16 v[44:47], a[0:3], a[44:47], v[44:47]
ds_read_b64_tr_b16 a[72:73], v12 offset:57344
v_mfma_f32_16x16x32_bf16 v[68:71], a[4:7], a[44:47], v[68:71]
ds_read_b64_tr_b16 a[74:75], v12 offset:57856
v_mfma_f32_16x16x32_bf16 v[92:95], a[8:11], a[44:47], v[92:95]
ds_read_b64_tr_b16 a[76:77], v13 offset:57344
v_mfma_f32_16x16x32_bf16 v[116:119], a[12:15], a[44:47], v[116:119]
ds_read_b64_tr_b16 a[78:79], v13 offset:57856
v_mfma_f32_16x16x32_bf16 v[48:51], a[0:3], a[48:51], v[48:51]
s_lshl_b32 s70, s60, 10
s_add_u32 s70, s70, s87
buffer_store_dwordx4 v[28:31], v16, s[12:15], s70 offen sc1
v_mfma_f32_16x16x32_bf16 v[72:75], a[4:7], a[48:51], v[72:75]
v_mfma_f32_16x16x32_bf16 v[96:99], a[8:11], a[48:51], v[96:99]
v_mfma_f32_16x16x32_bf16 v[120:123], a[12:15], a[48:51], v[120:123]
v_mfma_f32_16x16x32_bf16 v[52:55], a[0:3], a[52:55], v[52:55]
v_mfma_f32_16x16x32_bf16 v[76:79], a[4:7], a[52:55], v[76:79]
v_mfma_f32_16x16x32_bf16 v[100:103], a[8:11], a[52:55], v[100:103]
v_mfma_f32_16x16x32_bf16 v[124:127], a[12:15], a[52:55], v[124:127]
s_waitcnt lgkmcnt(0)
s_cmp_lg_u32 s94, 0
s_cbranch_scc1 L_nocs2_1
v_mfma_f32_16x16x32_bf16 v[128:131], a[80:83], a[56:59], v[128:131]
v_mfma_f32_16x16x32_bf16 v[132:135], a[80:83], a[60:63], v[132:135]
v_mfma_f32_16x16x32_bf16 v[136:139], a[80:83], a[64:67], v[136:139]
v_mfma_f32_16x16x32_bf16 v[140:143], a[80:83], a[68:71], v[140:143]
v_mfma_f32_16x16x32_bf16 v[144:147], a[80:83], a[72:75], v[144:147]
v_mfma_f32_16x16x32_bf16 v[148:151], a[80:83], a[76:79], v[148:151]
L_nocs2_1:
v_mfma_f32_16x16x32_bf16 v[32:35], a[56:59], a[16:19], v[32:35]
s_barrier
ds_read_b128 a[0:3], v8 offset:24576
v_mfma_f32_16x16x32_bf16 v[56:59], a[56:59], a[20:23], v[56:59]
ds_read_b64_tr_b16 a[32:33], v12 offset:0
v_mfma_f32_16x16x32_bf16 v[80:83], a[56:59], a[24:27], v[80:83]
ds_read_b64_tr_b16 a[34:35], v12 offset:512
v_mfma_f32_16x16x32_bf16 v[104:107], a[56:59], a[28:31], v[104:107]
ds_read_b128 a[4:7], v8 offset:26624
v_mfma_f32_16x16x32_bf16 v[36:39], a[60:63], a[16:19], v[36:39]
ds_read_b128 a[8:11], v8 offset:28672
v_mfma_f32_16x16x32_bf16 v[60:63], a[60:63], a[20:23], v[60:63]
ds_read_b128 a[12:15], v8 offset:30720
v_mfma_f32_16x16x32_bf16 v[84:87], a[60:63], a[24:27], v[84:87]
ds_read_b64_tr_b16 a[36:37], v13 offset:0
v_mfma_f32_16x16x32_bf16 v[108:111], a[60:63], a[28:31], v[108:111]
ds_read_b64_tr_b16 a[38:39], v13 offset:512
v_mfma_f32_16x16x32_bf16 v[40:43], a[16:19], a[64:67], v[40:43]
ds_read_b64_tr_b16 a[40:41], v12 offset:2048
v_mfma_f32_16x16x32_bf16 v[64:67], a[20:23], a[64:67], v[64:67]
ds_read_b64_tr_b16 a[42:43], v12 offset:2560
v_mfma_f32_16x16x32_bf16 v[88:91], a[24:27], a[64:67], v[88:91]
ds_read_b64_tr_b16 a[44:45], v13 offset:2048
v_mfma_f32_16x16x32_bf16 v[112:115], a[28:31], a[64:67], v[112:115]
ds_read_b64_tr_b16 a[46:47], v13 offset:2560
v_mfma_f32_16x16x32_bf16 v[44:47], a[16:19], a[68:71], v[44:47]
ds_read_b64_tr_b16 a[48:49], v12 offset:4096
v_mfma_f32_16x16x32_bf16 v[68:71], a[20:23], a[68:71], v[68:71]
ds_read_b64_tr_b16 a[50:51], v12 offset:4608
v_mfma_f32_16x16x32_bf16 v[92:95], a[24:27], a[68:71], v[92:95]
ds_read_b64_tr_b16 a[52:53], v13 offset:4096
v_mfma_f32_16x16x32_bf16 v[116:119], a[28:31], a[68:71], v[116:119]
ds_read_b64_tr_b16 a[54:55], v13 offset:4608
v_mfma_f32_16x16x32_bf16 v[48:51], a[16:19], a[72:75], v[48:51]
v_mfma_f32_16x16x32_bf16 v[72:75], a[20:23], a[72:75], v[72:75]
v_mfma_f32_16x16x32_bf16 v[96:99], a[24:27], a[72:75], v[96:99]
v_mfma_f32_16x16x32_bf16 v[120:123], a[28:31], a[72:75], v[120:123]
v_mfma_f32_16x16x32_bf16 v[52:55], a[16:19], a[76:79], v[52:55]
v_mfma_f32_16x16x32_bf16 v[76:79], a[20:23], a[76:79], v[76:79]
v_mfma_f32_16x16x32_bf16 v[100:103], a[24:27], a[76:79], v[100:103]
v_mfma_f32_16x16x32_bf16 v[124:127], a[28:31], a[76:79], v[124:127]
s_waitcnt lgkmcnt(0)
s_cmp_lg_u32 s94, 0
s_cbranch_scc1 L_nocs3_0
v_mfma_f32_16x16x32_bf16 v[128:131], a[80:83], a[32:35], v[128:131]
v_mfma_f32_16x16x32_bf16 v[132:135], a[80:83], a[36:39], v[132:135]
v_mfma_f32_16x16x32_bf16 v[136:139], a[80:83], a[40:43], v[136:139]
v_mfma_f32_16x16x32_bf16 v[140:143], a[80:83], a[44:47], v[140:143]
v_mfma_f32_16x16x32_bf16 v[144:147], a[80:83], a[48:51], v[144:147]
v_mfma_f32_16x16x32_bf16 v[148:151], a[80:83], a[52:55], v[148:151]
L_nocs3_0:
v_mfma_f32_16x16x32_bf16 v[32:35], a[32:35], a[0:3], v[32:35]
ds_read_b128 a[16:19], v9 offset:24576
v_mfma_f32_16x16x32_bf16 v[56:59], a[32:35], a[4:7], v[56:59]
ds_read_b64_tr_b16 a[56:57], v12 offset:12288
v_mfma_f32_16x16x32_bf16 v[80:83], a[32:35], a[8:11], v[80:83]
ds_read_b64_tr_b16 a[58:59], v12 offset:12800
v_mfma_f32_16x16x32_bf16 v[104:107], a[32:35], a[12:15], v[104:107]
ds_read_b128 a[20:23], v9 offset:26624
v_mfma_f32_16x16x32_bf16 v[36:39], a[36:39], a[0:3], v[36:39]
ds_read_b128 a[24:27], v9 offset:28672
v_mfma_f32_16x16x32_bf16 v[60:63], a[36:39], a[4:7], v[60:63]
ds_read_b128 a[28:31], v9 offset:30720
v_mfma_f32_16x16x32_bf16 v[84:87], a[36:39], a[8:11], v[84:87]
ds_read_b64_tr_b16 a[60:61], v13 offset:12288
v_mfma_f32_16x16x32_bf16 v[108:111], a[36:39], a[12:15], v[108:111]
ds_read_b64_tr_b16 a[62:63], v13 offset:12800
v_mfma_f32_16x16x32_bf16 v[40:43], a[0:3], a[40:43], v[40:43]
ds_read_b64_tr_b16 a[64:65], v12 offset:14336
v_mfma_f32_16x16x32_bf16 v[64:67], a[4:7], a[40:43], v[64:67]
ds_read_b64_tr_b16 a[66:67], v12 offset:14848
v_mfma_f32_16x16x32_bf16 v[88:91], a[8:11], a[40:43], v[88:91]
ds_read_b64_tr_b16 a[68:69], v13 offset:14336
v_mfma_f32_16x16x32_bf16 v[112:115], a[12:15], a[40:43], v[112:115]
ds_read_b64_tr_b16 a[70:71], v13 offset:14848
v_mfma_f32_16x16x32_bf16 v[44:47], a[0:3], a[44:47], v[44:47]
ds_read_b64_tr_b16 a[72:73], v12 offset:16384
v_mfma_f32_16x16x32_bf16 v[68:71], a[4:7], a[44:47], v[68:71]
ds_read_b64_tr_b16 a[74:75], v12 offset:16896
v_mfma_f32_16x16x32_bf16 v[92:95], a[8:11], a[44:47], v[92:95]
ds_read_b64_tr_b16 a[76:77], v13 offset:16384
v_mfma_f32_16x16x32_bf16 v[116:119], a[12:15], a[44:47], v[116:119]
ds_read_b64_tr_b16 a[78:79], v13 offset:16896
v_mfma_f32_16x16x32_bf16 v[48:51], a[0:3], a[48:51], v[48:51]
v_mfma_f32_16x16x32_bf16 v[72:75], a[4:7], a[48:51], v[72:75]
v_mfma_f32_16x16x32_bf16 v[96:99], a[8:11], a[48:51], v[96:99]
v_mfma_f32_16x16x32_bf16 v[120:123], a[12:15], a[48:51], v[120:123]
v_mfma_f32_16x16x32_bf16 v[52:55], a[0:3], a[52:55], v[52:55]
v_mfma_f32_16x16x32_bf16 v[76:79], a[4:7], a[52:55], v[76:79]
v_mfma_f32_16x16x32_bf16 v[100:103], a[8:11], a[52:55], v[100:103]
v_mfma_f32_16x16x32_bf16 v[124:127], a[12:15], a[52:55], v[124:127]
s_waitcnt lgkmcnt(0)
s_cmp_lg_u32 s94, 0
s_cbranch_scc1 L_nocs3_1
v_mfma_f32_16x16x32_bf16 v[128:131], a[80:83], a[56:59], v[128:131]
v_mfma_f32_16x16x32_bf16 v[132:135], a[80:83], a[60:63], v[132:135]
v_mfma_f32_16x16x32_bf16 v[136:139], a[80:83], a[64:67], v[136:139]
v_mfma_f32_16x16x32_bf16 v[140:143], a[80:83], a[68:71], v[140:143]
v_mfma_f32_16x16x32_bf16 v[144:147], a[80:83], a[72:75], v[144:147]
v_mfma_f32_16x16x32_bf16 v[148:151], a[80:83], a[76:79], v[148:151]
L_nocs3_1:
v_mfma_f32_16x16x32_bf16 v[32:35], a[56:59], a[16:19], v[32:35]
s_barrier
ds_read_b128 a[0:3], v10 offset:57344
v_mfma_f32_16x16x32_bf16 v[56:59], a[56:59], a[20:23], v[56:59]
ds_read_b64_tr_b16 a[32:33], v14 offset:16384
v_mfma_f32_16x16x32_bf16 v[80:83], a[56:59], a[24:27], v[80:83]
ds_read_b64_tr_b16 a[34:35], v14 offset:16896
s_branch L_over3
L_pad3:
s_branch L_ret4
L_over3:
v_mfma_f32_16x16x32_bf16 v[104:107], a[56:59], a[28:31], v[104:107]
ds_read_b128 a[4:7], v10 offset:59392
v_mfma_f32_16x16x32_bf16 v[36:39], a[60:63], a[16:19], v[36:39]
ds_read_b128 a[8:11], v10 offset:61440
v_mfma_f32_16x16x32_bf16 v[60:63], a[60:63], a[20:23], v[60:63]
ds_read_b128 a[12:15], v10 offset:63488
v_mfma_f32_16x16x32_bf16 v[84:87], a[60:63], a[24:27], v[84:87]
ds_read_b64_tr_b16 a[36:37], v15 offset:16384
v_mfma_f32_16x16x32_bf16 v[108:111], a[60:63], a[28:31], v[108:111]
ds_read_b64_tr_b16 a[38:39], v15 offset:16896
v_mfma_f32_16x16x32_bf16 v[40:43], a[16:19], a[64:67], v[40:43]
ds_read_b64_tr_b16 a[40:41], v14 offset:18432
v_mfma_f32_16x16x32_bf16 v[64:67], a[20:23], a[64:67], v[64:67]
ds_read_b64_tr_b16 a[42:43], v14 offset:18944
v_mfma_f32_16x16x32_bf16 v[88:91], a[24:27], a[64:67], v[88:91]
ds_read_b64_tr_b16 a[44:45], v15 offset:18432
v_mfma_f32_16x16x32_bf16 v[112:115], a[28:31], a[64:67], v[112:115]
ds_read_b64_tr_b16 a[46:47], v15 offset:18944
v_mfma_f32_16x16x32_bf16 v[44:47], a[16:19], a[68:71], v[44:47]
ds_read_b64_tr_b16 a[48:49], v14 offset:20480
v_mfma_f32_16x16x32_bf16 v[68:71], a[20:23], a[68:71], v[68:71]
ds_read_b64_tr_b16 a[50:51], v14 offset:20992
v_mfma_f32_16x16x32_bf16 v[92:95], a[24:27], a[68:71], v[92:95]
ds_read_b64_tr_b16 a[52:53], v15 offset:20480
v_mfma_f32_16x16x32_bf16 v[116:119], a[28:31], a[68:71], v[116:119]
ds_read_b64_tr_b16 a[54:55], v15 offset:20992
v_mfma_f32_16x16x32_bf16 v[48:51], a[16:19], a[72:75], v[48:51]
v_mfma_f32_16x16x32_bf16 v[72:75], a[20:23], a[72:75], v[72:75]
v_mfma_f32_16x16x32_bf16 v[96:99], a[24:27], a[72:75], v[96:99]
v_mfma_f32_16x16x32_bf16 v[120:123], a[28:31], a[72:75], v[120:123]
v_mfma_f32_16x16x32_bf16 v[52:55], a[16:19], a[76:79], v[52:55]
v_mfma_f32_16x16x32_bf16 v[76:79], a[20:23], a[76:79], v[76:79]
v_mfma_f32_16x16x32_bf16 v[100:103], a[24:27], a[76:79], v[100:103]
v_mfma_f32_16x16x32_bf16 v[124:127], a[28:31], a[76:79], v[124:127]
s_waitcnt lgkmcnt(0)
v_mfma_f32_16x16x32_bf16 v[32:35], a[32:35], a[0:3], v[32:35]
ds_read_b128 a[16:19], v11 offset:57344
v_mfma_f32_16x16x32_bf16 v[56:59], a[32:35], a[4:7], v[56:59]
ds_read_b64_tr_b16 a[56:57], v14 offset:28672
v_mfma_f32_16x16x32_bf16 v[80:83], a[32:35], a[8:11], v[80:83]
ds_read_b64_tr_b16 a[58:59], v14 offset:29184
v_mfma_f32_16x16x32_bf16 v[104:107], a[32:35], a[12:15], v[104:107]
ds_read_b128 a[20:23], v11 offset:59392
v_mfma_f32_16x16x32_bf16 v[36:39], a[36:39], a[0:3], v[36:39]
ds_read_b128 a[24:27], v11 offset:61440
v_mfma_f32_16x16x32_bf16 v[60:63], a[36:39], a[4:7], v[60:63]
ds_read_b128 a[28:31], v11 offset:63488
v_mfma_f32_16x16x32_bf16 v[84:87], a[36:39], a[8:11], v[84:87]
ds_read_b64_tr_b16 a[60:61], v15 offset:28672
v_mfma_f32_16x16x32_bf16 v[108:111], a[36:39], a[12:15], v[108:111]
ds_read_b64_tr_b16 a[62:63], v15 offset:29184
v_mfma_f32_16x16x32_bf16 v[40:43], a[0:3], a[40:43], v[40:43]
ds_read_b64_tr_b16 a[64:65], v14 offset:30720
v_mfma_f32_16x16x32_bf16 v[64:67], a[4:7], a[40:43], v[64:67]
ds_read_b64_tr_b16 a[66:67], v14 offset:31232
v_mfma_f32_16x16x32_bf16 v[88:91], a[8:11], a[40:43], v[88:91]
ds_read_b64_tr_b16 a[68:69], v15 offset:30720
v_mfma_f32_16x16x32_bf16 v[112:115], a[12:15], a[40:43], v[112:115]
ds_read_b64_tr_b16 a[70:71], v15 offset:31232
v_mfma_f32_16x16x32_bf16 v[44:47], a[0:3], a[44:47], v[44:47]
ds_read_b64_tr_b16 a[72:73], v14 offset:32768
v_mfma_f32_16x16x32_bf16 v[68:71], a[4:7], a[44:47], v[68:71]
ds_read_b64_tr_b16 a[74:75], v14 offset:33280
v_mfma_f32_16x16x32_bf16 v[92:95], a[8:11], a[44:47], v[92:95]
ds_read_b64_tr_b16 a[76:77], v15 offset:32768
v_mfma_f32_16x16x32_bf16 v[116:119], a[12:15], a[44:47], v[116:119]
ds_read_b64_tr_b16 a[78:79], v15 offset:33280
v_mfma_f32_16x16x32_bf16 v[48:51], a[0:3], a[48:51], v[48:51]
s_add_u32 s70, s88, 0
buffer_store_dwordx4 v[28:31], v16, s[12:15], s70 offen sc1
v_mfma_f32_16x16x32_bf16 v[72:75], a[4:7], a[48:51], v[72:75]
v_mfma_f32_16x16x32_bf16 v[96:99], a[8:11], a[48:51], v[96:99]
s_add_u32 s70, s88, 65536
buffer_store_dwordx4 v[28:31], v16, s[12:15], s70 offen sc1
v_mfma_f32_16x16x32_bf16 v[120:123], a[12:15], a[48:51], v[120:123]
v_mfma_f32_16x16x32_bf16 v[52:55], a[0:3], a[52:55], v[52:55]
v_mfma_f32_16x16x32_bf16 v[76:79], a[4:7], a[52:55], v[76:79]
v_mfma_f32_16x16x32_bf16 v[100:103], a[8:11], a[52:55], v[100:103]
v_mfma_f32_16x16x32_bf16 v[124:127], a[12:15], a[52:55], v[124:127]
s_waitcnt lgkmcnt(0)
v_mfma_f32_16x16x32_bf16 v[32:35], a[56:59], a[16:19], v[32:35]
s_barrier
ds_read_b128 a[0:3], v10 offset:40960
v_mfma_f32_16x16x32_bf16 v[56:59], a[56:59], a[20:23], v[56:59]
ds_read_b64_tr_b16 a[32:33], v12 offset:40960
v_mfma_f32_16x16x32_bf16 v[80:83], a[56:59], a[24:27], v[80:83]
ds_read_b64_tr_b16 a[34:35], v12 offset:41472
v_mfma_f32_16x16x32_bf16 v[104:107], a[56:59], a[28:31], v[104:107]
ds_read_b128 a[4:7], v10 offset:43008
v_mfma_f32_16x16x32_bf16 v[36:39], a[60:63], a[16:19], v[36:39]
ds_read_b128 a[8:11], v10 offset:45056
v_mfma_f32_16x16x32_bf16 v[60:63], a[60:63], a[20:23], v[60:63]
ds_read_b128 a[12:15], v10 offset:47104
v_mfma_f32_16x16x32_bf16 v[84:87], a[60:63], a[24:27], v[84:87]
ds_read_b64_tr_b16 a[36:37], v13 offset:40960
v_mfma_f32_16x16x32_bf16 v[108:111], a[60:63], a[28:31], v[108:111]
ds_read_b64_tr_b16 a[38:39], v13 offset:41472
v_mfma_f32_16x16x32_bf16 v[40:43], a[16:19], a[64:67], v[40:43]
ds_read_b64_tr_b16 a[40:41], v12 offset:43008
v_mfma_f32_16x16x32_bf16 v[64:67], a[20:23], a[64:67], v[64:67]
ds_read_b64_tr_b16 a[42:43], v12 offset:43520
v_mfma_f32_16x16x32_bf16 v[88:91], a[24:27], a[64:67], v[88:91]
ds_read_b64_tr_b16 a[44:45], v13 offset:43008
v_mfma_f32_16x16x32_bf16 v[112:115], a[28:31], a[64:67], v[112:115]
ds_read_b64_tr_b16 a[46:47], v13 offset:43520
v_mfma_f32_16x16x32_bf16 v[44:47], a[16:19], a[68:71], v[44:47]
ds_read_b64_tr_b16 a[48:49], v12 offset:45056
v_mfma_f32_16x16x32_bf16 v[68:71], a[20:23], a[68:71], v[68:71]
ds_read_b64_tr_b16 a[50:51], v12 offset:45568
v_mfma_f32_16x16x32_bf16 v[92:95], a[24:27], a[68:71], v[92:95]
ds_read_b64_tr_b16 a[52:53], v13 offset:45056
v_mfma_f32_16x16x32_bf16 v[116:119], a[28:31], a[68:71], v[116:119]
ds_read_b64_tr_b16 a[54:55], v13 offset:45568
v_mfma_f32_16x16x32_bf16 v[48:51], a[16:19], a[72:75], v[48:51]
v_mfma_f32_16x16x32_bf16 v[72:75], a[20:23], a[72:75], v[72:75]
v_mfma_f32_16x16x32_bf16 v[96:99], a[24:27], a[72:75], v[96:99]
v_mfma_f32_16x16x32_bf16 v[120:123], a[28:31], a[72:75], v[120:123]
v_mfma_f32_16x16x32_bf16 v[52:55], a[16:19], a[76:79], v[52:55]
v_mfma_f32_16x16x32_bf16 v[76:79], a[20:23], a[76:79], v[76:79]
v_mfma_f32_16x16x32_bf16 v[100:103], a[24:27], a[76:79], v[100:103]
v_mfma_f32_16x16x32_bf16 v[124:127], a[28:31], a[76:79], v[124:127]
s_waitcnt lgkmcnt(0)
v_mfma_f32_16x16x32_bf16 v[32:35], a[32:35], a[0:3], v[32:35]
ds_read_b128 a[16:19], v11 offset:40960
v_mfma_f32_16x16x32_bf16 v[56:59], a[32:35], a[4:7], v[56:59]
ds_read_b64_tr_b16 a[56:57], v12 offset:53248
v_mfma_f32_16x16x32_bf16 v[80:83], a[32:35], a[8:11], v[80:83]
ds_read_b64_tr_b16 a[58:59], v12 offset:53760
v_mfma_f32_16x16x32_bf16 v[104:107], a[32:35], a[12:15], v[104:107]
ds_read_b128 a[20:23], v11 offset:43008
v_mfma_f32_16x16x32_bf16 v[36:39], a[36:39], a[0:3], v[36:39]
ds_read_b128 a[24:27], v11 offset:45056
v_mfma_f32_16x16x32_bf16 v[60:63], a[36:39], a[4:7], v[60:63]
ds_read_b128 a[28:31], v11 offset:47104
v_mfma_f32_16x16x32_bf16 v[84:87], a[36:39], a[8:11], v[84:87]
ds_read_b64_tr_b16 a[60:61], v13 offset:53248
v_mfma_f32_16x16x32_bf16 v[108:111], a[36:39], a[12:15], v[108:111]
ds_read_b64_tr_b16 a[62:63], v13 offset:53760
v_mfma_f32_16x16x32_bf16 v[40:43], a[0:3], a[40:43], v[40:43]
ds_read_b64_tr_b16 a[64:65], v12 offset:55296
v_mfma_f32_16x16x32_bf16 v[64:67], a[4:7], a[40:43], v[64:67]
ds_read_b64_tr_b16 a[66:67], v12 offset:55808
v_mfma_f32_16x16x32_bf16 v[88:91], a[8:11], a[40:43], v[88:91]
ds_read_b64_tr_b16 a[68:69], v13 offset:55296
v_mfma_f32_16x16x32_bf16 v[112:115], a[12:15], a[40:43], v[112:115]
ds_read_b64_tr_b16 a[70:71], v13 offset:55808
v_mfma_f32_16x16x32_bf16 v[44:47], a[0:3], a[44:47], v[44:47]
ds_read_b64_tr_b16 a[72:73], v12 offset:57344
v_mfma_f32_16x16x32_bf16 v[68:71], a[4:7], a[44:47], v[68:71]
ds_read_b64_tr_b16 a[74:75], v12 offset:57856
v_mfma_f32_16x16x32_bf16 v[92:95], a[8:11], a[44:47], v[92:95]
ds_read_b64_tr_b16 a[76:77], v13 offset:57344
v_mfma_f32_16x16x32_bf16 v[116:119], a[12:15], a[44:47], v[116:119]
ds_read_b64_tr_b16 a[78:79], v13 offset:57856
v_mfma_f32_16x16x32_bf16 v[48:51], a[0:3], a[48:51], v[48:51]
s_cmp_lg_u32 s94, 0
s_cbranch_scc1 L_nocsp
v_and_b32 v2, 16, v1
v_cmp_ne_u32 vcc, 0, v2
s_nop 1
v_cndmask_b32 v24, v128, v132, vcc
v_cndmask_b32 v25, v136, v140, vcc
v_cndmask_b32 v26, v144, v148, vcc
v_mov_b32 v27, s68
s_lshl_b32 s70, s64, 4
s_lshr_b32 s71, s65, 2
s_add_u32 s70, s70, s71
s_lshl_b32 s70, s70, 10
s_lshl_b32 s71, s67, 9
s_add_u32 s70, s70, s71
s_add_u32 s70, s70, 65536
s_mov_b64 exec, 0xffffffff
buffer_store_dwordx4 v[24:27], v16, s[12:15], s70 offen sc1
s_mov_b64 exec, -1
L_nocsp:
v_mfma_f32_16x16x32_bf16 v[72:75], a[4:7], a[48:51], v[72:75]
v_mfma_f32_16x16x32_bf16 v[96:99], a[8:11], a[48:51], v[96:99]
s_add_u32 s70, s88, 131072
buffer_store_dwordx4 v[28:31], v16, s[12:15], s70 offen sc1
v_mfma_f32_16x16x32_bf16 v[120:123], a[12:15], a[48:51], v[120:123]
v_mfma_f32_16x16x32_bf16 v[52:55], a[0:3], a[52:55], v[52:55]
s_add_u32 s70, s88, 196608
buffer_store_dwordx4 v[28:31], v16, s[12:15], s70 offen sc1
v_mfma_f32_16x16x32_bf16 v[76:79], a[4:7], a[52:55], v[76:79]
v_mfma_f32_16x16x32_bf16 v[100:103], a[8:11], a[52:55], v[100:103]
v_mfma_f32_16x16x32_bf16 v[124:127], a[12:15], a[52:55], v[124:127]
s_waitcnt lgkmcnt(0)
v_mfma_f32_16x16x32_bf16 v[32:35], a[56:59], a[16:19], v[32:35]
s_barrier
ds_read_b128 a[0:3], v10 offset:0
v_mfma_f32_16x16x32_bf16 v[56:59], a[56:59], a[20:23], v[56:59]
ds_read_b64_tr_b16 a[32:33], v12 offset:0
v_mfma_f32_16x16x32_bf16 v[80:83], a[56:59], a[24:27], v[80:83]
ds_read_b64_tr_b16 a[34:35], v12 offset:512
v_mfma_f32_16x16x32_bf16 v[104:107], a[56:59], a[28:31], v[104:107]
ds_read_b128 a[4:7], v10 offset:2048
v_mfma_f32_16x16x32_bf16 v[36:39], a[60:63], a[16:19], v[36:39]
ds_read_b128 a[8:11], v10 offset:4096
v_mfma_f32_16x16x32_bf16 v[60:63], a[60:63], a[20:23], v[60:63]
ds_read_b128 a[12:15], v10 offset:6144
v_mfma_f32_16x16x32_bf16 v[84:87], a[60:63], a[24:27], v[84:87]
ds_read_b64_tr_b16 a[36:37], v13 offset:0
v_mfma_f32_16x16x32_bf16 v[108:111], a[60:63], a[28:31], v[108:111]
ds_read_b64_tr_b16 a[38:39], v13 offset:512
v_mfma_f32_16x16x32_bf16 v[40:43], a[16:19], a[64:67], v[40:43]
ds_read_b64_tr_b16 a[40:41], v12 offset:2048
v_mfma_f32_16x16x32_bf16 v[64:67], a[20:23], a[64:67], v[64:67]
ds_read_b64_tr_b16 a[42:43], v12 offset:2560
v_mfma_f32_16x16x32_bf16 v[88:91], a[24:27], a[64:67], v[88:91]
ds_read_b64_tr_b16 a[44:45], v13 offset:2048
v_mfma_f32_16x16x32_bf16 v[112:115], a[28:31], a[64:67], v[112:115]
ds_read_b64_tr_b16 a[46:47], v13 offset:2560
v_mfma_f32_16x16x32_bf16 v[44:47], a[16:19], a[68:71], v[44:47]
ds_read_b64_tr_b16 a[48:49], v12 offset:4096
v_mfma_f32_16x16x32_bf16 v[68:71], a[20:23], a[68:71], v[68:71]
ds_read_b64_tr_b16 a[50:51], v12 offset:4608
v_mfma_f32_16x16x32_bf16 v[92:95], a[24:27], a[68:71], v[92:95]
ds_read_b64_tr_b16 a[52:53], v13 offset:4096
v_mfma_f32_16x16x32_bf16 v[116:119], a[28:31], a[68:71], v[116:119]
ds_read_b64_tr_b16 a[54:55], v13 offset:4608
v_mfma_f32_16x16x32_bf16 v[48:51], a[16:19], a[72:75], v[48:51]
v_mfma_f32_16x16x32_bf16 v[72:75], a[20:23], a[72:75], v[72:75]
v_mfma_f32_16x16x32_bf16 v[96:99], a[24:27], a[72:75], v[96:99]
v_mfma_f32_16x16x32_bf16 v[120:123], a[28:31], a[72:75], v[120:123]
v_mfma_f32_16x16x32_bf16 v[52:55], a[16:19], a[76:79], v[52:55]
v_mfma_f32_16x16x32_bf16 v[76:79], a[20:23], a[76:79], v[76:79]
v_mfma_f32_16x16x32_bf16 v[100:103], a[24:27], a[76:79], v[100:103]
v_mfma_f32_16x16x32_bf16 v[124:127], a[28:31], a[76:79], v[124:127]
s_waitcnt lgkmcnt(0)
v_mfma_f32_16x16x32_bf16 v[32:35], a[32:35], a[0:3], v[32:35]
ds_read_b128 a[16:19], v11 offset:0
v_mfma_f32_16x16x32_bf16 v[56:59], a[32:35], a[4:7], v[56:59]
ds_read_b64_tr_b16 a[56:57], v12 offset:12288
v_mfma_f32_16x16x32_bf16 v[80:83], a[32:35], a[8:11], v[80:83]
ds_read_b64_tr_b16 a[58:59], v12 offset:12800
v_mfma_f32_16x16x32_bf16 v[104:107], a[32:35], a[12:15], v[104:107]
ds_read_b128 a[20:23], v11 offset:2048
v_mfma_f32_16x16x32_bf16 v[36:39], a[36:39], a[0:3], v[36:39]
ds_read_b128 a[24:27], v11 offset:4096
v_mfma_f32_16x16x32_bf16 v[60:63], a[36:39], a[4:7], v[60:63]
ds_read_b128 a[28:31], v11 offset:6144
v_mfma_f32_16x16x32_bf16 v[84:87], a[36:39], a[8:11], v[84:87]
ds_read_b64_tr_b16 a[60:61], v13 offset:12288
v_mfma_f32_16x16x32_bf16 v[108:111], a[36:39], a[12:15], v[108:111]
ds_read_b64_tr_b16 a[62:63], v13 offset:12800
v_mfma_f32_16x16x32_bf16 v[40:43], a[0:3], a[40:43], v[40:43]
ds_read_b64_tr_b16 a[64:65], v12 offset:14336
v_mfma_f32_16x16x32_bf16 v[64:67], a[4:7], a[40:43], v[64:67]
ds_read_b64_tr_b16 a[66:67], v12 offset:14848
v_mfma_f32_16x16x32_bf16 v[88:91], a[8:11], a[40:43], v[88:91]
ds_read_b64_tr_b16 a[68:69], v13 offset:14336
v_mfma_f32_16x16x32_bf16 v[112:115], a[12:15], a[40:43], v[112:115]
ds_read_b64_tr_b16 a[70:71], v13 offset:14848
v_mfma_f32_16x16x32_bf16 v[44:47], a[0:3], a[44:47], v[44:47]
ds_read_b64_tr_b16 a[72:73], v12 offset:16384
v_mfma_f32_16x16x32_bf16 v[68:71], a[4:7], a[44:47], v[68:71]
ds_read_b64_tr_b16 a[74:75], v12 offset:16896
v_mfma_f32_16x16x32_bf16 v[92:95], a[8:11], a[44:47], v[92:95]
ds_read_b64_tr_b16 a[76:77], v13 offset:16384
v_mfma_f32_16x16x32_bf16 v[116:119], a[12:15], a[44:47], v[116:119]
ds_read_b64_tr_b16 a[78:79], v13 offset:16896
v_mfma_f32_16x16x32_bf16 v[48:51], a[0:3], a[48:51], v[48:51]
v_mfma_f32_16x16x32_bf16 v[72:75], a[4:7], a[48:51], v[72:75]
v_mfma_f32_16x16x32_bf16 v[96:99], a[8:11], a[48:51], v[96:99]
v_mfma_f32_16x16x32_bf16 v[120:123], a[12:15], a[48:51], v[120:123]
v_mfma_f32_16x16x32_bf16 v[52:55], a[0:3], a[52:55], v[52:55]
v_mfma_f32_16x16x32_bf16 v[76:79], a[4:7], a[52:55], v[76:79]
v_mfma_f32_16x16x32_bf16 v[100:103], a[8:11], a[52:55], v[100:103]
v_mfma_f32_16x16x32_bf16 v[124:127], a[12:15], a[52:55], v[124:127]
s_waitcnt lgkmcnt(0)
v_mfma_f32_16x16x32_bf16 v[32:35], a[56:59], a[16:19], v[32:35]
s_barrier
ds_read_b128 a[0:3], v8 offset:24576
v_mfma_f32_16x16x32_bf16 v[56:59], a[56:59], a[20:23], v[56:59]
ds_read_b64_tr_b16 a[32:33], v14 offset:16384
v_mfma_f32_16x16x32_bf16 v[80:83], a[56:59], a[24:27], v[80:83]
ds_read_b64_tr_b16 a[34:35], v14 offset:16896
v_mfma_f32_16x16x32_bf16 v[104:107], a[56:59], a[28:31], v[104:107]
ds_read_b128 a[4:7], v8 offset:26624
v_mfma_f32_16x16x32_bf16 v[36:39], a[60:63], a[16:19], v[36:39]
ds_read_b128 a[8:11], v8 offset:28672
v_mfma_f32_16x16x32_bf16 v[60:63], a[60:63], a[20:23], v[60:63]
ds_read_b128 a[12:15], v8 offset:30720
v_mfma_f32_16x16x32_bf16 v[84:87], a[60:63], a[24:27], v[84:87]
ds_read_b64_tr_b16 a[36:37], v15 offset:16384
v_mfma_f32_16x16x32_bf16 v[108:111], a[60:63], a[28:31], v[108:111]
ds_read_b64_tr_b16 a[38:39], v15 offset:16896
v_mfma_f32_16x16x32_bf16 v[40:43], a[16:19], a[64:67], v[40:43]
ds_read_b64_tr_b16 a[40:41], v14 offset:18432
v_mfma_f32_16x16x32_bf16 v[64:67], a[20:23], a[64:67], v[64:67]
ds_read_b64_tr_b16 a[42:43], v14 offset:18944
v_mfma_f32_16x16x32_bf16 v[88:91], a[24:27], a[64:67], v[88:91]
ds_read_b64_tr_b16 a[44:45], v15 offset:18432
v_mfma_f32_16x16x32_bf16 v[112:115], a[28:31], a[64:67], v[112:115]
ds_read_b64_tr_b16 a[46:47], v15 offset:18944
v_mfma_f32_16x16x32_bf16 v[44:47], a[16:19], a[68:71], v[44:47]
ds_read_b64_tr_b16 a[48:49], v14 offset:20480
v_mfma_f32_16x16x32_bf16 v[68:71], a[20:23], a[68:71], v[68:71]
ds_read_b64_tr_b16 a[50:51], v14 offset:20992
v_mfma_f32_16x16x32_bf16 v[92:95], a[24:27], a[68:71], v[92:95]
ds_read_b64_tr_b16 a[52:53], v15 offset:20480
v_mfma_f32_16x16x32_bf16 v[116:119], a[28:31], a[68:71], v[116:119]
ds_read_b64_tr_b16 a[54:55], v15 offset:20992
v_mfma_f32_16x16x32_bf16 v[48:51], a[16:19], a[72:75], v[48:51]
v_mfma_f32_16x16x32_bf16 v[72:75], a[20:23], a[72:75], v[72:75]
v_mfma_f32_16x16x32_bf16 v[96:99], a[24:27], a[72:75], v[96:99]
v_mfma_f32_16x16x32_bf16 v[120:123], a[28:31], a[72:75], v[120:123]
v_mfma_f32_16x16x32_bf16 v[52:55], a[16:19], a[76:79], v[52:55]
v_mfma_f32_16x16x32_bf16 v[76:79], a[20:23], a[76:79], v[76:79]
v_mfma_f32_16x16x32_bf16 v[100:103], a[24:27], a[76:79], v[100:103]
v_mfma_f32_16x16x32_bf16 v[124:127], a[28:31], a[76:79], v[124:127]
s_waitcnt lgkmcnt(0)
v_mfma_f32_16x16x32_bf16 v[32:35], a[32:35], a[0:3], v[32:35]
ds_read_b128 a[16:19], v9 offset:24576
v_mfma_f32_16x16x32_bf16 v[56:59], a[32:35], a[4:7], v[56:59]
ds_read_b64_tr_b16 a[56:57], v14 offset:28672
v_mfma_f32_16x16x32_bf16 v[80:83], a[32:35], a[8:11], v[80:83]
ds_read_b64_tr_b16 a[58:59], v14 offset:29184
v_mfma_f32_16x16x32_bf16 v[104:107], a[32:35], a[12:15], v[104:107]
ds_read_b128 a[20:23], v9 offset:26624
v_mfma_f32_16x16x32_bf16 v[36:39], a[36:39], a[0:3], v[36:39]
ds_read_b128 a[24:27], v9 offset:28672
v_mfma_f32_16x16x32_bf16 v[60:63], a[36:39], a[4:7], v[60:63]
ds_read_b128 a[28:31], v9 offset:30720
v_mfma_f32_16x16x32_bf16 v[84:87], a[36:39], a[8:11], v[84:87]
ds_read_b64_tr_b16 a[60:61], v15 offset:28672
v_mfma_f32_16x16x32_bf16 v[108:111], a[36:39], a[12:15], v[108:111]
ds_read_b64_tr_b16 a[62:63], v15 offset:29184
v_mfma_f32_16x16x32_bf16 v[40:43], a[0:3], a[40:43], v[40:43]
ds_read_b64_tr_b16 a[64:65], v14 offset:30720
v_mfma_f32_16x16x32_bf16 v[64:67], a[4:7], a[40:43], v[64:67]
ds_read_b64_tr_b16 a[66:67], v14 offset:31232
v_mfma_f32_16x16x32_bf16 v[88:91], a[8:11], a[40:43], v[88:91]
ds_read_b64_tr_b16 a[68:69], v15 offset:30720
v_mfma_f32_16x16x32_bf16 v[112:115], a[12:15], a[40:43], v[112:115]
ds_read_b64_tr_b16 a[70:71], v15 offset:31232
v_mfma_f32_16x16x32_bf16 v[44:47], a[0:3], a[44:47], v[44:47]
ds_read_b64_tr_b16 a[72:73], v14 offset:32768
v_mfma_f32_16x16x32_bf16 v[68:71], a[4:7], a[44:47], v[68:71]
ds_read_b64_tr_b16 a[74:75], v14 offset:33280
v_mfma_f32_16x16x32_bf16 v[92:95], a[8:11], a[44:47], v[92:95]
ds_read_b64_tr_b16 a[76:77], v15 offset:32768
v_mfma_f32_16x16x32_bf16 v[116:119], a[12:15], a[44:47], v[116:119]
ds_read_b64_tr_b16 a[78:79], v15 offset:33280
v_mfma_f32_16x16x32_bf16 v[48:51], a[0:3], a[48:51], v[48:51]
s_waitcnt vmcnt(0)
v_mfma_f32_16x16x32_bf16 v[72:75], a[4:7], a[48:51], v[72:75]
v_mfma_f32_16x16x32_bf16 v[96:99], a[8:11], a[48:51], v[96:99]
v_mfma_f32_16x16x32_bf16 v[120:123], a[12:15], a[48:51], v[120:123]
v_mfma_f32_16x16x32_bf16 v[52:55], a[0:3], a[52:55], v[52:55]
v_mfma_f32_16x16x32_bf16 v[76:79], a[4:7], a[52:55], v[76:79]
v_mfma_f32_16x16x32_bf16 v[100:103], a[8:11], a[52:55], v[100:103]
v_mfma_f32_16x16x32_bf16 v[124:127], a[12:15], a[52:55], v[124:127]
s_waitcnt lgkmcnt(0)
v_mfma_f32_16x16x32_bf16 v[32:35], a[56:59], a[16:19], v[32:35]
s_barrier
ds_read_b128 a[0:3], v10 offset:57344
v_mfma_f32_16x16x32_bf16 v[56:59], a[56:59], a[20:23], v[56:59]
ds_read_b64_tr_b16 a[32:33], v12 offset:40960
v_mfma_f32_16x16x32_bf16 v[80:83], a[56:59], a[24:27], v[80:83]
ds_read_b64_tr_b16 a[34:35], v12 offset:41472
v_mfma_f32_16x16x32_bf16 v[104:107], a[56:59], a[28:31], v[104:107]
ds_read_b128 a[4:7], v10 offset:59392
v_mfma_f32_16x16x32_bf16 v[36:39], a[60:63], a[16:19], v[36:39]
ds_read_b128 a[8:11], v10 offset:61440
v_mfma_f32_16x16x32_bf16 v[60:63], a[60:63], a[20:23], v[60:63]
ds_read_b128 a[12:15], v10 offset:63488
v_mfma_f32_16x16x32_bf16 v[84:87], a[60:63], a[24:27], v[84:87]
ds_read_b64_tr_b16 a[36:37], v13 offset:40960
v_mfma_f32_16x16x32_bf16 v[108:111], a[60:63], a[28:31], v[108:111]
ds_read_b64_tr_b16 a[38:39], v13 offset:41472
v_mfma_f32_16x16x32_bf16 v[40:43], a[16:19], a[64:67], v[40:43]
ds_read_b64_tr_b16 a[40:41], v12 offset:43008
v_mfma_f32_16x16x32_bf16 v[64:67], a[20:23], a[64:67], v[64:67]
ds_read_b64_tr_b16 a[42:43], v12 offset:43520
v_mfma_f32_16x16x32_bf16 v[88:91], a[24:27], a[64:67], v[88:91]
ds_read_b64_tr_b16 a[44:45], v13 offset:43008
v_mfma_f32_16x16x32_bf16 v[112:115], a[28:31], a[64:67], v[112:115]
ds_read_b64_tr_b16 a[46:47], v13 offset:43520
v_mfma_f32_16x16x32_bf16 v[44:47], a[16:19], a[68:71], v[44:47]
ds_read_b64_tr_b16 a[48:49], v12 offset:45056
v_mfma_f32_16x16x32_bf16 v[68:71], a[20:23], a[68:71], v[68:71]
ds_read_b64_tr_b16 a[50:51], v12 offset:45568
v_mfma_f32_16x16x32_bf16 v[92:95], a[24:27], a[68:71], v[92:95]
ds_read_b64_tr_b16 a[52:53], v13 offset:45056
v_mfma_f32_16x16x32_bf16 v[116:119], a[28:31], a[68:71], v[116:119]
ds_read_b64_tr_b16 a[54:55], v13 offset:45568
v_mfma_f32_16x16x32_bf16 v[48:51], a[16:19], a[72:75], v[48:51]
v_mfma_f32_16x16x32_bf16 v[72:75], a[20:23], a[72:75], v[72:75]
v_mfma_f32_16x16x32_bf16 v[96:99], a[24:27], a[72:75], v[96:99]
v_mfma_f32_16x16x32_bf16 v[120:123], a[28:31], a[72:75], v[120:123]
v_mfma_f32_16x16x32_bf16 v[52:55], a[16:19], a[76:79], v[52:55]
v_mfma_f32_16x16x32_bf16 v[76:79], a[20:23], a[76:79], v[76:79]
v_mfma_f32_16x16x32_bf16 v[100:103], a[24:27], a[76:79], v[100:103]
v_mfma_f32_16x16x32_bf16 v[124:127], a[28:31], a[76:79], v[124:127]
s_waitcnt lgkmcnt(0)
v_mfma_f32_16x16x32_bf16 v[32:35], a[32:35], a[0:3], v[32:35]
ds_read_b128 a[16:19], v11 offset:57344
v_mfma_f32_16x16x32_bf16 v[56:59], a[32:35], a[4:7], v[56:59]
ds_read_b64_tr_b16 a[56:57], v12 offset:53248
v_mfma_f32_16x16x32_bf16 v[80:83], a[32:35], a[8:11], v[80:83]
ds_read_b64_tr_b16 a[58:59], v12 offset:53760
v_mfma_f32_16x16x32_bf16 v[104:107], a[32:35], a[12:15], v[104:107]
ds_read_b128 a[20:23], v11 offset:59392
v_mfma_f32_16x16x32_bf16 v[36:39], a[36:39], a[0:3], v[36:39]
ds_read_b128 a[24:27], v11 offset:61440
v_mfma_f32_16x16x32_bf16 v[60:63], a[36:39], a[4:7], v[60:63]
ds_read_b128 a[28:31], v11 offset:63488
v_mfma_f32_16x16x32_bf16 v[84:87], a[36:39], a[8:11], v[84:87]
ds_read_b64_tr_b16 a[60:61], v13 offset:53248
v_mfma_f32_16x16x32_bf16 v[108:111], a[36:39], a[12:15], v[108:111]
ds_read_b64_tr_b16 a[62:63], v13 offset:53760
v_mfma_f32_16x16x32_bf16 v[40:43], a[0:3], a[40:43], v[40:43]
ds_read_b64_tr_b16 a[64:65], v12 offset:55296
v_mfma_f32_16x16x32_bf16 v[64:67], a[4:7], a[40:43], v[64:67]
ds_read_b64_tr_b16 a[66:67], v12 offset:55808
v_mfma_f32_16x16x32_bf16 v[88:91], a[8:11], a[40:43], v[88:91]
ds_read_b64_tr_b16 a[68:69], v13 offset:55296
v_mfma_f32_16x16x32_bf16 v[112:115], a[12:15], a[40:43], v[112:115]
ds_read_b64_tr_b16 a[70:71], v13 offset:55808
v_mfma_f32_16x16x32_bf16 v[44:47], a[0:3], a[44:47], v[44:47]
ds_read_b64_tr_b16 a[72:73], v12 offset:57344
v_mfma_f32_16x16x32_bf16 v[68:71], a[4:7], a[44:47], v[68:71]
ds_read_b64_tr_b16 a[74:75], v12 offset:57856
v_mfma_f32_16x16x32_bf16 v[92:95], a[8:11], a[44:47], v[92:95]
ds_read_b64_tr_b16 a[76:77], v13 offset:57344
v_mfma_f32_16x16x32_bf16 v[116:119], a[12:15], a[44:47], v[116:119]
ds_read_b64_tr_b16 a[78:79], v13 offset:57856
v_mfma_f32_16x16x32_bf16 v[48:51], a[0:3], a[48:51], v[48:51]
v_mfma_f32_16x16x32_bf16 v[72:75], a[4:7], a[48:51], v[72:75]
v_mfma_f32_16x16x32_bf16 v[96:99], a[8:11], a[48:51], v[96:99]
v_mfma_f32_16x16x32_bf16 v[120:123], a[12:15], a[48:51], v[120:123]
v_mfma_f32_16x16x32_bf16 v[52:55], a[0:3], a[52:55], v[52:55]
v_mfma_f32_16x16x32_bf16 v[76:79], a[4:7], a[52:55], v[76:79]
v_mfma_f32_16x16x32_bf16 v[100:103], a[8:11], a[52:55], v[100:103]
v_mfma_f32_16x16x32_bf16 v[124:127], a[12:15], a[52:55], v[124:127]
s_waitcnt lgkmcnt(0)
v_mfma_f32_16x16x32_bf16 v[32:35], a[56:59], a[16:19], v[32:35]
s_barrier
ds_read_b128 a[0:3], v10 offset:40960
v_mfma_f32_16x16x32_bf16 v[56:59], a[56:59], a[20:23], v[56:59]
ds_read_b64_tr_b16 a[32:33], v12 offset:0
v_mfma_f32_16x16x32_bf16 v[80:83], a[56:59], a[24:27], v[80:83]
ds_read_b64_tr_b16 a[34:35], v12 offset:512
v_mfma_f32_16x16x32_bf16 v[104:107], a[56:59], a[28:31], v[104:107]
ds_read_b128 a[4:7], v10 offset:43008
v_mfma_f32_16x16x32_bf16 v[36:39], a[60:63], a[16:19], v[36:39]
ds_read_b128 a[8:11], v10 offset:45056
v_mfma_f32_16x16x32_bf16 v[60:63], a[60:63], a[20:23], v[60:63]
ds_read_b128 a[12:15], v10 offset:47104
v_mfma_f32_16x16x32_bf16 v[84:87], a[60:63], a[24:27], v[84:87]
ds_read_b64_tr_b16 a[36:37], v13 offset:0
v_mfma_f32_16x16x32_bf16 v[108:111], a[60:63], a[28:31], v[108:111]
ds_read_b64_tr_b16 a[38:39], v13 offset:512
v_mfma_f32_16x16x32_bf16 v[40:43], a[16:19], a[64:67], v[40:43]
ds_read_b64_tr_b16 a[40:41], v12 offset:2048
v_mfma_f32_16x16x32_bf16 v[64:67], a[20:23], a[64:67], v[64:67]
ds_read_b64_tr_b16 a[42:43], v12 offset:2560
v_mfma_f32_16x16x32_bf16 v[88:91], a[24:27], a[64:67], v[88:91]
ds_read_b64_tr_b16 a[44:45], v13 offset:2048
v_mfma_f32_16x16x32_bf16 v[112:115], a[28:31], a[64:67], v[112:115]
ds_read_b64_tr_b16 a[46:47], v13 offset:2560
v_mfma_f32_16x16x32_bf16 v[44:47], a[16:19], a[68:71], v[44:47]
ds_read_b64_tr_b16 a[48:49], v12 offset:4096
v_mfma_f32_16x16x32_bf16 v[68:71], a[20:23], a[68:71], v[68:71]
ds_read_b64_tr_b16 a[50:51], v12 offset:4608
v_mfma_f32_16x16x32_bf16 v[92:95], a[24:27], a[68:71], v[92:95]
ds_read_b64_tr_b16 a[52:53], v13 offset:4096
v_mfma_f32_16x16x32_bf16 v[116:119], a[28:31], a[68:71], v[116:119]
ds_read_b64_tr_b16 a[54:55], v13 offset:4608
v_mfma_f32_16x16x32_bf16 v[48:51], a[16:19], a[72:75], v[48:51]
v_mfma_f32_16x16x32_bf16 v[72:75], a[20:23], a[72:75], v[72:75]
v_mfma_f32_16x16x32_bf16 v[96:99], a[24:27], a[72:75], v[96:99]
v_mfma_f32_16x16x32_bf16 v[120:123], a[28:31], a[72:75], v[120:123]
v_mfma_f32_16x16x32_bf16 v[52:55], a[16:19], a[76:79], v[52:55]
v_mfma_f32_16x16x32_bf16 v[76:79], a[20:23], a[76:79], v[76:79]
v_mfma_f32_16x16x32_bf16 v[100:103], a[24:27], a[76:79], v[100:103]
v_mfma_f32_16x16x32_bf16 v[124:127], a[28:31], a[76:79], v[124:127]
s_waitcnt lgkmcnt(0)
v_mfma_f32_16x16x32_bf16 v[32:35], a[32:35], a[0:3], v[32:35]
ds_read_b128 a[16:19], v11 offset:40960
v_mfma_f32_16x16x32_bf16 v[56:59], a[32:35], a[4:7], v[56:59]
ds_read_b64_tr_b16 a[56:57], v12 offset:12288
v_mfma_f32_16x16x32_bf16 v[80:83], a[32:35], a[8:11], v[80:83]
ds_read_b64_tr_b16 a[58:59], v12 offset:12800
v_mfma_f32_16x16x32_bf16 v[104:107], a[32:35], a[12:15], v[104:107]
ds_read_b128 a[20:23], v11 offset:43008
v_mfma_f32_16x16x32_bf16 v[36:39], a[36:39], a[0:3], v[36:39]
ds_read_b128 a[24:27], v11 offset:45056
v_mfma_f32_16x16x32_bf16 v[60:63], a[36:39], a[4:7], v[60:63]
ds_read_b128 a[28:31], v11 offset:47104
v_mfma_f32_16x16x32_bf16 v[84:87], a[36:39], a[8:11], v[84:87]
ds_read_b64_tr_b16 a[60:61], v13 offset:12288
v_mfma_f32_16x16x32_bf16 v[108:111], a[36:39], a[12:15], v[108:111]
ds_read_b64_tr_b16 a[62:63], v13 offset:12800
v_mfma_f32_16x16x32_bf16 v[40:43], a[0:3], a[40:43], v[40:43]
ds_read_b64_tr_b16 a[64:65], v12 offset:14336
v_mfma_f32_16x16x32_bf16 v[64:67], a[4:7], a[40:43], v[64:67]
ds_read_b64_tr_b16 a[66:67], v12 offset:14848
v_mfma_f32_16x16x32_bf16 v[88:91], a[8:11], a[40:43], v[88:91]
ds_read_b64_tr_b16 a[68:69], v13 offset:14336
v_mfma_f32_16x16x32_bf16 v[112:115], a[12:15], a[40:43], v[112:115]
ds_read_b64_tr_b16 a[70:71], v13 offset:14848
v_mfma_f32_16x16x32_bf16 v[44:47], a[0:3], a[44:47], v[44:47]
ds_read_b64_tr_b16 a[72:73], v12 offset:16384
v_mfma_f32_16x16x32_bf16 v[68:71], a[4:7], a[44:47], v[68:71]
ds_read_b64_tr_b16 a[74:75], v12 offset:16896
v_mfma_f32_16x16x32_bf16 v[92:95], a[8:11], a[44:47], v[92:95]
ds_read_b64_tr_b16 a[76:77], v13 offset:16384
v_mfma_f32_16x16x32_bf16 v[116:119], a[12:15], a[44:47], v[116:119]
ds_read_b64_tr_b16 a[78:79], v13 offset:16896
v_mfma_f32_16x16x32_bf16 v[48:51], a[0:3], a[48:51], v[48:51]
v_mfma_f32_16x16x32_bf16 v[72:75], a[4:7], a[48:51], v[72:75]
v_mfma_f32_16x16x32_bf16 v[96:99], a[8:11], a[48:51], v[96:99]
v_mfma_f32_16x16x32_bf16 v[120:123], a[12:15], a[48:51], v[120:123]
v_mfma_f32_16x16x32_bf16 v[52:55], a[0:3], a[52:55], v[52:55]
v_mfma_f32_16x16x32_bf16 v[76:79], a[4:7], a[52:55], v[76:79]
v_mfma_f32_16x16x32_bf16 v[100:103], a[8:11], a[52:55], v[100:103]
v_mfma_f32_16x16x32_bf16 v[124:127], a[12:15], a[52:55], v[124:127]
s_waitcnt lgkmcnt(0)
v_mfma_f32_16x16x32_bf16 v[32:35], a[56:59], a[16:19], v[32:35]
s_barrier
ds_read_b128 a[0:3], v10 offset:0
v_mfma_f32_16x16x32_bf16 v[56:59], a[56:59], a[20:23], v[56:59]
ds_read_b64_tr_b16 a[32:33], v14 offset:16384
v_mfma_f32_16x16x32_bf16 v[80:83], a[56:59], a[24:27], v[80:83]
ds_read_b64_tr_b16 a[34:35], v14 offset:16896
v_mfma_f32_16x16x32_bf16 v[104:107], a[56:59], a[28:31], v[104:107]
ds_read_b128 a[4:7], v10 offset:2048
v_mfma_f32_16x16x32_bf16 v[36:39], a[60:63], a[16:19], v[36:39]
s_branch L_over4
L_pad4:
s_branch L_ret4
L_over4:
ds_read_b128 a[8:11], v10 offset:4096
v_mfma_f32_16x16x32_bf16 v[60:63], a[60:63], a[20:23], v[60:63]
ds_read_b128 a[12:15], v10 offset:6144
v_mfma_f32_16x16x32_bf16 v[84:87], a[60:63], a[24:27], v[84:87]
ds_read_b64_tr_b16 a[36:37], v15 offset:16384
v_mfma_f32_16x16x32_bf16 v[108:111], a[60:63], a[28:31], v[108:111]
ds_read_b64_tr_b16 a[38:39], v15 offset:16896
v_mfma_f32_16x16x32_bf16 v[40:43], a[16:19], a[64:67], v[40:43]
ds_read_b64_tr_b16 a[40:41], v14 offset:18432
v_mfma_f32_16x16x32_bf16 v[64:67], a[20:23], a[64:67], v[64:67]
ds_read_b64_tr_b16 a[42:43], v14 offset:18944
v_mfma_f32_16x16x32_bf16 v[88:91], a[24:27], a[64:67], v[88:91]
ds_read_b64_tr_b16 a[44:45], v15 offset:18432
v_mfma_f32_16x16x32_bf16 v[112:115], a[28:31], a[64:67], v[112:115]
ds_read_b64_tr_b16 a[46:47], v15 offset:18944
v_mfma_f32_16x16x32_bf16 v[44:47], a[16:19], a[68:71], v[44:47]
ds_read_b64_tr_b16 a[48:49], v14 offset:20480
v_mfma_f32_16x16x32_bf16 v[68:71], a[20:23], a[68:71], v[68:71]
ds_read_b64_tr_b16 a[50:51], v14 offset:20992
v_mfma_f32_16x16x32_bf16 v[92:95], a[24:27], a[68:71], v[92:95]
ds_read_b64_tr_b16 a[52:53], v15 offset:20480
v_mfma_f32_16x16x32_bf16 v[116:119], a[28:31], a[68:71], v[116:119]
ds_read_b64_tr_b16 a[54:55], v15 offset:20992
v_mfma_f32_16x16x32_bf16 v[48:51], a[16:19], a[72:75], v[48:51]
v_mfma_f32_16x16x32_bf16 v[72:75], a[20:23], a[72:75], v[72:75]
v_mfma_f32_16x16x32_bf16 v[96:99], a[24:27], a[72:75], v[96:99]
v_mfma_f32_16x16x32_bf16 v[120:123], a[28:31], a[72:75], v[120:123]
v_mfma_f32_16x16x32_bf16 v[52:55], a[16:19], a[76:79], v[52:55]
v_mfma_f32_16x16x32_bf16 v[76:79], a[20:23], a[76:79], v[76:79]
v_mfma_f32_16x16x32_bf16 v[100:103], a[24:27], a[76:79], v[100:103]
v_mfma_f32_16x16x32_bf16 v[124:127], a[28:31], a[76:79], v[124:127]
s_waitcnt lgkmcnt(0)
v_mfma_f32_16x16x32_bf16 v[32:35], a[32:35], a[0:3], v[32:35]
ds_read_b128 a[16:19], v11 offset:0
v_mfma_f32_16x16x32_bf16 v[56:59], a[32:35], a[4:7], v[56:59]
ds_read_b64_tr_b16 a[56:57], v14 offset:28672
v_mfma_f32_16x16x32_bf16 v[80:83], a[32:35], a[8:11], v[80:83]
ds_read_b64_tr_b16 a[58:59], v14 offset:29184
v_mfma_f32_16x16x32_bf16 v[104:107], a[32:35], a[12:15], v[104:107]
ds_read_b128 a[20:23], v11 offset:2048
v_mfma_f32_16x16x32_bf16 v[36:39], a[36:39], a[0:3], v[36:39]
ds_read_b128 a[24:27], v11 offset:4096
v_mfma_f32_16x16x32_bf16 v[60:63], a[36:39], a[4:7], v[60:63]
ds_read_b128 a[28:31], v11 offset:6144
v_mfma_f32_16x16x32_bf16 v[84:87], a[36:39], a[8:11], v[84:87]
ds_read_b64_tr_b16 a[60:61], v15 offset:28672
v_mfma_f32_16x16x32_bf16 v[108:111], a[36:39], a[12:15], v[108:111]
ds_read_b64_tr_b16 a[62:63], v15 offset:29184
v_mfma_f32_16x16x32_bf16 v[40:43], a[0:3], a[40:43], v[40:43]
ds_read_b64_tr_b16 a[64:65], v14 offset:30720
v_mfma_f32_16x16x32_bf16 v[64:67], a[4:7], a[40:43], v[64:67]
ds_read_b64_tr_b16 a[66:67], v14 offset:31232
v_mfma_f32_16x16x32_bf16 v[88:91], a[8:11], a[40:43], v[88:91]
ds_read_b64_tr_b16 a[68:69], v15 offset:30720
v_mfma_f32_16x16x32_bf16 v[112:115], a[12:15], a[40:43], v[112:115]
ds_read_b64_tr_b16 a[70:71], v15 offset:31232
v_mfma_f32_16x16x32_bf16 v[44:47], a[0:3], a[44:47], v[44:47]
ds_read_b64_tr_b16 a[72:73], v14 offset:32768
v_mfma_f32_16x16x32_bf16 v[68:71], a[4:7], a[44:47], v[68:71]
ds_read_b64_tr_b16 a[74:75], v14 offset:33280
v_mfma_f32_16x16x32_bf16 v[92:95], a[8:11], a[44:47], v[92:95]
ds_read_b64_tr_b16 a[76:77], v15 offset:32768
v_mfma_f32_16x16x32_bf16 v[116:119], a[12:15], a[44:47], v[116:119]
ds_read_b64_tr_b16 a[78:79], v15 offset:33280
v_mfma_f32_16x16x32_bf16 v[48:51], a[0:3], a[48:51], v[48:51]
v_mfma_f32_16x16x32_bf16 v[72:75], a[4:7], a[48:51], v[72:75]
v_mfma_f32_16x16x32_bf16 v[96:99], a[8:11], a[48:51], v[96:99]
v_mfma_f32_16x16x32_bf16 v[120:123], a[12:15], a[48:51], v[120:123]
v_mfma_f32_16x16x32_bf16 v[52:55], a[0:3], a[52:55], v[52:55]
v_mfma_f32_16x16x32_bf16 v[76:79], a[4:7], a[52:55], v[76:79]
v_mfma_f32_16x16x32_bf16 v[100:103], a[8:11], a[52:55], v[100:103]
v_mfma_f32_16x16x32_bf16 v[124:127], a[12:15], a[52:55], v[124:127]
s_waitcnt lgkmcnt(0)
v_mfma_f32_16x16x32_bf16 v[32:35], a[56:59], a[16:19], v[32:35]
s_barrier
ds_read_b128 a[0:3], v8 offset:24576
v_mfma_f32_16x16x32_bf16 v[56:59], a[56:59], a[20:23], v[56:59]
ds_read_b64_tr_b16 a[32:33], v12 offset:40960
v_mfma_f32_16x16x32_bf16 v[80:83], a[56:59], a[24:27], v[80:83]
ds_read_b64_tr_b16 a[34:35], v12 offset:41472
v_mfma_f32_16x16x32_bf16 v[104:107], a[56:59], a[28:31], v[104:107]
ds_read_b128 a[4:7], v8 offset:26624
v_mfma_f32_16x16x32_bf16 v[36:39], a[60:63], a[16:19], v[36:39]
ds_read_b128 a[8:11], v8 offset:28672
v_mfma_f32_16x16x32_bf16 v[60:63], a[60:63], a[20:23], v[60:63]
ds_read_b128 a[12:15], v8 offset:30720
v_mfma_f32_16x16x32_bf16 v[84:87], a[60:63], a[24:27], v[84:87]
ds_read_b64_tr_b16 a[36:37], v13 offset:40960
v_mfma_f32_16x16x32_bf16 v[108:111], a[60:63], a[28:31], v[108:111]
ds_read_b64_tr_b16 a[38:39], v13 offset:41472
v_mfma_f32_16x16x32_bf16 v[40:43], a[16:19], a[64:67], v[40:43]
ds_read_b64_tr_b16 a[40:41], v12 offset:43008
v_mfma_f32_16x16x32_bf16 v[64:67], a[20:23], a[64:67], v[64:67]
ds_read_b64_tr_b16 a[42:43], v12 offset:43520
v_mfma_f32_16x16x32_bf16 v[88:91], a[24:27], a[64:67], v[88:91]
ds_read_b64_tr_b16 a[44:45], v13 offset:43008
v_mfma_f32_16x16x32_bf16 v[112:115], a[28:31], a[64:67], v[112:115]
ds_read_b64_tr_b16 a[46:47], v13 offset:43520
v_mfma_f32_16x16x32_bf16 v[44:47], a[16:19], a[68:71], v[44:47]
ds_read_b64_tr_b16 a[48:49], v12 offset:45056
v_mfma_f32_16x16x32_bf16 v[68:71], a[20:23], a[68:71], v[68:71]
ds_read_b64_tr_b16 a[50:51], v12 offset:45568
v_mfma_f32_16x16x32_bf16 v[92:95], a[24:27], a[68:71], v[92:95]
ds_read_b64_tr_b16 a[52:53], v13 offset:45056
v_mfma_f32_16x16x32_bf16 v[116:119], a[28:31], a[68:71], v[116:119]
ds_read_b64_tr_b16 a[54:55], v13 offset:45568
v_mfma_f32_16x16x32_bf16 v[48:51], a[16:19], a[72:75], v[48:51]
v_mfma_f32_16x16x32_bf16 v[72:75], a[20:23], a[72:75], v[72:75]
v_mfma_f32_16x16x32_bf16 v[96:99], a[24:27], a[72:75], v[96:99]
v_mfma_f32_16x16x32_bf16 v[120:123], a[28:31], a[72:75], v[120:123]
v_mfma_f32_16x16x32_bf16 v[52:55], a[16:19], a[76:79], v[52:55]
v_mfma_f32_16x16x32_bf16 v[76:79], a[20:23], a[76:79], v[76:79]
v_mfma_f32_16x16x32_bf16 v[100:103], a[24:27], a[76:79], v[100:103]
v_mfma_f32_16x16x32_bf16 v[124:127], a[28:31], a[76:79], v[124:127]
s_waitcnt lgkmcnt(0)
v_mfma_f32_16x16x32_bf16 v[32:35], a[32:35], a[0:3], v[32:35]
ds_read_b128 a[16:19], v9 offset:24576
v_mfma_f32_16x16x32_bf16 v[56:59], a[32:35], a[4:7], v[56:59]
ds_read_b64_tr_b16 a[56:57], v12 offset:53248
v_mfma_f32_16x16x32_bf16 v[80:83], a[32:35], a[8:11], v[80:83]
ds_read_b64_tr_b16 a[58:59], v12 offset:53760
v_mfma_f32_16x16x32_bf16 v[104:107], a[32:35], a[12:15], v[104:107]
ds_read_b128 a[20:23], v9 offset:26624
v_mfma_f32_16x16x32_bf16 v[36:39], a[36:39], a[0:3], v[36:39]
ds_read_b128 a[24:27], v9 offset:28672
v_mfma_f32_16x16x32_bf16 v[60:63], a[36:39], a[4:7], v[60:63]
ds_read_b128 a[28:31], v9 offset:30720
v_mfma_f32_16x16x32_bf16 v[84:87], a[36:39], a[8:11], v[84:87]
ds_read_b64_tr_b16 a[60:61], v13 offset:53248
v_mfma_f32_16x16x32_bf16 v[108:111], a[36:39], a[12:15], v[108:111]
ds_read_b64_tr_b16 a[62:63], v13 offset:53760
v_mfma_f32_16x16x32_bf16 v[40:43], a[0:3], a[40:43], v[40:43]
ds_read_b64_tr_b16 a[64:65], v12 offset:55296
v_mfma_f32_16x16x32_bf16 v[64:67], a[4:7], a[40:43], v[64:67]
ds_read_b64_tr_b16 a[66:67], v12 offset:55808
v_mfma_f32_16x16x32_bf16 v[88:91], a[8:11], a[40:43], v[88:91]
ds_read_b64_tr_b16 a[68:69], v13 offset:55296
v_mfma_f32_16x16x32_bf16 v[112:115], a[12:15], a[40:43], v[112:115]
ds_read_b64_tr_b16 a[70:71], v13 offset:55808
v_mfma_f32_16x16x32_bf16 v[44:47], a[0:3], a[44:47], v[44:47]
ds_read_b64_tr_b16 a[72:73], v12 offset:57344
v_mfma_f32_16x16x32_bf16 v[68:71], a[4:7], a[44:47], v[68:71]
ds_read_b64_tr_b16 a[74:75], v12 offset:57856
v_mfma_f32_16x16x32_bf16 v[92:95], a[8:11], a[44:47], v[92:95]
ds_read_b64_tr_b16 a[76:77], v13 offset:57344
v_mfma_f32_16x16x32_bf16 v[116:119], a[12:15], a[44:47], v[116:119]
ds_read_b64_tr_b16 a[78:79], v13 offset:57856
v_mfma_f32_16x16x32_bf16 v[48:51], a[0:3], a[48:51], v[48:51]
v_mfma_f32_16x16x32_bf16 v[72:75], a[4:7], a[48:51], v[72:75]
v_mfma_f32_16x16x32_bf16 v[96:99], a[8:11], a[48:51], v[96:99]
v_mfma_f32_16x16x32_bf16 v[120:123], a[12:15], a[48:51], v[120:123]
v_mfma_f32_16x16x32_bf16 v[52:55], a[0:3], a[52:55], v[52:55]
v_mfma_f32_16x16x32_bf16 v[76:79], a[4:7], a[52:55], v[76:79]
v_mfma_f32_16x16x32_bf16 v[100:103], a[8:11], a[52:55], v[100:103]
v_mfma_f32_16x16x32_bf16 v[124:127], a[12:15], a[52:55], v[124:127]
s_waitcnt lgkmcnt(0)
v_mfma_f32_16x16x32_bf16 v[32:35], a[56:59], a[16:19], v[32:35]
s_barrier
ds_read_b128 a[0:3], v10 offset:57344
v_mfma_f32_16x16x32_bf16 v[56:59], a[56:59], a[20:23], v[56:59]
ds_read_b64_tr_b16 a[32:33], v12 offset:0
v_mfma_f32_16x16x32_bf16 v[80:83], a[56:59], a[24:27], v[80:83]
ds_read_b64_tr_b16 a[34:35], v12 offset:512
v_mfma_f32_16x16x32_bf16 v[104:107], a[56:59], a[28:31], v[104:107]
ds_read_b128 a[4:7], v10 offset:59392
v_mfma_f32_16x16x32_bf16 v[36:39], a[60:63], a[16:19], v[36:39]
ds_read_b128 a[8:11], v10 offset:61440
v_mfma_f32_16x16x32_bf16 v[60:63], a[60:63], a[20:23], v[60:63]
ds_read_b128 a[12:15], v10 offset:63488
v_mfma_f32_16x16x32_bf16 v[84:87], a[60:63], a[24:27], v[84:87]
ds_read_b64_tr_b16 a[36:37], v13 offset:0
v_mfma_f32_16x16x32_bf16 v[108:111], a[60:63], a[28:31], v[108:111]
ds_read_b64_tr_b16 a[38:39], v13 offset:512
v_mfma_f32_16x16x32_bf16 v[40:43], a[16:19], a[64:67], v[40:43]
ds_read_b64_tr_b16 a[40:41], v12 offset:2048
v_mfma_f32_16x16x32_bf16 v[64:67], a[20:23], a[64:67], v[64:67]
ds_read_b64_tr_b16 a[42:43], v12 offset:2560
v_mfma_f32_16x16x32_bf16 v[88:91], a[24:27], a[64:67], v[88:91]
ds_read_b64_tr_b16 a[44:45], v13 offset:2048
v_mfma_f32_16x16x32_bf16 v[112:115], a[28:31], a[64:67], v[112:115]
ds_read_b64_tr_b16 a[46:47], v13 offset:2560
v_mfma_f32_16x16x32_bf16 v[44:47], a[16:19], a[68:71], v[44:47]
ds_read_b64_tr_b16 a[48:49], v12 offset:4096
v_mfma_f32_16x16x32_bf16 v[68:71], a[20:23], a[68:71], v[68:71]
ds_read_b64_tr_b16 a[50:51], v12 offset:4608
v_mfma_f32_16x16x32_bf16 v[92:95], a[24:27], a[68:71], v[92:95]
ds_read_b64_tr_b16 a[52:53], v13 offset:4096
v_mfma_f32_16x16x32_bf16 v[116:119], a[28:31], a[68:71], v[116:119]
ds_read_b64_tr_b16 a[54:55], v13 offset:4608
v_mfma_f32_16x16x32_bf16 v[48:51], a[16:19], a[72:75], v[48:51]
v_mfma_f32_16x16x32_bf16 v[72:75], a[20:23], a[72:75], v[72:75]
v_mfma_f32_16x16x32_bf16 v[96:99], a[24:27], a[72:75], v[96:99]
v_mfma_f32_16x16x32_bf16 v[120:123], a[28:31], a[72:75], v[120:123]
v_mfma_f32_16x16x32_bf16 v[52:55], a[16:19], a[76:79], v[52:55]
v_mfma_f32_16x16x32_bf16 v[76:79], a[20:23], a[76:79], v[76:79]
v_mfma_f32_16x16x32_bf16 v[100:103], a[24:27], a[76:79], v[100:103]
v_mfma_f32_16x16x32_bf16 v[124:127], a[28:31], a[76:79], v[124:127]
s_waitcnt lgkmcnt(0)
v_mfma_f32_16x16x32_bf16 v[32:35], a[32:35], a[0:3], v[32:35]
ds_read_b128 a[16:19], v11 offset:57344
v_mfma_f32_16x16x32_bf16 v[56:59], a[32:35], a[4:7], v[56:59]
ds_read_b64_tr_b16 a[56:57], v12 offset:12288
v_mfma_f32_16x16x32_bf16 v[80:83], a[32:35], a[8:11], v[80:83]
ds_read_b64_tr_b16 a[58:59], v12 offset:12800
v_mfma_f32_16x16x32_bf16 v[104:107], a[32:35], a[12:15], v[104:107]
ds_read_b128 a[20:23], v11 offset:59392
v_mfma_f32_16x16x32_bf16 v[36:39], a[36:39], a[0:3], v[36:39]
ds_read_b128 a[24:27], v11 offset:61440
v_mfma_f32_16x16x32_bf16 v[60:63], a[36:39], a[4:7], v[60:63]
ds_read_b128 a[28:31], v11 offset:63488
v_mfma_f32_16x16x32_bf16 v[84:87], a[36:39], a[8:11], v[84:87]
ds_read_b64_tr_b16 a[60:61], v13 offset:12288
v_mfma_f32_16x16x32_bf16 v[108:111], a[36:39], a[12:15], v[108:111]
ds_read_b64_tr_b16 a[62:63], v13 offset:12800
v_mfma_f32_16x16x32_bf16 v[40:43], a[0:3], a[40:43], v[40:43]
ds_read_b64_tr_b16 a[64:65], v12 offset:14336
v_mfma_f32_16x16x32_bf16 v[64:67], a[4:7], a[40:43], v[64:67]
ds_read_b64_tr_b16 a[66:67], v12 offset:14848
v_mfma_f32_16x16x32_bf16 v[88:91], a[8:11], a[40:43], v[88:91]
ds_read_b64_tr_b16 a[68:69], v13 offset:14336
v_mfma_f32_16x16x32_bf16 v[112:115], a[12:15], a[40:43], v[112:115]
ds_read_b64_tr_b16 a[70:71], v13 offset:14848
v_mfma_f32_16x16x32_bf16 v[44:47], a[0:3], a[44:47], v[44:47]
ds_read_b64_tr_b16 a[72:73], v12 offset:16384
v_mfma_f32_16x16x32_bf16 v[68:71], a[4:7], a[44:47], v[68:71]
ds_read_b64_tr_b16 a[74:75], v12 offset:16896
v_mfma_f32_16x16x32_bf16 v[92:95], a[8:11], a[44:47], v[92:95]
ds_read_b64_tr_b16 a[76:77], v13 offset:16384
v_mfma_f32_16x16x32_bf16 v[116:119], a[12:15], a[44:47], v[116:119]
ds_read_b64_tr_b16 a[78:79], v13 offset:16896
v_mfma_f32_16x16x32_bf16 v[48:51], a[0:3], a[48:51], v[48:51]
v_mfma_f32_16x16x32_bf16 v[72:75], a[4:7], a[48:51], v[72:75]
v_mfma_f32_16x16x32_bf16 v[96:99], a[8:11], a[48:51], v[96:99]
v_mfma_f32_16x16x32_bf16 v[120:123], a[12:15], a[48:51], v[120:123]
v_mfma_f32_16x16x32_bf16 v[52:55], a[0:3], a[52:55], v[52:55]
v_mfma_f32_16x16x32_bf16 v[76:79], a[4:7], a[52:55], v[76:79]
v_mfma_f32_16x16x32_bf16 v[100:103], a[8:11], a[52:55], v[100:103]
v_mfma_f32_16x16x32_bf16 v[124:127], a[12:15], a[52:55], v[124:127]
s_waitcnt lgkmcnt(0)
v_mfma_f32_16x16x32_bf16 v[32:35], a[56:59], a[16:19], v[32:35]
s_barrier
ds_read_b128 a[0:3], v10 offset:40960
v_mfma_f32_16x16x32_bf16 v[56:59], a[56:59], a[20:23], v[56:59]
ds_read_b64_tr_b16 a[32:33], v14 offset:16384
v_mfma_f32_16x16x32_bf16 v[80:83], a[56:59], a[24:27], v[80:83]
ds_read_b64_tr_b16 a[34:35], v14 offset:16896
v_mfma_f32_16x16x32_bf16 v[104:107], a[56:59], a[28:31], v[104:107]
ds_read_b128 a[4:7], v10 offset:43008
v_mfma_f32_16x16x32_bf16 v[36:39], a[60:63], a[16:19], v[36:39]
ds_read_b128 a[8:11], v10 offset:45056
v_mfma_f32_16x16x32_bf16 v[60:63], a[60:63], a[20:23], v[60:63]
ds_read_b128 a[12:15], v10 offset:47104
v_mfma_f32_16x16x32_bf16 v[84:87], a[60:63], a[24:27], v[84:87]
ds_read_b64_tr_b16 a[36:37], v15 offset:16384
v_mfma_f32_16x16x32_bf16 v[108:111], a[60:63], a[28:31], v[108:111]
ds_read_b64_tr_b16 a[38:39], v15 offset:16896
v_mfma_f32_16x16x32_bf16 v[40:43], a[16:19], a[64:67], v[40:43]
ds_read_b64_tr_b16 a[40:41], v14 offset:18432
v_mfma_f32_16x16x32_bf16 v[64:67], a[20:23], a[64:67], v[64:67]
ds_read_b64_tr_b16 a[42:43], v14 offset:18944
v_mfma_f32_16x16x32_bf16 v[88:91], a[24:27], a[64:67], v[88:91]
ds_read_b64_tr_b16 a[44:45], v15 offset:18432
v_mfma_f32_16x16x32_bf16 v[112:115], a[28:31], a[64:67], v[112:115]
ds_read_b64_tr_b16 a[46:47], v15 offset:18944
v_mfma_f32_16x16x32_bf16 v[44:47], a[16:19], a[68:71], v[44:47]
ds_read_b64_tr_b16 a[48:49], v14 offset:20480
v_mfma_f32_16x16x32_bf16 v[68:71], a[20:23], a[68:71], v[68:71]
ds_read_b64_tr_b16 a[50:51], v14 offset:20992
v_mfma_f32_16x16x32_bf16 v[92:95], a[24:27], a[68:71], v[92:95]
ds_read_b64_tr_b16 a[52:53], v15 offset:20480
v_mfma_f32_16x16x32_bf16 v[116:119], a[28:31], a[68:71], v[116:119]
ds_read_b64_tr_b16 a[54:55], v15 offset:20992
v_mfma_f32_16x16x32_bf16 v[48:51], a[16:19], a[72:75], v[48:51]
v_mfma_f32_16x16x32_bf16 v[72:75], a[20:23], a[72:75], v[72:75]
v_mfma_f32_16x16x32_bf16 v[96:99], a[24:27], a[72:75], v[96:99]
v_mfma_f32_16x16x32_bf16 v[120:123], a[28:31], a[72:75], v[120:123]
v_mfma_f32_16x16x32_bf16 v[52:55], a[16:19], a[76:79], v[52:55]
v_mfma_f32_16x16x32_bf16 v[76:79], a[20:23], a[76:79], v[76:79]
v_mfma_f32_16x16x32_bf16 v[100:103], a[24:27], a[76:79], v[100:103]
v_mfma_f32_16x16x32_bf16 v[124:127], a[28:31], a[76:79], v[124:127]
s_waitcnt lgkmcnt(0)
v_mfma_f32_16x16x32_bf16 v[32:35], a[32:35], a[0:3], v[32:35]
ds_read_b128 a[16:19], v11 offset:40960
v_mfma_f32_16x16x32_bf16 v[56:59], a[32:35], a[4:7], v[56:59]
ds_read_b64_tr_b16 a[56:57], v14 offset:28672
v_mfma_f32_16x16x32_bf16 v[80:83], a[32:35], a[8:11], v[80:83]
ds_read_b64_tr_b16 a[58:59], v14 offset:29184
v_mfma_f32_16x16x32_bf16 v[104:107], a[32:35], a[12:15], v[104:107]
ds_read_b128 a[20:23], v11 offset:43008
v_mfma_f32_16x16x32_bf16 v[36:39], a[36:39], a[0:3], v[36:39]
ds_read_b128 a[24:27], v11 offset:45056
v_mfma_f32_16x16x32_bf16 v[60:63], a[36:39], a[4:7], v[60:63]
ds_read_b128 a[28:31], v11 offset:47104
v_mfma_f32_16x16x32_bf16 v[84:87], a[36:39], a[8:11], v[84:87]
ds_read_b64_tr_b16 a[60:61], v15 offset:28672
v_mfma_f32_16x16x32_bf16 v[108:111], a[36:39], a[12:15], v[108:111]
ds_read_b64_tr_b16 a[62:63], v15 offset:29184
v_mfma_f32_16x16x32_bf16 v[40:43], a[0:3], a[40:43], v[40:43]
ds_read_b64_tr_b16 a[64:65], v14 offset:30720
v_mfma_f32_16x16x32_bf16 v[64:67], a[4:7], a[40:43], v[64:67]
ds_read_b64_tr_b16 a[66:67], v14 offset:31232
v_mfma_f32_16x16x32_bf16 v[88:91], a[8:11], a[40:43], v[88:91]
ds_read_b64_tr_b16 a[68:69], v15 offset:30720
v_mfma_f32_16x16x32_bf16 v[112:115], a[12:15], a[40:43], v[112:115]
ds_read_b64_tr_b16 a[70:71], v15 offset:31232
v_mfma_f32_16x16x32_bf16 v[44:47], a[0:3], a[44:47], v[44:47]
ds_read_b64_tr_b16 a[72:73], v14 offset:32768
v_mfma_f32_16x16x32_bf16 v[68:71], a[4:7], a[44:47], v[68:71]
ds_read_b64_tr_b16 a[74:75], v14 offset:33280
v_mfma_f32_16x16x32_bf16 v[92:95], a[8:11], a[44:47], v[92:95]
ds_read_b64_tr_b16 a[76:77], v15 offset:32768
v_mfma_f32_16x16x32_bf16 v[116:119], a[12:15], a[44:47], v[116:119]
ds_read_b64_tr_b16 a[78:79], v15 offset:33280
v_mfma_f32_16x16x32_bf16 v[48:51], a[0:3], a[48:51], v[48:51]
v_mfma_f32_16x16x32_bf16 v[72:75], a[4:7], a[48:51], v[72:75]
v_mfma_f32_16x16x32_bf16 v[96:99], a[8:11], a[48:51], v[96:99]
v_mfma_f32_16x16x32_bf16 v[120:123], a[12:15], a[48:51], v[120:123]
v_mfma_f32_16x16x32_bf16 v[52:55], a[0:3], a[52:55], v[52:55]
v_mfma_f32_16x16x32_bf16 v[76:79], a[4:7], a[52:55], v[76:79]
v_mfma_f32_16x16x32_bf16 v[100:103], a[8:11], a[52:55], v[100:103]
v_mfma_f32_16x16x32_bf16 v[124:127], a[12:15], a[52:55], v[124:127]
s_waitcnt lgkmcnt(0)
v_mfma_f32_16x16x32_bf16 v[32:35], a[56:59], a[16:19], v[32:35]
s_barrier
ds_read_b128 a[0:3], v10 offset:0
v_mfma_f32_16x16x32_bf16 v[56:59], a[56:59], a[20:23], v[56:59]
ds_read_b64_tr_b16 a[32:33], v12 offset:40960
v_mfma_f32_16x16x32_bf16 v[80:83], a[56:59], a[24:27], v[80:83]
ds_read_b64_tr_b16 a[34:35], v12 offset:41472
v_mfma_f32_16x16x32_bf16 v[104:107], a[56:59], a[28:31], v[104:107]
ds_read_b128 a[4:7], v10 offset:2048
v_mfma_f32_16x16x32_bf16 v[36:39], a[60:63], a[16:19], v[36:39]
ds_read_b128 a[8:11], v10 offset:4096
v_mfma_f32_16x16x32_bf16 v[60:63], a[60:63], a[20:23], v[60:63]
ds_read_b128 a[12:15], v10 offset:6144
v_mfma_f32_16x16x32_bf16 v[84:87], a[60:63], a[24:27], v[84:87]
ds_read_b64_tr_b16 a[36:37], v13 offset:40960
v_mfma_f32_16x16x32_bf16 v[108:111], a[60:63], a[28:31], v[108:111]
ds_read_b64_tr_b16 a[38:39], v13 offset:41472
v_mfma_f32_16x16x32_bf16 v[40:43], a[16:19], a[64:67], v[40:43]
ds_read_b64_tr_b16 a[40:41], v12 offset:43008
v_mfma_f32_16x16x32_bf16 v[64:67], a[20:23], a[64:67], v[64:67]
ds_read_b64_tr_b16 a[42:43], v12 offset:43520
v_mfma_f32_16x16x32_bf16 v[88:91], a[24:27], a[64:67], v[88:91]
ds_read_b64_tr_b16 a[44:45], v13 offset:43008
v_mfma_f32_16x16x32_bf16 v[112:115], a[28:31], a[64:67], v[112:115]
ds_read_b64_tr_b16 a[46:47], v13 offset:43520
v_mfma_f32_16x16x32_bf16 v[44:47], a[16:19], a[68:71], v[44:47]
ds_read_b64_tr_b16 a[48:49], v12 offset:45056
v_mfma_f32_16x16x32_bf16 v[68:71], a[20:23], a[68:71], v[68:71]
ds_read_b64_tr_b16 a[50:51], v12 offset:45568
v_mfma_f32_16x16x32_bf16 v[92:95], a[24:27], a[68:71], v[92:95]
ds_read_b64_tr_b16 a[52:53], v13 offset:45056
v_mfma_f32_16x16x32_bf16 v[116:119], a[28:31], a[68:71], v[116:119]
ds_read_b64_tr_b16 a[54:55], v13 offset:45568
v_mfma_f32_16x16x32_bf16 v[48:51], a[16:19], a[72:75], v[48:51]
v_mfma_f32_16x16x32_bf16 v[72:75], a[20:23], a[72:75], v[72:75]
v_mfma_f32_16x16x32_bf16 v[96:99], a[24:27], a[72:75], v[96:99]
v_mfma_f32_16x16x32_bf16 v[120:123], a[28:31], a[72:75], v[120:123]
v_mfma_f32_16x16x32_bf16 v[52:55], a[16:19], a[76:79], v[52:55]
v_mfma_f32_16x16x32_bf16 v[76:79], a[20:23], a[76:79], v[76:79]
v_mfma_f32_16x16x32_bf16 v[100:103], a[24:27], a[76:79], v[100:103]
v_mfma_f32_16x16x32_bf16 v[124:127], a[28:31], a[76:79], v[124:127]
s_waitcnt lgkmcnt(0)
v_mfma_f32_16x16x32_bf16 v[32:35], a[32:35], a[0:3], v[32:35]
ds_read_b128 a[16:19], v11 offset:0
v_mfma_f32_16x16x32_bf16 v[56:59], a[32:35], a[4:7], v[56:59]
ds_read_b64_tr_b16 a[56:57], v12 offset:53248
v_mfma_f32_16x16x32_bf16 v[80:83], a[32:35], a[8:11], v[80:83]
ds_read_b64_tr_b16 a[58:59], v12 offset:53760
v_mfma_f32_16x16x32_bf16 v[104:107], a[32:35], a[12:15], v[104:107]
ds_read_b128 a[20:23], v11 offset:2048
v_mfma_f32_16x16x32_bf16 v[36:39], a[36:39], a[0:3], v[36:39]
ds_read_b128 a[24:27], v11 offset:4096
v_mfma_f32_16x16x32_bf16 v[60:63], a[36:39], a[4:7], v[60:63]
ds_read_b128 a[28:31], v11 offset:6144
v_mfma_f32_16x16x32_bf16 v[84:87], a[36:39], a[8:11], v[84:87]
ds_read_b64_tr_b16 a[60:61], v13 offset:53248
v_mfma_f32_16x16x32_bf16 v[108:111], a[36:39], a[12:15], v[108:111]
ds_read_b64_tr_b16 a[62:63], v13 offset:53760
v_mfma_f32_16x16x32_bf16 v[40:43], a[0:3], a[40:43], v[40:43]
ds_read_b64_tr_b16 a[64:65], v12 offset:55296
v_mfma_f32_16x16x32_bf16 v[64:67], a[4:7], a[40:43], v[64:67]
ds_read_b64_tr_b16 a[66:67], v12 offset:55808
v_mfma_f32_16x16x32_bf16 v[88:91], a[8:11], a[40:43], v[88:91]
ds_read_b64_tr_b16 a[68:69], v13 offset:55296
v_mfma_f32_16x16x32_bf16 v[112:115], a[12:15], a[40:43], v[112:115]
ds_read_b64_tr_b16 a[70:71], v13 offset:55808
v_mfma_f32_16x16x32_bf16 v[44:47], a[0:3], a[44:47], v[44:47]
ds_read_b64_tr_b16 a[72:73], v12 offset:57344
v_mfma_f32_16x16x32_bf16 v[68:71], a[4:7], a[44:47], v[68:71]
ds_read_b64_tr_b16 a[74:75], v12 offset:57856
v_mfma_f32_16x16x32_bf16 v[92:95], a[8:11], a[44:47], v[92:95]
ds_read_b64_tr_b16 a[76:77], v13 offset:57344
v_mfma_f32_16x16x32_bf16 v[116:119], a[12:15], a[44:47], v[116:119]
ds_read_b64_tr_b16 a[78:79], v13 offset:57856
v_mfma_f32_16x16x32_bf16 v[48:51], a[0:3], a[48:51], v[48:51]
v_lshrrev_b32 v2, 4, v1
v_lshlrev_b32 v2, 4, v2
s_lshl_b32 s70, s66, 8
s_add_u32 s70, s70, 159744
v_add_u32 v17, s70, v2
v_mfma_f32_16x16x32_bf16 v[72:75], a[4:7], a[48:51], v[72:75]
v_mfma_f32_16x16x32_bf16 v[96:99], a[8:11], a[48:51], v[96:99]
v_and_b32 v2, 15, v1
v_lshlrev_b32 v2, 2, v2
s_lshl_b32 s70, s67, 7
s_add_u32 s70, s70, 160768
v_add_u32 v18, s70, v2
v_mfma_f32_16x16x32_bf16 v[120:123], a[12:15], a[48:51], v[120:123]
v_mfma_f32_16x16x32_bf16 v[52:55], a[0:3], a[52:55], v[52:55]
v_mfma_f32_16x16x32_bf16 v[76:79], a[4:7], a[52:55], v[76:79]
v_mfma_f32_16x16x32_bf16 v[100:103], a[8:11], a[52:55], v[100:103]
v_mfma_f32_16x16x32_bf16 v[124:127], a[12:15], a[52:55], v[124:127]
s_waitcnt lgkmcnt(0)
v_mfma_f32_16x16x32_bf16 v[32:35], a[56:59], a[16:19], v[32:35]
s_barrier
ds_read_b128 a[0:3], v8 offset:24576
v_mfma_f32_16x16x32_bf16 v[56:59], a[56:59], a[20:23], v[56:59]
ds_read_b64_tr_b16 a[40:41], v12 offset:2048
v_mfma_f32_16x16x32_bf16 v[80:83], a[56:59], a[24:27], v[80:83]
ds_read_b64_tr_b16 a[42:43], v12 offset:2560
v_mfma_f32_16x16x32_bf16 v[104:107], a[56:59], a[28:31], v[104:107]
ds_read_b128 a[4:7], v8 offset:26624
v_mfma_f32_16x16x32_bf16 v[36:39], a[60:63], a[16:19], v[36:39]
ds_read_b128 a[8:11], v8 offset:28672
v_mfma_f32_16x16x32_bf16 v[60:63], a[60:63], a[20:23], v[60:63]
ds_read_b128 a[12:15], v8 offset:30720
v_mfma_f32_16x16x32_bf16 v[84:87], a[60:63], a[24:27], v[84:87]
ds_read_b64_tr_b16 a[44:45], v13 offset:2048
v_mfma_f32_16x16x32_bf16 v[108:111], a[60:63], a[28:31], v[108:111]
ds_read_b64_tr_b16 a[46:47], v13 offset:2560
v_mfma_f32_16x16x32_bf16 v[40:43], a[16:19], a[64:67], v[40:43]
ds_read_b64_tr_b16 a[48:49], v12 offset:4096
v_mfma_f32_16x16x32_bf16 v[64:67], a[20:23], a[64:67], v[64:67]
ds_read_b64_tr_b16 a[50:51], v12 offset:4608
v_mfma_f32_16x16x32_bf16 v[88:91], a[24:27], a[64:67], v[88:91]
ds_read_b64_tr_b16 a[52:53], v13 offset:4096
v_mfma_f32_16x16x32_bf16 v[112:115], a[28:31], a[64:67], v[112:115]
ds_read_b64_tr_b16 a[54:55], v13 offset:4608
v_mfma_f32_16x16x32_bf16 v[44:47], a[16:19], a[68:71], v[44:47]
ds_read_b64_tr_b16 a[32:33], v12 offset:0
v_mfma_f32_16x16x32_bf16 v[68:71], a[20:23], a[68:71], v[68:71]
ds_read_b64_tr_b16 a[34:35], v12 offset:512
v_mfma_f32_16x16x32_bf16 v[92:95], a[24:27], a[68:71], v[92:95]
ds_read_b64_tr_b16 a[36:37], v13 offset:0
v_mfma_f32_16x16x32_bf16 v[116:119], a[28:31], a[68:71], v[116:119]
ds_read_b64_tr_b16 a[38:39], v13 offset:512
v_mfma_f32_16x16x32_bf16 v[48:51], a[16:19], a[72:75], v[48:51]
v_mfma_f32_16x16x32_bf16 v[72:75], a[20:23], a[72:75], v[72:75]
v_mfma_f32_16x16x32_bf16 v[96:99], a[24:27], a[72:75], v[96:99]
v_mfma_f32_16x16x32_bf16 v[120:123], a[28:31], a[72:75], v[120:123]
v_mfma_f32_16x16x32_bf16 v[52:55], a[16:19], a[76:79], v[52:55]
v_mfma_f32_16x16x32_bf16 v[76:79], a[20:23], a[76:79], v[76:79]
v_mfma_f32_16x16x32_bf16 v[100:103], a[24:27], a[76:79], v[100:103]
v_mfma_f32_16x16x32_bf16 v[124:127], a[28:31], a[76:79], v[124:127]
s_waitcnt lgkmcnt(0)
v_mfma_f32_16x16x32_bf16 v[40:43], a[0:3], a[40:43], v[40:43]
ds_read_b128 a[16:19], v9 offset:24576
ds_read_b64_tr_b16 a[64:65], v12 offset:14336
v_mfma_f32_16x16x32_bf16 v[64:67], a[4:7], a[40:43], v[64:67]
ds_read_b64_tr_b16 a[66:67], v12 offset:14848
ds_read_b128 a[20:23], v9 offset:26624
v_mfma_f32_16x16x32_bf16 v[88:91], a[8:11], a[40:43], v[88:91]
ds_read_b128 a[24:27], v9 offset:28672
ds_read_b128 a[28:31], v9 offset:30720
v_mfma_f32_16x16x32_bf16 v[112:115], a[12:15], a[40:43], v[112:115]
ds_read_b64_tr_b16 a[68:69], v13 offset:14336
ds_read_b64_tr_b16 a[70:71], v13 offset:14848
v_mfma_f32_16x16x32_bf16 v[44:47], a[0:3], a[44:47], v[44:47]
ds_read_b64_tr_b16 a[72:73], v12 offset:16384
ds_read_b64_tr_b16 a[74:75], v12 offset:16896
v_mfma_f32_16x16x32_bf16 v[68:71], a[4:7], a[44:47], v[68:71]
ds_read_b64_tr_b16 a[76:77], v13 offset:16384
ds_read_b64_tr_b16 a[78:79], v13 offset:16896
v_mfma_f32_16x16x32_bf16 v[92:95], a[8:11], a[44:47], v[92:95]
ds_read_b64_tr_b16 a[56:57], v12 offset:12288
v_mfma_f32_16x16x32_bf16 v[116:119], a[12:15], a[44:47], v[116:119]
ds_read_b64_tr_b16 a[58:59], v12 offset:12800
v_mfma_f32_16x16x32_bf16 v[48:51], a[0:3], a[48:51], v[48:51]
ds_read_b64_tr_b16 a[60:61], v13 offset:12288
v_mfma_f32_16x16x32_bf16 v[72:75], a[4:7], a[48:51], v[72:75]
ds_read_b64_tr_b16 a[62:63], v13 offset:12800
v_mfma_f32_16x16x32_bf16 v[96:99], a[8:11], a[48:51], v[96:99]
v_mfma_f32_16x16x32_bf16 v[120:123], a[12:15], a[48:51], v[120:123]
v_mfma_f32_16x16x32_bf16 v[52:55], a[0:3], a[52:55], v[52:55]
v_mfma_f32_16x16x32_bf16 v[76:79], a[4:7], a[52:55], v[76:79]
v_mfma_f32_16x16x32_bf16 v[100:103], a[8:11], a[52:55], v[100:103]
v_mfma_f32_16x16x32_bf16 v[124:127], a[12:15], a[52:55], v[124:127]
s_waitcnt lgkmcnt(0)
v_mfma_f32_16x16x32_bf16 v[40:43], a[16:19], a[64:67], v[40:43]
s_barrier
ds_read_b128 v[20:23], v17 offset:0
ds_read_b128 v[24:27], v17 offset:512
v_mfma_f32_16x16x32_bf16 v[44:47], a[16:19], a[68:71], v[44:47]
ds_read_b32 v6, v18 offset:256
ds_read_b32 v8, v18 offset:320
v_mfma_f32_16x16x32_bf16 v[64:67], a[20:23], a[64:67], v[64:67]
ds_read_b32 v10, v18 offset:512
ds_read_b32 v18, v18 offset:576
v_mfma_f32_16x16x32_bf16 v[68:71], a[20:23], a[68:71], v[68:71]
v_mov_b32 v19, 161536
ds_read_b32 v19, v19
ds_read_b128 v[128:131], v17 offset:64
v_mfma_f32_16x16x32_bf16 v[88:91], a[24:27], a[64:67], v[88:91]
ds_read_b128 v[132:135], v17 offset:576
ds_read_b128 v[136:139], v17 offset:128
v_mfma_f32_16x16x32_bf16 v[92:95], a[24:27], a[68:71], v[92:95]
ds_read_b128 v[140:143], v17 offset:640
ds_read_b128 v[144:147], v17 offset:192
v_mfma_f32_16x16x32_bf16 v[112:115], a[28:31], a[64:67], v[112:115]
ds_read_b128 v[148:151], v17 offset:704
v_mfma_f32_16x16x32_bf16 v[116:119], a[28:31], a[68:71], v[116:119]
s_waitcnt lgkmcnt(6)
v_readfirstlane_b32 s69, v19
s_nop 0
s_and_b32 s61, s69, 0x2000
s_and_b32 s69, s69, 1
s_xor_b32 s88, s88, s61
v_pk_mul_f32 v[28:29], v[24:25], s[90:91]
v_pk_mul_f32 v[30:31], v[26:27], s[90:91]
v_pk_fma_f32 v[40:41], v[20:21], v[6:7], v[40:41] op_sel:[0,0,0] op_sel_hi:[1,0,1]
v_pk_fma_f32 v[44:45], v[20:21], v[8:9], v[44:45] op_sel:[0,0,0] op_sel_hi:[1,0,1]
v_pk_fma_f32 v[42:43], v[22:23], v[6:7], v[42:43] op_sel:[0,0,0] op_sel_hi:[1,0,1]
v_pk_fma_f32 v[46:47], v[22:23], v[8:9], v[46:47] op_sel:[0,0,0] op_sel_hi:[1,0,1]
v_pk_mul_f32 v[2:3], v[40:41], v[28:29]
s_branch L_over5
L_pad5:
s_branch L_ret9
L_over5:
v_pk_mul_f32 v[12:13], v[44:45], v[28:29]
v_pk_mul_f32 v[4:5], v[42:43], v[30:31]
v_pk_mul_f32 v[14:15], v[46:47], v[30:31]
v_pk_fma_f32 v[40:41], v[40:41], v[24:25], s[82:83]
v_pk_fma_f32 v[44:45], v[44:45], v[24:25], s[82:83]
v_pk_fma_f32 v[42:43], v[42:43], v[26:27], s[82:83]
v_pk_fma_f32 v[46:47], v[46:47], v[26:27], s[82:83]
v_exp_f32_e64 v2, v2 clamp
v_mfma_f32_16x16x32_bf16 v[48:51], a[16:19], a[72:75], v[48:51]
v_exp_f32_e64 v12, v12 clamp
v_exp_f32_e64 v3, v3 clamp
v_exp_f32_e64 v13, v13 clamp
v_exp_f32_e64 v4, v4 clamp
v_mfma_f32_16x16x32_bf16 v[52:55], a[16:19], a[76:79], v[52:55]
v_exp_f32_e64 v14, v14 clamp
v_exp_f32_e64 v5, v5 clamp
v_exp_f32_e64 v15, v15 clamp
v_pk_add_f32 v[2:3], v[2:3], s[80:81]
v_pk_add_f32 v[12:13], v[12:13], s[80:81]
v_pk_add_f32 v[4:5], v[4:5], s[80:81]
v_pk_add_f32 v[14:15], v[14:15], s[80:81]
v_max_f32 v40, v40, v2
v_max_f32 v44, v44, v12
v_max_f32 v41, v41, v3
v_max_f32 v45, v45, v13
v_max_f32 v42, v42, v4
v_max_f32 v46, v46, v14
v_max_f32 v43, v43, v5
v_max_f32 v47, v47, v15
v_cvt_pk_bf16_f32 v40, v40, v41
v_cvt_pk_bf16_f32 v44, v44, v45
v_cvt_pk_bf16_f32 v41, v42, v43
v_cvt_pk_bf16_f32 v45, v46, v47
s_waitcnt lgkmcnt(0)
v_pk_fma_f32 v[48:49], v[20:21], v[10:11], v[48:49] op_sel:[0,0,0] op_sel_hi:[1,0,1]
v_pk_fma_f32 v[52:53], v[20:21], v[18:19], v[52:53] op_sel:[0,0,0] op_sel_hi:[1,0,1]
v_pk_fma_f32 v[50:51], v[22:23], v[10:11], v[50:51] op_sel:[0,0,0] op_sel_hi:[1,0,1]
v_pk_fma_f32 v[54:55], v[22:23], v[18:19], v[54:55] op_sel:[0,0,0] op_sel_hi:[1,0,1]
v_pk_mul_f32 v[48:49], v[48:49], v[24:25]
v_pk_mul_f32 v[52:53], v[52:53], v[24:25]
v_pk_mul_f32 v[50:51], v[50:51], v[26:27]
v_pk_mul_f32 v[54:55], v[54:55], v[26:27]
v_cvt_pk_bf16_f32 v48, v48, v49
v_cvt_pk_bf16_f32 v52, v52, v53
v_cvt_pk_bf16_f32 v49, v50, v51
v_cvt_pk_bf16_f32 v53, v54, v55
v_pk_mul_f32 v[28:29], v[132:133], s[90:91]
v_pk_mul_f32 v[30:31], v[134:135], s[90:91]
v_pk_fma_f32 v[64:65], v[128:129], v[6:7], v[64:65] op_sel:[0,0,0] op_sel_hi:[1,0,1]
v_pk_fma_f32 v[68:69], v[128:129], v[8:9], v[68:69] op_sel:[0,0,0] op_sel_hi:[1,0,1]
v_pk_fma_f32 v[66:67], v[130:131], v[6:7], v[66:67] op_sel:[0,0,0] op_sel_hi:[1,0,1]
v_pk_fma_f32 v[70:71], v[130:131], v[8:9], v[70:71] op_sel:[0,0,0] op_sel_hi:[1,0,1]
v_pk_mul_f32 v[2:3], v[64:65], v[28:29]
v_pk_mul_f32 v[12:13], v[68:69], v[28:29]
v_pk_mul_f32 v[4:5], v[66:67], v[30:31]
v_pk_mul_f32 v[14:15], v[70:71], v[30:31]
v_pk_fma_f32 v[64:65], v[64:65], v[132:133], s[82:83]
v_pk_fma_f32 v[68:69], v[68:69], v[132:133], s[82:83]
v_pk_fma_f32 v[66:67], v[66:67], v[134:135], s[82:83]
v_pk_fma_f32 v[70:71], v[70:71], v[134:135], s[82:83]
v_exp_f32_e64 v2, v2 clamp
v_mfma_f32_16x16x32_bf16 v[72:75], a[20:23], a[72:75], v[72:75]
v_exp_f32_e64 v12, v12 clamp
v_exp_f32_e64 v3, v3 clamp
v_exp_f32_e64 v13, v13 clamp
v_exp_f32_e64 v4, v4 clamp
v_mfma_f32_16x16x32_bf16 v[76:79], a[20:23], a[76:79], v[76:79]
v_exp_f32_e64 v14, v14 clamp
v_exp_f32_e64 v5, v5 clamp
v_exp_f32_e64 v15, v15 clamp
v_pk_add_f32 v[2:3], v[2:3], s[80:81]
v_pk_add_f32 v[12:13], v[12:13], s[80:81]
v_pk_add_f32 v[4:5], v[4:5], s[80:81]
v_pk_add_f32 v[14:15], v[14:15], s[80:81]
v_max_f32 v64, v64, v2
v_max_f32 v68, v68, v12
v_max_f32 v65, v65, v3
v_max_f32 v69, v69, v13
v_max_f32 v66, v66, v4
v_max_f32 v70, v70, v14
v_max_f32 v67, v67, v5
v_max_f32 v71, v71, v15
v_cvt_pk_bf16_f32 v42, v64, v65
v_cvt_pk_bf16_f32 v46, v68, v69
v_cvt_pk_bf16_f32 v43, v66, v67
v_cvt_pk_bf16_f32 v47, v70, v71
v_pk_fma_f32 v[72:73], v[128:129], v[10:11], v[72:73] op_sel:[0,0,0] op_sel_hi:[1,0,1]
v_pk_fma_f32 v[76:77], v[128:129], v[18:19], v[76:77] op_sel:[0,0,0] op_sel_hi:[1,0,1]
v_pk_fma_f32 v[74:75], v[130:131], v[10:11], v[74:75] op_sel:[0,0,0] op_sel_hi:[1,0,1]
v_pk_fma_f32 v[78:79], v[130:131], v[18:19], v[78:79] op_sel:[0,0,0] op_sel_hi:[1,0,1]
v_pk_mul_f32 v[72:73], v[72:73], v[132:133]
v_pk_mul_f32 v[76:77], v[76:77], v[132:133]
v_pk_mul_f32 v[74:75], v[74:75], v[134:135]
v_pk_mul_f32 v[78:79], v[78:79], v[134:135]
v_cvt_pk_bf16_f32 v50, v72, v73
v_cvt_pk_bf16_f32 v54, v76, v77
v_cvt_pk_bf16_f32 v51, v74, v75
v_cvt_pk_bf16_f32 v55, v78, v79
v_pk_mul_f32 v[28:29], v[140:141], s[90:91]
v_pk_mul_f32 v[30:31], v[142:143], s[90:91]
v_pk_fma_f32 v[88:89], v[136:137], v[6:7], v[88:89] op_sel:[0,0,0] op_sel_hi:[1,0,1]
v_pk_fma_f32 v[92:93], v[136:137], v[8:9], v[92:93] op_sel:[0,0,0] op_sel_hi:[1,0,1]
v_pk_fma_f32 v[90:91], v[138:139], v[6:7], v[90:91] op_sel:[0,0,0] op_sel_hi:[1,0,1]
v_pk_fma_f32 v[94:95], v[138:139], v[8:9], v[94:95] op_sel:[0,0,0] op_sel_hi:[1,0,1]
v_pk_mul_f32 v[2:3], v[88:89], v[28:29]
v_pk_mul_f32 v[12:13], v[92:93], v[28:29]
v_pk_mul_f32 v[4:5], v[90:91], v[30:31]
v_pk_mul_f32 v[14:15], v[94:95], v[30:31]
v_pk_fma_f32 v[88:89], v[88:89], v[140:141], s[82:83]
v_pk_fma_f32 v[92:93], v[92:93], v[140:141], s[82:83]
v_pk_fma_f32 v[90:91], v[90:91], v[142:143], s[82:83]
v_pk_fma_f32 v[94:95], v[94:95], v[142:143], s[82:83]
v_exp_f32_e64 v2, v2 clamp
v_mfma_f32_16x16x32_bf16 v[96:99], a[24:27], a[72:75], v[96:99]
v_exp_f32_e64 v12, v12 clamp
v_mfma_f32_16x16x32_bf16 v[100:103], a[24:27], a[76:79], v[100:103]
v_exp_f32_e64 v3, v3 clamp
v_exp_f32_e64 v13, v13 clamp
v_mfma_f32_16x16x32_bf16 v[64:67], v[40:43], v[48:51], 0
v_exp_f32_e64 v4, v4 clamp
v_exp_f32_e64 v14, v14 clamp
v_mfma_f32_16x16x32_bf16 v[68:71], v[40:43], v[52:55], 0
v_exp_f32_e64 v5, v5 clamp
v_mfma_f32_16x16x32_bf16 v[20:23], v[40:43], a[80:83], 0
v_exp_f32_e64 v15, v15 clamp
v_pk_add_f32 v[2:3], v[2:3], s[80:81]
v_pk_add_f32 v[12:13], v[12:13], s[80:81]
v_pk_add_f32 v[4:5], v[4:5], s[80:81]
v_pk_add_f32 v[14:15], v[14:15], s[80:81]
v_max_f32 v88, v88, v2
v_max_f32 v92, v92, v12
v_max_f32 v89, v89, v3
v_max_f32 v93, v93, v13
v_max_f32 v90, v90, v4
v_max_f32 v94, v94, v14
v_max_f32 v91, v91, v5
v_max_f32 v95, v95, v15
v_cvt_pk_bf16_f32 v88, v88, v89
v_cvt_pk_bf16_f32 v92, v92, v93
v_cvt_pk_bf16_f32 v89, v90, v91
v_cvt_pk_bf16_f32 v93, v94, v95
v_pk_fma_f32 v[96:97], v[136:137], v[10:11], v[96:97] op_sel:[0,0,0] op_sel_hi:[1,0,1]
v_pk_fma_f32 v[100:101], v[136:137], v[18:19], v[100:101] op_sel:[0,0,0] op_sel_hi:[1,0,1]
v_pk_fma_f32 v[98:99], v[138:139], v[10:11], v[98:99] op_sel:[0,0,0] op_sel_hi:[1,0,1]
v_pk_fma_f32 v[102:103], v[138:139], v[18:19], v[102:103] op_sel:[0,0,0] op_sel_hi:[1,0,1]
v_pk_mul_f32 v[96:97], v[96:97], v[140:141]
v_pk_mul_f32 v[100:101], v[100:101], v[140:141]
v_pk_mul_f32 v[98:99], v[98:99], v[142:143]
v_pk_mul_f32 v[102:103], v[102:103], v[142:143]
v_cvt_pk_bf16_f32 v96, v96, v97
v_cvt_pk_bf16_f32 v100, v100, v101
v_cvt_pk_bf16_f32 v97, v98, v99
v_cvt_pk_bf16_f32 v101, v102, v103
v_pk_mul_f32 v[28:29], v[148:149], s[90:91]
v_pk_mul_f32 v[30:31], v[150:151], s[90:91]
v_pk_fma_f32 v[112:113], v[144:145], v[6:7], v[112:113] op_sel:[0,0,0] op_sel_hi:[1,0,1]
v_pk_fma_f32 v[116:117], v[144:145], v[8:9], v[116:117] op_sel:[0,0,0] op_sel_hi:[1,0,1]
v_pk_fma_f32 v[114:115], v[146:147], v[6:7], v[114:115] op_sel:[0,0,0] op_sel_hi:[1,0,1]
v_pk_fma_f32 v[118:119], v[146:147], v[8:9], v[118:119] op_sel:[0,0,0] op_sel_hi:[1,0,1]
v_pk_mul_f32 v[2:3], v[112:113], v[28:29]
v_pk_mul_f32 v[12:13], v[116:117], v[28:29]
v_pk_mul_f32 v[4:5], v[114:115], v[30:31]
v_pk_mul_f32 v[14:15], v[118:119], v[30:31]
v_pk_fma_f32 v[112:113], v[112:113], v[148:149], s[82:83]
v_pk_fma_f32 v[116:117], v[116:117], v[148:149], s[82:83]
v_pk_fma_f32 v[114:115], v[114:115], v[150:151], s[82:83]
v_pk_fma_f32 v[118:119], v[118:119], v[150:151], s[82:83]
v_exp_f32_e64 v2, v2 clamp
v_mfma_f32_16x16x32_bf16 v[120:123], a[28:31], a[72:75], v[120:123]
v_exp_f32_e64 v12, v12 clamp
v_mfma_f32_16x16x32_bf16 v[124:127], a[28:31], a[76:79], v[124:127]
v_exp_f32_e64 v3, v3 clamp
v_exp_f32_e64 v13, v13 clamp
v_mfma_f32_16x16x32_bf16 v[72:75], v[44:47], v[48:51], 0
v_exp_f32_e64 v4, v4 clamp
v_exp_f32_e64 v14, v14 clamp
v_mfma_f32_16x16x32_bf16 v[76:79], v[44:47], v[52:55], 0
v_exp_f32_e64 v5, v5 clamp
v_mfma_f32_16x16x32_bf16 v[24:27], v[44:47], a[80:83], 0
v_exp_f32_e64 v15, v15 clamp
v_pk_add_f32 v[2:3], v[2:3], s[80:81]
v_pk_add_f32 v[12:13], v[12:13], s[80:81]
v_pk_add_f32 v[4:5], v[4:5], s[80:81]
v_pk_add_f32 v[14:15], v[14:15], s[80:81]
v_max_f32 v112, v112, v2
v_max_f32 v116, v116, v12
v_max_f32 v113, v113, v3
v_max_f32 v117, v117, v13
v_max_f32 v114, v114, v4
v_max_f32 v118, v118, v14
v_max_f32 v115, v115, v5
v_max_f32 v119, v119, v15
v_cvt_pk_bf16_f32 v90, v112, v113
v_cvt_pk_bf16_f32 v94, v116, v117
v_cvt_pk_bf16_f32 v91, v114, v115
v_cvt_pk_bf16_f32 v95, v118, v119
v_pk_fma_f32 v[120:121], v[144:145], v[10:11], v[120:121] op_sel:[0,0,0] op_sel_hi:[1,0,1]
v_pk_fma_f32 v[124:125], v[144:145], v[18:19], v[124:125] op_sel:[0,0,0] op_sel_hi:[1,0,1]
v_pk_fma_f32 v[122:123], v[146:147], v[10:11], v[122:123] op_sel:[0,0,0] op_sel_hi:[1,0,1]
v_pk_fma_f32 v[126:127], v[146:147], v[18:19], v[126:127] op_sel:[0,0,0] op_sel_hi:[1,0,1]
v_pk_mul_f32 v[120:121], v[120:121], v[148:149]
v_pk_mul_f32 v[124:125], v[124:125], v[148:149]
v_pk_mul_f32 v[122:123], v[122:123], v[150:151]
v_pk_mul_f32 v[126:127], v[126:127], v[150:151]
v_cvt_pk_bf16_f32 v98, v120, v121
v_cvt_pk_bf16_f32 v102, v124, v125
v_cvt_pk_bf16_f32 v99, v122, v123
v_cvt_pk_bf16_f32 v103, v126, v127
s_nop 0
v_mfma_f32_16x16x32_bf16 v[64:67], v[88:91], v[96:99], v[64:67]
v_mfma_f32_16x16x32_bf16 v[68:71], v[88:91], v[100:103], v[68:71]
v_mfma_f32_16x16x32_bf16 v[20:23], v[88:91], a[80:83], v[20:23]
v_mfma_f32_16x16x32_bf16 v[72:75], v[92:95], v[96:99], v[72:75]
v_mfma_f32_16x16x32_bf16 v[76:79], v[92:95], v[100:103], v[76:79]
v_mfma_f32_16x16x32_bf16 v[24:27], v[92:95], a[80:83], v[24:27]
s_lshl_b32 s70, s60, 11
s_add_u32 s70, s70, 16384
v_add_u32 v2, s70, v16
v_xor_b32 v3, 4096, v2
v_lshrrev_b32 v4, 4, v1
v_lshlrev_b32 v5, 4, v4
v_lshlrev_b32 v4, 5, v4
s_lshl_b32 s70, s60, 6
s_add_u32 s70, s70, 163584
v_add_u32 v5, s70, v5
v_xor_b32 v6, 128, v5
s_lshl_b32 s72, s67, 1
s_add_u32 s72, s72, s66
s_lshl_b32 s72, s72, 10
s_add_u32 s72, s72, s87
s_lshl_b32 s73, s67, 7
s_lshl_b32 s70, s66, 4
s_add_u32 s73, s73, s70
s_add_u32 s73, s73, s87
s_add_u32 s73, s73, 4096
s_mov_b32 s92, 0x00010001
s_mov_b32 s93, 0x00010001
v_mov_b32 v15, s68
s_cmp_eq_u32 s66, 0
s_cbranch_scc0 L_ex1
ds_write_b128 v2, v[68:71]
ds_write_b128 v2, v[76:79] offset:1024
ds_write_b128 v5, v[24:27]
s_waitcnt lgkmcnt(0)
s_barrier
ds_read_b128 v[128:131], v3
ds_read_b128 v[132:135], v3 offset:1024
ds_read_b128 v[136:139], v6
s_waitcnt lgkmcnt(1)
v_pk_add_f32 v[128:129], v[128:129], v[64:65]
v_pk_add_f32 v[130:131], v[130:131], v[66:67]
v_pk_add_f32 v[132:133], v[132:133], v[72:73]
v_pk_add_f32 v[134:135], v[134:135], v[74:75]
s_waitcnt lgkmcnt(0)
v_pk_add_f32 v[136:137], v[136:137], v[20:21]
v_pk_add_f32 v[138:139], v[138:139], v[22:23]
s_branch L_ex_d
L_ex1:
ds_write_b128 v2, v[64:67]
ds_write_b128 v2, v[72:75] offset:1024
ds_write_b128 v5, v[20:23]
s_waitcnt lgkmcnt(0)
s_barrier
ds_read_b128 v[128:131], v3
ds_read_b128 v[132:135], v3 offset:1024
ds_read_b128 v[136:139], v6
s_waitcnt lgkmcnt(1)
v_pk_add_f32 v[128:129], v[128:129], v[68:69]
v_pk_add_f32 v[130:131], v[130:131], v[70:71]
v_pk_add_f32 v[132:133], v[132:133], v[76:77]
v_pk_add_f32 v[134:135], v[134:135], v[78:79]
s_waitcnt lgkmcnt(0)
v_pk_add_f32 v[136:137], v[136:137], v[24:25]
v_pk_add_f32 v[138:139], v[138:139], v[26:27]
L_ex_d:
v_cvt_pk_bf16_f32 v140, v128, v129
v_cvt_pk_bf16_f32 v141, v130, v131
v_cvt_pk_bf16_f32 v142, v132, v133
v_cvt_pk_bf16_f32 v143, v134, v135
v_bfi_b32 v136, s85, v15, v136
v_bfi_b32 v137, s85, v15, v137
v_bfi_b32 v138, s85, v15, v138
v_bfi_b32 v139, s85, v15, v139
s_cmp_eq_u32 s69, 0
s_cbranch_scc1 L_kvp_s
buffer_store_dwordx4 v[140:143], v16, s[12:15], s72 offen
s_mov_b64 exec, s[92:93]
buffer_store_dwordx4 v[136:139], v4, s[12:15], s73 offen
s_mov_b64 exec, -1
L_kvp_d:
s_barrier
v_and_b32 v2, 15, v1
v_lshlrev_b32 v2, 2, v2
s_lshl_b32 s70, s66, 8
s_add_u32 s70, s70, 159744
v_add_u32 v2, s70, v2
v_lshrrev_b32 v3, 4, v1
v_lshlrev_b32 v3, 4, v3
s_lshl_b32 s70, s67, 7
s_add_u32 s70, s70, 160768
v_add_u32_e64 v5, s70, v3
ds_read_b32 v8, v2 offset:0
ds_read_b32 v128, v2 offset:512
ds_read_b32 v10, v2 offset:64
ds_read_b32 v130, v2 offset:576
ds_read_b32 v12, v2 offset:128
ds_read_b32 v132, v2 offset:640
ds_read_b32 v14, v2 offset:192
ds_read_b32 v134, v2 offset:704
ds_read_b128 v[144:147], v5 offset:0
ds_read_b128 v[148:151], v5 offset:64
v_mfma_f32_16x16x32_bf16 v[32:35], a[32:35], a[0:3], v[32:35]
v_mfma_f32_16x16x32_bf16 v[56:59], a[32:35], a[4:7], v[56:59]
v_mfma_f32_16x16x32_bf16 v[80:83], a[32:35], a[8:11], v[80:83]
v_mfma_f32_16x16x32_bf16 v[104:107], a[32:35], a[12:15], v[104:107]
v_mfma_f32_16x16x32_bf16 v[36:39], a[36:39], a[0:3], v[36:39]
v_mfma_f32_16x16x32_bf16 v[60:63], a[36:39], a[4:7], v[60:63]
v_mfma_f32_16x16x32_bf16 v[84:87], a[36:39], a[8:11], v[84:87]
v_mfma_f32_16x16x32_bf16 v[108:111], a[36:39], a[12:15], v[108:111]
v_mfma_f32_16x16x32_bf16 v[32:35], a[56:59], a[16:19], v[32:35]
v_mfma_f32_16x16x32_bf16 v[56:59], a[56:59], a[20:23], v[56:59]
v_mfma_f32_16x16x32_bf16 v[80:83], a[56:59], a[24:27], v[80:83]
v_mfma_f32_16x16x32_bf16 v[104:107], a[56:59], a[28:31], v[104:107]
v_mfma_f32_16x16x32_bf16 v[36:39], a[60:63], a[16:19], v[36:39]
v_mfma_f32_16x16x32_bf16 v[60:63], a[60:63], a[20:23], v[60:63]
v_mfma_f32_16x16x32_bf16 v[84:87], a[60:63], a[24:27], v[84:87]
v_mfma_f32_16x16x32_bf16 v[108:111], a[60:63], a[28:31], v[108:111]
s_lshl1_add_u32 s70, s64, s67
s_lshl_b32 s70, s70, 11
s_add_u32 s70, s70, 1638400
v_add_u32 v17, s70, v16
s_lshl_b32 s70, s67, 6
s_add_u32 s70, s70, 161600
v_add_u32 v18, s70, v3
s_waitcnt lgkmcnt(0)
v_mul_f32 v20, s90, v128
v_mul_f32 v22, s90, v130
v_mul_f32 v4, s90, v132
v_mul_f32 v6, s90, v134
v_pk_fma_f32 v[32:33], v[144:145], v[8:9], v[32:33] op_sel:[0,0,0] op_sel_hi:[1,0,1]
v_pk_fma_f32 v[36:37], v[148:149], v[8:9], v[36:37] op_sel:[0,0,0] op_sel_hi:[1,0,1]
v_pk_fma_f32 v[34:35], v[146:147], v[8:9], v[34:35] op_sel:[0,0,0] op_sel_hi:[1,0,1]
v_pk_fma_f32 v[38:39], v[150:151], v[8:9], v[38:39] op_sel:[0,0,0] op_sel_hi:[1,0,1]
v_pk_mul_f32 v[24:25], v[32:33], v[20:21] op_sel:[0,0] op_sel_hi:[1,0]
v_pk_mul_f32 v[28:29], v[36:37], v[20:21] op_sel:[0,0] op_sel_hi:[1,0]
v_pk_mul_f32 v[26:27], v[34:35], v[20:21] op_sel:[0,0] op_sel_hi:[1,0]
v_pk_mul_f32 v[30:31], v[38:39], v[20:21] op_sel:[0,0] op_sel_hi:[1,0]
v_pk_fma_f32 v[32:33], v[32:33], v[128:129], s[82:83] op_sel:[0,0,0] op_sel_hi:[1,0,1]
v_pk_fma_f32 v[36:37], v[36:37], v[128:129], s[82:83] op_sel:[0,0,0] op_sel_hi:[1,0,1]
v_pk_fma_f32 v[34:35], v[34:35], v[128:129], s[82:83] op_sel:[0,0,0] op_sel_hi:[1,0,1]
v_pk_fma_f32 v[38:39], v[38:39], v[128:129], s[82:83] op_sel:[0,0,0] op_sel_hi:[1,0,1]
v_exp_f32_e64 v24, v24 clamp
v_exp_f32_e64 v28, v28 clamp
v_exp_f32_e64 v25, v25 clamp
v_exp_f32_e64 v29, v29 clamp
v_exp_f32_e64 v26, v26 clamp
v_exp_f32_e64 v30, v30 clamp
v_exp_f32_e64 v27, v27 clamp
v_exp_f32_e64 v31, v31 clamp
v_pk_add_f32 v[24:25], v[24:25], s[80:81]
v_pk_add_f32 v[28:29], v[28:29], s[80:81]
v_pk_add_f32 v[26:27], v[26:27], s[80:81]
v_pk_add_f32 v[30:31], v[30:31], s[80:81]
v_max_f32 v32, v32, v24
v_max_f32 v36, v36, v28
v_max_f32 v33, v33, v25
v_max_f32 v37, v37, v29
v_max_f32 v34, v34, v26
v_max_f32 v38, v38, v30
v_max_f32 v35, v35, v27
v_max_f32 v39, v39, v31
v_cvt_pk_bf16_f32 v32, v32, v33
v_cvt_pk_bf16_f32 v33, v34, v35
v_cvt_pk_bf16_f32 v34, v36, v37
v_cvt_pk_bf16_f32 v35, v38, v39
v_pk_fma_f32 v[56:57], v[144:145], v[10:11], v[56:57] op_sel:[0,0,0] op_sel_hi:[1,0,1]
v_pk_fma_f32 v[60:61], v[148:149], v[10:11], v[60:61] op_sel:[0,0,0] op_sel_hi:[1,0,1]
v_pk_fma_f32 v[58:59], v[146:147], v[10:11], v[58:59] op_sel:[0,0,0] op_sel_hi:[1,0,1]
v_pk_fma_f32 v[62:63], v[150:151], v[10:11], v[62:63] op_sel:[0,0,0] op_sel_hi:[1,0,1]
v_pk_mul_f32 v[24:25], v[56:57], v[22:23] op_sel:[0,0] op_sel_hi:[1,0]
v_pk_mul_f32 v[28:29], v[60:61], v[22:23] op_sel:[0,0] op_sel_hi:[1,0]
v_pk_mul_f32 v[26:27], v[58:59], v[22:23] op_sel:[0,0] op_sel_hi:[1,0]
v_pk_mul_f32 v[30:31], v[62:63], v[22:23] op_sel:[0,0] op_sel_hi:[1,0]
v_pk_fma_f32 v[56:57], v[56:57], v[130:131], s[82:83] op_sel:[0,0,0] op_sel_hi:[1,0,1]
v_pk_fma_f32 v[60:61], v[60:61], v[130:131], s[82:83] op_sel:[0,0,0] op_sel_hi:[1,0,1]
v_pk_fma_f32 v[58:59], v[58:59], v[130:131], s[82:83] op_sel:[0,0,0] op_sel_hi:[1,0,1]
v_pk_fma_f32 v[62:63], v[62:63], v[130:131], s[82:83] op_sel:[0,0,0] op_sel_hi:[1,0,1]
v_exp_f32_e64 v24, v24 clamp
v_exp_f32_e64 v28, v28 clamp
v_exp_f32_e64 v25, v25 clamp
v_exp_f32_e64 v29, v29 clamp
v_exp_f32_e64 v26, v26 clamp
v_exp_f32_e64 v30, v30 clamp
v_exp_f32_e64 v27, v27 clamp
v_exp_f32_e64 v31, v31 clamp
v_pk_add_f32 v[24:25], v[24:25], s[80:81]
v_pk_add_f32 v[28:29], v[28:29], s[80:81]
v_pk_add_f32 v[26:27], v[26:27], s[80:81]
v_pk_add_f32 v[30:31], v[30:31], s[80:81]
v_max_f32 v56, v56, v24
v_max_f32 v60, v60, v28
v_max_f32 v57, v57, v25
v_max_f32 v61, v61, v29
v_max_f32 v58, v58, v26
v_max_f32 v62, v62, v30
v_max_f32 v59, v59, v27
v_max_f32 v63, v63, v31
v_cvt_pk_bf16_f32 v56, v56, v57
v_cvt_pk_bf16_f32 v57, v58, v59
v_cvt_pk_bf16_f32 v58, v60, v61
v_cvt_pk_bf16_f32 v59, v62, v63
v_pk_fma_f32 v[80:81], v[144:145], v[12:13], v[80:81] op_sel:[0,0,0] op_sel_hi:[1,0,1]
v_pk_fma_f32 v[84:85], v[148:149], v[12:13], v[84:85] op_sel:[0,0,0] op_sel_hi:[1,0,1]
v_pk_fma_f32 v[82:83], v[146:147], v[12:13], v[82:83] op_sel:[0,0,0] op_sel_hi:[1,0,1]
v_pk_fma_f32 v[86:87], v[150:151], v[12:13], v[86:87] op_sel:[0,0,0] op_sel_hi:[1,0,1]
v_pk_mul_f32 v[24:25], v[80:81], v[4:5] op_sel:[0,0] op_sel_hi:[1,0]
v_pk_mul_f32 v[28:29], v[84:85], v[4:5] op_sel:[0,0] op_sel_hi:[1,0]
v_pk_mul_f32 v[26:27], v[82:83], v[4:5] op_sel:[0,0] op_sel_hi:[1,0]
v_pk_mul_f32 v[30:31], v[86:87], v[4:5] op_sel:[0,0] op_sel_hi:[1,0]
v_pk_fma_f32 v[80:81], v[80:81], v[132:133], s[82:83] op_sel:[0,0,0] op_sel_hi:[1,0,1]
v_pk_fma_f32 v[84:85], v[84:85], v[132:133], s[82:83] op_sel:[0,0,0] op_sel_hi:[1,0,1]
v_pk_fma_f32 v[82:83], v[82:83], v[132:133], s[82:83] op_sel:[0,0,0] op_sel_hi:[1,0,1]
v_pk_fma_f32 v[86:87], v[86:87], v[132:133], s[82:83] op_sel:[0,0,0] op_sel_hi:[1,0,1]
v_exp_f32_e64 v24, v24 clamp
v_exp_f32_e64 v28, v28 clamp
v_exp_f32_e64 v25, v25 clamp
v_exp_f32_e64 v29, v29 clamp
v_exp_f32_e64 v26, v26 clamp
v_exp_f32_e64 v30, v30 clamp
v_exp_f32_e64 v27, v27 clamp
v_exp_f32_e64 v31, v31 clamp
v_pk_add_f32 v[24:25], v[24:25], s[80:81]
v_pk_add_f32 v[28:29], v[28:29], s[80:81]
v_pk_add_f32 v[26:27], v[26:27], s[80:81]
v_pk_add_f32 v[30:31], v[30:31], s[80:81]
v_max_f32 v80, v80, v24
v_max_f32 v84, v84, v28
v_max_f32 v81, v81, v25
v_max_f32 v85, v85, v29
v_max_f32 v82, v82, v26
v_max_f32 v86, v86, v30
v_max_f32 v83, v83, v27
v_max_f32 v87, v87, v31
v_cvt_pk_bf16_f32 v80, v80, v81
v_cvt_pk_bf16_f32 v81, v82, v83
v_cvt_pk_bf16_f32 v82, v84, v85
v_cvt_pk_bf16_f32 v83, v86, v87
v_pk_fma_f32 v[104:105], v[144:145], v[14:15], v[104:105] op_sel:[0,0,0] op_sel_hi:[1,0,1]
v_pk_fma_f32 v[108:109], v[148:149], v[14:15], v[108:109] op_sel:[0,0,0] op_sel_hi:[1,0,1]
v_pk_fma_f32 v[106:107], v[146:147], v[14:15], v[106:107] op_sel:[0,0,0] op_sel_hi:[1,0,1]
v_pk_fma_f32 v[110:111], v[150:151], v[14:15], v[110:111] op_sel:[0,0,0] op_sel_hi:[1,0,1]
v_pk_mul_f32 v[24:25], v[104:105], v[6:7] op_sel:[0,0] op_sel_hi:[1,0]
v_pk_mul_f32 v[28:29], v[108:109], v[6:7] op_sel:[0,0] op_sel_hi:[1,0]
v_pk_mul_f32 v[26:27], v[106:107], v[6:7] op_sel:[0,0] op_sel_hi:[1,0]
v_pk_mul_f32 v[30:31], v[110:111], v[6:7] op_sel:[0,0] op_sel_hi:[1,0]
v_pk_fma_f32 v[104:105], v[104:105], v[134:135], s[82:83] op_sel:[0,0,0] op_sel_hi:[1,0,1]
v_pk_fma_f32 v[108:109], v[108:109], v[134:135], s[82:83] op_sel:[0,0,0] op_sel_hi:[1,0,1]
v_pk_fma_f32 v[106:107], v[106:107], v[134:135], s[82:83] op_sel:[0,0,0] op_sel_hi:[1,0,1]
v_pk_fma_f32 v[110:111], v[110:111], v[134:135], s[82:83] op_sel:[0,0,0] op_sel_hi:[1,0,1]
v_exp_f32_e64 v24, v24 clamp
v_exp_f32_e64 v28, v28 clamp
v_exp_f32_e64 v25, v25 clamp
v_exp_f32_e64 v29, v29 clamp
v_exp_f32_e64 v26, v26 clamp
v_exp_f32_e64 v30, v30 clamp
v_exp_f32_e64 v27, v27 clamp
v_exp_f32_e64 v31, v31 clamp
v_pk_add_f32 v[24:25], v[24:25], s[80:81]
v_pk_add_f32 v[28:29], v[28:29], s[80:81]
v_pk_add_f32 v[26:27], v[26:27], s[80:81]
v_pk_add_f32 v[30:31], v[30:31], s[80:81]
v_max_f32 v104, v104, v24
v_max_f32 v108, v108, v28
v_max_f32 v105, v105, v25
v_max_f32 v109, v109, v29
v_max_f32 v106, v106, v26
v_max_f32 v110, v110, v30
v_max_f32 v107, v107, v27
v_max_f32 v111, v111, v31
v_cvt_pk_bf16_f32 v104, v104, v105
v_cvt_pk_bf16_f32 v105, v106, v107
v_cvt_pk_bf16_f32 v106, v108, v109
v_cvt_pk_bf16_f32 v107, v110, v111
v_lshrrev_b32_e64 v2, 4, v1
v_bfe_u32 v3, v1, 2, 2
v_lshl_add_u32 v4, v2, 2, v3
v_lshlrev_b32 v5, 7, v4
v_bfe_u32 v4, v4, 1, 2
v_lshl_add_u32 v5, v4, 5, v5
v_and_b32 v4, 3, v1
v_lshl_add_u32 v5, v4, 3, v5
v_add_u32 v8, 28672, v5
v_xor_b32 v9, 32, v8
v_xor_b32 v10, 64, v8
v_xor_b32 v11, 96, v8
v_add_u32 v12, 65536, v8
v_add_u32 v13, 65536, v9
v_add_u32 v14, 65536, v10
v_add_u32 v15, 65536, v11
v_and_b32 v3, 15, v1
v_lshrrev_b32 v4, 1, v3
v_lshrrev_b32 v5, 1, v2
v_xor_b32 v4, v4, v5
v_lshlrev_b32 v4, 4, v4
v_lshl_add_u32 v4, v3, 7, v4
v_and_b32 v5, 1, v2
v_lshl_add_u32 v4, v5, 3, v4
s_lshl_b32 s70, s60, 12
v_add_u32 v20, s70, v4
v_xor_b32 v21, 32, v20
v_xor_b32 v22, 64, v20
v_xor_b32 v23, 96, v20
s_and_b32 s74, s64, 7
s_lshl_b32 s74, s74, 19
s_lshr_b32 s70, s64, 1
s_xor_b32 s70, s70, s64
s_and_b32 s70, s70, 4
s_lshl_b32 s70, s70, 11
s_xor_b32 s70, s70, 2105344
s_add_u32 s74, s74, s70
s_mul_i32 s70, s60, 131072
s_add_u32 s74, s74, s70
s_xor_b32 s74, s74, s61
v_add_u32 v6, s74, v16
v_add_u32 v19, 65536, v6
s_and_b32 s70, s89, 12
s_add_u32 s74, s89, s70
s_lshl_b32 s74, s74, 11
s_mul_i32 s70, s62, 5
s_add_u32 s70, s70, s65
s_mul_i32 s71, s70, 86
s_lshr_b32 s71, s71, 10
s_mul_i32 s71, s71, 12
s_sub_u32 s70, s70, s71
s_lshl_b32 s70, s70, 2
s_mov_b32 s0, 0x98765410
s_mov_b32 s1, 0xfedc
s_sub_u32 s71, 48, s70
s_lshl_b64 s[72:73], s[0:1], s71
s_lshr_b64 s[0:1], s[0:1], s70
s_or_b64 s[0:1], s[0:1], s[72:73]
s_lshl_b64 s[0:1], s[0:1], 16
s_or_b32 s0, s0, 0x2ab3
s_bfe_u32 s70, s0, 0x40000
s_and_b32 s71, s70, 12
s_add_u32 s70, s70, s71
s_lshl_b32 s24, s70, 11
s_bfe_u32 s70, s0, 0x40004
s_and_b32 s71, s70, 12
s_add_u32 s70, s70, s71
s_lshl_b32 s25, s70, 11
s_bfe_u32 s70, s0, 0x40008
s_and_b32 s71, s70, 12
s_add_u32 s70, s70, s71
s_lshl_b32 s26, s70, 11
s_bfe_u32 s70, s0, 0x4000c
s_and_b32 s71, s70, 12
s_add_u32 s70, s70, s71
s_lshl_b32 s27, s70, 11
s_bfe_u32 s70, s0, 0x40010
s_and_b32 s71, s70, 12
s_add_u32 s70, s70, s71
s_lshl_b32 s28, s70, 11
s_bfe_u32 s70, s0, 0x40014
s_and_b32 s71, s70, 12
s_add_u32 s70, s70, s71
s_lshl_b32 s29, s70, 11
s_bfe_u32 s70, s0, 0x40018
s_and_b32 s71, s70, 12
s_add_u32 s70, s70, s71
s_lshl_b32 s30, s70, 11
s_bfe_u32 s70, s0, 0x4001c
s_and_b32 s71, s70, 12
s_add_u32 s70, s70, s71
s_lshl_b32 s31, s70, 11
s_bfe_u32 s70, s1, 0x40000
s_and_b32 s71, s70, 12
s_add_u32 s70, s70, s71
s_lshl_b32 s32, s70, 11
s_bfe_u32 s70, s1, 0x40004
s_and_b32 s71, s70, 12
s_add_u32 s70, s70, s71
s_lshl_b32 s33, s70, 11
s_bfe_u32 s70, s1, 0x40008
s_and_b32 s71, s70, 12
s_add_u32 s70, s70, s71
s_lshl_b32 s34, s70, 11
s_bfe_u32 s70, s1, 0x4000c
s_and_b32 s71, s70, 12
s_add_u32 s70, s70, s71
s_lshl_b32 s35, s70, 11
s_bfe_u32 s70, s1, 0x40010
s_and_b32 s71, s70, 12
s_add_u32 s70, s70, s71
s_lshl_b32 s36, s70, 11
s_bfe_u32 s70, s1, 0x40014
s_and_b32 s71, s70, 12
s_add_u32 s70, s70, s71
s_lshl_b32 s37, s70, 11
s_bfe_u32 s70, s1, 0x40018
s_and_b32 s71, s70, 12
s_add_u32 s70, s70, s71
s_lshl_b32 s38, s70, 11
s_bfe_u32 s70, s1, 0x4001c
s_and_b32 s71, s70, 12
s_add_u32 s70, s70, s71
s_lshl_b32 s39, s70, 11
L_E2:
s_barrier
ds_read_b128 a[8:11], v18
buffer_load_dwordx4 v[136:139], v17, s[12:15], 0 offen sc1
buffer_load_dwordx4 v[140:143], v17, s[12:15], 0 offen offset:1024 sc1
s_waitcnt lgkmcnt(0)
v_mfma_f32_16x16x32_bf16 v[48:51], a[8:11], v[32:35], 0
v_mfma_f32_16x16x32_bf16 v[72:75], a[8:11], v[56:59], 0
v_mfma_f32_16x16x32_bf16 v[96:99], a[8:11], v[80:83], 0
v_mfma_f32_16x16x32_bf16 v[120:123], a[8:11], v[104:107], 0
s_branch L_over6
L_pad6:
s_branch L_retF
L_over6:
s_nop 4
v_add_f32 v48, s80, v48
v_rcp_f32 v48, v48
v_add_f32 v72, s80, v72
v_rcp_f32 v72, v72
v_add_f32 v96, s80, v96
v_rcp_f32 v96, v96
v_add_f32 v120, s80, v120
v_rcp_f32 v120, v120
s_waitcnt vmcnt(0)
L_k2_chk:
v_max_u32 v2, v136, v140
v_cmp_eq_u32 vcc, -1, v2
s_cbranch_vccnz L_k2_rt
L_k2_ok:
v_mfma_f32_16x16x32_bf16 v[40:43], v[136:139], v[32:35], 0
v_mfma_f32_16x16x32_bf16 v[44:47], v[140:143], v[32:35], 0
v_mfma_f32_16x16x32_bf16 v[64:67], v[136:139], v[56:59], 0
v_mfma_f32_16x16x32_bf16 v[68:71], v[140:143], v[56:59], 0
v_mfma_f32_16x16x32_bf16 v[88:91], v[136:139], v[80:83], 0
v_mfma_f32_16x16x32_bf16 v[92:95], v[140:143], v[80:83], 0
v_mfma_f32_16x16x32_bf16 v[112:115], v[136:139], v[104:107], 0
v_mfma_f32_16x16x32_bf16 v[116:119], v[140:143], v[104:107], 0
s_lshr_b32 s71, s65, 1
s_xor_b32 s71, s71, s62
s_xor_b32 s70, s69, 1
s_or_b32 s71, s71, s70
v_pk_mul_f32 v[40:41], v[40:41], v[48:49] op_sel_hi:[1,0]
v_pk_mul_f32 v[42:43], v[42:43], v[48:49] op_sel_hi:[1,0]
v_pk_mul_f32 v[44:45], v[44:45], v[48:49] op_sel_hi:[1,0]
v_pk_mul_f32 v[46:47], v[46:47], v[48:49] op_sel_hi:[1,0]
v_cvt_pk_bf16_f32 v52, v40, v41
v_cvt_pk_bf16_f32 v53, v42, v43
v_cvt_pk_bf16_f32 v54, v44, v45
v_cvt_pk_bf16_f32 v55, v46, v47
s_add_u32 s70, s88, 0
s_cmp_eq_u32 s71, 0
s_cbranch_scc1 L_oown0
buffer_store_dwordx4 v[52:55], v16, s[12:15], s70 offen sc1
L_ood0:
v_pk_mul_f32 v[64:65], v[64:65], v[72:73] op_sel_hi:[1,0]
v_pk_mul_f32 v[66:67], v[66:67], v[72:73] op_sel_hi:[1,0]
v_pk_mul_f32 v[68:69], v[68:69], v[72:73] op_sel_hi:[1,0]
v_pk_mul_f32 v[70:71], v[70:71], v[72:73] op_sel_hi:[1,0]
v_cvt_pk_bf16_f32 v76, v64, v65
v_cvt_pk_bf16_f32 v77, v66, v67
v_cvt_pk_bf16_f32 v78, v68, v69
v_cvt_pk_bf16_f32 v79, v70, v71
s_add_u32 s70, s88, 65536
s_cmp_eq_u32 s71, 0
s_cbranch_scc1 L_oown1
buffer_store_dwordx4 v[76:79], v16, s[12:15], s70 offen sc1
L_ood1:
v_pk_mul_f32 v[88:89], v[88:89], v[96:97] op_sel_hi:[1,0]
v_pk_mul_f32 v[90:91], v[90:91], v[96:97] op_sel_hi:[1,0]
v_pk_mul_f32 v[92:93], v[92:93], v[96:97] op_sel_hi:[1,0]
v_pk_mul_f32 v[94:95], v[94:95], v[96:97] op_sel_hi:[1,0]
v_cvt_pk_bf16_f32 v100, v88, v89
v_cvt_pk_bf16_f32 v101, v90, v91
v_cvt_pk_bf16_f32 v102, v92, v93
v_cvt_pk_bf16_f32 v103, v94, v95
s_add_u32 s70, s88, 131072
s_cmp_eq_u32 s71, 0
s_cbranch_scc1 L_oown2
buffer_store_dwordx4 v[100:103], v16, s[12:15], s70 offen sc1
L_ood2:
v_pk_mul_f32 v[112:113], v[112:113], v[120:121] op_sel_hi:[1,0]
v_pk_mul_f32 v[114:115], v[114:115], v[120:121] op_sel_hi:[1,0]
v_pk_mul_f32 v[116:117], v[116:117], v[120:121] op_sel_hi:[1,0]
v_pk_mul_f32 v[118:119], v[118:119], v[120:121] op_sel_hi:[1,0]
v_cvt_pk_bf16_f32 v124, v112, v113
v_cvt_pk_bf16_f32 v125, v114, v115
v_cvt_pk_bf16_f32 v126, v116, v117
v_cvt_pk_bf16_f32 v127, v118, v119
s_add_u32 s70, s88, 196608
s_cmp_eq_u32 s71, 0
s_cbranch_scc1 L_oown3
buffer_store_dwordx4 v[124:127], v16, s[12:15], s70 offen sc1
L_ood3:
v_xor_b32_e64 v7, s76, v7
buffer_load_dwordx4 v[56:59], v6, s[12:15], s24 offen offset:0 sc1
buffer_load_dwordx4 v[60:63], v19, s[12:15], s24 offen offset:0 sc1
buffer_load_dwordx4 v[64:67], v6, s[12:15], s24 offen offset:1024 sc1
buffer_load_dwordx4 v[68:71], v19, s[12:15], s24 offen offset:1024 sc1
s_barrier
ds_read_b64 v[26:27], v20 offset:0
ds_read_b64 v[30:31], v21 offset:0
ds_read_b64 v[34:35], v22 offset:0
ds_read_b64 v[38:39], v23 offset:0
ds_read_b64 v[42:43], v20 offset:2048
ds_read_b64 v[46:47], v21 offset:2048
ds_read_b64 v[50:51], v22 offset:2048
ds_read_b64 v[54:55], v23 offset:2048
s_waitcnt lgkmcnt(0)
ds_read_b64_tr_b16 a[0:1], v8 offset:0
ds_read_b64_tr_b16 a[2:3], v8 offset:2048
ds_read_b64_tr_b16 a[4:5], v9 offset:0
ds_read_b64_tr_b16 a[6:7], v9 offset:2048
ds_read_b64_tr_b16 a[8:9], v10 offset:0
ds_read_b64_tr_b16 a[10:11], v10 offset:2048
ds_read_b64_tr_b16 a[12:13], v11 offset:0
ds_read_b64_tr_b16 a[14:15], v11 offset:2048
ds_read_b64_tr_b16 a[16:17], v8 offset:4096
ds_read_b64_tr_b16 a[18:19], v8 offset:6144
ds_read_b64_tr_b16 a[20:21], v9 offset:4096
ds_read_b64_tr_b16 a[22:23], v9 offset:6144
ds_read_b64_tr_b16 a[24:25], v10 offset:4096
ds_read_b64_tr_b16 a[26:27], v10 offset:6144
ds_read_b64_tr_b16 a[28:29], v11 offset:4096
ds_read_b64_tr_b16 a[30:31], v11 offset:6144
v_lshlrev_b32 v24, 16, v26
v_and_b32 v25, 0xffff0000, v26
v_lshlrev_b32 v26, 16, v27
v_and_b32 v27, 0xffff0000, v27
v_lshlrev_b32 v28, 16, v30
v_and_b32 v29, 0xffff0000, v30
v_lshlrev_b32 v30, 16, v31
v_and_b32 v31, 0xffff0000, v31
v_lshlrev_b32 v32, 16, v34
v_and_b32 v33, 0xffff0000, v34
v_lshlrev_b32 v34, 16, v35
v_and_b32 v35, 0xffff0000, v35
v_lshlrev_b32 v36, 16, v38
v_and_b32 v37, 0xffff0000, v38
v_lshlrev_b32 v38, 16, v39
v_and_b32 v39, 0xffff0000, v39
v_lshlrev_b32 v40, 16, v42
v_and_b32 v41, 0xffff0000, v42
v_lshlrev_b32 v42, 16, v43
v_and_b32 v43, 0xffff0000, v43
v_lshlrev_b32 v44, 16, v46
v_and_b32 v45, 0xffff0000, v46
v_lshlrev_b32 v46, 16, v47
v_and_b32 v47, 0xffff0000, v47
v_lshlrev_b32 v48, 16, v50
v_and_b32 v49, 0xffff0000, v50
v_lshlrev_b32 v50, 16, v51
v_and_b32 v51, 0xffff0000, v51
v_lshlrev_b32 v52, 16, v54
v_and_b32 v53, 0xffff0000, v54
v_lshlrev_b32 v54, 16, v55
v_and_b32 v55, 0xffff0000, v55
v_lshrrev_b32 v2, 4, v1
v_lshlrev_b32 v2, 3, v2
v_add_u32 v2, 162048, v2
v_mov_b32 v3, 162176
ds_read_b64 v[136:137], v2 offset:0
ds_read_b64 v[138:139], v2 offset:32
ds_read_b64 v[140:141], v2 offset:64
ds_read_b64 v[142:143], v2 offset:96
ds_read_b128 v[148:151], v3
s_waitcnt lgkmcnt(0)
v_add_f32 v148, v148, v149
v_add_f32 v150, v150, v151
v_add_f32 v148, v148, v150
s_nop 0
v_readfirstlane_b32 s84, v148
v_and_b32 v2, 3, v1
v_cmp_eq_u32 vcc, 0, v2
v_mov_b32 v3, 0x3f803f80
s_nop 0
v_cndmask_b32 v3, 0, v3, vcc
v_cmp_eq_u32_e64 vcc, 2, v2
s_nop 1
v_cndmask_b32 v120, v3, v136, vcc
v_cndmask_b32 v121, v3, v137, vcc
v_cndmask_b32 v122, v3, v138, vcc
v_cndmask_b32 v123, v3, v139, vcc
v_cndmask_b32 v124, v3, v140, vcc
v_cndmask_b32 v125, v3, v141, vcc
v_cndmask_b32 v126, v3, v142, vcc
v_cndmask_b32 v127, v3, v143, vcc
v_and_b32 v2, 15, v1
v_lshrrev_b32 v3, 5, v1
v_lshlrev_b32 v4, 4, v2
v_mov_b32 v144, v4
s_lshl_b32 s75, s64, 15
s_lshl_b32 s70, s60, 9
s_add_u32 s75, s75, s70
s_add_u32 s75, s75, 6291456
s_lshl_b32 s70, s65, 11
s_add_u32 s72, s75, s70
s_mov_b32 s92, 0x00f0000f
s_mov_b32 s93, 0xf0000f00
s_mov_b32 s80, 0x22222222
s_mov_b32 s81, 0x22222222
s_mov_b32 s82, 0x44444444
s_mov_b32 s83, 0x44444444
s_mov_b32 s90, 0x88888888
s_mov_b32 s91, 0x88888888
v_and_b32_e64 v2, 31, v1
v_lshlrev_b32 v5, 4, v2
v_lshl_add_u32 v145, v3, 11, v5
s_lshl_b32 s70, s64, 7
s_lshl_b32 s71, s60, 5
s_add_u32 s70, s70, s71
s_add_u32 s87, s70, 6815744
s_lshr_b32 s70, s70, 4
v_lshl_add_u32 v146, v2, 7, s70
s_lshl_b32 s70, s64, 2
s_add_u32 s70, s70, s60
s_lshl_b32 s70, s70, 15
s_lshl_b32 s71, s65, 7
s_add_u32 s70, s70, s71
s_add_u32 s88, s70, 8388608
v_bfe_u32 v2, v1, 3, 1
v_and_b32 v3, 7, v1
v_lshlrev_b32 v147, 14, v2
v_lshl_add_u32 v147, v3, 4, v147
v_bfe_u32 v2, v1, 4, 1
v_lshl_add_u32 v147, v2, 13, v147
buffer_load_dwordx4 v[72:75], v6, s[12:15], s25 offen offset:0 sc1
buffer_load_dwordx4 v[76:79], v19, s[12:15], s25 offen offset:0 sc1
buffer_load_dwordx4 v[80:83], v6, s[12:15], s25 offen offset:1024 sc1
buffer_load_dwordx4 v[84:87], v19, s[12:15], s25 offen offset:1024 sc1
buffer_load_dwordx4 v[88:91], v6, s[12:15], s26 offen offset:0 sc1
buffer_load_dwordx4 v[92:95], v19, s[12:15], s26 offen offset:0 sc1
buffer_load_dwordx4 v[96:99], v6, s[12:15], s26 offen offset:1024 sc1
buffer_load_dwordx4 v[100:103], v19, s[12:15], s26 offen offset:1024 sc1
s_waitcnt vmcnt(8)
v_max3_u32 v2, v56, v60, v64
v_max_u32 v2, v2, v68
v_cmp_eq_u32_e64 vcc, -1, v2
s_cbranch_vccnz L_o0_rt
L_o0_ok:
s_waitcnt lgkmcnt(8)
v_mfma_f32_16x16x32_bf16 v[24:27], a[0:3], v[56:59], v[24:27]
ds_read_b64_tr_b16 a[32:33], v8 offset:8192
ds_read_b64_tr_b16 a[34:35], v8 offset:10240
v_mfma_f32_16x16x32_bf16 v[40:43], a[0:3], v[60:63], v[40:43]
buffer_load_dwordx4 v[104:107], v6, s[12:15], s27 offen offset:0 sc1
v_mfma_f32_16x16x32_bf16 v[28:31], a[4:7], v[56:59], v[28:31]
ds_read_b64_tr_b16 a[36:37], v9 offset:8192
ds_read_b64_tr_b16 a[38:39], v9 offset:10240
v_mfma_f32_16x16x32_bf16 v[44:47], a[4:7], v[60:63], v[44:47]
buffer_load_dwordx4 v[108:111], v19, s[12:15], s27 offen offset:0 sc1
v_mfma_f32_16x16x32_bf16 v[32:35], a[8:11], v[56:59], v[32:35]
ds_read_b64_tr_b16 a[40:41], v10 offset:8192
ds_read_b64_tr_b16 a[42:43], v10 offset:10240
v_mfma_f32_16x16x32_bf16 v[48:51], a[8:11], v[60:63], v[48:51]
buffer_load_dwordx4 v[112:115], v6, s[12:15], s27 offen offset:1024 sc1
v_mfma_f32_16x16x32_bf16 v[36:39], a[12:15], v[56:59], v[36:39]
ds_read_b64_tr_b16 a[44:45], v11 offset:8192
ds_read_b64_tr_b16 a[46:47], v11 offset:10240
v_mfma_f32_16x16x32_bf16 v[52:55], a[12:15], v[60:63], v[52:55]
buffer_load_dwordx4 v[116:119], v19, s[12:15], s27 offen offset:1024 sc1
s_waitcnt lgkmcnt(8)
v_mfma_f32_16x16x32_bf16 v[24:27], a[16:19], v[64:67], v[24:27]
ds_read_b64_tr_b16 a[0:1], v8 offset:12288
s_waitcnt vmcnt(8)
v_mfma_f32_16x16x32_bf16 v[40:43], a[16:19], v[68:71], v[40:43]
ds_read_b64_tr_b16 a[2:3], v8 offset:14336
v_max3_u32 v2, v72, v76, v80
v_mfma_f32_16x16x32_bf16 v[28:31], a[20:23], v[64:67], v[28:31]
ds_read_b64_tr_b16 a[4:5], v9 offset:12288
v_max_u32 v2, v2, v84
v_mfma_f32_16x16x32_bf16 v[44:47], a[20:23], v[68:71], v[44:47]
ds_read_b64_tr_b16 a[6:7], v9 offset:14336
v_cmp_eq_u32 vcc, -1, v2
v_mfma_f32_16x16x32_bf16 v[32:35], a[24:27], v[64:67], v[32:35]
ds_read_b64_tr_b16 a[8:9], v10 offset:12288
v_mfma_f32_16x16x32_bf16 v[48:51], a[24:27], v[68:71], v[48:51]
ds_read_b64_tr_b16 a[10:11], v10 offset:14336
v_mfma_f32_16x16x32_bf16 v[36:39], a[28:31], v[64:67], v[36:39]
ds_read_b64_tr_b16 a[12:13], v11 offset:12288
ds_read_b64_tr_b16 a[14:15], v11 offset:14336
v_mfma_f32_16x16x32_bf16 v[52:55], a[28:31], v[68:71], v[52:55]
s_cbranch_vccnz L_o1_rt
L_o1_ok:
s_waitcnt lgkmcnt(8)
v_mfma_f32_16x16x32_bf16 v[24:27], a[32:35], v[72:75], v[24:27]
ds_read_b64_tr_b16 a[16:17], v8 offset:16384
ds_read_b64_tr_b16 a[18:19], v8 offset:18432
v_mfma_f32_16x16x32_bf16 v[40:43], a[32:35], v[76:79], v[40:43]
buffer_load_dwordx4 v[56:59], v6, s[12:15], s28 offen offset:0 sc1
v_mfma_f32_16x16x32_bf16 v[28:31], a[36:39], v[72:75], v[28:31]
ds_read_b64_tr_b16 a[20:21], v9 offset:16384
ds_read_b64_tr_b16 a[22:23], v9 offset:18432
v_mfma_f32_16x16x32_bf16 v[44:47], a[36:39], v[76:79], v[44:47]
buffer_load_dwordx4 v[60:63], v19, s[12:15], s28 offen offset:0 sc1
v_mfma_f32_16x16x32_bf16 v[32:35], a[40:43], v[72:75], v[32:35]
ds_read_b64_tr_b16 a[24:25], v10 offset:16384
ds_read_b64_tr_b16 a[26:27], v10 offset:18432
v_mfma_f32_16x16x32_bf16 v[48:51], a[40:43], v[76:79], v[48:51]
buffer_load_dwordx4 v[64:67], v6, s[12:15], s28 offen offset:1024 sc1
v_mfma_f32_16x16x32_bf16 v[36:39], a[44:47], v[72:75], v[36:39]
ds_read_b64_tr_b16 a[28:29], v11 offset:16384
ds_read_b64_tr_b16 a[30:31], v11 offset:18432
v_mfma_f32_16x16x32_bf16 v[52:55], a[44:47], v[76:79], v[52:55]
buffer_load_dwordx4 v[68:71], v19, s[12:15], s28 offen offset:1024 sc1
s_waitcnt lgkmcnt(8)
v_mfma_f32_16x16x32_bf16 v[24:27], a[0:3], v[80:83], v[24:27]
ds_read_b64_tr_b16 a[32:33], v8 offset:20480
s_waitcnt vmcnt(8)
v_mfma_f32_16x16x32_bf16 v[40:43], a[0:3], v[84:87], v[40:43]
ds_read_b64_tr_b16 a[34:35], v8 offset:22528
v_max3_u32 v2, v88, v92, v96
v_mfma_f32_16x16x32_bf16 v[28:31], a[4:7], v[80:83], v[28:31]
ds_read_b64_tr_b16 a[36:37], v9 offset:20480
v_max_u32 v2, v2, v100
v_mfma_f32_16x16x32_bf16 v[44:47], a[4:7], v[84:87], v[44:47]
ds_read_b64_tr_b16 a[38:39], v9 offset:22528
v_cmp_eq_u32 vcc, -1, v2
v_mfma_f32_16x16x32_bf16 v[32:35], a[8:11], v[80:83], v[32:35]
ds_read_b64_tr_b16 a[40:41], v10 offset:20480
v_mfma_f32_16x16x32_bf16 v[48:51], a[8:11], v[84:87], v[48:51]
ds_read_b64_tr_b16 a[42:43], v10 offset:22528
v_mfma_f32_16x16x32_bf16 v[36:39], a[12:15], v[80:83], v[36:39]
ds_read_b64_tr_b16 a[44:45], v11 offset:20480
ds_read_b64_tr_b16 a[46:47], v11 offset:22528
v_mfma_f32_16x16x32_bf16 v[52:55], a[12:15], v[84:87], v[52:55]
s_cbranch_vccnz L_o2_rt
L_o2_ok:
s_waitcnt lgkmcnt(8)
v_mfma_f32_16x16x32_bf16 v[24:27], a[16:19], v[88:91], v[24:27]
ds_read_b64_tr_b16 a[0:1], v8 offset:24576
ds_read_b64_tr_b16 a[2:3], v8 offset:26624
v_mfma_f32_16x16x32_bf16 v[40:43], a[16:19], v[92:95], v[40:43]
buffer_load_dwordx4 v[72:75], v6, s[12:15], s29 offen offset:0 sc1
v_mfma_f32_16x16x32_bf16 v[28:31], a[20:23], v[88:91], v[28:31]
ds_read_b64_tr_b16 a[4:5], v9 offset:24576
ds_read_b64_tr_b16 a[6:7], v9 offset:26624
v_mfma_f32_16x16x32_bf16 v[44:47], a[20:23], v[92:95], v[44:47]
buffer_load_dwordx4 v[76:79], v19, s[12:15], s29 offen offset:0 sc1
v_mfma_f32_16x16x32_bf16 v[32:35], a[24:27], v[88:91], v[32:35]
ds_read_b64_tr_b16 a[8:9], v10 offset:24576
ds_read_b64_tr_b16 a[10:11], v10 offset:26624
v_mfma_f32_16x16x32_bf16 v[48:51], a[24:27], v[92:95], v[48:51]
buffer_load_dwordx4 v[80:83], v6, s[12:15], s29 offen offset:1024 sc1
v_mfma_f32_16x16x32_bf16 v[36:39], a[28:31], v[88:91], v[36:39]
ds_read_b64_tr_b16 a[12:13], v11 offset:24576
ds_read_b64_tr_b16 a[14:15], v11 offset:26624
v_mfma_f32_16x16x32_bf16 v[52:55], a[28:31], v[92:95], v[52:55]
buffer_load_dwordx4 v[84:87], v19, s[12:15], s29 offen offset:1024 sc1
s_waitcnt lgkmcnt(8)
v_mfma_f32_16x16x32_bf16 v[24:27], a[32:35], v[96:99], v[24:27]
ds_read_b64_tr_b16 a[16:17], v8 offset:28672
s_waitcnt vmcnt(8)
v_mfma_f32_16x16x32_bf16 v[40:43], a[32:35], v[100:103], v[40:43]
ds_read_b64_tr_b16 a[18:19], v8 offset:30720
v_max3_u32 v2, v104, v108, v112
v_mfma_f32_16x16x32_bf16 v[28:31], a[36:39], v[96:99], v[28:31]
ds_read_b64_tr_b16 a[20:21], v9 offset:28672
v_max_u32 v2, v2, v116
v_mfma_f32_16x16x32_bf16 v[44:47], a[36:39], v[100:103], v[44:47]
ds_read_b64_tr_b16 a[22:23], v9 offset:30720
v_cmp_eq_u32 vcc, -1, v2
v_mfma_f32_16x16x32_bf16 v[32:35], a[40:43], v[96:99], v[32:35]
ds_read_b64_tr_b16 a[24:25], v10 offset:28672
v_mfma_f32_16x16x32_bf16 v[48:51], a[40:43], v[100:103], v[48:51]
ds_read_b64_tr_b16 a[26:27], v10 offset:30720
v_mfma_f32_16x16x32_bf16 v[36:39], a[44:47], v[96:99], v[36:39]
ds_read_b64_tr_b16 a[28:29], v11 offset:28672
ds_read_b64_tr_b16 a[30:31], v11 offset:30720
v_mfma_f32_16x16x32_bf16 v[52:55], a[44:47], v[100:103], v[52:55]
s_cbranch_vccnz L_o3_rt
L_o3_ok:
s_waitcnt lgkmcnt(8)
v_mfma_f32_16x16x32_bf16 v[24:27], a[0:3], v[104:107], v[24:27]
ds_read_b64_tr_b16 a[32:33], v8 offset:32768
ds_read_b64_tr_b16 a[34:35], v8 offset:34816
v_mfma_f32_16x16x32_bf16 v[40:43], a[0:3], v[108:111], v[40:43]
buffer_load_dwordx4 v[88:91], v6, s[12:15], s30 offen offset:0 sc1
v_mfma_f32_16x16x32_bf16 v[28:31], a[4:7], v[104:107], v[28:31]
ds_read_b64_tr_b16 a[36:37], v9 offset:32768
ds_read_b64_tr_b16 a[38:39], v9 offset:34816
v_mfma_f32_16x16x32_bf16 v[44:47], a[4:7], v[108:111], v[44:47]
buffer_load_dwordx4 v[92:95], v19, s[12:15], s30 offen offset:0 sc1
v_mfma_f32_16x16x32_bf16 v[32:35], a[8:11], v[104:107], v[32:35]
ds_read_b64_tr_b16 a[40:41], v10 offset:32768
ds_read_b64_tr_b16 a[42:43], v10 offset:34816
v_mfma_f32_16x16x32_bf16 v[48:51], a[8:11], v[108:111], v[48:51]
buffer_load_dwordx4 v[96:99], v6, s[12:15], s30 offen offset:1024 sc1
v_mfma_f32_16x16x32_bf16 v[36:39], a[12:15], v[104:107], v[36:39]
ds_read_b64_tr_b16 a[44:45], v11 offset:32768
ds_read_b64_tr_b16 a[46:47], v11 offset:34816
v_mfma_f32_16x16x32_bf16 v[52:55], a[12:15], v[108:111], v[52:55]
buffer_load_dwordx4 v[100:103], v19, s[12:15], s30 offen offset:1024 sc1
s_waitcnt lgkmcnt(8)
v_mfma_f32_16x16x32_bf16 v[24:27], a[16:19], v[112:115], v[24:27]
ds_read_b64_tr_b16 a[0:1], v8 offset:36864
s_waitcnt vmcnt(8)
v_mfma_f32_16x16x32_bf16 v[40:43], a[16:19], v[116:119], v[40:43]
ds_read_b64_tr_b16 a[2:3], v8 offset:38912
v_max3_u32 v2, v56, v60, v64
v_mfma_f32_16x16x32_bf16 v[28:31], a[20:23], v[112:115], v[28:31]
ds_read_b64_tr_b16 a[4:5], v9 offset:36864
v_max_u32 v2, v2, v68
v_mfma_f32_16x16x32_bf16 v[44:47], a[20:23], v[116:119], v[44:47]
ds_read_b64_tr_b16 a[6:7], v9 offset:38912
v_cmp_eq_u32 vcc, -1, v2
v_mfma_f32_16x16x32_bf16 v[32:35], a[24:27], v[112:115], v[32:35]
ds_read_b64_tr_b16 a[8:9], v10 offset:36864
v_mfma_f32_16x16x32_bf16 v[48:51], a[24:27], v[116:119], v[48:51]
ds_read_b64_tr_b16 a[10:11], v10 offset:38912
v_mfma_f32_16x16x32_bf16 v[36:39], a[28:31], v[112:115], v[36:39]
ds_read_b64_tr_b16 a[12:13], v11 offset:36864
ds_read_b64_tr_b16 a[14:15], v11 offset:38912
v_mfma_f32_16x16x32_bf16 v[52:55], a[28:31], v[116:119], v[52:55]
s_cbranch_vccnz L_o4_rt
L_o4_ok:
s_waitcnt lgkmcnt(8)
v_mfma_f32_16x16x32_bf16 v[24:27], a[32:35], v[56:59], v[24:27]
ds_read_b64_tr_b16 a[16:17], v8 offset:40960
ds_read_b64_tr_b16 a[18:19], v8 offset:43008
v_mfma_f32_16x16x32_bf16 v[40:43], a[32:35], v[60:63], v[40:43]
buffer_load_dwordx4 v[104:107], v6, s[12:15], s31 offen offset:0 sc1
v_mfma_f32_16x16x32_bf16 v[28:31], a[36:39], v[56:59], v[28:31]
ds_read_b64_tr_b16 a[20:21], v9 offset:40960
ds_read_b64_tr_b16 a[22:23], v9 offset:43008
v_mfma_f32_16x16x32_bf16 v[44:47], a[36:39], v[60:63], v[44:47]
buffer_load_dwordx4 v[108:111], v19, s[12:15], s31 offen offset:0 sc1
v_mfma_f32_16x16x32_bf16 v[32:35], a[40:43], v[56:59], v[32:35]
ds_read_b64_tr_b16 a[24:25], v10 offset:40960
ds_read_b64_tr_b16 a[26:27], v10 offset:43008
v_mfma_f32_16x16x32_bf16 v[48:51], a[40:43], v[60:63], v[48:51]
buffer_load_dwordx4 v[112:115], v6, s[12:15], s31 offen offset:1024 sc1
v_mfma_f32_16x16x32_bf16 v[36:39], a[44:47], v[56:59], v[36:39]
ds_read_b64_tr_b16 a[28:29], v11 offset:40960
ds_read_b64_tr_b16 a[30:31], v11 offset:43008
v_mfma_f32_16x16x32_bf16 v[52:55], a[44:47], v[60:63], v[52:55]
buffer_load_dwordx4 v[116:119], v19, s[12:15], s31 offen offset:1024 sc1
s_waitcnt lgkmcnt(8)
v_mfma_f32_16x16x32_bf16 v[24:27], a[0:3], v[64:67], v[24:27]
ds_read_b64_tr_b16 a[32:33], v8 offset:45056
s_waitcnt vmcnt(8)
v_mfma_f32_16x16x32_bf16 v[40:43], a[0:3], v[68:71], v[40:43]
ds_read_b64_tr_b16 a[34:35], v8 offset:47104
v_max3_u32 v2, v72, v76, v80
v_mfma_f32_16x16x32_bf16 v[28:31], a[4:7], v[64:67], v[28:31]
ds_read_b64_tr_b16 a[36:37], v9 offset:45056
v_max_u32 v2, v2, v84
v_mfma_f32_16x16x32_bf16 v[44:47], a[4:7], v[68:71], v[44:47]
ds_read_b64_tr_b16 a[38:39], v9 offset:47104
v_cmp_eq_u32 vcc, -1, v2
v_mfma_f32_16x16x32_bf16 v[32:35], a[8:11], v[64:67], v[32:35]
ds_read_b64_tr_b16 a[40:41], v10 offset:45056
v_mfma_f32_16x16x32_bf16 v[48:51], a[8:11], v[68:71], v[48:51]
ds_read_b64_tr_b16 a[42:43], v10 offset:47104
v_mfma_f32_16x16x32_bf16 v[36:39], a[12:15], v[64:67], v[36:39]
ds_read_b64_tr_b16 a[44:45], v11 offset:45056
ds_read_b64_tr_b16 a[46:47], v11 offset:47104
v_mfma_f32_16x16x32_bf16 v[52:55], a[12:15], v[68:71], v[52:55]
s_cbranch_vccnz L_o5_rt
L_o5_ok:
s_waitcnt lgkmcnt(8)
v_mfma_f32_16x16x32_bf16 v[24:27], a[16:19], v[72:75], v[24:27]
ds_read_b64_tr_b16 a[0:1], v8 offset:49152
ds_read_b64_tr_b16 a[2:3], v8 offset:51200
v_mfma_f32_16x16x32_bf16 v[40:43], a[16:19], v[76:79], v[40:43]
buffer_load_dwordx4 v[56:59], v6, s[12:15], s32 offen offset:0 sc1
v_mfma_f32_16x16x32_bf16 v[28:31], a[20:23], v[72:75], v[28:31]
ds_read_b64_tr_b16 a[4:5], v9 offset:49152
ds_read_b64_tr_b16 a[6:7], v9 offset:51200
v_mfma_f32_16x16x32_bf16 v[44:47], a[20:23], v[76:79], v[44:47]
buffer_load_dwordx4 v[60:63], v19, s[12:15], s32 offen offset:0 sc1
v_mfma_f32_16x16x32_bf16 v[32:35], a[24:27], v[72:75], v[32:35]
ds_read_b64_tr_b16 a[8:9], v10 offset:49152
ds_read_b64_tr_b16 a[10:11], v10 offset:51200
v_mfma_f32_16x16x32_bf16 v[48:51], a[24:27], v[76:79], v[48:51]
buffer_load_dwordx4 v[64:67], v6, s[12:15], s32 offen offset:1024 sc1
v_mfma_f32_16x16x32_bf16 v[36:39], a[28:31], v[72:75], v[36:39]
ds_read_b64_tr_b16 a[12:13], v11 offset:49152
ds_read_b64_tr_b16 a[14:15], v11 offset:51200
v_mfma_f32_16x16x32_bf16 v[52:55], a[28:31], v[76:79], v[52:55]
buffer_load_dwordx4 v[68:71], v19, s[12:15], s32 offen offset:1024 sc1
s_waitcnt lgkmcnt(8)
v_mfma_f32_16x16x32_bf16 v[24:27], a[32:35], v[80:83], v[24:27]
ds_read_b64_tr_b16 a[16:17], v8 offset:53248
s_waitcnt vmcnt(8)
v_mfma_f32_16x16x32_bf16 v[40:43], a[32:35], v[84:87], v[40:43]
ds_read_b64_tr_b16 a[18:19], v8 offset:55296
v_max3_u32 v2, v88, v92, v96
v_mfma_f32_16x16x32_bf16 v[28:31], a[36:39], v[80:83], v[28:31]
ds_read_b64_tr_b16 a[20:21], v9 offset:53248
v_max_u32 v2, v2, v100
v_mfma_f32_16x16x32_bf16 v[44:47], a[36:39], v[84:87], v[44:47]
ds_read_b64_tr_b16 a[22:23], v9 offset:55296
v_cmp_eq_u32 vcc, -1, v2
v_mfma_f32_16x16x32_bf16 v[32:35], a[40:43], v[80:83], v[32:35]
ds_read_b64_tr_b16 a[24:25], v10 offset:53248
v_mfma_f32_16x16x32_bf16 v[48:51], a[40:43], v[84:87], v[48:51]
ds_read_b64_tr_b16 a[26:27], v10 offset:55296
v_mfma_f32_16x16x32_bf16 v[36:39], a[44:47], v[80:83], v[36:39]
ds_read_b64_tr_b16 a[28:29], v11 offset:53248
ds_read_b64_tr_b16 a[30:31], v11 offset:55296
v_mfma_f32_16x16x32_bf16 v[52:55], a[44:47], v[84:87], v[52:55]
s_cbranch_vccnz L_o6_rt
L_o6_ok:
s_waitcnt lgkmcnt(8)
v_mfma_f32_16x16x32_bf16 v[24:27], a[0:3], v[88:91], v[24:27]
ds_read_b64_tr_b16 a[32:33], v8 offset:57344
ds_read_b64_tr_b16 a[34:35], v8 offset:59392
v_mfma_f32_16x16x32_bf16 v[40:43], a[0:3], v[92:95], v[40:43]
buffer_load_dwordx4 v[72:75], v6, s[12:15], s33 offen offset:0 sc1
v_mfma_f32_16x16x32_bf16 v[28:31], a[4:7], v[88:91], v[28:31]
ds_read_b64_tr_b16 a[36:37], v9 offset:57344
ds_read_b64_tr_b16 a[38:39], v9 offset:59392
v_mfma_f32_16x16x32_bf16 v[44:47], a[4:7], v[92:95], v[44:47]
buffer_load_dwordx4 v[76:79], v19, s[12:15], s33 offen offset:0 sc1
v_mfma_f32_16x16x32_bf16 v[32:35], a[8:11], v[88:91], v[32:35]
ds_read_b64_tr_b16 a[40:41], v10 offset:57344
ds_read_b64_tr_b16 a[42:43], v10 offset:59392
v_mfma_f32_16x16x32_bf16 v[48:51], a[8:11], v[92:95], v[48:51]
buffer_load_dwordx4 v[80:83], v6, s[12:15], s33 offen offset:1024 sc1
v_mfma_f32_16x16x32_bf16 v[36:39], a[12:15], v[88:91], v[36:39]
ds_read_b64_tr_b16 a[44:45], v11 offset:57344
ds_read_b64_tr_b16 a[46:47], v11 offset:59392
v_mfma_f32_16x16x32_bf16 v[52:55], a[12:15], v[92:95], v[52:55]
buffer_load_dwordx4 v[84:87], v19, s[12:15], s33 offen offset:1024 sc1
s_waitcnt lgkmcnt(8)
v_mfma_f32_16x16x32_bf16 v[24:27], a[16:19], v[96:99], v[24:27]
ds_read_b64_tr_b16 a[0:1], v8 offset:61440
s_waitcnt vmcnt(8)
v_mfma_f32_16x16x32_bf16 v[40:43], a[16:19], v[100:103], v[40:43]
ds_read_b64_tr_b16 a[2:3], v8 offset:63488
v_max3_u32 v2, v104, v108, v112
v_mfma_f32_16x16x32_bf16 v[28:31], a[20:23], v[96:99], v[28:31]
ds_read_b64_tr_b16 a[4:5], v9 offset:61440
v_max_u32 v2, v2, v116
v_mfma_f32_16x16x32_bf16 v[44:47], a[20:23], v[100:103], v[44:47]
ds_read_b64_tr_b16 a[6:7], v9 offset:63488
v_cmp_eq_u32 vcc, -1, v2
v_mfma_f32_16x16x32_bf16 v[32:35], a[24:27], v[96:99], v[32:35]
ds_read_b64_tr_b16 a[8:9], v10 offset:61440
v_mfma_f32_16x16x32_bf16 v[48:51], a[24:27], v[100:103], v[48:51]
ds_read_b64_tr_b16 a[10:11], v10 offset:63488
v_mfma_f32_16x16x32_bf16 v[36:39], a[28:31], v[96:99], v[36:39]
ds_read_b64_tr_b16 a[12:13], v11 offset:61440
ds_read_b64_tr_b16 a[14:15], v11 offset:63488
v_mfma_f32_16x16x32_bf16 v[52:55], a[28:31], v[100:103], v[52:55]
s_cbranch_vccnz L_o7_rt
L_o7_ok:
s_waitcnt lgkmcnt(8)
v_mfma_f32_16x16x32_bf16 v[24:27], a[32:35], v[104:107], v[24:27]
ds_read_b64_tr_b16 a[16:17], v12 offset:0
ds_read_b64_tr_b16 a[18:19], v12 offset:2048
v_mfma_f32_16x16x32_bf16 v[40:43], a[32:35], v[108:111], v[40:43]
buffer_load_dwordx4 v[88:91], v6, s[12:15], s34 offen offset:0 sc1
v_mfma_f32_16x16x32_bf16 v[28:31], a[36:39], v[104:107], v[28:31]
ds_read_b64_tr_b16 a[20:21], v13 offset:0
ds_read_b64_tr_b16 a[22:23], v13 offset:2048
v_mfma_f32_16x16x32_bf16 v[44:47], a[36:39], v[108:111], v[44:47]
buffer_load_dwordx4 v[92:95], v19, s[12:15], s34 offen offset:0 sc1
v_mfma_f32_16x16x32_bf16 v[32:35], a[40:43], v[104:107], v[32:35]
ds_read_b64_tr_b16 a[24:25], v14 offset:0
ds_read_b64_tr_b16 a[26:27], v14 offset:2048
v_mfma_f32_16x16x32_bf16 v[48:51], a[40:43], v[108:111], v[48:51]
buffer_load_dwordx4 v[96:99], v6, s[12:15], s34 offen offset:1024 sc1
v_mfma_f32_16x16x32_bf16 v[36:39], a[44:47], v[104:107], v[36:39]
ds_read_b64_tr_b16 a[28:29], v15 offset:0
ds_read_b64_tr_b16 a[30:31], v15 offset:2048
v_mfma_f32_16x16x32_bf16 v[52:55], a[44:47], v[108:111], v[52:55]
buffer_load_dwordx4 v[100:103], v19, s[12:15], s34 offen offset:1024 sc1
s_waitcnt lgkmcnt(8)
v_mfma_f32_16x16x32_bf16 v[24:27], a[0:3], v[112:115], v[24:27]
ds_read_b64_tr_b16 a[32:33], v12 offset:4096
s_waitcnt vmcnt(8)
v_mfma_f32_16x16x32_bf16 v[40:43], a[0:3], v[116:119], v[40:43]
ds_read_b64_tr_b16 a[34:35], v12 offset:6144
v_max3_u32 v2, v56, v60, v64
v_mfma_f32_16x16x32_bf16 v[28:31], a[4:7], v[112:115], v[28:31]
ds_read_b64_tr_b16 a[36:37], v13 offset:4096
v_max_u32 v2, v2, v68
v_mfma_f32_16x16x32_bf16 v[44:47], a[4:7], v[116:119], v[44:47]
ds_read_b64_tr_b16 a[38:39], v13 offset:6144
v_cmp_eq_u32 vcc, -1, v2
v_mfma_f32_16x16x32_bf16 v[32:35], a[8:11], v[112:115], v[32:35]
ds_read_b64_tr_b16 a[40:41], v14 offset:4096
v_mfma_f32_16x16x32_bf16 v[48:51], a[8:11], v[116:119], v[48:51]
ds_read_b64_tr_b16 a[42:43], v14 offset:6144
v_mfma_f32_16x16x32_bf16 v[36:39], a[12:15], v[112:115], v[36:39]
ds_read_b64_tr_b16 a[44:45], v15 offset:4096
ds_read_b64_tr_b16 a[46:47], v15 offset:6144
v_mfma_f32_16x16x32_bf16 v[52:55], a[12:15], v[116:119], v[52:55]
s_cbranch_vccnz L_o8_rt
L_o8_ok:
s_waitcnt lgkmcnt(8)
v_mfma_f32_16x16x32_bf16 v[24:27], a[16:19], v[56:59], v[24:27]
ds_read_b64_tr_b16 a[0:1], v12 offset:8192
ds_read_b64_tr_b16 a[2:3], v12 offset:10240
v_mfma_f32_16x16x32_bf16 v[40:43], a[16:19], v[60:63], v[40:43]
buffer_load_dwordx4 v[104:107], v6, s[12:15], s35 offen offset:0 sc1
v_mfma_f32_16x16x32_bf16 v[28:31], a[20:23], v[56:59], v[28:31]
ds_read_b64_tr_b16 a[4:5], v13 offset:8192
ds_read_b64_tr_b16 a[6:7], v13 offset:10240
v_mfma_f32_16x16x32_bf16 v[44:47], a[20:23], v[60:63], v[44:47]
buffer_load_dwordx4 v[108:111], v19, s[12:15], s35 offen offset:0 sc1
v_mfma_f32_16x16x32_bf16 v[32:35], a[24:27], v[56:59], v[32:35]
ds_read_b64_tr_b16 a[8:9], v14 offset:8192
ds_read_b64_tr_b16 a[10:11], v14 offset:10240
v_mfma_f32_16x16x32_bf16 v[48:51], a[24:27], v[60:63], v[48:51]
buffer_load_dwordx4 v[112:115], v6, s[12:15], s35 offen offset:1024 sc1
v_mfma_f32_16x16x32_bf16 v[36:39], a[28:31], v[56:59], v[36:39]
ds_read_b64_tr_b16 a[12:13], v15 offset:8192
s_branch L_over7
L_pad7:
s_branch L_pad12
L_over7:
ds_read_b64_tr_b16 a[14:15], v15 offset:10240
v_mfma_f32_16x16x32_bf16 v[52:55], a[28:31], v[60:63], v[52:55]
buffer_load_dwordx4 v[116:119], v19, s[12:15], s35 offen offset:1024 sc1
s_waitcnt lgkmcnt(8)
v_mfma_f32_16x16x32_bf16 v[24:27], a[32:35], v[64:67], v[24:27]
ds_read_b64_tr_b16 a[16:17], v12 offset:12288
s_waitcnt vmcnt(8)
v_mfma_f32_16x16x32_bf16 v[40:43], a[32:35], v[68:71], v[40:43]
ds_read_b64_tr_b16 a[18:19], v12 offset:14336
v_max3_u32 v2, v72, v76, v80
v_mfma_f32_16x16x32_bf16 v[28:31], a[36:39], v[64:67], v[28:31]
ds_read_b64_tr_b16 a[20:21], v13 offset:12288
v_max_u32 v2, v2, v84
v_mfma_f32_16x16x32_bf16 v[44:47], a[36:39], v[68:71], v[44:47]
ds_read_b64_tr_b16 a[22:23], v13 offset:14336
v_cmp_eq_u32 vcc, -1, v2
v_mfma_f32_16x16x32_bf16 v[32:35], a[40:43], v[64:67], v[32:35]
ds_read_b64_tr_b16 a[24:25], v14 offset:12288
v_mfma_f32_16x16x32_bf16 v[48:51], a[40:43], v[68:71], v[48:51]
ds_read_b64_tr_b16 a[26:27], v14 offset:14336
v_mfma_f32_16x16x32_bf16 v[36:39], a[44:47], v[64:67], v[36:39]
ds_read_b64_tr_b16 a[28:29], v15 offset:12288
ds_read_b64_tr_b16 a[30:31], v15 offset:14336
v_mfma_f32_16x16x32_bf16 v[52:55], a[44:47], v[68:71], v[52:55]
s_cbranch_vccnz L_o9_rt
L_o9_ok:
s_waitcnt lgkmcnt(8)
v_mfma_f32_16x16x32_bf16 v[24:27], a[0:3], v[72:75], v[24:27]
ds_read_b64_tr_b16 a[32:33], v12 offset:16384
ds_read_b64_tr_b16 a[34:35], v12 offset:18432
v_mfma_f32_16x16x32_bf16 v[40:43], a[0:3], v[76:79], v[40:43]
buffer_load_dwordx4 v[56:59], v6, s[12:15], s36 offen offset:0 sc1
v_mfma_f32_16x16x32_bf16 v[28:31], a[4:7], v[72:75], v[28:31]
ds_read_b64_tr_b16 a[36:37], v13 offset:16384
ds_read_b64_tr_b16 a[38:39], v13 offset:18432
v_mfma_f32_16x16x32_bf16 v[44:47], a[4:7], v[76:79], v[44:47]
buffer_load_dwordx4 v[60:63], v19, s[12:15], s36 offen offset:0 sc1
v_mfma_f32_16x16x32_bf16 v[32:35], a[8:11], v[72:75], v[32:35]
ds_read_b64_tr_b16 a[40:41], v14 offset:16384
ds_read_b64_tr_b16 a[42:43], v14 offset:18432
v_mfma_f32_16x16x32_bf16 v[48:51], a[8:11], v[76:79], v[48:51]
buffer_load_dwordx4 v[64:67], v6, s[12:15], s36 offen offset:1024 sc1
v_mfma_f32_16x16x32_bf16 v[36:39], a[12:15], v[72:75], v[36:39]
ds_read_b64_tr_b16 a[44:45], v15 offset:16384
ds_read_b64_tr_b16 a[46:47], v15 offset:18432
v_mfma_f32_16x16x32_bf16 v[52:55], a[12:15], v[76:79], v[52:55]
buffer_load_dwordx4 v[68:71], v19, s[12:15], s36 offen offset:1024 sc1
s_waitcnt lgkmcnt(8)
v_mfma_f32_16x16x32_bf16 v[24:27], a[16:19], v[80:83], v[24:27]
ds_read_b64_tr_b16 a[0:1], v12 offset:20480
s_waitcnt vmcnt(8)
v_mfma_f32_16x16x32_bf16 v[40:43], a[16:19], v[84:87], v[40:43]
ds_read_b64_tr_b16 a[2:3], v12 offset:22528
v_max3_u32 v2, v88, v92, v96
v_mfma_f32_16x16x32_bf16 v[28:31], a[20:23], v[80:83], v[28:31]
ds_read_b64_tr_b16 a[4:5], v13 offset:20480
v_max_u32 v2, v2, v100
v_mfma_f32_16x16x32_bf16 v[44:47], a[20:23], v[84:87], v[44:47]
ds_read_b64_tr_b16 a[6:7], v13 offset:22528
v_cmp_eq_u32 vcc, -1, v2
v_mfma_f32_16x16x32_bf16 v[32:35], a[24:27], v[80:83], v[32:35]
ds_read_b64_tr_b16 a[8:9], v14 offset:20480
v_mfma_f32_16x16x32_bf16 v[48:51], a[24:27], v[84:87], v[48:51]
ds_read_b64_tr_b16 a[10:11], v14 offset:22528
v_mfma_f32_16x16x32_bf16 v[36:39], a[28:31], v[80:83], v[36:39]
ds_read_b64_tr_b16 a[12:13], v15 offset:20480
ds_read_b64_tr_b16 a[14:15], v15 offset:22528
v_mfma_f32_16x16x32_bf16 v[52:55], a[28:31], v[84:87], v[52:55]
s_cbranch_vccnz L_o10_rt
L_o10_ok:
s_waitcnt lgkmcnt(8)
v_mfma_f32_16x16x32_bf16 v[24:27], a[32:35], v[88:91], v[24:27]
ds_read_b64_tr_b16 a[16:17], v12 offset:24576
ds_read_b64_tr_b16 a[18:19], v12 offset:26624
v_mfma_f32_16x16x32_bf16 v[40:43], a[32:35], v[92:95], v[40:43]
buffer_load_dwordx4 v[72:75], v6, s[12:15], s37 offen offset:0 sc1
v_mfma_f32_16x16x32_bf16 v[28:31], a[36:39], v[88:91], v[28:31]
ds_read_b64_tr_b16 a[20:21], v13 offset:24576
ds_read_b64_tr_b16 a[22:23], v13 offset:26624
v_mfma_f32_16x16x32_bf16 v[44:47], a[36:39], v[92:95], v[44:47]
buffer_load_dwordx4 v[76:79], v19, s[12:15], s37 offen offset:0 sc1
v_mfma_f32_16x16x32_bf16 v[32:35], a[40:43], v[88:91], v[32:35]
ds_read_b64_tr_b16 a[24:25], v14 offset:24576
ds_read_b64_tr_b16 a[26:27], v14 offset:26624
v_mfma_f32_16x16x32_bf16 v[48:51], a[40:43], v[92:95], v[48:51]
buffer_load_dwordx4 v[80:83], v6, s[12:15], s37 offen offset:1024 sc1
v_mfma_f32_16x16x32_bf16 v[36:39], a[44:47], v[88:91], v[36:39]
ds_read_b64_tr_b16 a[28:29], v15 offset:24576
ds_read_b64_tr_b16 a[30:31], v15 offset:26624
v_mfma_f32_16x16x32_bf16 v[52:55], a[44:47], v[92:95], v[52:55]
buffer_load_dwordx4 v[84:87], v19, s[12:15], s37 offen offset:1024 sc1
s_waitcnt lgkmcnt(8)
v_mfma_f32_16x16x32_bf16 v[24:27], a[0:3], v[96:99], v[24:27]
ds_read_b64_tr_b16 a[32:33], v12 offset:28672
s_waitcnt vmcnt(8)
v_mfma_f32_16x16x32_bf16 v[40:43], a[0:3], v[100:103], v[40:43]
ds_read_b64_tr_b16 a[34:35], v12 offset:30720
v_max3_u32 v2, v104, v108, v112
v_mfma_f32_16x16x32_bf16 v[28:31], a[4:7], v[96:99], v[28:31]
ds_read_b64_tr_b16 a[36:37], v13 offset:28672
v_max_u32 v2, v2, v116
v_mfma_f32_16x16x32_bf16 v[44:47], a[4:7], v[100:103], v[44:47]
ds_read_b64_tr_b16 a[38:39], v13 offset:30720
v_cmp_eq_u32 vcc, -1, v2
v_mfma_f32_16x16x32_bf16 v[32:35], a[8:11], v[96:99], v[32:35]
ds_read_b64_tr_b16 a[40:41], v14 offset:28672
v_mfma_f32_16x16x32_bf16 v[48:51], a[8:11], v[100:103], v[48:51]
ds_read_b64_tr_b16 a[42:43], v14 offset:30720
v_mfma_f32_16x16x32_bf16 v[36:39], a[12:15], v[96:99], v[36:39]
ds_read_b64_tr_b16 a[44:45], v15 offset:28672
ds_read_b64_tr_b16 a[46:47], v15 offset:30720
v_mfma_f32_16x16x32_bf16 v[52:55], a[12:15], v[100:103], v[52:55]
s_cbranch_vccnz L_o11_rt
L_o11_ok:
s_waitcnt lgkmcnt(8)
v_mfma_f32_16x16x32_bf16 v[24:27], a[16:19], v[104:107], v[24:27]
ds_read_b64_tr_b16 a[0:1], v12 offset:32768
ds_read_b64_tr_b16 a[2:3], v12 offset:34816
v_mfma_f32_16x16x32_bf16 v[40:43], a[16:19], v[108:111], v[40:43]
buffer_load_dwordx4 v[88:91], v6, s[12:15], s38 offen offset:0 sc1
v_mfma_f32_16x16x32_bf16 v[28:31], a[20:23], v[104:107], v[28:31]
ds_read_b64_tr_b16 a[4:5], v13 offset:32768
ds_read_b64_tr_b16 a[6:7], v13 offset:34816
v_mfma_f32_16x16x32_bf16 v[44:47], a[20:23], v[108:111], v[44:47]
buffer_load_dwordx4 v[92:95], v19, s[12:15], s38 offen offset:0 sc1
v_mfma_f32_16x16x32_bf16 v[32:35], a[24:27], v[104:107], v[32:35]
ds_read_b64_tr_b16 a[8:9], v14 offset:32768
ds_read_b64_tr_b16 a[10:11], v14 offset:34816
v_mfma_f32_16x16x32_bf16 v[48:51], a[24:27], v[108:111], v[48:51]
buffer_load_dwordx4 v[96:99], v6, s[12:15], s38 offen offset:1024 sc1
v_mfma_f32_16x16x32_bf16 v[36:39], a[28:31], v[104:107], v[36:39]
ds_read_b64_tr_b16 a[12:13], v15 offset:32768
ds_read_b64_tr_b16 a[14:15], v15 offset:34816
v_mfma_f32_16x16x32_bf16 v[52:55], a[28:31], v[108:111], v[52:55]
buffer_load_dwordx4 v[100:103], v19, s[12:15], s38 offen offset:1024 sc1
s_waitcnt lgkmcnt(8)
v_mfma_f32_16x16x32_bf16 v[24:27], a[32:35], v[112:115], v[24:27]
ds_read_b64_tr_b16 a[16:17], v12 offset:36864
s_waitcnt vmcnt(8)
v_mfma_f32_16x16x32_bf16 v[40:43], a[32:35], v[116:119], v[40:43]
ds_read_b64_tr_b16 a[18:19], v12 offset:38912
v_max3_u32 v2, v56, v60, v64
v_mfma_f32_16x16x32_bf16 v[28:31], a[36:39], v[112:115], v[28:31]
ds_read_b64_tr_b16 a[20:21], v13 offset:36864
v_max_u32 v2, v2, v68
v_mfma_f32_16x16x32_bf16 v[44:47], a[36:39], v[116:119], v[44:47]
ds_read_b64_tr_b16 a[22:23], v13 offset:38912
v_cmp_eq_u32 vcc, -1, v2
v_mfma_f32_16x16x32_bf16 v[32:35], a[40:43], v[112:115], v[32:35]
ds_read_b64_tr_b16 a[24:25], v14 offset:36864
v_mfma_f32_16x16x32_bf16 v[48:51], a[40:43], v[116:119], v[48:51]
ds_read_b64_tr_b16 a[26:27], v14 offset:38912
v_mfma_f32_16x16x32_bf16 v[36:39], a[44:47], v[112:115], v[36:39]
ds_read_b64_tr_b16 a[28:29], v15 offset:36864
ds_read_b64_tr_b16 a[30:31], v15 offset:38912
v_mfma_f32_16x16x32_bf16 v[52:55], a[44:47], v[116:119], v[52:55]
s_cbranch_vccnz L_o12_rt
L_o12_ok:
s_waitcnt lgkmcnt(8)
v_mfma_f32_16x16x32_bf16 v[24:27], a[0:3], v[56:59], v[24:27]
ds_read_b64_tr_b16 a[32:33], v12 offset:40960
ds_read_b64_tr_b16 a[34:35], v12 offset:43008
v_mfma_f32_16x16x32_bf16 v[40:43], a[0:3], v[60:63], v[40:43]
buffer_load_dwordx4 v[104:107], v6, s[12:15], s39 offen offset:0 sc1
v_mfma_f32_16x16x32_bf16 v[28:31], a[4:7], v[56:59], v[28:31]
ds_read_b64_tr_b16 a[36:37], v13 offset:40960
ds_read_b64_tr_b16 a[38:39], v13 offset:43008
v_mfma_f32_16x16x32_bf16 v[44:47], a[4:7], v[60:63], v[44:47]
buffer_load_dwordx4 v[108:111], v19, s[12:15], s39 offen offset:0 sc1
v_mfma_f32_16x16x32_bf16 v[32:35], a[8:11], v[56:59], v[32:35]
ds_read_b64_tr_b16 a[40:41], v14 offset:40960
ds_read_b64_tr_b16 a[42:43], v14 offset:43008
v_mfma_f32_16x16x32_bf16 v[48:51], a[8:11], v[60:63], v[48:51]
buffer_load_dwordx4 v[112:115], v6, s[12:15], s39 offen offset:1024 sc1
v_mfma_f32_16x16x32_bf16 v[36:39], a[12:15], v[56:59], v[36:39]
ds_read_b64_tr_b16 a[44:45], v15 offset:40960
ds_read_b64_tr_b16 a[46:47], v15 offset:43008
v_mfma_f32_16x16x32_bf16 v[52:55], a[12:15], v[60:63], v[52:55]
buffer_load_dwordx4 v[116:119], v19, s[12:15], s39 offen offset:1024 sc1
s_waitcnt lgkmcnt(8)
v_mfma_f32_16x16x32_bf16 v[24:27], a[16:19], v[64:67], v[24:27]
ds_read_b64_tr_b16 a[0:1], v12 offset:45056
s_waitcnt vmcnt(8)
v_mfma_f32_16x16x32_bf16 v[40:43], a[16:19], v[68:71], v[40:43]
ds_read_b64_tr_b16 a[2:3], v12 offset:47104
v_max3_u32 v2, v72, v76, v80
v_mfma_f32_16x16x32_bf16 v[28:31], a[20:23], v[64:67], v[28:31]
ds_read_b64_tr_b16 a[4:5], v13 offset:45056
v_max_u32 v2, v2, v84
v_mfma_f32_16x16x32_bf16 v[44:47], a[20:23], v[68:71], v[44:47]
ds_read_b64_tr_b16 a[6:7], v13 offset:47104
v_cmp_eq_u32 vcc, -1, v2
v_mfma_f32_16x16x32_bf16 v[32:35], a[24:27], v[64:67], v[32:35]
ds_read_b64_tr_b16 a[8:9], v14 offset:45056
v_mfma_f32_16x16x32_bf16 v[48:51], a[24:27], v[68:71], v[48:51]
ds_read_b64_tr_b16 a[10:11], v14 offset:47104
v_mfma_f32_16x16x32_bf16 v[36:39], a[28:31], v[64:67], v[36:39]
ds_read_b64_tr_b16 a[12:13], v15 offset:45056
ds_read_b64_tr_b16 a[14:15], v15 offset:47104
v_mfma_f32_16x16x32_bf16 v[52:55], a[28:31], v[68:71], v[52:55]
s_cbranch_vccnz L_o13_rt
L_o13_ok:
s_waitcnt lgkmcnt(8)
v_mfma_f32_16x16x32_bf16 v[24:27], a[32:35], v[72:75], v[24:27]
ds_read_b64_tr_b16 a[16:17], v12 offset:49152
ds_read_b64_tr_b16 a[18:19], v12 offset:51200
v_mfma_f32_16x16x32_bf16 v[40:43], a[32:35], v[76:79], v[40:43]
v_mfma_f32_16x16x32_bf16 v[28:31], a[36:39], v[72:75], v[28:31]
ds_read_b64_tr_b16 a[20:21], v13 offset:49152
ds_read_b64_tr_b16 a[22:23], v13 offset:51200
v_mfma_f32_16x16x32_bf16 v[44:47], a[36:39], v[76:79], v[44:47]
v_mfma_f32_16x16x32_bf16 v[32:35], a[40:43], v[72:75], v[32:35]
ds_read_b64_tr_b16 a[24:25], v14 offset:49152
ds_read_b64_tr_b16 a[26:27], v14 offset:51200
v_mfma_f32_16x16x32_bf16 v[48:51], a[40:43], v[76:79], v[48:51]
v_mfma_f32_16x16x32_bf16 v[36:39], a[44:47], v[72:75], v[36:39]
ds_read_b64_tr_b16 a[28:29], v15 offset:49152
ds_read_b64_tr_b16 a[30:31], v15 offset:51200
v_mfma_f32_16x16x32_bf16 v[52:55], a[44:47], v[76:79], v[52:55]
s_waitcnt lgkmcnt(8)
v_mfma_f32_16x16x32_bf16 v[24:27], a[0:3], v[80:83], v[24:27]
ds_read_b64_tr_b16 a[32:33], v12 offset:53248
s_waitcnt vmcnt(4)
v_mfma_f32_16x16x32_bf16 v[40:43], a[0:3], v[84:87], v[40:43]
ds_read_b64_tr_b16 a[34:35], v12 offset:55296
v_max3_u32 v2, v88, v92, v96
v_mfma_f32_16x16x32_bf16 v[28:31], a[4:7], v[80:83], v[28:31]
ds_read_b64_tr_b16 a[36:37], v13 offset:53248
v_max_u32 v2, v2, v100
v_mfma_f32_16x16x32_bf16 v[44:47], a[4:7], v[84:87], v[44:47]
ds_read_b64_tr_b16 a[38:39], v13 offset:55296
v_cmp_eq_u32 vcc, -1, v2
v_mfma_f32_16x16x32_bf16 v[32:35], a[8:11], v[80:83], v[32:35]
ds_read_b64_tr_b16 a[40:41], v14 offset:53248
v_mfma_f32_16x16x32_bf16 v[48:51], a[8:11], v[84:87], v[48:51]
ds_read_b64_tr_b16 a[42:43], v14 offset:55296
v_mfma_f32_16x16x32_bf16 v[36:39], a[12:15], v[80:83], v[36:39]
ds_read_b64_tr_b16 a[44:45], v15 offset:53248
ds_read_b64_tr_b16 a[46:47], v15 offset:55296
v_mfma_f32_16x16x32_bf16 v[52:55], a[12:15], v[84:87], v[52:55]
s_cbranch_vccnz L_o14_rt
L_o14_ok:
s_waitcnt lgkmcnt(8)
v_mfma_f32_16x16x32_bf16 v[24:27], a[16:19], v[88:91], v[24:27]
ds_read_b64_tr_b16 a[0:1], v12 offset:57344
ds_read_b64_tr_b16 a[2:3], v12 offset:59392
v_mfma_f32_16x16x32_bf16 v[40:43], a[16:19], v[92:95], v[40:43]
v_mfma_f32_16x16x32_bf16 v[28:31], a[20:23], v[88:91], v[28:31]
ds_read_b64_tr_b16 a[4:5], v13 offset:57344
ds_read_b64_tr_b16 a[6:7], v13 offset:59392
v_mfma_f32_16x16x32_bf16 v[44:47], a[20:23], v[92:95], v[44:47]
v_mfma_f32_16x16x32_bf16 v[32:35], a[24:27], v[88:91], v[32:35]
ds_read_b64_tr_b16 a[8:9], v14 offset:57344
ds_read_b64_tr_b16 a[10:11], v14 offset:59392
v_mfma_f32_16x16x32_bf16 v[48:51], a[24:27], v[92:95], v[48:51]
v_mfma_f32_16x16x32_bf16 v[36:39], a[28:31], v[88:91], v[36:39]
ds_read_b64_tr_b16 a[12:13], v15 offset:57344
ds_read_b64_tr_b16 a[14:15], v15 offset:59392
v_mfma_f32_16x16x32_bf16 v[52:55], a[28:31], v[92:95], v[52:55]
s_waitcnt lgkmcnt(8)
v_mfma_f32_16x16x32_bf16 v[24:27], a[32:35], v[96:99], v[24:27]
ds_read_b64_tr_b16 a[16:17], v12 offset:61440
s_waitcnt vmcnt(0)
v_mfma_f32_16x16x32_bf16 v[40:43], a[32:35], v[100:103], v[40:43]
ds_read_b64_tr_b16 a[18:19], v12 offset:63488
v_max3_u32 v2, v104, v108, v112
v_mfma_f32_16x16x32_bf16 v[28:31], a[36:39], v[96:99], v[28:31]
ds_read_b64_tr_b16 a[20:21], v13 offset:61440
v_max_u32 v2, v2, v116
v_mfma_f32_16x16x32_bf16 v[44:47], a[36:39], v[100:103], v[44:47]
ds_read_b64_tr_b16 a[22:23], v13 offset:63488
v_cmp_eq_u32 vcc, -1, v2
v_mfma_f32_16x16x32_bf16 v[32:35], a[40:43], v[96:99], v[32:35]
ds_read_b64_tr_b16 a[24:25], v14 offset:61440
v_mfma_f32_16x16x32_bf16 v[48:51], a[40:43], v[100:103], v[48:51]
ds_read_b64_tr_b16 a[26:27], v14 offset:63488
v_mfma_f32_16x16x32_bf16 v[36:39], a[44:47], v[96:99], v[36:39]
ds_read_b64_tr_b16 a[28:29], v15 offset:61440
ds_read_b64_tr_b16 a[30:31], v15 offset:63488
v_mfma_f32_16x16x32_bf16 v[52:55], a[44:47], v[100:103], v[52:55]
s_cbranch_vccnz L_o15_rt
L_o15_ok:
s_waitcnt lgkmcnt(8)
v_mfma_f32_16x16x32_bf16 v[24:27], a[0:3], v[104:107], v[24:27]
v_mfma_f32_16x16x32_bf16 v[40:43], a[0:3], v[108:111], v[40:43]
v_mfma_f32_16x16x32_bf16 v[28:31], a[4:7], v[104:107], v[28:31]
v_mfma_f32_16x16x32_bf16 v[44:47], a[4:7], v[108:111], v[44:47]
v_mfma_f32_16x16x32_bf16 v[32:35], a[8:11], v[104:107], v[32:35]
v_mfma_f32_16x16x32_bf16 v[48:51], a[8:11], v[108:111], v[48:51]
v_mfma_f32_16x16x32_bf16 v[36:39], a[12:15], v[104:107], v[36:39]
v_mfma_f32_16x16x32_bf16 v[52:55], a[12:15], v[108:111], v[52:55]
s_waitcnt lgkmcnt(0)
v_mfma_f32_16x16x32_bf16 v[24:27], a[16:19], v[112:115], v[24:27]
v_mfma_f32_16x16x32_bf16 v[40:43], a[16:19], v[116:119], v[40:43]
v_mfma_f32_16x16x32_bf16 v[28:31], a[20:23], v[112:115], v[28:31]
v_mfma_f32_16x16x32_bf16 v[44:47], a[20:23], v[116:119], v[44:47]
v_mfma_f32_16x16x32_bf16 v[32:35], a[24:27], v[112:115], v[32:35]
v_mfma_f32_16x16x32_bf16 v[48:51], a[24:27], v[116:119], v[48:51]
v_mfma_f32_16x16x32_bf16 v[36:39], a[28:31], v[112:115], v[36:39]
v_mfma_f32_16x16x32_bf16 v[52:55], a[28:31], v[116:119], v[52:55]
s_nop 0
v_cvt_pk_bf16_f32 v128, v24, v25
v_cvt_pk_bf16_f32 v129, v26, v27
v_cvt_pk_bf16_f32 v130, v28, v29
v_cvt_pk_bf16_f32 v131, v30, v31
v_cvt_pk_bf16_f32 v132, v32, v33
v_cvt_pk_bf16_f32 v133, v34, v35
v_cvt_pk_bf16_f32 v134, v36, v37
v_cvt_pk_bf16_f32 v135, v38, v39
v_cvt_pk_bf16_f32 v136, v40, v41
v_cvt_pk_bf16_f32 v137, v42, v43
v_cvt_pk_bf16_f32 v138, v44, v45
v_cvt_pk_bf16_f32 v139, v46, v47
v_cvt_pk_bf16_f32 v140, v48, v49
v_cvt_pk_bf16_f32 v141, v50, v51
v_cvt_pk_bf16_f32 v142, v52, v53
v_cvt_pk_bf16_f32 v143, v54, v55
v_mfma_f32_16x16x32_bf16 v[80:83], v[128:131], v[128:131], 0
v_mfma_f32_16x16x32_bf16 v[72:75], v[120:123], v[128:131], 0
v_mfma_f32_16x16x32_bf16 v[80:83], v[132:135], v[132:135], v[80:83]
v_mfma_f32_16x16x32_bf16 v[72:75], v[124:127], v[132:135], v[72:75]
v_mfma_f32_16x16x32_bf16 v[84:87], v[136:139], v[136:139], 0
v_mfma_f32_16x16x32_bf16 v[76:79], v[120:123], v[136:139], 0
v_mfma_f32_16x16x32_bf16 v[84:87], v[140:143], v[140:143], v[84:87]
v_mfma_f32_16x16x32_bf16 v[76:79], v[124:127], v[140:143], v[76:79]
s_nop 2
v_cndmask_b32_e64 v80, v80, v81, s[80:81]
v_cndmask_b32_e64 v82, v82, v83, s[90:91]
s_or_b64 vcc, s[82:83], s[90:91]
v_mov_b32 v75, s68
v_cndmask_b32 v73, v80, v82, vcc
v_cndmask_b32_e64 v84, v84, v85, s[80:81]
v_cndmask_b32_e64 v86, v86, v87, s[90:91]
s_or_b64 vcc, s[82:83], s[90:91]
v_mov_b32 v79, s68
v_cndmask_b32_e64 v77, v84, v86, vcc
s_mov_b64 exec, s[92:93]
s_cmp_eq_u32 s69, 0
s_cbranch_scc1 L_stp_s
buffer_store_dwordx4 v[72:75], v144, s[12:15], s72 offen offset:0
buffer_store_dwordx4 v[76:79], v144, s[12:15], s72 offen offset:256
L_stp_d:
s_mov_b64 exec, -1
s_barrier
s_add_u32 s70, s75, 0
buffer_load_dwordx4 v[96:99], v145, s[12:15], s70 offen sc1
s_add_u32 s70, s75, 4096
buffer_load_dwordx4 v[100:103], v145, s[12:15], s70 offen sc1
s_add_u32 s70, s75, 8192
buffer_load_dwordx4 v[104:107], v145, s[12:15], s70 offen sc1
s_add_u32 s70, s75, 12288
buffer_load_dwordx4 v[108:111], v145, s[12:15], s70 offen sc1
s_add_u32 s70, s75, 16384
buffer_load_dwordx4 v[112:115], v145, s[12:15], s70 offen sc1
s_add_u32 s70, s75, 20480
buffer_load_dwordx4 v[116:119], v145, s[12:15], s70 offen sc1
s_add_u32 s70, s75, 24576
buffer_load_dwordx4 v[120:123], v145, s[12:15], s70 offen sc1
s_add_u32 s70, s75, 28672
buffer_load_dwordx4 v[124:127], v145, s[12:15], s70 offen sc1
ds_write_b64 v20, v[128:129] offset:0
ds_write_b64 v21, v[130:131] offset:0
ds_write_b64 v22, v[132:133] offset:0
ds_write_b64 v23, v[134:135] offset:0
ds_write_b64 v20, v[136:137] offset:2048
ds_write_b64 v21, v[138:139] offset:2048
ds_write_b64 v22, v[140:141] offset:2048
ds_write_b64 v23, v[142:143] offset:2048
v_lshrrev_b32 v2, 3, v1
v_lshrrev_b32 v3, 4, v1
v_and_b32 v13, 7, v1
v_xor_b32 v3, v3, v13
v_lshlrev_b32 v3, 4, v3
v_lshl_add_u32 v3, v2, 7, v3
s_lshl_b32 s70, s60, 12
v_add_u32 v9, s70, v3
v_xor_b32 v10, 64, v9
v_lshlrev_b32 v11, 11, v2
v_lshl_add_u32 v11, v13, 4, v11
v_mov_b32 v12, v2
s_lshl_b32 s76, s60, 12
s_lshl_b32 s74, s64, 18
s_lshl_b32 s70, s60, 16
s_add_u32 s74, s74, s70
s_lshl_b32 s70, s65, 7
s_add_u32 s74, s74, s70
s_mov_b32 s80, 0xff00ff00
s_mov_b32 s81, 0xff00ff00
s_lshl_b32 s70, s60, 5
s_add_u32 s70, s70, 161920
v_mov_b32 v14, s70
v_add_u32 v15, 16, v14
v_add_u32 v8, 161920, v16
v_lshlrev_b32 v8, 4, v13
v_add_u32 v8, 161920, v8
v_xor_b32 v17, 8192, v11
v_xor_b32 v17, s61, v17
s_waitcnt vmcnt(0)
L_st_chk:
v_xor_b32 v88, s68, v99
v_xor_b32 v89, s68, v103
v_xor_b32 v90, s68, v107
v_xor_b32 v91, s68, v111
v_xor_b32 v92, s68, v115
v_xor_b32 v93, s68, v119
v_xor_b32 v94, s68, v123
v_xor_b32 v95, s68, v127
v_or3_b32 v88, v88, v89, v90
v_or3_b32 v91, v91, v92, v93
v_or3_b32 v88, v88, v94, v95
v_or_b32_e64 v88, v88, v91
v_cmp_ne_u32 vcc, 0, v88
s_cbranch_vccnz L_st_rt
L_st_ok:
v_pk_add_f32 v[96:97], v[96:97], v[100:101]
v_add_f32 v98, v98, v102
v_pk_add_f32 v[104:105], v[104:105], v[108:109]
v_add_f32 v106, v106, v110
v_pk_add_f32 v[112:113], v[112:113], v[116:117]
v_add_f32 v114, v114, v118
v_pk_add_f32 v[120:121], v[120:121], v[124:125]
v_add_f32 v122, v122, v126
v_pk_add_f32 v[96:97], v[96:97], v[104:105]
v_add_f32 v98, v98, v106
v_pk_add_f32 v[112:113], v[112:113], v[120:121]
v_add_f32 v114, v114, v122
v_pk_add_f32 v[96:97], v[96:97], v[112:113]
v_add_f32 v98, v98, v114
v_mov_b32 v100, v96
v_mov_b32 v101, v97
v_mov_b32 v102, v98
v_permlane32_swap_b32 v96, v100
v_permlane32_swap_b32 v97, v101
v_permlane32_swap_b32 v98, v102
v_add_f32 v96, v96, v100
v_add_f32 v97, v97, v101
v_add_f32 v98, v98, v102
v_mul_f32 v73, 0x3a800000, v96
v_mul_f32 v97, 0x3a800000, v97
v_fma_f32 v97, -v73, v73, v97
v_fma_f32 v98, -v73, s84, v98
v_max_f32 v97, 0, v97
v_add_f32 v97, 0x3727c5ac, v97
v_rsq_f32 v74, v97
v_mov_b32 v75, s68
v_mul_f32 v98, v98, v74
v_ashrrev_i32 v99, 31, v98
v_or_b32 v99, 0x80000000, v99
v_xor_b32 v98, v98, v99
s_mov_b32 s70, 0xfffff000
v_and_or_b32 v72, v98, s70, v146
s_nop 1
v_mov_b32_dpp v78, v72 row_ror:1 row_mask:0xf bank_mask:0xf
v_max_u32 v76, v72, v78
v_min_u32 v77, v72, v78
s_nop 0
v_mov_b32_dpp v78, v76 row_ror:2 row_mask:0xf bank_mask:0xf
v_max_u32_dpp v79, v77, v77 row_ror:2 row_mask:0xf bank_mask:0xf
v_med3_u32 v77, v76, v78, v79
v_max_u32 v76, v76, v78
s_nop 1
v_mov_b32_dpp v78, v76 row_ror:4 row_mask:0xf bank_mask:0xf
v_max_u32_dpp v79, v77, v77 row_ror:4 row_mask:0xf bank_mask:0xf
v_med3_u32 v77, v76, v78, v79
v_max_u32 v76, v76, v78
s_nop 1
v_mov_b32_dpp v78, v76 row_ror:8 row_mask:0xf bank_mask:0xf
v_max_u32_dpp v79, v77, v77 row_ror:8 row_mask:0xf bank_mask:0xf
v_med3_u32 v77, v76, v78, v79
v_max_u32 v76, v76, v78
v_mov_b32 v78, v76
v_mov_b32 v79, v77
s_nop 0
v_permlane16_swap_b32 v76, v78
v_permlane16_swap_b32 v77, v79
v_max_u32_e64 v79, v77, v79
v_med3_u32 v77, v76, v78, v79
v_max_u32 v76, v76, v78
v_cmp_eq_u32 vcc, v72, v77
v_cmp_eq_u32_e64 s[92:93], v72, v76
s_nop 0
v_cndmask_b32 v2, v14, v15, vcc
v_addc_co_u32_e64 v72, s[72:73], 0, v72, vcc
s_or_b64 exec, vcc, s[92:93]
ds_write_b128 v2, v[72:75]
s_mov_b64 exec, -1
v_cndmask_b32_e64 v5, v76, v77, s[80:81]
v_bfe_u32 v6, v5, 8, 3
v_bfe_u32 v5, v5, 7, 5
v_xor_b32_e64 v6, v6, v13
v_lshl_add_u32 v6, v6, 4, s76
v_lshl_add_u32 v6, v5, 7, v6
ds_read_b128 v[88:91], v6
v_readfirstlane_b32 s86, v77
v_readfirstlane_b32 s85, v76
v_add_f32 v80, 1.0, v74
v_mul_f32_e64 v56, -v73, v74
v_mov_b32 v82, v80
v_mov_b32 v58, v56
s_nop 0
v_permlane16_swap_b32 v80, v82
v_permlane16_swap_b32 v56, v58
s_waitcnt lgkmcnt(1)
s_barrier
s_sub_u32 s70, s64, s65
s_or_b32 s70, s70, s60
s_cbranch_scc1 L_norec
ds_read_b128 v[92:95], v8
s_lshl_b32 s70, s62, 3
s_lshl_b64 s[72:73], 0xff, s70
s_cmp_eq_u32 s69, 0
s_cselect_b64 s[72:73], 0, s[72:73]
s_andn2_b64 exec, -1, s[72:73]
s_waitcnt lgkmcnt(0)
buffer_store_dwordx4 v[92:95], v17, s[12:15], s87 offen sc1
s_mov_b64 exec, s[72:73]
buffer_store_dwordx4 v[92:95], v17, s[12:15], s87 offen
s_mov_b64 exec, -1
L_norec:
s_mov_b32 exec_hi, 0
s_waitcnt lgkmcnt(0)
buffer_store_dwordx4 v[88:91], v147, s[12:15], s88 offen sc1
s_mov_b64 exec, -1
s_bfe_u32 s95, s86, 0x50007
s_bfe_u32 s94, s85, 0x50007
s_add_u32 s86, s86, 1
v_pk_fma_f32 v[24:25], v[24:25], v[80:81], v[56:57] op_sel_hi:[1,0,0]
v_pk_fma_f32 v[26:27], v[26:27], v[80:81], v[56:57] op_sel_hi:[1,0,0]
v_cvt_pk_bf16_f32 v128, v24, v25
v_cvt_pk_bf16_f32 v129, v26, v27
ds_write_b64 v20, v[128:129] offset:32768
v_pk_fma_f32 v[28:29], v[28:29], v[80:81], v[56:57] op_sel_hi:[1,0,0]
v_pk_fma_f32 v[30:31], v[30:31], v[80:81], v[56:57] op_sel_hi:[1,0,0]
v_cvt_pk_bf16_f32 v130, v28, v29
v_cvt_pk_bf16_f32 v131, v30, v31
ds_write_b64 v21, v[130:131] offset:32768
v_pk_fma_f32 v[32:33], v[32:33], v[80:81], v[56:57] op_sel_hi:[1,0,0]
v_pk_fma_f32 v[34:35], v[34:35], v[80:81], v[56:57] op_sel_hi:[1,0,0]
v_cvt_pk_bf16_f32 v132, v32, v33
v_cvt_pk_bf16_f32 v133, v34, v35
ds_write_b64 v22, v[132:133] offset:32768
v_pk_fma_f32 v[36:37], v[36:37], v[80:81], v[56:57] op_sel_hi:[1,0,0]
v_pk_fma_f32 v[38:39], v[38:39], v[80:81], v[56:57] op_sel_hi:[1,0,0]
v_cvt_pk_bf16_f32 v134, v36, v37
v_cvt_pk_bf16_f32 v135, v38, v39
ds_write_b64 v23, v[134:135] offset:32768
v_pk_fma_f32 v[40:41], v[40:41], v[82:83], v[58:59] op_sel_hi:[1,0,0]
v_pk_fma_f32 v[42:43], v[42:43], v[82:83], v[58:59] op_sel_hi:[1,0,0]
v_cvt_pk_bf16_f32 v136, v40, v41
v_cvt_pk_bf16_f32 v137, v42, v43
ds_write_b64 v20, v[136:137] offset:34816
v_pk_fma_f32 v[44:45], v[44:45], v[82:83], v[58:59] op_sel_hi:[1,0,0]
v_pk_fma_f32 v[46:47], v[46:47], v[82:83], v[58:59] op_sel_hi:[1,0,0]
v_cvt_pk_bf16_f32 v138, v44, v45
v_cvt_pk_bf16_f32 v139, v46, v47
ds_write_b64 v21, v[138:139] offset:34816
v_pk_fma_f32 v[48:49], v[48:49], v[82:83], v[58:59] op_sel_hi:[1,0,0]
v_pk_fma_f32 v[50:51], v[50:51], v[82:83], v[58:59] op_sel_hi:[1,0,0]
v_cvt_pk_bf16_f32 v140, v48, v49
v_cvt_pk_bf16_f32 v141, v50, v51
ds_write_b64 v22, v[140:141] offset:34816
v_pk_fma_f32 v[52:53], v[52:53], v[82:83], v[58:59] op_sel_hi:[1,0,0]
v_pk_fma_f32 v[54:55], v[54:55], v[82:83], v[58:59] op_sel_hi:[1,0,0]
v_cvt_pk_bf16_f32 v142, v52, v53
v_cvt_pk_bf16_f32 v143, v54, v55
ds_write_b64 v23, v[142:143] offset:34816
s_waitcnt lgkmcnt(0)
ds_read_b128 v[96:99], v9 offset:32768
ds_read_b128 v[100:103], v10 offset:33792
ds_read_b128 v[104:107], v9 offset:34816
ds_read_b128 v[108:111], v10 offset:35840
s_cmp_lt_u32 s63, 24
s_cbranch_scc1 L_outw
v_add_u32 v2, 0, v12
v_cmp_ne_u32 vcc, s94, v2
v_cmp_ne_u32_e64 s[92:93], s95, v2
s_add_u32 s70, s74, 0
s_waitcnt lgkmcnt(3)
s_and_b64 exec, vcc, s[92:93]
buffer_store_dwordx4 v[96:99], v11, s[20:23], s70 offen sc1
s_mov_b64 exec, -1
v_add_u32 v2, 8, v12
v_cmp_ne_u32 vcc, s94, v2
v_cmp_ne_u32_e64 s[92:93], s95, v2
s_add_u32 s70, s74, 16384
s_waitcnt lgkmcnt(2)
s_and_b64 exec, vcc, s[92:93]
buffer_store_dwordx4 v[100:103], v11, s[20:23], s70 offen sc1
s_mov_b64 exec, -1
v_add_u32 v2, 16, v12
v_cmp_ne_u32 vcc, s94, v2
v_cmp_ne_u32_e64 s[92:93], s95, v2
s_add_u32 s70, s74, 32768
s_waitcnt lgkmcnt(1)
s_and_b64 exec, vcc, s[92:93]
buffer_store_dwordx4 v[104:107], v11, s[20:23], s70 offen sc1
s_mov_b64 exec, -1
v_add_u32 v2, 24, v12
v_cmp_ne_u32_e64 vcc, s94, v2
v_cmp_ne_u32_e64 s[92:93], s95, v2
s_add_u32 s70, s74, 49152
s_waitcnt lgkmcnt(0)
s_and_b64 exec, vcc, s[92:93]
buffer_store_dwordx4 v[108:111], v11, s[20:23], s70 offen sc1
s_mov_b64 exec, -1
v_mov_b32 v2, 161792
s_barrier
ds_read_b32 v3, v2
ds_read_b32 v4, v2 offset:16
s_waitcnt lgkmcnt(0)
v_readfirstlane_b32 s72, v3
v_readfirstlane_b32 s73, v4
s_branch L_over8
L_pad8:
s_branch L_pad13
L_over8:
s_cmp_eq_u32 s85, s72
s_cselect_b32 s94, 255, s94
s_cmp_eq_u32 s85, s73
s_cselect_b32 s94, 255, s94
s_cmp_eq_u32 s86, s72
s_cselect_b32 s95, 255, s95
s_cmp_eq_u32 s86, s73
s_cselect_b32 s95, 255, s95
s_barrier
v_add_u32 v2, 0, v12
v_cmp_eq_u32 vcc, s94, v2
v_cmp_eq_u32_e64 s[92:93], s95, v2
s_add_u32 s70, s74, 0
s_or_b64 exec, vcc, s[92:93]
s_cbranch_execz L_nodef0
buffer_store_dwordx4 v[96:99], v11, s[20:23], s70 offen sc1
L_nodef0:
s_mov_b64 exec, -1
v_add_u32 v2, 8, v12
v_cmp_eq_u32 vcc, s94, v2
v_cmp_eq_u32_e64 s[92:93], s95, v2
s_add_u32 s70, s74, 16384
s_or_b64 exec, vcc, s[92:93]
s_cbranch_execz L_nodef1
buffer_store_dwordx4 v[100:103], v11, s[20:23], s70 offen sc1
L_nodef1:
s_mov_b64 exec, -1
v_add_u32 v2, 16, v12
v_cmp_eq_u32_e64 vcc, s94, v2
v_cmp_eq_u32_e64 s[92:93], s95, v2
s_add_u32 s70, s74, 32768
s_or_b64 exec, vcc, s[92:93]
s_cbranch_execz L_nodef2
buffer_store_dwordx4 v[104:107], v11, s[20:23], s70 offen sc1
L_nodef2:
s_mov_b64 exec, -1
v_add_u32 v2, 24, v12
v_cmp_eq_u32 vcc, s94, v2
v_cmp_eq_u32_e64 s[92:93], s95, v2
s_add_u32 s70, s74, 49152
s_or_b64 exec, vcc, s[92:93]
s_cbranch_execz L_nodef3
buffer_store_dwordx4 v[108:111], v11, s[20:23], s70 offen sc1
L_nodef3:
s_mov_b64 exec, -1
L_outd:
L_end:
s_endpgm
L_eg_rt:
s_add_u32 s78, s78, 1
s_cmp_gt_u32 s78, 65536
s_cbranch_scc1 L_eg_ok
s_add_u32 s70, s87, 0
buffer_load_dwordx4 v[20:23], v44, s[12:15], s70 offen sc1
buffer_load_dwordx4 v[36:39], v45, s[12:15], s88 offen sc1
buffer_load_dwordx4 v[40:43], v46, s[12:15], 0 offen offset:0 sc1
buffer_load_dword v47, v48, s[12:15], 0 offen sc1
s_waitcnt vmcnt(0)
s_branch L_eg_chk
L_kv2_s:
buffer_store_dwordx2 v[20:21], v53, s[12:15], s94 offen sc1
s_branch L_kv2_d
L_pad9:
s_branch L_retF
L_kvrt:
s_add_u32 s78, s78, 1
s_cmp_gt_u32 s78, 65536
s_cbranch_scc1 L_kvok
s_bitcmp1_b32 s73, 0
s_cbranch_scc0 L_kvn0
buffer_load_dwordx4 v[84:87], v54, s[12:15], s87 offen sc1
L_kvn0:
s_bitcmp1_b32 s73, 1
s_cbranch_scc0 L_kvn1
buffer_load_dwordx4 v[148:151], v55, s[12:15], s88 offen sc1
L_kvn1:
s_waitcnt vmcnt(0)
s_branch L_kvr
L_pad10:
s_branch L_pad16
L_pksame:
s_cmp_eq_u32 s73, 0
s_cbranch_scc1 L_pkf
s_add_u32 s78, s78, 1
s_cmp_le_u32 s78, 65536
s_cbranch_scc1 L_pk
s_branch L_pkf
L_pkx_rt:
s_add_u32 s78, s78, 1
s_cmp_gt_u32 s78, 65536
s_cbranch_scc1 L_pkx_ok
s_mov_b64 exec, s[92:93]
buffer_load_dwordx4 v[24:27], v58, s[12:15], 0 offen offset:0 sc1
buffer_load_dwordx4 v[28:31], v58, s[12:15], 0 offen offset:64 sc1
buffer_load_dwordx4 v[32:35], v58, s[12:15], 0 offen offset:128 sc1
buffer_load_dwordx4 v[36:39], v58, s[12:15], 0 offen offset:192 sc1
buffer_load_dwordx4 v[40:43], v58, s[12:15], 0 offen offset:256 sc1
buffer_load_dwordx4 v[44:47], v58, s[12:15], 0 offen offset:320 sc1
buffer_load_dwordx4 v[48:51], v58, s[12:15], 0 offen offset:384 sc1
buffer_load_dwordx4 v[52:55], v58, s[12:15], 0 offen offset:448 sc1
s_mov_b64 exec, -1
v_mul_f32_e64 v84, v68, -v21
v_mul_f32_e64 v85, v69, -v21
v_mul_f32_e64 v86, v70, -v21
v_mul_f32_e64 v87, v71, -v21
v_mul_f32_e64 v88, v72, -v21
v_mul_f32_e64 v89, v73, -v21
v_mul_f32_e64 v90, v74, -v21
v_mul_f32_e64 v91, v75, -v21
s_branch L_pkf
L_pxp_s:
buffer_store_dwordx4 v[84:87], v60, s[12:15], s85 offen sc1
s_branch L_pxp_d
L_pad11:
s_branch L_pad17
L_px_rt:
s_add_u32 s78, s78, 1
s_cmp_gt_u32 s78, 65536
s_cbranch_scc1 L_px_ok
v_and_b32 v2, s91, v24
v_cmp_ne_u32 vcc, 0, v2
v_xor_b32 v24, s84, v24
s_cbranch_vccz L_px_p0
buffer_load_dwordx4 v[24:27], v61, s[12:15], s86 offen offset:0 sc1
L_px_p0:
v_and_b32 v2, s91, v28
v_cmp_ne_u32 vcc, 0, v2
v_xor_b32 v28, s84, v28
s_cbranch_vccz L_px_p1
buffer_load_dwordx4 v[28:31], v61, s[12:15], s86 offen offset:1024 sc1
L_px_p1:
v_and_b32 v2, s91, v32
v_cmp_ne_u32 vcc, 0, v2
v_xor_b32 v32, s84, v32
s_cbranch_vccz L_px_p2
buffer_load_dwordx4 v[32:35], v61, s[12:15], s86 offen offset:2048 sc1
L_px_p2:
v_and_b32 v2, s91, v36
v_cmp_ne_u32 vcc, 0, v2
v_xor_b32 v36, s84, v36
s_cbranch_vccz L_px_p3
buffer_load_dwordx4 v[36:39], v61, s[12:15], s86 offen offset:3072 sc1
L_px_p3:
s_waitcnt vmcnt(0)
s_branch L_px_chk
L_pad12:
s_branch L_pad18
L_yown:
v_bfi_b32 v40, s91, v59, v40
buffer_store_dwordx4 v[40:43], v62, s[12:15], s88 offen
s_add_u32 s88, s88, 16384
v_bfi_b32 v44, s91, v59, v44
buffer_store_dwordx4 v[44:47], v62, s[12:15], s88 offen
s_add_u32 s88, s88, 16384
v_bfi_b32 v48, s91, v59, v48
buffer_store_dwordx4 v[48:51], v62, s[12:15], s88 offen
s_add_u32 s88, s88, 16384
v_bfi_b32 v52, s91, v59, v52
buffer_store_dwordx4 v[52:55], v62, s[12:15], s88 offen
s_branch L_yd
L_h_rt:
s_add_u32 s78, s78, 1
s_cmp_gt_u32 s78, 65536
s_cbranch_scc1 L_h_ok
buffer_load_ushort v84, v64, s[12:15], s72 offen sc1
s_waitcnt vmcnt(0)
s_branch L_h_chk
L_pad13:
s_branch L_pad19
L_y_rt:
s_add_u32 s78, s78, 1
s_cmp_gt_u32 s78, 65536
s_cbranch_scc1 L_yf0
buffer_load_dwordx4 v[120:123], v18, s[12:15], s88 offen offset:0 sc1
buffer_load_dwordx4 v[124:127], v18, s[12:15], s88 offen offset:1024 sc1
buffer_load_dwordx4 v[128:131], v18, s[12:15], s88 offen offset:2048 sc1
buffer_load_dwordx4 v[132:135], v18, s[12:15], s88 offen offset:3072 sc1
buffer_load_dwordx4 v[136:139], v18, s[12:15], s71 offen offset:0 sc1
buffer_load_dwordx4 v[140:143], v18, s[12:15], s71 offen offset:1024 sc1
buffer_load_dwordx4 v[144:147], v18, s[12:15], s71 offen offset:2048 sc1
v_mov_b32 v88, s84
s_waitcnt vmcnt(14)
v_xor_b32 v24, s84, v24
v_xor_b32 v28, s84, v28
v_xor_b32 v32, s84, v32
v_xor_b32_e64 v36, s84, v36
v_or3_b32 v2, v24, v28, v32
v_xor_b32 v92, s84, v92
v_xor_b32 v96, s84, v96
v_or3_b32 v2, v2, v36, v92
v_xor_b32 v100, s84, v100
v_xor_b32 v88, s84, v88
v_or3_b32 v2, v2, v96, v100
v_bitop3_b32 v2, v2, v88, s91 bitop3:0xa8
v_cmp_ne_u32 vcc, 0, v2
s_cbranch_vccz L_yf1
buffer_load_dwordx4 v[24:27], v18, s[12:15], s88 offen offset:0 sc1
buffer_load_dwordx4 v[28:31], v18, s[12:15], s88 offen offset:1024 sc1
buffer_load_dwordx4 v[32:35], v18, s[12:15], s88 offen offset:2048 sc1
buffer_load_dwordx4 v[36:39], v18, s[12:15], s88 offen offset:3072 sc1
buffer_load_dwordx4 v[92:95], v18, s[12:15], s71 offen offset:0 sc1
buffer_load_dwordx4 v[96:99], v18, s[12:15], s71 offen offset:1024 sc1
buffer_load_dwordx4 v[100:103], v18, s[12:15], s71 offen offset:2048 sc1
v_mov_b32 v88, s84
s_waitcnt vmcnt(14)
v_xor_b32 v40, s84, v40
v_xor_b32 v44, s84, v44
v_xor_b32 v48, s84, v48
v_xor_b32 v52, s84, v52
v_or3_b32 v2, v40, v44, v48
v_xor_b32 v104, s84, v104
v_xor_b32 v108, s84, v108
v_or3_b32 v2, v2, v52, v104
v_xor_b32 v112, s84, v112
v_xor_b32 v88, s84, v88
v_or3_b32 v2, v2, v108, v112
v_bitop3_b32 v2, v2, v88, s91 bitop3:0xa8
v_cmp_ne_u32 vcc, 0, v2
s_cbranch_vccz L_yf2
buffer_load_dwordx4 v[40:43], v18, s[12:15], s88 offen offset:0 sc1
buffer_load_dwordx4 v[44:47], v18, s[12:15], s88 offen offset:1024 sc1
buffer_load_dwordx4 v[48:51], v18, s[12:15], s88 offen offset:2048 sc1
buffer_load_dwordx4 v[52:55], v18, s[12:15], s88 offen offset:3072 sc1
buffer_load_dwordx4 v[104:107], v18, s[12:15], s71 offen offset:0 sc1
buffer_load_dwordx4 v[108:111], v18, s[12:15], s71 offen offset:1024 sc1
buffer_load_dwordx4 v[112:115], v18, s[12:15], s71 offen offset:2048 sc1
v_mov_b32 v88, s84
s_branch L_yr
L_yf1:
v_pk_add_f32 v[24:25], v[24:25], v[28:29]
v_pk_add_f32 v[26:27], v[26:27], v[30:31]
v_pk_add_f32 v[32:33], v[32:33], v[36:37]
v_pk_add_f32 v[34:35], v[34:35], v[38:39]
v_pk_add_f32 v[92:93], v[92:93], v[96:97]
v_pk_add_f32 v[94:95], v[94:95], v[98:99]
v_pk_add_f32 v[24:25], v[24:25], v[32:33]
v_pk_add_f32 v[26:27], v[26:27], v[34:35]
v_pk_add_f32 v[92:93], v[92:93], v[100:101]
v_pk_add_f32 v[94:95], v[94:95], v[102:103]
v_pk_add_f32 v[24:25], v[24:25], v[92:93]
v_pk_add_f32 v[26:27], v[26:27], v[94:95]
s_nop 1
v_permlane32_swap_b32 v24, v26
v_permlane32_swap_b32 v25, v27
v_add_f32 v68, v24, v26
v_add_f32_e64 v69, v25, v27
s_nop 0
s_branch L_yf
L_yf2:
v_pk_add_f32 v[40:41], v[40:41], v[44:45]
v_pk_add_f32 v[42:43], v[42:43], v[46:47]
v_pk_add_f32 v[48:49], v[48:49], v[52:53]
v_pk_add_f32 v[50:51], v[50:51], v[54:55]
v_pk_add_f32 v[104:105], v[104:105], v[108:109]
v_pk_add_f32 v[106:107], v[106:107], v[110:111]
v_pk_add_f32 v[40:41], v[40:41], v[48:49]
v_pk_add_f32 v[42:43], v[42:43], v[50:51]
v_pk_add_f32 v[104:105], v[104:105], v[112:113]
v_pk_add_f32 v[106:107], v[106:107], v[114:115]
v_pk_add_f32 v[40:41], v[40:41], v[104:105]
v_pk_add_f32 v[42:43], v[42:43], v[106:107]
s_nop 1
v_permlane32_swap_b32 v40, v42
v_permlane32_swap_b32 v41, v43
v_add_f32 v68, v40, v42
v_add_f32_e64 v69, v41, v43
s_nop 0
s_branch L_yf
L_kvp_s:
buffer_store_dwordx4 v[140:143], v16, s[12:15], s72 offen sc1
s_mov_b64 exec, s[92:93]
buffer_store_dwordx4 v[136:139], v4, s[12:15], s73 offen sc1
s_mov_b64 exec, -1
s_branch L_kvp_d
L_pad14:
s_branch L_retF
L_k2_rt:
s_add_u32 s78, s78, 1
s_cmp_gt_u32 s78, 65536
s_cbranch_scc1 L_k2_ok
buffer_load_dwordx4 v[136:139], v17, s[12:15], 0 offen sc1
buffer_load_dwordx4 v[140:143], v17, s[12:15], 0 offen offset:1024 sc1
s_waitcnt vmcnt(0)
s_branch L_k2_chk
L_pad15:
s_branch L_retF
L_oown0:
buffer_store_dwordx4 v[52:55], v16, s[12:15], s70 offen
s_branch L_ood0
L_oown1:
buffer_store_dwordx4 v[76:79], v16, s[12:15], s70 offen
s_branch L_ood1
L_oown2:
buffer_store_dwordx4 v[100:103], v16, s[12:15], s70 offen
s_branch L_ood2
L_oown3:
buffer_store_dwordx4 v[124:127], v16, s[12:15], s70 offen
s_branch L_ood3
L_pad16:
s_branch L_retG
L_o0_rt:
s_add_u32 s78, s78, 1
s_cmp_gt_u32 s78, 65536
s_cbranch_scc1 L_o0_ok
buffer_load_dwordx4 v[56:59], v6, s[12:15], s24 offen offset:0 sc1
buffer_load_dwordx4 v[60:63], v19, s[12:15], s24 offen offset:0 sc1
buffer_load_dwordx4 v[64:67], v6, s[12:15], s24 offen offset:1024 sc1
buffer_load_dwordx4 v[68:71], v19, s[12:15], s24 offen offset:1024 sc1
s_waitcnt vmcnt(4)
v_max3_u32 v2, v72, v76, v80
v_max3_u32 v2, v2, v84, v88
v_max3_u32 v2, v2, v92, v96
v_max3_u32 v2, v2, v100, v100
v_cmp_eq_u32 vcc, -1, v2
s_cbranch_vccz L_o0_a
buffer_load_dwordx4 v[72:75], v6, s[12:15], s25 offen offset:0 sc1
buffer_load_dwordx4 v[76:79], v19, s[12:15], s25 offen offset:0 sc1
buffer_load_dwordx4 v[80:83], v6, s[12:15], s25 offen offset:1024 sc1
buffer_load_dwordx4 v[84:87], v19, s[12:15], s25 offen offset:1024 sc1
buffer_load_dwordx4 v[88:91], v6, s[12:15], s26 offen offset:0 sc1
buffer_load_dwordx4 v[92:95], v19, s[12:15], s26 offen offset:0 sc1
buffer_load_dwordx4 v[96:99], v6, s[12:15], s26 offen offset:1024 sc1
buffer_load_dwordx4 v[100:103], v19, s[12:15], s26 offen offset:1024 sc1
s_waitcnt vmcnt(8)
s_branch L_o0_b
L_o0_a:
s_waitcnt vmcnt(0)
L_o0_b:
v_max3_u32 v2, v56, v60, v64
v_max_u32 v2, v2, v68
v_cmp_eq_u32 vcc, -1, v2
s_cbranch_vccnz L_o0_rt
s_branch L_o0_ok
L_pad17:
s_branch L_retG
L_o1_rt:
s_add_u32 s78, s78, 1
s_cmp_gt_u32 s78, 65536
s_cbranch_scc1 L_o1_ok
buffer_load_dwordx4 v[72:75], v6, s[12:15], s25 offen offset:0 sc1
buffer_load_dwordx4 v[76:79], v19, s[12:15], s25 offen offset:0 sc1
buffer_load_dwordx4 v[80:83], v6, s[12:15], s25 offen offset:1024 sc1
buffer_load_dwordx4 v[84:87], v19, s[12:15], s25 offen offset:1024 sc1
s_waitcnt vmcnt(4)
v_max3_u32 v2, v88, v92, v96
v_max3_u32 v2, v2, v100, v104
v_max3_u32 v2, v2, v108, v112
v_max3_u32 v2, v2, v116, v116
v_cmp_eq_u32 vcc, -1, v2
s_cbranch_vccz L_o1_a
buffer_load_dwordx4 v[88:91], v6, s[12:15], s26 offen offset:0 sc1
buffer_load_dwordx4 v[92:95], v19, s[12:15], s26 offen offset:0 sc1
buffer_load_dwordx4 v[96:99], v6, s[12:15], s26 offen offset:1024 sc1
buffer_load_dwordx4 v[100:103], v19, s[12:15], s26 offen offset:1024 sc1
buffer_load_dwordx4 v[104:107], v6, s[12:15], s27 offen offset:0 sc1
buffer_load_dwordx4 v[108:111], v19, s[12:15], s27 offen offset:0 sc1
buffer_load_dwordx4 v[112:115], v6, s[12:15], s27 offen offset:1024 sc1
buffer_load_dwordx4 v[116:119], v19, s[12:15], s27 offen offset:1024 sc1
s_waitcnt vmcnt(8)
s_branch L_o1_b
L_o1_a:
s_waitcnt vmcnt(0)
L_o1_b:
v_max3_u32 v2, v72, v76, v80
v_max_u32 v2, v2, v84
v_cmp_eq_u32 vcc, -1, v2
s_cbranch_vccnz L_o1_rt
s_branch L_o1_ok
L_o2_rt:
s_add_u32 s78, s78, 1
s_cmp_gt_u32 s78, 65536
s_cbranch_scc1 L_o2_ok
buffer_load_dwordx4 v[88:91], v6, s[12:15], s26 offen offset:0 sc1
buffer_load_dwordx4 v[92:95], v19, s[12:15], s26 offen offset:0 sc1
buffer_load_dwordx4 v[96:99], v6, s[12:15], s26 offen offset:1024 sc1
buffer_load_dwordx4 v[100:103], v19, s[12:15], s26 offen offset:1024 sc1
s_waitcnt vmcnt(4)
v_max3_u32 v2, v104, v108, v112
v_max3_u32 v2, v2, v116, v56
v_max3_u32 v2, v2, v60, v64
v_max3_u32 v2, v2, v68, v68
v_cmp_eq_u32 vcc, -1, v2
s_cbranch_vccz L_o2_a
buffer_load_dwordx4 v[104:107], v6, s[12:15], s27 offen offset:0 sc1
buffer_load_dwordx4 v[108:111], v19, s[12:15], s27 offen offset:0 sc1
buffer_load_dwordx4 v[112:115], v6, s[12:15], s27 offen offset:1024 sc1
buffer_load_dwordx4 v[116:119], v19, s[12:15], s27 offen offset:1024 sc1
buffer_load_dwordx4 v[56:59], v6, s[12:15], s28 offen offset:0 sc1
buffer_load_dwordx4 v[60:63], v19, s[12:15], s28 offen offset:0 sc1
buffer_load_dwordx4 v[64:67], v6, s[12:15], s28 offen offset:1024 sc1
buffer_load_dwordx4 v[68:71], v19, s[12:15], s28 offen offset:1024 sc1
s_waitcnt vmcnt(8)
s_branch L_o2_b
L_o2_a:
s_waitcnt vmcnt(0)
L_o2_b:
v_max3_u32 v2, v88, v92, v96
v_max_u32 v2, v2, v100
v_cmp_eq_u32 vcc, -1, v2
s_cbranch_vccnz L_o2_rt
s_branch L_o2_ok
L_o3_rt:
s_add_u32 s78, s78, 1
s_cmp_gt_u32 s78, 65536
s_cbranch_scc1 L_o3_ok
buffer_load_dwordx4 v[104:107], v6, s[12:15], s27 offen offset:0 sc1
buffer_load_dwordx4 v[108:111], v19, s[12:15], s27 offen offset:0 sc1
buffer_load_dwordx4 v[112:115], v6, s[12:15], s27 offen offset:1024 sc1
buffer_load_dwordx4 v[116:119], v19, s[12:15], s27 offen offset:1024 sc1
s_waitcnt vmcnt(4)
v_max3_u32 v2, v56, v60, v64
v_max3_u32 v2, v2, v68, v72
v_max3_u32 v2, v2, v76, v80
v_max3_u32 v2, v2, v84, v84
v_cmp_eq_u32 vcc, -1, v2
s_cbranch_vccz L_o3_a
buffer_load_dwordx4 v[56:59], v6, s[12:15], s28 offen offset:0 sc1
buffer_load_dwordx4 v[60:63], v19, s[12:15], s28 offen offset:0 sc1
buffer_load_dwordx4 v[64:67], v6, s[12:15], s28 offen offset:1024 sc1
buffer_load_dwordx4 v[68:71], v19, s[12:15], s28 offen offset:1024 sc1
buffer_load_dwordx4 v[72:75], v6, s[12:15], s29 offen offset:0 sc1
buffer_load_dwordx4 v[76:79], v19, s[12:15], s29 offen offset:0 sc1
buffer_load_dwordx4 v[80:83], v6, s[12:15], s29 offen offset:1024 sc1
buffer_load_dwordx4 v[84:87], v19, s[12:15], s29 offen offset:1024 sc1
s_waitcnt vmcnt(8)
s_branch L_o3_b
L_o3_a:
s_waitcnt vmcnt(0)
L_o3_b:
v_max3_u32 v2, v104, v108, v112
v_max_u32 v2, v2, v116
v_cmp_eq_u32 vcc, -1, v2
s_cbranch_vccnz L_o3_rt
s_branch L_o3_ok
L_o4_rt:
s_add_u32 s78, s78, 1
s_cmp_gt_u32 s78, 65536
s_cbranch_scc1 L_o4_ok
buffer_load_dwordx4 v[56:59], v6, s[12:15], s28 offen offset:0 sc1
buffer_load_dwordx4 v[60:63], v19, s[12:15], s28 offen offset:0 sc1
buffer_load_dwordx4 v[64:67], v6, s[12:15], s28 offen offset:1024 sc1
buffer_load_dwordx4 v[68:71], v19, s[12:15], s28 offen offset:1024 sc1
s_waitcnt vmcnt(4)
v_max3_u32 v2, v72, v76, v80
v_max3_u32 v2, v2, v84, v88
v_max3_u32 v2, v2, v92, v96
v_max3_u32 v2, v2, v100, v100
v_cmp_eq_u32 vcc, -1, v2
s_cbranch_vccz L_o4_a
buffer_load_dwordx4 v[72:75], v6, s[12:15], s29 offen offset:0 sc1
buffer_load_dwordx4 v[76:79], v19, s[12:15], s29 offen offset:0 sc1
buffer_load_dwordx4 v[80:83], v6, s[12:15], s29 offen offset:1024 sc1
buffer_load_dwordx4 v[84:87], v19, s[12:15], s29 offen offset:1024 sc1
buffer_load_dwordx4 v[88:91], v6, s[12:15], s30 offen offset:0 sc1
buffer_load_dwordx4 v[92:95], v19, s[12:15], s30 offen offset:0 sc1
buffer_load_dwordx4 v[96:99], v6, s[12:15], s30 offen offset:1024 sc1
buffer_load_dwordx4 v[100:103], v19, s[12:15], s30 offen offset:1024 sc1
s_waitcnt vmcnt(8)
s_branch L_o4_b
L_o4_a:
s_waitcnt vmcnt(0)
L_o4_b:
v_max3_u32 v2, v56, v60, v64
v_max_u32 v2, v2, v68
v_cmp_eq_u32 vcc, -1, v2
s_cbranch_vccnz L_o4_rt
s_branch L_o4_ok
L_o5_rt:
s_add_u32 s78, s78, 1
s_cmp_gt_u32 s78, 65536
s_cbranch_scc1 L_o5_ok
buffer_load_dwordx4 v[72:75], v6, s[12:15], s29 offen offset:0 sc1
buffer_load_dwordx4 v[76:79], v19, s[12:15], s29 offen offset:0 sc1
buffer_load_dwordx4 v[80:83], v6, s[12:15], s29 offen offset:1024 sc1
buffer_load_dwordx4 v[84:87], v19, s[12:15], s29 offen offset:1024 sc1
s_waitcnt vmcnt(4)
v_max3_u32 v2, v88, v92, v96
v_max3_u32 v2, v2, v100, v104
v_max3_u32 v2, v2, v108, v112
v_max3_u32 v2, v2, v116, v116
v_cmp_eq_u32 vcc, -1, v2
s_cbranch_vccz L_o5_a
buffer_load_dwordx4 v[88:91], v6, s[12:15], s30 offen offset:0 sc1
buffer_load_dwordx4 v[92:95], v19, s[12:15], s30 offen offset:0 sc1
buffer_load_dwordx4 v[96:99], v6, s[12:15], s30 offen offset:1024 sc1
buffer_load_dwordx4 v[100:103], v19, s[12:15], s30 offen offset:1024 sc1
buffer_load_dwordx4 v[104:107], v6, s[12:15], s31 offen offset:0 sc1
buffer_load_dwordx4 v[108:111], v19, s[12:15], s31 offen offset:0 sc1
buffer_load_dwordx4 v[112:115], v6, s[12:15], s31 offen offset:1024 sc1
buffer_load_dwordx4 v[116:119], v19, s[12:15], s31 offen offset:1024 sc1
s_waitcnt vmcnt(8)
s_branch L_o5_b
L_o5_a:
s_waitcnt vmcnt(0)
L_o5_b:
v_max3_u32 v2, v72, v76, v80
v_max_u32 v2, v2, v84
v_cmp_eq_u32 vcc, -1, v2
s_cbranch_vccnz L_o5_rt
s_branch L_o5_ok
L_o6_rt:
s_add_u32 s78, s78, 1
s_cmp_gt_u32 s78, 65536
s_cbranch_scc1 L_o6_ok
buffer_load_dwordx4 v[88:91], v6, s[12:15], s30 offen offset:0 sc1
buffer_load_dwordx4 v[92:95], v19, s[12:15], s30 offen offset:0 sc1
buffer_load_dwordx4 v[96:99], v6, s[12:15], s30 offen offset:1024 sc1
buffer_load_dwordx4 v[100:103], v19, s[12:15], s30 offen offset:1024 sc1
s_waitcnt vmcnt(4)
v_max3_u32 v2, v104, v108, v112
v_max3_u32 v2, v2, v116, v56
v_max3_u32 v2, v2, v60, v64
v_max3_u32 v2, v2, v68, v68
v_cmp_eq_u32 vcc, -1, v2
s_cbranch_vccz L_o6_a
buffer_load_dwordx4 v[104:107], v6, s[12:15], s31 offen offset:0 sc1
buffer_load_dwordx4 v[108:111], v19, s[12:15], s31 offen offset:0 sc1
buffer_load_dwordx4 v[112:115], v6, s[12:15], s31 offen offset:1024 sc1
buffer_load_dwordx4 v[116:119], v19, s[12:15], s31 offen offset:1024 sc1
buffer_load_dwordx4 v[56:59], v6, s[12:15], s32 offen offset:0 sc1
buffer_load_dwordx4 v[60:63], v19, s[12:15], s32 offen offset:0 sc1
buffer_load_dwordx4 v[64:67], v6, s[12:15], s32 offen offset:1024 sc1
buffer_load_dwordx4 v[68:71], v19, s[12:15], s32 offen offset:1024 sc1
s_waitcnt vmcnt(8)
s_branch L_o6_b
L_o6_a:
s_waitcnt vmcnt(0)
L_o6_b:
v_max3_u32 v2, v88, v92, v96
v_max_u32 v2, v2, v100
v_cmp_eq_u32 vcc, -1, v2
s_cbranch_vccnz L_o6_rt
s_branch L_o6_ok
L_o7_rt:
s_add_u32 s78, s78, 1
s_cmp_gt_u32 s78, 65536
s_cbranch_scc1 L_o7_ok
buffer_load_dwordx4 v[104:107], v6, s[12:15], s31 offen offset:0 sc1
buffer_load_dwordx4 v[108:111], v19, s[12:15], s31 offen offset:0 sc1
buffer_load_dwordx4 v[112:115], v6, s[12:15], s31 offen offset:1024 sc1
buffer_load_dwordx4 v[116:119], v19, s[12:15], s31 offen offset:1024 sc1
s_waitcnt vmcnt(4)
v_max3_u32 v2, v56, v60, v64
v_max3_u32 v2, v2, v68, v72
v_max3_u32 v2, v2, v76, v80
v_max3_u32 v2, v2, v84, v84
v_cmp_eq_u32 vcc, -1, v2
s_cbranch_vccz L_o7_a
buffer_load_dwordx4 v[56:59], v6, s[12:15], s32 offen offset:0 sc1
buffer_load_dwordx4 v[60:63], v19, s[12:15], s32 offen offset:0 sc1
buffer_load_dwordx4 v[64:67], v6, s[12:15], s32 offen offset:1024 sc1
buffer_load_dwordx4 v[68:71], v19, s[12:15], s32 offen offset:1024 sc1
buffer_load_dwordx4 v[72:75], v6, s[12:15], s33 offen offset:0 sc1
buffer_load_dwordx4 v[76:79], v19, s[12:15], s33 offen offset:0 sc1
buffer_load_dwordx4 v[80:83], v6, s[12:15], s33 offen offset:1024 sc1
buffer_load_dwordx4 v[84:87], v19, s[12:15], s33 offen offset:1024 sc1
s_waitcnt vmcnt(8)
s_branch L_o7_b
L_o7_a:
s_waitcnt vmcnt(0)
L_o7_b:
v_max3_u32 v2, v104, v108, v112
v_max_u32 v2, v2, v116
v_cmp_eq_u32 vcc, -1, v2
s_cbranch_vccnz L_o7_rt
s_branch L_o7_ok
L_o8_rt:
s_add_u32 s78, s78, 1
s_cmp_gt_u32 s78, 65536
s_cbranch_scc1 L_o8_ok
buffer_load_dwordx4 v[56:59], v6, s[12:15], s32 offen offset:0 sc1
buffer_load_dwordx4 v[60:63], v19, s[12:15], s32 offen offset:0 sc1
buffer_load_dwordx4 v[64:67], v6, s[12:15], s32 offen offset:1024 sc1
buffer_load_dwordx4 v[68:71], v19, s[12:15], s32 offen offset:1024 sc1
s_waitcnt vmcnt(4)
v_max3_u32 v2, v72, v76, v80
v_max3_u32 v2, v2, v84, v88
v_max3_u32 v2, v2, v92, v96
v_max3_u32 v2, v2, v100, v100
v_cmp_eq_u32 vcc, -1, v2
s_cbranch_vccz L_o8_a
buffer_load_dwordx4 v[72:75], v6, s[12:15], s33 offen offset:0 sc1
buffer_load_dwordx4 v[76:79], v19, s[12:15], s33 offen offset:0 sc1
buffer_load_dwordx4 v[80:83], v6, s[12:15], s33 offen offset:1024 sc1
buffer_load_dwordx4 v[84:87], v19, s[12:15], s33 offen offset:1024 sc1
buffer_load_dwordx4 v[88:91], v6, s[12:15], s34 offen offset:0 sc1
buffer_load_dwordx4 v[92:95], v19, s[12:15], s34 offen offset:0 sc1
buffer_load_dwordx4 v[96:99], v6, s[12:15], s34 offen offset:1024 sc1
buffer_load_dwordx4 v[100:103], v19, s[12:15], s34 offen offset:1024 sc1
s_waitcnt vmcnt(8)
s_branch L_o8_b
L_o8_a:
s_waitcnt vmcnt(0)
L_o8_b:
v_max3_u32 v2, v56, v60, v64
v_max_u32 v2, v2, v68
v_cmp_eq_u32 vcc, -1, v2
s_cbranch_vccnz L_o8_rt
s_branch L_o8_ok
L_o9_rt:
s_add_u32 s78, s78, 1
s_cmp_gt_u32 s78, 65536
s_cbranch_scc1 L_o9_ok
buffer_load_dwordx4 v[72:75], v6, s[12:15], s33 offen offset:0 sc1
buffer_load_dwordx4 v[76:79], v19, s[12:15], s33 offen offset:0 sc1
buffer_load_dwordx4 v[80:83], v6, s[12:15], s33 offen offset:1024 sc1
buffer_load_dwordx4 v[84:87], v19, s[12:15], s33 offen offset:1024 sc1
s_waitcnt vmcnt(4)
v_max3_u32 v2, v88, v92, v96
v_max3_u32 v2, v2, v100, v104
v_max3_u32 v2, v2, v108, v112
v_max3_u32 v2, v2, v116, v116
v_cmp_eq_u32 vcc, -1, v2
s_cbranch_vccz L_o9_a
buffer_load_dwordx4 v[88:91], v6, s[12:15], s34 offen offset:0 sc1
buffer_load_dwordx4 v[92:95], v19, s[12:15], s34 offen offset:0 sc1
buffer_load_dwordx4 v[96:99], v6, s[12:15], s34 offen offset:1024 sc1
buffer_load_dwordx4 v[100:103], v19, s[12:15], s34 offen offset:1024 sc1
buffer_load_dwordx4 v[104:107], v6, s[12:15], s35 offen offset:0 sc1
buffer_load_dwordx4 v[108:111], v19, s[12:15], s35 offen offset:0 sc1
buffer_load_dwordx4 v[112:115], v6, s[12:15], s35 offen offset:1024 sc1
buffer_load_dwordx4 v[116:119], v19, s[12:15], s35 offen offset:1024 sc1
s_waitcnt vmcnt(8)
s_branch L_o9_b
L_o9_a:
s_waitcnt vmcnt(0)
L_o9_b:
v_max3_u32 v2, v72, v76, v80
v_max_u32 v2, v2, v84
v_cmp_eq_u32 vcc, -1, v2
s_cbranch_vccnz L_o9_rt
s_branch L_o9_ok
L_o10_rt:
s_add_u32 s78, s78, 1
s_cmp_gt_u32 s78, 65536
s_cbranch_scc1 L_o10_ok
buffer_load_dwordx4 v[88:91], v6, s[12:15], s34 offen offset:0 sc1
buffer_load_dwordx4 v[92:95], v19, s[12:15], s34 offen offset:0 sc1
buffer_load_dwordx4 v[96:99], v6, s[12:15], s34 offen offset:1024 sc1
buffer_load_dwordx4 v[100:103], v19, s[12:15], s34 offen offset:1024 sc1
s_waitcnt vmcnt(4)
v_max3_u32 v2, v104, v108, v112
v_max3_u32 v2, v2, v116, v56
v_max3_u32 v2, v2, v60, v64
v_max3_u32 v2, v2, v68, v68
v_cmp_eq_u32 vcc, -1, v2
s_cbranch_vccz L_o10_a
buffer_load_dwordx4 v[104:107], v6, s[12:15], s35 offen offset:0 sc1
buffer_load_dwordx4 v[108:111], v19, s[12:15], s35 offen offset:0 sc1
buffer_load_dwordx4 v[112:115], v6, s[12:15], s35 offen offset:1024 sc1
buffer_load_dwordx4 v[116:119], v19, s[12:15], s35 offen offset:1024 sc1
buffer_load_dwordx4 v[56:59], v6, s[12:15], s36 offen offset:0 sc1
buffer_load_dwordx4 v[60:63], v19, s[12:15], s36 offen offset:0 sc1
buffer_load_dwordx4 v[64:67], v6, s[12:15], s36 offen offset:1024 sc1
buffer_load_dwordx4 v[68:71], v19, s[12:15], s36 offen offset:1024 sc1
s_waitcnt vmcnt(8)
s_branch L_o10_b
L_o10_a:
s_waitcnt vmcnt(0)
L_o10_b:
v_max3_u32 v2, v88, v92, v96
v_max_u32 v2, v2, v100
v_cmp_eq_u32 vcc, -1, v2
s_cbranch_vccnz L_o10_rt
s_branch L_o10_ok
L_o11_rt:
s_add_u32 s78, s78, 1
s_cmp_gt_u32 s78, 65536
s_cbranch_scc1 L_o11_ok
buffer_load_dwordx4 v[104:107], v6, s[12:15], s35 offen offset:0 sc1
buffer_load_dwordx4 v[108:111], v19, s[12:15], s35 offen offset:0 sc1
buffer_load_dwordx4 v[112:115], v6, s[12:15], s35 offen offset:1024 sc1
buffer_load_dwordx4 v[116:119], v19, s[12:15], s35 offen offset:1024 sc1
s_waitcnt vmcnt(4)
v_max3_u32 v2, v56, v60, v64
v_max3_u32 v2, v2, v68, v72
v_max3_u32 v2, v2, v76, v80
v_max3_u32 v2, v2, v84, v84
v_cmp_eq_u32 vcc, -1, v2
s_cbranch_vccz L_o11_a
buffer_load_dwordx4 v[56:59], v6, s[12:15], s36 offen offset:0 sc1
buffer_load_dwordx4 v[60:63], v19, s[12:15], s36 offen offset:0 sc1
buffer_load_dwordx4 v[64:67], v6, s[12:15], s36 offen offset:1024 sc1
buffer_load_dwordx4 v[68:71], v19, s[12:15], s36 offen offset:1024 sc1
buffer_load_dwordx4 v[72:75], v6, s[12:15], s37 offen offset:0 sc1
buffer_load_dwordx4 v[76:79], v19, s[12:15], s37 offen offset:0 sc1
buffer_load_dwordx4 v[80:83], v6, s[12:15], s37 offen offset:1024 sc1
buffer_load_dwordx4 v[84:87], v19, s[12:15], s37 offen offset:1024 sc1
s_waitcnt vmcnt(8)
s_branch L_o11_b
L_o11_a:
s_waitcnt vmcnt(0)
L_o11_b:
v_max3_u32 v2, v104, v108, v112
v_max_u32 v2, v2, v116
v_cmp_eq_u32 vcc, -1, v2
s_cbranch_vccnz L_o11_rt
s_branch L_o11_ok
L_o12_rt:
s_add_u32 s78, s78, 1
s_cmp_gt_u32 s78, 65536
s_cbranch_scc1 L_o12_ok
buffer_load_dwordx4 v[56:59], v6, s[12:15], s36 offen offset:0 sc1
buffer_load_dwordx4 v[60:63], v19, s[12:15], s36 offen offset:0 sc1
buffer_load_dwordx4 v[64:67], v6, s[12:15], s36 offen offset:1024 sc1
buffer_load_dwordx4 v[68:71], v19, s[12:15], s36 offen offset:1024 sc1
s_waitcnt vmcnt(4)
v_max3_u32 v2, v72, v76, v80
v_max3_u32 v2, v2, v84, v88
v_max3_u32 v2, v2, v92, v96
v_max3_u32 v2, v2, v100, v100
v_cmp_eq_u32 vcc, -1, v2
s_cbranch_vccz L_o12_a
buffer_load_dwordx4 v[72:75], v6, s[12:15], s37 offen offset:0 sc1
buffer_load_dwordx4 v[76:79], v19, s[12:15], s37 offen offset:0 sc1
buffer_load_dwordx4 v[80:83], v6, s[12:15], s37 offen offset:1024 sc1
buffer_load_dwordx4 v[84:87], v19, s[12:15], s37 offen offset:1024 sc1
buffer_load_dwordx4 v[88:91], v6, s[12:15], s38 offen offset:0 sc1
buffer_load_dwordx4 v[92:95], v19, s[12:15], s38 offen offset:0 sc1
buffer_load_dwordx4 v[96:99], v6, s[12:15], s38 offen offset:1024 sc1
buffer_load_dwordx4 v[100:103], v19, s[12:15], s38 offen offset:1024 sc1
s_waitcnt vmcnt(8)
s_branch L_o12_b
L_o12_a:
s_waitcnt vmcnt(0)
L_o12_b:
v_max3_u32 v2, v56, v60, v64
v_max_u32 v2, v2, v68
v_cmp_eq_u32 vcc, -1, v2
s_cbranch_vccnz L_o12_rt
s_branch L_o12_ok
L_o13_rt:
s_add_u32 s78, s78, 1
s_cmp_gt_u32 s78, 65536
s_cbranch_scc1 L_o13_ok
buffer_load_dwordx4 v[72:75], v6, s[12:15], s37 offen offset:0 sc1
buffer_load_dwordx4 v[76:79], v19, s[12:15], s37 offen offset:0 sc1
s_branch L_over18
L_pad18:
s_branch L_retG
L_over18:
buffer_load_dwordx4 v[80:83], v6, s[12:15], s37 offen offset:1024 sc1
buffer_load_dwordx4 v[84:87], v19, s[12:15], s37 offen offset:1024 sc1
s_waitcnt vmcnt(4)
v_max3_u32 v2, v88, v92, v96
v_max3_u32 v2, v2, v100, v104
v_max3_u32 v2, v2, v108, v112
v_max3_u32 v2, v2, v116, v116
v_cmp_eq_u32 vcc, -1, v2
s_cbranch_vccz L_o13_a
buffer_load_dwordx4 v[88:91], v6, s[12:15], s38 offen offset:0 sc1
buffer_load_dwordx4 v[92:95], v19, s[12:15], s38 offen offset:0 sc1
buffer_load_dwordx4 v[96:99], v6, s[12:15], s38 offen offset:1024 sc1
buffer_load_dwordx4 v[100:103], v19, s[12:15], s38 offen offset:1024 sc1
buffer_load_dwordx4 v[104:107], v6, s[12:15], s39 offen offset:0 sc1
buffer_load_dwordx4 v[108:111], v19, s[12:15], s39 offen offset:0 sc1
buffer_load_dwordx4 v[112:115], v6, s[12:15], s39 offen offset:1024 sc1
buffer_load_dwordx4 v[116:119], v19, s[12:15], s39 offen offset:1024 sc1
s_waitcnt vmcnt(8)
s_branch L_o13_b
L_o13_a:
s_waitcnt vmcnt(0)
L_o13_b:
v_max3_u32 v2, v72, v76, v80
v_max_u32 v2, v2, v84
v_cmp_eq_u32 vcc, -1, v2
s_cbranch_vccnz L_o13_rt
s_branch L_o13_ok
L_o14_rt:
s_add_u32 s78, s78, 1
s_cmp_gt_u32 s78, 65536
s_cbranch_scc1 L_o14_ok
buffer_load_dwordx4 v[88:91], v6, s[12:15], s38 offen offset:0 sc1
buffer_load_dwordx4 v[92:95], v19, s[12:15], s38 offen offset:0 sc1
buffer_load_dwordx4 v[96:99], v6, s[12:15], s38 offen offset:1024 sc1
buffer_load_dwordx4 v[100:103], v19, s[12:15], s38 offen offset:1024 sc1
s_waitcnt vmcnt(4)
v_max3_u32 v2, v104, v108, v112
v_max3_u32 v2, v2, v116, v116
v_cmp_eq_u32 vcc, -1, v2
s_cbranch_vccz L_o14_a
buffer_load_dwordx4 v[104:107], v6, s[12:15], s39 offen offset:0 sc1
buffer_load_dwordx4 v[108:111], v19, s[12:15], s39 offen offset:0 sc1
buffer_load_dwordx4 v[112:115], v6, s[12:15], s39 offen offset:1024 sc1
buffer_load_dwordx4 v[116:119], v19, s[12:15], s39 offen offset:1024 sc1
s_waitcnt vmcnt(4)
s_branch L_o14_b
L_o14_a:
s_waitcnt vmcnt(0)
L_o14_b:
v_max3_u32 v2, v88, v92, v96
v_max_u32 v2, v2, v100
v_cmp_eq_u32 vcc, -1, v2
s_cbranch_vccnz L_o14_rt
s_branch L_o14_ok
L_o15_rt:
s_add_u32 s78, s78, 1
s_cmp_gt_u32 s78, 65536
s_cbranch_scc1 L_o15_ok
buffer_load_dwordx4 v[104:107], v6, s[12:15], s39 offen offset:0 sc1
buffer_load_dwordx4 v[108:111], v19, s[12:15], s39 offen offset:0 sc1
buffer_load_dwordx4 v[112:115], v6, s[12:15], s39 offen offset:1024 sc1
buffer_load_dwordx4 v[116:119], v19, s[12:15], s39 offen offset:1024 sc1
s_waitcnt vmcnt(0)
L_o15_b:
v_max3_u32 v2, v104, v108, v112
v_max_u32 v2, v2, v116
v_cmp_eq_u32 vcc, -1, v2
s_cbranch_vccnz L_o15_rt
s_branch L_o15_ok
L_stp_s:
buffer_store_dwordx4 v[72:75], v144, s[12:15], s72 offen offset:0 sc1
buffer_store_dwordx4 v[76:79], v144, s[12:15], s72 offen offset:256 sc1
s_branch L_stp_d
L_pad19:
s_branch L_retG
L_st_rt:
s_add_u32 s78, s78, 1
s_cmp_gt_u32 s78, 65536
s_cbranch_scc1 L_st_ok
v_cmp_ne_u32 vcc, s68, v99
s_cbranch_vccz L_st_p0
s_add_u32 s70, s75, 0
buffer_load_dwordx4 v[96:99], v145, s[12:15], s70 offen sc1
L_st_p0:
v_cmp_ne_u32 vcc, s68, v103
s_cbranch_vccz L_st_p1
s_add_u32 s70, s75, 4096
buffer_load_dwordx4 v[100:103], v145, s[12:15], s70 offen sc1
L_st_p1:
v_cmp_ne_u32 vcc, s68, v107
s_cbranch_vccz L_st_p2
s_add_u32 s70, s75, 8192
buffer_load_dwordx4 v[104:107], v145, s[12:15], s70 offen sc1
L_st_p2:
v_cmp_ne_u32 vcc, s68, v111
s_cbranch_vccz L_st_p3
s_add_u32 s70, s75, 12288
buffer_load_dwordx4 v[108:111], v145, s[12:15], s70 offen sc1
L_st_p3:
v_cmp_ne_u32 vcc, s68, v115
s_cbranch_vccz L_st_p4
s_add_u32 s70, s75, 16384
buffer_load_dwordx4 v[112:115], v145, s[12:15], s70 offen sc1
L_st_p4:
v_cmp_ne_u32 vcc, s68, v119
s_cbranch_vccz L_st_p5
s_add_u32 s70, s75, 20480
buffer_load_dwordx4 v[116:119], v145, s[12:15], s70 offen sc1
L_st_p5:
v_cmp_ne_u32 vcc, s68, v123
s_cbranch_vccz L_st_p6
s_add_u32 s70, s75, 24576
buffer_load_dwordx4 v[120:123], v145, s[12:15], s70 offen sc1
L_st_p6:
v_cmp_ne_u32 vcc, s68, v127
s_cbranch_vccz L_st_p7
s_add_u32 s70, s75, 28672
buffer_load_dwordx4 v[124:127], v145, s[12:15], s70 offen sc1
L_st_p7:
s_waitcnt vmcnt(0)
s_branch L_st_chk
L_outw:
s_waitcnt lgkmcnt(2)
v_add_u32 v2, 0, v12
v_cmp_ne_u32_e64 vcc, s94, v2
v_cmp_ne_u32_e64 s[92:93], s95, v2
s_add_u32 s70, s74, 0
s_and_b64 exec, vcc, s[92:93]
buffer_store_dwordx4 v[96:99], v11, s[20:23], s70 offen sc1
s_mov_b64 exec, -1
v_add_u32 v2, 8, v12
v_cmp_ne_u32 vcc, s94, v2
v_cmp_ne_u32_e64 s[92:93], s95, v2
s_add_u32 s70, s74, 16384
s_and_b64 exec, vcc, s[92:93]
buffer_store_dwordx4 v[100:103], v11, s[20:23], s70 offen sc1
s_mov_b64 exec, -1
v_mov_b32 v2, 161792
s_barrier
ds_read_b32 v3, v2
ds_read_b32 v4, v2 offset:16
s_waitcnt lgkmcnt(0)
v_readfirstlane_b32 s72, v3
v_readfirstlane_b32 s73, v4
s_cmp_eq_u32 s85, s72
s_cselect_b32 s70, 1, 0
s_cmp_eq_u32 s85, s73
s_cselect_b32 s70, 1, s70
s_cmp_eq_u32 s70, 1
s_cselect_b32 s85, 255, s94
s_cselect_b32 s94, s94, 255
s_cmp_eq_u32 s86, s72
s_cselect_b32 s70, 1, 0
s_cmp_eq_u32 s86, s73
s_cselect_b32 s70, 1, s70
s_cmp_eq_u32 s70, 1
s_cselect_b32 s86, 255, s95
s_cselect_b32 s95, s95, 255
s_barrier
v_add_u32 v2, 0, v12
v_cmp_eq_u32 vcc, s85, v2
v_cmp_eq_u32_e64 s[92:93], s86, v2
s_add_u32 s70, s74, 0
s_or_b64 exec, vcc, s[92:93]
s_cbranch_execz L_nodw0
buffer_store_dwordx4 v[96:99], v11, s[20:23], s70 offen sc1
L_nodw0:
s_mov_b64 exec, -1
v_add_u32 v2, 8, v12
v_cmp_eq_u32 vcc, s85, v2
v_cmp_eq_u32_e64 s[92:93], s86, v2
s_add_u32 s70, s74, 16384
s_or_b64 exec, vcc, s[92:93]
s_cbranch_execz L_nodw1
buffer_store_dwordx4 v[100:103], v11, s[20:23], s70 offen sc1
L_nodw1:
s_mov_b64 exec, -1
v_add_u32 v2, 16, v12
v_cmp_ne_u32 vcc, s94, v2
v_cmp_ne_u32_e64 s[92:93], s95, v2
s_add_u32 s70, s74, 32768
s_and_b64 exec, vcc, s[92:93]
buffer_store_dwordx4 v[104:107], v11, s[20:23], s70 offen sc1
s_mov_b64 exec, -1
v_add_u32 v2, 24, v12
v_cmp_ne_u32 vcc, s94, v2
v_cmp_ne_u32_e64 s[92:93], s95, v2
s_add_u32 s70, s74, 49152
s_and_b64 exec, vcc, s[92:93]
buffer_store_dwordx4 v[108:111], v11, s[20:23], s70 offen sc1
s_mov_b64 exec, -1
s_branch L_outd
L_fin:
.section .rodata,"a"
.p2align 6
.amdhsa_kernel sequential_preLN__linear_attn_block__moe_arch_mod__prompt_kernel
  .amdhsa_next_free_vgpr 256
  .amdhsa_next_free_sgpr 102
  .amdhsa_accum_offset 152
  .amdhsa_group_segment_fixed_size 0
  .amdhsa_kernarg_size 88
  .amdhsa_user_sgpr_count 2
  .amdhsa_user_sgpr_kernarg_segment_ptr 1
  .amdhsa_system_sgpr_workgroup_id_x 1
  .amdhsa_float_denorm_mode_32 3
.end_amdhsa_kernel
```
